```python
import torch

def _softmax(x, axis=-1):
    return torch.softmax(x, dim=axis)
def _gelu(x):
    return torch.nn.functional.gelu(x, approximate="tanh")
def _silu(x):
    return torch.nn.functional.silu(x)
def _sigmoid(x):
    return torch.sigmoid(x)
def _layernorm(x, axis=-1, eps=1e-5):
    m = x.mean(dim=axis, keepdim=True)
    v = x.var(dim=axis, keepdim=True, unbiased=False)
    return (x - m) / torch.sqrt(v + eps)
def _scatter_add(tgt, idx, src, axis=0):
    return tgt.clone().index_add_(axis, idx, src)
def _segment_sum(src, seg, n):
    out = torch.zeros((n,) + src.shape[1:], dtype=src.dtype)
    return out.index_add_(0, seg, src)
def _pad(x, pw):
    flat = tuple(v for pair in reversed(pw) for v in pair)
    return torch.nn.functional.pad(x, flat)

kernel_name = 'standalone__mha_softmax__near_ridge'

def setup_inputs():

    _w = (lambda a: (lambda t: t.to(torch.bfloat16) if t.is_floating_point() else t)(torch.as_tensor(a)))
    B, H, Sq, Sk, D = 8, 32, 608, 512, 128
    return {
        "q": _w((lambda *s: torch.randn(*s, dtype=torch.bfloat16) * 0.8)(B, H, Sq, D)),
        "k": _w((lambda *s: torch.randn(*s, dtype=torch.bfloat16) * 0.8)(B, H, Sk, D)),
        "v": _w((lambda *s: torch.randn(*s, dtype=torch.bfloat16) * 0.05)(B, H, Sk, D)),
    }

def reference(q, k, v):
    scale = q.shape[-1] ** -0.5
    scores = torch.einsum("bhqd,bhkd->bhqk", q, k) * scale
    p = _softmax(scores, axis=-1)
    return torch.einsum("bhqk,bhkd->bhqd", p, v)
```

```asm
; @launch grid=(256,1,1) block=(256,1,1) lds=163840
.amdgcn_target "amdgcn-amd-amdhsa--gfx950"
.text
.globl standalone__mha_softmax__near_ridge_kernel
.p2align 8
.type standalone__mha_softmax__near_ridge_kernel,@function
standalone__mha_softmax__near_ridge_kernel:
s_cmp_lt_u32 s2, 256
s_cbranch_scc1 L_go
s_endpgm
L_go:
s_load_dwordx4 s[44:47], s[0:1], 0
s_load_dwordx4 s[48:51], s[0:1], 16
v_lshrrev_b32 v1, 6, v0
v_and_b32 v28, 15, v0
v_bfe_u32 v29, v0, 4, 2
v_readfirstlane_b32 s33, v1
s_getpc_b64 s[36:37]
L_pc:
s_lshr_b32 s60, s2, 4
s_lshl_b32 s60, s60, 12
s_mov_b32 s61, L_main0-L_pc
s_bitcmp1_b32 s2, 3
s_cselect_b32 s61, L_main1-L_pc, s61
s_add_u32 s60, s60, s61
v_min_u32 v93, 7, v28
v_lshl_add_u32 v93, v1, 3, v93
v_lshlrev_b32 v93, 7, v93
v_add_u32 v93, s60, v93
v_min_u32 v93, L_fast_end-L_pc, v93
global_load_dword v92, v93, s[36:37]
s_and_b32 s3, s2, 7
s_and_b32 s35, s2, 0xf0
s_add_u32 s52, s35, s3
s_add_u32 s53, s52, 8
s_lshl_b32 s28, s52, 17
s_lshl_b32 s29, s53, 17
s_mul_i32 s56, s52, 155648
s_mul_i32 s57, s53, 155648
v_lshl_add_u32 v30, v1, 3, v29
v_and_b32 v31, 15, v30
v_lshlrev_b32 v30, 8, v30
v_xor_b32 v31, v31, v28
v_lshl_add_u32 v14, v31, 4, v30
v_xor_b32 v15, 64, v14
v_lshlrev_b32 v31, 1, v29
v_xor_b32 v31, v31, v28
v_lshl_add_u32 v16, v31, 4, v30
v_xor_b32 v17, 0x80, v16
s_mul_i32 s62, s33, 20480
s_lshl_b32 s32, s33, 11
s_add_u32 s54, s62, 16384
s_lshl_b32 s55, s33, 14
s_add_u32 s55, s55, 81920
s_lshr_b32 s60, s33, 1
s_lshl_b32 s60, s60, 12
s_add_u32 s60, s60, 147456
s_bitcmp1_b32 s2, 3
s_cselect_b32 s63, s55, s62
s_cselect_b32 s72, s60, s54
s_cselect_b32 s58, s62, s55
s_cselect_b32 s73, s54, s60
s_sub_u32 s74, s72, s63
s_sub_u32 s74, s74, 12288
s_add_u32 s59, s62, 77824
s_cmp_eq_u32 s33, 0
s_cselect_b32 s59, 32768, s59
v_xor_b32 v31, v28, v29
v_lshlrev_b32 v30, 8, v29
v_lshl_add_u32 v30, v31, 4, v30
v_add_u32 v248, s63, v30
v_xor_b32 v249, 0x40, v248
v_xor_b32 v250, 0x80, v248
v_xor_b32 v251, 0xc0, v248
s_waitcnt lgkmcnt(0)
s_mov_b32 s20, s46
s_mov_b32 s21, s47
s_mov_b32 s22, 0x2000000
s_mov_b32 s23, 0x20000
s_add_u32 s4, s44, s56
s_addc_u32 s5, s45, 0
s_mov_b32 s6, 155648
s_mov_b32 s7, 0x20000
s_add_u32 s30, s28, 0
s_add_u32 m0, s32, 0
s_nop 0
buffer_load_dwordx4 v14, s[20:23], s30 offen nt lds
buffer_load_dwordx4 v15, s[20:23], s30 offen offset:1024 nt lds
s_add_u32 m0, s59, 0
s_nop 0
buffer_load_dwordx4 v248, s[4:7], 0 offen offset:0 nt lds
buffer_load_dwordx4 v249, s[4:7], 0 offen offset:1024 nt lds
buffer_load_dwordx4 v250, s[4:7], 0 offen offset:2048 nt lds
buffer_load_dwordx4 v251, s[4:7], 0 offen offset:3072 nt lds
v_add_u32 v248, 4096, v248
v_add_u32 v249, 4096, v249
v_add_u32 v250, 4096, v250
v_add_u32 v251, 4096, v251
s_add_u32 m0, s59, 4096
s_nop 0
buffer_load_dwordx4 v248, s[4:7], 0 offen offset:0 nt lds
buffer_load_dwordx4 v249, s[4:7], 0 offen offset:1024 nt lds
buffer_load_dwordx4 v250, s[4:7], 0 offen offset:2048 nt lds
buffer_load_dwordx4 v251, s[4:7], 0 offen offset:3072 nt lds
s_mov_b32 s24, s48
s_mov_b32 s25, s49
s_mov_b32 s26, 0x2000000
s_mov_b32 s27, 0x20000
s_add_u32 s8, s44, s57
s_addc_u32 s9, s45, 0
s_mov_b32 s10, 155648
s_mov_b32 s11, 0x20000
s_add_u32 s12, s50, s56
s_addc_u32 s13, s51, 0
s_mov_b32 s14, 155648
s_mov_b32 s15, 0x20000
s_add_u32 s16, s50, s57
s_addc_u32 s17, s51, 0
s_mov_b32 s18, 155648
s_mov_b32 s19, 0x20000
s_mov_b32 s34, 0x49800000
s_mov_b32 s35, 0x2b800000
s_mov_b64 s[40:41], 0
s_mov_b64 s[42:43], 0
s_and_b32 s76, s33, 1
s_lshl_b32 s77, s76, 13
s_lshl_b32 s76, s76, 7
s_xor_b32 s75, s76, 0x80
s_add_u32 s78, s77, s76
v_lshlrev_b32 v94, 8, v28
v_lshl_add_u32 v18, v29, 4, v94
v_lshl_add_u32 v2, v31, 4, v94
v_xor_b32 v3, 0x40, v2
v_xor_b32 v4, 0x80, v2
v_xor_b32 v5, 0xc0, v2
v_add_u32 v252, s59, v2
v_add_u32 v253, s59, v3
v_add_u32 v254, s59, v4
v_add_u32 v255, s59, v5
s_lshl_b32 s79, s33, 13
s_add_u32 s79, s79, 131072
v_bfe_u32 v93, v0, 3, 3
v_and_b32 v94, 7, v0
v_lshlrev_b32 v94, 4, v94
v_lshl_add_u32 v19, v93, 8, v94
v_mul_u32_u24 v93, 144, v93
v_add3_u32 v21, v93, v94, s79
v_mul_u32_u24 v93, 144, v28
v_lshl_add_u32 v93, v29, 3, v93
v_add_u32 v20, s79, v93
v_lshrrev_b32 v93, 2, v28
v_lshl_add_u32 v93, v29, 2, v93
v_and_b32 v94, 7, v93
v_lshlrev_b32 v94, 5, v94
v_and_b32 v95, 3, v28
v_lshlrev_b32 v95, 3, v95
v_xor_b32 v94, v94, v95
v_lshl_add_u32 v94, v93, 8, v94
v_add_u32 v6, 0x10000, v94
v_xor_b32 v7, 0x20, v6
v_xor_b32 v8, 0x40, v6
v_xor_b32 v9, 0x60, v6
v_xor_b32 v10, 0x80, v6
v_xor_b32 v11, 0xa0, v6
v_xor_b32 v12, 0xc0, v6
v_xor_b32 v13, 0xe0, v6
v_and_b32 v93, 3, v28
v_cmp_eq_u32 vcc, 0, v93
v_mov_b32 v94, 0x3f803f80
s_nop 0
v_cndmask_b32 v93, 0, v94, vcc
v_accvgpr_write_b32 a244, v93
v_accvgpr_write_b32 a245, v93
v_accvgpr_write_b32 a246, v93
v_accvgpr_write_b32 a247, v93
v_and_b32 v93, 63, v0
s_lshr_b32 s80, s33, 1
s_lshl_b32 s80, s80, 16
s_add_u32 s80, s80, s77
s_bitcmp1_b32 s2, 3
s_cselect_b32 s80, s79, s80
v_lshl_add_u32 v29, v93, 4, s80
v_xor_b32 v30, 0x2000, v29
v_add_u32 v248, 4096, v248
v_add_u32 v249, 4096, v249
v_add_u32 v250, 4096, v250
v_add_u32 v251, 4096, v251
s_add_u32 m0, s59, 8192
s_nop 0
buffer_load_dwordx4 v248, s[4:7], 0 offen offset:0 nt lds
buffer_load_dwordx4 v249, s[4:7], 0 offen offset:1024 nt lds
buffer_load_dwordx4 v250, s[4:7], 0 offen offset:2048 nt lds
buffer_load_dwordx4 v251, s[4:7], 0 offen offset:3072 nt lds
s_add_u32 s31, s28, 0
s_add_u32 m0, s32, 65536
s_nop 0
buffer_load_dwordx4 v16, s[24:27], s31 offen nt lds
buffer_load_dwordx4 v17, s[24:27], s31 offen offset:1024 nt lds
s_add_u32 s30, s28, 8192
s_add_u32 m0, s32, 8192
s_nop 0
buffer_load_dwordx4 v14, s[20:23], s30 offen nt lds
buffer_load_dwordx4 v15, s[20:23], s30 offen offset:1024 nt lds
s_add_u32 s31, s28, 8192
s_add_u32 m0, s32, 73728
s_nop 0
buffer_load_dwordx4 v16, s[24:27], s31 offen nt lds
buffer_load_dwordx4 v17, s[24:27], s31 offen offset:1024 nt lds
s_mov_b64 exec, 0
s_bitcmp1_b32 s2, 3
s_cbranch_scc1 L_walk1
s_cmp_eq_u32 s33, 0
s_cbranch_scc1 L_pad0_0
s_cmp_eq_u32 s33, 1
s_cbranch_scc1 L_pad0_1
s_cmp_eq_u32 s33, 2
s_cbranch_scc1 L_pad0_2
s_branch L_pad0_3
L_walk1:
s_cmp_eq_u32 s33, 0
s_cbranch_scc1 L_pad1_0
s_cmp_eq_u32 s33, 1
s_cbranch_scc1 L_pad1_1
s_cmp_eq_u32 s33, 2
s_cbranch_scc1 L_pad1_2
s_branch L_pad1_3
L_back:
s_mov_b64 exec, -1
s_waitcnt vmcnt(18)
s_barrier
s_bitcmp1_b32 s2, 3
s_cbranch_scc1 L_main1
s_branch L_main0
.p2align 12
L_main0:
L_pad0_0:
s_cbranch_execz L_pad0_4
s_waitcnt vmcnt(14)
ds_read_b128 a[0:3], v252 offset:0
ds_read_b128 a[160:163], v2 offset:0
ds_read_b128 a[4:7], v253 offset:0
ds_read_b128 a[164:167], v3 offset:0
ds_read_b128 a[8:11], v254 offset:0
ds_read_b128 a[168:171], v4 offset:0
ds_read_b128 a[12:15], v255 offset:0
ds_read_b128 a[172:175], v5 offset:0
s_waitcnt lgkmcnt(6)
v_mfma_f32_16x16x32_bf16 v[32:35], a[160:163], a[0:3], 0
s_waitcnt vmcnt(10) lgkmcnt(4)
s_add_u32 m0, s59, 12288
ds_read_b128 a[16:19], v252 offset:4096
ds_read_b128 a[20:23], v253 offset:4096
ds_read_b128 a[24:27], v254 offset:4096
ds_read_b128 a[28:31], v255 offset:4096
v_mfma_f32_16x16x32_bf16 v[32:35], a[164:167], a[4:7], v[32:35]
s_waitcnt lgkmcnt(6)
s_add_u32 s30, s28, 16384
ds_read_b128 a[176:179], v2 offset:4096
v_add_u32 v248, 4096, v248
v_mfma_f32_16x16x32_bf16 v[32:35], a[168:171], a[8:11], v[32:35]
s_waitcnt lgkmcnt(5)
s_add_u32 s31, s28, 16384
ds_read_b128 a[180:183], v3 offset:4096
v_add_u32 v249, 4096, v249
v_mfma_f32_16x16x32_bf16 v[32:35], a[172:175], a[12:15], v[32:35]
s_waitcnt lgkmcnt(5)
s_add_u32 s38, s58, 0
buffer_load_dwordx4 v248, s[4:7], 0 offen offset:0 nt lds
v_add_u32 v250, 4096, v250
v_mfma_f32_16x16x32_bf16 v[36:39], a[160:163], a[16:19], 0
s_waitcnt vmcnt(7) lgkmcnt(4)
ds_read_b128 a[32:35], v252 offset:8192
ds_read_b128 a[36:39], v253 offset:8192
ds_read_b128 a[40:43], v254 offset:8192
ds_read_b128 a[44:47], v255 offset:8192
v_mfma_f32_16x16x32_bf16 v[36:39], a[164:167], a[20:23], v[36:39]
s_waitcnt lgkmcnt(7)
ds_read_b128 a[184:187], v4 offset:4096
v_add_u32 v251, 4096, v251
v_mfma_f32_16x16x32_bf16 v[36:39], a[168:171], a[24:27], v[36:39]
s_waitcnt lgkmcnt(7)
ds_read_b128 a[188:191], v5 offset:4096
v_max3_f32 v23, v32, v33, v34
v_mfma_f32_16x16x32_bf16 v[36:39], a[172:175], a[28:31], v[36:39]
s_waitcnt lgkmcnt(5)
v_max_f32 v23, v23, v35
v_mov_b32 v93, v23
v_mfma_f32_16x16x32_bf16 v[40:43], a[160:163], a[32:35], 0
s_waitcnt lgkmcnt(4)
v_permlane32_swap_b32 v93, v23
v_mfma_f32_16x16x32_bf16 v[40:43], a[164:167], a[36:39], v[40:43]
s_waitcnt lgkmcnt(3)
v_max_f32 v23, v23, v93
v_mov_b32 v93, v23
v_mfma_f32_16x16x32_bf16 v[40:43], a[168:171], a[40:43], v[40:43]
s_waitcnt lgkmcnt(2)
v_permlane16_swap_b32 v93, v23
v_max_f32 v23, v23, v93
v_mul_f32 v23, 0xbe0293ee, v23
v_fmamk_f32 v32, v32, 0x3e0293ee, v23
v_fmamk_f32 v33, v33, 0x3e0293ee, v23
v_fmamk_f32 v34, v34, 0x3e0293ee, v23
v_exp_f32 v32, v32
v_exp_f32 v33, v33
v_exp_f32 v34, v34
v_fmamk_f32 v35, v35, 0x3e0293ee, v23
v_exp_f32 v35, v35
v_mfma_f32_16x16x32_bf16 v[40:43], a[172:175], a[44:47], v[40:43]
s_waitcnt vmcnt(1)
buffer_load_dwordx4 v249, s[4:7], 0 offen offset:1024 nt lds
v_cvt_pk_bf16_f32 v48, v32, v33
v_cvt_pk_bf16_f32 v49, v34, v35
v_mfma_f32_16x16x32_bf16 v[32:35], a[176:179], a[0:3], 0
s_barrier
v_max3_f32 v24, v36, v37, v38
v_max_f32 v24, v24, v39
v_mov_b32 v93, v24
v_mfma_f32_16x16x32_bf16 v[32:35], a[180:183], a[4:7], v[32:35]
s_waitcnt lgkmcnt(1)
v_permlane32_swap_b32 v93, v24
v_max_f32 v24, v24, v93
v_mov_b32 v93, v24
v_mfma_f32_16x16x32_bf16 v[32:35], a[184:187], a[8:11], v[32:35]
s_waitcnt lgkmcnt(0)
v_permlane16_swap_b32 v93, v24
v_max_f32 v24, v24, v93
v_mul_f32 v24, 0xbe0293ee, v24
v_fmamk_f32 v36, v36, 0x3e0293ee, v24
v_fmamk_f32 v37, v37, 0x3e0293ee, v24
v_fmamk_f32 v38, v38, 0x3e0293ee, v24
v_exp_f32 v36, v36
v_exp_f32 v37, v37
v_exp_f32 v38, v38
v_fmamk_f32 v39, v39, 0x3e0293ee, v24
v_exp_f32 v39, v39
v_mfma_f32_16x16x32_bf16 v[32:35], a[188:191], a[12:15], v[32:35]
v_cvt_pk_bf16_f32 v52, v36, v37
v_cvt_pk_bf16_f32 v53, v38, v39
v_mfma_f32_16x16x32_bf16 v[36:39], a[176:179], a[16:19], 0
ds_read_b128 a[160:163], v2 offset:8192
v_max3_f32 v25, v40, v41, v42
v_max_f32 v25, v25, v43
v_mov_b32 v93, v25
v_mfma_f32_16x16x32_bf16 v[36:39], a[180:183], a[20:23], v[36:39]
buffer_load_dwordx4 v250, s[4:7], 0 offen offset:2048 nt lds
ds_read_b128 a[164:167], v3 offset:8192
v_permlane32_swap_b32 v93, v25
v_max_f32 v25, v25, v93
v_mov_b32 v93, v25
v_mfma_f32_16x16x32_bf16 v[36:39], a[184:187], a[24:27], v[36:39]
ds_read_b128 a[168:171], v4 offset:8192
v_permlane16_swap_b32 v93, v25
v_max_f32 v25, v25, v93
v_mul_f32 v25, 0xbe0293ee, v25
v_fmamk_f32 v40, v40, 0x3e0293ee, v25
v_fmamk_f32 v41, v41, 0x3e0293ee, v25
v_fmamk_f32 v42, v42, 0x3e0293ee, v25
v_exp_f32 v40, v40
v_exp_f32 v41, v41
v_exp_f32 v42, v42
v_fmamk_f32 v43, v43, 0x3e0293ee, v25
v_exp_f32 v43, v43
v_mfma_f32_16x16x32_bf16 v[36:39], a[188:191], a[28:31], v[36:39]
ds_read_b128 a[172:175], v5 offset:8192
v_cvt_pk_bf16_f32 v56, v40, v41
v_cvt_pk_bf16_f32 v57, v42, v43
v_mfma_f32_16x16x32_bf16 v[40:43], a[176:179], a[32:35], 0
ds_read_b64_tr_b16 a[192:193], v6 offset:0
ds_read_b64_tr_b16 a[194:195], v6 offset:4096
v_mfma_f32_16x16x32_bf16 v[40:43], a[180:183], a[36:39], v[40:43]
ds_read_b64_tr_b16 a[196:197], v7 offset:0
ds_read_b64_tr_b16 a[198:199], v7 offset:4096
v_mfma_f32_16x16x32_bf16 v[40:43], a[184:187], a[40:43], v[40:43]
ds_read_b64_tr_b16 a[200:201], v8 offset:0
ds_read_b64_tr_b16 a[202:203], v8 offset:4096
v_fmamk_f32 v32, v32, 0x3e0293ee, v23
v_fmamk_f32 v33, v33, 0x3e0293ee, v23
v_fmamk_f32 v34, v34, 0x3e0293ee, v23
v_exp_f32 v32, v32
v_exp_f32 v33, v33
v_exp_f32 v34, v34
v_fmamk_f32 v35, v35, 0x3e0293ee, v23
v_exp_f32 v35, v35
v_mfma_f32_16x16x32_bf16 v[40:43], a[188:191], a[44:47], v[40:43]
s_waitcnt lgkmcnt(8)
buffer_load_dwordx4 v251, s[4:7], 0 offen offset:3072 nt lds
ds_read_b64_tr_b16 a[204:205], v9 offset:0
ds_read_b64_tr_b16 a[206:207], v9 offset:4096
v_cvt_pk_bf16_f32 v50, v32, v33
v_cvt_pk_bf16_f32 v51, v34, v35
v_mfma_f32_16x16x32_bf16 v[32:35], a[160:163], a[0:3], 0
s_add_u32 m0, s59, 16384
ds_read_b128 a[176:179], v2 offset:12288
v_add_u32 v248, s74, v248
v_mfma_f32_16x16x32_bf16 v[32:35], a[164:167], a[4:7], v[32:35]
s_waitcnt lgkmcnt(10)
ds_read_b128 a[180:183], v3 offset:12288
v_fmamk_f32 v36, v36, 0x3e0293ee, v24
v_mfma_f32_16x16x32_bf16 v[32:35], a[168:171], a[8:11], v[32:35]
s_waitcnt lgkmcnt(10)
v_exp_f32 v36, v36
v_mfma_f32_16x16x32_bf16 v[32:35], a[172:175], a[12:15], v[32:35]
s_waitcnt lgkmcnt(8)
buffer_load_dwordx4 v248, s[4:7], 0 offen offset:0 nt lds
v_fmamk_f32 v37, v37, 0x3e0293ee, v24
v_mfma_f32_16x16x32_bf16 v[96:99], a[192:195], v[48:51], 0
s_waitcnt lgkmcnt(6)
v_exp_f32 v37, v37
v_mfma_f32_16x16x32_bf16 v[100:103], a[196:199], v[48:51], 0
s_waitcnt lgkmcnt(4)
v_fmamk_f32 v38, v38, 0x3e0293ee, v24
v_fmamk_f32 v39, v39, 0x3e0293ee, v24
v_mfma_f32_16x16x32_bf16 v[104:107], a[200:203], v[48:51], 0
s_waitcnt lgkmcnt(2)
v_exp_f32 v38, v38
v_mfma_f32_16x16x32_bf16 v[108:111], a[204:207], v[48:51], 0
v_exp_f32 v39, v39
v_mfma_f32_16x16x32_bf16 a[224:227], a[244:247], v[48:51], 0
v_cvt_pk_bf16_f32 v54, v36, v37
v_cvt_pk_bf16_f32 v55, v38, v39
v_mfma_f32_16x16x32_bf16 v[36:39], a[160:163], a[16:19], 0
ds_read_b128 a[184:187], v4 offset:12288
v_add_u32 v249, s74, v249
v_mfma_f32_16x16x32_bf16 v[36:39], a[164:167], a[20:23], v[36:39]
buffer_load_dwordx4 v249, s[4:7], 0 offen offset:1024 nt lds
v_fmamk_f32 v40, v40, 0x3e0293ee, v25
v_mfma_f32_16x16x32_bf16 v[36:39], a[168:171], a[24:27], v[36:39]
v_exp_f32 v40, v40
v_mfma_f32_16x16x32_bf16 v[36:39], a[172:175], a[28:31], v[36:39]
ds_read_b128 a[188:191], v5 offset:12288
v_fmamk_f32 v41, v41, 0x3e0293ee, v25
v_mfma_f32_16x16x32_bf16 v[128:131], a[192:195], v[52:55], 0
v_exp_f32 v41, v41
v_mfma_f32_16x16x32_bf16 v[132:135], a[196:199], v[52:55], 0
ds_read_b64_tr_b16 a[208:209], v10 offset:0
v_fmamk_f32 v42, v42, 0x3e0293ee, v25
v_mfma_f32_16x16x32_bf16 v[136:139], a[200:203], v[52:55], 0
v_exp_f32 v42, v42
v_fmamk_f32 v43, v43, 0x3e0293ee, v25
v_exp_f32 v43, v43
v_mfma_f32_16x16x32_bf16 v[140:143], a[204:207], v[52:55], 0
v_add_u32 v250, s74, v250
v_cvt_pk_bf16_f32 v58, v40, v41
v_cvt_pk_bf16_f32 v59, v42, v43
v_mfma_f32_16x16x32_bf16 v[40:43], a[160:163], a[32:35], 0
buffer_load_dwordx4 v250, s[4:7], 0 offen offset:2048 nt lds
v_add_u32 v251, s74, v251
v_mfma_f32_16x16x32_bf16 v[40:43], a[164:167], a[36:39], v[40:43]
ds_read_b64_tr_b16 a[210:211], v10 offset:4096
v_fmamk_f32 v32, v32, 0x3e0293ee, v23
v_mfma_f32_16x16x32_bf16 v[40:43], a[168:171], a[40:43], v[40:43]
ds_read_b64_tr_b16 a[212:213], v11 offset:0
v_fmamk_f32 v33, v33, 0x3e0293ee, v23
v_mfma_f32_16x16x32_bf16 v[40:43], a[172:175], a[44:47], v[40:43]
ds_read_b64_tr_b16 a[214:215], v11 offset:4096
v_fmamk_f32 v34, v34, 0x3e0293ee, v23
v_mfma_f32_16x16x32_bf16 v[160:163], a[192:195], v[56:59], 0
buffer_load_dwordx4 v251, s[4:7], 0 offen offset:3072 nt lds
v_fmamk_f32 v35, v35, 0x3e0293ee, v23
v_mfma_f32_16x16x32_bf16 v[164:167], a[196:199], v[56:59], 0
s_add_u32 m0, s32, 16384
v_exp_f32 v32, v32
v_mfma_f32_16x16x32_bf16 v[168:171], a[200:203], v[56:59], 0
v_exp_f32 v33, v33
v_mfma_f32_16x16x32_bf16 v[172:175], a[204:207], v[56:59], 0
ds_read_b64_tr_b16 a[216:217], v12 offset:0
ds_read_b64_tr_b16 a[218:219], v12 offset:4096
v_exp_f32 v34, v34
v_exp_f32 v35, v35
v_mfma_f32_16x16x32_bf16 a[228:231], a[244:247], v[52:55], 0
s_waitcnt lgkmcnt(5)
ds_read_b64_tr_b16 a[220:221], v13 offset:0
ds_read_b64_tr_b16 a[222:223], v13 offset:4096
v_cvt_pk_bf16_f32 v60, v32, v33
v_cvt_pk_bf16_f32 v61, v34, v35
v_mfma_f32_16x16x32_bf16 v[32:35], a[176:179], a[0:3], 0
ds_read_b128 a[160:163], v2 offset:0
v_fmamk_f32 v36, v36, 0x3e0293ee, v24
v_mfma_f32_16x16x32_bf16 v[32:35], a[180:183], a[4:7], v[32:35]
buffer_load_dwordx4 v14, s[20:23], s30 offen nt lds
v_fmamk_f32 v37, v37, 0x3e0293ee, v24
v_mfma_f32_16x16x32_bf16 v[32:35], a[184:187], a[8:11], v[32:35]
v_exp_f32 v36, v36
v_mfma_f32_16x16x32_bf16 v[32:35], a[188:191], a[12:15], v[32:35]
s_waitcnt lgkmcnt(5)
v_exp_f32 v37, v37
v_mfma_f32_16x16x32_bf16 v[112:115], a[208:211], v[48:51], 0
ds_read_b128 a[164:167], v3 offset:0
v_fmamk_f32 v38, v38, 0x3e0293ee, v24
v_mfma_f32_16x16x32_bf16 v[116:119], a[212:215], v[48:51], 0
s_waitcnt lgkmcnt(4)
v_exp_f32 v38, v38
v_mfma_f32_16x16x32_bf16 v[120:123], a[216:219], v[48:51], 0
s_waitcnt lgkmcnt(2)
v_fmamk_f32 v39, v39, 0x3e0293ee, v24
v_exp_f32 v39, v39
v_mfma_f32_16x16x32_bf16 v[124:127], a[220:223], v[48:51], 0
v_cvt_pk_bf16_f32 v64, v36, v37
v_cvt_pk_bf16_f32 v65, v38, v39
v_mfma_f32_16x16x32_bf16 v[36:39], a[176:179], a[16:19], 0
buffer_load_dwordx4 v15, s[20:23], s30 offen offset:1024 nt lds
v_fmamk_f32 v40, v40, 0x3e0293ee, v25
v_mfma_f32_16x16x32_bf16 v[36:39], a[180:183], a[20:23], v[36:39]
s_add_u32 m0, s32, 81920
v_exp_f32 v40, v40
v_mfma_f32_16x16x32_bf16 v[36:39], a[184:187], a[24:27], v[36:39]
s_add_u32 s30, s28, 24576
ds_read_b128 a[168:171], v4 offset:0
v_fmamk_f32 v41, v41, 0x3e0293ee, v25
v_mfma_f32_16x16x32_bf16 v[36:39], a[188:191], a[28:31], v[36:39]
v_exp_f32 v41, v41
v_mfma_f32_16x16x32_bf16 v[144:147], a[208:211], v[52:55], 0
ds_read_b128 a[172:175], v5 offset:0
v_fmamk_f32 v42, v42, 0x3e0293ee, v25
v_mfma_f32_16x16x32_bf16 v[148:151], a[212:215], v[52:55], 0
v_exp_f32 v42, v42
v_mfma_f32_16x16x32_bf16 v[152:155], a[216:219], v[52:55], 0
buffer_load_dwordx4 v16, s[24:27], s31 offen nt lds
v_fmamk_f32 v43, v43, 0x3e0293ee, v25
v_mfma_f32_16x16x32_bf16 v[156:159], a[220:223], v[52:55], 0
v_exp_f32 v43, v43
v_mfma_f32_16x16x32_bf16 a[232:235], a[244:247], v[56:59], 0
v_cvt_pk_bf16_f32 v68, v40, v41
v_cvt_pk_bf16_f32 v69, v42, v43
v_mfma_f32_16x16x32_bf16 v[40:43], a[176:179], a[32:35], 0
ds_read_b64_tr_b16 a[192:193], v6 offset:8192
v_fmamk_f32 v32, v32, 0x3e0293ee, v23
v_mfma_f32_16x16x32_bf16 v[40:43], a[180:183], a[36:39], v[40:43]
ds_read_b64_tr_b16 a[194:195], v6 offset:12288
v_fmamk_f32 v33, v33, 0x3e0293ee, v23
v_mfma_f32_16x16x32_bf16 v[40:43], a[184:187], a[40:43], v[40:43]
buffer_load_dwordx4 v17, s[24:27], s31 offen offset:1024 nt lds
v_fmamk_f32 v34, v34, 0x3e0293ee, v23
v_mfma_f32_16x16x32_bf16 v[40:43], a[188:191], a[44:47], v[40:43]
s_add_u32 m0, s32, 24576
ds_read_b64_tr_b16 a[196:197], v7 offset:8192
v_fmamk_f32 v35, v35, 0x3e0293ee, v23
v_mfma_f32_16x16x32_bf16 v[176:179], a[208:211], v[56:59], 0
s_waitcnt vmcnt(8)
s_add_u32 s31, s28, 24576
ds_read_b128 a[48:51], v252 offset:12288
ds_read_b128 a[52:55], v253 offset:12288
ds_read_b128 a[56:59], v254 offset:12288
ds_read_b128 a[60:63], v255 offset:12288
v_mfma_f32_16x16x32_bf16 v[180:183], a[212:215], v[56:59], 0
ds_read_b64_tr_b16 a[198:199], v7 offset:12288
v_fmamk_f32 v36, v36, 0x3e0293ee, v24
v_mfma_f32_16x16x32_bf16 v[184:187], a[216:219], v[56:59], 0
ds_read_b64_tr_b16 a[200:201], v8 offset:8192
ds_read_b64_tr_b16 a[202:203], v8 offset:12288
v_exp_f32 v32, v32
v_exp_f32 v33, v33
v_exp_f32 v34, v34
v_exp_f32 v35, v35
v_mfma_f32_16x16x32_bf16 v[188:191], a[220:223], v[56:59], 0
s_waitcnt lgkmcnt(6)
ds_read_b64_tr_b16 a[204:205], v9 offset:8192
ds_read_b64_tr_b16 a[206:207], v9 offset:12288
v_cvt_pk_bf16_f32 v62, v32, v33
v_cvt_pk_bf16_f32 v63, v34, v35
v_mfma_f32_16x16x32_bf16 v[32:35], a[160:163], a[48:51], 0
s_waitcnt lgkmcnt(7)
buffer_load_dwordx4 v14, s[20:23], s30 offen nt lds
v_fmamk_f32 v37, v37, 0x3e0293ee, v24
v_mfma_f32_16x16x32_bf16 v[32:35], a[164:167], a[52:55], v[32:35]
s_waitcnt lgkmcnt(6)
v_exp_f32 v36, v36
v_mfma_f32_16x16x32_bf16 v[32:35], a[168:171], a[56:59], v[32:35]
s_waitcnt lgkmcnt(5)
v_exp_f32 v37, v37
v_mfma_f32_16x16x32_bf16 v[32:35], a[172:175], a[60:63], v[32:35]
ds_read_b128 a[176:179], v2 offset:4096
v_fmamk_f32 v38, v38, 0x3e0293ee, v24
v_mfma_f32_16x16x32_bf16 v[96:99], a[192:195], v[60:63], v[96:99]
s_waitcnt lgkmcnt(5)
v_exp_f32 v38, v38
v_mfma_f32_16x16x32_bf16 v[100:103], a[196:199], v[60:63], v[100:103]
s_waitcnt vmcnt(5) lgkmcnt(3)
ds_read_b128 a[64:67], v252 offset:16384
ds_read_b128 a[68:71], v253 offset:16384
ds_read_b128 a[72:75], v254 offset:16384
ds_read_b128 a[76:79], v255 offset:16384
v_mfma_f32_16x16x32_bf16 v[104:107], a[200:203], v[60:63], v[104:107]
s_waitcnt lgkmcnt(5)
buffer_load_dwordx4 v15, s[20:23], s30 offen offset:1024 nt lds
v_fmamk_f32 v39, v39, 0x3e0293ee, v24
v_mfma_f32_16x16x32_bf16 v[108:111], a[204:207], v[60:63], v[108:111]
s_add_u32 m0, s32, 90112
v_exp_f32 v39, v39
v_mfma_f32_16x16x32_bf16 a[224:227], a[244:247], v[60:63], a[224:227]
s_waitcnt lgkmcnt(3)
s_add_u32 s30, s28, 32768
v_cvt_pk_bf16_f32 v66, v36, v37
v_cvt_pk_bf16_f32 v67, v38, v39
v_mfma_f32_16x16x32_bf16 v[36:39], a[160:163], a[64:67], 0
s_waitcnt lgkmcnt(2)
ds_read_b128 a[180:183], v3 offset:4096
v_fmamk_f32 v40, v40, 0x3e0293ee, v25
v_mfma_f32_16x16x32_bf16 v[36:39], a[164:167], a[68:71], v[36:39]
s_waitcnt lgkmcnt(2)
ds_read_b128 a[184:187], v4 offset:4096
v_fmamk_f32 v41, v41, 0x3e0293ee, v25
v_mfma_f32_16x16x32_bf16 v[36:39], a[168:171], a[72:75], v[36:39]
s_waitcnt lgkmcnt(2)
ds_read_b128 a[188:191], v5 offset:4096
v_fmamk_f32 v42, v42, 0x3e0293ee, v25
v_mfma_f32_16x16x32_bf16 v[36:39], a[172:175], a[76:79], v[36:39]
buffer_load_dwordx4 v16, s[24:27], s31 offen nt lds
v_fmamk_f32 v43, v43, 0x3e0293ee, v25
v_mfma_f32_16x16x32_bf16 v[128:131], a[192:195], v[64:67], v[128:131]
v_exp_f32 v40, v40
v_mfma_f32_16x16x32_bf16 v[132:135], a[196:199], v[64:67], v[132:135]
v_exp_f32 v41, v41
v_mfma_f32_16x16x32_bf16 v[136:139], a[200:203], v[64:67], v[136:139]
v_exp_f32 v42, v42
v_exp_f32 v43, v43
v_mfma_f32_16x16x32_bf16 v[140:143], a[204:207], v[64:67], v[140:143]
s_waitcnt lgkmcnt(0)
v_cvt_pk_bf16_f32 v70, v40, v41
v_cvt_pk_bf16_f32 v71, v42, v43
v_mfma_f32_16x16x32_bf16 v[40:43], a[176:179], a[48:51], 0
s_barrier
ds_read_b64_tr_b16 a[208:209], v10 offset:8192
v_max3_f32 v26, v32, v33, v34
v_mfma_f32_16x16x32_bf16 v[40:43], a[180:183], a[52:55], v[40:43]
ds_read_b64_tr_b16 a[210:211], v10 offset:12288
v_max_f32 v26, v26, v35
v_mfma_f32_16x16x32_bf16 v[40:43], a[184:187], a[56:59], v[40:43]
ds_read_b64_tr_b16 a[212:213], v11 offset:8192
ds_read_b64_tr_b16 a[214:215], v11 offset:12288
v_mfma_f32_16x16x32_bf16 v[40:43], a[188:191], a[60:63], v[40:43]
buffer_load_dwordx4 v17, s[24:27], s31 offen offset:1024 nt lds
ds_read_b64_tr_b16 a[216:217], v12 offset:8192
ds_read_b64_tr_b16 a[218:219], v12 offset:12288
v_mfma_f32_16x16x32_bf16 v[160:163], a[192:195], v[68:71], v[160:163]
s_add_u32 m0, s32, 32768
ds_read_b64_tr_b16 a[220:221], v13 offset:8192
ds_read_b64_tr_b16 a[222:223], v13 offset:12288
v_mfma_f32_16x16x32_bf16 v[164:167], a[196:199], v[68:71], v[164:167]
s_add_u32 s31, s28, 32768
ds_read_b128 a[160:163], v2 offset:8192
v_mov_b32 v93, v26
v_mfma_f32_16x16x32_bf16 v[168:171], a[200:203], v[68:71], v[168:171]
s_nop 0
v_permlane32_swap_b32 v93, v26
v_mfma_f32_16x16x32_bf16 v[172:175], a[204:207], v[68:71], v[172:175]
ds_read_b128 a[164:167], v3 offset:8192
v_max_f32 v26, v26, v93
v_mfma_f32_16x16x32_bf16 a[228:231], a[244:247], v[64:67], a[228:231]
s_waitcnt lgkmcnt(8)
buffer_load_dwordx4 v14, s[20:23], s30 offen nt lds
v_mov_b32 v93, v26
v_mfma_f32_16x16x32_bf16 v[112:115], a[208:211], v[60:63], v[112:115]
s_waitcnt lgkmcnt(6)
v_permlane16_swap_b32 v93, v26
v_mfma_f32_16x16x32_bf16 v[116:119], a[212:215], v[60:63], v[116:119]
s_waitcnt lgkmcnt(4)
ds_read_b128 a[168:171], v4 offset:8192
v_max_f32 v26, v26, v93
v_mfma_f32_16x16x32_bf16 v[120:123], a[216:219], v[60:63], v[120:123]
s_waitcnt lgkmcnt(3)
v_mul_f32 v26, 0xbe0293ee, v26
v_fmamk_f32 v32, v32, 0x3e0293ee, v26
v_fmamk_f32 v33, v33, 0x3e0293ee, v26
v_fmamk_f32 v34, v34, 0x3e0293ee, v26
v_exp_f32 v32, v32
v_exp_f32 v33, v33
v_exp_f32 v34, v34
v_fmamk_f32 v35, v35, 0x3e0293ee, v26
v_exp_f32 v35, v35
v_mfma_f32_16x16x32_bf16 v[124:127], a[220:223], v[60:63], v[124:127]
v_cvt_pk_bf16_f32 v72, v32, v33
v_cvt_pk_bf16_f32 v73, v34, v35
v_mfma_f32_16x16x32_bf16 v[32:35], a[176:179], a[64:67], 0
ds_read_b128 a[172:175], v5 offset:8192
v_max3_f32 v27, v36, v37, v38
v_mfma_f32_16x16x32_bf16 v[32:35], a[180:183], a[68:71], v[32:35]
buffer_load_dwordx4 v15, s[20:23], s30 offen offset:1024 nt lds
v_max_f32 v27, v27, v39
v_mfma_f32_16x16x32_bf16 v[32:35], a[184:187], a[72:75], v[32:35]
s_add_u32 m0, s32, 98304
ds_read_b64_tr_b16 a[192:193], v6 offset:0
v_mov_b32 v93, v27
v_mfma_f32_16x16x32_bf16 v[32:35], a[188:191], a[76:79], v[32:35]
s_add_u32 s30, s28, 40960
v_permlane32_swap_b32 v93, v27
v_mfma_f32_16x16x32_bf16 v[144:147], a[208:211], v[64:67], v[144:147]
buffer_load_dwordx4 v16, s[24:27], s31 offen nt lds
v_max_f32 v27, v27, v93
v_mfma_f32_16x16x32_bf16 v[148:151], a[212:215], v[64:67], v[148:151]
ds_read_b64_tr_b16 a[194:195], v6 offset:4096
v_mov_b32 v93, v27
v_mfma_f32_16x16x32_bf16 v[152:155], a[216:219], v[64:67], v[152:155]
s_nop 0
v_permlane16_swap_b32 v93, v27
v_mfma_f32_16x16x32_bf16 v[156:159], a[220:223], v[64:67], v[156:159]
v_max_f32 v27, v27, v93
v_mul_f32 v27, 0xbe0293ee, v27
v_fmamk_f32 v36, v36, 0x3e0293ee, v27
v_fmamk_f32 v37, v37, 0x3e0293ee, v27
v_fmamk_f32 v38, v38, 0x3e0293ee, v27
v_exp_f32 v36, v36
v_exp_f32 v37, v37
v_exp_f32 v38, v38
v_fmamk_f32 v39, v39, 0x3e0293ee, v27
v_exp_f32 v39, v39
v_mfma_f32_16x16x32_bf16 a[232:235], a[244:247], v[68:71], a[232:235]
s_waitcnt lgkmcnt(2)
v_cvt_pk_bf16_f32 v76, v36, v37
v_cvt_pk_bf16_f32 v77, v38, v39
v_mfma_f32_16x16x32_bf16 v[36:39], a[160:163], a[48:51], 0
ds_read_b64_tr_b16 a[196:197], v7 offset:0
v_fmamk_f32 v40, v40, 0x3e0293ee, v26
v_mfma_f32_16x16x32_bf16 v[36:39], a[164:167], a[52:55], v[36:39]
ds_read_b64_tr_b16 a[198:199], v7 offset:4096
v_fmamk_f32 v41, v41, 0x3e0293ee, v26
v_mfma_f32_16x16x32_bf16 v[36:39], a[168:171], a[56:59], v[36:39]
v_exp_f32 v40, v40
v_mfma_f32_16x16x32_bf16 v[36:39], a[172:175], a[60:63], v[36:39]
v_exp_f32 v41, v41
v_mfma_f32_16x16x32_bf16 v[176:179], a[208:211], v[68:71], v[176:179]
buffer_load_dwordx4 v17, s[24:27], s31 offen offset:1024 nt lds
v_fmamk_f32 v42, v42, 0x3e0293ee, v26
v_mfma_f32_16x16x32_bf16 v[180:183], a[212:215], v[68:71], v[180:183]
s_add_u32 m0, s32, 40960
v_exp_f32 v42, v42
v_mfma_f32_16x16x32_bf16 v[184:187], a[216:219], v[68:71], v[184:187]
s_add_u32 s31, s28, 40960
ds_read_b64_tr_b16 a[200:201], v8 offset:0
ds_read_b64_tr_b16 a[202:203], v8 offset:4096
v_fmamk_f32 v43, v43, 0x3e0293ee, v26
v_exp_f32 v43, v43
v_mfma_f32_16x16x32_bf16 v[188:191], a[220:223], v[68:71], v[188:191]
ds_read_b64_tr_b16 a[204:205], v9 offset:0
ds_read_b64_tr_b16 a[206:207], v9 offset:4096
v_cvt_pk_bf16_f32 v74, v40, v41
v_cvt_pk_bf16_f32 v75, v42, v43
v_mfma_f32_16x16x32_bf16 v[40:43], a[160:163], a[64:67], 0
ds_read_b128 a[176:179], v2 offset:12288
v_fmamk_f32 v32, v32, 0x3e0293ee, v27
v_mfma_f32_16x16x32_bf16 v[40:43], a[164:167], a[68:71], v[40:43]
buffer_load_dwordx4 v14, s[20:23], s30 offen nt lds
v_fmamk_f32 v33, v33, 0x3e0293ee, v27
v_mfma_f32_16x16x32_bf16 v[40:43], a[168:171], a[72:75], v[40:43]
ds_read_b128 a[180:183], v3 offset:12288
v_fmamk_f32 v34, v34, 0x3e0293ee, v27
v_mfma_f32_16x16x32_bf16 v[40:43], a[172:175], a[76:79], v[40:43]
s_waitcnt lgkmcnt(6)
ds_read_b128 a[184:187], v4 offset:12288
v_fmamk_f32 v35, v35, 0x3e0293ee, v27
v_mfma_f32_16x16x32_bf16 v[192:195], a[192:195], v[72:75], 0
ds_read_b128 a[188:191], v5 offset:12288
v_fmamk_f32 v36, v36, 0x3e0293ee, v26
v_mfma_f32_16x16x32_bf16 v[196:199], a[196:199], v[72:75], 0
s_waitcnt lgkmcnt(4)
buffer_load_dwordx4 v15, s[20:23], s30 offen offset:1024 nt lds
v_fmamk_f32 v37, v37, 0x3e0293ee, v26
v_mfma_f32_16x16x32_bf16 v[200:203], a[200:203], v[72:75], 0
s_add_u32 m0, s32, 106496
v_exp_f32 v32, v32
v_mfma_f32_16x16x32_bf16 v[204:207], a[204:207], v[72:75], 0
s_add_u32 s30, s28, 49152
v_exp_f32 v33, v33
v_exp_f32 v34, v34
v_exp_f32 v35, v35
v_mfma_f32_16x16x32_bf16 a[236:239], a[244:247], v[72:75], 0
s_waitcnt vmcnt(10) lgkmcnt(0)
v_cvt_pk_bf16_f32 v78, v32, v33
v_cvt_pk_bf16_f32 v79, v34, v35
v_mfma_f32_16x16x32_bf16 v[32:35], a[176:179], a[48:51], 0
s_barrier
buffer_load_dwordx4 v16, s[24:27], s31 offen nt lds
v_fmamk_f32 v38, v38, 0x3e0293ee, v26
v_mfma_f32_16x16x32_bf16 v[32:35], a[180:183], a[52:55], v[32:35]
ds_read_b64_tr_b16 a[208:209], v10 offset:0
v_fmamk_f32 v39, v39, 0x3e0293ee, v26
v_mfma_f32_16x16x32_bf16 v[32:35], a[184:187], a[56:59], v[32:35]
ds_read_b64_tr_b16 a[210:211], v10 offset:4096
v_fmamk_f32 v40, v40, 0x3e0293ee, v27
v_mfma_f32_16x16x32_bf16 v[32:35], a[188:191], a[60:63], v[32:35]
buffer_load_dwordx4 v17, s[24:27], s31 offen offset:1024 nt lds
v_fmamk_f32 v41, v41, 0x3e0293ee, v27
v_mfma_f32_16x16x32_bf16 v[224:227], a[192:195], v[76:79], 0
s_add_u32 m0, s32, 49152
ds_read_b64_tr_b16 a[212:213], v11 offset:0
v_fmamk_f32 v42, v42, 0x3e0293ee, v27
v_mfma_f32_16x16x32_bf16 v[228:231], a[196:199], v[76:79], 0
s_add_u32 s31, s28, 49152
ds_read_b64_tr_b16 a[214:215], v11 offset:4096
v_fmamk_f32 v43, v43, 0x3e0293ee, v27
v_mfma_f32_16x16x32_bf16 v[232:235], a[200:203], v[76:79], 0
ds_read_b64_tr_b16 a[216:217], v12 offset:0
ds_read_b64_tr_b16 a[218:219], v12 offset:4096
v_exp_f32 v36, v36
v_exp_f32 v37, v37
v_exp_f32 v38, v38
v_exp_f32 v39, v39
v_mfma_f32_16x16x32_bf16 v[236:239], a[204:207], v[76:79], 0
ds_read_b64_tr_b16 a[220:221], v13 offset:0
ds_read_b64_tr_b16 a[222:223], v13 offset:4096
v_cvt_pk_bf16_f32 v48, v36, v37
v_cvt_pk_bf16_f32 v49, v38, v39
v_mfma_f32_16x16x32_bf16 v[36:39], a[176:179], a[64:67], 0
ds_read_b128 a[160:163], v2 offset:16384
v_fmamk_f32 v32, v32, 0x3e0293ee, v26
v_mfma_f32_16x16x32_bf16 v[36:39], a[180:183], a[68:71], v[36:39]
ds_read_b128 a[164:167], v3 offset:16384
v_fmamk_f32 v33, v33, 0x3e0293ee, v26
v_mfma_f32_16x16x32_bf16 v[36:39], a[184:187], a[72:75], v[36:39]
ds_read_b128 a[168:171], v4 offset:16384
v_fmamk_f32 v34, v34, 0x3e0293ee, v26
v_mfma_f32_16x16x32_bf16 v[36:39], a[188:191], a[76:79], v[36:39]
s_waitcnt lgkmcnt(9)
ds_read_b128 a[172:175], v5 offset:16384
v_fmamk_f32 v35, v35, 0x3e0293ee, v26
v_mfma_f32_16x16x32_bf16 v[208:211], a[208:211], v[72:75], 0
s_waitcnt lgkmcnt(8)
v_exp_f32 v40, v40
v_mfma_f32_16x16x32_bf16 v[212:215], a[212:215], v[72:75], 0
s_waitcnt lgkmcnt(6)
v_exp_f32 v41, v41
v_mfma_f32_16x16x32_bf16 v[216:219], a[216:219], v[72:75], 0
s_waitcnt lgkmcnt(4)
v_exp_f32 v42, v42
v_mfma_f32_16x16x32_bf16 v[220:223], a[220:223], v[72:75], 0
v_exp_f32 v43, v43
v_mfma_f32_16x16x32_bf16 a[240:243], a[244:247], v[76:79], 0
s_waitcnt lgkmcnt(3)
buffer_load_dwordx4 v14, s[20:23], s30 offen nt lds
v_cvt_pk_bf16_f32 v52, v40, v41
v_cvt_pk_bf16_f32 v53, v42, v43
v_mfma_f32_16x16x32_bf16 v[40:43], a[160:163], a[0:3], 0
s_waitcnt lgkmcnt(2)
ds_read_b64_tr_b16 a[192:193], v6 offset:8192
v_fmamk_f32 v36, v36, 0x3e0293ee, v27
v_mfma_f32_16x16x32_bf16 v[40:43], a[164:167], a[4:7], v[40:43]
s_waitcnt lgkmcnt(2)
ds_read_b64_tr_b16 a[194:195], v6 offset:12288
v_fmamk_f32 v37, v37, 0x3e0293ee, v27
v_mfma_f32_16x16x32_bf16 v[40:43], a[168:171], a[8:11], v[40:43]
s_waitcnt lgkmcnt(2)
L_pad0_1:
s_cbranch_execz L_pad0_5
ds_read_b64_tr_b16 a[196:197], v7 offset:8192
v_fmamk_f32 v38, v38, 0x3e0293ee, v27
v_mfma_f32_16x16x32_bf16 v[40:43], a[172:175], a[12:15], v[40:43]
ds_read_b64_tr_b16 a[198:199], v7 offset:12288
v_fmamk_f32 v39, v39, 0x3e0293ee, v27
v_mfma_f32_16x16x32_bf16 v[240:243], a[208:211], v[76:79], 0
v_exp_f32 v32, v32
v_mfma_f32_16x16x32_bf16 v[244:247], a[212:215], v[76:79], 0
v_exp_f32 v33, v33
v_mfma_f32_16x16x32_bf16 v[248:251], a[216:219], v[76:79], 0
ds_read_b64_tr_b16 a[200:201], v8 offset:8192
ds_read_b64_tr_b16 a[202:203], v8 offset:12288
v_exp_f32 v34, v34
v_exp_f32 v35, v35
v_mfma_f32_16x16x32_bf16 v[252:255], a[220:223], v[76:79], 0
buffer_load_dwordx4 v15, s[20:23], s30 offen offset:1024 nt lds
ds_read_b64_tr_b16 a[204:205], v9 offset:8192
ds_read_b64_tr_b16 a[206:207], v9 offset:12288
v_cvt_pk_bf16_f32 v50, v32, v33
v_cvt_pk_bf16_f32 v51, v34, v35
v_mfma_f32_16x16x32_bf16 v[32:35], a[160:163], a[16:19], 0
s_add_u32 m0, s32, 114688
v_exp_f32 v36, v36
v_mfma_f32_16x16x32_bf16 v[32:35], a[164:167], a[20:23], v[32:35]
s_add_u32 s30, s28, 57344
v_exp_f32 v37, v37
v_mfma_f32_16x16x32_bf16 v[32:35], a[168:171], a[24:27], v[32:35]
v_exp_f32 v38, v38
v_mfma_f32_16x16x32_bf16 v[32:35], a[172:175], a[28:31], v[32:35]
s_waitcnt lgkmcnt(4)
v_exp_f32 v39, v39
v_mfma_f32_16x16x32_bf16 v[192:195], a[192:195], v[48:51], v[192:195]
buffer_load_dwordx4 v16, s[24:27], s31 offen nt lds
v_cvt_pk_bf16_f32 v54, v36, v37
v_mfma_f32_16x16x32_bf16 v[196:199], a[196:199], v[48:51], v[196:199]
s_waitcnt lgkmcnt(2)
ds_read_b64_tr_b16 a[208:209], v10 offset:8192
v_cvt_pk_bf16_f32 v55, v38, v39
v_mfma_f32_16x16x32_bf16 v[200:203], a[200:203], v[48:51], v[200:203]
s_waitcnt lgkmcnt(1)
ds_read_b64_tr_b16 a[210:211], v10 offset:12288
v_fmamk_f32 v40, v40, 0x3e0293ee, v23
v_mfma_f32_16x16x32_bf16 v[204:207], a[204:207], v[48:51], v[204:207]
ds_read_b64_tr_b16 a[212:213], v11 offset:8192
v_fmamk_f32 v41, v41, 0x3e0293ee, v23
v_mfma_f32_16x16x32_bf16 a[236:239], a[244:247], v[48:51], a[236:239]
ds_read_b64_tr_b16 a[214:215], v11 offset:12288
v_fmamk_f32 v42, v42, 0x3e0293ee, v23
v_mfma_f32_16x16x32_bf16 v[36:39], a[160:163], a[32:35], 0
v_exp_f32 v40, v40
v_mfma_f32_16x16x32_bf16 v[36:39], a[164:167], a[36:39], v[36:39]
v_exp_f32 v41, v41
v_mfma_f32_16x16x32_bf16 v[36:39], a[168:171], a[40:43], v[36:39]
v_exp_f32 v42, v42
v_mfma_f32_16x16x32_bf16 v[36:39], a[172:175], a[44:47], v[36:39]
buffer_load_dwordx4 v17, s[24:27], s31 offen offset:1024 nt lds
v_fmamk_f32 v43, v43, 0x3e0293ee, v23
v_mfma_f32_16x16x32_bf16 v[224:227], a[192:195], v[52:55], v[224:227]
s_add_u32 m0, s32, 57344
v_exp_f32 v43, v43
v_mfma_f32_16x16x32_bf16 v[228:231], a[196:199], v[52:55], v[228:231]
s_add_u32 s31, s28, 57344
ds_read_b64_tr_b16 a[216:217], v12 offset:8192
v_cvt_pk_bf16_f32 v56, v40, v41
v_mfma_f32_16x16x32_bf16 v[232:235], a[200:203], v[52:55], v[232:235]
ds_read_b64_tr_b16 a[218:219], v12 offset:12288
v_cvt_pk_bf16_f32 v57, v42, v43
v_mfma_f32_16x16x32_bf16 v[236:239], a[204:207], v[52:55], v[236:239]
ds_read_b64_tr_b16 a[220:221], v13 offset:8192
ds_read_b64_tr_b16 a[222:223], v13 offset:12288
v_mfma_f32_16x16x32_bf16 v[40:43], a[160:163], a[48:51], 0
ds_read_b128 a[176:179], v2 offset:20480
v_fmamk_f32 v32, v32, 0x3e0293ee, v24
v_mfma_f32_16x16x32_bf16 v[40:43], a[164:167], a[52:55], v[40:43]
v_exp_f32 v32, v32
v_mfma_f32_16x16x32_bf16 v[40:43], a[168:171], a[56:59], v[40:43]
ds_read_b128 a[180:183], v3 offset:20480
v_fmamk_f32 v33, v33, 0x3e0293ee, v24
v_mfma_f32_16x16x32_bf16 v[40:43], a[172:175], a[60:63], v[40:43]
s_waitcnt lgkmcnt(6)
v_exp_f32 v33, v33
v_mfma_f32_16x16x32_bf16 v[208:211], a[208:211], v[48:51], v[208:211]
ds_read_b128 a[184:187], v4 offset:20480
v_fmamk_f32 v34, v34, 0x3e0293ee, v24
v_mfma_f32_16x16x32_bf16 v[212:215], a[212:215], v[48:51], v[212:215]
s_waitcnt lgkmcnt(5)
v_exp_f32 v34, v34
v_mfma_f32_16x16x32_bf16 v[216:219], a[216:219], v[48:51], v[216:219]
s_waitcnt lgkmcnt(3)
ds_read_b128 a[188:191], v5 offset:20480
v_fmamk_f32 v35, v35, 0x3e0293ee, v24
v_mfma_f32_16x16x32_bf16 v[220:223], a[220:223], v[48:51], v[220:223]
v_exp_f32 v35, v35
v_mfma_f32_16x16x32_bf16 a[240:243], a[244:247], v[52:55], a[240:243]
v_cvt_pk_bf16_f32 v60, v32, v33
v_cvt_pk_bf16_f32 v61, v34, v35
v_mfma_f32_16x16x32_bf16 v[32:35], a[160:163], a[64:67], 0
ds_read_b64_tr_b16 a[192:193], v6 offset:16384
v_fmamk_f32 v36, v36, 0x3e0293ee, v25
v_mfma_f32_16x16x32_bf16 v[32:35], a[164:167], a[68:71], v[32:35]
v_exp_f32 v36, v36
v_mfma_f32_16x16x32_bf16 v[32:35], a[168:171], a[72:75], v[32:35]
ds_read_b64_tr_b16 a[194:195], v6 offset:20480
v_fmamk_f32 v37, v37, 0x3e0293ee, v25
v_mfma_f32_16x16x32_bf16 v[32:35], a[172:175], a[76:79], v[32:35]
v_exp_f32 v37, v37
v_mfma_f32_16x16x32_bf16 v[240:243], a[208:211], v[52:55], v[240:243]
ds_read_b64_tr_b16 a[196:197], v7 offset:16384
v_fmamk_f32 v38, v38, 0x3e0293ee, v25
v_mfma_f32_16x16x32_bf16 v[244:247], a[212:215], v[52:55], v[244:247]
v_exp_f32 v38, v38
v_mfma_f32_16x16x32_bf16 v[248:251], a[216:219], v[52:55], v[248:251]
v_fmamk_f32 v39, v39, 0x3e0293ee, v25
v_exp_f32 v39, v39
v_mfma_f32_16x16x32_bf16 v[252:255], a[220:223], v[52:55], v[252:255]
s_waitcnt vmcnt(12) lgkmcnt(3)
v_cvt_pk_bf16_f32 v64, v36, v37
v_cvt_pk_bf16_f32 v65, v38, v39
v_mfma_f32_16x16x32_bf16 v[36:39], a[176:179], a[0:3], 0
s_barrier
ds_read_b64_tr_b16 a[198:199], v7 offset:20480
v_fmamk_f32 v40, v40, 0x3e0293ee, v26
v_mfma_f32_16x16x32_bf16 v[36:39], a[180:183], a[4:7], v[36:39]
v_exp_f32 v40, v40
v_mfma_f32_16x16x32_bf16 v[36:39], a[184:187], a[8:11], v[36:39]
v_fmamk_f32 v41, v41, 0x3e0293ee, v26
v_fmamk_f32 v42, v42, 0x3e0293ee, v26
v_fmamk_f32 v43, v43, 0x3e0293ee, v26
v_exp_f32 v41, v41
v_exp_f32 v42, v42
v_exp_f32 v43, v43
v_mfma_f32_16x16x32_bf16 v[36:39], a[188:191], a[12:15], v[36:39]
v_cvt_pk_bf16_f32 v68, v40, v41
v_cvt_pk_bf16_f32 v69, v42, v43
v_mfma_f32_16x16x32_bf16 v[40:43], a[176:179], a[16:19], 0
ds_read_b64_tr_b16 a[200:201], v8 offset:16384
v_fmamk_f32 v32, v32, 0x3e0293ee, v27
v_mfma_f32_16x16x32_bf16 v[40:43], a[180:183], a[20:23], v[40:43]
v_exp_f32 v32, v32
v_mfma_f32_16x16x32_bf16 v[40:43], a[184:187], a[24:27], v[40:43]
v_fmamk_f32 v33, v33, 0x3e0293ee, v27
v_fmamk_f32 v34, v34, 0x3e0293ee, v27
v_fmamk_f32 v35, v35, 0x3e0293ee, v27
v_exp_f32 v33, v33
v_exp_f32 v34, v34
v_exp_f32 v35, v35
v_mfma_f32_16x16x32_bf16 v[40:43], a[188:191], a[28:31], v[40:43]
v_cvt_pk_bf16_f32 v72, v32, v33
v_cvt_pk_bf16_f32 v73, v34, v35
v_mfma_f32_16x16x32_bf16 v[32:35], a[176:179], a[32:35], 0
ds_read_b64_tr_b16 a[202:203], v8 offset:20480
v_fmamk_f32 v36, v36, 0x3e0293ee, v23
v_mfma_f32_16x16x32_bf16 v[32:35], a[180:183], a[36:39], v[32:35]
v_exp_f32 v36, v36
v_mfma_f32_16x16x32_bf16 v[32:35], a[184:187], a[40:43], v[32:35]
v_fmamk_f32 v37, v37, 0x3e0293ee, v23
v_fmamk_f32 v38, v38, 0x3e0293ee, v23
v_fmamk_f32 v39, v39, 0x3e0293ee, v23
v_exp_f32 v37, v37
v_exp_f32 v38, v38
v_exp_f32 v39, v39
v_mfma_f32_16x16x32_bf16 v[32:35], a[188:191], a[44:47], v[32:35]
ds_read_b64_tr_b16 a[204:205], v9 offset:16384
ds_read_b64_tr_b16 a[206:207], v9 offset:20480
v_cvt_pk_bf16_f32 v58, v36, v37
v_cvt_pk_bf16_f32 v59, v38, v39
v_mfma_f32_16x16x32_bf16 v[36:39], a[176:179], a[48:51], 0
buffer_load_dwordx4 v14, s[20:23], s30 offen nt lds
v_fmamk_f32 v40, v40, 0x3e0293ee, v24
v_mfma_f32_16x16x32_bf16 v[36:39], a[180:183], a[52:55], v[36:39]
v_exp_f32 v40, v40
v_mfma_f32_16x16x32_bf16 v[36:39], a[184:187], a[56:59], v[36:39]
ds_read_b128 a[160:163], v2 offset:24576
v_fmamk_f32 v41, v41, 0x3e0293ee, v24
v_mfma_f32_16x16x32_bf16 v[36:39], a[188:191], a[60:63], v[36:39]
s_waitcnt lgkmcnt(4)
v_exp_f32 v41, v41
v_mfma_f32_16x16x32_bf16 v[96:99], a[192:195], v[56:59], v[96:99]
ds_read_b128 a[164:167], v3 offset:24576
v_fmamk_f32 v42, v42, 0x3e0293ee, v24
v_mfma_f32_16x16x32_bf16 v[100:103], a[196:199], v[56:59], v[100:103]
s_waitcnt lgkmcnt(4)
v_exp_f32 v42, v42
v_mfma_f32_16x16x32_bf16 v[104:107], a[200:203], v[56:59], v[104:107]
s_waitcnt lgkmcnt(2)
ds_read_b128 a[168:171], v4 offset:24576
v_fmamk_f32 v43, v43, 0x3e0293ee, v24
v_mfma_f32_16x16x32_bf16 v[108:111], a[204:207], v[56:59], v[108:111]
v_exp_f32 v43, v43
v_mfma_f32_16x16x32_bf16 a[224:227], a[244:247], v[56:59], a[224:227]
v_cvt_pk_bf16_f32 v62, v40, v41
v_cvt_pk_bf16_f32 v63, v42, v43
v_mfma_f32_16x16x32_bf16 v[40:43], a[176:179], a[64:67], 0
ds_read_b128 a[172:175], v5 offset:24576
v_fmamk_f32 v32, v32, 0x3e0293ee, v25
v_mfma_f32_16x16x32_bf16 v[40:43], a[180:183], a[68:71], v[40:43]
v_exp_f32 v32, v32
v_mfma_f32_16x16x32_bf16 v[40:43], a[184:187], a[72:75], v[40:43]
v_fmamk_f32 v33, v33, 0x3e0293ee, v25
v_fmamk_f32 v34, v34, 0x3e0293ee, v25
v_mfma_f32_16x16x32_bf16 v[40:43], a[188:191], a[76:79], v[40:43]
v_exp_f32 v33, v33
v_mfma_f32_16x16x32_bf16 v[128:131], a[192:195], v[60:63], v[128:131]
v_exp_f32 v34, v34
v_mfma_f32_16x16x32_bf16 v[132:135], a[196:199], v[60:63], v[132:135]
s_waitcnt lgkmcnt(1)
buffer_load_dwordx4 v15, s[20:23], s30 offen offset:1024 nt lds
v_fmamk_f32 v35, v35, 0x3e0293ee, v25
v_mfma_f32_16x16x32_bf16 v[136:139], a[200:203], v[60:63], v[136:139]
s_add_u32 m0, s32, 122880
v_exp_f32 v35, v35
v_mfma_f32_16x16x32_bf16 v[140:143], a[204:207], v[60:63], v[140:143]
s_add_u32 s30, s28, 65536
v_cvt_pk_bf16_f32 v66, v32, v33
v_cvt_pk_bf16_f32 v67, v34, v35
v_mfma_f32_16x16x32_bf16 v[32:35], a[160:163], a[0:3], 0
v_fmamk_f32 v36, v36, 0x3e0293ee, v26
v_fmamk_f32 v37, v37, 0x3e0293ee, v26
v_mfma_f32_16x16x32_bf16 v[32:35], a[164:167], a[4:7], v[32:35]
v_exp_f32 v36, v36
v_mfma_f32_16x16x32_bf16 v[32:35], a[168:171], a[8:11], v[32:35]
s_waitcnt lgkmcnt(0)
v_exp_f32 v37, v37
v_mfma_f32_16x16x32_bf16 v[32:35], a[172:175], a[12:15], v[32:35]
v_fmamk_f32 v38, v38, 0x3e0293ee, v26
v_fmamk_f32 v39, v39, 0x3e0293ee, v26
v_mfma_f32_16x16x32_bf16 v[160:163], a[192:195], v[64:67], v[160:163]
v_exp_f32 v38, v38
v_mfma_f32_16x16x32_bf16 v[164:167], a[196:199], v[64:67], v[164:167]
v_exp_f32 v39, v39
v_mfma_f32_16x16x32_bf16 v[168:171], a[200:203], v[64:67], v[168:171]
v_cvt_pk_bf16_f32 v70, v36, v37
v_cvt_pk_bf16_f32 v71, v38, v39
v_mfma_f32_16x16x32_bf16 v[172:175], a[204:207], v[64:67], v[172:175]
ds_read_b64_tr_b16 a[208:209], v10 offset:16384
v_fmamk_f32 v40, v40, 0x3e0293ee, v27
v_mfma_f32_16x16x32_bf16 a[228:231], a[244:247], v[60:63], a[228:231]
v_exp_f32 v40, v40
v_mfma_f32_16x16x32_bf16 v[36:39], a[160:163], a[16:19], 0
ds_read_b64_tr_b16 a[210:211], v10 offset:20480
v_fmamk_f32 v41, v41, 0x3e0293ee, v27
v_mfma_f32_16x16x32_bf16 v[36:39], a[164:167], a[20:23], v[36:39]
v_exp_f32 v41, v41
v_mfma_f32_16x16x32_bf16 v[36:39], a[168:171], a[24:27], v[36:39]
ds_read_b64_tr_b16 a[212:213], v11 offset:16384
v_fmamk_f32 v42, v42, 0x3e0293ee, v27
v_mfma_f32_16x16x32_bf16 v[36:39], a[172:175], a[28:31], v[36:39]
v_exp_f32 v42, v42
v_mfma_f32_16x16x32_bf16 v[192:195], a[192:195], v[68:71], v[192:195]
ds_read_b64_tr_b16 a[214:215], v11 offset:20480
v_fmamk_f32 v43, v43, 0x3e0293ee, v27
v_mfma_f32_16x16x32_bf16 v[196:199], a[196:199], v[68:71], v[196:199]
v_exp_f32 v43, v43
v_mfma_f32_16x16x32_bf16 v[200:203], a[200:203], v[68:71], v[200:203]
ds_read_b64_tr_b16 a[216:217], v12 offset:16384
v_cvt_pk_bf16_f32 v74, v40, v41
v_mfma_f32_16x16x32_bf16 v[204:207], a[204:207], v[68:71], v[204:207]
v_cvt_pk_bf16_f32 v75, v42, v43
v_fmamk_f32 v32, v32, 0x3e0293ee, v23
v_mfma_f32_16x16x32_bf16 v[40:43], a[160:163], a[32:35], 0
v_exp_f32 v32, v32
v_mfma_f32_16x16x32_bf16 v[40:43], a[164:167], a[36:39], v[40:43]
ds_read_b64_tr_b16 a[218:219], v12 offset:20480
v_fmamk_f32 v33, v33, 0x3e0293ee, v23
v_mfma_f32_16x16x32_bf16 v[40:43], a[168:171], a[40:43], v[40:43]
v_exp_f32 v33, v33
v_mfma_f32_16x16x32_bf16 v[40:43], a[172:175], a[44:47], v[40:43]
ds_read_b64_tr_b16 a[220:221], v13 offset:16384
v_fmamk_f32 v34, v34, 0x3e0293ee, v23
v_mfma_f32_16x16x32_bf16 v[224:227], a[192:195], v[72:75], v[224:227]
v_exp_f32 v34, v34
v_mfma_f32_16x16x32_bf16 v[228:231], a[196:199], v[72:75], v[228:231]
ds_read_b64_tr_b16 a[222:223], v13 offset:20480
v_fmamk_f32 v35, v35, 0x3e0293ee, v23
v_mfma_f32_16x16x32_bf16 v[232:235], a[200:203], v[72:75], v[232:235]
v_exp_f32 v35, v35
v_mfma_f32_16x16x32_bf16 v[236:239], a[204:207], v[72:75], v[236:239]
buffer_load_dwordx4 v16, s[24:27], s31 offen nt lds
v_cvt_pk_bf16_f32 v76, v32, v33
v_mfma_f32_16x16x32_bf16 a[232:235], a[244:247], v[64:67], a[232:235]
v_cvt_pk_bf16_f32 v77, v34, v35
v_fmamk_f32 v36, v36, 0x3e0293ee, v24
v_mfma_f32_16x16x32_bf16 v[32:35], a[160:163], a[48:51], 0
v_exp_f32 v36, v36
v_mfma_f32_16x16x32_bf16 v[32:35], a[164:167], a[52:55], v[32:35]
ds_read_b128 a[176:179], v2 offset:28672
v_fmamk_f32 v37, v37, 0x3e0293ee, v24
v_mfma_f32_16x16x32_bf16 v[32:35], a[168:171], a[56:59], v[32:35]
v_exp_f32 v37, v37
v_mfma_f32_16x16x32_bf16 v[32:35], a[172:175], a[60:63], v[32:35]
s_waitcnt lgkmcnt(2)
ds_read_b128 a[180:183], v3 offset:28672
v_fmamk_f32 v38, v38, 0x3e0293ee, v24
v_mfma_f32_16x16x32_bf16 v[112:115], a[208:211], v[56:59], v[112:115]
v_exp_f32 v38, v38
v_mfma_f32_16x16x32_bf16 v[116:119], a[212:215], v[56:59], v[116:119]
ds_read_b128 a[184:187], v4 offset:28672
v_fmamk_f32 v39, v39, 0x3e0293ee, v24
v_mfma_f32_16x16x32_bf16 v[120:123], a[216:219], v[56:59], v[120:123]
s_waitcnt lgkmcnt(3)
v_exp_f32 v39, v39
v_mfma_f32_16x16x32_bf16 v[124:127], a[220:223], v[56:59], v[124:127]
v_cvt_pk_bf16_f32 v48, v36, v37
v_cvt_pk_bf16_f32 v49, v38, v39
v_mfma_f32_16x16x32_bf16 v[36:39], a[160:163], a[64:67], 0
ds_read_b128 a[188:191], v5 offset:28672
v_add_u32 v28, s38, v18
v_mfma_f32_16x16x32_bf16 v[36:39], a[164:167], a[68:71], v[36:39]
s_add_u32 s38, s58, 4096
v_fmamk_f32 v40, v40, 0x3e0293ee, v25
v_fmamk_f32 v41, v41, 0x3e0293ee, v25
v_mfma_f32_16x16x32_bf16 v[36:39], a[168:171], a[72:75], v[36:39]
v_exp_f32 v40, v40
v_mfma_f32_16x16x32_bf16 v[36:39], a[172:175], a[76:79], v[36:39]
v_exp_f32 v41, v41
v_mfma_f32_16x16x32_bf16 v[144:147], a[208:211], v[60:63], v[144:147]
buffer_load_dwordx4 v17, s[24:27], s31 offen offset:1024 nt lds
buffer_load_dwordx4 a[80:83], v28, s[8:11], 0 offen offset:0
v_mfma_f32_16x16x32_bf16 v[148:151], a[212:215], v[60:63], v[148:151]
s_add_u32 m0, s32, 0
v_fmamk_f32 v42, v42, 0x3e0293ee, v25
v_fmamk_f32 v43, v43, 0x3e0293ee, v25
v_mfma_f32_16x16x32_bf16 v[152:155], a[216:219], v[60:63], v[152:155]
s_add_u32 s31, s28, 65536
v_exp_f32 v42, v42
v_mfma_f32_16x16x32_bf16 v[156:159], a[220:223], v[60:63], v[156:159]
v_exp_f32 v43, v43
v_mfma_f32_16x16x32_bf16 a[236:239], a[244:247], v[68:71], a[236:239]
s_waitcnt vmcnt(9) lgkmcnt(0)
v_cvt_pk_bf16_f32 v52, v40, v41
v_cvt_pk_bf16_f32 v53, v42, v43
v_mfma_f32_16x16x32_bf16 v[40:43], a[176:179], a[0:3], 0
s_barrier
buffer_load_dwordx4 a[84:87], v28, s[8:11], 0 offen offset:64
v_fmamk_f32 v32, v32, 0x3e0293ee, v26
v_mfma_f32_16x16x32_bf16 v[40:43], a[180:183], a[4:7], v[40:43]
v_exp_f32 v32, v32
v_mfma_f32_16x16x32_bf16 v[40:43], a[184:187], a[8:11], v[40:43]
v_fmamk_f32 v33, v33, 0x3e0293ee, v26
v_fmamk_f32 v34, v34, 0x3e0293ee, v26
v_mfma_f32_16x16x32_bf16 v[40:43], a[188:191], a[12:15], v[40:43]
v_exp_f32 v33, v33
v_mfma_f32_16x16x32_bf16 v[176:179], a[208:211], v[64:67], v[176:179]
v_exp_f32 v34, v34
v_mfma_f32_16x16x32_bf16 v[180:183], a[212:215], v[64:67], v[180:183]
buffer_load_dwordx4 v14, s[20:23], s30 offen nt lds
v_fmamk_f32 v35, v35, 0x3e0293ee, v26
v_mfma_f32_16x16x32_bf16 v[184:187], a[216:219], v[64:67], v[184:187]
v_exp_f32 v35, v35
v_mfma_f32_16x16x32_bf16 v[188:191], a[220:223], v[64:67], v[188:191]
v_cvt_pk_bf16_f32 v56, v32, v33
v_cvt_pk_bf16_f32 v57, v34, v35
v_mfma_f32_16x16x32_bf16 v[32:35], a[176:179], a[16:19], 0
ds_read_b64_tr_b16 a[192:193], v6 offset:24576
v_fmamk_f32 v36, v36, 0x3e0293ee, v27
v_mfma_f32_16x16x32_bf16 v[32:35], a[180:183], a[20:23], v[32:35]
v_exp_f32 v36, v36
v_mfma_f32_16x16x32_bf16 v[32:35], a[184:187], a[24:27], v[32:35]
ds_read_b64_tr_b16 a[194:195], v6 offset:28672
v_fmamk_f32 v37, v37, 0x3e0293ee, v27
v_mfma_f32_16x16x32_bf16 v[32:35], a[188:191], a[28:31], v[32:35]
v_exp_f32 v37, v37
v_mfma_f32_16x16x32_bf16 v[208:211], a[208:211], v[68:71], v[208:211]
ds_read_b64_tr_b16 a[196:197], v7 offset:24576
v_fmamk_f32 v38, v38, 0x3e0293ee, v27
v_mfma_f32_16x16x32_bf16 v[212:215], a[212:215], v[68:71], v[212:215]
v_exp_f32 v38, v38
v_mfma_f32_16x16x32_bf16 v[216:219], a[216:219], v[68:71], v[216:219]
ds_read_b64_tr_b16 a[198:199], v7 offset:28672
v_fmamk_f32 v39, v39, 0x3e0293ee, v27
v_mfma_f32_16x16x32_bf16 v[220:223], a[220:223], v[68:71], v[220:223]
v_exp_f32 v39, v39
v_mfma_f32_16x16x32_bf16 a[240:243], a[244:247], v[72:75], a[240:243]
v_cvt_pk_bf16_f32 v60, v36, v37
v_cvt_pk_bf16_f32 v61, v38, v39
v_mfma_f32_16x16x32_bf16 v[36:39], a[176:179], a[32:35], 0
ds_read_b64_tr_b16 a[200:201], v8 offset:24576
v_fmamk_f32 v40, v40, 0x3e0293ee, v23
v_mfma_f32_16x16x32_bf16 v[36:39], a[180:183], a[36:39], v[36:39]
v_exp_f32 v40, v40
v_mfma_f32_16x16x32_bf16 v[36:39], a[184:187], a[40:43], v[36:39]
ds_read_b64_tr_b16 a[202:203], v8 offset:28672
v_fmamk_f32 v41, v41, 0x3e0293ee, v23
v_mfma_f32_16x16x32_bf16 v[36:39], a[188:191], a[44:47], v[36:39]
v_exp_f32 v41, v41
v_mfma_f32_16x16x32_bf16 v[240:243], a[208:211], v[72:75], v[240:243]
ds_read_b64_tr_b16 a[204:205], v9 offset:24576
v_fmamk_f32 v42, v42, 0x3e0293ee, v23
v_mfma_f32_16x16x32_bf16 v[244:247], a[212:215], v[72:75], v[244:247]
v_exp_f32 v42, v42
v_mfma_f32_16x16x32_bf16 v[248:251], a[216:219], v[72:75], v[248:251]
v_fmamk_f32 v43, v43, 0x3e0293ee, v23
v_exp_f32 v43, v43
v_mfma_f32_16x16x32_bf16 v[252:255], a[220:223], v[72:75], v[252:255]
ds_read_b64_tr_b16 a[206:207], v9 offset:28672
v_cvt_pk_bf16_f32 v78, v40, v41
v_cvt_pk_bf16_f32 v79, v42, v43
v_mfma_f32_16x16x32_bf16 v[40:43], a[176:179], a[48:51], 0
ds_read_b128 a[160:163], v2 offset:32768
v_fmamk_f32 v32, v32, 0x3e0293ee, v24
v_mfma_f32_16x16x32_bf16 v[40:43], a[180:183], a[52:55], v[40:43]
v_exp_f32 v32, v32
v_mfma_f32_16x16x32_bf16 v[40:43], a[184:187], a[56:59], v[40:43]
ds_read_b128 a[164:167], v3 offset:32768
v_fmamk_f32 v33, v33, 0x3e0293ee, v24
v_mfma_f32_16x16x32_bf16 v[40:43], a[188:191], a[60:63], v[40:43]
s_waitcnt lgkmcnt(4)
v_exp_f32 v33, v33
v_mfma_f32_16x16x32_bf16 v[96:99], a[192:195], v[76:79], v[96:99]
ds_read_b128 a[168:171], v4 offset:32768
v_fmamk_f32 v34, v34, 0x3e0293ee, v24
v_mfma_f32_16x16x32_bf16 v[100:103], a[196:199], v[76:79], v[100:103]
v_exp_f32 v34, v34
v_mfma_f32_16x16x32_bf16 v[104:107], a[200:203], v[76:79], v[104:107]
s_waitcnt lgkmcnt(3)
buffer_load_dwordx4 v15, s[20:23], s30 offen offset:1024 nt lds
v_fmamk_f32 v35, v35, 0x3e0293ee, v24
v_mfma_f32_16x16x32_bf16 v[108:111], a[204:207], v[76:79], v[108:111]
s_add_u32 m0, s32, 65536
v_exp_f32 v35, v35
v_mfma_f32_16x16x32_bf16 a[224:227], a[244:247], v[76:79], a[224:227]
s_add_u32 s30, s28, 73728
v_cvt_pk_bf16_f32 v50, v32, v33
v_cvt_pk_bf16_f32 v51, v34, v35
v_mfma_f32_16x16x32_bf16 v[32:35], a[176:179], a[64:67], 0
ds_read_b128 a[172:175], v5 offset:32768
v_fmamk_f32 v36, v36, 0x3e0293ee, v25
v_mfma_f32_16x16x32_bf16 v[32:35], a[180:183], a[68:71], v[32:35]
v_exp_f32 v36, v36
v_mfma_f32_16x16x32_bf16 v[32:35], a[184:187], a[72:75], v[32:35]
v_fmamk_f32 v37, v37, 0x3e0293ee, v25
v_fmamk_f32 v38, v38, 0x3e0293ee, v25
v_mfma_f32_16x16x32_bf16 v[32:35], a[188:191], a[76:79], v[32:35]
v_exp_f32 v37, v37
v_mfma_f32_16x16x32_bf16 v[128:131], a[192:195], v[48:51], v[128:131]
v_exp_f32 v38, v38
v_mfma_f32_16x16x32_bf16 v[132:135], a[196:199], v[48:51], v[132:135]
v_fmamk_f32 v39, v39, 0x3e0293ee, v25
v_cvt_pk_bf16_f32 v54, v36, v37
v_mfma_f32_16x16x32_bf16 v[136:139], a[200:203], v[48:51], v[136:139]
v_exp_f32 v39, v39
v_mfma_f32_16x16x32_bf16 v[140:143], a[204:207], v[48:51], v[140:143]
s_waitcnt lgkmcnt(1)
v_cvt_pk_bf16_f32 v55, v38, v39
v_fmamk_f32 v40, v40, 0x3e0293ee, v26
v_mfma_f32_16x16x32_bf16 v[36:39], a[160:163], a[0:3], 0
v_exp_f32 v40, v40
v_mfma_f32_16x16x32_bf16 v[36:39], a[164:167], a[4:7], v[36:39]
v_fmamk_f32 v41, v41, 0x3e0293ee, v26
v_fmamk_f32 v42, v42, 0x3e0293ee, v26
v_mfma_f32_16x16x32_bf16 v[36:39], a[168:171], a[8:11], v[36:39]
s_waitcnt lgkmcnt(0)
v_exp_f32 v41, v41
v_mfma_f32_16x16x32_bf16 v[36:39], a[172:175], a[12:15], v[36:39]
v_exp_f32 v42, v42
v_mfma_f32_16x16x32_bf16 v[160:163], a[192:195], v[52:55], v[160:163]
buffer_load_dwordx4 v16, s[24:27], s31 offen nt lds
v_fmamk_f32 v43, v43, 0x3e0293ee, v26
v_mfma_f32_16x16x32_bf16 v[164:167], a[196:199], v[52:55], v[164:167]
v_exp_f32 v43, v43
v_mfma_f32_16x16x32_bf16 v[168:171], a[200:203], v[52:55], v[168:171]
v_cvt_pk_bf16_f32 v58, v40, v41
v_cvt_pk_bf16_f32 v59, v42, v43
v_mfma_f32_16x16x32_bf16 v[172:175], a[204:207], v[52:55], v[172:175]
ds_read_b64_tr_b16 a[208:209], v10 offset:24576
v_fmamk_f32 v32, v32, 0x3e0293ee, v27
v_mfma_f32_16x16x32_bf16 a[228:231], a[244:247], v[48:51], a[228:231]
v_exp_f32 v32, v32
v_mfma_f32_16x16x32_bf16 v[40:43], a[160:163], a[16:19], 0
ds_read_b64_tr_b16 a[210:211], v10 offset:28672
v_fmamk_f32 v33, v33, 0x3e0293ee, v27
v_mfma_f32_16x16x32_bf16 v[40:43], a[164:167], a[20:23], v[40:43]
v_exp_f32 v33, v33
v_mfma_f32_16x16x32_bf16 v[40:43], a[168:171], a[24:27], v[40:43]
ds_read_b64_tr_b16 a[212:213], v11 offset:24576
v_fmamk_f32 v34, v34, 0x3e0293ee, v27
v_mfma_f32_16x16x32_bf16 v[40:43], a[172:175], a[28:31], v[40:43]
v_exp_f32 v34, v34
v_mfma_f32_16x16x32_bf16 v[192:195], a[192:195], v[56:59], v[192:195]
ds_read_b64_tr_b16 a[214:215], v11 offset:28672
v_fmamk_f32 v35, v35, 0x3e0293ee, v27
v_mfma_f32_16x16x32_bf16 v[196:199], a[196:199], v[56:59], v[196:199]
v_exp_f32 v35, v35
v_mfma_f32_16x16x32_bf16 v[200:203], a[200:203], v[56:59], v[200:203]
ds_read_b64_tr_b16 a[216:217], v12 offset:24576
v_cvt_pk_bf16_f32 v62, v32, v33
v_mfma_f32_16x16x32_bf16 v[204:207], a[204:207], v[56:59], v[204:207]
v_cvt_pk_bf16_f32 v63, v34, v35
v_fmamk_f32 v36, v36, 0x3e0293ee, v23
v_mfma_f32_16x16x32_bf16 v[32:35], a[160:163], a[32:35], 0
v_exp_f32 v36, v36
v_mfma_f32_16x16x32_bf16 v[32:35], a[164:167], a[36:39], v[32:35]
ds_read_b64_tr_b16 a[218:219], v12 offset:28672
v_fmamk_f32 v37, v37, 0x3e0293ee, v23
v_mfma_f32_16x16x32_bf16 v[32:35], a[168:171], a[40:43], v[32:35]
v_exp_f32 v37, v37
v_mfma_f32_16x16x32_bf16 v[32:35], a[172:175], a[44:47], v[32:35]
ds_read_b64_tr_b16 a[220:221], v13 offset:24576
v_fmamk_f32 v38, v38, 0x3e0293ee, v23
v_mfma_f32_16x16x32_bf16 v[224:227], a[192:195], v[60:63], v[224:227]
v_exp_f32 v38, v38
v_mfma_f32_16x16x32_bf16 v[228:231], a[196:199], v[60:63], v[228:231]
ds_read_b64_tr_b16 a[222:223], v13 offset:28672
v_fmamk_f32 v39, v39, 0x3e0293ee, v23
v_mfma_f32_16x16x32_bf16 v[232:235], a[200:203], v[60:63], v[232:235]
v_exp_f32 v39, v39
v_mfma_f32_16x16x32_bf16 v[236:239], a[204:207], v[60:63], v[236:239]
ds_read_b128 a[176:179], v2 offset:36864
v_cvt_pk_bf16_f32 v64, v36, v37
v_mfma_f32_16x16x32_bf16 a[232:235], a[244:247], v[52:55], a[232:235]
buffer_load_dwordx4 v17, s[24:27], s31 offen offset:1024 nt lds
buffer_load_dwordx4 a[88:91], v28, s[8:11], 0 offen offset:128
v_cvt_pk_bf16_f32 v65, v38, v39
v_mfma_f32_16x16x32_bf16 v[36:39], a[160:163], a[48:51], 0
s_add_u32 m0, s32, 8192
ds_read_b128 a[180:183], v3 offset:36864
v_fmamk_f32 v40, v40, 0x3e0293ee, v24
v_mfma_f32_16x16x32_bf16 v[36:39], a[164:167], a[52:55], v[36:39]
s_add_u32 s31, s28, 73728
v_exp_f32 v40, v40
v_mfma_f32_16x16x32_bf16 v[36:39], a[168:171], a[56:59], v[36:39]
ds_read_b128 a[184:187], v4 offset:36864
v_fmamk_f32 v41, v41, 0x3e0293ee, v24
v_mfma_f32_16x16x32_bf16 v[36:39], a[172:175], a[60:63], v[36:39]
s_waitcnt lgkmcnt(4)
v_exp_f32 v41, v41
v_mfma_f32_16x16x32_bf16 v[112:115], a[208:211], v[76:79], v[112:115]
ds_read_b128 a[188:191], v5 offset:36864
v_fmamk_f32 v42, v42, 0x3e0293ee, v24
v_mfma_f32_16x16x32_bf16 v[116:119], a[212:215], v[76:79], v[116:119]
v_exp_f32 v42, v42
v_mfma_f32_16x16x32_bf16 v[120:123], a[216:219], v[76:79], v[120:123]
s_waitcnt lgkmcnt(3)
v_fmamk_f32 v43, v43, 0x3e0293ee, v24
v_exp_f32 v43, v43
v_mfma_f32_16x16x32_bf16 v[124:127], a[220:223], v[76:79], v[124:127]
v_cvt_pk_bf16_f32 v68, v40, v41
v_cvt_pk_bf16_f32 v69, v42, v43
v_mfma_f32_16x16x32_bf16 v[40:43], a[160:163], a[64:67], 0
v_fmamk_f32 v32, v32, 0x3e0293ee, v25
v_fmamk_f32 v33, v33, 0x3e0293ee, v25
v_mfma_f32_16x16x32_bf16 v[40:43], a[164:167], a[68:71], v[40:43]
v_exp_f32 v32, v32
v_mfma_f32_16x16x32_bf16 v[40:43], a[168:171], a[72:75], v[40:43]
v_exp_f32 v33, v33
v_mfma_f32_16x16x32_bf16 v[40:43], a[172:175], a[76:79], v[40:43]
v_fmamk_f32 v34, v34, 0x3e0293ee, v25
v_fmamk_f32 v35, v35, 0x3e0293ee, v25
v_mfma_f32_16x16x32_bf16 v[144:147], a[208:211], v[48:51], v[144:147]
v_exp_f32 v34, v34
v_mfma_f32_16x16x32_bf16 v[148:151], a[212:215], v[48:51], v[148:151]
v_exp_f32 v35, v35
v_mfma_f32_16x16x32_bf16 v[152:155], a[216:219], v[48:51], v[152:155]
v_cvt_pk_bf16_f32 v72, v32, v33
v_cvt_pk_bf16_f32 v73, v34, v35
v_mfma_f32_16x16x32_bf16 v[156:159], a[220:223], v[48:51], v[156:159]
v_fmamk_f32 v36, v36, 0x3e0293ee, v26
v_fmamk_f32 v37, v37, 0x3e0293ee, v26
v_mfma_f32_16x16x32_bf16 a[236:239], a[244:247], v[56:59], a[236:239]
v_exp_f32 v36, v36
v_mfma_f32_16x16x32_bf16 v[32:35], a[176:179], a[0:3], 0
s_waitcnt lgkmcnt(0)
v_exp_f32 v37, v37
v_mfma_f32_16x16x32_bf16 v[32:35], a[180:183], a[4:7], v[32:35]
v_fmamk_f32 v38, v38, 0x3e0293ee, v26
v_fmamk_f32 v39, v39, 0x3e0293ee, v26
v_mfma_f32_16x16x32_bf16 v[32:35], a[184:187], a[8:11], v[32:35]
v_exp_f32 v38, v38
v_mfma_f32_16x16x32_bf16 v[32:35], a[188:191], a[12:15], v[32:35]
v_exp_f32 v39, v39
v_mfma_f32_16x16x32_bf16 v[176:179], a[208:211], v[52:55], v[176:179]
L_pad0_2:
s_cbranch_execz L_pad0_6
buffer_load_dwordx4 v14, s[20:23], s30 offen nt lds
v_cvt_pk_bf16_f32 v76, v36, v37
v_mfma_f32_16x16x32_bf16 v[180:183], a[212:215], v[52:55], v[180:183]
ds_read_b64_tr_b16 a[192:193], v6 offset:32768
v_cvt_pk_bf16_f32 v77, v38, v39
v_mfma_f32_16x16x32_bf16 v[184:187], a[216:219], v[52:55], v[184:187]
ds_read_b64_tr_b16 a[194:195], v6 offset:36864
v_fmamk_f32 v40, v40, 0x3e0293ee, v27
v_mfma_f32_16x16x32_bf16 v[188:191], a[220:223], v[52:55], v[188:191]
v_exp_f32 v40, v40
v_mfma_f32_16x16x32_bf16 v[36:39], a[176:179], a[16:19], 0
ds_read_b64_tr_b16 a[196:197], v7 offset:32768
v_fmamk_f32 v41, v41, 0x3e0293ee, v27
v_mfma_f32_16x16x32_bf16 v[36:39], a[180:183], a[20:23], v[36:39]
v_exp_f32 v41, v41
v_mfma_f32_16x16x32_bf16 v[36:39], a[184:187], a[24:27], v[36:39]
ds_read_b64_tr_b16 a[198:199], v7 offset:36864
v_fmamk_f32 v42, v42, 0x3e0293ee, v27
v_mfma_f32_16x16x32_bf16 v[36:39], a[188:191], a[28:31], v[36:39]
v_exp_f32 v42, v42
v_mfma_f32_16x16x32_bf16 v[208:211], a[208:211], v[56:59], v[208:211]
ds_read_b64_tr_b16 a[200:201], v8 offset:32768
v_fmamk_f32 v43, v43, 0x3e0293ee, v27
v_mfma_f32_16x16x32_bf16 v[212:215], a[212:215], v[56:59], v[212:215]
v_exp_f32 v43, v43
v_mfma_f32_16x16x32_bf16 v[216:219], a[216:219], v[56:59], v[216:219]
ds_read_b64_tr_b16 a[202:203], v8 offset:36864
v_cvt_pk_bf16_f32 v48, v40, v41
v_mfma_f32_16x16x32_bf16 v[220:223], a[220:223], v[56:59], v[220:223]
ds_read_b64_tr_b16 a[204:205], v9 offset:32768
v_cvt_pk_bf16_f32 v49, v42, v43
v_mfma_f32_16x16x32_bf16 a[240:243], a[244:247], v[60:63], a[240:243]
ds_read_b64_tr_b16 a[206:207], v9 offset:36864
v_fmamk_f32 v32, v32, 0x3e0293ee, v23
v_mfma_f32_16x16x32_bf16 v[40:43], a[176:179], a[32:35], 0
v_exp_f32 v32, v32
v_mfma_f32_16x16x32_bf16 v[40:43], a[180:183], a[36:39], v[40:43]
ds_read_b128 a[160:163], v2 offset:40960
v_fmamk_f32 v33, v33, 0x3e0293ee, v23
v_mfma_f32_16x16x32_bf16 v[40:43], a[184:187], a[40:43], v[40:43]
v_exp_f32 v33, v33
v_mfma_f32_16x16x32_bf16 v[40:43], a[188:191], a[44:47], v[40:43]
ds_read_b128 a[164:167], v3 offset:40960
v_fmamk_f32 v34, v34, 0x3e0293ee, v23
v_mfma_f32_16x16x32_bf16 v[240:243], a[208:211], v[60:63], v[240:243]
v_exp_f32 v34, v34
v_mfma_f32_16x16x32_bf16 v[244:247], a[212:215], v[60:63], v[244:247]
ds_read_b128 a[168:171], v4 offset:40960
v_fmamk_f32 v35, v35, 0x3e0293ee, v23
v_mfma_f32_16x16x32_bf16 v[248:251], a[216:219], v[60:63], v[248:251]
v_exp_f32 v35, v35
v_mfma_f32_16x16x32_bf16 v[252:255], a[220:223], v[60:63], v[252:255]
v_cvt_pk_bf16_f32 v66, v32, v33
v_cvt_pk_bf16_f32 v67, v34, v35
v_mfma_f32_16x16x32_bf16 v[32:35], a[176:179], a[48:51], 0
buffer_load_dwordx4 v15, s[20:23], s30 offen offset:1024 nt lds
v_fmamk_f32 v36, v36, 0x3e0293ee, v24
v_mfma_f32_16x16x32_bf16 v[32:35], a[180:183], a[52:55], v[32:35]
s_add_u32 m0, s32, 73728
v_exp_f32 v36, v36
v_mfma_f32_16x16x32_bf16 v[32:35], a[184:187], a[56:59], v[32:35]
s_add_u32 s30, s28, 81920
ds_read_b128 a[172:175], v5 offset:40960
v_fmamk_f32 v37, v37, 0x3e0293ee, v24
v_mfma_f32_16x16x32_bf16 v[32:35], a[188:191], a[60:63], v[32:35]
s_waitcnt lgkmcnt(2)
v_exp_f32 v37, v37
v_mfma_f32_16x16x32_bf16 v[96:99], a[192:195], v[64:67], v[96:99]
v_fmamk_f32 v38, v38, 0x3e0293ee, v24
v_fmamk_f32 v39, v39, 0x3e0293ee, v24
v_mfma_f32_16x16x32_bf16 v[100:103], a[196:199], v[64:67], v[100:103]
v_exp_f32 v38, v38
v_mfma_f32_16x16x32_bf16 v[104:107], a[200:203], v[64:67], v[104:107]
v_exp_f32 v39, v39
v_mfma_f32_16x16x32_bf16 v[108:111], a[204:207], v[64:67], v[108:111]
v_cvt_pk_bf16_f32 v70, v36, v37
v_cvt_pk_bf16_f32 v71, v38, v39
v_mfma_f32_16x16x32_bf16 a[224:227], a[244:247], v[64:67], a[224:227]
v_fmamk_f32 v40, v40, 0x3e0293ee, v25
v_fmamk_f32 v41, v41, 0x3e0293ee, v25
v_mfma_f32_16x16x32_bf16 v[36:39], a[176:179], a[64:67], 0
v_exp_f32 v40, v40
v_mfma_f32_16x16x32_bf16 v[36:39], a[180:183], a[68:71], v[36:39]
v_exp_f32 v41, v41
v_mfma_f32_16x16x32_bf16 v[36:39], a[184:187], a[72:75], v[36:39]
v_fmamk_f32 v42, v42, 0x3e0293ee, v25
v_fmamk_f32 v43, v43, 0x3e0293ee, v25
v_mfma_f32_16x16x32_bf16 v[36:39], a[188:191], a[76:79], v[36:39]
v_exp_f32 v42, v42
v_mfma_f32_16x16x32_bf16 v[128:131], a[192:195], v[68:71], v[128:131]
v_exp_f32 v43, v43
v_mfma_f32_16x16x32_bf16 v[132:135], a[196:199], v[68:71], v[132:135]
v_cvt_pk_bf16_f32 v74, v40, v41
v_cvt_pk_bf16_f32 v75, v42, v43
v_mfma_f32_16x16x32_bf16 v[136:139], a[200:203], v[68:71], v[136:139]
v_fmamk_f32 v32, v32, 0x3e0293ee, v26
v_fmamk_f32 v33, v33, 0x3e0293ee, v26
v_mfma_f32_16x16x32_bf16 v[140:143], a[204:207], v[68:71], v[140:143]
v_exp_f32 v32, v32
v_mfma_f32_16x16x32_bf16 v[40:43], a[160:163], a[0:3], 0
v_exp_f32 v33, v33
v_mfma_f32_16x16x32_bf16 v[40:43], a[164:167], a[4:7], v[40:43]
s_waitcnt lgkmcnt(0)
v_fmamk_f32 v34, v34, 0x3e0293ee, v26
v_fmamk_f32 v35, v35, 0x3e0293ee, v26
v_mfma_f32_16x16x32_bf16 v[40:43], a[168:171], a[8:11], v[40:43]
v_exp_f32 v34, v34
v_mfma_f32_16x16x32_bf16 v[40:43], a[172:175], a[12:15], v[40:43]
v_exp_f32 v35, v35
v_mfma_f32_16x16x32_bf16 v[160:163], a[192:195], v[72:75], v[160:163]
buffer_load_dwordx4 v16, s[24:27], s31 offen nt lds
v_cvt_pk_bf16_f32 v78, v32, v33
v_mfma_f32_16x16x32_bf16 v[164:167], a[196:199], v[72:75], v[164:167]
ds_read_b64_tr_b16 a[208:209], v10 offset:32768
v_cvt_pk_bf16_f32 v79, v34, v35
v_mfma_f32_16x16x32_bf16 v[168:171], a[200:203], v[72:75], v[168:171]
ds_read_b64_tr_b16 a[210:211], v10 offset:36864
v_fmamk_f32 v36, v36, 0x3e0293ee, v27
v_mfma_f32_16x16x32_bf16 v[172:175], a[204:207], v[72:75], v[172:175]
v_exp_f32 v36, v36
v_mfma_f32_16x16x32_bf16 a[228:231], a[244:247], v[68:71], a[228:231]
ds_read_b64_tr_b16 a[212:213], v11 offset:32768
v_fmamk_f32 v37, v37, 0x3e0293ee, v27
v_mfma_f32_16x16x32_bf16 v[32:35], a[160:163], a[16:19], 0
v_exp_f32 v37, v37
v_mfma_f32_16x16x32_bf16 v[32:35], a[164:167], a[20:23], v[32:35]
ds_read_b64_tr_b16 a[214:215], v11 offset:36864
v_fmamk_f32 v38, v38, 0x3e0293ee, v27
v_mfma_f32_16x16x32_bf16 v[32:35], a[168:171], a[24:27], v[32:35]
v_exp_f32 v38, v38
v_mfma_f32_16x16x32_bf16 v[32:35], a[172:175], a[28:31], v[32:35]
ds_read_b64_tr_b16 a[216:217], v12 offset:32768
v_fmamk_f32 v39, v39, 0x3e0293ee, v27
v_mfma_f32_16x16x32_bf16 v[192:195], a[192:195], v[76:79], v[192:195]
v_exp_f32 v39, v39
v_mfma_f32_16x16x32_bf16 v[196:199], a[196:199], v[76:79], v[196:199]
ds_read_b64_tr_b16 a[218:219], v12 offset:36864
v_cvt_pk_bf16_f32 v50, v36, v37
v_mfma_f32_16x16x32_bf16 v[200:203], a[200:203], v[76:79], v[200:203]
ds_read_b64_tr_b16 a[220:221], v13 offset:32768
v_cvt_pk_bf16_f32 v51, v38, v39
v_mfma_f32_16x16x32_bf16 v[204:207], a[204:207], v[76:79], v[204:207]
ds_read_b64_tr_b16 a[222:223], v13 offset:36864
v_fmamk_f32 v40, v40, 0x3e0293ee, v23
v_mfma_f32_16x16x32_bf16 v[36:39], a[160:163], a[32:35], 0
v_exp_f32 v40, v40
v_mfma_f32_16x16x32_bf16 v[36:39], a[164:167], a[36:39], v[36:39]
ds_read_b128 a[176:179], v2 offset:45056
v_fmamk_f32 v41, v41, 0x3e0293ee, v23
v_mfma_f32_16x16x32_bf16 v[36:39], a[168:171], a[40:43], v[36:39]
v_exp_f32 v41, v41
v_mfma_f32_16x16x32_bf16 v[36:39], a[172:175], a[44:47], v[36:39]
ds_read_b128 a[180:183], v3 offset:45056
v_fmamk_f32 v42, v42, 0x3e0293ee, v23
v_mfma_f32_16x16x32_bf16 v[224:227], a[192:195], v[48:51], v[224:227]
v_exp_f32 v42, v42
v_mfma_f32_16x16x32_bf16 v[228:231], a[196:199], v[48:51], v[228:231]
ds_read_b128 a[184:187], v4 offset:45056
v_fmamk_f32 v43, v43, 0x3e0293ee, v23
v_mfma_f32_16x16x32_bf16 v[232:235], a[200:203], v[48:51], v[232:235]
v_exp_f32 v43, v43
v_mfma_f32_16x16x32_bf16 v[236:239], a[204:207], v[48:51], v[236:239]
v_cvt_pk_bf16_f32 v52, v40, v41
v_cvt_pk_bf16_f32 v53, v42, v43
v_mfma_f32_16x16x32_bf16 a[232:235], a[244:247], v[72:75], a[232:235]
buffer_load_dwordx4 v17, s[24:27], s31 offen offset:1024 nt lds
buffer_load_dwordx4 a[92:95], v28, s[8:11], 0 offen offset:192
v_mfma_f32_16x16x32_bf16 v[40:43], a[160:163], a[48:51], 0
s_add_u32 m0, s32, 16384
ds_read_b128 a[188:191], v5 offset:45056
v_fmamk_f32 v32, v32, 0x3e0293ee, v24
v_mfma_f32_16x16x32_bf16 v[40:43], a[164:167], a[52:55], v[40:43]
s_add_u32 s31, s28, 81920
v_exp_f32 v32, v32
v_mfma_f32_16x16x32_bf16 v[40:43], a[168:171], a[56:59], v[40:43]
v_fmamk_f32 v33, v33, 0x3e0293ee, v24
v_fmamk_f32 v34, v34, 0x3e0293ee, v24
v_mfma_f32_16x16x32_bf16 v[40:43], a[172:175], a[60:63], v[40:43]
s_waitcnt lgkmcnt(2)
v_exp_f32 v33, v33
v_mfma_f32_16x16x32_bf16 v[112:115], a[208:211], v[64:67], v[112:115]
v_exp_f32 v34, v34
v_mfma_f32_16x16x32_bf16 v[116:119], a[212:215], v[64:67], v[116:119]
v_fmamk_f32 v35, v35, 0x3e0293ee, v24
v_cvt_pk_bf16_f32 v56, v32, v33
v_mfma_f32_16x16x32_bf16 v[120:123], a[216:219], v[64:67], v[120:123]
v_exp_f32 v35, v35
v_mfma_f32_16x16x32_bf16 v[124:127], a[220:223], v[64:67], v[124:127]
v_cvt_pk_bf16_f32 v57, v34, v35
v_add_u32 v28, s38, v18
v_mfma_f32_16x16x32_bf16 v[32:35], a[160:163], a[64:67], 0
s_add_u32 s38, s58, 8192
buffer_load_dwordx4 a[96:99], v28, s[8:11], 0 offen offset:0
v_fmamk_f32 v36, v36, 0x3e0293ee, v25
v_mfma_f32_16x16x32_bf16 v[32:35], a[164:167], a[68:71], v[32:35]
v_exp_f32 v36, v36
v_mfma_f32_16x16x32_bf16 v[32:35], a[168:171], a[72:75], v[32:35]
v_fmamk_f32 v37, v37, 0x3e0293ee, v25
v_fmamk_f32 v38, v38, 0x3e0293ee, v25
v_mfma_f32_16x16x32_bf16 v[32:35], a[172:175], a[76:79], v[32:35]
v_exp_f32 v37, v37
v_mfma_f32_16x16x32_bf16 v[144:147], a[208:211], v[68:71], v[144:147]
v_exp_f32 v38, v38
v_mfma_f32_16x16x32_bf16 v[148:151], a[212:215], v[68:71], v[148:151]
v_fmamk_f32 v39, v39, 0x3e0293ee, v25
v_cvt_pk_bf16_f32 v60, v36, v37
v_mfma_f32_16x16x32_bf16 v[152:155], a[216:219], v[68:71], v[152:155]
v_exp_f32 v39, v39
v_mfma_f32_16x16x32_bf16 v[156:159], a[220:223], v[68:71], v[156:159]
v_cvt_pk_bf16_f32 v61, v38, v39
v_fmamk_f32 v40, v40, 0x3e0293ee, v26
v_mfma_f32_16x16x32_bf16 a[236:239], a[244:247], v[76:79], a[236:239]
s_waitcnt vmcnt(13) lgkmcnt(0)
v_exp_f32 v40, v40
v_mfma_f32_16x16x32_bf16 v[36:39], a[176:179], a[0:3], 0
s_barrier
v_fmamk_f32 v41, v41, 0x3e0293ee, v26
v_fmamk_f32 v42, v42, 0x3e0293ee, v26
v_mfma_f32_16x16x32_bf16 v[36:39], a[180:183], a[4:7], v[36:39]
v_exp_f32 v41, v41
v_mfma_f32_16x16x32_bf16 v[36:39], a[184:187], a[8:11], v[36:39]
v_exp_f32 v42, v42
v_mfma_f32_16x16x32_bf16 v[36:39], a[188:191], a[12:15], v[36:39]
v_fmamk_f32 v43, v43, 0x3e0293ee, v26
v_cvt_pk_bf16_f32 v64, v40, v41
v_mfma_f32_16x16x32_bf16 v[176:179], a[208:211], v[72:75], v[176:179]
v_exp_f32 v43, v43
v_mfma_f32_16x16x32_bf16 v[180:183], a[212:215], v[72:75], v[180:183]
buffer_load_dwordx4 v14, s[20:23], s30 offen nt lds
v_cvt_pk_bf16_f32 v65, v42, v43
v_mfma_f32_16x16x32_bf16 v[184:187], a[216:219], v[72:75], v[184:187]
ds_read_b64_tr_b16 a[192:193], v6 offset:40960
v_fmamk_f32 v32, v32, 0x3e0293ee, v27
v_mfma_f32_16x16x32_bf16 v[188:191], a[220:223], v[72:75], v[188:191]
v_exp_f32 v32, v32
v_mfma_f32_16x16x32_bf16 v[40:43], a[176:179], a[16:19], 0
ds_read_b64_tr_b16 a[194:195], v6 offset:45056
v_fmamk_f32 v33, v33, 0x3e0293ee, v27
v_mfma_f32_16x16x32_bf16 v[40:43], a[180:183], a[20:23], v[40:43]
v_exp_f32 v33, v33
v_mfma_f32_16x16x32_bf16 v[40:43], a[184:187], a[24:27], v[40:43]
ds_read_b64_tr_b16 a[196:197], v7 offset:40960
v_fmamk_f32 v34, v34, 0x3e0293ee, v27
v_mfma_f32_16x16x32_bf16 v[40:43], a[188:191], a[28:31], v[40:43]
v_exp_f32 v34, v34
v_mfma_f32_16x16x32_bf16 v[208:211], a[208:211], v[76:79], v[208:211]
ds_read_b64_tr_b16 a[198:199], v7 offset:45056
v_fmamk_f32 v35, v35, 0x3e0293ee, v27
v_mfma_f32_16x16x32_bf16 v[212:215], a[212:215], v[76:79], v[212:215]
v_exp_f32 v35, v35
v_mfma_f32_16x16x32_bf16 v[216:219], a[216:219], v[76:79], v[216:219]
ds_read_b64_tr_b16 a[200:201], v8 offset:40960
v_cvt_pk_bf16_f32 v68, v32, v33
v_mfma_f32_16x16x32_bf16 v[220:223], a[220:223], v[76:79], v[220:223]
ds_read_b64_tr_b16 a[202:203], v8 offset:45056
v_cvt_pk_bf16_f32 v69, v34, v35
v_mfma_f32_16x16x32_bf16 a[240:243], a[244:247], v[48:51], a[240:243]
ds_read_b64_tr_b16 a[204:205], v9 offset:40960
v_fmamk_f32 v36, v36, 0x3e0293ee, v23
v_mfma_f32_16x16x32_bf16 v[32:35], a[176:179], a[32:35], 0
v_exp_f32 v36, v36
v_mfma_f32_16x16x32_bf16 v[32:35], a[180:183], a[36:39], v[32:35]
ds_read_b64_tr_b16 a[206:207], v9 offset:45056
v_fmamk_f32 v37, v37, 0x3e0293ee, v23
v_mfma_f32_16x16x32_bf16 v[32:35], a[184:187], a[40:43], v[32:35]
v_exp_f32 v37, v37
v_mfma_f32_16x16x32_bf16 v[32:35], a[188:191], a[44:47], v[32:35]
buffer_load_dwordx4 v15, s[20:23], s30 offen offset:1024 nt lds
v_fmamk_f32 v38, v38, 0x3e0293ee, v23
v_mfma_f32_16x16x32_bf16 v[240:243], a[208:211], v[48:51], v[240:243]
s_add_u32 m0, s32, 81920
v_exp_f32 v38, v38
v_mfma_f32_16x16x32_bf16 v[244:247], a[212:215], v[48:51], v[244:247]
s_add_u32 s30, s28, 90112
ds_read_b128 a[160:163], v2 offset:49152
v_fmamk_f32 v39, v39, 0x3e0293ee, v23
v_mfma_f32_16x16x32_bf16 v[248:251], a[216:219], v[48:51], v[248:251]
v_exp_f32 v39, v39
v_mfma_f32_16x16x32_bf16 v[252:255], a[220:223], v[48:51], v[252:255]
v_cvt_pk_bf16_f32 v54, v36, v37
v_cvt_pk_bf16_f32 v55, v38, v39
v_mfma_f32_16x16x32_bf16 v[36:39], a[176:179], a[48:51], 0
ds_read_b128 a[164:167], v3 offset:49152
v_fmamk_f32 v40, v40, 0x3e0293ee, v24
v_mfma_f32_16x16x32_bf16 v[36:39], a[180:183], a[52:55], v[36:39]
v_exp_f32 v40, v40
v_mfma_f32_16x16x32_bf16 v[36:39], a[184:187], a[56:59], v[36:39]
buffer_load_dwordx4 v16, s[24:27], s31 offen nt lds
v_fmamk_f32 v41, v41, 0x3e0293ee, v24
v_mfma_f32_16x16x32_bf16 v[36:39], a[188:191], a[60:63], v[36:39]
s_waitcnt lgkmcnt(2)
v_exp_f32 v41, v41
v_mfma_f32_16x16x32_bf16 v[96:99], a[192:195], v[52:55], v[96:99]
ds_read_b128 a[168:171], v4 offset:49152
v_fmamk_f32 v42, v42, 0x3e0293ee, v24
v_mfma_f32_16x16x32_bf16 v[100:103], a[196:199], v[52:55], v[100:103]
v_exp_f32 v42, v42
v_mfma_f32_16x16x32_bf16 v[104:107], a[200:203], v[52:55], v[104:107]
ds_read_b128 a[172:175], v5 offset:49152
v_fmamk_f32 v43, v43, 0x3e0293ee, v24
v_mfma_f32_16x16x32_bf16 v[108:111], a[204:207], v[52:55], v[108:111]
v_exp_f32 v43, v43
v_mfma_f32_16x16x32_bf16 a[224:227], a[244:247], v[52:55], a[224:227]
v_cvt_pk_bf16_f32 v58, v40, v41
v_cvt_pk_bf16_f32 v59, v42, v43
v_mfma_f32_16x16x32_bf16 v[40:43], a[176:179], a[64:67], 0
buffer_load_dwordx4 v17, s[24:27], s31 offen offset:1024 nt lds
v_fmamk_f32 v32, v32, 0x3e0293ee, v25
v_mfma_f32_16x16x32_bf16 v[40:43], a[180:183], a[68:71], v[40:43]
s_add_u32 m0, s32, 24576
v_exp_f32 v32, v32
v_mfma_f32_16x16x32_bf16 v[40:43], a[184:187], a[72:75], v[40:43]
s_add_u32 s31, s28, 90112
v_fmamk_f32 v33, v33, 0x3e0293ee, v25
v_fmamk_f32 v34, v34, 0x3e0293ee, v25
v_mfma_f32_16x16x32_bf16 v[40:43], a[188:191], a[76:79], v[40:43]
v_exp_f32 v33, v33
v_mfma_f32_16x16x32_bf16 v[128:131], a[192:195], v[56:59], v[128:131]
v_exp_f32 v34, v34
v_mfma_f32_16x16x32_bf16 v[132:135], a[196:199], v[56:59], v[132:135]
v_fmamk_f32 v35, v35, 0x3e0293ee, v25
v_cvt_pk_bf16_f32 v62, v32, v33
v_mfma_f32_16x16x32_bf16 v[136:139], a[200:203], v[56:59], v[136:139]
v_exp_f32 v35, v35
v_mfma_f32_16x16x32_bf16 v[140:143], a[204:207], v[56:59], v[140:143]
s_waitcnt lgkmcnt(0)
v_cvt_pk_bf16_f32 v63, v34, v35
v_fmamk_f32 v36, v36, 0x3e0293ee, v26
v_mfma_f32_16x16x32_bf16 v[32:35], a[160:163], a[0:3], 0
v_exp_f32 v36, v36
v_mfma_f32_16x16x32_bf16 v[32:35], a[164:167], a[4:7], v[32:35]
v_fmamk_f32 v37, v37, 0x3e0293ee, v26
v_fmamk_f32 v38, v38, 0x3e0293ee, v26
v_mfma_f32_16x16x32_bf16 v[32:35], a[168:171], a[8:11], v[32:35]
v_exp_f32 v37, v37
v_mfma_f32_16x16x32_bf16 v[32:35], a[172:175], a[12:15], v[32:35]
v_exp_f32 v38, v38
v_mfma_f32_16x16x32_bf16 v[160:163], a[192:195], v[60:63], v[160:163]
buffer_load_dwordx4 v14, s[20:23], s30 offen nt lds
v_fmamk_f32 v39, v39, 0x3e0293ee, v26
v_mfma_f32_16x16x32_bf16 v[164:167], a[196:199], v[60:63], v[164:167]
v_exp_f32 v39, v39
v_mfma_f32_16x16x32_bf16 v[168:171], a[200:203], v[60:63], v[168:171]
v_cvt_pk_bf16_f32 v66, v36, v37
v_cvt_pk_bf16_f32 v67, v38, v39
v_mfma_f32_16x16x32_bf16 v[172:175], a[204:207], v[60:63], v[172:175]
ds_read_b64_tr_b16 a[208:209], v10 offset:40960
v_fmamk_f32 v40, v40, 0x3e0293ee, v27
v_mfma_f32_16x16x32_bf16 a[228:231], a[244:247], v[56:59], a[228:231]
v_exp_f32 v40, v40
v_mfma_f32_16x16x32_bf16 v[36:39], a[160:163], a[16:19], 0
ds_read_b64_tr_b16 a[210:211], v10 offset:45056
v_fmamk_f32 v41, v41, 0x3e0293ee, v27
v_mfma_f32_16x16x32_bf16 v[36:39], a[164:167], a[20:23], v[36:39]
v_exp_f32 v41, v41
v_mfma_f32_16x16x32_bf16 v[36:39], a[168:171], a[24:27], v[36:39]
ds_read_b64_tr_b16 a[212:213], v11 offset:40960
v_fmamk_f32 v42, v42, 0x3e0293ee, v27
v_mfma_f32_16x16x32_bf16 v[36:39], a[172:175], a[28:31], v[36:39]
v_exp_f32 v42, v42
v_mfma_f32_16x16x32_bf16 v[192:195], a[192:195], v[64:67], v[192:195]
buffer_load_dwordx4 v15, s[20:23], s30 offen offset:1024 nt lds
v_fmamk_f32 v43, v43, 0x3e0293ee, v27
v_mfma_f32_16x16x32_bf16 v[196:199], a[196:199], v[64:67], v[196:199]
s_add_u32 m0, s32, 90112
v_exp_f32 v43, v43
v_mfma_f32_16x16x32_bf16 v[200:203], a[200:203], v[64:67], v[200:203]
s_add_u32 s30, s28, 98304
ds_read_b64_tr_b16 a[214:215], v11 offset:45056
v_cvt_pk_bf16_f32 v70, v40, v41
v_mfma_f32_16x16x32_bf16 v[204:207], a[204:207], v[64:67], v[204:207]
v_cvt_pk_bf16_f32 v71, v42, v43
v_fmamk_f32 v32, v32, 0x3e0293ee, v23
v_mfma_f32_16x16x32_bf16 v[40:43], a[160:163], a[32:35], 0
v_exp_f32 v32, v32
v_mfma_f32_16x16x32_bf16 v[40:43], a[164:167], a[36:39], v[40:43]
ds_read_b64_tr_b16 a[216:217], v12 offset:40960
v_fmamk_f32 v33, v33, 0x3e0293ee, v23
v_mfma_f32_16x16x32_bf16 v[40:43], a[168:171], a[40:43], v[40:43]
v_exp_f32 v33, v33
v_mfma_f32_16x16x32_bf16 v[40:43], a[172:175], a[44:47], v[40:43]
ds_read_b64_tr_b16 a[218:219], v12 offset:45056
v_fmamk_f32 v34, v34, 0x3e0293ee, v23
v_mfma_f32_16x16x32_bf16 v[224:227], a[192:195], v[68:71], v[224:227]
v_exp_f32 v34, v34
v_mfma_f32_16x16x32_bf16 v[228:231], a[196:199], v[68:71], v[228:231]
buffer_load_dwordx4 v16, s[24:27], s31 offen nt lds
v_fmamk_f32 v35, v35, 0x3e0293ee, v23
v_mfma_f32_16x16x32_bf16 v[232:235], a[200:203], v[68:71], v[232:235]
v_exp_f32 v35, v35
v_mfma_f32_16x16x32_bf16 v[236:239], a[204:207], v[68:71], v[236:239]
ds_read_b64_tr_b16 a[220:221], v13 offset:40960
v_cvt_pk_bf16_f32 v72, v32, v33
v_mfma_f32_16x16x32_bf16 a[232:235], a[244:247], v[60:63], a[232:235]
ds_read_b64_tr_b16 a[222:223], v13 offset:45056
v_cvt_pk_bf16_f32 v73, v34, v35
v_mfma_f32_16x16x32_bf16 v[32:35], a[160:163], a[48:51], 0
ds_read_b128 a[176:179], v2 offset:53248
v_fmamk_f32 v36, v36, 0x3e0293ee, v24
v_mfma_f32_16x16x32_bf16 v[32:35], a[164:167], a[52:55], v[32:35]
v_exp_f32 v36, v36
v_mfma_f32_16x16x32_bf16 v[32:35], a[168:171], a[56:59], v[32:35]
ds_read_b128 a[180:183], v3 offset:53248
v_fmamk_f32 v37, v37, 0x3e0293ee, v24
v_mfma_f32_16x16x32_bf16 v[32:35], a[172:175], a[60:63], v[32:35]
s_waitcnt lgkmcnt(4)
v_exp_f32 v37, v37
v_mfma_f32_16x16x32_bf16 v[112:115], a[208:211], v[52:55], v[112:115]
ds_read_b128 a[184:187], v4 offset:53248
v_fmamk_f32 v38, v38, 0x3e0293ee, v24
v_mfma_f32_16x16x32_bf16 v[116:119], a[212:215], v[52:55], v[116:119]
v_exp_f32 v38, v38
v_mfma_f32_16x16x32_bf16 v[120:123], a[216:219], v[52:55], v[120:123]
s_waitcnt lgkmcnt(3)
buffer_load_dwordx4 v17, s[24:27], s31 offen offset:1024 nt lds
buffer_load_dwordx4 a[100:103], v28, s[8:11], 0 offen offset:64
v_fmamk_f32 v39, v39, 0x3e0293ee, v24
v_exp_f32 v39, v39
v_mfma_f32_16x16x32_bf16 v[124:127], a[220:223], v[52:55], v[124:127]
s_add_u32 m0, s32, 32768
v_cvt_pk_bf16_f32 v76, v36, v37
v_cvt_pk_bf16_f32 v77, v38, v39
v_mfma_f32_16x16x32_bf16 v[36:39], a[160:163], a[64:67], 0
s_add_u32 s31, s28, 98304
ds_read_b128 a[188:191], v5 offset:53248
v_fmamk_f32 v40, v40, 0x3e0293ee, v25
v_mfma_f32_16x16x32_bf16 v[36:39], a[164:167], a[68:71], v[36:39]
v_exp_f32 v40, v40
v_mfma_f32_16x16x32_bf16 v[36:39], a[168:171], a[72:75], v[36:39]
v_fmamk_f32 v41, v41, 0x3e0293ee, v25
v_fmamk_f32 v42, v42, 0x3e0293ee, v25
v_mfma_f32_16x16x32_bf16 v[36:39], a[172:175], a[76:79], v[36:39]
v_exp_f32 v41, v41
v_mfma_f32_16x16x32_bf16 v[144:147], a[208:211], v[56:59], v[144:147]
v_exp_f32 v42, v42
v_mfma_f32_16x16x32_bf16 v[148:151], a[212:215], v[56:59], v[148:151]
v_fmamk_f32 v43, v43, 0x3e0293ee, v25
v_cvt_pk_bf16_f32 v48, v40, v41
v_mfma_f32_16x16x32_bf16 v[152:155], a[216:219], v[56:59], v[152:155]
v_exp_f32 v43, v43
v_mfma_f32_16x16x32_bf16 v[156:159], a[220:223], v[56:59], v[156:159]
v_cvt_pk_bf16_f32 v49, v42, v43
v_fmamk_f32 v32, v32, 0x3e0293ee, v26
v_mfma_f32_16x16x32_bf16 a[236:239], a[244:247], v[64:67], a[236:239]
s_waitcnt lgkmcnt(0)
v_exp_f32 v32, v32
v_mfma_f32_16x16x32_bf16 v[40:43], a[176:179], a[0:3], 0
v_fmamk_f32 v33, v33, 0x3e0293ee, v26
v_fmamk_f32 v34, v34, 0x3e0293ee, v26
v_mfma_f32_16x16x32_bf16 v[40:43], a[180:183], a[4:7], v[40:43]
v_exp_f32 v33, v33
v_mfma_f32_16x16x32_bf16 v[40:43], a[184:187], a[8:11], v[40:43]
v_exp_f32 v34, v34
v_mfma_f32_16x16x32_bf16 v[40:43], a[188:191], a[12:15], v[40:43]
v_fmamk_f32 v35, v35, 0x3e0293ee, v26
v_cvt_pk_bf16_f32 v52, v32, v33
v_mfma_f32_16x16x32_bf16 v[176:179], a[208:211], v[60:63], v[176:179]
v_exp_f32 v35, v35
v_mfma_f32_16x16x32_bf16 v[180:183], a[212:215], v[60:63], v[180:183]
buffer_load_dwordx4 v14, s[20:23], s30 offen nt lds
v_cvt_pk_bf16_f32 v53, v34, v35
v_mfma_f32_16x16x32_bf16 v[184:187], a[216:219], v[60:63], v[184:187]
ds_read_b64_tr_b16 a[192:193], v6 offset:49152
v_fmamk_f32 v36, v36, 0x3e0293ee, v27
v_mfma_f32_16x16x32_bf16 v[188:191], a[220:223], v[60:63], v[188:191]
v_exp_f32 v36, v36
v_mfma_f32_16x16x32_bf16 v[32:35], a[176:179], a[16:19], 0
ds_read_b64_tr_b16 a[194:195], v6 offset:53248
v_fmamk_f32 v37, v37, 0x3e0293ee, v27
v_mfma_f32_16x16x32_bf16 v[32:35], a[180:183], a[20:23], v[32:35]
v_exp_f32 v37, v37
v_mfma_f32_16x16x32_bf16 v[32:35], a[184:187], a[24:27], v[32:35]
ds_read_b64_tr_b16 a[196:197], v7 offset:49152
v_fmamk_f32 v38, v38, 0x3e0293ee, v27
v_mfma_f32_16x16x32_bf16 v[32:35], a[188:191], a[28:31], v[32:35]
v_exp_f32 v38, v38
v_mfma_f32_16x16x32_bf16 v[208:211], a[208:211], v[64:67], v[208:211]
ds_read_b64_tr_b16 a[198:199], v7 offset:53248
v_fmamk_f32 v39, v39, 0x3e0293ee, v27
v_mfma_f32_16x16x32_bf16 v[212:215], a[212:215], v[64:67], v[212:215]
v_exp_f32 v39, v39
v_mfma_f32_16x16x32_bf16 v[216:219], a[216:219], v[64:67], v[216:219]
ds_read_b64_tr_b16 a[200:201], v8 offset:49152
v_cvt_pk_bf16_f32 v56, v36, v37
v_mfma_f32_16x16x32_bf16 v[220:223], a[220:223], v[64:67], v[220:223]
ds_read_b64_tr_b16 a[202:203], v8 offset:53248
v_cvt_pk_bf16_f32 v57, v38, v39
v_mfma_f32_16x16x32_bf16 a[240:243], a[244:247], v[68:71], a[240:243]
ds_read_b64_tr_b16 a[204:205], v9 offset:49152
v_fmamk_f32 v40, v40, 0x3e0293ee, v23
v_mfma_f32_16x16x32_bf16 v[36:39], a[176:179], a[32:35], 0
v_exp_f32 v40, v40
v_mfma_f32_16x16x32_bf16 v[36:39], a[180:183], a[36:39], v[36:39]
ds_read_b64_tr_b16 a[206:207], v9 offset:53248
v_fmamk_f32 v41, v41, 0x3e0293ee, v23
v_mfma_f32_16x16x32_bf16 v[36:39], a[184:187], a[40:43], v[36:39]
v_exp_f32 v41, v41
v_mfma_f32_16x16x32_bf16 v[36:39], a[188:191], a[44:47], v[36:39]
ds_read_b128 a[160:163], v2 offset:57344
v_fmamk_f32 v42, v42, 0x3e0293ee, v23
v_mfma_f32_16x16x32_bf16 v[240:243], a[208:211], v[68:71], v[240:243]
v_exp_f32 v42, v42
v_mfma_f32_16x16x32_bf16 v[244:247], a[212:215], v[68:71], v[244:247]
ds_read_b128 a[164:167], v3 offset:57344
v_fmamk_f32 v43, v43, 0x3e0293ee, v23
v_mfma_f32_16x16x32_bf16 v[248:251], a[216:219], v[68:71], v[248:251]
v_exp_f32 v43, v43
v_mfma_f32_16x16x32_bf16 v[252:255], a[220:223], v[68:71], v[252:255]
v_cvt_pk_bf16_f32 v74, v40, v41
v_cvt_pk_bf16_f32 v75, v42, v43
v_mfma_f32_16x16x32_bf16 v[40:43], a[176:179], a[48:51], 0
ds_read_b128 a[168:171], v4 offset:57344
v_fmamk_f32 v32, v32, 0x3e0293ee, v24
v_mfma_f32_16x16x32_bf16 v[40:43], a[180:183], a[52:55], v[40:43]
v_exp_f32 v32, v32
v_mfma_f32_16x16x32_bf16 v[40:43], a[184:187], a[56:59], v[40:43]
s_waitcnt lgkmcnt(2)
buffer_load_dwordx4 v15, s[20:23], s30 offen offset:1024 nt lds
v_fmamk_f32 v33, v33, 0x3e0293ee, v24
v_mfma_f32_16x16x32_bf16 v[40:43], a[188:191], a[60:63], v[40:43]
s_add_u32 m0, s32, 98304
v_exp_f32 v33, v33
v_mfma_f32_16x16x32_bf16 v[96:99], a[192:195], v[72:75], v[96:99]
s_add_u32 s30, s28, 106496
ds_read_b128 a[172:175], v5 offset:57344
v_fmamk_f32 v34, v34, 0x3e0293ee, v24
v_mfma_f32_16x16x32_bf16 v[100:103], a[196:199], v[72:75], v[100:103]
v_exp_f32 v34, v34
v_mfma_f32_16x16x32_bf16 v[104:107], a[200:203], v[72:75], v[104:107]
v_fmamk_f32 v35, v35, 0x3e0293ee, v24
v_cvt_pk_bf16_f32 v78, v32, v33
v_mfma_f32_16x16x32_bf16 v[108:111], a[204:207], v[72:75], v[108:111]
v_exp_f32 v35, v35
v_mfma_f32_16x16x32_bf16 a[224:227], a[244:247], v[72:75], a[224:227]
v_cvt_pk_bf16_f32 v79, v34, v35
v_fmamk_f32 v36, v36, 0x3e0293ee, v25
v_mfma_f32_16x16x32_bf16 v[32:35], a[176:179], a[64:67], 0
v_exp_f32 v36, v36
v_mfma_f32_16x16x32_bf16 v[32:35], a[180:183], a[68:71], v[32:35]
v_fmamk_f32 v37, v37, 0x3e0293ee, v25
v_fmamk_f32 v38, v38, 0x3e0293ee, v25
v_mfma_f32_16x16x32_bf16 v[32:35], a[184:187], a[72:75], v[32:35]
v_exp_f32 v37, v37
v_mfma_f32_16x16x32_bf16 v[32:35], a[188:191], a[76:79], v[32:35]
v_exp_f32 v38, v38
v_mfma_f32_16x16x32_bf16 v[128:131], a[192:195], v[76:79], v[128:131]
v_fmamk_f32 v39, v39, 0x3e0293ee, v25
v_cvt_pk_bf16_f32 v50, v36, v37
v_mfma_f32_16x16x32_bf16 v[132:135], a[196:199], v[76:79], v[132:135]
v_exp_f32 v39, v39
v_mfma_f32_16x16x32_bf16 v[136:139], a[200:203], v[76:79], v[136:139]
v_cvt_pk_bf16_f32 v51, v38, v39
v_fmamk_f32 v40, v40, 0x3e0293ee, v26
v_mfma_f32_16x16x32_bf16 v[140:143], a[204:207], v[76:79], v[140:143]
v_exp_f32 v40, v40
v_mfma_f32_16x16x32_bf16 v[36:39], a[160:163], a[0:3], 0
s_waitcnt lgkmcnt(0)
v_fmamk_f32 v41, v41, 0x3e0293ee, v26
v_fmamk_f32 v42, v42, 0x3e0293ee, v26
v_mfma_f32_16x16x32_bf16 v[36:39], a[164:167], a[4:7], v[36:39]
v_exp_f32 v41, v41
v_mfma_f32_16x16x32_bf16 v[36:39], a[168:171], a[8:11], v[36:39]
v_exp_f32 v42, v42
v_mfma_f32_16x16x32_bf16 v[36:39], a[172:175], a[12:15], v[36:39]
v_fmamk_f32 v43, v43, 0x3e0293ee, v26
v_cvt_pk_bf16_f32 v54, v40, v41
v_mfma_f32_16x16x32_bf16 v[160:163], a[192:195], v[48:51], v[160:163]
L_pad0_3:
s_cbranch_execz L_pad0_7
v_exp_f32 v43, v43
v_mfma_f32_16x16x32_bf16 v[164:167], a[196:199], v[48:51], v[164:167]
buffer_load_dwordx4 v16, s[24:27], s31 offen nt lds
v_cvt_pk_bf16_f32 v55, v42, v43
v_mfma_f32_16x16x32_bf16 v[168:171], a[200:203], v[48:51], v[168:171]
ds_read_b64_tr_b16 a[208:209], v10 offset:49152
v_fmamk_f32 v32, v32, 0x3e0293ee, v27
v_mfma_f32_16x16x32_bf16 v[172:175], a[204:207], v[48:51], v[172:175]
v_exp_f32 v32, v32
v_mfma_f32_16x16x32_bf16 a[228:231], a[244:247], v[76:79], a[228:231]
ds_read_b64_tr_b16 a[210:211], v10 offset:53248
v_fmamk_f32 v33, v33, 0x3e0293ee, v27
v_mfma_f32_16x16x32_bf16 v[40:43], a[160:163], a[16:19], 0
v_exp_f32 v33, v33
v_mfma_f32_16x16x32_bf16 v[40:43], a[164:167], a[20:23], v[40:43]
ds_read_b64_tr_b16 a[212:213], v11 offset:49152
v_fmamk_f32 v34, v34, 0x3e0293ee, v27
v_mfma_f32_16x16x32_bf16 v[40:43], a[168:171], a[24:27], v[40:43]
v_exp_f32 v34, v34
v_mfma_f32_16x16x32_bf16 v[40:43], a[172:175], a[28:31], v[40:43]
ds_read_b64_tr_b16 a[214:215], v11 offset:53248
v_fmamk_f32 v35, v35, 0x3e0293ee, v27
v_mfma_f32_16x16x32_bf16 v[192:195], a[192:195], v[52:55], v[192:195]
v_exp_f32 v35, v35
v_mfma_f32_16x16x32_bf16 v[196:199], a[196:199], v[52:55], v[196:199]
ds_read_b64_tr_b16 a[216:217], v12 offset:49152
v_cvt_pk_bf16_f32 v58, v32, v33
v_mfma_f32_16x16x32_bf16 v[200:203], a[200:203], v[52:55], v[200:203]
ds_read_b64_tr_b16 a[218:219], v12 offset:53248
v_cvt_pk_bf16_f32 v59, v34, v35
v_mfma_f32_16x16x32_bf16 v[204:207], a[204:207], v[52:55], v[204:207]
ds_read_b64_tr_b16 a[220:221], v13 offset:49152
v_fmamk_f32 v36, v36, 0x3e0293ee, v23
v_mfma_f32_16x16x32_bf16 v[32:35], a[160:163], a[32:35], 0
v_exp_f32 v36, v36
v_mfma_f32_16x16x32_bf16 v[32:35], a[164:167], a[36:39], v[32:35]
ds_read_b64_tr_b16 a[222:223], v13 offset:53248
v_fmamk_f32 v37, v37, 0x3e0293ee, v23
v_mfma_f32_16x16x32_bf16 v[32:35], a[168:171], a[40:43], v[32:35]
v_exp_f32 v37, v37
v_mfma_f32_16x16x32_bf16 v[32:35], a[172:175], a[44:47], v[32:35]
ds_read_b128 a[176:179], v2 offset:61440
v_fmamk_f32 v38, v38, 0x3e0293ee, v23
v_mfma_f32_16x16x32_bf16 v[224:227], a[192:195], v[56:59], v[224:227]
v_exp_f32 v38, v38
v_mfma_f32_16x16x32_bf16 v[228:231], a[196:199], v[56:59], v[228:231]
ds_read_b128 a[180:183], v3 offset:61440
v_fmamk_f32 v39, v39, 0x3e0293ee, v23
v_mfma_f32_16x16x32_bf16 v[232:235], a[200:203], v[56:59], v[232:235]
v_exp_f32 v39, v39
v_mfma_f32_16x16x32_bf16 v[236:239], a[204:207], v[56:59], v[236:239]
ds_read_b128 a[184:187], v4 offset:61440
v_cvt_pk_bf16_f32 v60, v36, v37
v_mfma_f32_16x16x32_bf16 a[232:235], a[244:247], v[48:51], a[232:235]
buffer_load_dwordx4 v17, s[24:27], s31 offen offset:1024 nt lds
buffer_load_dwordx4 a[104:107], v28, s[8:11], 0 offen offset:128
v_cvt_pk_bf16_f32 v61, v38, v39
v_mfma_f32_16x16x32_bf16 v[36:39], a[160:163], a[48:51], 0
s_add_u32 m0, s32, 40960
ds_read_b128 a[188:191], v5 offset:61440
v_fmamk_f32 v40, v40, 0x3e0293ee, v24
v_mfma_f32_16x16x32_bf16 v[36:39], a[164:167], a[52:55], v[36:39]
s_add_u32 s31, s28, 106496
v_exp_f32 v40, v40
v_mfma_f32_16x16x32_bf16 v[36:39], a[168:171], a[56:59], v[36:39]
v_fmamk_f32 v41, v41, 0x3e0293ee, v24
v_fmamk_f32 v42, v42, 0x3e0293ee, v24
v_mfma_f32_16x16x32_bf16 v[36:39], a[172:175], a[60:63], v[36:39]
s_waitcnt lgkmcnt(3)
v_exp_f32 v41, v41
v_mfma_f32_16x16x32_bf16 v[112:115], a[208:211], v[72:75], v[112:115]
v_exp_f32 v42, v42
v_mfma_f32_16x16x32_bf16 v[116:119], a[212:215], v[72:75], v[116:119]
buffer_load_dwordx4 a[108:111], v28, s[8:11], 0 offen offset:192
v_fmamk_f32 v43, v43, 0x3e0293ee, v24
v_mfma_f32_16x16x32_bf16 v[120:123], a[216:219], v[72:75], v[120:123]
v_exp_f32 v43, v43
v_mfma_f32_16x16x32_bf16 v[124:127], a[220:223], v[72:75], v[124:127]
v_cvt_pk_bf16_f32 v64, v40, v41
v_cvt_pk_bf16_f32 v65, v42, v43
v_mfma_f32_16x16x32_bf16 v[40:43], a[160:163], a[64:67], 0
v_fmamk_f32 v32, v32, 0x3e0293ee, v25
v_fmamk_f32 v33, v33, 0x3e0293ee, v25
v_mfma_f32_16x16x32_bf16 v[40:43], a[164:167], a[68:71], v[40:43]
v_exp_f32 v32, v32
v_mfma_f32_16x16x32_bf16 v[40:43], a[168:171], a[72:75], v[40:43]
v_exp_f32 v33, v33
v_mfma_f32_16x16x32_bf16 v[40:43], a[172:175], a[76:79], v[40:43]
v_fmamk_f32 v34, v34, 0x3e0293ee, v25
v_fmamk_f32 v35, v35, 0x3e0293ee, v25
v_mfma_f32_16x16x32_bf16 v[144:147], a[208:211], v[76:79], v[144:147]
v_exp_f32 v34, v34
v_mfma_f32_16x16x32_bf16 v[148:151], a[212:215], v[76:79], v[148:151]
v_exp_f32 v35, v35
v_mfma_f32_16x16x32_bf16 v[152:155], a[216:219], v[76:79], v[152:155]
v_cvt_pk_bf16_f32 v68, v32, v33
v_cvt_pk_bf16_f32 v69, v34, v35
v_mfma_f32_16x16x32_bf16 v[156:159], a[220:223], v[76:79], v[156:159]
v_fmamk_f32 v36, v36, 0x3e0293ee, v26
v_fmamk_f32 v37, v37, 0x3e0293ee, v26
v_mfma_f32_16x16x32_bf16 a[236:239], a[244:247], v[52:55], a[236:239]
s_waitcnt vmcnt(17) lgkmcnt(0)
v_exp_f32 v36, v36
v_mfma_f32_16x16x32_bf16 v[32:35], a[176:179], a[0:3], 0
s_barrier
v_exp_f32 v37, v37
v_mfma_f32_16x16x32_bf16 v[32:35], a[180:183], a[4:7], v[32:35]
v_fmamk_f32 v38, v38, 0x3e0293ee, v26
v_fmamk_f32 v39, v39, 0x3e0293ee, v26
v_mfma_f32_16x16x32_bf16 v[32:35], a[184:187], a[8:11], v[32:35]
v_exp_f32 v38, v38
v_mfma_f32_16x16x32_bf16 v[32:35], a[188:191], a[12:15], v[32:35]
v_exp_f32 v39, v39
v_mfma_f32_16x16x32_bf16 v[176:179], a[208:211], v[48:51], v[176:179]
buffer_load_dwordx4 v14, s[20:23], s30 offen nt lds
v_cvt_pk_bf16_f32 v72, v36, v37
v_mfma_f32_16x16x32_bf16 v[180:183], a[212:215], v[48:51], v[180:183]
ds_read_b64_tr_b16 a[192:193], v6 offset:57344
v_cvt_pk_bf16_f32 v73, v38, v39
v_mfma_f32_16x16x32_bf16 v[184:187], a[216:219], v[48:51], v[184:187]
ds_read_b64_tr_b16 a[194:195], v6 offset:61440
v_fmamk_f32 v40, v40, 0x3e0293ee, v27
v_mfma_f32_16x16x32_bf16 v[188:191], a[220:223], v[48:51], v[188:191]
v_exp_f32 v40, v40
v_mfma_f32_16x16x32_bf16 v[36:39], a[176:179], a[16:19], 0
ds_read_b64_tr_b16 a[196:197], v7 offset:57344
v_fmamk_f32 v41, v41, 0x3e0293ee, v27
v_mfma_f32_16x16x32_bf16 v[36:39], a[180:183], a[20:23], v[36:39]
v_exp_f32 v41, v41
v_mfma_f32_16x16x32_bf16 v[36:39], a[184:187], a[24:27], v[36:39]
ds_read_b64_tr_b16 a[198:199], v7 offset:61440
v_fmamk_f32 v42, v42, 0x3e0293ee, v27
v_mfma_f32_16x16x32_bf16 v[36:39], a[188:191], a[28:31], v[36:39]
v_exp_f32 v42, v42
v_mfma_f32_16x16x32_bf16 v[208:211], a[208:211], v[52:55], v[208:211]
ds_read_b64_tr_b16 a[200:201], v8 offset:57344
v_fmamk_f32 v43, v43, 0x3e0293ee, v27
v_mfma_f32_16x16x32_bf16 v[212:215], a[212:215], v[52:55], v[212:215]
v_exp_f32 v43, v43
v_mfma_f32_16x16x32_bf16 v[216:219], a[216:219], v[52:55], v[216:219]
ds_read_b64_tr_b16 a[202:203], v8 offset:61440
v_cvt_pk_bf16_f32 v76, v40, v41
v_mfma_f32_16x16x32_bf16 v[220:223], a[220:223], v[52:55], v[220:223]
ds_read_b64_tr_b16 a[204:205], v9 offset:57344
v_cvt_pk_bf16_f32 v77, v42, v43
v_mfma_f32_16x16x32_bf16 a[240:243], a[244:247], v[56:59], a[240:243]
ds_read_b64_tr_b16 a[206:207], v9 offset:61440
v_fmamk_f32 v32, v32, 0x3e0293ee, v23
v_mfma_f32_16x16x32_bf16 v[40:43], a[176:179], a[32:35], 0
v_exp_f32 v32, v32
v_mfma_f32_16x16x32_bf16 v[40:43], a[180:183], a[36:39], v[40:43]
ds_read_b128 a[160:163], v2 offset:0
v_fmamk_f32 v33, v33, 0x3e0293ee, v23
v_mfma_f32_16x16x32_bf16 v[40:43], a[184:187], a[40:43], v[40:43]
v_exp_f32 v33, v33
v_mfma_f32_16x16x32_bf16 v[40:43], a[188:191], a[44:47], v[40:43]
ds_read_b128 a[164:167], v3 offset:0
v_fmamk_f32 v34, v34, 0x3e0293ee, v23
v_mfma_f32_16x16x32_bf16 v[240:243], a[208:211], v[56:59], v[240:243]
v_exp_f32 v34, v34
v_mfma_f32_16x16x32_bf16 v[244:247], a[212:215], v[56:59], v[244:247]
ds_read_b128 a[168:171], v4 offset:0
v_fmamk_f32 v35, v35, 0x3e0293ee, v23
v_mfma_f32_16x16x32_bf16 v[248:251], a[216:219], v[56:59], v[248:251]
v_exp_f32 v35, v35
v_mfma_f32_16x16x32_bf16 v[252:255], a[220:223], v[56:59], v[252:255]
v_cvt_pk_bf16_f32 v62, v32, v33
v_cvt_pk_bf16_f32 v63, v34, v35
v_mfma_f32_16x16x32_bf16 v[32:35], a[176:179], a[48:51], 0
buffer_load_dwordx4 v15, s[20:23], s30 offen offset:1024 nt lds
v_fmamk_f32 v36, v36, 0x3e0293ee, v24
v_mfma_f32_16x16x32_bf16 v[32:35], a[180:183], a[52:55], v[32:35]
s_add_u32 m0, s32, 106496
v_exp_f32 v36, v36
v_mfma_f32_16x16x32_bf16 v[32:35], a[184:187], a[56:59], v[32:35]
s_add_u32 s30, s28, 114688
ds_read_b128 a[172:175], v5 offset:0
v_fmamk_f32 v37, v37, 0x3e0293ee, v24
v_mfma_f32_16x16x32_bf16 v[32:35], a[188:191], a[60:63], v[32:35]
s_waitcnt lgkmcnt(2)
v_exp_f32 v37, v37
v_mfma_f32_16x16x32_bf16 v[96:99], a[192:195], v[60:63], v[96:99]
v_fmamk_f32 v38, v38, 0x3e0293ee, v24
v_fmamk_f32 v39, v39, 0x3e0293ee, v24
v_mfma_f32_16x16x32_bf16 v[100:103], a[196:199], v[60:63], v[100:103]
v_exp_f32 v38, v38
v_mfma_f32_16x16x32_bf16 v[104:107], a[200:203], v[60:63], v[104:107]
v_exp_f32 v39, v39
v_mfma_f32_16x16x32_bf16 v[108:111], a[204:207], v[60:63], v[108:111]
v_cvt_pk_bf16_f32 v66, v36, v37
v_cvt_pk_bf16_f32 v67, v38, v39
v_mfma_f32_16x16x32_bf16 a[224:227], a[244:247], v[60:63], a[224:227]
v_fmamk_f32 v40, v40, 0x3e0293ee, v25
v_fmamk_f32 v41, v41, 0x3e0293ee, v25
v_mfma_f32_16x16x32_bf16 v[36:39], a[176:179], a[64:67], 0
v_exp_f32 v40, v40
v_mfma_f32_16x16x32_bf16 v[36:39], a[180:183], a[68:71], v[36:39]
v_exp_f32 v41, v41
v_mfma_f32_16x16x32_bf16 v[36:39], a[184:187], a[72:75], v[36:39]
v_fmamk_f32 v42, v42, 0x3e0293ee, v25
v_fmamk_f32 v43, v43, 0x3e0293ee, v25
v_mfma_f32_16x16x32_bf16 v[36:39], a[188:191], a[76:79], v[36:39]
v_exp_f32 v42, v42
v_mfma_f32_16x16x32_bf16 v[128:131], a[192:195], v[64:67], v[128:131]
v_exp_f32 v43, v43
v_mfma_f32_16x16x32_bf16 v[132:135], a[196:199], v[64:67], v[132:135]
v_cvt_pk_bf16_f32 v70, v40, v41
v_cvt_pk_bf16_f32 v71, v42, v43
v_mfma_f32_16x16x32_bf16 v[136:139], a[200:203], v[64:67], v[136:139]
v_fmamk_f32 v32, v32, 0x3e0293ee, v26
v_fmamk_f32 v33, v33, 0x3e0293ee, v26
v_mfma_f32_16x16x32_bf16 v[140:143], a[204:207], v[64:67], v[140:143]
v_exp_f32 v32, v32
v_mfma_f32_16x16x32_bf16 v[40:43], a[160:163], a[0:3], 0
v_exp_f32 v33, v33
v_mfma_f32_16x16x32_bf16 v[40:43], a[164:167], a[4:7], v[40:43]
s_waitcnt lgkmcnt(0)
v_fmamk_f32 v34, v34, 0x3e0293ee, v26
v_fmamk_f32 v35, v35, 0x3e0293ee, v26
v_mfma_f32_16x16x32_bf16 v[40:43], a[168:171], a[8:11], v[40:43]
v_exp_f32 v34, v34
v_mfma_f32_16x16x32_bf16 v[40:43], a[172:175], a[12:15], v[40:43]
v_exp_f32 v35, v35
v_mfma_f32_16x16x32_bf16 v[160:163], a[192:195], v[68:71], v[160:163]
buffer_load_dwordx4 v16, s[24:27], s31 offen nt lds
v_cvt_pk_bf16_f32 v74, v32, v33
v_mfma_f32_16x16x32_bf16 v[164:167], a[196:199], v[68:71], v[164:167]
ds_read_b64_tr_b16 a[208:209], v10 offset:57344
v_cvt_pk_bf16_f32 v75, v34, v35
v_mfma_f32_16x16x32_bf16 v[168:171], a[200:203], v[68:71], v[168:171]
ds_read_b64_tr_b16 a[210:211], v10 offset:61440
v_fmamk_f32 v36, v36, 0x3e0293ee, v27
v_mfma_f32_16x16x32_bf16 v[172:175], a[204:207], v[68:71], v[172:175]
v_exp_f32 v36, v36
v_mfma_f32_16x16x32_bf16 a[228:231], a[244:247], v[64:67], a[228:231]
ds_read_b64_tr_b16 a[212:213], v11 offset:57344
v_fmamk_f32 v37, v37, 0x3e0293ee, v27
v_mfma_f32_16x16x32_bf16 v[32:35], a[160:163], a[16:19], 0
v_exp_f32 v37, v37
v_mfma_f32_16x16x32_bf16 v[32:35], a[164:167], a[20:23], v[32:35]
ds_read_b64_tr_b16 a[214:215], v11 offset:61440
v_fmamk_f32 v38, v38, 0x3e0293ee, v27
v_mfma_f32_16x16x32_bf16 v[32:35], a[168:171], a[24:27], v[32:35]
v_exp_f32 v38, v38
v_mfma_f32_16x16x32_bf16 v[32:35], a[172:175], a[28:31], v[32:35]
ds_read_b64_tr_b16 a[216:217], v12 offset:57344
v_fmamk_f32 v39, v39, 0x3e0293ee, v27
v_mfma_f32_16x16x32_bf16 v[192:195], a[192:195], v[72:75], v[192:195]
v_exp_f32 v39, v39
v_mfma_f32_16x16x32_bf16 v[196:199], a[196:199], v[72:75], v[196:199]
ds_read_b64_tr_b16 a[218:219], v12 offset:61440
v_cvt_pk_bf16_f32 v78, v36, v37
v_mfma_f32_16x16x32_bf16 v[200:203], a[200:203], v[72:75], v[200:203]
ds_read_b64_tr_b16 a[220:221], v13 offset:57344
v_cvt_pk_bf16_f32 v79, v38, v39
v_mfma_f32_16x16x32_bf16 v[204:207], a[204:207], v[72:75], v[204:207]
ds_read_b64_tr_b16 a[222:223], v13 offset:61440
v_add_u32 v28, s38, v18
v_mfma_f32_16x16x32_bf16 v[36:39], a[160:163], a[32:35], 0
s_add_u32 s38, s58, 12288
ds_read_b128 a[176:179], v2 offset:4096
v_fmamk_f32 v40, v40, 0x3e0293ee, v23
v_mfma_f32_16x16x32_bf16 v[36:39], a[164:167], a[36:39], v[36:39]
v_exp_f32 v40, v40
v_mfma_f32_16x16x32_bf16 v[36:39], a[168:171], a[40:43], v[36:39]
ds_read_b128 a[180:183], v3 offset:4096
v_fmamk_f32 v41, v41, 0x3e0293ee, v23
v_mfma_f32_16x16x32_bf16 v[36:39], a[172:175], a[44:47], v[36:39]
v_exp_f32 v41, v41
v_mfma_f32_16x16x32_bf16 v[224:227], a[192:195], v[76:79], v[224:227]
v_fmamk_f32 v42, v42, 0x3e0293ee, v23
v_fmamk_f32 v43, v43, 0x3e0293ee, v23
v_mfma_f32_16x16x32_bf16 v[228:231], a[196:199], v[76:79], v[228:231]
v_exp_f32 v42, v42
v_mfma_f32_16x16x32_bf16 v[232:235], a[200:203], v[76:79], v[232:235]
v_exp_f32 v43, v43
v_mfma_f32_16x16x32_bf16 v[236:239], a[204:207], v[76:79], v[236:239]
ds_read_b128 a[184:187], v4 offset:4096
v_cvt_pk_bf16_f32 v48, v40, v41
v_mfma_f32_16x16x32_bf16 a[232:235], a[244:247], v[68:71], a[232:235]
buffer_load_dwordx4 v17, s[24:27], s31 offen offset:1024 nt lds
buffer_load_dwordx4 a[112:115], v28, s[8:11], 0 offen offset:0
v_cvt_pk_bf16_f32 v49, v42, v43
v_mfma_f32_16x16x32_bf16 v[40:43], a[160:163], a[48:51], 0
s_add_u32 m0, s32, 49152
ds_read_b128 a[188:191], v5 offset:4096
v_fmamk_f32 v32, v32, 0x3e0293ee, v24
v_mfma_f32_16x16x32_bf16 v[40:43], a[164:167], a[52:55], v[40:43]
s_add_u32 s31, s28, 114688
v_exp_f32 v32, v32
v_mfma_f32_16x16x32_bf16 v[40:43], a[168:171], a[56:59], v[40:43]
v_fmamk_f32 v33, v33, 0x3e0293ee, v24
v_fmamk_f32 v34, v34, 0x3e0293ee, v24
v_mfma_f32_16x16x32_bf16 v[40:43], a[172:175], a[60:63], v[40:43]
s_waitcnt lgkmcnt(2)
v_exp_f32 v33, v33
v_mfma_f32_16x16x32_bf16 v[112:115], a[208:211], v[60:63], v[112:115]
v_exp_f32 v34, v34
v_mfma_f32_16x16x32_bf16 v[116:119], a[212:215], v[60:63], v[116:119]
v_fmamk_f32 v35, v35, 0x3e0293ee, v24
v_cvt_pk_bf16_f32 v52, v32, v33
v_mfma_f32_16x16x32_bf16 v[120:123], a[216:219], v[60:63], v[120:123]
v_exp_f32 v35, v35
v_mfma_f32_16x16x32_bf16 v[124:127], a[220:223], v[60:63], v[124:127]
v_cvt_pk_bf16_f32 v53, v34, v35
v_fmamk_f32 v36, v36, 0x3e0293ee, v25
v_mfma_f32_16x16x32_bf16 v[32:35], a[160:163], a[64:67], 0
v_exp_f32 v36, v36
v_mfma_f32_16x16x32_bf16 v[32:35], a[164:167], a[68:71], v[32:35]
v_fmamk_f32 v37, v37, 0x3e0293ee, v25
v_fmamk_f32 v38, v38, 0x3e0293ee, v25
v_mfma_f32_16x16x32_bf16 v[32:35], a[168:171], a[72:75], v[32:35]
v_exp_f32 v37, v37
v_mfma_f32_16x16x32_bf16 v[32:35], a[172:175], a[76:79], v[32:35]
v_exp_f32 v38, v38
v_mfma_f32_16x16x32_bf16 v[144:147], a[208:211], v[64:67], v[144:147]
v_fmamk_f32 v39, v39, 0x3e0293ee, v25
v_cvt_pk_bf16_f32 v56, v36, v37
v_mfma_f32_16x16x32_bf16 v[148:151], a[212:215], v[64:67], v[148:151]
v_exp_f32 v39, v39
v_mfma_f32_16x16x32_bf16 v[152:155], a[216:219], v[64:67], v[152:155]
v_cvt_pk_bf16_f32 v57, v38, v39
v_fmamk_f32 v40, v40, 0x3e0293ee, v26
v_mfma_f32_16x16x32_bf16 v[156:159], a[220:223], v[64:67], v[156:159]
v_exp_f32 v40, v40
v_mfma_f32_16x16x32_bf16 a[236:239], a[244:247], v[72:75], a[236:239]
v_fmamk_f32 v41, v41, 0x3e0293ee, v26
v_fmamk_f32 v42, v42, 0x3e0293ee, v26
v_mfma_f32_16x16x32_bf16 v[36:39], a[176:179], a[0:3], 0
v_exp_f32 v41, v41
v_mfma_f32_16x16x32_bf16 v[36:39], a[180:183], a[4:7], v[36:39]
s_waitcnt lgkmcnt(0)
v_exp_f32 v42, v42
v_mfma_f32_16x16x32_bf16 v[36:39], a[184:187], a[8:11], v[36:39]
v_fmamk_f32 v43, v43, 0x3e0293ee, v26
v_cvt_pk_bf16_f32 v60, v40, v41
v_mfma_f32_16x16x32_bf16 v[36:39], a[188:191], a[12:15], v[36:39]
v_exp_f32 v43, v43
v_mfma_f32_16x16x32_bf16 v[176:179], a[208:211], v[68:71], v[176:179]
buffer_load_dwordx4 v14, s[20:23], s30 offen nt lds
v_cvt_pk_bf16_f32 v61, v42, v43
v_mfma_f32_16x16x32_bf16 v[180:183], a[212:215], v[68:71], v[180:183]
ds_read_b64_tr_b16 a[192:193], v6 offset:0
v_fmamk_f32 v32, v32, 0x3e0293ee, v27
v_mfma_f32_16x16x32_bf16 v[184:187], a[216:219], v[68:71], v[184:187]
v_exp_f32 v32, v32
v_mfma_f32_16x16x32_bf16 v[188:191], a[220:223], v[68:71], v[188:191]
ds_read_b64_tr_b16 a[194:195], v6 offset:4096
v_fmamk_f32 v33, v33, 0x3e0293ee, v27
v_mfma_f32_16x16x32_bf16 v[40:43], a[176:179], a[16:19], 0
v_exp_f32 v33, v33
v_mfma_f32_16x16x32_bf16 v[40:43], a[180:183], a[20:23], v[40:43]
ds_read_b64_tr_b16 a[196:197], v7 offset:0
v_fmamk_f32 v34, v34, 0x3e0293ee, v27
v_mfma_f32_16x16x32_bf16 v[40:43], a[184:187], a[24:27], v[40:43]
v_exp_f32 v34, v34
v_mfma_f32_16x16x32_bf16 v[40:43], a[188:191], a[28:31], v[40:43]
ds_read_b64_tr_b16 a[198:199], v7 offset:4096
v_fmamk_f32 v35, v35, 0x3e0293ee, v27
v_mfma_f32_16x16x32_bf16 v[208:211], a[208:211], v[72:75], v[208:211]
v_exp_f32 v35, v35
v_mfma_f32_16x16x32_bf16 v[212:215], a[212:215], v[72:75], v[212:215]
ds_read_b64_tr_b16 a[200:201], v8 offset:0
v_cvt_pk_bf16_f32 v64, v32, v33
v_mfma_f32_16x16x32_bf16 v[216:219], a[216:219], v[72:75], v[216:219]
ds_read_b64_tr_b16 a[202:203], v8 offset:4096
v_cvt_pk_bf16_f32 v65, v34, v35
v_mfma_f32_16x16x32_bf16 v[220:223], a[220:223], v[72:75], v[220:223]
ds_read_b64_tr_b16 a[204:205], v9 offset:0
v_fmamk_f32 v36, v36, 0x3e0293ee, v23
v_mfma_f32_16x16x32_bf16 a[240:243], a[244:247], v[76:79], a[240:243]
v_exp_f32 v36, v36
v_mfma_f32_16x16x32_bf16 v[32:35], a[176:179], a[32:35], 0
ds_read_b64_tr_b16 a[206:207], v9 offset:4096
v_fmamk_f32 v37, v37, 0x3e0293ee, v23
v_mfma_f32_16x16x32_bf16 v[32:35], a[180:183], a[36:39], v[32:35]
v_exp_f32 v37, v37
v_mfma_f32_16x16x32_bf16 v[32:35], a[184:187], a[40:43], v[32:35]
ds_read_b128 a[160:163], v2 offset:8192
v_fmamk_f32 v38, v38, 0x3e0293ee, v23
v_mfma_f32_16x16x32_bf16 v[32:35], a[188:191], a[44:47], v[32:35]
v_exp_f32 v38, v38
v_mfma_f32_16x16x32_bf16 v[240:243], a[208:211], v[76:79], v[240:243]
ds_read_b128 a[164:167], v3 offset:8192
v_fmamk_f32 v39, v39, 0x3e0293ee, v23
v_mfma_f32_16x16x32_bf16 v[244:247], a[212:215], v[76:79], v[244:247]
v_exp_f32 v39, v39
v_mfma_f32_16x16x32_bf16 v[248:251], a[216:219], v[76:79], v[248:251]
ds_read_b128 a[168:171], v4 offset:8192
v_cvt_pk_bf16_f32 v50, v36, v37
v_mfma_f32_16x16x32_bf16 v[252:255], a[220:223], v[76:79], v[252:255]
v_cvt_pk_bf16_f32 v51, v38, v39
v_fmamk_f32 v40, v40, 0x3e0293ee, v24
v_mfma_f32_16x16x32_bf16 v[36:39], a[176:179], a[48:51], 0
v_exp_f32 v40, v40
v_mfma_f32_16x16x32_bf16 v[36:39], a[180:183], a[52:55], v[36:39]
s_waitcnt lgkmcnt(2)
buffer_load_dwordx4 v15, s[20:23], s30 offen offset:1024 nt lds
v_fmamk_f32 v41, v41, 0x3e0293ee, v24
v_mfma_f32_16x16x32_bf16 v[36:39], a[184:187], a[56:59], v[36:39]
s_add_u32 m0, s32, 114688
v_exp_f32 v41, v41
v_mfma_f32_16x16x32_bf16 v[36:39], a[188:191], a[60:63], v[36:39]
s_add_u32 s30, s28, 122880
ds_read_b128 a[172:175], v5 offset:8192
v_fmamk_f32 v42, v42, 0x3e0293ee, v24
v_mfma_f32_16x16x32_bf16 v[96:99], a[192:195], v[48:51], v[96:99]
v_exp_f32 v42, v42
v_mfma_f32_16x16x32_bf16 v[100:103], a[196:199], v[48:51], v[100:103]
v_fmamk_f32 v43, v43, 0x3e0293ee, v24
v_cvt_pk_bf16_f32 v54, v40, v41
v_mfma_f32_16x16x32_bf16 v[104:107], a[200:203], v[48:51], v[104:107]
v_exp_f32 v43, v43
v_mfma_f32_16x16x32_bf16 v[108:111], a[204:207], v[48:51], v[108:111]
v_cvt_pk_bf16_f32 v55, v42, v43
v_fmamk_f32 v32, v32, 0x3e0293ee, v25
v_mfma_f32_16x16x32_bf16 a[224:227], a[244:247], v[48:51], a[224:227]
v_exp_f32 v32, v32
v_mfma_f32_16x16x32_bf16 v[40:43], a[176:179], a[64:67], 0
v_fmamk_f32 v33, v33, 0x3e0293ee, v25
v_fmamk_f32 v34, v34, 0x3e0293ee, v25
v_mfma_f32_16x16x32_bf16 v[40:43], a[180:183], a[68:71], v[40:43]
v_exp_f32 v33, v33
v_mfma_f32_16x16x32_bf16 v[40:43], a[184:187], a[72:75], v[40:43]
v_exp_f32 v34, v34
v_mfma_f32_16x16x32_bf16 v[40:43], a[188:191], a[76:79], v[40:43]
v_fmamk_f32 v35, v35, 0x3e0293ee, v25
v_cvt_pk_bf16_f32 v58, v32, v33
v_mfma_f32_16x16x32_bf16 v[128:131], a[192:195], v[52:55], v[128:131]
v_exp_f32 v35, v35
v_mfma_f32_16x16x32_bf16 v[132:135], a[196:199], v[52:55], v[132:135]
v_cvt_pk_bf16_f32 v59, v34, v35
v_fmamk_f32 v36, v36, 0x3e0293ee, v26
v_mfma_f32_16x16x32_bf16 v[136:139], a[200:203], v[52:55], v[136:139]
v_exp_f32 v36, v36
v_mfma_f32_16x16x32_bf16 v[140:143], a[204:207], v[52:55], v[140:143]
v_fmamk_f32 v37, v37, 0x3e0293ee, v26
v_fmamk_f32 v38, v38, 0x3e0293ee, v26
v_mfma_f32_16x16x32_bf16 v[32:35], a[160:163], a[0:3], 0
s_waitcnt lgkmcnt(0)
v_exp_f32 v37, v37
v_mfma_f32_16x16x32_bf16 v[32:35], a[164:167], a[4:7], v[32:35]
v_exp_f32 v38, v38
v_mfma_f32_16x16x32_bf16 v[32:35], a[168:171], a[8:11], v[32:35]
v_fmamk_f32 v39, v39, 0x3e0293ee, v26
v_cvt_pk_bf16_f32 v62, v36, v37
v_mfma_f32_16x16x32_bf16 v[32:35], a[172:175], a[12:15], v[32:35]
v_exp_f32 v39, v39
v_mfma_f32_16x16x32_bf16 v[160:163], a[192:195], v[56:59], v[160:163]
buffer_load_dwordx4 v16, s[24:27], s31 offen nt lds
v_cvt_pk_bf16_f32 v63, v38, v39
v_mfma_f32_16x16x32_bf16 v[164:167], a[196:199], v[56:59], v[164:167]
ds_read_b64_tr_b16 a[208:209], v10 offset:0
v_fmamk_f32 v40, v40, 0x3e0293ee, v27
v_mfma_f32_16x16x32_bf16 v[168:171], a[200:203], v[56:59], v[168:171]
v_exp_f32 v40, v40
v_mfma_f32_16x16x32_bf16 v[172:175], a[204:207], v[56:59], v[172:175]
ds_read_b64_tr_b16 a[210:211], v10 offset:4096
v_fmamk_f32 v41, v41, 0x3e0293ee, v27
v_mfma_f32_16x16x32_bf16 a[228:231], a[244:247], v[52:55], a[228:231]
v_exp_f32 v41, v41
v_mfma_f32_16x16x32_bf16 v[36:39], a[160:163], a[16:19], 0
ds_read_b64_tr_b16 a[212:213], v11 offset:0
v_fmamk_f32 v42, v42, 0x3e0293ee, v27
v_mfma_f32_16x16x32_bf16 v[36:39], a[164:167], a[20:23], v[36:39]
v_exp_f32 v42, v42
v_mfma_f32_16x16x32_bf16 v[36:39], a[168:171], a[24:27], v[36:39]
ds_read_b64_tr_b16 a[214:215], v11 offset:4096
v_fmamk_f32 v43, v43, 0x3e0293ee, v27
v_mfma_f32_16x16x32_bf16 v[36:39], a[172:175], a[28:31], v[36:39]
v_exp_f32 v43, v43
v_mfma_f32_16x16x32_bf16 v[192:195], a[192:195], v[60:63], v[192:195]
ds_read_b64_tr_b16 a[216:217], v12 offset:0
v_cvt_pk_bf16_f32 v66, v40, v41
v_mfma_f32_16x16x32_bf16 v[196:199], a[196:199], v[60:63], v[196:199]
ds_read_b64_tr_b16 a[218:219], v12 offset:4096
v_cvt_pk_bf16_f32 v67, v42, v43
v_mfma_f32_16x16x32_bf16 v[200:203], a[200:203], v[60:63], v[200:203]
ds_read_b64_tr_b16 a[220:221], v13 offset:0
v_fmamk_f32 v32, v32, 0x3e0293ee, v23
v_mfma_f32_16x16x32_bf16 v[204:207], a[204:207], v[60:63], v[204:207]
v_exp_f32 v32, v32
v_mfma_f32_16x16x32_bf16 v[40:43], a[160:163], a[32:35], 0
ds_read_b64_tr_b16 a[222:223], v13 offset:4096
v_fmamk_f32 v33, v33, 0x3e0293ee, v23
v_mfma_f32_16x16x32_bf16 v[40:43], a[164:167], a[36:39], v[40:43]
v_exp_f32 v33, v33
v_mfma_f32_16x16x32_bf16 v[40:43], a[168:171], a[40:43], v[40:43]
ds_read_b128 a[176:179], v2 offset:12288
v_fmamk_f32 v34, v34, 0x3e0293ee, v23
v_mfma_f32_16x16x32_bf16 v[40:43], a[172:175], a[44:47], v[40:43]
v_exp_f32 v34, v34
v_mfma_f32_16x16x32_bf16 v[224:227], a[192:195], v[64:67], v[224:227]
ds_read_b128 a[180:183], v3 offset:12288
v_fmamk_f32 v35, v35, 0x3e0293ee, v23
v_mfma_f32_16x16x32_bf16 v[228:231], a[196:199], v[64:67], v[228:231]
v_exp_f32 v35, v35
v_mfma_f32_16x16x32_bf16 v[232:235], a[200:203], v[64:67], v[232:235]
ds_read_b128 a[184:187], v4 offset:12288
v_cvt_pk_bf16_f32 v68, v32, v33
v_mfma_f32_16x16x32_bf16 v[236:239], a[204:207], v[64:67], v[236:239]
ds_read_b128 a[188:191], v5 offset:12288
v_cvt_pk_bf16_f32 v69, v34, v35
v_mfma_f32_16x16x32_bf16 a[232:235], a[244:247], v[56:59], a[232:235]
buffer_load_dwordx4 v17, s[24:27], s31 offen offset:1024 nt lds
buffer_load_dwordx4 a[116:119], v28, s[8:11], 0 offen offset:64
v_mfma_f32_16x16x32_bf16 v[32:35], a[160:163], a[48:51], 0
s_add_u32 m0, s32, 57344
v_fmamk_f32 v36, v36, 0x3e0293ee, v24
v_fmamk_f32 v37, v37, 0x3e0293ee, v24
v_mfma_f32_16x16x32_bf16 v[32:35], a[164:167], a[52:55], v[32:35]
s_add_u32 s31, s28, 122880
v_exp_f32 v36, v36
v_mfma_f32_16x16x32_bf16 v[32:35], a[168:171], a[56:59], v[32:35]
v_exp_f32 v37, v37
v_mfma_f32_16x16x32_bf16 v[32:35], a[172:175], a[60:63], v[32:35]
s_waitcnt lgkmcnt(2)
v_fmamk_f32 v38, v38, 0x3e0293ee, v24
v_fmamk_f32 v39, v39, 0x3e0293ee, v24
v_mfma_f32_16x16x32_bf16 v[112:115], a[208:211], v[48:51], v[112:115]
v_exp_f32 v38, v38
v_mfma_f32_16x16x32_bf16 v[116:119], a[212:215], v[48:51], v[116:119]
v_exp_f32 v39, v39
v_mfma_f32_16x16x32_bf16 v[120:123], a[216:219], v[48:51], v[120:123]
buffer_load_dwordx4 a[120:123], v28, s[8:11], 0 offen offset:128
v_cvt_pk_bf16_f32 v72, v36, v37
v_mfma_f32_16x16x32_bf16 v[124:127], a[220:223], v[48:51], v[124:127]
v_cvt_pk_bf16_f32 v73, v38, v39
v_fmamk_f32 v40, v40, 0x3e0293ee, v25
v_mfma_f32_16x16x32_bf16 v[36:39], a[160:163], a[64:67], 0
v_exp_f32 v40, v40
v_mfma_f32_16x16x32_bf16 v[36:39], a[164:167], a[68:71], v[36:39]
v_fmamk_f32 v41, v41, 0x3e0293ee, v25
v_fmamk_f32 v42, v42, 0x3e0293ee, v25
v_mfma_f32_16x16x32_bf16 v[36:39], a[168:171], a[72:75], v[36:39]
v_exp_f32 v41, v41
v_mfma_f32_16x16x32_bf16 v[36:39], a[172:175], a[76:79], v[36:39]
v_exp_f32 v42, v42
v_mfma_f32_16x16x32_bf16 v[144:147], a[208:211], v[52:55], v[144:147]
v_fmamk_f32 v43, v43, 0x3e0293ee, v25
v_cvt_pk_bf16_f32 v76, v40, v41
v_mfma_f32_16x16x32_bf16 v[148:151], a[212:215], v[52:55], v[148:151]
v_exp_f32 v43, v43
v_mfma_f32_16x16x32_bf16 v[152:155], a[216:219], v[52:55], v[152:155]
v_cvt_pk_bf16_f32 v77, v42, v43
v_fmamk_f32 v32, v32, 0x3e0293ee, v26
v_mfma_f32_16x16x32_bf16 v[156:159], a[220:223], v[52:55], v[156:159]
v_exp_f32 v32, v32
v_mfma_f32_16x16x32_bf16 a[236:239], a[244:247], v[60:63], a[236:239]
s_waitcnt vmcnt(18) lgkmcnt(0)
v_fmamk_f32 v33, v33, 0x3e0293ee, v26
v_fmamk_f32 v34, v34, 0x3e0293ee, v26
v_mfma_f32_16x16x32_bf16 v[40:43], a[176:179], a[0:3], 0
s_barrier
v_exp_f32 v33, v33
v_mfma_f32_16x16x32_bf16 v[40:43], a[180:183], a[4:7], v[40:43]
v_exp_f32 v34, v34
v_mfma_f32_16x16x32_bf16 v[40:43], a[184:187], a[8:11], v[40:43]
v_fmamk_f32 v35, v35, 0x3e0293ee, v26
v_cvt_pk_bf16_f32 v48, v32, v33
v_mfma_f32_16x16x32_bf16 v[40:43], a[188:191], a[12:15], v[40:43]
v_exp_f32 v35, v35
v_mfma_f32_16x16x32_bf16 v[176:179], a[208:211], v[56:59], v[176:179]
buffer_load_dwordx4 v14, s[20:23], s30 offen nt lds
v_cvt_pk_bf16_f32 v49, v34, v35
v_mfma_f32_16x16x32_bf16 v[180:183], a[212:215], v[56:59], v[180:183]
ds_read_b64_tr_b16 a[192:193], v6 offset:8192
v_fmamk_f32 v36, v36, 0x3e0293ee, v27
v_mfma_f32_16x16x32_bf16 v[184:187], a[216:219], v[56:59], v[184:187]
L_pad0_4:
s_cbranch_execz L_pad0_8
v_exp_f32 v36, v36
v_mfma_f32_16x16x32_bf16 v[188:191], a[220:223], v[56:59], v[188:191]
ds_read_b64_tr_b16 a[194:195], v6 offset:12288
v_fmamk_f32 v37, v37, 0x3e0293ee, v27
v_mfma_f32_16x16x32_bf16 v[32:35], a[176:179], a[16:19], 0
v_exp_f32 v37, v37
v_mfma_f32_16x16x32_bf16 v[32:35], a[180:183], a[20:23], v[32:35]
ds_read_b64_tr_b16 a[196:197], v7 offset:8192
v_fmamk_f32 v38, v38, 0x3e0293ee, v27
v_mfma_f32_16x16x32_bf16 v[32:35], a[184:187], a[24:27], v[32:35]
v_exp_f32 v38, v38
v_mfma_f32_16x16x32_bf16 v[32:35], a[188:191], a[28:31], v[32:35]
ds_read_b64_tr_b16 a[198:199], v7 offset:12288
v_fmamk_f32 v39, v39, 0x3e0293ee, v27
v_mfma_f32_16x16x32_bf16 v[208:211], a[208:211], v[60:63], v[208:211]
v_exp_f32 v39, v39
v_mfma_f32_16x16x32_bf16 v[212:215], a[212:215], v[60:63], v[212:215]
ds_read_b64_tr_b16 a[200:201], v8 offset:8192
v_cvt_pk_bf16_f32 v52, v36, v37
v_mfma_f32_16x16x32_bf16 v[216:219], a[216:219], v[60:63], v[216:219]
ds_read_b64_tr_b16 a[202:203], v8 offset:12288
v_cvt_pk_bf16_f32 v53, v38, v39
v_mfma_f32_16x16x32_bf16 v[220:223], a[220:223], v[60:63], v[220:223]
ds_read_b64_tr_b16 a[204:205], v9 offset:8192
v_fmamk_f32 v40, v40, 0x3e0293ee, v23
v_mfma_f32_16x16x32_bf16 a[240:243], a[244:247], v[64:67], a[240:243]
v_exp_f32 v40, v40
v_mfma_f32_16x16x32_bf16 v[36:39], a[176:179], a[32:35], 0
ds_read_b64_tr_b16 a[206:207], v9 offset:12288
v_fmamk_f32 v41, v41, 0x3e0293ee, v23
v_mfma_f32_16x16x32_bf16 v[36:39], a[180:183], a[36:39], v[36:39]
v_exp_f32 v41, v41
v_mfma_f32_16x16x32_bf16 v[36:39], a[184:187], a[40:43], v[36:39]
ds_read_b128 a[160:163], v2 offset:16384
v_fmamk_f32 v42, v42, 0x3e0293ee, v23
v_mfma_f32_16x16x32_bf16 v[36:39], a[188:191], a[44:47], v[36:39]
v_exp_f32 v42, v42
v_mfma_f32_16x16x32_bf16 v[240:243], a[208:211], v[64:67], v[240:243]
ds_read_b128 a[164:167], v3 offset:16384
v_fmamk_f32 v43, v43, 0x3e0293ee, v23
v_mfma_f32_16x16x32_bf16 v[244:247], a[212:215], v[64:67], v[244:247]
v_exp_f32 v43, v43
v_mfma_f32_16x16x32_bf16 v[248:251], a[216:219], v[64:67], v[248:251]
ds_read_b128 a[168:171], v4 offset:16384
v_cvt_pk_bf16_f32 v70, v40, v41
v_mfma_f32_16x16x32_bf16 v[252:255], a[220:223], v[64:67], v[252:255]
v_cvt_pk_bf16_f32 v71, v42, v43
v_fmamk_f32 v32, v32, 0x3e0293ee, v24
v_mfma_f32_16x16x32_bf16 v[40:43], a[176:179], a[48:51], 0
v_exp_f32 v32, v32
v_mfma_f32_16x16x32_bf16 v[40:43], a[180:183], a[52:55], v[40:43]
s_waitcnt lgkmcnt(2)
buffer_load_dwordx4 v15, s[20:23], s30 offen offset:1024 nt lds
v_fmamk_f32 v33, v33, 0x3e0293ee, v24
v_mfma_f32_16x16x32_bf16 v[40:43], a[184:187], a[56:59], v[40:43]
s_add_u32 m0, s32, 122880
v_exp_f32 v33, v33
v_mfma_f32_16x16x32_bf16 v[40:43], a[188:191], a[60:63], v[40:43]
s_add_u32 s30, s29, 0
ds_read_b128 a[172:175], v5 offset:16384
v_fmamk_f32 v34, v34, 0x3e0293ee, v24
v_mfma_f32_16x16x32_bf16 v[96:99], a[192:195], v[68:71], v[96:99]
v_exp_f32 v34, v34
v_mfma_f32_16x16x32_bf16 v[100:103], a[196:199], v[68:71], v[100:103]
v_fmamk_f32 v35, v35, 0x3e0293ee, v24
v_cvt_pk_bf16_f32 v74, v32, v33
v_mfma_f32_16x16x32_bf16 v[104:107], a[200:203], v[68:71], v[104:107]
v_exp_f32 v35, v35
v_mfma_f32_16x16x32_bf16 v[108:111], a[204:207], v[68:71], v[108:111]
v_cvt_pk_bf16_f32 v75, v34, v35
v_fmamk_f32 v36, v36, 0x3e0293ee, v25
v_mfma_f32_16x16x32_bf16 a[224:227], a[244:247], v[68:71], a[224:227]
v_exp_f32 v36, v36
v_mfma_f32_16x16x32_bf16 v[32:35], a[176:179], a[64:67], 0
v_fmamk_f32 v37, v37, 0x3e0293ee, v25
v_fmamk_f32 v38, v38, 0x3e0293ee, v25
v_mfma_f32_16x16x32_bf16 v[32:35], a[180:183], a[68:71], v[32:35]
v_exp_f32 v37, v37
v_mfma_f32_16x16x32_bf16 v[32:35], a[184:187], a[72:75], v[32:35]
v_exp_f32 v38, v38
v_mfma_f32_16x16x32_bf16 v[32:35], a[188:191], a[76:79], v[32:35]
v_fmamk_f32 v39, v39, 0x3e0293ee, v25
v_cvt_pk_bf16_f32 v78, v36, v37
v_mfma_f32_16x16x32_bf16 v[128:131], a[192:195], v[72:75], v[128:131]
v_exp_f32 v39, v39
v_mfma_f32_16x16x32_bf16 v[132:135], a[196:199], v[72:75], v[132:135]
v_cvt_pk_bf16_f32 v79, v38, v39
v_fmamk_f32 v40, v40, 0x3e0293ee, v26
v_mfma_f32_16x16x32_bf16 v[136:139], a[200:203], v[72:75], v[136:139]
v_exp_f32 v40, v40
v_mfma_f32_16x16x32_bf16 v[140:143], a[204:207], v[72:75], v[140:143]
v_fmamk_f32 v41, v41, 0x3e0293ee, v26
v_fmamk_f32 v42, v42, 0x3e0293ee, v26
v_mfma_f32_16x16x32_bf16 v[36:39], a[160:163], a[0:3], 0
s_waitcnt lgkmcnt(0)
v_exp_f32 v41, v41
v_mfma_f32_16x16x32_bf16 v[36:39], a[164:167], a[4:7], v[36:39]
v_exp_f32 v42, v42
v_mfma_f32_16x16x32_bf16 v[36:39], a[168:171], a[8:11], v[36:39]
v_fmamk_f32 v43, v43, 0x3e0293ee, v26
v_cvt_pk_bf16_f32 v50, v40, v41
v_mfma_f32_16x16x32_bf16 v[36:39], a[172:175], a[12:15], v[36:39]
v_exp_f32 v43, v43
v_mfma_f32_16x16x32_bf16 v[160:163], a[192:195], v[76:79], v[160:163]
buffer_load_dwordx4 v16, s[24:27], s31 offen nt lds
v_cvt_pk_bf16_f32 v51, v42, v43
v_mfma_f32_16x16x32_bf16 v[164:167], a[196:199], v[76:79], v[164:167]
ds_read_b64_tr_b16 a[208:209], v10 offset:8192
v_fmamk_f32 v32, v32, 0x3e0293ee, v27
v_mfma_f32_16x16x32_bf16 v[168:171], a[200:203], v[76:79], v[168:171]
v_exp_f32 v32, v32
v_mfma_f32_16x16x32_bf16 v[172:175], a[204:207], v[76:79], v[172:175]
ds_read_b64_tr_b16 a[210:211], v10 offset:12288
v_fmamk_f32 v33, v33, 0x3e0293ee, v27
v_mfma_f32_16x16x32_bf16 a[228:231], a[244:247], v[72:75], a[228:231]
v_exp_f32 v33, v33
v_mfma_f32_16x16x32_bf16 v[40:43], a[160:163], a[16:19], 0
ds_read_b64_tr_b16 a[212:213], v11 offset:8192
v_fmamk_f32 v34, v34, 0x3e0293ee, v27
v_mfma_f32_16x16x32_bf16 v[40:43], a[164:167], a[20:23], v[40:43]
v_exp_f32 v34, v34
v_mfma_f32_16x16x32_bf16 v[40:43], a[168:171], a[24:27], v[40:43]
ds_read_b64_tr_b16 a[214:215], v11 offset:12288
v_fmamk_f32 v35, v35, 0x3e0293ee, v27
v_mfma_f32_16x16x32_bf16 v[40:43], a[172:175], a[28:31], v[40:43]
v_exp_f32 v35, v35
v_mfma_f32_16x16x32_bf16 v[192:195], a[192:195], v[48:51], v[192:195]
ds_read_b64_tr_b16 a[216:217], v12 offset:8192
v_cvt_pk_bf16_f32 v54, v32, v33
v_mfma_f32_16x16x32_bf16 v[196:199], a[196:199], v[48:51], v[196:199]
ds_read_b64_tr_b16 a[218:219], v12 offset:12288
v_cvt_pk_bf16_f32 v55, v34, v35
v_mfma_f32_16x16x32_bf16 v[200:203], a[200:203], v[48:51], v[200:203]
ds_read_b64_tr_b16 a[220:221], v13 offset:8192
v_fmamk_f32 v36, v36, 0x3e0293ee, v23
v_mfma_f32_16x16x32_bf16 v[204:207], a[204:207], v[48:51], v[204:207]
v_exp_f32 v36, v36
v_mfma_f32_16x16x32_bf16 v[32:35], a[160:163], a[32:35], 0
ds_read_b64_tr_b16 a[222:223], v13 offset:12288
v_fmamk_f32 v37, v37, 0x3e0293ee, v23
v_mfma_f32_16x16x32_bf16 v[32:35], a[164:167], a[36:39], v[32:35]
v_exp_f32 v37, v37
v_mfma_f32_16x16x32_bf16 v[32:35], a[168:171], a[40:43], v[32:35]
ds_read_b128 a[176:179], v2 offset:20480
v_fmamk_f32 v38, v38, 0x3e0293ee, v23
v_mfma_f32_16x16x32_bf16 v[32:35], a[172:175], a[44:47], v[32:35]
v_exp_f32 v38, v38
v_mfma_f32_16x16x32_bf16 v[224:227], a[192:195], v[52:55], v[224:227]
ds_read_b128 a[180:183], v3 offset:20480
v_fmamk_f32 v39, v39, 0x3e0293ee, v23
v_mfma_f32_16x16x32_bf16 v[228:231], a[196:199], v[52:55], v[228:231]
v_exp_f32 v39, v39
v_mfma_f32_16x16x32_bf16 v[232:235], a[200:203], v[52:55], v[232:235]
ds_read_b128 a[184:187], v4 offset:20480
v_cvt_pk_bf16_f32 v56, v36, v37
v_mfma_f32_16x16x32_bf16 v[236:239], a[204:207], v[52:55], v[236:239]
ds_read_b128 a[188:191], v5 offset:20480
v_cvt_pk_bf16_f32 v57, v38, v39
v_mfma_f32_16x16x32_bf16 a[232:235], a[244:247], v[76:79], a[232:235]
buffer_load_dwordx4 v17, s[24:27], s31 offen offset:1024 nt lds
buffer_load_dwordx4 a[124:127], v28, s[8:11], 0 offen offset:192
v_mfma_f32_16x16x32_bf16 v[36:39], a[160:163], a[48:51], 0
s_add_u32 m0, s32, 0
v_fmamk_f32 v40, v40, 0x3e0293ee, v24
v_fmamk_f32 v41, v41, 0x3e0293ee, v24
v_mfma_f32_16x16x32_bf16 v[36:39], a[164:167], a[52:55], v[36:39]
s_add_u32 s31, s29, 0
v_exp_f32 v40, v40
v_mfma_f32_16x16x32_bf16 v[36:39], a[168:171], a[56:59], v[36:39]
v_exp_f32 v41, v41
v_mfma_f32_16x16x32_bf16 v[36:39], a[172:175], a[60:63], v[36:39]
s_waitcnt lgkmcnt(2)
v_fmamk_f32 v42, v42, 0x3e0293ee, v24
v_fmamk_f32 v43, v43, 0x3e0293ee, v24
v_mfma_f32_16x16x32_bf16 v[112:115], a[208:211], v[68:71], v[112:115]
v_exp_f32 v42, v42
v_mfma_f32_16x16x32_bf16 v[116:119], a[212:215], v[68:71], v[116:119]
v_exp_f32 v43, v43
v_mfma_f32_16x16x32_bf16 v[120:123], a[216:219], v[68:71], v[120:123]
v_cvt_pk_bf16_f32 v60, v40, v41
v_cvt_pk_bf16_f32 v61, v42, v43
v_mfma_f32_16x16x32_bf16 v[124:127], a[220:223], v[68:71], v[124:127]
v_fmamk_f32 v32, v32, 0x3e0293ee, v25
v_fmamk_f32 v33, v33, 0x3e0293ee, v25
v_mfma_f32_16x16x32_bf16 v[40:43], a[160:163], a[64:67], 0
v_exp_f32 v32, v32
v_mfma_f32_16x16x32_bf16 v[40:43], a[164:167], a[68:71], v[40:43]
v_exp_f32 v33, v33
v_mfma_f32_16x16x32_bf16 v[40:43], a[168:171], a[72:75], v[40:43]
v_fmamk_f32 v34, v34, 0x3e0293ee, v25
v_fmamk_f32 v35, v35, 0x3e0293ee, v25
v_mfma_f32_16x16x32_bf16 v[40:43], a[172:175], a[76:79], v[40:43]
v_exp_f32 v34, v34
v_mfma_f32_16x16x32_bf16 v[144:147], a[208:211], v[72:75], v[144:147]
v_exp_f32 v35, v35
v_mfma_f32_16x16x32_bf16 v[148:151], a[212:215], v[72:75], v[148:151]
v_cvt_pk_bf16_f32 v64, v32, v33
v_cvt_pk_bf16_f32 v65, v34, v35
v_mfma_f32_16x16x32_bf16 v[152:155], a[216:219], v[72:75], v[152:155]
v_fmamk_f32 v36, v36, 0x3e0293ee, v26
v_fmamk_f32 v37, v37, 0x3e0293ee, v26
v_mfma_f32_16x16x32_bf16 v[156:159], a[220:223], v[72:75], v[156:159]
v_exp_f32 v36, v36
v_mfma_f32_16x16x32_bf16 a[236:239], a[244:247], v[48:51], a[236:239]
v_exp_f32 v37, v37
v_mfma_f32_16x16x32_bf16 v[32:35], a[176:179], a[0:3], 0
v_fmamk_f32 v38, v38, 0x3e0293ee, v26
v_fmamk_f32 v39, v39, 0x3e0293ee, v26
v_mfma_f32_16x16x32_bf16 v[32:35], a[180:183], a[4:7], v[32:35]
s_waitcnt lgkmcnt(0)
v_exp_f32 v38, v38
v_mfma_f32_16x16x32_bf16 v[32:35], a[184:187], a[8:11], v[32:35]
v_exp_f32 v39, v39
v_mfma_f32_16x16x32_bf16 v[32:35], a[188:191], a[12:15], v[32:35]
v_cvt_pk_bf16_f32 v68, v36, v37
v_cvt_pk_bf16_f32 v69, v38, v39
v_mfma_f32_16x16x32_bf16 v[176:179], a[208:211], v[76:79], v[176:179]
buffer_load_dwordx4 v14, s[20:23], s30 offen nt lds
v_fmamk_f32 v40, v40, 0x3e0293ee, v27
v_mfma_f32_16x16x32_bf16 v[180:183], a[212:215], v[76:79], v[180:183]
v_exp_f32 v40, v40
v_mfma_f32_16x16x32_bf16 v[184:187], a[216:219], v[76:79], v[184:187]
ds_read_b64_tr_b16 a[192:193], v6 offset:16384
v_fmamk_f32 v41, v41, 0x3e0293ee, v27
v_mfma_f32_16x16x32_bf16 v[188:191], a[220:223], v[76:79], v[188:191]
v_exp_f32 v41, v41
v_mfma_f32_16x16x32_bf16 v[36:39], a[176:179], a[16:19], 0
ds_read_b64_tr_b16 a[194:195], v6 offset:20480
v_fmamk_f32 v42, v42, 0x3e0293ee, v27
v_mfma_f32_16x16x32_bf16 v[36:39], a[180:183], a[20:23], v[36:39]
v_exp_f32 v42, v42
v_mfma_f32_16x16x32_bf16 v[36:39], a[184:187], a[24:27], v[36:39]
ds_read_b64_tr_b16 a[196:197], v7 offset:16384
v_fmamk_f32 v43, v43, 0x3e0293ee, v27
v_mfma_f32_16x16x32_bf16 v[36:39], a[188:191], a[28:31], v[36:39]
v_exp_f32 v43, v43
v_mfma_f32_16x16x32_bf16 v[208:211], a[208:211], v[48:51], v[208:211]
ds_read_b64_tr_b16 a[198:199], v7 offset:20480
v_cvt_pk_bf16_f32 v72, v40, v41
v_mfma_f32_16x16x32_bf16 v[212:215], a[212:215], v[48:51], v[212:215]
ds_read_b64_tr_b16 a[200:201], v8 offset:16384
v_cvt_pk_bf16_f32 v73, v42, v43
v_mfma_f32_16x16x32_bf16 v[216:219], a[216:219], v[48:51], v[216:219]
ds_read_b64_tr_b16 a[202:203], v8 offset:20480
v_fmamk_f32 v32, v32, 0x3e0293ee, v23
v_mfma_f32_16x16x32_bf16 v[220:223], a[220:223], v[48:51], v[220:223]
v_exp_f32 v32, v32
v_mfma_f32_16x16x32_bf16 a[240:243], a[244:247], v[52:55], a[240:243]
ds_read_b64_tr_b16 a[204:205], v9 offset:16384
v_fmamk_f32 v33, v33, 0x3e0293ee, v23
v_mfma_f32_16x16x32_bf16 v[40:43], a[176:179], a[32:35], 0
v_exp_f32 v33, v33
v_mfma_f32_16x16x32_bf16 v[40:43], a[180:183], a[36:39], v[40:43]
ds_read_b64_tr_b16 a[206:207], v9 offset:20480
v_fmamk_f32 v34, v34, 0x3e0293ee, v23
v_mfma_f32_16x16x32_bf16 v[40:43], a[184:187], a[40:43], v[40:43]
v_exp_f32 v34, v34
v_mfma_f32_16x16x32_bf16 v[40:43], a[188:191], a[44:47], v[40:43]
ds_read_b128 a[160:163], v2 offset:24576
v_fmamk_f32 v35, v35, 0x3e0293ee, v23
v_mfma_f32_16x16x32_bf16 v[240:243], a[208:211], v[52:55], v[240:243]
v_exp_f32 v35, v35
v_mfma_f32_16x16x32_bf16 v[244:247], a[212:215], v[52:55], v[244:247]
ds_read_b128 a[164:167], v3 offset:24576
v_cvt_pk_bf16_f32 v58, v32, v33
v_mfma_f32_16x16x32_bf16 v[248:251], a[216:219], v[52:55], v[248:251]
ds_read_b128 a[168:171], v4 offset:24576
v_cvt_pk_bf16_f32 v59, v34, v35
v_mfma_f32_16x16x32_bf16 v[252:255], a[220:223], v[52:55], v[252:255]
ds_read_b128 a[172:175], v5 offset:24576
v_fmamk_f32 v36, v36, 0x3e0293ee, v24
v_mfma_f32_16x16x32_bf16 v[32:35], a[176:179], a[48:51], 0
v_exp_f32 v36, v36
v_mfma_f32_16x16x32_bf16 v[32:35], a[180:183], a[52:55], v[32:35]
s_waitcnt lgkmcnt(3)
buffer_load_dwordx4 v15, s[20:23], s30 offen offset:1024 nt lds
v_fmamk_f32 v37, v37, 0x3e0293ee, v24
v_mfma_f32_16x16x32_bf16 v[32:35], a[184:187], a[56:59], v[32:35]
s_add_u32 m0, s32, 65536
v_exp_f32 v37, v37
v_mfma_f32_16x16x32_bf16 v[32:35], a[188:191], a[60:63], v[32:35]
s_add_u32 s30, s29, 8192
v_fmamk_f32 v38, v38, 0x3e0293ee, v24
v_fmamk_f32 v39, v39, 0x3e0293ee, v24
v_mfma_f32_16x16x32_bf16 v[96:99], a[192:195], v[56:59], v[96:99]
v_exp_f32 v38, v38
v_mfma_f32_16x16x32_bf16 v[100:103], a[196:199], v[56:59], v[100:103]
v_exp_f32 v39, v39
v_mfma_f32_16x16x32_bf16 v[104:107], a[200:203], v[56:59], v[104:107]
v_cvt_pk_bf16_f32 v62, v36, v37
v_cvt_pk_bf16_f32 v63, v38, v39
v_mfma_f32_16x16x32_bf16 v[108:111], a[204:207], v[56:59], v[108:111]
v_fmamk_f32 v40, v40, 0x3e0293ee, v25
v_fmamk_f32 v41, v41, 0x3e0293ee, v25
v_mfma_f32_16x16x32_bf16 a[224:227], a[244:247], v[56:59], a[224:227]
v_exp_f32 v40, v40
v_mfma_f32_16x16x32_bf16 v[36:39], a[176:179], a[64:67], 0
v_exp_f32 v41, v41
v_mfma_f32_16x16x32_bf16 v[36:39], a[180:183], a[68:71], v[36:39]
v_fmamk_f32 v42, v42, 0x3e0293ee, v25
v_fmamk_f32 v43, v43, 0x3e0293ee, v25
v_mfma_f32_16x16x32_bf16 v[36:39], a[184:187], a[72:75], v[36:39]
v_exp_f32 v42, v42
v_mfma_f32_16x16x32_bf16 v[36:39], a[188:191], a[76:79], v[36:39]
v_exp_f32 v43, v43
v_mfma_f32_16x16x32_bf16 v[128:131], a[192:195], v[60:63], v[128:131]
v_cvt_pk_bf16_f32 v66, v40, v41
v_cvt_pk_bf16_f32 v67, v42, v43
v_mfma_f32_16x16x32_bf16 v[132:135], a[196:199], v[60:63], v[132:135]
v_fmamk_f32 v32, v32, 0x3e0293ee, v26
v_fmamk_f32 v33, v33, 0x3e0293ee, v26
v_mfma_f32_16x16x32_bf16 v[136:139], a[200:203], v[60:63], v[136:139]
v_exp_f32 v32, v32
v_mfma_f32_16x16x32_bf16 v[140:143], a[204:207], v[60:63], v[140:143]
v_exp_f32 v33, v33
v_mfma_f32_16x16x32_bf16 v[40:43], a[160:163], a[0:3], 0
s_waitcnt lgkmcnt(0)
v_fmamk_f32 v34, v34, 0x3e0293ee, v26
v_fmamk_f32 v35, v35, 0x3e0293ee, v26
v_mfma_f32_16x16x32_bf16 v[40:43], a[164:167], a[4:7], v[40:43]
v_exp_f32 v34, v34
v_mfma_f32_16x16x32_bf16 v[40:43], a[168:171], a[8:11], v[40:43]
v_exp_f32 v35, v35
v_mfma_f32_16x16x32_bf16 v[40:43], a[172:175], a[12:15], v[40:43]
v_cvt_pk_bf16_f32 v70, v32, v33
v_cvt_pk_bf16_f32 v71, v34, v35
v_mfma_f32_16x16x32_bf16 v[160:163], a[192:195], v[64:67], v[160:163]
buffer_load_dwordx4 v16, s[24:27], s31 offen nt lds
v_fmamk_f32 v36, v36, 0x3e0293ee, v27
v_mfma_f32_16x16x32_bf16 v[164:167], a[196:199], v[64:67], v[164:167]
v_exp_f32 v36, v36
v_mfma_f32_16x16x32_bf16 v[168:171], a[200:203], v[64:67], v[168:171]
ds_read_b64_tr_b16 a[208:209], v10 offset:16384
v_fmamk_f32 v37, v37, 0x3e0293ee, v27
v_mfma_f32_16x16x32_bf16 v[172:175], a[204:207], v[64:67], v[172:175]
v_exp_f32 v37, v37
v_mfma_f32_16x16x32_bf16 a[228:231], a[244:247], v[60:63], a[228:231]
ds_read_b64_tr_b16 a[210:211], v10 offset:20480
v_fmamk_f32 v38, v38, 0x3e0293ee, v27
v_mfma_f32_16x16x32_bf16 v[32:35], a[160:163], a[16:19], 0
v_exp_f32 v38, v38
v_mfma_f32_16x16x32_bf16 v[32:35], a[164:167], a[20:23], v[32:35]
ds_read_b64_tr_b16 a[212:213], v11 offset:16384
v_fmamk_f32 v39, v39, 0x3e0293ee, v27
v_mfma_f32_16x16x32_bf16 v[32:35], a[168:171], a[24:27], v[32:35]
v_exp_f32 v39, v39
v_mfma_f32_16x16x32_bf16 v[32:35], a[172:175], a[28:31], v[32:35]
ds_read_b64_tr_b16 a[214:215], v11 offset:20480
v_cvt_pk_bf16_f32 v74, v36, v37
v_mfma_f32_16x16x32_bf16 v[192:195], a[192:195], v[68:71], v[192:195]
ds_read_b64_tr_b16 a[216:217], v12 offset:16384
v_cvt_pk_bf16_f32 v75, v38, v39
v_mfma_f32_16x16x32_bf16 v[196:199], a[196:199], v[68:71], v[196:199]
ds_read_b64_tr_b16 a[218:219], v12 offset:20480
v_add_u32 v28, s38, v18
v_mfma_f32_16x16x32_bf16 v[200:203], a[200:203], v[68:71], v[200:203]
s_mov_b32 s38, s73
ds_read_b64_tr_b16 a[220:221], v13 offset:16384
v_fmamk_f32 v40, v40, 0x3e0293ee, v23
v_mfma_f32_16x16x32_bf16 v[204:207], a[204:207], v[68:71], v[204:207]
v_exp_f32 v40, v40
v_mfma_f32_16x16x32_bf16 v[36:39], a[160:163], a[32:35], 0
ds_read_b64_tr_b16 a[222:223], v13 offset:20480
v_fmamk_f32 v41, v41, 0x3e0293ee, v23
v_mfma_f32_16x16x32_bf16 v[36:39], a[164:167], a[36:39], v[36:39]
v_exp_f32 v41, v41
v_mfma_f32_16x16x32_bf16 v[36:39], a[168:171], a[40:43], v[36:39]
ds_read_b128 a[176:179], v2 offset:28672
v_fmamk_f32 v42, v42, 0x3e0293ee, v23
v_mfma_f32_16x16x32_bf16 v[36:39], a[172:175], a[44:47], v[36:39]
v_exp_f32 v42, v42
v_mfma_f32_16x16x32_bf16 v[224:227], a[192:195], v[72:75], v[224:227]
ds_read_b128 a[180:183], v3 offset:28672
v_fmamk_f32 v43, v43, 0x3e0293ee, v23
v_mfma_f32_16x16x32_bf16 v[228:231], a[196:199], v[72:75], v[228:231]
v_exp_f32 v43, v43
v_mfma_f32_16x16x32_bf16 v[232:235], a[200:203], v[72:75], v[232:235]
ds_read_b128 a[184:187], v4 offset:28672
v_cvt_pk_bf16_f32 v76, v40, v41
v_mfma_f32_16x16x32_bf16 v[236:239], a[204:207], v[72:75], v[236:239]
ds_read_b128 a[188:191], v5 offset:28672
v_cvt_pk_bf16_f32 v77, v42, v43
v_mfma_f32_16x16x32_bf16 a[232:235], a[244:247], v[64:67], a[232:235]
buffer_load_dwordx4 v17, s[24:27], s31 offen offset:1024 nt lds
buffer_load_dwordx4 a[128:131], v28, s[8:11], 0 offen offset:0
v_mfma_f32_16x16x32_bf16 v[40:43], a[160:163], a[48:51], 0
s_add_u32 m0, s32, 8192
v_fmamk_f32 v32, v32, 0x3e0293ee, v24
v_fmamk_f32 v33, v33, 0x3e0293ee, v24
v_mfma_f32_16x16x32_bf16 v[40:43], a[164:167], a[52:55], v[40:43]
s_add_u32 s31, s29, 8192
v_exp_f32 v32, v32
v_mfma_f32_16x16x32_bf16 v[40:43], a[168:171], a[56:59], v[40:43]
v_exp_f32 v33, v33
v_mfma_f32_16x16x32_bf16 v[40:43], a[172:175], a[60:63], v[40:43]
s_waitcnt lgkmcnt(2)
v_fmamk_f32 v34, v34, 0x3e0293ee, v24
v_fmamk_f32 v35, v35, 0x3e0293ee, v24
v_mfma_f32_16x16x32_bf16 v[112:115], a[208:211], v[56:59], v[112:115]
v_exp_f32 v34, v34
v_mfma_f32_16x16x32_bf16 v[116:119], a[212:215], v[56:59], v[116:119]
v_exp_f32 v35, v35
v_mfma_f32_16x16x32_bf16 v[120:123], a[216:219], v[56:59], v[120:123]
buffer_load_dwordx4 a[132:135], v28, s[8:11], 0 offen offset:64
v_cvt_pk_bf16_f32 v48, v32, v33
v_mfma_f32_16x16x32_bf16 v[124:127], a[220:223], v[56:59], v[124:127]
v_cvt_pk_bf16_f32 v49, v34, v35
v_fmamk_f32 v36, v36, 0x3e0293ee, v25
v_mfma_f32_16x16x32_bf16 v[32:35], a[160:163], a[64:67], 0
v_exp_f32 v36, v36
v_mfma_f32_16x16x32_bf16 v[32:35], a[164:167], a[68:71], v[32:35]
v_fmamk_f32 v37, v37, 0x3e0293ee, v25
v_fmamk_f32 v38, v38, 0x3e0293ee, v25
v_mfma_f32_16x16x32_bf16 v[32:35], a[168:171], a[72:75], v[32:35]
v_exp_f32 v37, v37
v_mfma_f32_16x16x32_bf16 v[32:35], a[172:175], a[76:79], v[32:35]
v_exp_f32 v38, v38
v_mfma_f32_16x16x32_bf16 v[144:147], a[208:211], v[60:63], v[144:147]
v_fmamk_f32 v39, v39, 0x3e0293ee, v25
v_cvt_pk_bf16_f32 v52, v36, v37
v_mfma_f32_16x16x32_bf16 v[148:151], a[212:215], v[60:63], v[148:151]
v_exp_f32 v39, v39
v_mfma_f32_16x16x32_bf16 v[152:155], a[216:219], v[60:63], v[152:155]
v_cvt_pk_bf16_f32 v53, v38, v39
v_fmamk_f32 v40, v40, 0x3e0293ee, v26
v_mfma_f32_16x16x32_bf16 v[156:159], a[220:223], v[60:63], v[156:159]
v_exp_f32 v40, v40
v_mfma_f32_16x16x32_bf16 a[236:239], a[244:247], v[68:71], a[236:239]
s_waitcnt vmcnt(18) lgkmcnt(0)
v_fmamk_f32 v41, v41, 0x3e0293ee, v26
v_fmamk_f32 v42, v42, 0x3e0293ee, v26
v_mfma_f32_16x16x32_bf16 v[36:39], a[176:179], a[0:3], 0
s_barrier
v_exp_f32 v41, v41
v_mfma_f32_16x16x32_bf16 v[36:39], a[180:183], a[4:7], v[36:39]
v_exp_f32 v42, v42
v_mfma_f32_16x16x32_bf16 v[36:39], a[184:187], a[8:11], v[36:39]
v_fmamk_f32 v43, v43, 0x3e0293ee, v26
v_cvt_pk_bf16_f32 v56, v40, v41
v_mfma_f32_16x16x32_bf16 v[36:39], a[188:191], a[12:15], v[36:39]
v_exp_f32 v43, v43
v_mfma_f32_16x16x32_bf16 v[176:179], a[208:211], v[64:67], v[176:179]
buffer_load_dwordx4 v14, s[20:23], s30 offen nt lds
v_cvt_pk_bf16_f32 v57, v42, v43
v_mfma_f32_16x16x32_bf16 v[180:183], a[212:215], v[64:67], v[180:183]
ds_read_b64_tr_b16 a[192:193], v6 offset:24576
v_fmamk_f32 v32, v32, 0x3e0293ee, v27
v_mfma_f32_16x16x32_bf16 v[184:187], a[216:219], v[64:67], v[184:187]
v_exp_f32 v32, v32
v_mfma_f32_16x16x32_bf16 v[188:191], a[220:223], v[64:67], v[188:191]
ds_read_b64_tr_b16 a[194:195], v6 offset:28672
v_fmamk_f32 v33, v33, 0x3e0293ee, v27
v_mfma_f32_16x16x32_bf16 v[40:43], a[176:179], a[16:19], 0
v_exp_f32 v33, v33
v_mfma_f32_16x16x32_bf16 v[40:43], a[180:183], a[20:23], v[40:43]
ds_read_b64_tr_b16 a[196:197], v7 offset:24576
v_fmamk_f32 v34, v34, 0x3e0293ee, v27
v_mfma_f32_16x16x32_bf16 v[40:43], a[184:187], a[24:27], v[40:43]
v_exp_f32 v34, v34
v_mfma_f32_16x16x32_bf16 v[40:43], a[188:191], a[28:31], v[40:43]
ds_read_b64_tr_b16 a[198:199], v7 offset:28672
v_fmamk_f32 v35, v35, 0x3e0293ee, v27
v_mfma_f32_16x16x32_bf16 v[208:211], a[208:211], v[68:71], v[208:211]
v_exp_f32 v35, v35
v_mfma_f32_16x16x32_bf16 v[212:215], a[212:215], v[68:71], v[212:215]
ds_read_b64_tr_b16 a[200:201], v8 offset:24576
v_cvt_pk_bf16_f32 v60, v32, v33
v_mfma_f32_16x16x32_bf16 v[216:219], a[216:219], v[68:71], v[216:219]
ds_read_b64_tr_b16 a[202:203], v8 offset:28672
v_cvt_pk_bf16_f32 v61, v34, v35
v_mfma_f32_16x16x32_bf16 v[220:223], a[220:223], v[68:71], v[220:223]
ds_read_b64_tr_b16 a[204:205], v9 offset:24576
v_fmamk_f32 v36, v36, 0x3e0293ee, v23
v_mfma_f32_16x16x32_bf16 a[240:243], a[244:247], v[72:75], a[240:243]
v_exp_f32 v36, v36
v_mfma_f32_16x16x32_bf16 v[32:35], a[176:179], a[32:35], 0
ds_read_b64_tr_b16 a[206:207], v9 offset:28672
v_fmamk_f32 v37, v37, 0x3e0293ee, v23
v_mfma_f32_16x16x32_bf16 v[32:35], a[180:183], a[36:39], v[32:35]
v_exp_f32 v37, v37
v_mfma_f32_16x16x32_bf16 v[32:35], a[184:187], a[40:43], v[32:35]
ds_read_b128 a[160:163], v2 offset:32768
v_fmamk_f32 v38, v38, 0x3e0293ee, v23
v_mfma_f32_16x16x32_bf16 v[32:35], a[188:191], a[44:47], v[32:35]
v_exp_f32 v38, v38
v_mfma_f32_16x16x32_bf16 v[240:243], a[208:211], v[72:75], v[240:243]
ds_read_b128 a[164:167], v3 offset:32768
v_fmamk_f32 v39, v39, 0x3e0293ee, v23
v_mfma_f32_16x16x32_bf16 v[244:247], a[212:215], v[72:75], v[244:247]
v_exp_f32 v39, v39
v_mfma_f32_16x16x32_bf16 v[248:251], a[216:219], v[72:75], v[248:251]
ds_read_b128 a[168:171], v4 offset:32768
v_cvt_pk_bf16_f32 v78, v36, v37
v_mfma_f32_16x16x32_bf16 v[252:255], a[220:223], v[72:75], v[252:255]
v_cvt_pk_bf16_f32 v79, v38, v39
v_fmamk_f32 v40, v40, 0x3e0293ee, v24
v_mfma_f32_16x16x32_bf16 v[36:39], a[176:179], a[48:51], 0
v_exp_f32 v40, v40
v_mfma_f32_16x16x32_bf16 v[36:39], a[180:183], a[52:55], v[36:39]
s_waitcnt lgkmcnt(2)
buffer_load_dwordx4 v15, s[20:23], s30 offen offset:1024 nt lds
v_fmamk_f32 v41, v41, 0x3e0293ee, v24
v_mfma_f32_16x16x32_bf16 v[36:39], a[184:187], a[56:59], v[36:39]
s_add_u32 m0, s32, 73728
v_exp_f32 v41, v41
v_mfma_f32_16x16x32_bf16 v[36:39], a[188:191], a[60:63], v[36:39]
s_add_u32 s30, s29, 16384
ds_read_b128 a[172:175], v5 offset:32768
v_fmamk_f32 v42, v42, 0x3e0293ee, v24
v_mfma_f32_16x16x32_bf16 v[96:99], a[192:195], v[76:79], v[96:99]
v_exp_f32 v42, v42
v_mfma_f32_16x16x32_bf16 v[100:103], a[196:199], v[76:79], v[100:103]
v_fmamk_f32 v43, v43, 0x3e0293ee, v24
v_cvt_pk_bf16_f32 v50, v40, v41
v_mfma_f32_16x16x32_bf16 v[104:107], a[200:203], v[76:79], v[104:107]
v_exp_f32 v43, v43
v_mfma_f32_16x16x32_bf16 v[108:111], a[204:207], v[76:79], v[108:111]
v_cvt_pk_bf16_f32 v51, v42, v43
v_fmamk_f32 v32, v32, 0x3e0293ee, v25
v_mfma_f32_16x16x32_bf16 a[224:227], a[244:247], v[76:79], a[224:227]
v_exp_f32 v32, v32
v_mfma_f32_16x16x32_bf16 v[40:43], a[176:179], a[64:67], 0
v_fmamk_f32 v33, v33, 0x3e0293ee, v25
v_fmamk_f32 v34, v34, 0x3e0293ee, v25
v_mfma_f32_16x16x32_bf16 v[40:43], a[180:183], a[68:71], v[40:43]
v_exp_f32 v33, v33
v_mfma_f32_16x16x32_bf16 v[40:43], a[184:187], a[72:75], v[40:43]
v_exp_f32 v34, v34
v_mfma_f32_16x16x32_bf16 v[40:43], a[188:191], a[76:79], v[40:43]
v_fmamk_f32 v35, v35, 0x3e0293ee, v25
v_cvt_pk_bf16_f32 v54, v32, v33
v_mfma_f32_16x16x32_bf16 v[128:131], a[192:195], v[48:51], v[128:131]
v_exp_f32 v35, v35
v_mfma_f32_16x16x32_bf16 v[132:135], a[196:199], v[48:51], v[132:135]
v_cvt_pk_bf16_f32 v55, v34, v35
v_fmamk_f32 v36, v36, 0x3e0293ee, v26
v_mfma_f32_16x16x32_bf16 v[136:139], a[200:203], v[48:51], v[136:139]
v_exp_f32 v36, v36
v_mfma_f32_16x16x32_bf16 v[140:143], a[204:207], v[48:51], v[140:143]
v_fmamk_f32 v37, v37, 0x3e0293ee, v26
v_fmamk_f32 v38, v38, 0x3e0293ee, v26
v_mfma_f32_16x16x32_bf16 v[32:35], a[160:163], a[0:3], 0
s_waitcnt lgkmcnt(0)
v_exp_f32 v37, v37
v_mfma_f32_16x16x32_bf16 v[32:35], a[164:167], a[4:7], v[32:35]
v_exp_f32 v38, v38
v_mfma_f32_16x16x32_bf16 v[32:35], a[168:171], a[8:11], v[32:35]
v_fmamk_f32 v39, v39, 0x3e0293ee, v26
v_cvt_pk_bf16_f32 v58, v36, v37
v_mfma_f32_16x16x32_bf16 v[32:35], a[172:175], a[12:15], v[32:35]
v_exp_f32 v39, v39
v_mfma_f32_16x16x32_bf16 v[160:163], a[192:195], v[52:55], v[160:163]
buffer_load_dwordx4 v16, s[24:27], s31 offen nt lds
v_cvt_pk_bf16_f32 v59, v38, v39
v_mfma_f32_16x16x32_bf16 v[164:167], a[196:199], v[52:55], v[164:167]
ds_read_b64_tr_b16 a[208:209], v10 offset:24576
v_fmamk_f32 v40, v40, 0x3e0293ee, v27
v_mfma_f32_16x16x32_bf16 v[168:171], a[200:203], v[52:55], v[168:171]
v_exp_f32 v40, v40
v_mfma_f32_16x16x32_bf16 v[172:175], a[204:207], v[52:55], v[172:175]
ds_read_b64_tr_b16 a[210:211], v10 offset:28672
v_fmamk_f32 v41, v41, 0x3e0293ee, v27
v_mfma_f32_16x16x32_bf16 a[228:231], a[244:247], v[48:51], a[228:231]
v_exp_f32 v41, v41
v_mfma_f32_16x16x32_bf16 v[36:39], a[160:163], a[16:19], 0
ds_read_b64_tr_b16 a[212:213], v11 offset:24576
v_fmamk_f32 v42, v42, 0x3e0293ee, v27
v_mfma_f32_16x16x32_bf16 v[36:39], a[164:167], a[20:23], v[36:39]
v_exp_f32 v42, v42
v_mfma_f32_16x16x32_bf16 v[36:39], a[168:171], a[24:27], v[36:39]
ds_read_b64_tr_b16 a[214:215], v11 offset:28672
v_fmamk_f32 v43, v43, 0x3e0293ee, v27
v_mfma_f32_16x16x32_bf16 v[36:39], a[172:175], a[28:31], v[36:39]
L_pad0_5:
s_cbranch_execz L_pad0_9
v_exp_f32 v43, v43
v_mfma_f32_16x16x32_bf16 v[192:195], a[192:195], v[56:59], v[192:195]
ds_read_b64_tr_b16 a[216:217], v12 offset:24576
v_cvt_pk_bf16_f32 v62, v40, v41
v_mfma_f32_16x16x32_bf16 v[196:199], a[196:199], v[56:59], v[196:199]
ds_read_b64_tr_b16 a[218:219], v12 offset:28672
v_cvt_pk_bf16_f32 v63, v42, v43
v_mfma_f32_16x16x32_bf16 v[200:203], a[200:203], v[56:59], v[200:203]
ds_read_b64_tr_b16 a[220:221], v13 offset:24576
v_fmamk_f32 v32, v32, 0x3e0293ee, v23
v_mfma_f32_16x16x32_bf16 v[204:207], a[204:207], v[56:59], v[204:207]
v_exp_f32 v32, v32
v_mfma_f32_16x16x32_bf16 v[40:43], a[160:163], a[32:35], 0
ds_read_b64_tr_b16 a[222:223], v13 offset:28672
v_fmamk_f32 v33, v33, 0x3e0293ee, v23
v_mfma_f32_16x16x32_bf16 v[40:43], a[164:167], a[36:39], v[40:43]
v_exp_f32 v33, v33
v_mfma_f32_16x16x32_bf16 v[40:43], a[168:171], a[40:43], v[40:43]
ds_read_b128 a[176:179], v2 offset:36864
v_fmamk_f32 v34, v34, 0x3e0293ee, v23
v_mfma_f32_16x16x32_bf16 v[40:43], a[172:175], a[44:47], v[40:43]
v_exp_f32 v34, v34
v_mfma_f32_16x16x32_bf16 v[224:227], a[192:195], v[60:63], v[224:227]
ds_read_b128 a[180:183], v3 offset:36864
v_fmamk_f32 v35, v35, 0x3e0293ee, v23
v_mfma_f32_16x16x32_bf16 v[228:231], a[196:199], v[60:63], v[228:231]
v_exp_f32 v35, v35
v_mfma_f32_16x16x32_bf16 v[232:235], a[200:203], v[60:63], v[232:235]
ds_read_b128 a[184:187], v4 offset:36864
v_cvt_pk_bf16_f32 v64, v32, v33
v_mfma_f32_16x16x32_bf16 v[236:239], a[204:207], v[60:63], v[236:239]
ds_read_b128 a[188:191], v5 offset:36864
v_cvt_pk_bf16_f32 v65, v34, v35
v_mfma_f32_16x16x32_bf16 a[232:235], a[244:247], v[52:55], a[232:235]
buffer_load_dwordx4 v17, s[24:27], s31 offen offset:1024 nt lds
buffer_load_dwordx4 a[136:139], v28, s[8:11], 0 offen offset:128
v_mfma_f32_16x16x32_bf16 v[32:35], a[160:163], a[48:51], 0
s_add_u32 m0, s32, 16384
v_fmamk_f32 v36, v36, 0x3e0293ee, v24
v_fmamk_f32 v37, v37, 0x3e0293ee, v24
v_mfma_f32_16x16x32_bf16 v[32:35], a[164:167], a[52:55], v[32:35]
s_add_u32 s31, s29, 16384
v_exp_f32 v36, v36
v_mfma_f32_16x16x32_bf16 v[32:35], a[168:171], a[56:59], v[32:35]
v_exp_f32 v37, v37
v_mfma_f32_16x16x32_bf16 v[32:35], a[172:175], a[60:63], v[32:35]
s_waitcnt lgkmcnt(2)
v_fmamk_f32 v38, v38, 0x3e0293ee, v24
v_fmamk_f32 v39, v39, 0x3e0293ee, v24
v_mfma_f32_16x16x32_bf16 v[112:115], a[208:211], v[76:79], v[112:115]
v_exp_f32 v38, v38
v_mfma_f32_16x16x32_bf16 v[116:119], a[212:215], v[76:79], v[116:119]
v_exp_f32 v39, v39
v_mfma_f32_16x16x32_bf16 v[120:123], a[216:219], v[76:79], v[120:123]
v_cvt_pk_bf16_f32 v68, v36, v37
v_cvt_pk_bf16_f32 v69, v38, v39
v_mfma_f32_16x16x32_bf16 v[124:127], a[220:223], v[76:79], v[124:127]
v_fmamk_f32 v40, v40, 0x3e0293ee, v25
v_fmamk_f32 v41, v41, 0x3e0293ee, v25
v_mfma_f32_16x16x32_bf16 v[36:39], a[160:163], a[64:67], 0
v_exp_f32 v40, v40
v_mfma_f32_16x16x32_bf16 v[36:39], a[164:167], a[68:71], v[36:39]
v_exp_f32 v41, v41
v_mfma_f32_16x16x32_bf16 v[36:39], a[168:171], a[72:75], v[36:39]
v_fmamk_f32 v42, v42, 0x3e0293ee, v25
v_fmamk_f32 v43, v43, 0x3e0293ee, v25
v_mfma_f32_16x16x32_bf16 v[36:39], a[172:175], a[76:79], v[36:39]
v_exp_f32 v42, v42
v_mfma_f32_16x16x32_bf16 v[144:147], a[208:211], v[48:51], v[144:147]
v_exp_f32 v43, v43
v_mfma_f32_16x16x32_bf16 v[148:151], a[212:215], v[48:51], v[148:151]
v_cvt_pk_bf16_f32 v72, v40, v41
v_cvt_pk_bf16_f32 v73, v42, v43
v_mfma_f32_16x16x32_bf16 v[152:155], a[216:219], v[48:51], v[152:155]
v_fmamk_f32 v32, v32, 0x3e0293ee, v26
v_fmamk_f32 v33, v33, 0x3e0293ee, v26
v_mfma_f32_16x16x32_bf16 v[156:159], a[220:223], v[48:51], v[156:159]
v_exp_f32 v32, v32
v_mfma_f32_16x16x32_bf16 a[236:239], a[244:247], v[56:59], a[236:239]
v_exp_f32 v33, v33
v_mfma_f32_16x16x32_bf16 v[40:43], a[176:179], a[0:3], 0
v_fmamk_f32 v34, v34, 0x3e0293ee, v26
v_fmamk_f32 v35, v35, 0x3e0293ee, v26
v_mfma_f32_16x16x32_bf16 v[40:43], a[180:183], a[4:7], v[40:43]
s_waitcnt lgkmcnt(0)
v_exp_f32 v34, v34
v_mfma_f32_16x16x32_bf16 v[40:43], a[184:187], a[8:11], v[40:43]
v_exp_f32 v35, v35
v_mfma_f32_16x16x32_bf16 v[40:43], a[188:191], a[12:15], v[40:43]
v_cvt_pk_bf16_f32 v76, v32, v33
v_cvt_pk_bf16_f32 v77, v34, v35
v_mfma_f32_16x16x32_bf16 v[176:179], a[208:211], v[52:55], v[176:179]
buffer_load_dwordx4 v14, s[20:23], s30 offen nt lds
v_fmamk_f32 v36, v36, 0x3e0293ee, v27
v_mfma_f32_16x16x32_bf16 v[180:183], a[212:215], v[52:55], v[180:183]
v_exp_f32 v36, v36
v_mfma_f32_16x16x32_bf16 v[184:187], a[216:219], v[52:55], v[184:187]
ds_read_b64_tr_b16 a[192:193], v6 offset:32768
v_fmamk_f32 v37, v37, 0x3e0293ee, v27
v_mfma_f32_16x16x32_bf16 v[188:191], a[220:223], v[52:55], v[188:191]
v_exp_f32 v37, v37
v_mfma_f32_16x16x32_bf16 v[32:35], a[176:179], a[16:19], 0
ds_read_b64_tr_b16 a[194:195], v6 offset:36864
v_fmamk_f32 v38, v38, 0x3e0293ee, v27
v_mfma_f32_16x16x32_bf16 v[32:35], a[180:183], a[20:23], v[32:35]
v_exp_f32 v38, v38
v_mfma_f32_16x16x32_bf16 v[32:35], a[184:187], a[24:27], v[32:35]
ds_read_b64_tr_b16 a[196:197], v7 offset:32768
v_fmamk_f32 v39, v39, 0x3e0293ee, v27
v_mfma_f32_16x16x32_bf16 v[32:35], a[188:191], a[28:31], v[32:35]
v_exp_f32 v39, v39
v_mfma_f32_16x16x32_bf16 v[208:211], a[208:211], v[56:59], v[208:211]
ds_read_b64_tr_b16 a[198:199], v7 offset:36864
v_cvt_pk_bf16_f32 v48, v36, v37
v_mfma_f32_16x16x32_bf16 v[212:215], a[212:215], v[56:59], v[212:215]
ds_read_b64_tr_b16 a[200:201], v8 offset:32768
v_cvt_pk_bf16_f32 v49, v38, v39
v_mfma_f32_16x16x32_bf16 v[216:219], a[216:219], v[56:59], v[216:219]
ds_read_b64_tr_b16 a[202:203], v8 offset:36864
v_fmamk_f32 v40, v40, 0x3e0293ee, v23
v_mfma_f32_16x16x32_bf16 v[220:223], a[220:223], v[56:59], v[220:223]
v_exp_f32 v40, v40
v_mfma_f32_16x16x32_bf16 a[240:243], a[244:247], v[60:63], a[240:243]
ds_read_b64_tr_b16 a[204:205], v9 offset:32768
v_fmamk_f32 v41, v41, 0x3e0293ee, v23
v_mfma_f32_16x16x32_bf16 v[36:39], a[176:179], a[32:35], 0
v_exp_f32 v41, v41
v_mfma_f32_16x16x32_bf16 v[36:39], a[180:183], a[36:39], v[36:39]
ds_read_b64_tr_b16 a[206:207], v9 offset:36864
v_fmamk_f32 v42, v42, 0x3e0293ee, v23
v_mfma_f32_16x16x32_bf16 v[36:39], a[184:187], a[40:43], v[36:39]
v_exp_f32 v42, v42
v_mfma_f32_16x16x32_bf16 v[36:39], a[188:191], a[44:47], v[36:39]
ds_read_b128 a[160:163], v2 offset:40960
v_fmamk_f32 v43, v43, 0x3e0293ee, v23
v_mfma_f32_16x16x32_bf16 v[240:243], a[208:211], v[60:63], v[240:243]
v_exp_f32 v43, v43
v_mfma_f32_16x16x32_bf16 v[244:247], a[212:215], v[60:63], v[244:247]
ds_read_b128 a[164:167], v3 offset:40960
v_cvt_pk_bf16_f32 v66, v40, v41
v_mfma_f32_16x16x32_bf16 v[248:251], a[216:219], v[60:63], v[248:251]
ds_read_b128 a[168:171], v4 offset:40960
v_cvt_pk_bf16_f32 v67, v42, v43
v_mfma_f32_16x16x32_bf16 v[252:255], a[220:223], v[60:63], v[252:255]
ds_read_b128 a[172:175], v5 offset:40960
v_fmamk_f32 v32, v32, 0x3e0293ee, v24
v_mfma_f32_16x16x32_bf16 v[40:43], a[176:179], a[48:51], 0
v_exp_f32 v32, v32
v_mfma_f32_16x16x32_bf16 v[40:43], a[180:183], a[52:55], v[40:43]
s_waitcnt lgkmcnt(3)
buffer_load_dwordx4 v15, s[20:23], s30 offen offset:1024 nt lds
v_fmamk_f32 v33, v33, 0x3e0293ee, v24
v_mfma_f32_16x16x32_bf16 v[40:43], a[184:187], a[56:59], v[40:43]
s_add_u32 m0, s32, 81920
v_exp_f32 v33, v33
v_mfma_f32_16x16x32_bf16 v[40:43], a[188:191], a[60:63], v[40:43]
s_add_u32 s30, s29, 24576
v_fmamk_f32 v34, v34, 0x3e0293ee, v24
v_fmamk_f32 v35, v35, 0x3e0293ee, v24
v_mfma_f32_16x16x32_bf16 v[96:99], a[192:195], v[64:67], v[96:99]
v_exp_f32 v34, v34
v_mfma_f32_16x16x32_bf16 v[100:103], a[196:199], v[64:67], v[100:103]
v_exp_f32 v35, v35
v_mfma_f32_16x16x32_bf16 v[104:107], a[200:203], v[64:67], v[104:107]
v_cvt_pk_bf16_f32 v70, v32, v33
v_cvt_pk_bf16_f32 v71, v34, v35
v_mfma_f32_16x16x32_bf16 v[108:111], a[204:207], v[64:67], v[108:111]
v_fmamk_f32 v36, v36, 0x3e0293ee, v25
v_fmamk_f32 v37, v37, 0x3e0293ee, v25
v_mfma_f32_16x16x32_bf16 a[224:227], a[244:247], v[64:67], a[224:227]
v_exp_f32 v36, v36
v_mfma_f32_16x16x32_bf16 v[32:35], a[176:179], a[64:67], 0
v_exp_f32 v37, v37
v_mfma_f32_16x16x32_bf16 v[32:35], a[180:183], a[68:71], v[32:35]
v_fmamk_f32 v38, v38, 0x3e0293ee, v25
v_fmamk_f32 v39, v39, 0x3e0293ee, v25
v_mfma_f32_16x16x32_bf16 v[32:35], a[184:187], a[72:75], v[32:35]
v_exp_f32 v38, v38
v_mfma_f32_16x16x32_bf16 v[32:35], a[188:191], a[76:79], v[32:35]
v_exp_f32 v39, v39
v_mfma_f32_16x16x32_bf16 v[128:131], a[192:195], v[68:71], v[128:131]
v_cvt_pk_bf16_f32 v74, v36, v37
v_cvt_pk_bf16_f32 v75, v38, v39
v_mfma_f32_16x16x32_bf16 v[132:135], a[196:199], v[68:71], v[132:135]
v_fmamk_f32 v40, v40, 0x3e0293ee, v26
v_fmamk_f32 v41, v41, 0x3e0293ee, v26
v_mfma_f32_16x16x32_bf16 v[136:139], a[200:203], v[68:71], v[136:139]
v_exp_f32 v40, v40
v_mfma_f32_16x16x32_bf16 v[140:143], a[204:207], v[68:71], v[140:143]
v_exp_f32 v41, v41
v_mfma_f32_16x16x32_bf16 v[36:39], a[160:163], a[0:3], 0
s_waitcnt lgkmcnt(0)
v_fmamk_f32 v42, v42, 0x3e0293ee, v26
v_fmamk_f32 v43, v43, 0x3e0293ee, v26
v_mfma_f32_16x16x32_bf16 v[36:39], a[164:167], a[4:7], v[36:39]
v_exp_f32 v42, v42
v_mfma_f32_16x16x32_bf16 v[36:39], a[168:171], a[8:11], v[36:39]
v_exp_f32 v43, v43
v_mfma_f32_16x16x32_bf16 v[36:39], a[172:175], a[12:15], v[36:39]
v_cvt_pk_bf16_f32 v78, v40, v41
v_cvt_pk_bf16_f32 v79, v42, v43
v_mfma_f32_16x16x32_bf16 v[160:163], a[192:195], v[72:75], v[160:163]
buffer_load_dwordx4 v16, s[24:27], s31 offen nt lds
v_fmamk_f32 v32, v32, 0x3e0293ee, v27
v_mfma_f32_16x16x32_bf16 v[164:167], a[196:199], v[72:75], v[164:167]
v_exp_f32 v32, v32
v_mfma_f32_16x16x32_bf16 v[168:171], a[200:203], v[72:75], v[168:171]
ds_read_b64_tr_b16 a[208:209], v10 offset:32768
v_fmamk_f32 v33, v33, 0x3e0293ee, v27
v_mfma_f32_16x16x32_bf16 v[172:175], a[204:207], v[72:75], v[172:175]
v_exp_f32 v33, v33
v_mfma_f32_16x16x32_bf16 a[228:231], a[244:247], v[68:71], a[228:231]
ds_read_b64_tr_b16 a[210:211], v10 offset:36864
v_fmamk_f32 v34, v34, 0x3e0293ee, v27
v_mfma_f32_16x16x32_bf16 v[40:43], a[160:163], a[16:19], 0
v_exp_f32 v34, v34
v_mfma_f32_16x16x32_bf16 v[40:43], a[164:167], a[20:23], v[40:43]
ds_read_b64_tr_b16 a[212:213], v11 offset:32768
v_fmamk_f32 v35, v35, 0x3e0293ee, v27
v_mfma_f32_16x16x32_bf16 v[40:43], a[168:171], a[24:27], v[40:43]
v_exp_f32 v35, v35
v_mfma_f32_16x16x32_bf16 v[40:43], a[172:175], a[28:31], v[40:43]
ds_read_b64_tr_b16 a[214:215], v11 offset:36864
v_cvt_pk_bf16_f32 v50, v32, v33
v_mfma_f32_16x16x32_bf16 v[192:195], a[192:195], v[76:79], v[192:195]
ds_read_b64_tr_b16 a[216:217], v12 offset:32768
v_cvt_pk_bf16_f32 v51, v34, v35
v_mfma_f32_16x16x32_bf16 v[196:199], a[196:199], v[76:79], v[196:199]
ds_read_b64_tr_b16 a[218:219], v12 offset:36864
v_fmamk_f32 v36, v36, 0x3e0293ee, v23
v_mfma_f32_16x16x32_bf16 v[200:203], a[200:203], v[76:79], v[200:203]
v_exp_f32 v36, v36
v_mfma_f32_16x16x32_bf16 v[204:207], a[204:207], v[76:79], v[204:207]
ds_read_b64_tr_b16 a[220:221], v13 offset:32768
v_fmamk_f32 v37, v37, 0x3e0293ee, v23
v_mfma_f32_16x16x32_bf16 v[32:35], a[160:163], a[32:35], 0
v_exp_f32 v37, v37
v_mfma_f32_16x16x32_bf16 v[32:35], a[164:167], a[36:39], v[32:35]
ds_read_b64_tr_b16 a[222:223], v13 offset:36864
v_fmamk_f32 v38, v38, 0x3e0293ee, v23
v_mfma_f32_16x16x32_bf16 v[32:35], a[168:171], a[40:43], v[32:35]
v_exp_f32 v38, v38
v_mfma_f32_16x16x32_bf16 v[32:35], a[172:175], a[44:47], v[32:35]
ds_read_b128 a[176:179], v2 offset:45056
v_fmamk_f32 v39, v39, 0x3e0293ee, v23
v_mfma_f32_16x16x32_bf16 v[224:227], a[192:195], v[48:51], v[224:227]
v_exp_f32 v39, v39
v_mfma_f32_16x16x32_bf16 v[228:231], a[196:199], v[48:51], v[228:231]
ds_read_b128 a[180:183], v3 offset:45056
v_cvt_pk_bf16_f32 v52, v36, v37
v_mfma_f32_16x16x32_bf16 v[232:235], a[200:203], v[48:51], v[232:235]
ds_read_b128 a[184:187], v4 offset:45056
v_cvt_pk_bf16_f32 v53, v38, v39
v_mfma_f32_16x16x32_bf16 v[236:239], a[204:207], v[48:51], v[236:239]
ds_read_b128 a[188:191], v5 offset:45056
v_fmamk_f32 v40, v40, 0x3e0293ee, v24
v_mfma_f32_16x16x32_bf16 a[232:235], a[244:247], v[72:75], a[232:235]
buffer_load_dwordx4 v17, s[24:27], s31 offen offset:1024 nt lds
buffer_load_dwordx4 a[140:143], v28, s[8:11], 0 offen offset:192
v_mfma_f32_16x16x32_bf16 v[36:39], a[160:163], a[48:51], 0
s_add_u32 m0, s32, 24576
v_exp_f32 v40, v40
v_mfma_f32_16x16x32_bf16 v[36:39], a[164:167], a[52:55], v[36:39]
s_add_u32 s31, s29, 24576
v_fmamk_f32 v41, v41, 0x3e0293ee, v24
v_fmamk_f32 v42, v42, 0x3e0293ee, v24
v_mfma_f32_16x16x32_bf16 v[36:39], a[168:171], a[56:59], v[36:39]
v_exp_f32 v41, v41
v_mfma_f32_16x16x32_bf16 v[36:39], a[172:175], a[60:63], v[36:39]
s_waitcnt lgkmcnt(3)
v_exp_f32 v42, v42
v_mfma_f32_16x16x32_bf16 v[112:115], a[208:211], v[64:67], v[112:115]
v_fmamk_f32 v43, v43, 0x3e0293ee, v24
v_cvt_pk_bf16_f32 v56, v40, v41
v_mfma_f32_16x16x32_bf16 v[116:119], a[212:215], v[64:67], v[116:119]
v_exp_f32 v43, v43
v_mfma_f32_16x16x32_bf16 v[120:123], a[216:219], v[64:67], v[120:123]
v_cvt_pk_bf16_f32 v57, v42, v43
v_add_u32 v28, s38, v18
v_mfma_f32_16x16x32_bf16 v[124:127], a[220:223], v[64:67], v[124:127]
s_add_u32 s38, s63, 0
buffer_load_dwordx4 a[144:147], v28, s[8:11], 0 offen offset:0
v_fmamk_f32 v32, v32, 0x3e0293ee, v25
v_mfma_f32_16x16x32_bf16 v[40:43], a[160:163], a[64:67], 0
v_exp_f32 v32, v32
v_mfma_f32_16x16x32_bf16 v[40:43], a[164:167], a[68:71], v[40:43]
v_fmamk_f32 v33, v33, 0x3e0293ee, v25
v_fmamk_f32 v34, v34, 0x3e0293ee, v25
v_mfma_f32_16x16x32_bf16 v[40:43], a[168:171], a[72:75], v[40:43]
v_exp_f32 v33, v33
v_mfma_f32_16x16x32_bf16 v[40:43], a[172:175], a[76:79], v[40:43]
v_exp_f32 v34, v34
v_mfma_f32_16x16x32_bf16 v[144:147], a[208:211], v[68:71], v[144:147]
v_fmamk_f32 v35, v35, 0x3e0293ee, v25
v_cvt_pk_bf16_f32 v60, v32, v33
v_mfma_f32_16x16x32_bf16 v[148:151], a[212:215], v[68:71], v[148:151]
v_exp_f32 v35, v35
v_mfma_f32_16x16x32_bf16 v[152:155], a[216:219], v[68:71], v[152:155]
v_cvt_pk_bf16_f32 v61, v34, v35
v_fmamk_f32 v36, v36, 0x3e0293ee, v26
v_mfma_f32_16x16x32_bf16 v[156:159], a[220:223], v[68:71], v[156:159]
v_exp_f32 v36, v36
v_mfma_f32_16x16x32_bf16 a[236:239], a[244:247], v[76:79], a[236:239]
s_waitcnt vmcnt(18) lgkmcnt(0)
v_fmamk_f32 v37, v37, 0x3e0293ee, v26
v_fmamk_f32 v38, v38, 0x3e0293ee, v26
v_mfma_f32_16x16x32_bf16 v[32:35], a[176:179], a[0:3], 0
s_barrier
v_exp_f32 v37, v37
v_mfma_f32_16x16x32_bf16 v[32:35], a[180:183], a[4:7], v[32:35]
v_exp_f32 v38, v38
v_mfma_f32_16x16x32_bf16 v[32:35], a[184:187], a[8:11], v[32:35]
v_fmamk_f32 v39, v39, 0x3e0293ee, v26
v_cvt_pk_bf16_f32 v64, v36, v37
v_mfma_f32_16x16x32_bf16 v[32:35], a[188:191], a[12:15], v[32:35]
v_exp_f32 v39, v39
v_mfma_f32_16x16x32_bf16 v[176:179], a[208:211], v[72:75], v[176:179]
buffer_load_dwordx4 v14, s[20:23], s30 offen nt lds
v_cvt_pk_bf16_f32 v65, v38, v39
v_mfma_f32_16x16x32_bf16 v[180:183], a[212:215], v[72:75], v[180:183]
ds_read_b64_tr_b16 a[192:193], v6 offset:40960
v_fmamk_f32 v40, v40, 0x3e0293ee, v27
v_mfma_f32_16x16x32_bf16 v[184:187], a[216:219], v[72:75], v[184:187]
v_exp_f32 v40, v40
v_mfma_f32_16x16x32_bf16 v[188:191], a[220:223], v[72:75], v[188:191]
ds_read_b64_tr_b16 a[194:195], v6 offset:45056
v_fmamk_f32 v41, v41, 0x3e0293ee, v27
v_mfma_f32_16x16x32_bf16 v[36:39], a[176:179], a[16:19], 0
v_exp_f32 v41, v41
v_mfma_f32_16x16x32_bf16 v[36:39], a[180:183], a[20:23], v[36:39]
ds_read_b64_tr_b16 a[196:197], v7 offset:40960
v_fmamk_f32 v42, v42, 0x3e0293ee, v27
v_mfma_f32_16x16x32_bf16 v[36:39], a[184:187], a[24:27], v[36:39]
v_exp_f32 v42, v42
v_mfma_f32_16x16x32_bf16 v[36:39], a[188:191], a[28:31], v[36:39]
ds_read_b64_tr_b16 a[198:199], v7 offset:45056
v_fmamk_f32 v43, v43, 0x3e0293ee, v27
v_mfma_f32_16x16x32_bf16 v[208:211], a[208:211], v[76:79], v[208:211]
v_exp_f32 v43, v43
v_mfma_f32_16x16x32_bf16 v[212:215], a[212:215], v[76:79], v[212:215]
ds_read_b64_tr_b16 a[200:201], v8 offset:40960
v_cvt_pk_bf16_f32 v68, v40, v41
v_mfma_f32_16x16x32_bf16 v[216:219], a[216:219], v[76:79], v[216:219]
ds_read_b64_tr_b16 a[202:203], v8 offset:45056
v_cvt_pk_bf16_f32 v69, v42, v43
v_mfma_f32_16x16x32_bf16 v[220:223], a[220:223], v[76:79], v[220:223]
ds_read_b64_tr_b16 a[204:205], v9 offset:40960
v_fmamk_f32 v32, v32, 0x3e0293ee, v23
v_mfma_f32_16x16x32_bf16 a[240:243], a[244:247], v[48:51], a[240:243]
v_exp_f32 v32, v32
v_mfma_f32_16x16x32_bf16 v[40:43], a[176:179], a[32:35], 0
ds_read_b64_tr_b16 a[206:207], v9 offset:45056
v_fmamk_f32 v33, v33, 0x3e0293ee, v23
v_mfma_f32_16x16x32_bf16 v[40:43], a[180:183], a[36:39], v[40:43]
v_exp_f32 v33, v33
v_mfma_f32_16x16x32_bf16 v[40:43], a[184:187], a[40:43], v[40:43]
ds_read_b128 a[160:163], v2 offset:49152
v_fmamk_f32 v34, v34, 0x3e0293ee, v23
v_mfma_f32_16x16x32_bf16 v[40:43], a[188:191], a[44:47], v[40:43]
v_exp_f32 v34, v34
v_mfma_f32_16x16x32_bf16 v[240:243], a[208:211], v[48:51], v[240:243]
ds_read_b128 a[164:167], v3 offset:49152
v_fmamk_f32 v35, v35, 0x3e0293ee, v23
v_mfma_f32_16x16x32_bf16 v[244:247], a[212:215], v[48:51], v[244:247]
v_exp_f32 v35, v35
v_mfma_f32_16x16x32_bf16 v[248:251], a[216:219], v[48:51], v[248:251]
ds_read_b128 a[168:171], v4 offset:49152
v_cvt_pk_bf16_f32 v54, v32, v33
v_mfma_f32_16x16x32_bf16 v[252:255], a[220:223], v[48:51], v[252:255]
v_cvt_pk_bf16_f32 v55, v34, v35
v_fmamk_f32 v36, v36, 0x3e0293ee, v24
v_mfma_f32_16x16x32_bf16 v[32:35], a[176:179], a[48:51], 0
v_exp_f32 v36, v36
v_mfma_f32_16x16x32_bf16 v[32:35], a[180:183], a[52:55], v[32:35]
s_waitcnt lgkmcnt(2)
buffer_load_dwordx4 v15, s[20:23], s30 offen offset:1024 nt lds
v_fmamk_f32 v37, v37, 0x3e0293ee, v24
v_mfma_f32_16x16x32_bf16 v[32:35], a[184:187], a[56:59], v[32:35]
s_add_u32 m0, s32, 90112
v_exp_f32 v37, v37
v_mfma_f32_16x16x32_bf16 v[32:35], a[188:191], a[60:63], v[32:35]
s_add_u32 s30, s29, 32768
ds_read_b128 a[172:175], v5 offset:49152
v_fmamk_f32 v38, v38, 0x3e0293ee, v24
v_mfma_f32_16x16x32_bf16 v[96:99], a[192:195], v[52:55], v[96:99]
v_exp_f32 v38, v38
v_mfma_f32_16x16x32_bf16 v[100:103], a[196:199], v[52:55], v[100:103]
v_fmamk_f32 v39, v39, 0x3e0293ee, v24
v_cvt_pk_bf16_f32 v58, v36, v37
v_mfma_f32_16x16x32_bf16 v[104:107], a[200:203], v[52:55], v[104:107]
v_exp_f32 v39, v39
v_mfma_f32_16x16x32_bf16 v[108:111], a[204:207], v[52:55], v[108:111]
v_cvt_pk_bf16_f32 v59, v38, v39
v_fmamk_f32 v40, v40, 0x3e0293ee, v25
v_mfma_f32_16x16x32_bf16 a[224:227], a[244:247], v[52:55], a[224:227]
v_exp_f32 v40, v40
v_mfma_f32_16x16x32_bf16 v[36:39], a[176:179], a[64:67], 0
v_fmamk_f32 v41, v41, 0x3e0293ee, v25
v_fmamk_f32 v42, v42, 0x3e0293ee, v25
v_mfma_f32_16x16x32_bf16 v[36:39], a[180:183], a[68:71], v[36:39]
v_exp_f32 v41, v41
v_mfma_f32_16x16x32_bf16 v[36:39], a[184:187], a[72:75], v[36:39]
v_exp_f32 v42, v42
v_mfma_f32_16x16x32_bf16 v[36:39], a[188:191], a[76:79], v[36:39]
v_fmamk_f32 v43, v43, 0x3e0293ee, v25
v_cvt_pk_bf16_f32 v62, v40, v41
v_mfma_f32_16x16x32_bf16 v[128:131], a[192:195], v[56:59], v[128:131]
v_exp_f32 v43, v43
v_mfma_f32_16x16x32_bf16 v[132:135], a[196:199], v[56:59], v[132:135]
v_cvt_pk_bf16_f32 v63, v42, v43
v_fmamk_f32 v32, v32, 0x3e0293ee, v26
v_mfma_f32_16x16x32_bf16 v[136:139], a[200:203], v[56:59], v[136:139]
v_exp_f32 v32, v32
v_mfma_f32_16x16x32_bf16 v[140:143], a[204:207], v[56:59], v[140:143]
v_fmamk_f32 v33, v33, 0x3e0293ee, v26
v_fmamk_f32 v34, v34, 0x3e0293ee, v26
v_mfma_f32_16x16x32_bf16 v[40:43], a[160:163], a[0:3], 0
s_waitcnt lgkmcnt(0)
v_exp_f32 v33, v33
v_mfma_f32_16x16x32_bf16 v[40:43], a[164:167], a[4:7], v[40:43]
v_exp_f32 v34, v34
v_mfma_f32_16x16x32_bf16 v[40:43], a[168:171], a[8:11], v[40:43]
v_fmamk_f32 v35, v35, 0x3e0293ee, v26
v_cvt_pk_bf16_f32 v66, v32, v33
v_mfma_f32_16x16x32_bf16 v[40:43], a[172:175], a[12:15], v[40:43]
v_exp_f32 v35, v35
v_mfma_f32_16x16x32_bf16 v[160:163], a[192:195], v[60:63], v[160:163]
buffer_load_dwordx4 v16, s[24:27], s31 offen nt lds
v_cvt_pk_bf16_f32 v67, v34, v35
v_mfma_f32_16x16x32_bf16 v[164:167], a[196:199], v[60:63], v[164:167]
ds_read_b64_tr_b16 a[208:209], v10 offset:40960
v_fmamk_f32 v36, v36, 0x3e0293ee, v27
v_mfma_f32_16x16x32_bf16 v[168:171], a[200:203], v[60:63], v[168:171]
v_exp_f32 v36, v36
v_mfma_f32_16x16x32_bf16 v[172:175], a[204:207], v[60:63], v[172:175]
ds_read_b64_tr_b16 a[210:211], v10 offset:45056
v_fmamk_f32 v37, v37, 0x3e0293ee, v27
v_mfma_f32_16x16x32_bf16 a[228:231], a[244:247], v[56:59], a[228:231]
v_exp_f32 v37, v37
v_mfma_f32_16x16x32_bf16 v[32:35], a[160:163], a[16:19], 0
ds_read_b64_tr_b16 a[212:213], v11 offset:40960
v_fmamk_f32 v38, v38, 0x3e0293ee, v27
v_mfma_f32_16x16x32_bf16 v[32:35], a[164:167], a[20:23], v[32:35]
v_exp_f32 v38, v38
v_mfma_f32_16x16x32_bf16 v[32:35], a[168:171], a[24:27], v[32:35]
ds_read_b64_tr_b16 a[214:215], v11 offset:45056
v_fmamk_f32 v39, v39, 0x3e0293ee, v27
v_mfma_f32_16x16x32_bf16 v[32:35], a[172:175], a[28:31], v[32:35]
v_exp_f32 v39, v39
v_mfma_f32_16x16x32_bf16 v[192:195], a[192:195], v[64:67], v[192:195]
ds_read_b64_tr_b16 a[216:217], v12 offset:40960
v_cvt_pk_bf16_f32 v70, v36, v37
v_mfma_f32_16x16x32_bf16 v[196:199], a[196:199], v[64:67], v[196:199]
ds_read_b64_tr_b16 a[218:219], v12 offset:45056
v_cvt_pk_bf16_f32 v71, v38, v39
v_mfma_f32_16x16x32_bf16 v[200:203], a[200:203], v[64:67], v[200:203]
ds_read_b64_tr_b16 a[220:221], v13 offset:40960
v_fmamk_f32 v40, v40, 0x3e0293ee, v23
v_mfma_f32_16x16x32_bf16 v[204:207], a[204:207], v[64:67], v[204:207]
v_exp_f32 v40, v40
v_mfma_f32_16x16x32_bf16 v[36:39], a[160:163], a[32:35], 0
ds_read_b64_tr_b16 a[222:223], v13 offset:45056
v_fmamk_f32 v41, v41, 0x3e0293ee, v23
v_mfma_f32_16x16x32_bf16 v[36:39], a[164:167], a[36:39], v[36:39]
v_exp_f32 v41, v41
v_mfma_f32_16x16x32_bf16 v[36:39], a[168:171], a[40:43], v[36:39]
ds_read_b128 a[176:179], v2 offset:53248
v_fmamk_f32 v42, v42, 0x3e0293ee, v23
v_mfma_f32_16x16x32_bf16 v[36:39], a[172:175], a[44:47], v[36:39]
v_exp_f32 v42, v42
v_mfma_f32_16x16x32_bf16 v[224:227], a[192:195], v[68:71], v[224:227]
ds_read_b128 a[180:183], v3 offset:53248
v_fmamk_f32 v43, v43, 0x3e0293ee, v23
v_mfma_f32_16x16x32_bf16 v[228:231], a[196:199], v[68:71], v[228:231]
v_exp_f32 v43, v43
v_mfma_f32_16x16x32_bf16 v[232:235], a[200:203], v[68:71], v[232:235]
ds_read_b128 a[184:187], v4 offset:53248
v_cvt_pk_bf16_f32 v72, v40, v41
v_mfma_f32_16x16x32_bf16 v[236:239], a[204:207], v[68:71], v[236:239]
ds_read_b128 a[188:191], v5 offset:53248
v_cvt_pk_bf16_f32 v73, v42, v43
v_mfma_f32_16x16x32_bf16 a[232:235], a[244:247], v[60:63], a[232:235]
buffer_load_dwordx4 v17, s[24:27], s31 offen offset:1024 nt lds
buffer_load_dwordx4 a[148:151], v28, s[8:11], 0 offen offset:64
v_mfma_f32_16x16x32_bf16 v[40:43], a[160:163], a[48:51], 0
s_add_u32 m0, s32, 32768
v_fmamk_f32 v32, v32, 0x3e0293ee, v24
v_fmamk_f32 v33, v33, 0x3e0293ee, v24
v_mfma_f32_16x16x32_bf16 v[40:43], a[164:167], a[52:55], v[40:43]
s_add_u32 s31, s29, 32768
v_exp_f32 v32, v32
v_mfma_f32_16x16x32_bf16 v[40:43], a[168:171], a[56:59], v[40:43]
v_exp_f32 v33, v33
v_mfma_f32_16x16x32_bf16 v[40:43], a[172:175], a[60:63], v[40:43]
s_waitcnt lgkmcnt(2)
v_fmamk_f32 v34, v34, 0x3e0293ee, v24
v_fmamk_f32 v35, v35, 0x3e0293ee, v24
v_mfma_f32_16x16x32_bf16 v[112:115], a[208:211], v[52:55], v[112:115]
v_exp_f32 v34, v34
v_mfma_f32_16x16x32_bf16 v[116:119], a[212:215], v[52:55], v[116:119]
v_exp_f32 v35, v35
v_mfma_f32_16x16x32_bf16 v[120:123], a[216:219], v[52:55], v[120:123]
v_cvt_pk_bf16_f32 v76, v32, v33
v_cvt_pk_bf16_f32 v77, v34, v35
v_mfma_f32_16x16x32_bf16 v[124:127], a[220:223], v[52:55], v[124:127]
v_fmamk_f32 v36, v36, 0x3e0293ee, v25
v_fmamk_f32 v37, v37, 0x3e0293ee, v25
v_mfma_f32_16x16x32_bf16 v[32:35], a[160:163], a[64:67], 0
v_exp_f32 v36, v36
v_mfma_f32_16x16x32_bf16 v[32:35], a[164:167], a[68:71], v[32:35]
v_exp_f32 v37, v37
v_mfma_f32_16x16x32_bf16 v[32:35], a[168:171], a[72:75], v[32:35]
v_fmamk_f32 v38, v38, 0x3e0293ee, v25
v_fmamk_f32 v39, v39, 0x3e0293ee, v25
v_mfma_f32_16x16x32_bf16 v[32:35], a[172:175], a[76:79], v[32:35]
v_exp_f32 v38, v38
v_mfma_f32_16x16x32_bf16 v[144:147], a[208:211], v[56:59], v[144:147]
v_exp_f32 v39, v39
v_mfma_f32_16x16x32_bf16 v[148:151], a[212:215], v[56:59], v[148:151]
v_cvt_pk_bf16_f32 v48, v36, v37
v_cvt_pk_bf16_f32 v49, v38, v39
v_mfma_f32_16x16x32_bf16 v[152:155], a[216:219], v[56:59], v[152:155]
v_fmamk_f32 v40, v40, 0x3e0293ee, v26
v_fmamk_f32 v41, v41, 0x3e0293ee, v26
v_mfma_f32_16x16x32_bf16 v[156:159], a[220:223], v[56:59], v[156:159]
v_exp_f32 v40, v40
v_mfma_f32_16x16x32_bf16 a[236:239], a[244:247], v[64:67], a[236:239]
v_exp_f32 v41, v41
v_mfma_f32_16x16x32_bf16 v[36:39], a[176:179], a[0:3], 0
v_fmamk_f32 v42, v42, 0x3e0293ee, v26
v_fmamk_f32 v43, v43, 0x3e0293ee, v26
v_mfma_f32_16x16x32_bf16 v[36:39], a[180:183], a[4:7], v[36:39]
s_waitcnt lgkmcnt(0)
v_exp_f32 v42, v42
v_mfma_f32_16x16x32_bf16 v[36:39], a[184:187], a[8:11], v[36:39]
v_exp_f32 v43, v43
v_mfma_f32_16x16x32_bf16 v[36:39], a[188:191], a[12:15], v[36:39]
v_cvt_pk_bf16_f32 v52, v40, v41
v_cvt_pk_bf16_f32 v53, v42, v43
v_mfma_f32_16x16x32_bf16 v[176:179], a[208:211], v[60:63], v[176:179]
buffer_load_dwordx4 v14, s[20:23], s30 offen nt lds
v_fmamk_f32 v32, v32, 0x3e0293ee, v27
v_mfma_f32_16x16x32_bf16 v[180:183], a[212:215], v[60:63], v[180:183]
v_exp_f32 v32, v32
v_mfma_f32_16x16x32_bf16 v[184:187], a[216:219], v[60:63], v[184:187]
ds_read_b64_tr_b16 a[192:193], v6 offset:49152
v_fmamk_f32 v33, v33, 0x3e0293ee, v27
v_mfma_f32_16x16x32_bf16 v[188:191], a[220:223], v[60:63], v[188:191]
v_exp_f32 v33, v33
v_mfma_f32_16x16x32_bf16 v[40:43], a[176:179], a[16:19], 0
ds_read_b64_tr_b16 a[194:195], v6 offset:53248
v_fmamk_f32 v34, v34, 0x3e0293ee, v27
v_mfma_f32_16x16x32_bf16 v[40:43], a[180:183], a[20:23], v[40:43]
v_exp_f32 v34, v34
v_mfma_f32_16x16x32_bf16 v[40:43], a[184:187], a[24:27], v[40:43]
ds_read_b64_tr_b16 a[196:197], v7 offset:49152
v_fmamk_f32 v35, v35, 0x3e0293ee, v27
v_mfma_f32_16x16x32_bf16 v[40:43], a[188:191], a[28:31], v[40:43]
v_exp_f32 v35, v35
v_mfma_f32_16x16x32_bf16 v[208:211], a[208:211], v[64:67], v[208:211]
ds_read_b64_tr_b16 a[198:199], v7 offset:53248
v_cvt_pk_bf16_f32 v56, v32, v33
v_mfma_f32_16x16x32_bf16 v[212:215], a[212:215], v[64:67], v[212:215]
ds_read_b64_tr_b16 a[200:201], v8 offset:49152
v_cvt_pk_bf16_f32 v57, v34, v35
v_mfma_f32_16x16x32_bf16 v[216:219], a[216:219], v[64:67], v[216:219]
L_pad0_6:
s_cbranch_execz L_pad0_10
ds_read_b64_tr_b16 a[202:203], v8 offset:53248
v_fmamk_f32 v36, v36, 0x3e0293ee, v23
v_mfma_f32_16x16x32_bf16 v[220:223], a[220:223], v[64:67], v[220:223]
v_exp_f32 v36, v36
v_mfma_f32_16x16x32_bf16 a[240:243], a[244:247], v[68:71], a[240:243]
ds_read_b64_tr_b16 a[204:205], v9 offset:49152
v_fmamk_f32 v37, v37, 0x3e0293ee, v23
v_mfma_f32_16x16x32_bf16 v[32:35], a[176:179], a[32:35], 0
v_exp_f32 v37, v37
v_mfma_f32_16x16x32_bf16 v[32:35], a[180:183], a[36:39], v[32:35]
ds_read_b64_tr_b16 a[206:207], v9 offset:53248
v_fmamk_f32 v38, v38, 0x3e0293ee, v23
v_mfma_f32_16x16x32_bf16 v[32:35], a[184:187], a[40:43], v[32:35]
v_exp_f32 v38, v38
v_mfma_f32_16x16x32_bf16 v[32:35], a[188:191], a[44:47], v[32:35]
ds_read_b128 a[160:163], v2 offset:57344
v_fmamk_f32 v39, v39, 0x3e0293ee, v23
v_mfma_f32_16x16x32_bf16 v[240:243], a[208:211], v[68:71], v[240:243]
v_exp_f32 v39, v39
v_mfma_f32_16x16x32_bf16 v[244:247], a[212:215], v[68:71], v[244:247]
ds_read_b128 a[164:167], v3 offset:57344
v_cvt_pk_bf16_f32 v74, v36, v37
v_mfma_f32_16x16x32_bf16 v[248:251], a[216:219], v[68:71], v[248:251]
ds_read_b128 a[168:171], v4 offset:57344
v_cvt_pk_bf16_f32 v75, v38, v39
v_mfma_f32_16x16x32_bf16 v[252:255], a[220:223], v[68:71], v[252:255]
ds_read_b128 a[172:175], v5 offset:57344
v_fmamk_f32 v40, v40, 0x3e0293ee, v24
v_mfma_f32_16x16x32_bf16 v[36:39], a[176:179], a[48:51], 0
v_exp_f32 v40, v40
v_mfma_f32_16x16x32_bf16 v[36:39], a[180:183], a[52:55], v[36:39]
s_waitcnt lgkmcnt(3)
buffer_load_dwordx4 v15, s[20:23], s30 offen offset:1024 nt lds
v_fmamk_f32 v41, v41, 0x3e0293ee, v24
v_mfma_f32_16x16x32_bf16 v[36:39], a[184:187], a[56:59], v[36:39]
s_add_u32 m0, s32, 98304
v_exp_f32 v41, v41
v_mfma_f32_16x16x32_bf16 v[36:39], a[188:191], a[60:63], v[36:39]
s_add_u32 s30, s29, 40960
v_fmamk_f32 v42, v42, 0x3e0293ee, v24
v_fmamk_f32 v43, v43, 0x3e0293ee, v24
v_mfma_f32_16x16x32_bf16 v[96:99], a[192:195], v[72:75], v[96:99]
v_exp_f32 v42, v42
v_mfma_f32_16x16x32_bf16 v[100:103], a[196:199], v[72:75], v[100:103]
v_exp_f32 v43, v43
v_mfma_f32_16x16x32_bf16 v[104:107], a[200:203], v[72:75], v[104:107]
v_cvt_pk_bf16_f32 v78, v40, v41
v_cvt_pk_bf16_f32 v79, v42, v43
v_mfma_f32_16x16x32_bf16 v[108:111], a[204:207], v[72:75], v[108:111]
v_fmamk_f32 v32, v32, 0x3e0293ee, v25
v_fmamk_f32 v33, v33, 0x3e0293ee, v25
v_mfma_f32_16x16x32_bf16 a[224:227], a[244:247], v[72:75], a[224:227]
v_exp_f32 v32, v32
v_mfma_f32_16x16x32_bf16 v[40:43], a[176:179], a[64:67], 0
v_exp_f32 v33, v33
v_mfma_f32_16x16x32_bf16 v[40:43], a[180:183], a[68:71], v[40:43]
v_fmamk_f32 v34, v34, 0x3e0293ee, v25
v_fmamk_f32 v35, v35, 0x3e0293ee, v25
v_mfma_f32_16x16x32_bf16 v[40:43], a[184:187], a[72:75], v[40:43]
v_exp_f32 v34, v34
v_mfma_f32_16x16x32_bf16 v[40:43], a[188:191], a[76:79], v[40:43]
v_exp_f32 v35, v35
v_mfma_f32_16x16x32_bf16 v[128:131], a[192:195], v[76:79], v[128:131]
v_cvt_pk_bf16_f32 v50, v32, v33
v_cvt_pk_bf16_f32 v51, v34, v35
v_mfma_f32_16x16x32_bf16 v[132:135], a[196:199], v[76:79], v[132:135]
v_fmamk_f32 v36, v36, 0x3e0293ee, v26
v_fmamk_f32 v37, v37, 0x3e0293ee, v26
v_mfma_f32_16x16x32_bf16 v[136:139], a[200:203], v[76:79], v[136:139]
v_exp_f32 v36, v36
v_mfma_f32_16x16x32_bf16 v[140:143], a[204:207], v[76:79], v[140:143]
v_exp_f32 v37, v37
v_mfma_f32_16x16x32_bf16 v[32:35], a[160:163], a[0:3], 0
s_waitcnt lgkmcnt(0)
v_fmamk_f32 v38, v38, 0x3e0293ee, v26
v_fmamk_f32 v39, v39, 0x3e0293ee, v26
v_mfma_f32_16x16x32_bf16 v[32:35], a[164:167], a[4:7], v[32:35]
v_exp_f32 v38, v38
v_mfma_f32_16x16x32_bf16 v[32:35], a[168:171], a[8:11], v[32:35]
v_exp_f32 v39, v39
v_mfma_f32_16x16x32_bf16 v[32:35], a[172:175], a[12:15], v[32:35]
v_cvt_pk_bf16_f32 v54, v36, v37
v_cvt_pk_bf16_f32 v55, v38, v39
v_mfma_f32_16x16x32_bf16 v[160:163], a[192:195], v[48:51], v[160:163]
buffer_load_dwordx4 v16, s[24:27], s31 offen nt lds
v_fmamk_f32 v40, v40, 0x3e0293ee, v27
v_mfma_f32_16x16x32_bf16 v[164:167], a[196:199], v[48:51], v[164:167]
v_exp_f32 v40, v40
v_mfma_f32_16x16x32_bf16 v[168:171], a[200:203], v[48:51], v[168:171]
ds_read_b64_tr_b16 a[208:209], v10 offset:49152
v_fmamk_f32 v41, v41, 0x3e0293ee, v27
v_mfma_f32_16x16x32_bf16 v[172:175], a[204:207], v[48:51], v[172:175]
v_exp_f32 v41, v41
v_mfma_f32_16x16x32_bf16 a[228:231], a[244:247], v[76:79], a[228:231]
ds_read_b64_tr_b16 a[210:211], v10 offset:53248
v_fmamk_f32 v42, v42, 0x3e0293ee, v27
v_mfma_f32_16x16x32_bf16 v[36:39], a[160:163], a[16:19], 0
v_exp_f32 v42, v42
v_mfma_f32_16x16x32_bf16 v[36:39], a[164:167], a[20:23], v[36:39]
ds_read_b64_tr_b16 a[212:213], v11 offset:49152
v_fmamk_f32 v43, v43, 0x3e0293ee, v27
v_mfma_f32_16x16x32_bf16 v[36:39], a[168:171], a[24:27], v[36:39]
v_exp_f32 v43, v43
v_mfma_f32_16x16x32_bf16 v[36:39], a[172:175], a[28:31], v[36:39]
ds_read_b64_tr_b16 a[214:215], v11 offset:53248
v_cvt_pk_bf16_f32 v58, v40, v41
v_mfma_f32_16x16x32_bf16 v[192:195], a[192:195], v[52:55], v[192:195]
ds_read_b64_tr_b16 a[216:217], v12 offset:49152
v_cvt_pk_bf16_f32 v59, v42, v43
v_mfma_f32_16x16x32_bf16 v[196:199], a[196:199], v[52:55], v[196:199]
ds_read_b64_tr_b16 a[218:219], v12 offset:53248
v_fmamk_f32 v32, v32, 0x3e0293ee, v23
v_mfma_f32_16x16x32_bf16 v[200:203], a[200:203], v[52:55], v[200:203]
v_exp_f32 v32, v32
v_mfma_f32_16x16x32_bf16 v[204:207], a[204:207], v[52:55], v[204:207]
ds_read_b64_tr_b16 a[220:221], v13 offset:49152
v_fmamk_f32 v33, v33, 0x3e0293ee, v23
v_mfma_f32_16x16x32_bf16 v[40:43], a[160:163], a[32:35], 0
v_exp_f32 v33, v33
v_mfma_f32_16x16x32_bf16 v[40:43], a[164:167], a[36:39], v[40:43]
ds_read_b64_tr_b16 a[222:223], v13 offset:53248
v_fmamk_f32 v34, v34, 0x3e0293ee, v23
v_mfma_f32_16x16x32_bf16 v[40:43], a[168:171], a[40:43], v[40:43]
v_exp_f32 v34, v34
v_mfma_f32_16x16x32_bf16 v[40:43], a[172:175], a[44:47], v[40:43]
ds_read_b128 a[176:179], v2 offset:61440
v_fmamk_f32 v35, v35, 0x3e0293ee, v23
v_mfma_f32_16x16x32_bf16 v[224:227], a[192:195], v[56:59], v[224:227]
v_exp_f32 v35, v35
v_mfma_f32_16x16x32_bf16 v[228:231], a[196:199], v[56:59], v[228:231]
ds_read_b128 a[180:183], v3 offset:61440
v_cvt_pk_bf16_f32 v60, v32, v33
v_mfma_f32_16x16x32_bf16 v[232:235], a[200:203], v[56:59], v[232:235]
ds_read_b128 a[184:187], v4 offset:61440
v_cvt_pk_bf16_f32 v61, v34, v35
v_mfma_f32_16x16x32_bf16 v[236:239], a[204:207], v[56:59], v[236:239]
ds_read_b128 a[188:191], v5 offset:61440
v_fmamk_f32 v36, v36, 0x3e0293ee, v24
v_mfma_f32_16x16x32_bf16 a[232:235], a[244:247], v[48:51], a[232:235]
buffer_load_dwordx4 v17, s[24:27], s31 offen offset:1024 nt lds
buffer_load_dwordx4 a[152:155], v28, s[8:11], 0 offen offset:128
v_mfma_f32_16x16x32_bf16 v[32:35], a[160:163], a[48:51], 0
s_add_u32 m0, s32, 40960
v_exp_f32 v36, v36
v_mfma_f32_16x16x32_bf16 v[32:35], a[164:167], a[52:55], v[32:35]
s_add_u32 s31, s29, 40960
v_fmamk_f32 v37, v37, 0x3e0293ee, v24
v_fmamk_f32 v38, v38, 0x3e0293ee, v24
v_mfma_f32_16x16x32_bf16 v[32:35], a[168:171], a[56:59], v[32:35]
v_exp_f32 v37, v37
v_mfma_f32_16x16x32_bf16 v[32:35], a[172:175], a[60:63], v[32:35]
s_waitcnt lgkmcnt(3)
v_exp_f32 v38, v38
v_mfma_f32_16x16x32_bf16 v[112:115], a[208:211], v[72:75], v[112:115]
buffer_load_dwordx4 a[156:159], v28, s[8:11], 0 offen offset:192
v_fmamk_f32 v39, v39, 0x3e0293ee, v24
v_mfma_f32_16x16x32_bf16 v[116:119], a[212:215], v[72:75], v[116:119]
v_exp_f32 v39, v39
v_mfma_f32_16x16x32_bf16 v[120:123], a[216:219], v[72:75], v[120:123]
v_cvt_pk_bf16_f32 v64, v36, v37
v_cvt_pk_bf16_f32 v65, v38, v39
v_mfma_f32_16x16x32_bf16 v[124:127], a[220:223], v[72:75], v[124:127]
v_fmamk_f32 v40, v40, 0x3e0293ee, v25
v_fmamk_f32 v41, v41, 0x3e0293ee, v25
v_mfma_f32_16x16x32_bf16 v[36:39], a[160:163], a[64:67], 0
v_exp_f32 v40, v40
v_mfma_f32_16x16x32_bf16 v[36:39], a[164:167], a[68:71], v[36:39]
v_exp_f32 v41, v41
v_mfma_f32_16x16x32_bf16 v[36:39], a[168:171], a[72:75], v[36:39]
v_fmamk_f32 v42, v42, 0x3e0293ee, v25
v_fmamk_f32 v43, v43, 0x3e0293ee, v25
v_mfma_f32_16x16x32_bf16 v[36:39], a[172:175], a[76:79], v[36:39]
v_exp_f32 v42, v42
v_mfma_f32_16x16x32_bf16 v[144:147], a[208:211], v[76:79], v[144:147]
v_exp_f32 v43, v43
v_mfma_f32_16x16x32_bf16 v[148:151], a[212:215], v[76:79], v[148:151]
v_cvt_pk_bf16_f32 v68, v40, v41
v_cvt_pk_bf16_f32 v69, v42, v43
v_mfma_f32_16x16x32_bf16 v[152:155], a[216:219], v[76:79], v[152:155]
v_fmamk_f32 v32, v32, 0x3e0293ee, v26
v_fmamk_f32 v33, v33, 0x3e0293ee, v26
v_mfma_f32_16x16x32_bf16 v[156:159], a[220:223], v[76:79], v[156:159]
v_exp_f32 v32, v32
v_mfma_f32_16x16x32_bf16 a[236:239], a[244:247], v[52:55], a[236:239]
s_waitcnt vmcnt(18) lgkmcnt(0)
v_exp_f32 v33, v33
v_mfma_f32_16x16x32_bf16 v[40:43], a[176:179], a[0:3], 0
s_barrier
v_fmamk_f32 v34, v34, 0x3e0293ee, v26
v_fmamk_f32 v35, v35, 0x3e0293ee, v26
v_mfma_f32_16x16x32_bf16 v[40:43], a[180:183], a[4:7], v[40:43]
v_exp_f32 v34, v34
v_mfma_f32_16x16x32_bf16 v[40:43], a[184:187], a[8:11], v[40:43]
v_exp_f32 v35, v35
v_mfma_f32_16x16x32_bf16 v[40:43], a[188:191], a[12:15], v[40:43]
v_cvt_pk_bf16_f32 v72, v32, v33
v_cvt_pk_bf16_f32 v73, v34, v35
v_mfma_f32_16x16x32_bf16 v[176:179], a[208:211], v[48:51], v[176:179]
buffer_load_dwordx4 v14, s[20:23], s30 offen nt lds
v_fmamk_f32 v36, v36, 0x3e0293ee, v27
v_mfma_f32_16x16x32_bf16 v[180:183], a[212:215], v[48:51], v[180:183]
v_exp_f32 v36, v36
v_mfma_f32_16x16x32_bf16 v[184:187], a[216:219], v[48:51], v[184:187]
ds_read_b64_tr_b16 a[192:193], v6 offset:57344
v_fmamk_f32 v37, v37, 0x3e0293ee, v27
v_mfma_f32_16x16x32_bf16 v[188:191], a[220:223], v[48:51], v[188:191]
v_exp_f32 v37, v37
v_mfma_f32_16x16x32_bf16 v[32:35], a[176:179], a[16:19], 0
ds_read_b64_tr_b16 a[194:195], v6 offset:61440
v_fmamk_f32 v38, v38, 0x3e0293ee, v27
v_mfma_f32_16x16x32_bf16 v[32:35], a[180:183], a[20:23], v[32:35]
v_exp_f32 v38, v38
v_mfma_f32_16x16x32_bf16 v[32:35], a[184:187], a[24:27], v[32:35]
ds_read_b64_tr_b16 a[196:197], v7 offset:57344
v_fmamk_f32 v39, v39, 0x3e0293ee, v27
v_mfma_f32_16x16x32_bf16 v[32:35], a[188:191], a[28:31], v[32:35]
v_exp_f32 v39, v39
v_mfma_f32_16x16x32_bf16 v[208:211], a[208:211], v[52:55], v[208:211]
ds_read_b64_tr_b16 a[198:199], v7 offset:61440
v_cvt_pk_bf16_f32 v76, v36, v37
v_mfma_f32_16x16x32_bf16 v[212:215], a[212:215], v[52:55], v[212:215]
ds_read_b64_tr_b16 a[200:201], v8 offset:57344
v_cvt_pk_bf16_f32 v77, v38, v39
v_mfma_f32_16x16x32_bf16 v[216:219], a[216:219], v[52:55], v[216:219]
ds_read_b64_tr_b16 a[202:203], v8 offset:61440
v_fmamk_f32 v40, v40, 0x3e0293ee, v23
v_mfma_f32_16x16x32_bf16 v[220:223], a[220:223], v[52:55], v[220:223]
v_exp_f32 v40, v40
v_mfma_f32_16x16x32_bf16 a[240:243], a[244:247], v[56:59], a[240:243]
ds_read_b64_tr_b16 a[204:205], v9 offset:57344
v_fmamk_f32 v41, v41, 0x3e0293ee, v23
v_mfma_f32_16x16x32_bf16 v[36:39], a[176:179], a[32:35], 0
v_exp_f32 v41, v41
v_mfma_f32_16x16x32_bf16 v[36:39], a[180:183], a[36:39], v[36:39]
ds_read_b64_tr_b16 a[206:207], v9 offset:61440
v_fmamk_f32 v42, v42, 0x3e0293ee, v23
v_mfma_f32_16x16x32_bf16 v[36:39], a[184:187], a[40:43], v[36:39]
v_exp_f32 v42, v42
v_mfma_f32_16x16x32_bf16 v[36:39], a[188:191], a[44:47], v[36:39]
v_fmamk_f32 v43, v43, 0x3e0293ee, v23
v_cvt_pk_bf16_f32 v62, v40, v41
v_mfma_f32_16x16x32_bf16 v[240:243], a[208:211], v[56:59], v[240:243]
v_exp_f32 v43, v43
v_mfma_f32_16x16x32_bf16 v[244:247], a[212:215], v[56:59], v[244:247]
v_cvt_pk_bf16_f32 v63, v42, v43
v_fmamk_f32 v32, v32, 0x3e0293ee, v24
v_mfma_f32_16x16x32_bf16 v[248:251], a[216:219], v[56:59], v[248:251]
v_exp_f32 v32, v32
v_mfma_f32_16x16x32_bf16 v[252:255], a[220:223], v[56:59], v[252:255]
v_fmamk_f32 v33, v33, 0x3e0293ee, v24
v_fmamk_f32 v34, v34, 0x3e0293ee, v24
v_mfma_f32_16x16x32_bf16 v[40:43], a[176:179], a[48:51], 0
v_exp_f32 v33, v33
v_mfma_f32_16x16x32_bf16 v[40:43], a[180:183], a[52:55], v[40:43]
v_exp_f32 v34, v34
v_mfma_f32_16x16x32_bf16 v[40:43], a[184:187], a[56:59], v[40:43]
s_waitcnt lgkmcnt(0)
buffer_load_dwordx4 v15, s[20:23], s30 offen offset:1024 nt lds
v_fmamk_f32 v35, v35, 0x3e0293ee, v24
v_mfma_f32_16x16x32_bf16 v[40:43], a[188:191], a[60:63], v[40:43]
s_add_u32 m0, s32, 106496
v_exp_f32 v35, v35
v_mfma_f32_16x16x32_bf16 v[96:99], a[192:195], v[60:63], v[96:99]
s_add_u32 s30, s29, 49152
v_cvt_pk_bf16_f32 v66, v32, v33
v_cvt_pk_bf16_f32 v67, v34, v35
v_mfma_f32_16x16x32_bf16 v[100:103], a[196:199], v[60:63], v[100:103]
v_xor_b32 v2, s77, v2
v_xor_b32 v3, s77, v3
v_mfma_f32_16x16x32_bf16 v[104:107], a[200:203], v[60:63], v[104:107]
ds_read_b128 a[160:163], v2 offset:0
v_xor_b32 v4, s77, v4
v_mfma_f32_16x16x32_bf16 v[108:111], a[204:207], v[60:63], v[108:111]
ds_read_b128 a[164:167], v3 offset:0
v_xor_b32 v5, s77, v5
v_mfma_f32_16x16x32_bf16 a[224:227], a[244:247], v[60:63], a[224:227]
ds_read_b128 a[168:171], v4 offset:0
v_fmamk_f32 v36, v36, 0x3e0293ee, v25
v_mfma_f32_16x16x32_bf16 v[32:35], a[176:179], a[64:67], 0
ds_read_b128 a[172:175], v5 offset:0
v_fmamk_f32 v37, v37, 0x3e0293ee, v25
v_mfma_f32_16x16x32_bf16 v[32:35], a[180:183], a[68:71], v[32:35]
v_exp_f32 v36, v36
v_mfma_f32_16x16x32_bf16 v[32:35], a[184:187], a[72:75], v[32:35]
v_exp_f32 v37, v37
v_mfma_f32_16x16x32_bf16 v[32:35], a[188:191], a[76:79], v[32:35]
v_fmamk_f32 v38, v38, 0x3e0293ee, v25
v_fmamk_f32 v39, v39, 0x3e0293ee, v25
v_mfma_f32_16x16x32_bf16 v[128:131], a[192:195], v[64:67], v[128:131]
v_exp_f32 v38, v38
v_mfma_f32_16x16x32_bf16 v[132:135], a[196:199], v[64:67], v[132:135]
v_exp_f32 v39, v39
v_mfma_f32_16x16x32_bf16 v[136:139], a[200:203], v[64:67], v[136:139]
v_cvt_pk_bf16_f32 v70, v36, v37
v_cvt_pk_bf16_f32 v71, v38, v39
v_mfma_f32_16x16x32_bf16 v[140:143], a[204:207], v[64:67], v[140:143]
s_waitcnt lgkmcnt(1)
v_accvgpr_read_b32 v88, a224
v_cmp_nge_f32 vcc, s34, v88
v_rcp_f32 v88, v88
v_mfma_f32_16x16x32_bf16 v[36:39], a[160:163], a[80:83], 0
s_or_b64 s[40:41], s[40:41], vcc
v_pk_mul_f32 v[96:97], v[96:97], v[88:89] op_sel:[0,0] op_sel_hi:[1,0]
v_pk_mul_f32 v[98:99], v[98:99], v[88:89] op_sel:[0,0] op_sel_hi:[1,0]
v_pk_mul_f32 v[100:101], v[100:101], v[88:89] op_sel:[0,0] op_sel_hi:[1,0]
v_cvt_pk_bf16_f32 v96, v96, v97
v_cvt_pk_bf16_f32 v97, v98, v99
v_pk_mul_f32 v[102:103], v[102:103], v[88:89] op_sel:[0,0] op_sel_hi:[1,0]
v_cvt_pk_bf16_f32 v100, v100, v101
v_pk_mul_f32 v[104:105], v[104:105], v[88:89] op_sel:[0,0] op_sel_hi:[1,0]
v_cvt_pk_bf16_f32 v101, v102, v103
v_pk_mul_f32 v[106:107], v[106:107], v[88:89] op_sel:[0,0] op_sel_hi:[1,0]
v_cvt_pk_bf16_f32 v104, v104, v105
v_pk_mul_f32 v[108:109], v[108:109], v[88:89] op_sel:[0,0] op_sel_hi:[1,0]
v_cvt_pk_bf16_f32 v105, v106, v107
v_pk_mul_f32 v[110:111], v[110:111], v[88:89] op_sel:[0,0] op_sel_hi:[1,0]
v_cvt_pk_bf16_f32 v108, v108, v109
v_fmamk_f32 v40, v40, 0x3e0293ee, v26
v_cvt_pk_bf16_f32 v109, v110, v111
v_fmamk_f32 v41, v41, 0x3e0293ee, v26
v_mfma_f32_16x16x32_bf16 v[36:39], a[164:167], a[84:87], v[36:39]
ds_write2_b64 v20, v[96:97], v[100:101] offset0:0 offset1:4
ds_write2_b64 v20, v[104:105], v[108:109] offset0:8 offset1:12
v_exp_f32 v40, v40
v_mfma_f32_16x16x32_bf16 v[36:39], a[168:171], a[88:91], v[36:39]
s_waitcnt lgkmcnt(2)
v_exp_f32 v41, v41
v_mfma_f32_16x16x32_bf16 v[36:39], a[172:175], a[92:95], v[36:39]
v_fmamk_f32 v42, v42, 0x3e0293ee, v26
v_fmamk_f32 v43, v43, 0x3e0293ee, v26
v_mfma_f32_16x16x32_bf16 v[160:163], a[192:195], v[68:71], v[160:163]
v_exp_f32 v42, v42
v_mfma_f32_16x16x32_bf16 v[164:167], a[196:199], v[68:71], v[164:167]
v_exp_f32 v43, v43
v_mfma_f32_16x16x32_bf16 v[168:171], a[200:203], v[68:71], v[168:171]
buffer_load_dwordx4 v16, s[24:27], s31 offen nt lds
v_cvt_pk_bf16_f32 v74, v40, v41
v_mfma_f32_16x16x32_bf16 v[172:175], a[204:207], v[68:71], v[172:175]
ds_read_b64_tr_b16 a[208:209], v10 offset:57344
v_cvt_pk_bf16_f32 v75, v42, v43
v_mfma_f32_16x16x32_bf16 a[228:231], a[244:247], v[64:67], a[228:231]
ds_read_b128 a[0:3], v21 offset:0
ds_read_b128 a[4:7], v21 offset:1152
ds_read_b64_tr_b16 a[210:211], v10 offset:61440
v_fmamk_f32 v32, v32, 0x3e0293ee, v27
v_mfma_f32_16x16x32_bf16 v[40:43], a[160:163], a[96:99], 0
v_exp_f32 v32, v32
v_mfma_f32_16x16x32_bf16 v[40:43], a[164:167], a[100:103], v[40:43]
ds_read_b64_tr_b16 a[212:213], v11 offset:57344
v_fmamk_f32 v33, v33, 0x3e0293ee, v27
v_mfma_f32_16x16x32_bf16 v[40:43], a[168:171], a[104:107], v[40:43]
v_exp_f32 v33, v33
v_mfma_f32_16x16x32_bf16 v[40:43], a[172:175], a[108:111], v[40:43]
ds_read_b64_tr_b16 a[214:215], v11 offset:61440
v_fmamk_f32 v34, v34, 0x3e0293ee, v27
v_mfma_f32_16x16x32_bf16 v[192:195], a[192:195], v[72:75], v[192:195]
v_exp_f32 v34, v34
v_mfma_f32_16x16x32_bf16 v[196:199], a[196:199], v[72:75], v[196:199]
ds_read_b64_tr_b16 a[216:217], v12 offset:57344
v_fmamk_f32 v35, v35, 0x3e0293ee, v27
v_mfma_f32_16x16x32_bf16 v[200:203], a[200:203], v[72:75], v[200:203]
v_exp_f32 v35, v35
v_mfma_f32_16x16x32_bf16 v[204:207], a[204:207], v[72:75], v[204:207]
v_cvt_pk_bf16_f32 v78, v32, v33
v_cvt_pk_bf16_f32 v79, v34, v35
v_accvgpr_read_b32 v89, a228
v_cmp_nge_f32 vcc, s34, v89
v_rcp_f32 v89, v89
v_mfma_f32_16x16x32_bf16 v[32:35], a[160:163], a[112:115], 0
s_or_b64 s[40:41], s[40:41], vcc
ds_read_b64_tr_b16 a[218:219], v12 offset:61440
v_pk_mul_f32 v[128:129], v[128:129], v[88:89] op_sel:[0,1] op_sel_hi:[1,1]
v_pk_mul_f32 v[130:131], v[130:131], v[88:89] op_sel:[0,1] op_sel_hi:[1,1]
v_pk_mul_f32 v[132:133], v[132:133], v[88:89] op_sel:[0,1] op_sel_hi:[1,1]
v_cvt_pk_bf16_f32 v128, v128, v129
v_cvt_pk_bf16_f32 v129, v130, v131
v_pk_mul_f32 v[134:135], v[134:135], v[88:89] op_sel:[0,1] op_sel_hi:[1,1]
v_cvt_pk_bf16_f32 v132, v132, v133
v_pk_mul_f32 v[136:137], v[136:137], v[88:89] op_sel:[0,1] op_sel_hi:[1,1]
v_cvt_pk_bf16_f32 v133, v134, v135
v_pk_mul_f32 v[138:139], v[138:139], v[88:89] op_sel:[0,1] op_sel_hi:[1,1]
v_cvt_pk_bf16_f32 v136, v136, v137
v_pk_mul_f32 v[140:141], v[140:141], v[88:89] op_sel:[0,1] op_sel_hi:[1,1]
v_cvt_pk_bf16_f32 v137, v138, v139
v_pk_mul_f32 v[142:143], v[142:143], v[88:89] op_sel:[0,1] op_sel_hi:[1,1]
v_cvt_pk_bf16_f32 v140, v140, v141
v_max3_f32 v23, v36, v37, v38
v_cvt_pk_bf16_f32 v141, v142, v143
v_mfma_f32_16x16x32_bf16 v[32:35], a[164:167], a[116:119], v[32:35]
ds_write2_b64 v20, v[128:129], v[132:133] offset0:0 offset1:4
ds_write2_b64 v20, v[136:137], v[140:141] offset0:8 offset1:12
ds_read_b64_tr_b16 a[220:221], v13 offset:57344
v_max_f32 v23, v23, v39
v_mfma_f32_16x16x32_bf16 v[32:35], a[168:171], a[120:123], v[32:35]
ds_read_b64_tr_b16 a[222:223], v13 offset:61440
v_mov_b32 v93, v23
v_mfma_f32_16x16x32_bf16 v[32:35], a[172:175], a[124:127], v[32:35]
s_nop 0
v_permlane32_swap_b32 v93, v23
v_mfma_f32_16x16x32_bf16 v[224:227], a[192:195], v[76:79], v[224:227]
ds_read_b128 a[176:179], v2 offset:4096
v_max_f32 v23, v23, v93
v_mfma_f32_16x16x32_bf16 v[228:231], a[196:199], v[76:79], v[228:231]
ds_read_b128 a[180:183], v3 offset:4096
v_mov_b32 v93, v23
v_mfma_f32_16x16x32_bf16 v[232:235], a[200:203], v[76:79], v[232:235]
s_nop 0
v_permlane16_swap_b32 v93, v23
v_mfma_f32_16x16x32_bf16 v[236:239], a[204:207], v[76:79], v[236:239]
v_max_f32 v23, v23, v93
v_mul_f32 v23, 0xbe0293ee, v23
v_fmamk_f32 v36, v36, 0x3e0293ee, v23
v_fmamk_f32 v37, v37, 0x3e0293ee, v23
v_fmamk_f32 v38, v38, 0x3e0293ee, v23
v_exp_f32 v36, v36
v_exp_f32 v37, v37
v_exp_f32 v38, v38
v_fmamk_f32 v39, v39, 0x3e0293ee, v23
v_exp_f32 v39, v39
v_mfma_f32_16x16x32_bf16 a[232:235], a[244:247], v[68:71], a[232:235]
ds_read_b128 a[16:19], v21 offset:0
ds_read_b128 a[20:23], v21 offset:1152
v_cvt_pk_bf16_f32 v48, v36, v37
v_cvt_pk_bf16_f32 v49, v38, v39
v_mfma_f32_16x16x32_bf16 v[36:39], a[160:163], a[128:131], 0
buffer_load_dwordx4 v17, s[24:27], s31 offen offset:1024 nt lds
v_max3_f32 v24, v40, v41, v42
v_mfma_f32_16x16x32_bf16 v[36:39], a[164:167], a[132:135], v[36:39]
s_waitcnt vmcnt(21)
s_add_u32 m0, s32, 49152
ds_read_b128 a[184:187], v4 offset:4096
v_max_f32 v24, v24, v43
v_mfma_f32_16x16x32_bf16 v[36:39], a[168:171], a[136:139], v[36:39]
s_waitcnt vmcnt(16)
s_add_u32 s31, s29, 49152
ds_read_b128 a[188:191], v5 offset:4096
v_mov_b32 v93, v24
v_mfma_f32_16x16x32_bf16 v[36:39], a[172:175], a[140:143], v[36:39]
s_waitcnt lgkmcnt(5)
v_permlane32_swap_b32 v93, v24
v_mfma_f32_16x16x32_bf16 v[112:115], a[208:211], v[60:63], v[112:115]
v_max_f32 v24, v24, v93
v_mov_b32 v93, v24
v_mfma_f32_16x16x32_bf16 v[116:119], a[212:215], v[60:63], v[116:119]
s_nop 0
v_permlane16_swap_b32 v93, v24
v_mfma_f32_16x16x32_bf16 v[120:123], a[216:219], v[60:63], v[120:123]
v_max_f32 v24, v24, v93
v_mul_f32 v24, 0xbe0293ee, v24
v_fmamk_f32 v40, v40, 0x3e0293ee, v24
v_fmamk_f32 v41, v41, 0x3e0293ee, v24
v_fmamk_f32 v42, v42, 0x3e0293ee, v24
v_exp_f32 v40, v40
v_exp_f32 v41, v41
v_exp_f32 v42, v42
v_fmamk_f32 v43, v43, 0x3e0293ee, v24
v_exp_f32 v43, v43
v_mfma_f32_16x16x32_bf16 v[124:127], a[220:223], v[60:63], v[124:127]
s_waitcnt vmcnt(15)
v_cvt_pk_bf16_f32 v52, v40, v41
v_cvt_pk_bf16_f32 v53, v42, v43
v_accvgpr_read_b32 v90, a232
v_cmp_nge_f32 vcc, s34, v90
v_rcp_f32 v90, v90
v_mfma_f32_16x16x32_bf16 v[40:43], a[160:163], a[144:147], 0
s_waitcnt vmcnt(10)
s_or_b64 s[40:41], s[40:41], vcc
v_pk_mul_f32 v[160:161], v[160:161], v[90:91] op_sel:[0,0] op_sel_hi:[1,0]
v_pk_mul_f32 v[162:163], v[162:163], v[90:91] op_sel:[0,0] op_sel_hi:[1,0]
v_pk_mul_f32 v[164:165], v[164:165], v[90:91] op_sel:[0,0] op_sel_hi:[1,0]
v_cvt_pk_bf16_f32 v160, v160, v161
v_cvt_pk_bf16_f32 v161, v162, v163
v_pk_mul_f32 v[166:167], v[166:167], v[90:91] op_sel:[0,0] op_sel_hi:[1,0]
v_cvt_pk_bf16_f32 v164, v164, v165
v_pk_mul_f32 v[168:169], v[168:169], v[90:91] op_sel:[0,0] op_sel_hi:[1,0]
v_cvt_pk_bf16_f32 v165, v166, v167
v_pk_mul_f32 v[170:171], v[170:171], v[90:91] op_sel:[0,0] op_sel_hi:[1,0]
v_cvt_pk_bf16_f32 v168, v168, v169
v_pk_mul_f32 v[172:173], v[172:173], v[90:91] op_sel:[0,0] op_sel_hi:[1,0]
v_cvt_pk_bf16_f32 v169, v170, v171
v_pk_mul_f32 v[174:175], v[174:175], v[90:91] op_sel:[0,0] op_sel_hi:[1,0]
v_cvt_pk_bf16_f32 v172, v172, v173
v_max3_f32 v25, v32, v33, v34
v_cvt_pk_bf16_f32 v173, v174, v175
v_max_f32 v25, v25, v35
v_mfma_f32_16x16x32_bf16 v[40:43], a[164:167], a[148:151], v[40:43]
s_waitcnt vmcnt(5)
ds_write2_b64 v20, v[160:161], v[164:165] offset0:0 offset1:4
ds_write2_b64 v20, v[168:169], v[172:173] offset0:8 offset1:12
v_mov_b32 v93, v25
v_max3_f32 v26, v36, v37, v38
v_mfma_f32_16x16x32_bf16 v[40:43], a[168:171], a[152:155], v[40:43]
s_waitcnt vmcnt(4)
v_permlane32_swap_b32 v93, v25
v_mfma_f32_16x16x32_bf16 v[40:43], a[172:175], a[156:159], v[40:43]
v_max_f32 v25, v25, v93
v_mov_b32 v93, v25
v_mfma_f32_16x16x32_bf16 v[144:147], a[208:211], v[64:67], v[144:147]
s_nop 0
v_permlane16_swap_b32 v93, v25
v_mfma_f32_16x16x32_bf16 v[148:151], a[212:215], v[64:67], v[148:151]
v_max_f32 v25, v25, v93
v_mul_f32 v25, 0xbe0293ee, v25
v_mfma_f32_16x16x32_bf16 v[152:155], a[216:219], v[64:67], v[152:155]
v_fmamk_f32 v32, v32, 0x3e0293ee, v25
v_fmamk_f32 v33, v33, 0x3e0293ee, v25
v_mfma_f32_16x16x32_bf16 v[156:159], a[220:223], v[64:67], v[156:159]
v_exp_f32 v32, v32
v_exp_f32 v33, v33
v_fmamk_f32 v34, v34, 0x3e0293ee, v25
v_fmamk_f32 v35, v35, 0x3e0293ee, v25
v_exp_f32 v34, v34
v_exp_f32 v35, v35
v_mfma_f32_16x16x32_bf16 a[236:239], a[244:247], v[72:75], a[236:239]
ds_read_b128 a[32:35], v21 offset:0
ds_read_b128 a[36:39], v21 offset:1152
v_cvt_pk_bf16_f32 v56, v32, v33
v_cvt_pk_bf16_f32 v57, v34, v35
v_pk_mul_f32 v[112:113], v[112:113], v[88:89] op_sel:[0,0] op_sel_hi:[1,0]
v_pk_mul_f32 v[114:115], v[114:115], v[88:89] op_sel:[0,0] op_sel_hi:[1,0]
v_pk_mul_f32 v[116:117], v[116:117], v[88:89] op_sel:[0,0] op_sel_hi:[1,0]
v_cvt_pk_bf16_f32 v112, v112, v113
v_cvt_pk_bf16_f32 v113, v114, v115
v_pk_mul_f32 v[118:119], v[118:119], v[88:89] op_sel:[0,0] op_sel_hi:[1,0]
v_cvt_pk_bf16_f32 v116, v116, v117
v_pk_mul_f32 v[120:121], v[120:121], v[88:89] op_sel:[0,0] op_sel_hi:[1,0]
v_cvt_pk_bf16_f32 v117, v118, v119
v_pk_mul_f32 v[122:123], v[122:123], v[88:89] op_sel:[0,0] op_sel_hi:[1,0]
v_cvt_pk_bf16_f32 v120, v120, v121
v_pk_mul_f32 v[124:125], v[124:125], v[88:89] op_sel:[0,0] op_sel_hi:[1,0]
v_cvt_pk_bf16_f32 v121, v122, v123
v_pk_mul_f32 v[126:127], v[126:127], v[88:89] op_sel:[0,0] op_sel_hi:[1,0]
v_cvt_pk_bf16_f32 v124, v124, v125
v_cvt_pk_bf16_f32 v125, v126, v127
v_mfma_f32_16x16x32_bf16 v[32:35], a[176:179], a[80:83], 0
s_waitcnt lgkmcnt(2)
ds_write2_b64 v20, v[112:113], v[116:117] offset0:0 offset1:4
ds_write2_b64 v20, v[120:121], v[124:125] offset0:8 offset1:12
v_max_f32 v26, v26, v39
v_mov_b32 v93, v26
v_mfma_f32_16x16x32_bf16 v[32:35], a[180:183], a[84:87], v[32:35]
s_nop 0
v_permlane32_swap_b32 v93, v26
v_mfma_f32_16x16x32_bf16 v[32:35], a[184:187], a[88:91], v[32:35]
v_max_f32 v26, v26, v93
v_mov_b32 v93, v26
v_mfma_f32_16x16x32_bf16 v[32:35], a[188:191], a[92:95], v[32:35]
s_nop 0
v_permlane16_swap_b32 v93, v26
v_mfma_f32_16x16x32_bf16 v[176:179], a[208:211], v[68:71], v[176:179]
v_max_f32 v26, v26, v93
v_mul_f32 v26, 0xbe0293ee, v26
v_mfma_f32_16x16x32_bf16 v[180:183], a[212:215], v[68:71], v[180:183]
v_fmamk_f32 v36, v36, 0x3e0293ee, v26
v_fmamk_f32 v37, v37, 0x3e0293ee, v26
v_mfma_f32_16x16x32_bf16 v[184:187], a[216:219], v[68:71], v[184:187]
v_exp_f32 v36, v36
v_exp_f32 v37, v37
v_fmamk_f32 v38, v38, 0x3e0293ee, v26
v_fmamk_f32 v39, v39, 0x3e0293ee, v26
v_exp_f32 v38, v38
v_exp_f32 v39, v39
v_mfma_f32_16x16x32_bf16 v[188:191], a[220:223], v[68:71], v[188:191]
ds_read_b128 a[8:11], v21 offset:0
ds_read_b128 a[12:15], v21 offset:1152
v_cvt_pk_bf16_f32 v60, v36, v37
v_cvt_pk_bf16_f32 v61, v38, v39
v_mfma_f32_16x16x32_bf16 v[36:39], a[176:179], a[96:99], 0
v_pk_mul_f32 v[144:145], v[144:145], v[88:89] op_sel:[0,1] op_sel_hi:[1,1]
v_pk_mul_f32 v[146:147], v[146:147], v[88:89] op_sel:[0,1] op_sel_hi:[1,1]
v_pk_mul_f32 v[148:149], v[148:149], v[88:89] op_sel:[0,1] op_sel_hi:[1,1]
v_cvt_pk_bf16_f32 v144, v144, v145
v_cvt_pk_bf16_f32 v145, v146, v147
v_pk_mul_f32 v[150:151], v[150:151], v[88:89] op_sel:[0,1] op_sel_hi:[1,1]
v_cvt_pk_bf16_f32 v148, v148, v149
v_pk_mul_f32 v[152:153], v[152:153], v[88:89] op_sel:[0,1] op_sel_hi:[1,1]
v_cvt_pk_bf16_f32 v149, v150, v151
v_pk_mul_f32 v[154:155], v[154:155], v[88:89] op_sel:[0,1] op_sel_hi:[1,1]
v_cvt_pk_bf16_f32 v152, v152, v153
v_pk_mul_f32 v[156:157], v[156:157], v[88:89] op_sel:[0,1] op_sel_hi:[1,1]
v_cvt_pk_bf16_f32 v153, v154, v155
v_pk_mul_f32 v[158:159], v[158:159], v[88:89] op_sel:[0,1] op_sel_hi:[1,1]
v_cvt_pk_bf16_f32 v156, v156, v157
v_max3_f32 v27, v40, v41, v42
v_cvt_pk_bf16_f32 v157, v158, v159
v_max_f32 v27, v27, v43
v_mfma_f32_16x16x32_bf16 v[36:39], a[180:183], a[100:103], v[36:39]
L_pad0_7:
s_cbranch_execz L_pad0_11
ds_write2_b64 v20, v[144:145], v[148:149] offset0:0 offset1:4
ds_write2_b64 v20, v[152:153], v[156:157] offset0:8 offset1:12
v_mov_b32 v93, v27
v_accvgpr_read_b32 v91, a236
v_mfma_f32_16x16x32_bf16 v[36:39], a[184:187], a[104:107], v[36:39]
v_permlane32_swap_b32 v93, v27
v_mfma_f32_16x16x32_bf16 v[36:39], a[188:191], a[108:111], v[36:39]
v_max_f32 v27, v27, v93
v_mov_b32 v93, v27
v_mfma_f32_16x16x32_bf16 v[208:211], a[208:211], v[72:75], v[208:211]
s_nop 0
v_permlane16_swap_b32 v93, v27
v_mfma_f32_16x16x32_bf16 v[212:215], a[212:215], v[72:75], v[212:215]
v_cmp_nge_f32 vcc, s34, v91
v_max_f32 v27, v27, v93
v_mfma_f32_16x16x32_bf16 v[216:219], a[216:219], v[72:75], v[216:219]
s_or_b64 s[40:41], s[40:41], vcc
v_rcp_f32 v91, v91
v_mfma_f32_16x16x32_bf16 v[220:223], a[220:223], v[72:75], v[220:223]
v_mul_f32 v27, 0xbe0293ee, v27
v_fmamk_f32 v40, v40, 0x3e0293ee, v27
v_fmamk_f32 v41, v41, 0x3e0293ee, v27
v_fmamk_f32 v42, v42, 0x3e0293ee, v27
v_exp_f32 v40, v40
v_exp_f32 v41, v41
v_exp_f32 v42, v42
v_fmamk_f32 v43, v43, 0x3e0293ee, v27
v_exp_f32 v43, v43
v_mfma_f32_16x16x32_bf16 a[240:243], a[244:247], v[76:79], a[240:243]
ds_read_b128 a[24:27], v21 offset:0
ds_read_b128 a[28:31], v21 offset:1152
v_pk_mul_f32 v[192:193], v[192:193], v[90:91] op_sel:[0,1] op_sel_hi:[1,1]
v_pk_mul_f32 v[194:195], v[194:195], v[90:91] op_sel:[0,1] op_sel_hi:[1,1]
v_pk_mul_f32 v[196:197], v[196:197], v[90:91] op_sel:[0,1] op_sel_hi:[1,1]
v_cvt_pk_bf16_f32 v192, v192, v193
v_cvt_pk_bf16_f32 v193, v194, v195
v_pk_mul_f32 v[198:199], v[198:199], v[90:91] op_sel:[0,1] op_sel_hi:[1,1]
v_cvt_pk_bf16_f32 v196, v196, v197
v_pk_mul_f32 v[200:201], v[200:201], v[90:91] op_sel:[0,1] op_sel_hi:[1,1]
v_cvt_pk_bf16_f32 v197, v198, v199
v_pk_mul_f32 v[202:203], v[202:203], v[90:91] op_sel:[0,1] op_sel_hi:[1,1]
v_cvt_pk_bf16_f32 v200, v200, v201
v_pk_mul_f32 v[204:205], v[204:205], v[90:91] op_sel:[0,1] op_sel_hi:[1,1]
v_cvt_pk_bf16_f32 v201, v202, v203
v_pk_mul_f32 v[206:207], v[206:207], v[90:91] op_sel:[0,1] op_sel_hi:[1,1]
v_cvt_pk_bf16_f32 v204, v204, v205
v_cvt_pk_bf16_f32 v64, v40, v41
v_cvt_pk_bf16_f32 v205, v206, v207
v_cvt_pk_bf16_f32 v65, v42, v43
v_mfma_f32_16x16x32_bf16 v[40:43], a[176:179], a[112:115], 0
ds_write2_b64 v20, v[192:193], v[196:197] offset0:0 offset1:4
ds_write2_b64 v20, v[200:201], v[204:205] offset0:8 offset1:12
v_xor_b32 v6, s78, v6
v_xor_b32 v7, s78, v7
v_mfma_f32_16x16x32_bf16 v[40:43], a[180:183], a[116:119], v[40:43]
ds_read_b64_tr_b16 a[192:193], v6 offset:0
v_xor_b32 v8, s78, v8
v_mfma_f32_16x16x32_bf16 v[40:43], a[184:187], a[120:123], v[40:43]
ds_read_b64_tr_b16 a[194:195], v6 offset:4096
v_fmamk_f32 v32, v32, 0x3e0293ee, v23
v_mfma_f32_16x16x32_bf16 v[40:43], a[188:191], a[124:127], v[40:43]
ds_read_b64_tr_b16 a[196:197], v7 offset:0
v_fmamk_f32 v33, v33, 0x3e0293ee, v23
v_mfma_f32_16x16x32_bf16 v[240:243], a[208:211], v[76:79], v[240:243]
ds_read_b64_tr_b16 a[198:199], v7 offset:4096
v_fmamk_f32 v34, v34, 0x3e0293ee, v23
v_mfma_f32_16x16x32_bf16 v[244:247], a[212:215], v[76:79], v[244:247]
v_exp_f32 v32, v32
v_mfma_f32_16x16x32_bf16 v[248:251], a[216:219], v[76:79], v[248:251]
ds_read_b64_tr_b16 a[200:201], v8 offset:0
ds_read_b64_tr_b16 a[202:203], v8 offset:4096
v_exp_f32 v33, v33
v_exp_f32 v34, v34
v_fmamk_f32 v35, v35, 0x3e0293ee, v23
v_xor_b32 v9, s78, v9
v_exp_f32 v35, v35
v_mfma_f32_16x16x32_bf16 v[252:255], a[220:223], v[76:79], v[252:255]
ds_read_b128 a[48:51], v21 offset:0
ds_read_b128 a[52:55], v21 offset:1152
ds_read_b64_tr_b16 a[204:205], v9 offset:0
ds_read_b64_tr_b16 a[206:207], v9 offset:4096
v_pk_mul_f32 v[176:177], v[176:177], v[90:91] op_sel:[0,0] op_sel_hi:[1,0]
v_pk_mul_f32 v[178:179], v[178:179], v[90:91] op_sel:[0,0] op_sel_hi:[1,0]
v_pk_mul_f32 v[180:181], v[180:181], v[90:91] op_sel:[0,0] op_sel_hi:[1,0]
v_cvt_pk_bf16_f32 v176, v176, v177
v_cvt_pk_bf16_f32 v177, v178, v179
v_pk_mul_f32 v[182:183], v[182:183], v[90:91] op_sel:[0,0] op_sel_hi:[1,0]
v_cvt_pk_bf16_f32 v180, v180, v181
v_pk_mul_f32 v[184:185], v[184:185], v[90:91] op_sel:[0,0] op_sel_hi:[1,0]
v_cvt_pk_bf16_f32 v181, v182, v183
v_pk_mul_f32 v[186:187], v[186:187], v[90:91] op_sel:[0,0] op_sel_hi:[1,0]
v_cvt_pk_bf16_f32 v184, v184, v185
v_pk_mul_f32 v[188:189], v[188:189], v[90:91] op_sel:[0,0] op_sel_hi:[1,0]
v_cvt_pk_bf16_f32 v185, v186, v187
v_pk_mul_f32 v[190:191], v[190:191], v[90:91] op_sel:[0,0] op_sel_hi:[1,0]
v_cvt_pk_bf16_f32 v188, v188, v189
v_cvt_pk_bf16_f32 v50, v32, v33
v_cvt_pk_bf16_f32 v189, v190, v191
v_cvt_pk_bf16_f32 v51, v34, v35
v_mfma_f32_16x16x32_bf16 v[32:35], a[176:179], a[128:131], 0
ds_write2_b64 v20, v[176:177], v[180:181] offset0:0 offset1:4
ds_write2_b64 v20, v[184:185], v[188:189] offset0:8 offset1:12
v_fmamk_f32 v36, v36, 0x3e0293ee, v24
v_fmamk_f32 v37, v37, 0x3e0293ee, v24
v_mfma_f32_16x16x32_bf16 v[32:35], a[180:183], a[132:135], v[32:35]
v_exp_f32 v36, v36
v_mfma_f32_16x16x32_bf16 v[32:35], a[184:187], a[136:139], v[32:35]
v_exp_f32 v37, v37
v_mfma_f32_16x16x32_bf16 v[32:35], a[188:191], a[140:143], v[32:35]
s_waitcnt lgkmcnt(9)
v_fmamk_f32 v38, v38, 0x3e0293ee, v24
v_fmamk_f32 v39, v39, 0x3e0293ee, v24
v_mfma_f32_16x16x32_bf16 v[96:99], a[192:195], v[48:51], 0
s_waitcnt lgkmcnt(8)
v_exp_f32 v38, v38
v_mfma_f32_16x16x32_bf16 v[100:103], a[196:199], v[48:51], 0
s_waitcnt lgkmcnt(6)
v_exp_f32 v39, v39
v_mfma_f32_16x16x32_bf16 v[104:107], a[200:203], v[48:51], 0
s_waitcnt lgkmcnt(2)
v_xor_b32 v44, 0x2000, v2
v_cvt_pk_bf16_f32 v54, v36, v37
v_mfma_f32_16x16x32_bf16 v[108:111], a[204:207], v[48:51], 0
ds_read_b128 a[40:43], v21 offset:0
ds_read_b128 a[44:47], v21 offset:1152
ds_read_b128 a[160:163], v44 offset:0
v_pk_mul_f32 v[208:209], v[208:209], v[90:91] op_sel:[0,1] op_sel_hi:[1,1]
v_pk_mul_f32 v[210:211], v[210:211], v[90:91] op_sel:[0,1] op_sel_hi:[1,1]
v_pk_mul_f32 v[212:213], v[212:213], v[90:91] op_sel:[0,1] op_sel_hi:[1,1]
v_cvt_pk_bf16_f32 v208, v208, v209
v_cvt_pk_bf16_f32 v209, v210, v211
v_pk_mul_f32 v[214:215], v[214:215], v[90:91] op_sel:[0,1] op_sel_hi:[1,1]
v_cvt_pk_bf16_f32 v212, v212, v213
v_pk_mul_f32 v[216:217], v[216:217], v[90:91] op_sel:[0,1] op_sel_hi:[1,1]
v_cvt_pk_bf16_f32 v213, v214, v215
v_pk_mul_f32 v[218:219], v[218:219], v[90:91] op_sel:[0,1] op_sel_hi:[1,1]
v_cvt_pk_bf16_f32 v216, v216, v217
v_pk_mul_f32 v[220:221], v[220:221], v[90:91] op_sel:[0,1] op_sel_hi:[1,1]
v_cvt_pk_bf16_f32 v217, v218, v219
v_pk_mul_f32 v[222:223], v[222:223], v[90:91] op_sel:[0,1] op_sel_hi:[1,1]
v_cvt_pk_bf16_f32 v220, v220, v221
v_cvt_pk_bf16_f32 v55, v38, v39
v_cvt_pk_bf16_f32 v221, v222, v223
v_mfma_f32_16x16x32_bf16 a[224:227], a[244:247], v[48:51], 0
ds_write2_b64 v20, v[208:209], v[212:213] offset0:0 offset1:4
ds_write2_b64 v20, v[216:217], v[220:221] offset0:8 offset1:12
v_xor_b32 v45, 0x2000, v3
v_xor_b32 v46, 0x2000, v4
v_mfma_f32_16x16x32_bf16 v[36:39], a[176:179], a[144:147], 0
ds_read_b128 a[164:167], v45 offset:0
v_xor_b32 v47, 0x2000, v5
v_mfma_f32_16x16x32_bf16 v[36:39], a[180:183], a[148:151], v[36:39]
ds_read_b128 a[168:171], v46 offset:0
v_accvgpr_read_b32 v92, a240
v_mfma_f32_16x16x32_bf16 v[36:39], a[184:187], a[152:155], v[36:39]
ds_read_b128 a[172:175], v47 offset:0
v_cmp_nge_f32 vcc, s34, v92
v_mfma_f32_16x16x32_bf16 v[36:39], a[188:191], a[156:159], v[36:39]
s_or_b64 s[40:41], s[40:41], vcc
v_rcp_f32 v92, v92
v_mfma_f32_16x16x32_bf16 v[128:131], a[192:195], v[52:55], 0
v_fmamk_f32 v40, v40, 0x3e0293ee, v25
v_fmamk_f32 v41, v41, 0x3e0293ee, v25
v_mfma_f32_16x16x32_bf16 v[132:135], a[196:199], v[52:55], 0
v_exp_f32 v40, v40
v_mfma_f32_16x16x32_bf16 v[136:139], a[200:203], v[52:55], 0
ds_read_b128 a[56:59], v21 offset:0
ds_read_b128 a[60:63], v21 offset:1152
v_pk_mul_f32 v[224:225], v[224:225], v[92:93] op_sel:[0,0] op_sel_hi:[1,0]
v_pk_mul_f32 v[226:227], v[226:227], v[92:93] op_sel:[0,0] op_sel_hi:[1,0]
v_pk_mul_f32 v[228:229], v[228:229], v[92:93] op_sel:[0,0] op_sel_hi:[1,0]
v_cvt_pk_bf16_f32 v224, v224, v225
v_cvt_pk_bf16_f32 v225, v226, v227
v_pk_mul_f32 v[230:231], v[230:231], v[92:93] op_sel:[0,0] op_sel_hi:[1,0]
v_cvt_pk_bf16_f32 v228, v228, v229
v_pk_mul_f32 v[232:233], v[232:233], v[92:93] op_sel:[0,0] op_sel_hi:[1,0]
v_cvt_pk_bf16_f32 v229, v230, v231
v_pk_mul_f32 v[234:235], v[234:235], v[92:93] op_sel:[0,0] op_sel_hi:[1,0]
v_cvt_pk_bf16_f32 v232, v232, v233
v_pk_mul_f32 v[236:237], v[236:237], v[92:93] op_sel:[0,0] op_sel_hi:[1,0]
v_cvt_pk_bf16_f32 v233, v234, v235
v_pk_mul_f32 v[238:239], v[238:239], v[92:93] op_sel:[0,0] op_sel_hi:[1,0]
v_cvt_pk_bf16_f32 v236, v236, v237
v_exp_f32 v41, v41
v_cvt_pk_bf16_f32 v237, v238, v239
v_fmamk_f32 v42, v42, 0x3e0293ee, v25
v_fmamk_f32 v43, v43, 0x3e0293ee, v25
v_exp_f32 v42, v42
v_exp_f32 v43, v43
v_mfma_f32_16x16x32_bf16 v[140:143], a[204:207], v[52:55], 0
s_waitcnt lgkmcnt(5)
ds_write2_b64 v20, v[224:225], v[228:229] offset0:0 offset1:4
ds_write2_b64 v20, v[232:233], v[236:237] offset0:8 offset1:12
v_cvt_pk_bf16_f32 v58, v40, v41
v_cvt_pk_bf16_f32 v59, v42, v43
v_mfma_f32_16x16x32_bf16 v[40:43], a[160:163], a[80:83], 0
s_waitcnt lgkmcnt(6)
v_fmamk_f32 v32, v32, 0x3e0293ee, v26
v_fmamk_f32 v33, v33, 0x3e0293ee, v26
v_mfma_f32_16x16x32_bf16 v[40:43], a[164:167], a[84:87], v[40:43]
s_waitcnt lgkmcnt(5)
v_exp_f32 v32, v32
v_mfma_f32_16x16x32_bf16 v[40:43], a[168:171], a[88:91], v[40:43]
s_waitcnt lgkmcnt(4)
v_exp_f32 v33, v33
v_mfma_f32_16x16x32_bf16 v[40:43], a[172:175], a[92:95], v[40:43]
v_fmamk_f32 v34, v34, 0x3e0293ee, v26
v_fmamk_f32 v35, v35, 0x3e0293ee, v26
v_mfma_f32_16x16x32_bf16 v[160:163], a[192:195], v[56:59], 0
v_exp_f32 v34, v34
v_mfma_f32_16x16x32_bf16 v[164:167], a[196:199], v[56:59], 0
v_exp_f32 v35, v35
v_mfma_f32_16x16x32_bf16 v[168:171], a[200:203], v[56:59], 0
ds_read_b128 a[64:67], v21 offset:0
ds_read_b128 a[68:71], v21 offset:1152
v_pk_mul_f32 v[240:241], v[240:241], v[92:93] op_sel:[0,0] op_sel_hi:[1,0]
v_pk_mul_f32 v[242:243], v[242:243], v[92:93] op_sel:[0,0] op_sel_hi:[1,0]
v_pk_mul_f32 v[244:245], v[244:245], v[92:93] op_sel:[0,0] op_sel_hi:[1,0]
v_cvt_pk_bf16_f32 v240, v240, v241
v_cvt_pk_bf16_f32 v241, v242, v243
v_pk_mul_f32 v[246:247], v[246:247], v[92:93] op_sel:[0,0] op_sel_hi:[1,0]
v_cvt_pk_bf16_f32 v244, v244, v245
v_pk_mul_f32 v[248:249], v[248:249], v[92:93] op_sel:[0,0] op_sel_hi:[1,0]
v_cvt_pk_bf16_f32 v245, v246, v247
v_pk_mul_f32 v[250:251], v[250:251], v[92:93] op_sel:[0,0] op_sel_hi:[1,0]
v_cvt_pk_bf16_f32 v248, v248, v249
v_pk_mul_f32 v[252:253], v[252:253], v[92:93] op_sel:[0,0] op_sel_hi:[1,0]
v_cvt_pk_bf16_f32 v249, v250, v251
v_pk_mul_f32 v[254:255], v[254:255], v[92:93] op_sel:[0,0] op_sel_hi:[1,0]
v_cvt_pk_bf16_f32 v252, v252, v253
v_cvt_pk_bf16_f32 v62, v32, v33
v_cvt_pk_bf16_f32 v253, v254, v255
v_cvt_pk_bf16_f32 v63, v34, v35
v_mfma_f32_16x16x32_bf16 v[172:175], a[204:207], v[56:59], 0
ds_write2_b64 v20, v[240:241], v[244:245] offset0:0 offset1:4
ds_write2_b64 v20, v[248:249], v[252:253] offset0:8 offset1:12
v_fmamk_f32 v36, v36, 0x3e0293ee, v27
v_fmamk_f32 v37, v37, 0x3e0293ee, v27
v_mfma_f32_16x16x32_bf16 a[228:231], a[244:247], v[52:55], 0
v_exp_f32 v36, v36
v_mfma_f32_16x16x32_bf16 v[32:35], a[160:163], a[96:99], 0
v_exp_f32 v37, v37
v_mfma_f32_16x16x32_bf16 v[32:35], a[164:167], a[100:103], v[32:35]
v_fmamk_f32 v38, v38, 0x3e0293ee, v27
v_fmamk_f32 v39, v39, 0x3e0293ee, v27
v_mfma_f32_16x16x32_bf16 v[32:35], a[168:171], a[104:107], v[32:35]
v_exp_f32 v38, v38
v_mfma_f32_16x16x32_bf16 v[32:35], a[172:175], a[108:111], v[32:35]
v_exp_f32 v39, v39
v_mfma_f32_16x16x32_bf16 v[192:195], a[192:195], v[60:63], 0
v_cvt_pk_bf16_f32 v66, v36, v37
v_cvt_pk_bf16_f32 v67, v38, v39
v_mfma_f32_16x16x32_bf16 v[196:199], a[196:199], v[60:63], 0
ds_read_b128 a[72:75], v21 offset:0
ds_read_b128 a[76:79], v21 offset:1152
v_xor_b32 v10, s78, v10
v_xor_b32 v11, s78, v11
v_mfma_f32_16x16x32_bf16 v[200:203], a[200:203], v[60:63], 0
ds_read_b64_tr_b16 a[208:209], v10 offset:0
v_xor_b32 v12, s78, v12
v_mfma_f32_16x16x32_bf16 v[204:207], a[204:207], v[60:63], 0
ds_read_b64_tr_b16 a[210:211], v10 offset:4096
v_xor_b32 v13, s78, v13
v_mfma_f32_16x16x32_bf16 v[36:39], a[160:163], a[112:115], 0
ds_read_b64_tr_b16 a[212:213], v11 offset:0
v_fmamk_f32 v40, v40, 0x3e0293ee, v23
v_mfma_f32_16x16x32_bf16 v[36:39], a[164:167], a[116:119], v[36:39]
ds_read_b64_tr_b16 a[214:215], v11 offset:4096
v_fmamk_f32 v41, v41, 0x3e0293ee, v23
v_mfma_f32_16x16x32_bf16 v[36:39], a[168:171], a[120:123], v[36:39]
ds_read_b64_tr_b16 a[216:217], v12 offset:0
v_fmamk_f32 v42, v42, 0x3e0293ee, v23
v_mfma_f32_16x16x32_bf16 v[36:39], a[172:175], a[124:127], v[36:39]
ds_read_b64_tr_b16 a[218:219], v12 offset:4096
v_fmamk_f32 v43, v43, 0x3e0293ee, v23
v_mfma_f32_16x16x32_bf16 v[224:227], a[192:195], v[64:67], 0
ds_read_b64_tr_b16 a[220:221], v13 offset:0
ds_read_b64_tr_b16 a[222:223], v13 offset:4096
v_mfma_f32_16x16x32_bf16 v[228:231], a[196:199], v[64:67], 0
v_exp_f32 v40, v40
v_mfma_f32_16x16x32_bf16 v[232:235], a[200:203], v[64:67], 0
v_exp_f32 v41, v41
v_mfma_f32_16x16x32_bf16 v[236:239], a[204:207], v[64:67], 0
v_exp_f32 v42, v42
v_mfma_f32_16x16x32_bf16 a[232:235], a[244:247], v[56:59], 0
s_waitcnt lgkmcnt(5)
v_exp_f32 v43, v43
v_mfma_f32_16x16x32_bf16 v[112:115], a[208:211], v[48:51], 0
s_waitcnt lgkmcnt(4)
ds_read_b128 a[176:179], v44 offset:4096
v_cvt_pk_bf16_f32 v68, v40, v41
v_mfma_f32_16x16x32_bf16 v[116:119], a[212:215], v[48:51], 0
s_waitcnt lgkmcnt(3)
ds_read_b128 a[180:183], v45 offset:4096
v_cvt_pk_bf16_f32 v69, v42, v43
v_mfma_f32_16x16x32_bf16 v[120:123], a[216:219], v[48:51], 0
s_waitcnt lgkmcnt(2)
ds_read_b128 a[184:187], v46 offset:4096
v_fmamk_f32 v32, v32, 0x3e0293ee, v24
v_mfma_f32_16x16x32_bf16 v[124:127], a[220:223], v[48:51], 0
ds_read_b128 a[188:191], v47 offset:4096
v_fmamk_f32 v33, v33, 0x3e0293ee, v24
v_mfma_f32_16x16x32_bf16 v[40:43], a[160:163], a[128:131], 0
v_exp_f32 v32, v32
v_mfma_f32_16x16x32_bf16 v[40:43], a[164:167], a[132:135], v[40:43]
v_exp_f32 v33, v33
v_mfma_f32_16x16x32_bf16 v[40:43], a[168:171], a[136:139], v[40:43]
v_fmamk_f32 v34, v34, 0x3e0293ee, v24
v_fmamk_f32 v35, v35, 0x3e0293ee, v24
v_mfma_f32_16x16x32_bf16 v[40:43], a[172:175], a[140:143], v[40:43]
v_exp_f32 v34, v34
v_mfma_f32_16x16x32_bf16 v[144:147], a[208:211], v[52:55], 0
v_exp_f32 v35, v35
v_mfma_f32_16x16x32_bf16 v[148:151], a[212:215], v[52:55], 0
v_cvt_pk_bf16_f32 v72, v32, v33
v_cvt_pk_bf16_f32 v73, v34, v35
v_mfma_f32_16x16x32_bf16 v[152:155], a[216:219], v[52:55], 0
v_fmamk_f32 v36, v36, 0x3e0293ee, v25
v_fmamk_f32 v37, v37, 0x3e0293ee, v25
v_mfma_f32_16x16x32_bf16 v[156:159], a[220:223], v[52:55], 0
v_exp_f32 v36, v36
v_mfma_f32_16x16x32_bf16 a[236:239], a[244:247], v[60:63], 0
s_waitcnt lgkmcnt(0)
v_exp_f32 v37, v37
v_mfma_f32_16x16x32_bf16 v[32:35], a[176:179], a[80:83], 0
s_barrier
v_fmamk_f32 v38, v38, 0x3e0293ee, v25
v_fmamk_f32 v39, v39, 0x3e0293ee, v25
v_mfma_f32_16x16x32_bf16 v[32:35], a[180:183], a[84:87], v[32:35]
v_exp_f32 v38, v38
v_mfma_f32_16x16x32_bf16 v[32:35], a[184:187], a[88:91], v[32:35]
v_exp_f32 v39, v39
v_mfma_f32_16x16x32_bf16 v[32:35], a[188:191], a[92:95], v[32:35]
v_cvt_pk_bf16_f32 v76, v36, v37
v_cvt_pk_bf16_f32 v77, v38, v39
v_mfma_f32_16x16x32_bf16 v[176:179], a[208:211], v[56:59], 0
buffer_load_dwordx4 v14, s[20:23], s30 offen nt lds
v_fmamk_f32 v40, v40, 0x3e0293ee, v26
v_mfma_f32_16x16x32_bf16 v[180:183], a[212:215], v[56:59], 0
v_exp_f32 v40, v40
v_mfma_f32_16x16x32_bf16 v[184:187], a[216:219], v[56:59], 0
ds_read_b128 a[160:163], v2 offset:16384
v_fmamk_f32 v41, v41, 0x3e0293ee, v26
v_mfma_f32_16x16x32_bf16 v[188:191], a[220:223], v[56:59], 0
v_exp_f32 v41, v41
v_mfma_f32_16x16x32_bf16 v[36:39], a[176:179], a[96:99], 0
ds_read_b128 a[164:167], v3 offset:16384
v_fmamk_f32 v42, v42, 0x3e0293ee, v26
v_mfma_f32_16x16x32_bf16 v[36:39], a[180:183], a[100:103], v[36:39]
v_exp_f32 v42, v42
v_mfma_f32_16x16x32_bf16 v[36:39], a[184:187], a[104:107], v[36:39]
ds_read_b128 a[168:171], v4 offset:16384
v_fmamk_f32 v43, v43, 0x3e0293ee, v26
v_mfma_f32_16x16x32_bf16 v[36:39], a[188:191], a[108:111], v[36:39]
v_exp_f32 v43, v43
v_mfma_f32_16x16x32_bf16 v[208:211], a[208:211], v[60:63], 0
v_cvt_pk_bf16_f32 v48, v40, v41
v_cvt_pk_bf16_f32 v49, v42, v43
v_mfma_f32_16x16x32_bf16 v[212:215], a[212:215], v[60:63], 0
ds_read_b128 a[172:175], v5 offset:16384
v_xor_b32 v80, 0x2000, v6
v_mfma_f32_16x16x32_bf16 v[216:219], a[216:219], v[60:63], 0
ds_read_b64_tr_b16 a[192:193], v80 offset:0
v_xor_b32 v81, 0x2000, v7
v_mfma_f32_16x16x32_bf16 v[220:223], a[220:223], v[60:63], 0
ds_read_b64_tr_b16 a[194:195], v80 offset:4096
v_xor_b32 v82, 0x2000, v8
v_mfma_f32_16x16x32_bf16 a[240:243], a[244:247], v[64:67], 0
ds_read_b64_tr_b16 a[196:197], v81 offset:0
v_xor_b32 v83, 0x2000, v9
v_mfma_f32_16x16x32_bf16 v[40:43], a[176:179], a[112:115], 0
ds_read_b64_tr_b16 a[198:199], v81 offset:4096
v_fmamk_f32 v32, v32, 0x3e0293ee, v23
v_mfma_f32_16x16x32_bf16 v[40:43], a[180:183], a[116:119], v[40:43]
v_exp_f32 v32, v32
v_mfma_f32_16x16x32_bf16 v[40:43], a[184:187], a[120:123], v[40:43]
ds_read_b64_tr_b16 a[200:201], v82 offset:0
v_fmamk_f32 v33, v33, 0x3e0293ee, v23
v_mfma_f32_16x16x32_bf16 v[40:43], a[188:191], a[124:127], v[40:43]
v_exp_f32 v33, v33
v_mfma_f32_16x16x32_bf16 v[240:243], a[208:211], v[64:67], 0
ds_read_b64_tr_b16 a[202:203], v82 offset:4096
v_fmamk_f32 v34, v34, 0x3e0293ee, v23
v_mfma_f32_16x16x32_bf16 v[244:247], a[212:215], v[64:67], 0
v_exp_f32 v34, v34
v_mfma_f32_16x16x32_bf16 v[248:251], a[216:219], v[64:67], 0
v_fmamk_f32 v35, v35, 0x3e0293ee, v23
v_exp_f32 v35, v35
v_mfma_f32_16x16x32_bf16 v[252:255], a[220:223], v[64:67], 0
ds_read_b64_tr_b16 a[204:205], v83 offset:0
ds_read_b64_tr_b16 a[206:207], v83 offset:4096
v_cvt_pk_bf16_f32 v70, v32, v33
v_cvt_pk_bf16_f32 v71, v34, v35
v_mfma_f32_16x16x32_bf16 v[32:35], a[176:179], a[128:131], 0
buffer_load_dwordx4 v15, s[20:23], s30 offen offset:1024 nt lds
v_fmamk_f32 v36, v36, 0x3e0293ee, v24
v_mfma_f32_16x16x32_bf16 v[32:35], a[180:183], a[132:135], v[32:35]
s_add_u32 m0, s32, 114688
v_exp_f32 v36, v36
v_mfma_f32_16x16x32_bf16 v[32:35], a[184:187], a[136:139], v[32:35]
s_add_u32 s30, s29, 57344
v_fmamk_f32 v37, v37, 0x3e0293ee, v24
v_fmamk_f32 v38, v38, 0x3e0293ee, v24
v_mfma_f32_16x16x32_bf16 v[32:35], a[188:191], a[140:143], v[32:35]
s_waitcnt lgkmcnt(3)
v_exp_f32 v37, v37
v_mfma_f32_16x16x32_bf16 v[96:99], a[192:195], v[68:71], v[96:99]
v_exp_f32 v38, v38
v_mfma_f32_16x16x32_bf16 v[100:103], a[196:199], v[68:71], v[100:103]
s_waitcnt lgkmcnt(2)
v_fmamk_f32 v39, v39, 0x3e0293ee, v24
v_cvt_pk_bf16_f32 v74, v36, v37
v_mfma_f32_16x16x32_bf16 v[104:107], a[200:203], v[68:71], v[104:107]
s_waitcnt lgkmcnt(0)
v_exp_f32 v39, v39
v_mfma_f32_16x16x32_bf16 v[108:111], a[204:207], v[68:71], v[108:111]
v_cvt_pk_bf16_f32 v75, v38, v39
v_fmamk_f32 v40, v40, 0x3e0293ee, v25
v_mfma_f32_16x16x32_bf16 a[224:227], a[244:247], v[68:71], a[224:227]
v_exp_f32 v40, v40
v_mfma_f32_16x16x32_bf16 v[36:39], a[160:163], a[80:83], 0
v_fmamk_f32 v41, v41, 0x3e0293ee, v25
v_fmamk_f32 v42, v42, 0x3e0293ee, v25
v_mfma_f32_16x16x32_bf16 v[36:39], a[164:167], a[84:87], v[36:39]
v_exp_f32 v41, v41
v_mfma_f32_16x16x32_bf16 v[36:39], a[168:171], a[88:91], v[36:39]
v_exp_f32 v42, v42
v_mfma_f32_16x16x32_bf16 v[36:39], a[172:175], a[92:95], v[36:39]
v_fmamk_f32 v43, v43, 0x3e0293ee, v25
v_cvt_pk_bf16_f32 v78, v40, v41
v_mfma_f32_16x16x32_bf16 v[128:131], a[192:195], v[72:75], v[128:131]
v_exp_f32 v43, v43
v_mfma_f32_16x16x32_bf16 v[132:135], a[196:199], v[72:75], v[132:135]
buffer_load_dwordx4 v16, s[24:27], s31 offen nt lds
v_cvt_pk_bf16_f32 v79, v42, v43
v_mfma_f32_16x16x32_bf16 v[136:139], a[200:203], v[72:75], v[136:139]
v_fmamk_f32 v32, v32, 0x3e0293ee, v26
v_fmamk_f32 v33, v33, 0x3e0293ee, v26
v_mfma_f32_16x16x32_bf16 v[140:143], a[204:207], v[72:75], v[140:143]
v_exp_f32 v32, v32
v_mfma_f32_16x16x32_bf16 v[40:43], a[160:163], a[96:99], 0
v_exp_f32 v33, v33
v_mfma_f32_16x16x32_bf16 v[40:43], a[164:167], a[100:103], v[40:43]
v_fmamk_f32 v34, v34, 0x3e0293ee, v26
v_fmamk_f32 v35, v35, 0x3e0293ee, v26
v_mfma_f32_16x16x32_bf16 v[40:43], a[168:171], a[104:107], v[40:43]
v_exp_f32 v34, v34
v_mfma_f32_16x16x32_bf16 v[40:43], a[172:175], a[108:111], v[40:43]
v_exp_f32 v35, v35
v_mfma_f32_16x16x32_bf16 v[160:163], a[192:195], v[76:79], v[160:163]
v_cvt_pk_bf16_f32 v50, v32, v33
v_cvt_pk_bf16_f32 v51, v34, v35
v_mfma_f32_16x16x32_bf16 v[164:167], a[196:199], v[76:79], v[164:167]
v_xor_b32 v84, 0x2000, v10
v_xor_b32 v85, 0x2000, v11
v_mfma_f32_16x16x32_bf16 v[168:171], a[200:203], v[76:79], v[168:171]
ds_read_b64_tr_b16 a[208:209], v84 offset:0
v_xor_b32 v86, 0x2000, v12
v_mfma_f32_16x16x32_bf16 v[172:175], a[204:207], v[76:79], v[172:175]
ds_read_b64_tr_b16 a[210:211], v84 offset:4096
v_xor_b32 v87, 0x2000, v13
v_mfma_f32_16x16x32_bf16 a[228:231], a[244:247], v[72:75], a[228:231]
ds_read_b64_tr_b16 a[212:213], v85 offset:0
v_fmamk_f32 v36, v36, 0x3e0293ee, v23
v_mfma_f32_16x16x32_bf16 v[32:35], a[160:163], a[112:115], 0
ds_read_b64_tr_b16 a[214:215], v85 offset:4096
v_fmamk_f32 v37, v37, 0x3e0293ee, v23
v_mfma_f32_16x16x32_bf16 v[32:35], a[164:167], a[116:119], v[32:35]
v_exp_f32 v36, v36
v_mfma_f32_16x16x32_bf16 v[32:35], a[168:171], a[120:123], v[32:35]
v_exp_f32 v37, v37
v_mfma_f32_16x16x32_bf16 v[32:35], a[172:175], a[124:127], v[32:35]
ds_read_b64_tr_b16 a[216:217], v86 offset:0
v_fmamk_f32 v38, v38, 0x3e0293ee, v23
v_mfma_f32_16x16x32_bf16 v[192:195], a[192:195], v[48:51], v[192:195]
v_exp_f32 v38, v38
v_mfma_f32_16x16x32_bf16 v[196:199], a[196:199], v[48:51], v[196:199]
ds_read_b64_tr_b16 a[218:219], v86 offset:4096
v_fmamk_f32 v39, v39, 0x3e0293ee, v23
v_mfma_f32_16x16x32_bf16 v[200:203], a[200:203], v[48:51], v[200:203]
v_exp_f32 v39, v39
v_mfma_f32_16x16x32_bf16 v[204:207], a[204:207], v[48:51], v[204:207]
ds_read_b64_tr_b16 a[220:221], v87 offset:0
ds_read_b64_tr_b16 a[222:223], v87 offset:4096
v_cvt_pk_bf16_f32 v52, v36, v37
v_cvt_pk_bf16_f32 v53, v38, v39
v_mfma_f32_16x16x32_bf16 v[36:39], a[160:163], a[128:131], 0
buffer_load_dwordx4 v17, s[24:27], s31 offen offset:1024 nt lds
v_fmamk_f32 v40, v40, 0x3e0293ee, v24
v_mfma_f32_16x16x32_bf16 v[36:39], a[164:167], a[132:135], v[36:39]
s_add_u32 m0, s32, 57344
v_exp_f32 v40, v40
v_mfma_f32_16x16x32_bf16 v[36:39], a[168:171], a[136:139], v[36:39]
s_add_u32 s31, s29, 57344
ds_read_b128 a[176:179], v2 offset:20480
v_fmamk_f32 v41, v41, 0x3e0293ee, v24
v_mfma_f32_16x16x32_bf16 v[36:39], a[172:175], a[140:143], v[36:39]
s_waitcnt lgkmcnt(4)
v_exp_f32 v41, v41
v_mfma_f32_16x16x32_bf16 v[112:115], a[208:211], v[68:71], v[112:115]
ds_read_b128 a[180:183], v3 offset:20480
v_fmamk_f32 v42, v42, 0x3e0293ee, v24
v_mfma_f32_16x16x32_bf16 v[116:119], a[212:215], v[68:71], v[116:119]
s_waitcnt lgkmcnt(4)
v_exp_f32 v42, v42
v_mfma_f32_16x16x32_bf16 v[120:123], a[216:219], v[68:71], v[120:123]
s_waitcnt lgkmcnt(2)
ds_read_b128 a[184:187], v4 offset:20480
v_fmamk_f32 v43, v43, 0x3e0293ee, v24
v_mfma_f32_16x16x32_bf16 v[124:127], a[220:223], v[68:71], v[124:127]
v_exp_f32 v43, v43
v_mfma_f32_16x16x32_bf16 a[232:235], a[244:247], v[76:79], a[232:235]
v_cvt_pk_bf16_f32 v56, v40, v41
v_cvt_pk_bf16_f32 v57, v42, v43
v_mfma_f32_16x16x32_bf16 v[40:43], a[160:163], a[144:147], 0
ds_read_b128 a[188:191], v5 offset:20480
v_fmamk_f32 v32, v32, 0x3e0293ee, v25
v_mfma_f32_16x16x32_bf16 v[40:43], a[164:167], a[148:151], v[40:43]
v_exp_f32 v32, v32
v_mfma_f32_16x16x32_bf16 v[40:43], a[168:171], a[152:155], v[40:43]
v_fmamk_f32 v33, v33, 0x3e0293ee, v25
v_fmamk_f32 v34, v34, 0x3e0293ee, v25
v_mfma_f32_16x16x32_bf16 v[40:43], a[172:175], a[156:159], v[40:43]
v_exp_f32 v33, v33
v_mfma_f32_16x16x32_bf16 v[144:147], a[208:211], v[72:75], v[144:147]
v_exp_f32 v34, v34
v_mfma_f32_16x16x32_bf16 v[148:151], a[212:215], v[72:75], v[148:151]
v_fmamk_f32 v35, v35, 0x3e0293ee, v25
v_cvt_pk_bf16_f32 v60, v32, v33
v_mfma_f32_16x16x32_bf16 v[152:155], a[216:219], v[72:75], v[152:155]
v_exp_f32 v35, v35
v_mfma_f32_16x16x32_bf16 v[156:159], a[220:223], v[72:75], v[156:159]
s_waitcnt lgkmcnt(1)
v_cvt_pk_bf16_f32 v61, v34, v35
v_fmamk_f32 v36, v36, 0x3e0293ee, v26
v_mfma_f32_16x16x32_bf16 v[32:35], a[176:179], a[80:83], 0
v_exp_f32 v36, v36
v_mfma_f32_16x16x32_bf16 v[32:35], a[180:183], a[84:87], v[32:35]
ds_read_b64_tr_b16 a[192:193], v6 offset:16384
v_fmamk_f32 v37, v37, 0x3e0293ee, v26
v_mfma_f32_16x16x32_bf16 v[32:35], a[184:187], a[88:91], v[32:35]
s_waitcnt lgkmcnt(1)
v_exp_f32 v37, v37
v_mfma_f32_16x16x32_bf16 v[32:35], a[188:191], a[92:95], v[32:35]
ds_read_b64_tr_b16 a[194:195], v6 offset:20480
v_fmamk_f32 v38, v38, 0x3e0293ee, v26
v_mfma_f32_16x16x32_bf16 v[176:179], a[208:211], v[76:79], v[176:179]
v_exp_f32 v38, v38
v_mfma_f32_16x16x32_bf16 v[180:183], a[212:215], v[76:79], v[180:183]
ds_read_b64_tr_b16 a[196:197], v7 offset:16384
v_fmamk_f32 v39, v39, 0x3e0293ee, v26
v_mfma_f32_16x16x32_bf16 v[184:187], a[216:219], v[76:79], v[184:187]
v_exp_f32 v39, v39
v_mfma_f32_16x16x32_bf16 v[188:191], a[220:223], v[76:79], v[188:191]
ds_read_b64_tr_b16 a[198:199], v7 offset:20480
v_cvt_pk_bf16_f32 v64, v36, v37
v_mfma_f32_16x16x32_bf16 a[236:239], a[244:247], v[48:51], a[236:239]
v_cvt_pk_bf16_f32 v65, v38, v39
v_fmamk_f32 v40, v40, 0x3e0293ee, v27
v_mfma_f32_16x16x32_bf16 v[36:39], a[176:179], a[96:99], 0
v_exp_f32 v40, v40
v_mfma_f32_16x16x32_bf16 v[36:39], a[180:183], a[100:103], v[36:39]
ds_read_b64_tr_b16 a[200:201], v8 offset:16384
v_fmamk_f32 v41, v41, 0x3e0293ee, v27
v_mfma_f32_16x16x32_bf16 v[36:39], a[184:187], a[104:107], v[36:39]
L_pad0_8:
s_cbranch_execz L_pad0_12
v_exp_f32 v41, v41
v_mfma_f32_16x16x32_bf16 v[36:39], a[188:191], a[108:111], v[36:39]
ds_read_b64_tr_b16 a[202:203], v8 offset:20480
v_fmamk_f32 v42, v42, 0x3e0293ee, v27
v_mfma_f32_16x16x32_bf16 v[208:211], a[208:211], v[48:51], v[208:211]
v_exp_f32 v42, v42
v_mfma_f32_16x16x32_bf16 v[212:215], a[212:215], v[48:51], v[212:215]
ds_read_b64_tr_b16 a[204:205], v9 offset:16384
v_fmamk_f32 v43, v43, 0x3e0293ee, v27
v_mfma_f32_16x16x32_bf16 v[216:219], a[216:219], v[48:51], v[216:219]
v_exp_f32 v43, v43
v_mfma_f32_16x16x32_bf16 v[220:223], a[220:223], v[48:51], v[220:223]
v_cvt_pk_bf16_f32 v68, v40, v41
v_cvt_pk_bf16_f32 v69, v42, v43
v_mfma_f32_16x16x32_bf16 v[40:43], a[176:179], a[112:115], 0
ds_read_b64_tr_b16 a[206:207], v9 offset:20480
v_add_u32 v28, s38, v19
v_mfma_f32_16x16x32_bf16 v[40:43], a[180:183], a[116:119], v[40:43]
s_add_u32 s38, s63, 4096
ds_read_b128 a[160:163], v44 offset:16384
v_fmamk_f32 v32, v32, 0x3e0293ee, v23
v_mfma_f32_16x16x32_bf16 v[40:43], a[184:187], a[120:123], v[40:43]
v_exp_f32 v32, v32
v_fmamk_f32 v33, v33, 0x3e0293ee, v23
v_fmamk_f32 v34, v34, 0x3e0293ee, v23
v_fmamk_f32 v35, v35, 0x3e0293ee, v23
v_exp_f32 v33, v33
v_exp_f32 v34, v34
v_exp_f32 v35, v35
v_mfma_f32_16x16x32_bf16 v[40:43], a[188:191], a[124:127], v[40:43]
buffer_store_dwordx4 a[0:3], v28, s[12:15], 0 offen offset:0 sc0 sc1 nt
buffer_load_dwordx4 v14, s[20:23], s30 offen nt lds
buffer_load_dwordx4 v15, s[20:23], s30 offen offset:1024 nt lds
v_cvt_pk_bf16_f32 v54, v32, v33
v_cvt_pk_bf16_f32 v55, v34, v35
v_mfma_f32_16x16x32_bf16 v[32:35], a[176:179], a[128:131], 0
s_add_u32 m0, s32, 122880
ds_read_b128 a[164:167], v45 offset:16384
v_fmamk_f32 v36, v36, 0x3e0293ee, v24
v_mfma_f32_16x16x32_bf16 v[32:35], a[180:183], a[132:135], v[32:35]
s_add_u32 s30, s29, 65536
v_exp_f32 v36, v36
v_mfma_f32_16x16x32_bf16 v[32:35], a[184:187], a[136:139], v[32:35]
ds_read_b128 a[168:171], v46 offset:16384
v_fmamk_f32 v37, v37, 0x3e0293ee, v24
v_mfma_f32_16x16x32_bf16 v[32:35], a[188:191], a[140:143], v[32:35]
s_waitcnt lgkmcnt(4)
v_exp_f32 v37, v37
v_mfma_f32_16x16x32_bf16 v[96:99], a[192:195], v[52:55], v[96:99]
ds_read_b128 a[172:175], v47 offset:16384
v_fmamk_f32 v38, v38, 0x3e0293ee, v24
v_mfma_f32_16x16x32_bf16 v[100:103], a[196:199], v[52:55], v[100:103]
v_exp_f32 v38, v38
v_mfma_f32_16x16x32_bf16 v[104:107], a[200:203], v[52:55], v[104:107]
s_waitcnt lgkmcnt(3)
v_fmamk_f32 v39, v39, 0x3e0293ee, v24
v_cvt_pk_bf16_f32 v58, v36, v37
v_mfma_f32_16x16x32_bf16 v[108:111], a[204:207], v[52:55], v[108:111]
v_exp_f32 v39, v39
v_mfma_f32_16x16x32_bf16 a[224:227], a[244:247], v[52:55], a[224:227]
v_cvt_pk_bf16_f32 v59, v38, v39
v_fmamk_f32 v40, v40, 0x3e0293ee, v25
v_mfma_f32_16x16x32_bf16 v[36:39], a[176:179], a[144:147], 0
v_exp_f32 v40, v40
v_mfma_f32_16x16x32_bf16 v[36:39], a[180:183], a[148:151], v[36:39]
v_fmamk_f32 v41, v41, 0x3e0293ee, v25
v_fmamk_f32 v42, v42, 0x3e0293ee, v25
v_mfma_f32_16x16x32_bf16 v[36:39], a[184:187], a[152:155], v[36:39]
v_exp_f32 v41, v41
v_mfma_f32_16x16x32_bf16 v[36:39], a[188:191], a[156:159], v[36:39]
v_exp_f32 v42, v42
v_mfma_f32_16x16x32_bf16 v[128:131], a[192:195], v[56:59], v[128:131]
v_fmamk_f32 v43, v43, 0x3e0293ee, v25
v_cvt_pk_bf16_f32 v62, v40, v41
v_mfma_f32_16x16x32_bf16 v[132:135], a[196:199], v[56:59], v[132:135]
v_exp_f32 v43, v43
v_mfma_f32_16x16x32_bf16 v[136:139], a[200:203], v[56:59], v[136:139]
ds_read_b64_tr_b16 a[208:209], v10 offset:16384
v_cvt_pk_bf16_f32 v63, v42, v43
v_mfma_f32_16x16x32_bf16 v[140:143], a[204:207], v[56:59], v[140:143]
ds_read_b64_tr_b16 a[210:211], v10 offset:20480
v_fmamk_f32 v32, v32, 0x3e0293ee, v26
v_mfma_f32_16x16x32_bf16 v[40:43], a[160:163], a[80:83], 0
s_waitcnt lgkmcnt(2)
v_exp_f32 v32, v32
v_mfma_f32_16x16x32_bf16 v[40:43], a[164:167], a[84:87], v[40:43]
ds_read_b64_tr_b16 a[212:213], v11 offset:16384
v_fmamk_f32 v33, v33, 0x3e0293ee, v26
v_mfma_f32_16x16x32_bf16 v[40:43], a[168:171], a[88:91], v[40:43]
v_exp_f32 v33, v33
v_mfma_f32_16x16x32_bf16 v[40:43], a[172:175], a[92:95], v[40:43]
ds_read_b64_tr_b16 a[214:215], v11 offset:20480
v_fmamk_f32 v34, v34, 0x3e0293ee, v26
v_mfma_f32_16x16x32_bf16 v[160:163], a[192:195], v[60:63], v[160:163]
v_exp_f32 v34, v34
v_mfma_f32_16x16x32_bf16 v[164:167], a[196:199], v[60:63], v[164:167]
ds_read_b64_tr_b16 a[216:217], v12 offset:16384
v_fmamk_f32 v35, v35, 0x3e0293ee, v26
v_mfma_f32_16x16x32_bf16 v[168:171], a[200:203], v[60:63], v[168:171]
v_exp_f32 v35, v35
v_mfma_f32_16x16x32_bf16 v[172:175], a[204:207], v[60:63], v[172:175]
ds_read_b64_tr_b16 a[218:219], v12 offset:20480
v_cvt_pk_bf16_f32 v66, v32, v33
v_mfma_f32_16x16x32_bf16 a[228:231], a[244:247], v[56:59], a[228:231]
v_cvt_pk_bf16_f32 v67, v34, v35
v_fmamk_f32 v36, v36, 0x3e0293ee, v27
v_mfma_f32_16x16x32_bf16 v[32:35], a[160:163], a[96:99], 0
ds_read_b64_tr_b16 a[220:221], v13 offset:16384
v_fmamk_f32 v37, v37, 0x3e0293ee, v27
v_mfma_f32_16x16x32_bf16 v[32:35], a[164:167], a[100:103], v[32:35]
ds_read_b64_tr_b16 a[222:223], v13 offset:20480
v_fmamk_f32 v38, v38, 0x3e0293ee, v27
v_mfma_f32_16x16x32_bf16 v[32:35], a[168:171], a[104:107], v[32:35]
ds_read_b128 a[176:179], v44 offset:20480
v_fmamk_f32 v39, v39, 0x3e0293ee, v27
v_mfma_f32_16x16x32_bf16 v[32:35], a[172:175], a[108:111], v[32:35]
buffer_store_dwordx4 a[4:7], v28, s[12:15], 0 offen offset:2048 sc0 sc1 nt
buffer_load_dwordx4 v16, s[24:27], s31 offen nt lds
buffer_load_dwordx4 v17, s[24:27], s31 offen offset:1024 nt lds
v_mfma_f32_16x16x32_bf16 v[192:195], a[192:195], v[64:67], v[192:195]
s_add_u32 m0, s32, 0
v_exp_f32 v36, v36
v_mfma_f32_16x16x32_bf16 v[196:199], a[196:199], v[64:67], v[196:199]
s_add_u32 s31, s29, 65536
v_exp_f32 v37, v37
v_mfma_f32_16x16x32_bf16 v[200:203], a[200:203], v[64:67], v[200:203]
v_exp_f32 v38, v38
v_exp_f32 v39, v39
v_mfma_f32_16x16x32_bf16 v[204:207], a[204:207], v[64:67], v[204:207]
v_cvt_pk_bf16_f32 v70, v36, v37
v_cvt_pk_bf16_f32 v71, v38, v39
v_mfma_f32_16x16x32_bf16 v[36:39], a[160:163], a[112:115], 0
ds_read_b128 a[180:183], v45 offset:20480
v_fmamk_f32 v40, v40, 0x3e0293ee, v23
v_mfma_f32_16x16x32_bf16 v[36:39], a[164:167], a[116:119], v[36:39]
v_exp_f32 v40, v40
v_mfma_f32_16x16x32_bf16 v[36:39], a[168:171], a[120:123], v[36:39]
ds_read_b128 a[184:187], v46 offset:20480
v_fmamk_f32 v41, v41, 0x3e0293ee, v23
v_mfma_f32_16x16x32_bf16 v[36:39], a[172:175], a[124:127], v[36:39]
v_exp_f32 v41, v41
v_mfma_f32_16x16x32_bf16 v[224:227], a[192:195], v[68:71], v[224:227]
ds_read_b128 a[188:191], v47 offset:20480
v_fmamk_f32 v42, v42, 0x3e0293ee, v23
v_mfma_f32_16x16x32_bf16 v[228:231], a[196:199], v[68:71], v[228:231]
v_exp_f32 v42, v42
v_mfma_f32_16x16x32_bf16 v[232:235], a[200:203], v[68:71], v[232:235]
v_fmamk_f32 v43, v43, 0x3e0293ee, v23
v_cvt_pk_bf16_f32 v72, v40, v41
v_mfma_f32_16x16x32_bf16 v[236:239], a[204:207], v[68:71], v[236:239]
v_exp_f32 v43, v43
v_mfma_f32_16x16x32_bf16 a[232:235], a[244:247], v[60:63], a[232:235]
s_waitcnt lgkmcnt(2)
v_cvt_pk_bf16_f32 v73, v42, v43
v_fmamk_f32 v32, v32, 0x3e0293ee, v24
v_mfma_f32_16x16x32_bf16 v[112:115], a[208:211], v[52:55], v[112:115]
v_exp_f32 v32, v32
v_mfma_f32_16x16x32_bf16 v[116:119], a[212:215], v[52:55], v[116:119]
v_fmamk_f32 v33, v33, 0x3e0293ee, v24
v_fmamk_f32 v34, v34, 0x3e0293ee, v24
v_mfma_f32_16x16x32_bf16 v[120:123], a[216:219], v[52:55], v[120:123]
v_exp_f32 v33, v33
v_mfma_f32_16x16x32_bf16 v[124:127], a[220:223], v[52:55], v[124:127]
v_exp_f32 v34, v34
v_mfma_f32_16x16x32_bf16 v[40:43], a[160:163], a[128:131], 0
v_fmamk_f32 v35, v35, 0x3e0293ee, v24
v_cvt_pk_bf16_f32 v76, v32, v33
v_mfma_f32_16x16x32_bf16 v[40:43], a[164:167], a[132:135], v[40:43]
v_exp_f32 v35, v35
v_mfma_f32_16x16x32_bf16 v[40:43], a[168:171], a[136:139], v[40:43]
v_cvt_pk_bf16_f32 v77, v34, v35
v_fmamk_f32 v36, v36, 0x3e0293ee, v25
v_mfma_f32_16x16x32_bf16 v[40:43], a[172:175], a[140:143], v[40:43]
v_exp_f32 v36, v36
v_mfma_f32_16x16x32_bf16 v[144:147], a[208:211], v[56:59], v[144:147]
v_fmamk_f32 v37, v37, 0x3e0293ee, v25
v_fmamk_f32 v38, v38, 0x3e0293ee, v25
v_mfma_f32_16x16x32_bf16 v[148:151], a[212:215], v[56:59], v[148:151]
v_exp_f32 v37, v37
v_mfma_f32_16x16x32_bf16 v[152:155], a[216:219], v[56:59], v[152:155]
v_exp_f32 v38, v38
v_mfma_f32_16x16x32_bf16 v[156:159], a[220:223], v[56:59], v[156:159]
v_fmamk_f32 v39, v39, 0x3e0293ee, v25
v_cvt_pk_bf16_f32 v48, v36, v37
v_mfma_f32_16x16x32_bf16 a[236:239], a[244:247], v[64:67], a[236:239]
s_waitcnt vmcnt(8) lgkmcnt(0)
v_exp_f32 v39, v39
v_mfma_f32_16x16x32_bf16 v[32:35], a[176:179], a[80:83], 0
s_barrier
ds_read_b64_tr_b16 a[192:193], v80 offset:16384
v_cvt_pk_bf16_f32 v49, v38, v39
v_mfma_f32_16x16x32_bf16 v[32:35], a[180:183], a[84:87], v[32:35]
ds_read_b64_tr_b16 a[194:195], v80 offset:20480
v_fmamk_f32 v40, v40, 0x3e0293ee, v26
v_mfma_f32_16x16x32_bf16 v[32:35], a[184:187], a[88:91], v[32:35]
v_exp_f32 v40, v40
v_mfma_f32_16x16x32_bf16 v[32:35], a[188:191], a[92:95], v[32:35]
ds_read_b64_tr_b16 a[196:197], v81 offset:16384
v_fmamk_f32 v41, v41, 0x3e0293ee, v26
v_mfma_f32_16x16x32_bf16 v[176:179], a[208:211], v[60:63], v[176:179]
ds_read_b64_tr_b16 a[198:199], v81 offset:20480
v_fmamk_f32 v42, v42, 0x3e0293ee, v26
v_mfma_f32_16x16x32_bf16 v[180:183], a[212:215], v[60:63], v[180:183]
ds_read_b64_tr_b16 a[200:201], v82 offset:16384
v_fmamk_f32 v43, v43, 0x3e0293ee, v26
v_mfma_f32_16x16x32_bf16 v[184:187], a[216:219], v[60:63], v[184:187]
buffer_store_dwordx4 a[8:11], v28, s[12:15], 0 offen offset:128 sc0 sc1 nt
buffer_load_dwordx4 v14, s[20:23], s30 offen nt lds
buffer_load_dwordx4 v15, s[20:23], s30 offen offset:1024 nt lds
v_mfma_f32_16x16x32_bf16 v[188:191], a[220:223], v[60:63], v[188:191]
s_add_u32 m0, s32, 65536
v_exp_f32 v41, v41
v_mfma_f32_16x16x32_bf16 v[36:39], a[176:179], a[96:99], 0
s_add_u32 s30, s29, 73728
v_exp_f32 v42, v42
v_mfma_f32_16x16x32_bf16 v[36:39], a[180:183], a[100:103], v[36:39]
v_exp_f32 v43, v43
v_mfma_f32_16x16x32_bf16 v[36:39], a[184:187], a[104:107], v[36:39]
ds_read_b64_tr_b16 a[202:203], v82 offset:20480
v_cvt_pk_bf16_f32 v52, v40, v41
v_mfma_f32_16x16x32_bf16 v[36:39], a[188:191], a[108:111], v[36:39]
ds_read_b64_tr_b16 a[204:205], v83 offset:16384
v_cvt_pk_bf16_f32 v53, v42, v43
v_mfma_f32_16x16x32_bf16 v[208:211], a[208:211], v[64:67], v[208:211]
ds_read_b64_tr_b16 a[206:207], v83 offset:20480
v_fmamk_f32 v32, v32, 0x3e0293ee, v23
v_mfma_f32_16x16x32_bf16 v[212:215], a[212:215], v[64:67], v[212:215]
v_exp_f32 v32, v32
v_mfma_f32_16x16x32_bf16 v[216:219], a[216:219], v[64:67], v[216:219]
ds_read_b128 a[160:163], v2 offset:32768
v_fmamk_f32 v33, v33, 0x3e0293ee, v23
v_mfma_f32_16x16x32_bf16 v[220:223], a[220:223], v[64:67], v[220:223]
v_exp_f32 v33, v33
v_mfma_f32_16x16x32_bf16 a[240:243], a[244:247], v[68:71], a[240:243]
ds_read_b128 a[164:167], v3 offset:32768
v_fmamk_f32 v34, v34, 0x3e0293ee, v23
v_mfma_f32_16x16x32_bf16 v[40:43], a[176:179], a[112:115], 0
v_exp_f32 v34, v34
v_mfma_f32_16x16x32_bf16 v[40:43], a[180:183], a[116:119], v[40:43]
ds_read_b128 a[168:171], v4 offset:32768
v_fmamk_f32 v35, v35, 0x3e0293ee, v23
v_mfma_f32_16x16x32_bf16 v[40:43], a[184:187], a[120:123], v[40:43]
v_exp_f32 v35, v35
v_mfma_f32_16x16x32_bf16 v[40:43], a[188:191], a[124:127], v[40:43]
ds_read_b128 a[172:175], v5 offset:32768
v_cvt_pk_bf16_f32 v74, v32, v33
v_mfma_f32_16x16x32_bf16 v[240:243], a[208:211], v[68:71], v[240:243]
v_cvt_pk_bf16_f32 v75, v34, v35
v_fmamk_f32 v36, v36, 0x3e0293ee, v24
v_mfma_f32_16x16x32_bf16 v[244:247], a[212:215], v[68:71], v[244:247]
v_exp_f32 v36, v36
v_mfma_f32_16x16x32_bf16 v[248:251], a[216:219], v[68:71], v[248:251]
v_fmamk_f32 v37, v37, 0x3e0293ee, v24
v_fmamk_f32 v38, v38, 0x3e0293ee, v24
v_mfma_f32_16x16x32_bf16 v[252:255], a[220:223], v[68:71], v[252:255]
v_exp_f32 v37, v37
v_mfma_f32_16x16x32_bf16 v[32:35], a[176:179], a[128:131], 0
v_exp_f32 v38, v38
v_mfma_f32_16x16x32_bf16 v[32:35], a[180:183], a[132:135], v[32:35]
v_fmamk_f32 v39, v39, 0x3e0293ee, v24
v_cvt_pk_bf16_f32 v78, v36, v37
v_mfma_f32_16x16x32_bf16 v[32:35], a[184:187], a[136:139], v[32:35]
v_exp_f32 v39, v39
v_mfma_f32_16x16x32_bf16 v[32:35], a[188:191], a[140:143], v[32:35]
s_waitcnt lgkmcnt(0)
v_cvt_pk_bf16_f32 v79, v38, v39
v_fmamk_f32 v40, v40, 0x3e0293ee, v25
v_mfma_f32_16x16x32_bf16 v[96:99], a[192:195], v[72:75], v[96:99]
v_exp_f32 v40, v40
v_mfma_f32_16x16x32_bf16 v[100:103], a[196:199], v[72:75], v[100:103]
v_fmamk_f32 v41, v41, 0x3e0293ee, v25
v_fmamk_f32 v42, v42, 0x3e0293ee, v25
v_mfma_f32_16x16x32_bf16 v[104:107], a[200:203], v[72:75], v[104:107]
v_exp_f32 v41, v41
v_mfma_f32_16x16x32_bf16 v[108:111], a[204:207], v[72:75], v[108:111]
v_exp_f32 v42, v42
v_mfma_f32_16x16x32_bf16 a[224:227], a[244:247], v[72:75], a[224:227]
v_fmamk_f32 v43, v43, 0x3e0293ee, v25
v_cvt_pk_bf16_f32 v50, v40, v41
v_mfma_f32_16x16x32_bf16 v[36:39], a[160:163], a[80:83], 0
v_exp_f32 v43, v43
v_mfma_f32_16x16x32_bf16 v[36:39], a[164:167], a[84:87], v[36:39]
ds_read_b64_tr_b16 a[208:209], v84 offset:16384
v_cvt_pk_bf16_f32 v51, v42, v43
v_mfma_f32_16x16x32_bf16 v[36:39], a[168:171], a[88:91], v[36:39]
ds_read_b64_tr_b16 a[210:211], v84 offset:20480
v_fmamk_f32 v32, v32, 0x3e0293ee, v26
v_mfma_f32_16x16x32_bf16 v[36:39], a[172:175], a[92:95], v[36:39]
v_exp_f32 v32, v32
v_mfma_f32_16x16x32_bf16 v[128:131], a[192:195], v[76:79], v[128:131]
ds_read_b64_tr_b16 a[212:213], v85 offset:16384
v_fmamk_f32 v33, v33, 0x3e0293ee, v26
v_mfma_f32_16x16x32_bf16 v[132:135], a[196:199], v[76:79], v[132:135]
ds_read_b64_tr_b16 a[214:215], v85 offset:20480
v_fmamk_f32 v34, v34, 0x3e0293ee, v26
v_mfma_f32_16x16x32_bf16 v[136:139], a[200:203], v[76:79], v[136:139]
ds_read_b64_tr_b16 a[216:217], v86 offset:16384
v_fmamk_f32 v35, v35, 0x3e0293ee, v26
v_mfma_f32_16x16x32_bf16 v[140:143], a[204:207], v[76:79], v[140:143]
buffer_store_dwordx4 a[12:15], v28, s[12:15], 0 offen offset:2176 sc0 sc1 nt
buffer_load_dwordx4 v16, s[24:27], s31 offen nt lds
buffer_load_dwordx4 v17, s[24:27], s31 offen offset:1024 nt lds
v_mfma_f32_16x16x32_bf16 v[40:43], a[160:163], a[96:99], 0
s_add_u32 m0, s32, 8192
v_exp_f32 v33, v33
v_mfma_f32_16x16x32_bf16 v[40:43], a[164:167], a[100:103], v[40:43]
s_add_u32 s31, s29, 73728
v_exp_f32 v34, v34
v_mfma_f32_16x16x32_bf16 v[40:43], a[168:171], a[104:107], v[40:43]
v_exp_f32 v35, v35
v_mfma_f32_16x16x32_bf16 v[40:43], a[172:175], a[108:111], v[40:43]
ds_read_b64_tr_b16 a[218:219], v86 offset:20480
v_cvt_pk_bf16_f32 v54, v32, v33
v_mfma_f32_16x16x32_bf16 v[160:163], a[192:195], v[48:51], v[160:163]
ds_read_b64_tr_b16 a[220:221], v87 offset:16384
v_cvt_pk_bf16_f32 v55, v34, v35
v_mfma_f32_16x16x32_bf16 v[164:167], a[196:199], v[48:51], v[164:167]
ds_read_b64_tr_b16 a[222:223], v87 offset:20480
v_fmamk_f32 v36, v36, 0x3e0293ee, v23
v_mfma_f32_16x16x32_bf16 v[168:171], a[200:203], v[48:51], v[168:171]
v_exp_f32 v36, v36
v_mfma_f32_16x16x32_bf16 v[172:175], a[204:207], v[48:51], v[172:175]
ds_read_b128 a[176:179], v2 offset:36864
v_fmamk_f32 v37, v37, 0x3e0293ee, v23
v_mfma_f32_16x16x32_bf16 a[228:231], a[244:247], v[76:79], a[228:231]
v_exp_f32 v37, v37
v_mfma_f32_16x16x32_bf16 v[32:35], a[160:163], a[112:115], 0
ds_read_b128 a[180:183], v3 offset:36864
v_fmamk_f32 v38, v38, 0x3e0293ee, v23
v_mfma_f32_16x16x32_bf16 v[32:35], a[164:167], a[116:119], v[32:35]
v_exp_f32 v38, v38
v_mfma_f32_16x16x32_bf16 v[32:35], a[168:171], a[120:123], v[32:35]
ds_read_b128 a[184:187], v4 offset:36864
v_fmamk_f32 v39, v39, 0x3e0293ee, v23
v_mfma_f32_16x16x32_bf16 v[32:35], a[172:175], a[124:127], v[32:35]
v_exp_f32 v39, v39
v_mfma_f32_16x16x32_bf16 v[192:195], a[192:195], v[52:55], v[192:195]
v_cvt_pk_bf16_f32 v56, v36, v37
v_cvt_pk_bf16_f32 v57, v38, v39
v_mfma_f32_16x16x32_bf16 v[196:199], a[196:199], v[52:55], v[196:199]
ds_read_b128 a[188:191], v5 offset:36864
v_fmamk_f32 v40, v40, 0x3e0293ee, v24
v_mfma_f32_16x16x32_bf16 v[200:203], a[200:203], v[52:55], v[200:203]
v_exp_f32 v40, v40
v_mfma_f32_16x16x32_bf16 v[204:207], a[204:207], v[52:55], v[204:207]
v_fmamk_f32 v41, v41, 0x3e0293ee, v24
v_fmamk_f32 v42, v42, 0x3e0293ee, v24
v_mfma_f32_16x16x32_bf16 v[36:39], a[160:163], a[128:131], 0
v_exp_f32 v41, v41
v_mfma_f32_16x16x32_bf16 v[36:39], a[164:167], a[132:135], v[36:39]
v_exp_f32 v42, v42
v_mfma_f32_16x16x32_bf16 v[36:39], a[168:171], a[136:139], v[36:39]
v_fmamk_f32 v43, v43, 0x3e0293ee, v24
v_cvt_pk_bf16_f32 v60, v40, v41
v_mfma_f32_16x16x32_bf16 v[36:39], a[172:175], a[140:143], v[36:39]
s_waitcnt lgkmcnt(1)
v_exp_f32 v43, v43
v_mfma_f32_16x16x32_bf16 v[112:115], a[208:211], v[72:75], v[112:115]
v_cvt_pk_bf16_f32 v61, v42, v43
v_fmamk_f32 v32, v32, 0x3e0293ee, v25
v_mfma_f32_16x16x32_bf16 v[116:119], a[212:215], v[72:75], v[116:119]
v_exp_f32 v32, v32
v_mfma_f32_16x16x32_bf16 v[120:123], a[216:219], v[72:75], v[120:123]
v_fmamk_f32 v33, v33, 0x3e0293ee, v25
v_fmamk_f32 v34, v34, 0x3e0293ee, v25
v_mfma_f32_16x16x32_bf16 v[124:127], a[220:223], v[72:75], v[124:127]
v_exp_f32 v33, v33
v_mfma_f32_16x16x32_bf16 a[232:235], a[244:247], v[48:51], a[232:235]
v_exp_f32 v34, v34
v_mfma_f32_16x16x32_bf16 v[40:43], a[160:163], a[144:147], 0
v_fmamk_f32 v35, v35, 0x3e0293ee, v25
v_cvt_pk_bf16_f32 v64, v32, v33
v_mfma_f32_16x16x32_bf16 v[40:43], a[164:167], a[148:151], v[40:43]
v_exp_f32 v35, v35
v_mfma_f32_16x16x32_bf16 v[40:43], a[168:171], a[152:155], v[40:43]
ds_read_b64_tr_b16 a[192:193], v6 offset:32768
v_cvt_pk_bf16_f32 v65, v34, v35
v_mfma_f32_16x16x32_bf16 v[40:43], a[172:175], a[156:159], v[40:43]
ds_read_b64_tr_b16 a[194:195], v6 offset:36864
v_fmamk_f32 v36, v36, 0x3e0293ee, v26
v_mfma_f32_16x16x32_bf16 v[144:147], a[208:211], v[76:79], v[144:147]
v_exp_f32 v36, v36
v_mfma_f32_16x16x32_bf16 v[148:151], a[212:215], v[76:79], v[148:151]
ds_read_b64_tr_b16 a[196:197], v7 offset:32768
v_fmamk_f32 v37, v37, 0x3e0293ee, v26
v_mfma_f32_16x16x32_bf16 v[152:155], a[216:219], v[76:79], v[152:155]
v_exp_f32 v37, v37
v_mfma_f32_16x16x32_bf16 v[156:159], a[220:223], v[76:79], v[156:159]
ds_read_b64_tr_b16 a[198:199], v7 offset:36864
v_fmamk_f32 v38, v38, 0x3e0293ee, v26
v_mfma_f32_16x16x32_bf16 v[32:35], a[176:179], a[80:83], 0
v_exp_f32 v38, v38
v_mfma_f32_16x16x32_bf16 v[32:35], a[180:183], a[84:87], v[32:35]
ds_read_b64_tr_b16 a[200:201], v8 offset:32768
v_fmamk_f32 v39, v39, 0x3e0293ee, v26
v_mfma_f32_16x16x32_bf16 v[32:35], a[184:187], a[88:91], v[32:35]
s_waitcnt lgkmcnt(4)
v_exp_f32 v39, v39
v_mfma_f32_16x16x32_bf16 v[32:35], a[188:191], a[92:95], v[32:35]
ds_read_b64_tr_b16 a[202:203], v8 offset:36864
v_cvt_pk_bf16_f32 v68, v36, v37
v_mfma_f32_16x16x32_bf16 v[176:179], a[208:211], v[48:51], v[176:179]
ds_read_b64_tr_b16 a[204:205], v9 offset:32768
v_cvt_pk_bf16_f32 v69, v38, v39
v_mfma_f32_16x16x32_bf16 v[180:183], a[212:215], v[48:51], v[180:183]
ds_read_b64_tr_b16 a[206:207], v9 offset:36864
v_fmamk_f32 v40, v40, 0x3e0293ee, v27
v_mfma_f32_16x16x32_bf16 v[184:187], a[216:219], v[48:51], v[184:187]
v_exp_f32 v40, v40
v_mfma_f32_16x16x32_bf16 v[188:191], a[220:223], v[48:51], v[188:191]
v_fmamk_f32 v41, v41, 0x3e0293ee, v27
v_fmamk_f32 v42, v42, 0x3e0293ee, v27
v_mfma_f32_16x16x32_bf16 a[236:239], a[244:247], v[52:55], a[236:239]
v_exp_f32 v41, v41
v_mfma_f32_16x16x32_bf16 v[36:39], a[176:179], a[96:99], 0
v_exp_f32 v42, v42
v_mfma_f32_16x16x32_bf16 v[36:39], a[180:183], a[100:103], v[36:39]
v_fmamk_f32 v43, v43, 0x3e0293ee, v27
v_cvt_pk_bf16_f32 v72, v40, v41
v_mfma_f32_16x16x32_bf16 v[36:39], a[184:187], a[104:107], v[36:39]
v_exp_f32 v43, v43
v_mfma_f32_16x16x32_bf16 v[36:39], a[188:191], a[108:111], v[36:39]
ds_read_b128 a[160:163], v44 offset:32768
v_cvt_pk_bf16_f32 v73, v42, v43
v_mfma_f32_16x16x32_bf16 v[208:211], a[208:211], v[52:55], v[208:211]
ds_read_b128 a[164:167], v45 offset:32768
v_add_u32 v28, s38, v19
v_mfma_f32_16x16x32_bf16 v[212:215], a[212:215], v[52:55], v[212:215]
s_add_u32 s38, s63, 8192
v_fmamk_f32 v32, v32, 0x3e0293ee, v23
v_fmamk_f32 v33, v33, 0x3e0293ee, v23
v_mfma_f32_16x16x32_bf16 v[216:219], a[216:219], v[52:55], v[216:219]
v_fmamk_f32 v34, v34, 0x3e0293ee, v23
v_fmamk_f32 v35, v35, 0x3e0293ee, v23
v_mfma_f32_16x16x32_bf16 v[220:223], a[220:223], v[52:55], v[220:223]
buffer_store_dwordx4 a[16:19], v28, s[12:15], 0 offen offset:0 sc0 sc1 nt
buffer_load_dwordx4 v14, s[20:23], s30 offen nt lds
buffer_load_dwordx4 v15, s[20:23], s30 offen offset:1024 nt lds
v_mfma_f32_16x16x32_bf16 v[40:43], a[176:179], a[112:115], 0
s_add_u32 m0, s32, 73728
v_exp_f32 v32, v32
v_mfma_f32_16x16x32_bf16 v[40:43], a[180:183], a[116:119], v[40:43]
s_add_u32 s30, s29, 81920
v_exp_f32 v33, v33
v_mfma_f32_16x16x32_bf16 v[40:43], a[184:187], a[120:123], v[40:43]
v_exp_f32 v34, v34
v_exp_f32 v35, v35
v_mfma_f32_16x16x32_bf16 v[40:43], a[188:191], a[124:127], v[40:43]
v_cvt_pk_bf16_f32 v58, v32, v33
v_cvt_pk_bf16_f32 v59, v34, v35
v_mfma_f32_16x16x32_bf16 v[32:35], a[176:179], a[128:131], 0
ds_read_b128 a[168:171], v46 offset:32768
v_fmamk_f32 v36, v36, 0x3e0293ee, v24
v_mfma_f32_16x16x32_bf16 v[32:35], a[180:183], a[132:135], v[32:35]
v_exp_f32 v36, v36
v_mfma_f32_16x16x32_bf16 v[32:35], a[184:187], a[136:139], v[32:35]
ds_read_b128 a[172:175], v47 offset:32768
v_fmamk_f32 v37, v37, 0x3e0293ee, v24
v_mfma_f32_16x16x32_bf16 v[32:35], a[188:191], a[140:143], v[32:35]
s_waitcnt lgkmcnt(2)
v_exp_f32 v37, v37
v_mfma_f32_16x16x32_bf16 v[96:99], a[192:195], v[56:59], v[96:99]
v_fmamk_f32 v38, v38, 0x3e0293ee, v24
v_fmamk_f32 v39, v39, 0x3e0293ee, v24
v_mfma_f32_16x16x32_bf16 v[100:103], a[196:199], v[56:59], v[100:103]
v_exp_f32 v38, v38
v_mfma_f32_16x16x32_bf16 v[104:107], a[200:203], v[56:59], v[104:107]
v_exp_f32 v39, v39
v_mfma_f32_16x16x32_bf16 v[108:111], a[204:207], v[56:59], v[108:111]
v_cvt_pk_bf16_f32 v62, v36, v37
v_cvt_pk_bf16_f32 v63, v38, v39
v_mfma_f32_16x16x32_bf16 a[224:227], a[244:247], v[56:59], a[224:227]
v_fmamk_f32 v40, v40, 0x3e0293ee, v25
v_fmamk_f32 v41, v41, 0x3e0293ee, v25
v_mfma_f32_16x16x32_bf16 v[36:39], a[176:179], a[144:147], 0
v_exp_f32 v40, v40
v_mfma_f32_16x16x32_bf16 v[36:39], a[180:183], a[148:151], v[36:39]
v_exp_f32 v41, v41
v_mfma_f32_16x16x32_bf16 v[36:39], a[184:187], a[152:155], v[36:39]
v_fmamk_f32 v42, v42, 0x3e0293ee, v25
v_fmamk_f32 v43, v43, 0x3e0293ee, v25
v_mfma_f32_16x16x32_bf16 v[36:39], a[188:191], a[156:159], v[36:39]
v_exp_f32 v42, v42
v_mfma_f32_16x16x32_bf16 v[128:131], a[192:195], v[60:63], v[128:131]
v_exp_f32 v43, v43
v_mfma_f32_16x16x32_bf16 v[132:135], a[196:199], v[60:63], v[132:135]
v_cvt_pk_bf16_f32 v66, v40, v41
v_cvt_pk_bf16_f32 v67, v42, v43
v_mfma_f32_16x16x32_bf16 v[136:139], a[200:203], v[60:63], v[136:139]
ds_read_b64_tr_b16 a[208:209], v10 offset:32768
v_fmamk_f32 v32, v32, 0x3e0293ee, v26
v_mfma_f32_16x16x32_bf16 v[140:143], a[204:207], v[60:63], v[140:143]
v_exp_f32 v32, v32
v_mfma_f32_16x16x32_bf16 v[40:43], a[160:163], a[80:83], 0
ds_read_b64_tr_b16 a[210:211], v10 offset:36864
v_fmamk_f32 v33, v33, 0x3e0293ee, v26
v_mfma_f32_16x16x32_bf16 v[40:43], a[164:167], a[84:87], v[40:43]
s_waitcnt lgkmcnt(2)
v_exp_f32 v33, v33
v_mfma_f32_16x16x32_bf16 v[40:43], a[168:171], a[88:91], v[40:43]
ds_read_b64_tr_b16 a[212:213], v11 offset:32768
v_fmamk_f32 v34, v34, 0x3e0293ee, v26
v_mfma_f32_16x16x32_bf16 v[40:43], a[172:175], a[92:95], v[40:43]
v_exp_f32 v34, v34
v_mfma_f32_16x16x32_bf16 v[160:163], a[192:195], v[64:67], v[160:163]
ds_read_b64_tr_b16 a[214:215], v11 offset:36864
v_fmamk_f32 v35, v35, 0x3e0293ee, v26
v_mfma_f32_16x16x32_bf16 v[164:167], a[196:199], v[64:67], v[164:167]
v_exp_f32 v35, v35
v_mfma_f32_16x16x32_bf16 v[168:171], a[200:203], v[64:67], v[168:171]
ds_read_b64_tr_b16 a[216:217], v12 offset:32768
v_cvt_pk_bf16_f32 v70, v32, v33
v_mfma_f32_16x16x32_bf16 v[172:175], a[204:207], v[64:67], v[172:175]
ds_read_b64_tr_b16 a[218:219], v12 offset:36864
v_cvt_pk_bf16_f32 v71, v34, v35
v_mfma_f32_16x16x32_bf16 a[228:231], a[244:247], v[60:63], a[228:231]
ds_read_b64_tr_b16 a[220:221], v13 offset:32768
v_fmamk_f32 v36, v36, 0x3e0293ee, v27
v_mfma_f32_16x16x32_bf16 v[32:35], a[160:163], a[96:99], 0
ds_read_b64_tr_b16 a[222:223], v13 offset:36864
v_fmamk_f32 v37, v37, 0x3e0293ee, v27
v_mfma_f32_16x16x32_bf16 v[32:35], a[164:167], a[100:103], v[32:35]
v_fmamk_f32 v38, v38, 0x3e0293ee, v27
v_fmamk_f32 v39, v39, 0x3e0293ee, v27
v_mfma_f32_16x16x32_bf16 v[32:35], a[168:171], a[104:107], v[32:35]
buffer_store_dwordx4 a[20:23], v28, s[12:15], 0 offen offset:2048 sc0 sc1 nt
buffer_load_dwordx4 v16, s[24:27], s31 offen nt lds
buffer_load_dwordx4 v17, s[24:27], s31 offen offset:1024 nt lds
v_mfma_f32_16x16x32_bf16 v[32:35], a[172:175], a[108:111], v[32:35]
s_add_u32 m0, s32, 16384
v_exp_f32 v36, v36
v_mfma_f32_16x16x32_bf16 v[192:195], a[192:195], v[68:71], v[192:195]
s_add_u32 s31, s29, 81920
v_exp_f32 v37, v37
v_mfma_f32_16x16x32_bf16 v[196:199], a[196:199], v[68:71], v[196:199]
v_exp_f32 v38, v38
v_mfma_f32_16x16x32_bf16 v[200:203], a[200:203], v[68:71], v[200:203]
v_exp_f32 v39, v39
v_mfma_f32_16x16x32_bf16 v[204:207], a[204:207], v[68:71], v[204:207]
v_cvt_pk_bf16_f32 v74, v36, v37
v_cvt_pk_bf16_f32 v75, v38, v39
v_mfma_f32_16x16x32_bf16 v[36:39], a[160:163], a[112:115], 0
ds_read_b128 a[176:179], v44 offset:36864
v_fmamk_f32 v40, v40, 0x3e0293ee, v23
v_mfma_f32_16x16x32_bf16 v[36:39], a[164:167], a[116:119], v[36:39]
v_exp_f32 v40, v40
v_mfma_f32_16x16x32_bf16 v[36:39], a[168:171], a[120:123], v[36:39]
ds_read_b128 a[180:183], v45 offset:36864
v_fmamk_f32 v41, v41, 0x3e0293ee, v23
v_mfma_f32_16x16x32_bf16 v[36:39], a[172:175], a[124:127], v[36:39]
v_exp_f32 v41, v41
v_mfma_f32_16x16x32_bf16 v[224:227], a[192:195], v[72:75], v[224:227]
ds_read_b128 a[184:187], v46 offset:36864
v_fmamk_f32 v42, v42, 0x3e0293ee, v23
v_mfma_f32_16x16x32_bf16 v[228:231], a[196:199], v[72:75], v[228:231]
v_exp_f32 v42, v42
v_mfma_f32_16x16x32_bf16 v[232:235], a[200:203], v[72:75], v[232:235]
ds_read_b128 a[188:191], v47 offset:36864
v_fmamk_f32 v43, v43, 0x3e0293ee, v23
v_mfma_f32_16x16x32_bf16 v[236:239], a[204:207], v[72:75], v[236:239]
v_exp_f32 v43, v43
v_mfma_f32_16x16x32_bf16 a[232:235], a[244:247], v[64:67], a[232:235]
s_waitcnt lgkmcnt(3)
v_cvt_pk_bf16_f32 v76, v40, v41
v_cvt_pk_bf16_f32 v77, v42, v43
v_mfma_f32_16x16x32_bf16 v[112:115], a[208:211], v[56:59], v[112:115]
v_fmamk_f32 v32, v32, 0x3e0293ee, v24
v_fmamk_f32 v33, v33, 0x3e0293ee, v24
v_mfma_f32_16x16x32_bf16 v[116:119], a[212:215], v[56:59], v[116:119]
L_pad0_9:
s_cbranch_execz L_pad0_13
v_exp_f32 v32, v32
v_mfma_f32_16x16x32_bf16 v[120:123], a[216:219], v[56:59], v[120:123]
v_exp_f32 v33, v33
v_mfma_f32_16x16x32_bf16 v[124:127], a[220:223], v[56:59], v[124:127]
v_fmamk_f32 v34, v34, 0x3e0293ee, v24
v_fmamk_f32 v35, v35, 0x3e0293ee, v24
v_mfma_f32_16x16x32_bf16 v[40:43], a[160:163], a[128:131], 0
v_exp_f32 v34, v34
v_mfma_f32_16x16x32_bf16 v[40:43], a[164:167], a[132:135], v[40:43]
v_exp_f32 v35, v35
v_mfma_f32_16x16x32_bf16 v[40:43], a[168:171], a[136:139], v[40:43]
v_cvt_pk_bf16_f32 v48, v32, v33
v_cvt_pk_bf16_f32 v49, v34, v35
v_mfma_f32_16x16x32_bf16 v[40:43], a[172:175], a[140:143], v[40:43]
v_fmamk_f32 v36, v36, 0x3e0293ee, v25
v_fmamk_f32 v37, v37, 0x3e0293ee, v25
v_mfma_f32_16x16x32_bf16 v[144:147], a[208:211], v[60:63], v[144:147]
v_exp_f32 v36, v36
v_mfma_f32_16x16x32_bf16 v[148:151], a[212:215], v[60:63], v[148:151]
v_exp_f32 v37, v37
v_mfma_f32_16x16x32_bf16 v[152:155], a[216:219], v[60:63], v[152:155]
v_fmamk_f32 v38, v38, 0x3e0293ee, v25
v_fmamk_f32 v39, v39, 0x3e0293ee, v25
v_mfma_f32_16x16x32_bf16 v[156:159], a[220:223], v[60:63], v[156:159]
v_exp_f32 v38, v38
v_mfma_f32_16x16x32_bf16 a[236:239], a[244:247], v[68:71], a[236:239]
s_waitcnt vmcnt(8) lgkmcnt(0)
v_exp_f32 v39, v39
v_mfma_f32_16x16x32_bf16 v[32:35], a[176:179], a[80:83], 0
s_barrier
v_cvt_pk_bf16_f32 v52, v36, v37
v_cvt_pk_bf16_f32 v53, v38, v39
v_mfma_f32_16x16x32_bf16 v[32:35], a[180:183], a[84:87], v[32:35]
ds_read_b64_tr_b16 a[192:193], v80 offset:32768
v_fmamk_f32 v40, v40, 0x3e0293ee, v26
v_mfma_f32_16x16x32_bf16 v[32:35], a[184:187], a[88:91], v[32:35]
v_exp_f32 v40, v40
v_mfma_f32_16x16x32_bf16 v[32:35], a[188:191], a[92:95], v[32:35]
ds_read_b64_tr_b16 a[194:195], v80 offset:36864
v_fmamk_f32 v41, v41, 0x3e0293ee, v26
v_mfma_f32_16x16x32_bf16 v[176:179], a[208:211], v[64:67], v[176:179]
ds_read_b64_tr_b16 a[196:197], v81 offset:32768
v_fmamk_f32 v42, v42, 0x3e0293ee, v26
v_mfma_f32_16x16x32_bf16 v[180:183], a[212:215], v[64:67], v[180:183]
ds_read_b64_tr_b16 a[198:199], v81 offset:36864
v_fmamk_f32 v43, v43, 0x3e0293ee, v26
v_mfma_f32_16x16x32_bf16 v[184:187], a[216:219], v[64:67], v[184:187]
buffer_store_dwordx4 a[24:27], v28, s[12:15], 0 offen offset:128 sc0 sc1 nt
buffer_load_dwordx4 v14, s[20:23], s30 offen nt lds
buffer_load_dwordx4 v15, s[20:23], s30 offen offset:1024 nt lds
v_mfma_f32_16x16x32_bf16 v[188:191], a[220:223], v[64:67], v[188:191]
s_add_u32 m0, s32, 81920
v_exp_f32 v41, v41
v_mfma_f32_16x16x32_bf16 v[36:39], a[176:179], a[96:99], 0
s_add_u32 s30, s29, 90112
v_exp_f32 v42, v42
v_mfma_f32_16x16x32_bf16 v[36:39], a[180:183], a[100:103], v[36:39]
v_exp_f32 v43, v43
v_mfma_f32_16x16x32_bf16 v[36:39], a[184:187], a[104:107], v[36:39]
ds_read_b64_tr_b16 a[200:201], v82 offset:32768
v_cvt_pk_bf16_f32 v56, v40, v41
v_mfma_f32_16x16x32_bf16 v[36:39], a[188:191], a[108:111], v[36:39]
ds_read_b64_tr_b16 a[202:203], v82 offset:36864
v_cvt_pk_bf16_f32 v57, v42, v43
v_mfma_f32_16x16x32_bf16 v[208:211], a[208:211], v[68:71], v[208:211]
ds_read_b64_tr_b16 a[204:205], v83 offset:32768
v_fmamk_f32 v32, v32, 0x3e0293ee, v23
v_mfma_f32_16x16x32_bf16 v[212:215], a[212:215], v[68:71], v[212:215]
v_exp_f32 v32, v32
v_mfma_f32_16x16x32_bf16 v[216:219], a[216:219], v[68:71], v[216:219]
ds_read_b64_tr_b16 a[206:207], v83 offset:36864
v_fmamk_f32 v33, v33, 0x3e0293ee, v23
v_mfma_f32_16x16x32_bf16 v[220:223], a[220:223], v[68:71], v[220:223]
v_exp_f32 v33, v33
v_mfma_f32_16x16x32_bf16 a[240:243], a[244:247], v[72:75], a[240:243]
ds_read_b128 a[160:163], v2 offset:49152
v_fmamk_f32 v34, v34, 0x3e0293ee, v23
v_mfma_f32_16x16x32_bf16 v[40:43], a[176:179], a[112:115], 0
v_exp_f32 v34, v34
v_mfma_f32_16x16x32_bf16 v[40:43], a[180:183], a[116:119], v[40:43]
ds_read_b128 a[164:167], v3 offset:49152
v_fmamk_f32 v35, v35, 0x3e0293ee, v23
v_mfma_f32_16x16x32_bf16 v[40:43], a[184:187], a[120:123], v[40:43]
v_exp_f32 v35, v35
v_mfma_f32_16x16x32_bf16 v[40:43], a[188:191], a[124:127], v[40:43]
ds_read_b128 a[168:171], v4 offset:49152
v_cvt_pk_bf16_f32 v78, v32, v33
v_mfma_f32_16x16x32_bf16 v[240:243], a[208:211], v[72:75], v[240:243]
ds_read_b128 a[172:175], v5 offset:49152
v_cvt_pk_bf16_f32 v79, v34, v35
v_mfma_f32_16x16x32_bf16 v[244:247], a[212:215], v[72:75], v[244:247]
v_fmamk_f32 v36, v36, 0x3e0293ee, v24
v_fmamk_f32 v37, v37, 0x3e0293ee, v24
v_mfma_f32_16x16x32_bf16 v[248:251], a[216:219], v[72:75], v[248:251]
v_exp_f32 v36, v36
v_mfma_f32_16x16x32_bf16 v[252:255], a[220:223], v[72:75], v[252:255]
v_exp_f32 v37, v37
v_mfma_f32_16x16x32_bf16 v[32:35], a[176:179], a[128:131], 0
v_fmamk_f32 v38, v38, 0x3e0293ee, v24
v_fmamk_f32 v39, v39, 0x3e0293ee, v24
v_mfma_f32_16x16x32_bf16 v[32:35], a[180:183], a[132:135], v[32:35]
v_exp_f32 v38, v38
v_mfma_f32_16x16x32_bf16 v[32:35], a[184:187], a[136:139], v[32:35]
v_exp_f32 v39, v39
v_mfma_f32_16x16x32_bf16 v[32:35], a[188:191], a[140:143], v[32:35]
s_waitcnt lgkmcnt(1)
v_cvt_pk_bf16_f32 v50, v36, v37
v_cvt_pk_bf16_f32 v51, v38, v39
v_mfma_f32_16x16x32_bf16 v[96:99], a[192:195], v[76:79], v[96:99]
v_fmamk_f32 v40, v40, 0x3e0293ee, v25
v_fmamk_f32 v41, v41, 0x3e0293ee, v25
v_mfma_f32_16x16x32_bf16 v[100:103], a[196:199], v[76:79], v[100:103]
v_exp_f32 v40, v40
v_mfma_f32_16x16x32_bf16 v[104:107], a[200:203], v[76:79], v[104:107]
v_exp_f32 v41, v41
v_mfma_f32_16x16x32_bf16 v[108:111], a[204:207], v[76:79], v[108:111]
v_fmamk_f32 v42, v42, 0x3e0293ee, v25
v_fmamk_f32 v43, v43, 0x3e0293ee, v25
v_mfma_f32_16x16x32_bf16 a[224:227], a[244:247], v[76:79], a[224:227]
v_exp_f32 v42, v42
v_mfma_f32_16x16x32_bf16 v[36:39], a[160:163], a[80:83], 0
v_exp_f32 v43, v43
v_mfma_f32_16x16x32_bf16 v[36:39], a[164:167], a[84:87], v[36:39]
v_cvt_pk_bf16_f32 v54, v40, v41
v_cvt_pk_bf16_f32 v55, v42, v43
v_mfma_f32_16x16x32_bf16 v[36:39], a[168:171], a[88:91], v[36:39]
s_waitcnt lgkmcnt(0)
ds_read_b64_tr_b16 a[208:209], v84 offset:32768
v_fmamk_f32 v32, v32, 0x3e0293ee, v26
v_mfma_f32_16x16x32_bf16 v[36:39], a[172:175], a[92:95], v[36:39]
v_exp_f32 v32, v32
v_mfma_f32_16x16x32_bf16 v[128:131], a[192:195], v[48:51], v[128:131]
ds_read_b64_tr_b16 a[210:211], v84 offset:36864
v_fmamk_f32 v33, v33, 0x3e0293ee, v26
v_mfma_f32_16x16x32_bf16 v[132:135], a[196:199], v[48:51], v[132:135]
ds_read_b64_tr_b16 a[212:213], v85 offset:32768
v_fmamk_f32 v34, v34, 0x3e0293ee, v26
v_mfma_f32_16x16x32_bf16 v[136:139], a[200:203], v[48:51], v[136:139]
ds_read_b64_tr_b16 a[214:215], v85 offset:36864
v_fmamk_f32 v35, v35, 0x3e0293ee, v26
v_mfma_f32_16x16x32_bf16 v[140:143], a[204:207], v[48:51], v[140:143]
buffer_store_dwordx4 a[28:31], v28, s[12:15], 0 offen offset:2176 sc0 sc1 nt
buffer_load_dwordx4 v16, s[24:27], s31 offen nt lds
buffer_load_dwordx4 v17, s[24:27], s31 offen offset:1024 nt lds
v_mfma_f32_16x16x32_bf16 v[40:43], a[160:163], a[96:99], 0
s_add_u32 m0, s32, 24576
v_exp_f32 v33, v33
v_mfma_f32_16x16x32_bf16 v[40:43], a[164:167], a[100:103], v[40:43]
s_add_u32 s31, s29, 90112
v_exp_f32 v34, v34
v_mfma_f32_16x16x32_bf16 v[40:43], a[168:171], a[104:107], v[40:43]
v_exp_f32 v35, v35
v_mfma_f32_16x16x32_bf16 v[40:43], a[172:175], a[108:111], v[40:43]
ds_read_b64_tr_b16 a[216:217], v86 offset:32768
v_cvt_pk_bf16_f32 v58, v32, v33
v_mfma_f32_16x16x32_bf16 v[160:163], a[192:195], v[52:55], v[160:163]
ds_read_b64_tr_b16 a[218:219], v86 offset:36864
v_cvt_pk_bf16_f32 v59, v34, v35
v_mfma_f32_16x16x32_bf16 v[164:167], a[196:199], v[52:55], v[164:167]
ds_read_b64_tr_b16 a[220:221], v87 offset:32768
v_fmamk_f32 v36, v36, 0x3e0293ee, v23
v_mfma_f32_16x16x32_bf16 v[168:171], a[200:203], v[52:55], v[168:171]
v_exp_f32 v36, v36
v_mfma_f32_16x16x32_bf16 v[172:175], a[204:207], v[52:55], v[172:175]
ds_read_b64_tr_b16 a[222:223], v87 offset:36864
v_fmamk_f32 v37, v37, 0x3e0293ee, v23
v_mfma_f32_16x16x32_bf16 a[228:231], a[244:247], v[48:51], a[228:231]
v_exp_f32 v37, v37
v_mfma_f32_16x16x32_bf16 v[32:35], a[160:163], a[112:115], 0
ds_read_b128 a[176:179], v2 offset:53248
v_fmamk_f32 v38, v38, 0x3e0293ee, v23
v_mfma_f32_16x16x32_bf16 v[32:35], a[164:167], a[116:119], v[32:35]
v_exp_f32 v38, v38
v_mfma_f32_16x16x32_bf16 v[32:35], a[168:171], a[120:123], v[32:35]
ds_read_b128 a[180:183], v3 offset:53248
v_fmamk_f32 v39, v39, 0x3e0293ee, v23
v_mfma_f32_16x16x32_bf16 v[32:35], a[172:175], a[124:127], v[32:35]
v_exp_f32 v39, v39
v_mfma_f32_16x16x32_bf16 v[192:195], a[192:195], v[56:59], v[192:195]
ds_read_b128 a[184:187], v4 offset:53248
v_cvt_pk_bf16_f32 v60, v36, v37
v_mfma_f32_16x16x32_bf16 v[196:199], a[196:199], v[56:59], v[196:199]
ds_read_b128 a[188:191], v5 offset:53248
v_cvt_pk_bf16_f32 v61, v38, v39
v_mfma_f32_16x16x32_bf16 v[200:203], a[200:203], v[56:59], v[200:203]
v_fmamk_f32 v40, v40, 0x3e0293ee, v24
v_fmamk_f32 v41, v41, 0x3e0293ee, v24
v_mfma_f32_16x16x32_bf16 v[204:207], a[204:207], v[56:59], v[204:207]
v_exp_f32 v40, v40
v_mfma_f32_16x16x32_bf16 v[36:39], a[160:163], a[128:131], 0
v_exp_f32 v41, v41
v_mfma_f32_16x16x32_bf16 v[36:39], a[164:167], a[132:135], v[36:39]
v_fmamk_f32 v42, v42, 0x3e0293ee, v24
v_fmamk_f32 v43, v43, 0x3e0293ee, v24
v_mfma_f32_16x16x32_bf16 v[36:39], a[168:171], a[136:139], v[36:39]
v_exp_f32 v42, v42
v_mfma_f32_16x16x32_bf16 v[36:39], a[172:175], a[140:143], v[36:39]
s_waitcnt lgkmcnt(2)
v_exp_f32 v43, v43
v_mfma_f32_16x16x32_bf16 v[112:115], a[208:211], v[76:79], v[112:115]
v_cvt_pk_bf16_f32 v64, v40, v41
v_cvt_pk_bf16_f32 v65, v42, v43
v_mfma_f32_16x16x32_bf16 v[116:119], a[212:215], v[76:79], v[116:119]
v_fmamk_f32 v32, v32, 0x3e0293ee, v25
v_fmamk_f32 v33, v33, 0x3e0293ee, v25
v_mfma_f32_16x16x32_bf16 v[120:123], a[216:219], v[76:79], v[120:123]
v_exp_f32 v32, v32
v_mfma_f32_16x16x32_bf16 v[124:127], a[220:223], v[76:79], v[124:127]
v_exp_f32 v33, v33
v_mfma_f32_16x16x32_bf16 a[232:235], a[244:247], v[52:55], a[232:235]
v_fmamk_f32 v34, v34, 0x3e0293ee, v25
v_fmamk_f32 v35, v35, 0x3e0293ee, v25
v_mfma_f32_16x16x32_bf16 v[40:43], a[160:163], a[144:147], 0
v_exp_f32 v34, v34
v_mfma_f32_16x16x32_bf16 v[40:43], a[164:167], a[148:151], v[40:43]
v_exp_f32 v35, v35
v_mfma_f32_16x16x32_bf16 v[40:43], a[168:171], a[152:155], v[40:43]
v_cvt_pk_bf16_f32 v68, v32, v33
v_cvt_pk_bf16_f32 v69, v34, v35
v_mfma_f32_16x16x32_bf16 v[40:43], a[172:175], a[156:159], v[40:43]
ds_read_b64_tr_b16 a[192:193], v6 offset:49152
v_fmamk_f32 v36, v36, 0x3e0293ee, v26
v_mfma_f32_16x16x32_bf16 v[144:147], a[208:211], v[48:51], v[144:147]
v_exp_f32 v36, v36
v_mfma_f32_16x16x32_bf16 v[148:151], a[212:215], v[48:51], v[148:151]
ds_read_b64_tr_b16 a[194:195], v6 offset:53248
v_fmamk_f32 v37, v37, 0x3e0293ee, v26
v_mfma_f32_16x16x32_bf16 v[152:155], a[216:219], v[48:51], v[152:155]
v_exp_f32 v37, v37
v_mfma_f32_16x16x32_bf16 v[156:159], a[220:223], v[48:51], v[156:159]
ds_read_b64_tr_b16 a[196:197], v7 offset:49152
v_fmamk_f32 v38, v38, 0x3e0293ee, v26
v_mfma_f32_16x16x32_bf16 v[32:35], a[176:179], a[80:83], 0
v_exp_f32 v38, v38
v_mfma_f32_16x16x32_bf16 v[32:35], a[180:183], a[84:87], v[32:35]
s_waitcnt lgkmcnt(3)
ds_read_b64_tr_b16 a[198:199], v7 offset:53248
v_fmamk_f32 v39, v39, 0x3e0293ee, v26
v_mfma_f32_16x16x32_bf16 v[32:35], a[184:187], a[88:91], v[32:35]
v_exp_f32 v39, v39
v_mfma_f32_16x16x32_bf16 v[32:35], a[188:191], a[92:95], v[32:35]
ds_read_b64_tr_b16 a[200:201], v8 offset:49152
v_cvt_pk_bf16_f32 v72, v36, v37
v_mfma_f32_16x16x32_bf16 v[176:179], a[208:211], v[52:55], v[176:179]
ds_read_b64_tr_b16 a[202:203], v8 offset:53248
v_cvt_pk_bf16_f32 v73, v38, v39
v_mfma_f32_16x16x32_bf16 v[180:183], a[212:215], v[52:55], v[180:183]
ds_read_b64_tr_b16 a[204:205], v9 offset:49152
v_fmamk_f32 v40, v40, 0x3e0293ee, v27
v_mfma_f32_16x16x32_bf16 v[184:187], a[216:219], v[52:55], v[184:187]
v_exp_f32 v40, v40
v_mfma_f32_16x16x32_bf16 v[188:191], a[220:223], v[52:55], v[188:191]
ds_read_b64_tr_b16 a[206:207], v9 offset:53248
v_fmamk_f32 v41, v41, 0x3e0293ee, v27
v_mfma_f32_16x16x32_bf16 a[236:239], a[244:247], v[56:59], a[236:239]
v_exp_f32 v41, v41
v_mfma_f32_16x16x32_bf16 v[36:39], a[176:179], a[96:99], 0
v_fmamk_f32 v42, v42, 0x3e0293ee, v27
v_fmamk_f32 v43, v43, 0x3e0293ee, v27
v_mfma_f32_16x16x32_bf16 v[36:39], a[180:183], a[100:103], v[36:39]
v_exp_f32 v42, v42
v_mfma_f32_16x16x32_bf16 v[36:39], a[184:187], a[104:107], v[36:39]
v_exp_f32 v43, v43
v_mfma_f32_16x16x32_bf16 v[36:39], a[188:191], a[108:111], v[36:39]
v_cvt_pk_bf16_f32 v76, v40, v41
v_cvt_pk_bf16_f32 v77, v42, v43
v_mfma_f32_16x16x32_bf16 v[208:211], a[208:211], v[56:59], v[208:211]
ds_read_b128 a[160:163], v44 offset:49152
v_add_u32 v28, s38, v19
v_mfma_f32_16x16x32_bf16 v[212:215], a[212:215], v[56:59], v[212:215]
s_add_u32 s38, s63, 12288
ds_read_b128 a[164:167], v45 offset:49152
v_fmamk_f32 v32, v32, 0x3e0293ee, v23
v_mfma_f32_16x16x32_bf16 v[216:219], a[216:219], v[56:59], v[216:219]
v_fmamk_f32 v33, v33, 0x3e0293ee, v23
v_fmamk_f32 v34, v34, 0x3e0293ee, v23
v_mfma_f32_16x16x32_bf16 v[220:223], a[220:223], v[56:59], v[220:223]
ds_read_b128 a[168:171], v46 offset:49152
v_fmamk_f32 v35, v35, 0x3e0293ee, v23
v_mfma_f32_16x16x32_bf16 v[40:43], a[176:179], a[112:115], 0
buffer_store_dwordx4 a[32:35], v28, s[12:15], 0 offen offset:0 sc0 sc1 nt
buffer_load_dwordx4 v14, s[20:23], s30 offen nt lds
buffer_load_dwordx4 v15, s[20:23], s30 offen offset:1024 nt lds
v_mfma_f32_16x16x32_bf16 v[40:43], a[180:183], a[116:119], v[40:43]
s_add_u32 m0, s32, 90112
v_exp_f32 v32, v32
v_mfma_f32_16x16x32_bf16 v[40:43], a[184:187], a[120:123], v[40:43]
s_add_u32 s30, s29, 98304
v_exp_f32 v33, v33
v_exp_f32 v34, v34
v_exp_f32 v35, v35
v_mfma_f32_16x16x32_bf16 v[40:43], a[188:191], a[124:127], v[40:43]
v_cvt_pk_bf16_f32 v62, v32, v33
v_cvt_pk_bf16_f32 v63, v34, v35
v_mfma_f32_16x16x32_bf16 v[32:35], a[176:179], a[128:131], 0
ds_read_b128 a[172:175], v47 offset:49152
v_fmamk_f32 v36, v36, 0x3e0293ee, v24
v_mfma_f32_16x16x32_bf16 v[32:35], a[180:183], a[132:135], v[32:35]
v_exp_f32 v36, v36
v_mfma_f32_16x16x32_bf16 v[32:35], a[184:187], a[136:139], v[32:35]
v_fmamk_f32 v37, v37, 0x3e0293ee, v24
v_fmamk_f32 v38, v38, 0x3e0293ee, v24
v_mfma_f32_16x16x32_bf16 v[32:35], a[188:191], a[140:143], v[32:35]
s_waitcnt lgkmcnt(1)
v_exp_f32 v37, v37
v_mfma_f32_16x16x32_bf16 v[96:99], a[192:195], v[60:63], v[96:99]
v_exp_f32 v38, v38
v_mfma_f32_16x16x32_bf16 v[100:103], a[196:199], v[60:63], v[100:103]
v_fmamk_f32 v39, v39, 0x3e0293ee, v24
v_cvt_pk_bf16_f32 v66, v36, v37
v_mfma_f32_16x16x32_bf16 v[104:107], a[200:203], v[60:63], v[104:107]
v_exp_f32 v39, v39
v_mfma_f32_16x16x32_bf16 v[108:111], a[204:207], v[60:63], v[108:111]
v_cvt_pk_bf16_f32 v67, v38, v39
v_fmamk_f32 v40, v40, 0x3e0293ee, v25
v_mfma_f32_16x16x32_bf16 a[224:227], a[244:247], v[60:63], a[224:227]
v_exp_f32 v40, v40
v_mfma_f32_16x16x32_bf16 v[36:39], a[176:179], a[144:147], 0
v_fmamk_f32 v41, v41, 0x3e0293ee, v25
v_fmamk_f32 v42, v42, 0x3e0293ee, v25
v_mfma_f32_16x16x32_bf16 v[36:39], a[180:183], a[148:151], v[36:39]
v_exp_f32 v41, v41
v_mfma_f32_16x16x32_bf16 v[36:39], a[184:187], a[152:155], v[36:39]
v_exp_f32 v42, v42
v_mfma_f32_16x16x32_bf16 v[36:39], a[188:191], a[156:159], v[36:39]
v_fmamk_f32 v43, v43, 0x3e0293ee, v25
v_cvt_pk_bf16_f32 v70, v40, v41
v_mfma_f32_16x16x32_bf16 v[128:131], a[192:195], v[64:67], v[128:131]
v_exp_f32 v43, v43
v_mfma_f32_16x16x32_bf16 v[132:135], a[196:199], v[64:67], v[132:135]
ds_read_b64_tr_b16 a[208:209], v10 offset:49152
v_cvt_pk_bf16_f32 v71, v42, v43
v_mfma_f32_16x16x32_bf16 v[136:139], a[200:203], v[64:67], v[136:139]
ds_read_b64_tr_b16 a[210:211], v10 offset:53248
v_fmamk_f32 v32, v32, 0x3e0293ee, v26
v_mfma_f32_16x16x32_bf16 v[140:143], a[204:207], v[64:67], v[140:143]
v_exp_f32 v32, v32
v_mfma_f32_16x16x32_bf16 v[40:43], a[160:163], a[80:83], 0
ds_read_b64_tr_b16 a[212:213], v11 offset:49152
v_fmamk_f32 v33, v33, 0x3e0293ee, v26
v_mfma_f32_16x16x32_bf16 v[40:43], a[164:167], a[84:87], v[40:43]
v_exp_f32 v33, v33
v_mfma_f32_16x16x32_bf16 v[40:43], a[168:171], a[88:91], v[40:43]
s_waitcnt lgkmcnt(3)
ds_read_b64_tr_b16 a[214:215], v11 offset:53248
v_fmamk_f32 v34, v34, 0x3e0293ee, v26
v_mfma_f32_16x16x32_bf16 v[40:43], a[172:175], a[92:95], v[40:43]
v_exp_f32 v34, v34
v_mfma_f32_16x16x32_bf16 v[160:163], a[192:195], v[68:71], v[160:163]
ds_read_b64_tr_b16 a[216:217], v12 offset:49152
v_fmamk_f32 v35, v35, 0x3e0293ee, v26
v_mfma_f32_16x16x32_bf16 v[164:167], a[196:199], v[68:71], v[164:167]
v_exp_f32 v35, v35
v_mfma_f32_16x16x32_bf16 v[168:171], a[200:203], v[68:71], v[168:171]
ds_read_b64_tr_b16 a[218:219], v12 offset:53248
v_cvt_pk_bf16_f32 v74, v32, v33
v_mfma_f32_16x16x32_bf16 v[172:175], a[204:207], v[68:71], v[172:175]
ds_read_b64_tr_b16 a[220:221], v13 offset:49152
v_cvt_pk_bf16_f32 v75, v34, v35
v_mfma_f32_16x16x32_bf16 a[228:231], a[244:247], v[64:67], a[228:231]
ds_read_b64_tr_b16 a[222:223], v13 offset:53248
v_fmamk_f32 v36, v36, 0x3e0293ee, v27
v_mfma_f32_16x16x32_bf16 v[32:35], a[160:163], a[96:99], 0
v_fmamk_f32 v37, v37, 0x3e0293ee, v27
v_fmamk_f32 v38, v38, 0x3e0293ee, v27
v_mfma_f32_16x16x32_bf16 v[32:35], a[164:167], a[100:103], v[32:35]
ds_read_b128 a[176:179], v44 offset:53248
v_fmamk_f32 v39, v39, 0x3e0293ee, v27
v_mfma_f32_16x16x32_bf16 v[32:35], a[168:171], a[104:107], v[32:35]
buffer_store_dwordx4 a[36:39], v28, s[12:15], 0 offen offset:2048 sc0 sc1 nt
buffer_load_dwordx4 v16, s[24:27], s31 offen nt lds
buffer_load_dwordx4 v17, s[24:27], s31 offen offset:1024 nt lds
v_mfma_f32_16x16x32_bf16 v[32:35], a[172:175], a[108:111], v[32:35]
s_add_u32 m0, s32, 32768
v_exp_f32 v36, v36
v_mfma_f32_16x16x32_bf16 v[192:195], a[192:195], v[72:75], v[192:195]
s_add_u32 s31, s29, 98304
v_exp_f32 v37, v37
v_mfma_f32_16x16x32_bf16 v[196:199], a[196:199], v[72:75], v[196:199]
v_exp_f32 v38, v38
v_mfma_f32_16x16x32_bf16 v[200:203], a[200:203], v[72:75], v[200:203]
v_exp_f32 v39, v39
v_mfma_f32_16x16x32_bf16 v[204:207], a[204:207], v[72:75], v[204:207]
v_cvt_pk_bf16_f32 v78, v36, v37
v_cvt_pk_bf16_f32 v79, v38, v39
v_mfma_f32_16x16x32_bf16 v[36:39], a[160:163], a[112:115], 0
ds_read_b128 a[180:183], v45 offset:53248
v_fmamk_f32 v40, v40, 0x3e0293ee, v23
v_mfma_f32_16x16x32_bf16 v[36:39], a[164:167], a[116:119], v[36:39]
v_exp_f32 v40, v40
v_mfma_f32_16x16x32_bf16 v[36:39], a[168:171], a[120:123], v[36:39]
ds_read_b128 a[184:187], v46 offset:53248
v_fmamk_f32 v41, v41, 0x3e0293ee, v23
v_mfma_f32_16x16x32_bf16 v[36:39], a[172:175], a[124:127], v[36:39]
v_exp_f32 v41, v41
v_mfma_f32_16x16x32_bf16 v[224:227], a[192:195], v[76:79], v[224:227]
ds_read_b128 a[188:191], v47 offset:53248
v_fmamk_f32 v42, v42, 0x3e0293ee, v23
v_mfma_f32_16x16x32_bf16 v[228:231], a[196:199], v[76:79], v[228:231]
v_exp_f32 v42, v42
v_mfma_f32_16x16x32_bf16 v[232:235], a[200:203], v[76:79], v[232:235]
v_fmamk_f32 v43, v43, 0x3e0293ee, v23
v_cvt_pk_bf16_f32 v48, v40, v41
v_mfma_f32_16x16x32_bf16 v[236:239], a[204:207], v[76:79], v[236:239]
v_exp_f32 v43, v43
v_mfma_f32_16x16x32_bf16 a[232:235], a[244:247], v[68:71], a[232:235]
s_waitcnt lgkmcnt(2)
v_cvt_pk_bf16_f32 v49, v42, v43
v_fmamk_f32 v32, v32, 0x3e0293ee, v24
v_mfma_f32_16x16x32_bf16 v[112:115], a[208:211], v[60:63], v[112:115]
v_exp_f32 v32, v32
v_mfma_f32_16x16x32_bf16 v[116:119], a[212:215], v[60:63], v[116:119]
v_fmamk_f32 v33, v33, 0x3e0293ee, v24
v_fmamk_f32 v34, v34, 0x3e0293ee, v24
v_mfma_f32_16x16x32_bf16 v[120:123], a[216:219], v[60:63], v[120:123]
v_exp_f32 v33, v33
v_mfma_f32_16x16x32_bf16 v[124:127], a[220:223], v[60:63], v[124:127]
v_exp_f32 v34, v34
v_mfma_f32_16x16x32_bf16 v[40:43], a[160:163], a[128:131], 0
v_fmamk_f32 v35, v35, 0x3e0293ee, v24
v_cvt_pk_bf16_f32 v52, v32, v33
v_mfma_f32_16x16x32_bf16 v[40:43], a[164:167], a[132:135], v[40:43]
v_exp_f32 v35, v35
v_mfma_f32_16x16x32_bf16 v[40:43], a[168:171], a[136:139], v[40:43]
v_cvt_pk_bf16_f32 v53, v34, v35
v_fmamk_f32 v36, v36, 0x3e0293ee, v25
v_mfma_f32_16x16x32_bf16 v[40:43], a[172:175], a[140:143], v[40:43]
v_exp_f32 v36, v36
v_mfma_f32_16x16x32_bf16 v[144:147], a[208:211], v[64:67], v[144:147]
v_fmamk_f32 v37, v37, 0x3e0293ee, v25
v_fmamk_f32 v38, v38, 0x3e0293ee, v25
v_mfma_f32_16x16x32_bf16 v[148:151], a[212:215], v[64:67], v[148:151]
v_exp_f32 v37, v37
v_mfma_f32_16x16x32_bf16 v[152:155], a[216:219], v[64:67], v[152:155]
v_exp_f32 v38, v38
v_mfma_f32_16x16x32_bf16 v[156:159], a[220:223], v[64:67], v[156:159]
v_fmamk_f32 v39, v39, 0x3e0293ee, v25
v_cvt_pk_bf16_f32 v56, v36, v37
v_mfma_f32_16x16x32_bf16 a[236:239], a[244:247], v[72:75], a[236:239]
s_waitcnt vmcnt(8) lgkmcnt(0)
v_exp_f32 v39, v39
v_mfma_f32_16x16x32_bf16 v[32:35], a[176:179], a[80:83], 0
s_barrier
ds_read_b64_tr_b16 a[192:193], v80 offset:49152
v_cvt_pk_bf16_f32 v57, v38, v39
v_mfma_f32_16x16x32_bf16 v[32:35], a[180:183], a[84:87], v[32:35]
ds_read_b64_tr_b16 a[194:195], v80 offset:53248
v_fmamk_f32 v40, v40, 0x3e0293ee, v26
v_mfma_f32_16x16x32_bf16 v[32:35], a[184:187], a[88:91], v[32:35]
v_exp_f32 v40, v40
v_mfma_f32_16x16x32_bf16 v[32:35], a[188:191], a[92:95], v[32:35]
ds_read_b64_tr_b16 a[196:197], v81 offset:49152
v_fmamk_f32 v41, v41, 0x3e0293ee, v26
v_mfma_f32_16x16x32_bf16 v[176:179], a[208:211], v[68:71], v[176:179]
ds_read_b64_tr_b16 a[198:199], v81 offset:53248
v_fmamk_f32 v42, v42, 0x3e0293ee, v26
v_mfma_f32_16x16x32_bf16 v[180:183], a[212:215], v[68:71], v[180:183]
ds_read_b64_tr_b16 a[200:201], v82 offset:49152
v_fmamk_f32 v43, v43, 0x3e0293ee, v26
v_mfma_f32_16x16x32_bf16 v[184:187], a[216:219], v[68:71], v[184:187]
buffer_store_dwordx4 a[40:43], v28, s[12:15], 0 offen offset:128 sc0 sc1 nt
buffer_load_dwordx4 v14, s[20:23], s30 offen nt lds
buffer_load_dwordx4 v15, s[20:23], s30 offen offset:1024 nt lds
v_mfma_f32_16x16x32_bf16 v[188:191], a[220:223], v[68:71], v[188:191]
s_add_u32 m0, s32, 98304
v_exp_f32 v41, v41
v_mfma_f32_16x16x32_bf16 v[36:39], a[176:179], a[96:99], 0
s_add_u32 s30, s29, 106496
v_exp_f32 v42, v42
v_mfma_f32_16x16x32_bf16 v[36:39], a[180:183], a[100:103], v[36:39]
v_exp_f32 v43, v43
v_mfma_f32_16x16x32_bf16 v[36:39], a[184:187], a[104:107], v[36:39]
ds_read_b64_tr_b16 a[202:203], v82 offset:53248
v_cvt_pk_bf16_f32 v60, v40, v41
v_mfma_f32_16x16x32_bf16 v[36:39], a[188:191], a[108:111], v[36:39]
ds_read_b64_tr_b16 a[204:205], v83 offset:49152
v_cvt_pk_bf16_f32 v61, v42, v43
v_mfma_f32_16x16x32_bf16 v[208:211], a[208:211], v[72:75], v[208:211]
ds_read_b64_tr_b16 a[206:207], v83 offset:53248
v_fmamk_f32 v32, v32, 0x3e0293ee, v23
v_mfma_f32_16x16x32_bf16 v[212:215], a[212:215], v[72:75], v[212:215]
v_exp_f32 v32, v32
v_mfma_f32_16x16x32_bf16 v[216:219], a[216:219], v[72:75], v[216:219]
ds_read_b128 a[160:163], v2 offset:0
v_fmamk_f32 v33, v33, 0x3e0293ee, v23
v_mfma_f32_16x16x32_bf16 v[220:223], a[220:223], v[72:75], v[220:223]
v_exp_f32 v33, v33
v_mfma_f32_16x16x32_bf16 a[240:243], a[244:247], v[76:79], a[240:243]
ds_read_b128 a[164:167], v3 offset:0
v_fmamk_f32 v34, v34, 0x3e0293ee, v23
v_mfma_f32_16x16x32_bf16 v[40:43], a[176:179], a[112:115], 0
v_exp_f32 v34, v34
v_mfma_f32_16x16x32_bf16 v[40:43], a[180:183], a[116:119], v[40:43]
ds_read_b128 a[168:171], v4 offset:0
v_fmamk_f32 v35, v35, 0x3e0293ee, v23
v_mfma_f32_16x16x32_bf16 v[40:43], a[184:187], a[120:123], v[40:43]
v_exp_f32 v35, v35
v_mfma_f32_16x16x32_bf16 v[40:43], a[188:191], a[124:127], v[40:43]
ds_read_b128 a[172:175], v5 offset:0
v_cvt_pk_bf16_f32 v50, v32, v33
v_mfma_f32_16x16x32_bf16 v[240:243], a[208:211], v[76:79], v[240:243]
v_cvt_pk_bf16_f32 v51, v34, v35
v_fmamk_f32 v36, v36, 0x3e0293ee, v24
v_mfma_f32_16x16x32_bf16 v[244:247], a[212:215], v[76:79], v[244:247]
v_exp_f32 v36, v36
v_mfma_f32_16x16x32_bf16 v[248:251], a[216:219], v[76:79], v[248:251]
v_fmamk_f32 v37, v37, 0x3e0293ee, v24
v_fmamk_f32 v38, v38, 0x3e0293ee, v24
v_mfma_f32_16x16x32_bf16 v[252:255], a[220:223], v[76:79], v[252:255]
v_exp_f32 v37, v37
v_mfma_f32_16x16x32_bf16 v[32:35], a[176:179], a[128:131], 0
v_exp_f32 v38, v38
v_mfma_f32_16x16x32_bf16 v[32:35], a[180:183], a[132:135], v[32:35]
v_fmamk_f32 v39, v39, 0x3e0293ee, v24
v_cvt_pk_bf16_f32 v54, v36, v37
v_mfma_f32_16x16x32_bf16 v[32:35], a[184:187], a[136:139], v[32:35]
v_exp_f32 v39, v39
v_mfma_f32_16x16x32_bf16 v[32:35], a[188:191], a[140:143], v[32:35]
s_waitcnt lgkmcnt(0)
v_cvt_pk_bf16_f32 v55, v38, v39
v_fmamk_f32 v40, v40, 0x3e0293ee, v25
v_mfma_f32_16x16x32_bf16 v[96:99], a[192:195], v[48:51], v[96:99]
v_exp_f32 v40, v40
v_mfma_f32_16x16x32_bf16 v[100:103], a[196:199], v[48:51], v[100:103]
v_fmamk_f32 v41, v41, 0x3e0293ee, v25
v_fmamk_f32 v42, v42, 0x3e0293ee, v25
v_mfma_f32_16x16x32_bf16 v[104:107], a[200:203], v[48:51], v[104:107]
v_exp_f32 v41, v41
v_mfma_f32_16x16x32_bf16 v[108:111], a[204:207], v[48:51], v[108:111]
v_exp_f32 v42, v42
v_mfma_f32_16x16x32_bf16 a[224:227], a[244:247], v[48:51], a[224:227]
v_fmamk_f32 v43, v43, 0x3e0293ee, v25
v_cvt_pk_bf16_f32 v58, v40, v41
v_mfma_f32_16x16x32_bf16 v[36:39], a[160:163], a[80:83], 0
v_exp_f32 v43, v43
v_mfma_f32_16x16x32_bf16 v[36:39], a[164:167], a[84:87], v[36:39]
ds_read_b64_tr_b16 a[208:209], v84 offset:49152
v_cvt_pk_bf16_f32 v59, v42, v43
v_mfma_f32_16x16x32_bf16 v[36:39], a[168:171], a[88:91], v[36:39]
ds_read_b64_tr_b16 a[210:211], v84 offset:53248
v_fmamk_f32 v32, v32, 0x3e0293ee, v26
v_mfma_f32_16x16x32_bf16 v[36:39], a[172:175], a[92:95], v[36:39]
v_exp_f32 v32, v32
v_mfma_f32_16x16x32_bf16 v[128:131], a[192:195], v[52:55], v[128:131]
ds_read_b64_tr_b16 a[212:213], v85 offset:49152
v_fmamk_f32 v33, v33, 0x3e0293ee, v26
v_mfma_f32_16x16x32_bf16 v[132:135], a[196:199], v[52:55], v[132:135]
ds_read_b64_tr_b16 a[214:215], v85 offset:53248
v_fmamk_f32 v34, v34, 0x3e0293ee, v26
v_mfma_f32_16x16x32_bf16 v[136:139], a[200:203], v[52:55], v[136:139]
ds_read_b64_tr_b16 a[216:217], v86 offset:49152
v_fmamk_f32 v35, v35, 0x3e0293ee, v26
v_mfma_f32_16x16x32_bf16 v[140:143], a[204:207], v[52:55], v[140:143]
buffer_store_dwordx4 a[44:47], v28, s[12:15], 0 offen offset:2176 sc0 sc1 nt
buffer_load_dwordx4 v16, s[24:27], s31 offen nt lds
buffer_load_dwordx4 v17, s[24:27], s31 offen offset:1024 nt lds
v_mfma_f32_16x16x32_bf16 v[40:43], a[160:163], a[96:99], 0
s_add_u32 m0, s32, 40960
v_exp_f32 v33, v33
v_mfma_f32_16x16x32_bf16 v[40:43], a[164:167], a[100:103], v[40:43]
s_add_u32 s31, s29, 106496
v_exp_f32 v34, v34
v_mfma_f32_16x16x32_bf16 v[40:43], a[168:171], a[104:107], v[40:43]
v_exp_f32 v35, v35
v_mfma_f32_16x16x32_bf16 v[40:43], a[172:175], a[108:111], v[40:43]
ds_read_b64_tr_b16 a[218:219], v86 offset:53248
v_cvt_pk_bf16_f32 v62, v32, v33
v_mfma_f32_16x16x32_bf16 v[160:163], a[192:195], v[56:59], v[160:163]
L_pad0_10:
s_cbranch_execz L_back
ds_read_b64_tr_b16 a[220:221], v87 offset:49152
v_cvt_pk_bf16_f32 v63, v34, v35
v_mfma_f32_16x16x32_bf16 v[164:167], a[196:199], v[56:59], v[164:167]
ds_read_b64_tr_b16 a[222:223], v87 offset:53248
v_fmamk_f32 v36, v36, 0x3e0293ee, v23
v_mfma_f32_16x16x32_bf16 v[168:171], a[200:203], v[56:59], v[168:171]
v_exp_f32 v36, v36
v_mfma_f32_16x16x32_bf16 v[172:175], a[204:207], v[56:59], v[172:175]
ds_read_b128 a[176:179], v2 offset:4096
v_fmamk_f32 v37, v37, 0x3e0293ee, v23
v_mfma_f32_16x16x32_bf16 a[228:231], a[244:247], v[52:55], a[228:231]
v_exp_f32 v37, v37
v_mfma_f32_16x16x32_bf16 v[32:35], a[160:163], a[112:115], 0
ds_read_b128 a[180:183], v3 offset:4096
v_fmamk_f32 v38, v38, 0x3e0293ee, v23
v_mfma_f32_16x16x32_bf16 v[32:35], a[164:167], a[116:119], v[32:35]
v_exp_f32 v38, v38
v_mfma_f32_16x16x32_bf16 v[32:35], a[168:171], a[120:123], v[32:35]
ds_read_b128 a[184:187], v4 offset:4096
v_fmamk_f32 v39, v39, 0x3e0293ee, v23
v_mfma_f32_16x16x32_bf16 v[32:35], a[172:175], a[124:127], v[32:35]
v_exp_f32 v39, v39
v_mfma_f32_16x16x32_bf16 v[192:195], a[192:195], v[60:63], v[192:195]
v_cvt_pk_bf16_f32 v64, v36, v37
v_cvt_pk_bf16_f32 v65, v38, v39
v_mfma_f32_16x16x32_bf16 v[196:199], a[196:199], v[60:63], v[196:199]
ds_read_b128 a[188:191], v5 offset:4096
v_fmamk_f32 v40, v40, 0x3e0293ee, v24
v_mfma_f32_16x16x32_bf16 v[200:203], a[200:203], v[60:63], v[200:203]
v_exp_f32 v40, v40
v_mfma_f32_16x16x32_bf16 v[204:207], a[204:207], v[60:63], v[204:207]
v_fmamk_f32 v41, v41, 0x3e0293ee, v24
v_fmamk_f32 v42, v42, 0x3e0293ee, v24
v_mfma_f32_16x16x32_bf16 v[36:39], a[160:163], a[128:131], 0
v_exp_f32 v41, v41
v_mfma_f32_16x16x32_bf16 v[36:39], a[164:167], a[132:135], v[36:39]
v_exp_f32 v42, v42
v_mfma_f32_16x16x32_bf16 v[36:39], a[168:171], a[136:139], v[36:39]
v_fmamk_f32 v43, v43, 0x3e0293ee, v24
v_cvt_pk_bf16_f32 v68, v40, v41
v_mfma_f32_16x16x32_bf16 v[36:39], a[172:175], a[140:143], v[36:39]
s_waitcnt lgkmcnt(1)
v_exp_f32 v43, v43
v_mfma_f32_16x16x32_bf16 v[112:115], a[208:211], v[48:51], v[112:115]
v_cvt_pk_bf16_f32 v69, v42, v43
v_fmamk_f32 v32, v32, 0x3e0293ee, v25
v_mfma_f32_16x16x32_bf16 v[116:119], a[212:215], v[48:51], v[116:119]
v_exp_f32 v32, v32
v_mfma_f32_16x16x32_bf16 v[120:123], a[216:219], v[48:51], v[120:123]
v_fmamk_f32 v33, v33, 0x3e0293ee, v25
v_fmamk_f32 v34, v34, 0x3e0293ee, v25
v_mfma_f32_16x16x32_bf16 v[124:127], a[220:223], v[48:51], v[124:127]
v_exp_f32 v33, v33
v_mfma_f32_16x16x32_bf16 a[232:235], a[244:247], v[56:59], a[232:235]
v_exp_f32 v34, v34
v_mfma_f32_16x16x32_bf16 v[40:43], a[160:163], a[144:147], 0
v_fmamk_f32 v35, v35, 0x3e0293ee, v25
v_cvt_pk_bf16_f32 v72, v32, v33
v_mfma_f32_16x16x32_bf16 v[40:43], a[164:167], a[148:151], v[40:43]
v_exp_f32 v35, v35
v_mfma_f32_16x16x32_bf16 v[40:43], a[168:171], a[152:155], v[40:43]
ds_read_b64_tr_b16 a[192:193], v6 offset:0
v_cvt_pk_bf16_f32 v73, v34, v35
v_mfma_f32_16x16x32_bf16 v[40:43], a[172:175], a[156:159], v[40:43]
ds_read_b64_tr_b16 a[194:195], v6 offset:4096
v_fmamk_f32 v36, v36, 0x3e0293ee, v26
v_mfma_f32_16x16x32_bf16 v[144:147], a[208:211], v[52:55], v[144:147]
v_exp_f32 v36, v36
v_mfma_f32_16x16x32_bf16 v[148:151], a[212:215], v[52:55], v[148:151]
ds_read_b64_tr_b16 a[196:197], v7 offset:0
v_fmamk_f32 v37, v37, 0x3e0293ee, v26
v_mfma_f32_16x16x32_bf16 v[152:155], a[216:219], v[52:55], v[152:155]
v_exp_f32 v37, v37
v_mfma_f32_16x16x32_bf16 v[156:159], a[220:223], v[52:55], v[156:159]
ds_read_b64_tr_b16 a[198:199], v7 offset:4096
v_fmamk_f32 v38, v38, 0x3e0293ee, v26
v_mfma_f32_16x16x32_bf16 v[32:35], a[176:179], a[80:83], 0
v_exp_f32 v38, v38
v_mfma_f32_16x16x32_bf16 v[32:35], a[180:183], a[84:87], v[32:35]
ds_read_b64_tr_b16 a[200:201], v8 offset:0
v_fmamk_f32 v39, v39, 0x3e0293ee, v26
v_mfma_f32_16x16x32_bf16 v[32:35], a[184:187], a[88:91], v[32:35]
s_waitcnt lgkmcnt(4)
v_exp_f32 v39, v39
v_mfma_f32_16x16x32_bf16 v[32:35], a[188:191], a[92:95], v[32:35]
ds_read_b64_tr_b16 a[202:203], v8 offset:4096
v_cvt_pk_bf16_f32 v76, v36, v37
v_mfma_f32_16x16x32_bf16 v[176:179], a[208:211], v[56:59], v[176:179]
ds_read_b64_tr_b16 a[204:205], v9 offset:0
v_cvt_pk_bf16_f32 v77, v38, v39
v_mfma_f32_16x16x32_bf16 v[180:183], a[212:215], v[56:59], v[180:183]
ds_read_b64_tr_b16 a[206:207], v9 offset:4096
v_fmamk_f32 v40, v40, 0x3e0293ee, v27
v_mfma_f32_16x16x32_bf16 v[184:187], a[216:219], v[56:59], v[184:187]
v_exp_f32 v40, v40
v_mfma_f32_16x16x32_bf16 v[188:191], a[220:223], v[56:59], v[188:191]
v_fmamk_f32 v41, v41, 0x3e0293ee, v27
v_fmamk_f32 v42, v42, 0x3e0293ee, v27
v_mfma_f32_16x16x32_bf16 a[236:239], a[244:247], v[60:63], a[236:239]
v_exp_f32 v41, v41
v_mfma_f32_16x16x32_bf16 v[36:39], a[176:179], a[96:99], 0
v_exp_f32 v42, v42
v_mfma_f32_16x16x32_bf16 v[36:39], a[180:183], a[100:103], v[36:39]
v_fmamk_f32 v43, v43, 0x3e0293ee, v27
v_cvt_pk_bf16_f32 v48, v40, v41
v_mfma_f32_16x16x32_bf16 v[36:39], a[184:187], a[104:107], v[36:39]
v_exp_f32 v43, v43
v_mfma_f32_16x16x32_bf16 v[36:39], a[188:191], a[108:111], v[36:39]
ds_read_b128 a[160:163], v44 offset:0
v_cvt_pk_bf16_f32 v49, v42, v43
v_mfma_f32_16x16x32_bf16 v[208:211], a[208:211], v[60:63], v[208:211]
ds_read_b128 a[164:167], v45 offset:0
v_add_u32 v28, s38, v19
v_mfma_f32_16x16x32_bf16 v[212:215], a[212:215], v[60:63], v[212:215]
s_mov_b32 s38, s72
v_fmamk_f32 v32, v32, 0x3e0293ee, v23
v_fmamk_f32 v33, v33, 0x3e0293ee, v23
v_mfma_f32_16x16x32_bf16 v[216:219], a[216:219], v[60:63], v[216:219]
v_fmamk_f32 v34, v34, 0x3e0293ee, v23
v_fmamk_f32 v35, v35, 0x3e0293ee, v23
v_mfma_f32_16x16x32_bf16 v[220:223], a[220:223], v[60:63], v[220:223]
buffer_store_dwordx4 a[48:51], v28, s[12:15], 0 offen offset:0 sc0 sc1 nt
buffer_load_dwordx4 v14, s[20:23], s30 offen nt lds
buffer_load_dwordx4 v15, s[20:23], s30 offen offset:1024 nt lds
v_mfma_f32_16x16x32_bf16 v[40:43], a[176:179], a[112:115], 0
s_add_u32 m0, s32, 106496
v_exp_f32 v32, v32
v_mfma_f32_16x16x32_bf16 v[40:43], a[180:183], a[116:119], v[40:43]
s_add_u32 s30, s29, 114688
v_exp_f32 v33, v33
v_mfma_f32_16x16x32_bf16 v[40:43], a[184:187], a[120:123], v[40:43]
v_exp_f32 v34, v34
v_exp_f32 v35, v35
v_mfma_f32_16x16x32_bf16 v[40:43], a[188:191], a[124:127], v[40:43]
v_cvt_pk_bf16_f32 v66, v32, v33
v_cvt_pk_bf16_f32 v67, v34, v35
v_mfma_f32_16x16x32_bf16 v[32:35], a[176:179], a[128:131], 0
ds_read_b128 a[168:171], v46 offset:0
v_fmamk_f32 v36, v36, 0x3e0293ee, v24
v_mfma_f32_16x16x32_bf16 v[32:35], a[180:183], a[132:135], v[32:35]
v_exp_f32 v36, v36
v_mfma_f32_16x16x32_bf16 v[32:35], a[184:187], a[136:139], v[32:35]
ds_read_b128 a[172:175], v47 offset:0
v_fmamk_f32 v37, v37, 0x3e0293ee, v24
v_mfma_f32_16x16x32_bf16 v[32:35], a[188:191], a[140:143], v[32:35]
s_waitcnt lgkmcnt(2)
v_exp_f32 v37, v37
v_mfma_f32_16x16x32_bf16 v[96:99], a[192:195], v[64:67], v[96:99]
v_fmamk_f32 v38, v38, 0x3e0293ee, v24
v_fmamk_f32 v39, v39, 0x3e0293ee, v24
v_mfma_f32_16x16x32_bf16 v[100:103], a[196:199], v[64:67], v[100:103]
v_exp_f32 v38, v38
v_mfma_f32_16x16x32_bf16 v[104:107], a[200:203], v[64:67], v[104:107]
v_exp_f32 v39, v39
v_mfma_f32_16x16x32_bf16 v[108:111], a[204:207], v[64:67], v[108:111]
v_cvt_pk_bf16_f32 v70, v36, v37
v_cvt_pk_bf16_f32 v71, v38, v39
v_mfma_f32_16x16x32_bf16 a[224:227], a[244:247], v[64:67], a[224:227]
v_fmamk_f32 v40, v40, 0x3e0293ee, v25
v_fmamk_f32 v41, v41, 0x3e0293ee, v25
v_mfma_f32_16x16x32_bf16 v[36:39], a[176:179], a[144:147], 0
v_exp_f32 v40, v40
v_mfma_f32_16x16x32_bf16 v[36:39], a[180:183], a[148:151], v[36:39]
v_exp_f32 v41, v41
v_mfma_f32_16x16x32_bf16 v[36:39], a[184:187], a[152:155], v[36:39]
v_fmamk_f32 v42, v42, 0x3e0293ee, v25
v_fmamk_f32 v43, v43, 0x3e0293ee, v25
v_mfma_f32_16x16x32_bf16 v[36:39], a[188:191], a[156:159], v[36:39]
v_exp_f32 v42, v42
v_mfma_f32_16x16x32_bf16 v[128:131], a[192:195], v[68:71], v[128:131]
v_exp_f32 v43, v43
v_mfma_f32_16x16x32_bf16 v[132:135], a[196:199], v[68:71], v[132:135]
v_cvt_pk_bf16_f32 v74, v40, v41
v_cvt_pk_bf16_f32 v75, v42, v43
v_mfma_f32_16x16x32_bf16 v[136:139], a[200:203], v[68:71], v[136:139]
ds_read_b64_tr_b16 a[208:209], v10 offset:0
v_fmamk_f32 v32, v32, 0x3e0293ee, v26
v_mfma_f32_16x16x32_bf16 v[140:143], a[204:207], v[68:71], v[140:143]
v_exp_f32 v32, v32
v_mfma_f32_16x16x32_bf16 v[40:43], a[160:163], a[80:83], 0
ds_read_b64_tr_b16 a[210:211], v10 offset:4096
v_fmamk_f32 v33, v33, 0x3e0293ee, v26
v_mfma_f32_16x16x32_bf16 v[40:43], a[164:167], a[84:87], v[40:43]
s_waitcnt lgkmcnt(2)
v_exp_f32 v33, v33
v_mfma_f32_16x16x32_bf16 v[40:43], a[168:171], a[88:91], v[40:43]
ds_read_b64_tr_b16 a[212:213], v11 offset:0
v_fmamk_f32 v34, v34, 0x3e0293ee, v26
v_mfma_f32_16x16x32_bf16 v[40:43], a[172:175], a[92:95], v[40:43]
v_exp_f32 v34, v34
v_mfma_f32_16x16x32_bf16 v[160:163], a[192:195], v[72:75], v[160:163]
ds_read_b64_tr_b16 a[214:215], v11 offset:4096
v_fmamk_f32 v35, v35, 0x3e0293ee, v26
v_mfma_f32_16x16x32_bf16 v[164:167], a[196:199], v[72:75], v[164:167]
v_exp_f32 v35, v35
v_mfma_f32_16x16x32_bf16 v[168:171], a[200:203], v[72:75], v[168:171]
ds_read_b64_tr_b16 a[216:217], v12 offset:0
v_cvt_pk_bf16_f32 v78, v32, v33
v_mfma_f32_16x16x32_bf16 v[172:175], a[204:207], v[72:75], v[172:175]
ds_read_b64_tr_b16 a[218:219], v12 offset:4096
v_cvt_pk_bf16_f32 v79, v34, v35
v_mfma_f32_16x16x32_bf16 a[228:231], a[244:247], v[68:71], a[228:231]
ds_read_b64_tr_b16 a[220:221], v13 offset:0
v_fmamk_f32 v36, v36, 0x3e0293ee, v27
v_mfma_f32_16x16x32_bf16 v[32:35], a[160:163], a[96:99], 0
ds_read_b64_tr_b16 a[222:223], v13 offset:4096
v_fmamk_f32 v37, v37, 0x3e0293ee, v27
v_mfma_f32_16x16x32_bf16 v[32:35], a[164:167], a[100:103], v[32:35]
v_fmamk_f32 v38, v38, 0x3e0293ee, v27
v_fmamk_f32 v39, v39, 0x3e0293ee, v27
v_mfma_f32_16x16x32_bf16 v[32:35], a[168:171], a[104:107], v[32:35]
buffer_store_dwordx4 a[52:55], v28, s[12:15], 0 offen offset:2048 sc0 sc1 nt
buffer_load_dwordx4 v16, s[24:27], s31 offen nt lds
buffer_load_dwordx4 v17, s[24:27], s31 offen offset:1024 nt lds
v_mfma_f32_16x16x32_bf16 v[32:35], a[172:175], a[108:111], v[32:35]
s_add_u32 m0, s32, 49152
v_exp_f32 v36, v36
v_mfma_f32_16x16x32_bf16 v[192:195], a[192:195], v[76:79], v[192:195]
s_add_u32 s31, s29, 114688
v_exp_f32 v37, v37
v_mfma_f32_16x16x32_bf16 v[196:199], a[196:199], v[76:79], v[196:199]
v_exp_f32 v38, v38
v_mfma_f32_16x16x32_bf16 v[200:203], a[200:203], v[76:79], v[200:203]
v_exp_f32 v39, v39
v_mfma_f32_16x16x32_bf16 v[204:207], a[204:207], v[76:79], v[204:207]
v_cvt_pk_bf16_f32 v50, v36, v37
v_cvt_pk_bf16_f32 v51, v38, v39
v_mfma_f32_16x16x32_bf16 v[36:39], a[160:163], a[112:115], 0
ds_read_b128 a[176:179], v44 offset:4096
v_fmamk_f32 v40, v40, 0x3e0293ee, v23
v_mfma_f32_16x16x32_bf16 v[36:39], a[164:167], a[116:119], v[36:39]
v_exp_f32 v40, v40
v_mfma_f32_16x16x32_bf16 v[36:39], a[168:171], a[120:123], v[36:39]
ds_read_b128 a[180:183], v45 offset:4096
v_fmamk_f32 v41, v41, 0x3e0293ee, v23
v_mfma_f32_16x16x32_bf16 v[36:39], a[172:175], a[124:127], v[36:39]
v_exp_f32 v41, v41
v_mfma_f32_16x16x32_bf16 v[224:227], a[192:195], v[48:51], v[224:227]
ds_read_b128 a[184:187], v46 offset:4096
v_fmamk_f32 v42, v42, 0x3e0293ee, v23
v_mfma_f32_16x16x32_bf16 v[228:231], a[196:199], v[48:51], v[228:231]
v_exp_f32 v42, v42
v_mfma_f32_16x16x32_bf16 v[232:235], a[200:203], v[48:51], v[232:235]
ds_read_b128 a[188:191], v47 offset:4096
v_fmamk_f32 v43, v43, 0x3e0293ee, v23
v_mfma_f32_16x16x32_bf16 v[236:239], a[204:207], v[48:51], v[236:239]
v_exp_f32 v43, v43
v_mfma_f32_16x16x32_bf16 a[232:235], a[244:247], v[72:75], a[232:235]
s_waitcnt lgkmcnt(3)
v_cvt_pk_bf16_f32 v52, v40, v41
v_cvt_pk_bf16_f32 v53, v42, v43
v_mfma_f32_16x16x32_bf16 v[112:115], a[208:211], v[64:67], v[112:115]
v_fmamk_f32 v32, v32, 0x3e0293ee, v24
v_fmamk_f32 v33, v33, 0x3e0293ee, v24
v_mfma_f32_16x16x32_bf16 v[116:119], a[212:215], v[64:67], v[116:119]
v_exp_f32 v32, v32
v_mfma_f32_16x16x32_bf16 v[120:123], a[216:219], v[64:67], v[120:123]
v_exp_f32 v33, v33
v_mfma_f32_16x16x32_bf16 v[124:127], a[220:223], v[64:67], v[124:127]
v_fmamk_f32 v34, v34, 0x3e0293ee, v24
v_fmamk_f32 v35, v35, 0x3e0293ee, v24
v_mfma_f32_16x16x32_bf16 v[40:43], a[160:163], a[128:131], 0
v_exp_f32 v34, v34
v_mfma_f32_16x16x32_bf16 v[40:43], a[164:167], a[132:135], v[40:43]
v_exp_f32 v35, v35
v_mfma_f32_16x16x32_bf16 v[40:43], a[168:171], a[136:139], v[40:43]
v_cvt_pk_bf16_f32 v56, v32, v33
v_cvt_pk_bf16_f32 v57, v34, v35
v_mfma_f32_16x16x32_bf16 v[40:43], a[172:175], a[140:143], v[40:43]
v_fmamk_f32 v36, v36, 0x3e0293ee, v25
v_fmamk_f32 v37, v37, 0x3e0293ee, v25
v_mfma_f32_16x16x32_bf16 v[144:147], a[208:211], v[68:71], v[144:147]
v_exp_f32 v36, v36
v_mfma_f32_16x16x32_bf16 v[148:151], a[212:215], v[68:71], v[148:151]
v_exp_f32 v37, v37
v_mfma_f32_16x16x32_bf16 v[152:155], a[216:219], v[68:71], v[152:155]
v_fmamk_f32 v38, v38, 0x3e0293ee, v25
v_fmamk_f32 v39, v39, 0x3e0293ee, v25
v_mfma_f32_16x16x32_bf16 v[156:159], a[220:223], v[68:71], v[156:159]
v_exp_f32 v38, v38
v_mfma_f32_16x16x32_bf16 a[236:239], a[244:247], v[76:79], a[236:239]
s_waitcnt vmcnt(8) lgkmcnt(0)
v_exp_f32 v39, v39
v_mfma_f32_16x16x32_bf16 v[32:35], a[176:179], a[80:83], 0
s_barrier
v_cvt_pk_bf16_f32 v60, v36, v37
v_cvt_pk_bf16_f32 v61, v38, v39
v_mfma_f32_16x16x32_bf16 v[32:35], a[180:183], a[84:87], v[32:35]
ds_read_b64_tr_b16 a[192:193], v80 offset:0
v_fmamk_f32 v40, v40, 0x3e0293ee, v26
v_mfma_f32_16x16x32_bf16 v[32:35], a[184:187], a[88:91], v[32:35]
v_exp_f32 v40, v40
v_mfma_f32_16x16x32_bf16 v[32:35], a[188:191], a[92:95], v[32:35]
ds_read_b64_tr_b16 a[194:195], v80 offset:4096
v_fmamk_f32 v41, v41, 0x3e0293ee, v26
v_mfma_f32_16x16x32_bf16 v[176:179], a[208:211], v[72:75], v[176:179]
ds_read_b64_tr_b16 a[196:197], v81 offset:0
v_fmamk_f32 v42, v42, 0x3e0293ee, v26
v_mfma_f32_16x16x32_bf16 v[180:183], a[212:215], v[72:75], v[180:183]
ds_read_b64_tr_b16 a[198:199], v81 offset:4096
v_fmamk_f32 v43, v43, 0x3e0293ee, v26
v_mfma_f32_16x16x32_bf16 v[184:187], a[216:219], v[72:75], v[184:187]
buffer_store_dwordx4 a[56:59], v28, s[12:15], 0 offen offset:128 sc0 sc1 nt
buffer_load_dwordx4 v14, s[20:23], s30 offen nt lds
buffer_load_dwordx4 v15, s[20:23], s30 offen offset:1024 nt lds
v_mfma_f32_16x16x32_bf16 v[188:191], a[220:223], v[72:75], v[188:191]
s_add_u32 m0, s32, 114688
v_exp_f32 v41, v41
v_mfma_f32_16x16x32_bf16 v[36:39], a[176:179], a[96:99], 0
s_add_u32 s30, s29, 122880
v_exp_f32 v42, v42
v_mfma_f32_16x16x32_bf16 v[36:39], a[180:183], a[100:103], v[36:39]
v_exp_f32 v43, v43
v_mfma_f32_16x16x32_bf16 v[36:39], a[184:187], a[104:107], v[36:39]
ds_read_b64_tr_b16 a[200:201], v82 offset:0
v_cvt_pk_bf16_f32 v64, v40, v41
v_mfma_f32_16x16x32_bf16 v[36:39], a[188:191], a[108:111], v[36:39]
ds_read_b64_tr_b16 a[202:203], v82 offset:4096
v_cvt_pk_bf16_f32 v65, v42, v43
v_mfma_f32_16x16x32_bf16 v[208:211], a[208:211], v[76:79], v[208:211]
ds_read_b64_tr_b16 a[204:205], v83 offset:0
v_fmamk_f32 v32, v32, 0x3e0293ee, v23
v_mfma_f32_16x16x32_bf16 v[212:215], a[212:215], v[76:79], v[212:215]
v_exp_f32 v32, v32
v_mfma_f32_16x16x32_bf16 v[216:219], a[216:219], v[76:79], v[216:219]
ds_read_b64_tr_b16 a[206:207], v83 offset:4096
v_fmamk_f32 v33, v33, 0x3e0293ee, v23
v_mfma_f32_16x16x32_bf16 v[220:223], a[220:223], v[76:79], v[220:223]
v_exp_f32 v33, v33
v_mfma_f32_16x16x32_bf16 a[240:243], a[244:247], v[48:51], a[240:243]
ds_read_b128 a[160:163], v2 offset:16384
v_fmamk_f32 v34, v34, 0x3e0293ee, v23
v_mfma_f32_16x16x32_bf16 v[40:43], a[176:179], a[112:115], 0
v_exp_f32 v34, v34
v_mfma_f32_16x16x32_bf16 v[40:43], a[180:183], a[116:119], v[40:43]
ds_read_b128 a[164:167], v3 offset:16384
v_fmamk_f32 v35, v35, 0x3e0293ee, v23
v_mfma_f32_16x16x32_bf16 v[40:43], a[184:187], a[120:123], v[40:43]
v_exp_f32 v35, v35
v_mfma_f32_16x16x32_bf16 v[40:43], a[188:191], a[124:127], v[40:43]
ds_read_b128 a[168:171], v4 offset:16384
v_cvt_pk_bf16_f32 v54, v32, v33
v_mfma_f32_16x16x32_bf16 v[240:243], a[208:211], v[48:51], v[240:243]
ds_read_b128 a[172:175], v5 offset:16384
v_cvt_pk_bf16_f32 v55, v34, v35
v_mfma_f32_16x16x32_bf16 v[244:247], a[212:215], v[48:51], v[244:247]
v_fmamk_f32 v36, v36, 0x3e0293ee, v24
v_fmamk_f32 v37, v37, 0x3e0293ee, v24
v_mfma_f32_16x16x32_bf16 v[248:251], a[216:219], v[48:51], v[248:251]
v_exp_f32 v36, v36
v_mfma_f32_16x16x32_bf16 v[252:255], a[220:223], v[48:51], v[252:255]
v_exp_f32 v37, v37
v_mfma_f32_16x16x32_bf16 v[32:35], a[176:179], a[128:131], 0
v_fmamk_f32 v38, v38, 0x3e0293ee, v24
v_fmamk_f32 v39, v39, 0x3e0293ee, v24
v_mfma_f32_16x16x32_bf16 v[32:35], a[180:183], a[132:135], v[32:35]
v_exp_f32 v38, v38
v_mfma_f32_16x16x32_bf16 v[32:35], a[184:187], a[136:139], v[32:35]
v_exp_f32 v39, v39
v_mfma_f32_16x16x32_bf16 v[32:35], a[188:191], a[140:143], v[32:35]
s_waitcnt lgkmcnt(1)
v_cvt_pk_bf16_f32 v58, v36, v37
v_cvt_pk_bf16_f32 v59, v38, v39
v_mfma_f32_16x16x32_bf16 v[96:99], a[192:195], v[52:55], v[96:99]
v_fmamk_f32 v40, v40, 0x3e0293ee, v25
v_fmamk_f32 v41, v41, 0x3e0293ee, v25
v_mfma_f32_16x16x32_bf16 v[100:103], a[196:199], v[52:55], v[100:103]
v_exp_f32 v40, v40
v_mfma_f32_16x16x32_bf16 v[104:107], a[200:203], v[52:55], v[104:107]
v_exp_f32 v41, v41
v_mfma_f32_16x16x32_bf16 v[108:111], a[204:207], v[52:55], v[108:111]
v_fmamk_f32 v42, v42, 0x3e0293ee, v25
v_fmamk_f32 v43, v43, 0x3e0293ee, v25
v_mfma_f32_16x16x32_bf16 a[224:227], a[244:247], v[52:55], a[224:227]
v_exp_f32 v42, v42
v_mfma_f32_16x16x32_bf16 v[36:39], a[160:163], a[80:83], 0
v_exp_f32 v43, v43
v_mfma_f32_16x16x32_bf16 v[36:39], a[164:167], a[84:87], v[36:39]
v_cvt_pk_bf16_f32 v62, v40, v41
v_cvt_pk_bf16_f32 v63, v42, v43
v_mfma_f32_16x16x32_bf16 v[36:39], a[168:171], a[88:91], v[36:39]
s_waitcnt lgkmcnt(0)
ds_read_b64_tr_b16 a[208:209], v84 offset:0
v_fmamk_f32 v32, v32, 0x3e0293ee, v26
v_mfma_f32_16x16x32_bf16 v[36:39], a[172:175], a[92:95], v[36:39]
v_exp_f32 v32, v32
v_mfma_f32_16x16x32_bf16 v[128:131], a[192:195], v[56:59], v[128:131]
ds_read_b64_tr_b16 a[210:211], v84 offset:4096
v_fmamk_f32 v33, v33, 0x3e0293ee, v26
v_mfma_f32_16x16x32_bf16 v[132:135], a[196:199], v[56:59], v[132:135]
ds_read_b64_tr_b16 a[212:213], v85 offset:0
v_fmamk_f32 v34, v34, 0x3e0293ee, v26
v_mfma_f32_16x16x32_bf16 v[136:139], a[200:203], v[56:59], v[136:139]
ds_read_b64_tr_b16 a[214:215], v85 offset:4096
v_fmamk_f32 v35, v35, 0x3e0293ee, v26
v_mfma_f32_16x16x32_bf16 v[140:143], a[204:207], v[56:59], v[140:143]
buffer_store_dwordx4 a[60:63], v28, s[12:15], 0 offen offset:2176 sc0 sc1 nt
buffer_load_dwordx4 v16, s[24:27], s31 offen nt lds
buffer_load_dwordx4 v17, s[24:27], s31 offen offset:1024 nt lds
v_mfma_f32_16x16x32_bf16 v[40:43], a[160:163], a[96:99], 0
s_add_u32 m0, s32, 57344
v_exp_f32 v33, v33
v_mfma_f32_16x16x32_bf16 v[40:43], a[164:167], a[100:103], v[40:43]
s_add_u32 s31, s29, 122880
v_exp_f32 v34, v34
v_mfma_f32_16x16x32_bf16 v[40:43], a[168:171], a[104:107], v[40:43]
v_exp_f32 v35, v35
v_mfma_f32_16x16x32_bf16 v[40:43], a[172:175], a[108:111], v[40:43]
ds_read_b64_tr_b16 a[216:217], v86 offset:0
v_cvt_pk_bf16_f32 v66, v32, v33
v_mfma_f32_16x16x32_bf16 v[160:163], a[192:195], v[60:63], v[160:163]
ds_read_b64_tr_b16 a[218:219], v86 offset:4096
v_cvt_pk_bf16_f32 v67, v34, v35
v_mfma_f32_16x16x32_bf16 v[164:167], a[196:199], v[60:63], v[164:167]
ds_read_b64_tr_b16 a[220:221], v87 offset:0
v_fmamk_f32 v36, v36, 0x3e0293ee, v23
v_mfma_f32_16x16x32_bf16 v[168:171], a[200:203], v[60:63], v[168:171]
v_exp_f32 v36, v36
v_mfma_f32_16x16x32_bf16 v[172:175], a[204:207], v[60:63], v[172:175]
ds_read_b64_tr_b16 a[222:223], v87 offset:4096
v_fmamk_f32 v37, v37, 0x3e0293ee, v23
v_mfma_f32_16x16x32_bf16 a[228:231], a[244:247], v[56:59], a[228:231]
v_exp_f32 v37, v37
v_mfma_f32_16x16x32_bf16 v[32:35], a[160:163], a[112:115], 0
ds_read_b128 a[176:179], v2 offset:20480
v_fmamk_f32 v38, v38, 0x3e0293ee, v23
v_mfma_f32_16x16x32_bf16 v[32:35], a[164:167], a[116:119], v[32:35]
v_exp_f32 v38, v38
v_mfma_f32_16x16x32_bf16 v[32:35], a[168:171], a[120:123], v[32:35]
ds_read_b128 a[180:183], v3 offset:20480
v_fmamk_f32 v39, v39, 0x3e0293ee, v23
v_mfma_f32_16x16x32_bf16 v[32:35], a[172:175], a[124:127], v[32:35]
v_exp_f32 v39, v39
v_mfma_f32_16x16x32_bf16 v[192:195], a[192:195], v[64:67], v[192:195]
ds_read_b128 a[184:187], v4 offset:20480
v_cvt_pk_bf16_f32 v68, v36, v37
v_mfma_f32_16x16x32_bf16 v[196:199], a[196:199], v[64:67], v[196:199]
ds_read_b128 a[188:191], v5 offset:20480
v_cvt_pk_bf16_f32 v69, v38, v39
v_mfma_f32_16x16x32_bf16 v[200:203], a[200:203], v[64:67], v[200:203]
v_fmamk_f32 v40, v40, 0x3e0293ee, v24
v_fmamk_f32 v41, v41, 0x3e0293ee, v24
v_mfma_f32_16x16x32_bf16 v[204:207], a[204:207], v[64:67], v[204:207]
v_exp_f32 v40, v40
v_mfma_f32_16x16x32_bf16 v[36:39], a[160:163], a[128:131], 0
v_exp_f32 v41, v41
v_mfma_f32_16x16x32_bf16 v[36:39], a[164:167], a[132:135], v[36:39]
v_fmamk_f32 v42, v42, 0x3e0293ee, v24
v_fmamk_f32 v43, v43, 0x3e0293ee, v24
v_mfma_f32_16x16x32_bf16 v[36:39], a[168:171], a[136:139], v[36:39]
v_exp_f32 v42, v42
v_mfma_f32_16x16x32_bf16 v[36:39], a[172:175], a[140:143], v[36:39]
s_waitcnt lgkmcnt(2)
v_exp_f32 v43, v43
v_mfma_f32_16x16x32_bf16 v[112:115], a[208:211], v[52:55], v[112:115]
v_cvt_pk_bf16_f32 v72, v40, v41
v_cvt_pk_bf16_f32 v73, v42, v43
v_mfma_f32_16x16x32_bf16 v[116:119], a[212:215], v[52:55], v[116:119]
v_fmamk_f32 v32, v32, 0x3e0293ee, v25
v_fmamk_f32 v33, v33, 0x3e0293ee, v25
v_mfma_f32_16x16x32_bf16 v[120:123], a[216:219], v[52:55], v[120:123]
v_exp_f32 v32, v32
v_mfma_f32_16x16x32_bf16 v[124:127], a[220:223], v[52:55], v[124:127]
v_exp_f32 v33, v33
v_mfma_f32_16x16x32_bf16 a[232:235], a[244:247], v[60:63], a[232:235]
v_fmamk_f32 v34, v34, 0x3e0293ee, v25
v_fmamk_f32 v35, v35, 0x3e0293ee, v25
v_mfma_f32_16x16x32_bf16 v[40:43], a[160:163], a[144:147], 0
v_exp_f32 v34, v34
v_mfma_f32_16x16x32_bf16 v[40:43], a[164:167], a[148:151], v[40:43]
v_exp_f32 v35, v35
v_mfma_f32_16x16x32_bf16 v[40:43], a[168:171], a[152:155], v[40:43]
v_cvt_pk_bf16_f32 v76, v32, v33
v_cvt_pk_bf16_f32 v77, v34, v35
v_mfma_f32_16x16x32_bf16 v[40:43], a[172:175], a[156:159], v[40:43]
ds_read_b64_tr_b16 a[192:193], v6 offset:16384
v_fmamk_f32 v36, v36, 0x3e0293ee, v26
v_mfma_f32_16x16x32_bf16 v[144:147], a[208:211], v[56:59], v[144:147]
v_exp_f32 v36, v36
v_mfma_f32_16x16x32_bf16 v[148:151], a[212:215], v[56:59], v[148:151]
ds_read_b64_tr_b16 a[194:195], v6 offset:20480
v_fmamk_f32 v37, v37, 0x3e0293ee, v26
v_mfma_f32_16x16x32_bf16 v[152:155], a[216:219], v[56:59], v[152:155]
v_exp_f32 v37, v37
v_mfma_f32_16x16x32_bf16 v[156:159], a[220:223], v[56:59], v[156:159]
ds_read_b64_tr_b16 a[196:197], v7 offset:16384
v_fmamk_f32 v38, v38, 0x3e0293ee, v26
v_mfma_f32_16x16x32_bf16 v[32:35], a[176:179], a[80:83], 0
v_exp_f32 v38, v38
v_mfma_f32_16x16x32_bf16 v[32:35], a[180:183], a[84:87], v[32:35]
s_waitcnt lgkmcnt(3)
ds_read_b64_tr_b16 a[198:199], v7 offset:20480
v_fmamk_f32 v39, v39, 0x3e0293ee, v26
v_mfma_f32_16x16x32_bf16 v[32:35], a[184:187], a[88:91], v[32:35]
v_exp_f32 v39, v39
v_mfma_f32_16x16x32_bf16 v[32:35], a[188:191], a[92:95], v[32:35]
ds_read_b64_tr_b16 a[200:201], v8 offset:16384
v_cvt_pk_bf16_f32 v48, v36, v37
v_mfma_f32_16x16x32_bf16 v[176:179], a[208:211], v[60:63], v[176:179]
ds_read_b64_tr_b16 a[202:203], v8 offset:20480
v_cvt_pk_bf16_f32 v49, v38, v39
v_mfma_f32_16x16x32_bf16 v[180:183], a[212:215], v[60:63], v[180:183]
ds_read_b64_tr_b16 a[204:205], v9 offset:16384
v_fmamk_f32 v40, v40, 0x3e0293ee, v27
v_mfma_f32_16x16x32_bf16 v[184:187], a[216:219], v[60:63], v[184:187]
v_exp_f32 v40, v40
v_mfma_f32_16x16x32_bf16 v[188:191], a[220:223], v[60:63], v[188:191]
ds_read_b64_tr_b16 a[206:207], v9 offset:20480
v_fmamk_f32 v41, v41, 0x3e0293ee, v27
v_mfma_f32_16x16x32_bf16 a[236:239], a[244:247], v[64:67], a[236:239]
v_exp_f32 v41, v41
v_mfma_f32_16x16x32_bf16 v[36:39], a[176:179], a[96:99], 0
v_fmamk_f32 v42, v42, 0x3e0293ee, v27
v_fmamk_f32 v43, v43, 0x3e0293ee, v27
v_mfma_f32_16x16x32_bf16 v[36:39], a[180:183], a[100:103], v[36:39]
v_exp_f32 v42, v42
v_mfma_f32_16x16x32_bf16 v[36:39], a[184:187], a[104:107], v[36:39]
v_exp_f32 v43, v43
v_mfma_f32_16x16x32_bf16 v[36:39], a[188:191], a[108:111], v[36:39]
v_cvt_pk_bf16_f32 v52, v40, v41
v_cvt_pk_bf16_f32 v53, v42, v43
v_mfma_f32_16x16x32_bf16 v[208:211], a[208:211], v[64:67], v[208:211]
ds_read_b128 a[160:163], v44 offset:16384
v_add_u32 v28, s38, v19
v_mfma_f32_16x16x32_bf16 v[212:215], a[212:215], v[64:67], v[212:215]
s_mov_b32 s38, s73
ds_read_b128 a[164:167], v45 offset:16384
v_fmamk_f32 v32, v32, 0x3e0293ee, v23
v_mfma_f32_16x16x32_bf16 v[216:219], a[216:219], v[64:67], v[216:219]
s_add_u32 s38, s38, s76
v_fmamk_f32 v33, v33, 0x3e0293ee, v23
v_fmamk_f32 v34, v34, 0x3e0293ee, v23
v_mfma_f32_16x16x32_bf16 v[220:223], a[220:223], v[64:67], v[220:223]
ds_read_b128 a[168:171], v46 offset:16384
v_fmamk_f32 v35, v35, 0x3e0293ee, v23
v_mfma_f32_16x16x32_bf16 v[40:43], a[176:179], a[112:115], 0
buffer_store_dwordx4 a[64:67], v28, s[12:15], 0 offen offset:0 sc0 sc1 nt
buffer_load_dwordx4 v14, s[20:23], s30 offen nt lds
buffer_load_dwordx4 v15, s[20:23], s30 offen offset:1024 nt lds
v_mfma_f32_16x16x32_bf16 v[40:43], a[180:183], a[116:119], v[40:43]
s_add_u32 m0, s32, 122880
v_exp_f32 v32, v32
v_mfma_f32_16x16x32_bf16 v[40:43], a[184:187], a[120:123], v[40:43]
v_exp_f32 v33, v33
v_exp_f32 v34, v34
v_exp_f32 v35, v35
v_mfma_f32_16x16x32_bf16 v[40:43], a[188:191], a[124:127], v[40:43]
v_cvt_pk_bf16_f32 v70, v32, v33
v_cvt_pk_bf16_f32 v71, v34, v35
v_mfma_f32_16x16x32_bf16 v[32:35], a[176:179], a[128:131], 0
ds_read_b128 a[172:175], v47 offset:16384
v_fmamk_f32 v36, v36, 0x3e0293ee, v24
v_mfma_f32_16x16x32_bf16 v[32:35], a[180:183], a[132:135], v[32:35]
v_exp_f32 v36, v36
v_mfma_f32_16x16x32_bf16 v[32:35], a[184:187], a[136:139], v[32:35]
v_fmamk_f32 v37, v37, 0x3e0293ee, v24
v_fmamk_f32 v38, v38, 0x3e0293ee, v24
v_mfma_f32_16x16x32_bf16 v[32:35], a[188:191], a[140:143], v[32:35]
s_waitcnt lgkmcnt(1)
v_exp_f32 v37, v37
v_mfma_f32_16x16x32_bf16 v[96:99], a[192:195], v[68:71], v[96:99]
v_exp_f32 v38, v38
v_mfma_f32_16x16x32_bf16 v[100:103], a[196:199], v[68:71], v[100:103]
v_fmamk_f32 v39, v39, 0x3e0293ee, v24
v_cvt_pk_bf16_f32 v74, v36, v37
v_mfma_f32_16x16x32_bf16 v[104:107], a[200:203], v[68:71], v[104:107]
v_exp_f32 v39, v39
v_mfma_f32_16x16x32_bf16 v[108:111], a[204:207], v[68:71], v[108:111]
v_cvt_pk_bf16_f32 v75, v38, v39
v_fmamk_f32 v40, v40, 0x3e0293ee, v25
v_mfma_f32_16x16x32_bf16 a[224:227], a[244:247], v[68:71], a[224:227]
L_pad0_11:
s_cbranch_execz L_back
v_exp_f32 v40, v40
v_mfma_f32_16x16x32_bf16 v[36:39], a[176:179], a[144:147], 0
v_fmamk_f32 v41, v41, 0x3e0293ee, v25
v_fmamk_f32 v42, v42, 0x3e0293ee, v25
v_mfma_f32_16x16x32_bf16 v[36:39], a[180:183], a[148:151], v[36:39]
v_exp_f32 v41, v41
v_mfma_f32_16x16x32_bf16 v[36:39], a[184:187], a[152:155], v[36:39]
v_exp_f32 v42, v42
v_mfma_f32_16x16x32_bf16 v[36:39], a[188:191], a[156:159], v[36:39]
v_fmamk_f32 v43, v43, 0x3e0293ee, v25
v_cvt_pk_bf16_f32 v78, v40, v41
v_mfma_f32_16x16x32_bf16 v[128:131], a[192:195], v[72:75], v[128:131]
v_exp_f32 v43, v43
v_mfma_f32_16x16x32_bf16 v[132:135], a[196:199], v[72:75], v[132:135]
ds_read_b64_tr_b16 a[208:209], v10 offset:16384
v_cvt_pk_bf16_f32 v79, v42, v43
v_mfma_f32_16x16x32_bf16 v[136:139], a[200:203], v[72:75], v[136:139]
ds_read_b64_tr_b16 a[210:211], v10 offset:20480
v_fmamk_f32 v32, v32, 0x3e0293ee, v26
v_mfma_f32_16x16x32_bf16 v[140:143], a[204:207], v[72:75], v[140:143]
v_exp_f32 v32, v32
v_mfma_f32_16x16x32_bf16 v[40:43], a[160:163], a[80:83], 0
ds_read_b64_tr_b16 a[212:213], v11 offset:16384
v_fmamk_f32 v33, v33, 0x3e0293ee, v26
v_mfma_f32_16x16x32_bf16 v[40:43], a[164:167], a[84:87], v[40:43]
v_exp_f32 v33, v33
v_mfma_f32_16x16x32_bf16 v[40:43], a[168:171], a[88:91], v[40:43]
s_waitcnt lgkmcnt(3)
ds_read_b64_tr_b16 a[214:215], v11 offset:20480
v_fmamk_f32 v34, v34, 0x3e0293ee, v26
v_mfma_f32_16x16x32_bf16 v[40:43], a[172:175], a[92:95], v[40:43]
v_exp_f32 v34, v34
v_mfma_f32_16x16x32_bf16 v[160:163], a[192:195], v[76:79], v[160:163]
ds_read_b64_tr_b16 a[216:217], v12 offset:16384
v_fmamk_f32 v35, v35, 0x3e0293ee, v26
v_mfma_f32_16x16x32_bf16 v[164:167], a[196:199], v[76:79], v[164:167]
v_exp_f32 v35, v35
v_mfma_f32_16x16x32_bf16 v[168:171], a[200:203], v[76:79], v[168:171]
ds_read_b64_tr_b16 a[218:219], v12 offset:20480
v_cvt_pk_bf16_f32 v50, v32, v33
v_mfma_f32_16x16x32_bf16 v[172:175], a[204:207], v[76:79], v[172:175]
ds_read_b64_tr_b16 a[220:221], v13 offset:16384
v_cvt_pk_bf16_f32 v51, v34, v35
v_mfma_f32_16x16x32_bf16 a[228:231], a[244:247], v[72:75], a[228:231]
ds_read_b64_tr_b16 a[222:223], v13 offset:20480
v_fmamk_f32 v36, v36, 0x3e0293ee, v27
v_mfma_f32_16x16x32_bf16 v[32:35], a[160:163], a[96:99], 0
v_fmamk_f32 v37, v37, 0x3e0293ee, v27
v_fmamk_f32 v38, v38, 0x3e0293ee, v27
v_mfma_f32_16x16x32_bf16 v[32:35], a[164:167], a[100:103], v[32:35]
ds_read_b128 a[176:179], v44 offset:20480
v_fmamk_f32 v39, v39, 0x3e0293ee, v27
v_mfma_f32_16x16x32_bf16 v[32:35], a[168:171], a[104:107], v[32:35]
buffer_store_dwordx4 a[68:71], v28, s[12:15], 0 offen offset:2048 sc0 sc1 nt
buffer_load_dwordx4 v16, s[24:27], s31 offen nt lds
buffer_load_dwordx4 v17, s[24:27], s31 offen offset:1024 nt lds
v_mfma_f32_16x16x32_bf16 v[32:35], a[172:175], a[108:111], v[32:35]
v_exp_f32 v36, v36
v_mfma_f32_16x16x32_bf16 v[192:195], a[192:195], v[48:51], v[192:195]
v_exp_f32 v37, v37
v_mfma_f32_16x16x32_bf16 v[196:199], a[196:199], v[48:51], v[196:199]
v_exp_f32 v38, v38
v_mfma_f32_16x16x32_bf16 v[200:203], a[200:203], v[48:51], v[200:203]
v_exp_f32 v39, v39
v_mfma_f32_16x16x32_bf16 v[204:207], a[204:207], v[48:51], v[204:207]
v_cvt_pk_bf16_f32 v54, v36, v37
v_cvt_pk_bf16_f32 v55, v38, v39
v_mfma_f32_16x16x32_bf16 v[36:39], a[160:163], a[112:115], 0
ds_read_b128 a[180:183], v45 offset:20480
v_fmamk_f32 v40, v40, 0x3e0293ee, v23
v_mfma_f32_16x16x32_bf16 v[36:39], a[164:167], a[116:119], v[36:39]
v_exp_f32 v40, v40
v_mfma_f32_16x16x32_bf16 v[36:39], a[168:171], a[120:123], v[36:39]
ds_read_b128 a[184:187], v46 offset:20480
v_fmamk_f32 v41, v41, 0x3e0293ee, v23
v_mfma_f32_16x16x32_bf16 v[36:39], a[172:175], a[124:127], v[36:39]
v_exp_f32 v41, v41
v_mfma_f32_16x16x32_bf16 v[224:227], a[192:195], v[52:55], v[224:227]
ds_read_b128 a[188:191], v47 offset:20480
v_fmamk_f32 v42, v42, 0x3e0293ee, v23
v_mfma_f32_16x16x32_bf16 v[228:231], a[196:199], v[52:55], v[228:231]
v_exp_f32 v42, v42
v_mfma_f32_16x16x32_bf16 v[232:235], a[200:203], v[52:55], v[232:235]
v_fmamk_f32 v43, v43, 0x3e0293ee, v23
v_cvt_pk_bf16_f32 v56, v40, v41
v_mfma_f32_16x16x32_bf16 v[236:239], a[204:207], v[52:55], v[236:239]
v_exp_f32 v43, v43
v_mfma_f32_16x16x32_bf16 a[232:235], a[244:247], v[76:79], a[232:235]
s_waitcnt lgkmcnt(2)
v_cvt_pk_bf16_f32 v57, v42, v43
v_fmamk_f32 v32, v32, 0x3e0293ee, v24
v_mfma_f32_16x16x32_bf16 v[112:115], a[208:211], v[68:71], v[112:115]
v_exp_f32 v32, v32
v_mfma_f32_16x16x32_bf16 v[116:119], a[212:215], v[68:71], v[116:119]
v_fmamk_f32 v33, v33, 0x3e0293ee, v24
v_fmamk_f32 v34, v34, 0x3e0293ee, v24
v_mfma_f32_16x16x32_bf16 v[120:123], a[216:219], v[68:71], v[120:123]
v_exp_f32 v33, v33
v_mfma_f32_16x16x32_bf16 v[124:127], a[220:223], v[68:71], v[124:127]
v_exp_f32 v34, v34
v_mfma_f32_16x16x32_bf16 v[40:43], a[160:163], a[128:131], 0
v_fmamk_f32 v35, v35, 0x3e0293ee, v24
v_cvt_pk_bf16_f32 v60, v32, v33
v_mfma_f32_16x16x32_bf16 v[40:43], a[164:167], a[132:135], v[40:43]
v_exp_f32 v35, v35
v_mfma_f32_16x16x32_bf16 v[40:43], a[168:171], a[136:139], v[40:43]
v_cvt_pk_bf16_f32 v61, v34, v35
v_fmamk_f32 v36, v36, 0x3e0293ee, v25
v_mfma_f32_16x16x32_bf16 v[40:43], a[172:175], a[140:143], v[40:43]
v_exp_f32 v36, v36
v_mfma_f32_16x16x32_bf16 v[144:147], a[208:211], v[72:75], v[144:147]
v_fmamk_f32 v37, v37, 0x3e0293ee, v25
v_fmamk_f32 v38, v38, 0x3e0293ee, v25
v_mfma_f32_16x16x32_bf16 v[148:151], a[212:215], v[72:75], v[148:151]
v_exp_f32 v37, v37
v_mfma_f32_16x16x32_bf16 v[152:155], a[216:219], v[72:75], v[152:155]
v_exp_f32 v38, v38
v_mfma_f32_16x16x32_bf16 v[156:159], a[220:223], v[72:75], v[156:159]
v_fmamk_f32 v39, v39, 0x3e0293ee, v25
v_cvt_pk_bf16_f32 v64, v36, v37
v_mfma_f32_16x16x32_bf16 a[236:239], a[244:247], v[48:51], a[236:239]
s_waitcnt vmcnt(8) lgkmcnt(0)
v_exp_f32 v39, v39
v_mfma_f32_16x16x32_bf16 v[32:35], a[176:179], a[80:83], 0
s_barrier
ds_read_b64_tr_b16 a[192:193], v80 offset:16384
v_cvt_pk_bf16_f32 v65, v38, v39
v_mfma_f32_16x16x32_bf16 v[32:35], a[180:183], a[84:87], v[32:35]
ds_read_b64_tr_b16 a[194:195], v80 offset:20480
v_fmamk_f32 v40, v40, 0x3e0293ee, v26
v_mfma_f32_16x16x32_bf16 v[32:35], a[184:187], a[88:91], v[32:35]
v_exp_f32 v40, v40
v_mfma_f32_16x16x32_bf16 v[32:35], a[188:191], a[92:95], v[32:35]
ds_read_b64_tr_b16 a[196:197], v81 offset:16384
v_fmamk_f32 v41, v41, 0x3e0293ee, v26
v_mfma_f32_16x16x32_bf16 v[176:179], a[208:211], v[76:79], v[176:179]
v_exp_f32 v41, v41
v_mfma_f32_16x16x32_bf16 v[180:183], a[212:215], v[76:79], v[180:183]
ds_read_b64_tr_b16 a[198:199], v81 offset:20480
v_fmamk_f32 v42, v42, 0x3e0293ee, v26
v_mfma_f32_16x16x32_bf16 v[184:187], a[216:219], v[76:79], v[184:187]
v_exp_f32 v42, v42
v_mfma_f32_16x16x32_bf16 v[188:191], a[220:223], v[76:79], v[188:191]
ds_read_b64_tr_b16 a[200:201], v82 offset:16384
v_fmamk_f32 v43, v43, 0x3e0293ee, v26
v_mfma_f32_16x16x32_bf16 v[36:39], a[176:179], a[96:99], 0
v_exp_f32 v43, v43
v_mfma_f32_16x16x32_bf16 v[36:39], a[180:183], a[100:103], v[36:39]
ds_read_b64_tr_b16 a[202:203], v82 offset:20480
v_cvt_pk_bf16_f32 v68, v40, v41
v_mfma_f32_16x16x32_bf16 v[36:39], a[184:187], a[104:107], v[36:39]
ds_read_b64_tr_b16 a[204:205], v83 offset:16384
v_cvt_pk_bf16_f32 v69, v42, v43
v_mfma_f32_16x16x32_bf16 v[36:39], a[188:191], a[108:111], v[36:39]
ds_read_b64_tr_b16 a[206:207], v83 offset:20480
v_fmamk_f32 v32, v32, 0x3e0293ee, v23
v_mfma_f32_16x16x32_bf16 v[208:211], a[208:211], v[48:51], v[208:211]
v_exp_f32 v32, v32
v_mfma_f32_16x16x32_bf16 v[212:215], a[212:215], v[48:51], v[212:215]
ds_read_b128 a[160:163], v2 offset:32768
v_fmamk_f32 v33, v33, 0x3e0293ee, v23
v_mfma_f32_16x16x32_bf16 v[216:219], a[216:219], v[48:51], v[216:219]
v_exp_f32 v33, v33
v_mfma_f32_16x16x32_bf16 v[220:223], a[220:223], v[48:51], v[220:223]
ds_read_b128 a[164:167], v3 offset:32768
v_fmamk_f32 v34, v34, 0x3e0293ee, v23
v_mfma_f32_16x16x32_bf16 a[240:243], a[244:247], v[52:55], a[240:243]
v_exp_f32 v34, v34
v_mfma_f32_16x16x32_bf16 v[40:43], a[176:179], a[112:115], 0
ds_read_b128 a[168:171], v4 offset:32768
v_fmamk_f32 v35, v35, 0x3e0293ee, v23
v_mfma_f32_16x16x32_bf16 v[40:43], a[180:183], a[116:119], v[40:43]
v_exp_f32 v35, v35
v_mfma_f32_16x16x32_bf16 v[40:43], a[184:187], a[120:123], v[40:43]
ds_read_b128 a[172:175], v5 offset:32768
v_cvt_pk_bf16_f32 v58, v32, v33
v_mfma_f32_16x16x32_bf16 v[40:43], a[188:191], a[124:127], v[40:43]
v_cvt_pk_bf16_f32 v59, v34, v35
v_fmamk_f32 v36, v36, 0x3e0293ee, v24
v_mfma_f32_16x16x32_bf16 v[240:243], a[208:211], v[52:55], v[240:243]
v_exp_f32 v36, v36
v_mfma_f32_16x16x32_bf16 v[244:247], a[212:215], v[52:55], v[244:247]
v_fmamk_f32 v37, v37, 0x3e0293ee, v24
v_fmamk_f32 v38, v38, 0x3e0293ee, v24
v_mfma_f32_16x16x32_bf16 v[248:251], a[216:219], v[52:55], v[248:251]
v_exp_f32 v37, v37
v_mfma_f32_16x16x32_bf16 v[252:255], a[220:223], v[52:55], v[252:255]
v_exp_f32 v38, v38
v_mfma_f32_16x16x32_bf16 v[32:35], a[176:179], a[128:131], 0
v_fmamk_f32 v39, v39, 0x3e0293ee, v24
v_cvt_pk_bf16_f32 v62, v36, v37
v_mfma_f32_16x16x32_bf16 v[32:35], a[180:183], a[132:135], v[32:35]
v_exp_f32 v39, v39
v_mfma_f32_16x16x32_bf16 v[32:35], a[184:187], a[136:139], v[32:35]
ds_read_b64_tr_b16 a[208:209], v84 offset:16384
v_cvt_pk_bf16_f32 v63, v38, v39
v_mfma_f32_16x16x32_bf16 v[32:35], a[188:191], a[140:143], v[32:35]
s_waitcnt lgkmcnt(1)
ds_read_b64_tr_b16 a[210:211], v84 offset:20480
v_fmamk_f32 v40, v40, 0x3e0293ee, v25
v_mfma_f32_16x16x32_bf16 v[96:99], a[192:195], v[56:59], v[96:99]
v_exp_f32 v40, v40
v_mfma_f32_16x16x32_bf16 v[100:103], a[196:199], v[56:59], v[100:103]
ds_read_b64_tr_b16 a[212:213], v85 offset:16384
v_fmamk_f32 v41, v41, 0x3e0293ee, v25
v_mfma_f32_16x16x32_bf16 v[104:107], a[200:203], v[56:59], v[104:107]
v_exp_f32 v41, v41
v_mfma_f32_16x16x32_bf16 v[108:111], a[204:207], v[56:59], v[108:111]
ds_read_b64_tr_b16 a[214:215], v85 offset:20480
v_fmamk_f32 v42, v42, 0x3e0293ee, v25
v_mfma_f32_16x16x32_bf16 a[224:227], a[244:247], v[56:59], a[224:227]
v_exp_f32 v42, v42
v_mfma_f32_16x16x32_bf16 v[36:39], a[160:163], a[144:147], 0
ds_read_b64_tr_b16 a[216:217], v86 offset:16384
v_fmamk_f32 v43, v43, 0x3e0293ee, v25
v_mfma_f32_16x16x32_bf16 v[36:39], a[164:167], a[148:151], v[36:39]
v_exp_f32 v43, v43
v_mfma_f32_16x16x32_bf16 v[36:39], a[168:171], a[152:155], v[36:39]
ds_read_b64_tr_b16 a[218:219], v86 offset:20480
v_cvt_pk_bf16_f32 v66, v40, v41
v_mfma_f32_16x16x32_bf16 v[36:39], a[172:175], a[156:159], v[36:39]
ds_read_b64_tr_b16 a[220:221], v87 offset:16384
v_cvt_pk_bf16_f32 v67, v42, v43
v_mfma_f32_16x16x32_bf16 v[128:131], a[192:195], v[60:63], v[128:131]
ds_read_b64_tr_b16 a[222:223], v87 offset:20480
v_fmamk_f32 v32, v32, 0x3e0293ee, v26
v_mfma_f32_16x16x32_bf16 v[132:135], a[196:199], v[60:63], v[132:135]
v_exp_f32 v32, v32
v_mfma_f32_16x16x32_bf16 v[136:139], a[200:203], v[60:63], v[136:139]
ds_read_b128 a[176:179], v2 offset:36864
v_fmamk_f32 v33, v33, 0x3e0293ee, v26
v_mfma_f32_16x16x32_bf16 v[140:143], a[204:207], v[60:63], v[140:143]
v_exp_f32 v33, v33
v_mfma_f32_16x16x32_bf16 v[40:43], a[160:163], a[80:83], 0
ds_read_b128 a[180:183], v3 offset:36864
v_fmamk_f32 v34, v34, 0x3e0293ee, v26
v_mfma_f32_16x16x32_bf16 v[40:43], a[164:167], a[84:87], v[40:43]
v_exp_f32 v34, v34
v_mfma_f32_16x16x32_bf16 v[40:43], a[168:171], a[88:91], v[40:43]
buffer_store_dwordx4 a[72:75], v28, s[12:15], 0 offen offset:128 sc0 sc1 nt
v_fmamk_f32 v35, v35, 0x3e0293ee, v26
v_mfma_f32_16x16x32_bf16 v[40:43], a[172:175], a[92:95], v[40:43]
v_exp_f32 v35, v35
v_mfma_f32_16x16x32_bf16 v[160:163], a[192:195], v[64:67], v[160:163]
ds_read_b128 a[184:187], v4 offset:36864
v_cvt_pk_bf16_f32 v70, v32, v33
v_mfma_f32_16x16x32_bf16 v[164:167], a[196:199], v[64:67], v[164:167]
ds_read_b128 a[188:191], v5 offset:36864
v_cvt_pk_bf16_f32 v71, v34, v35
v_mfma_f32_16x16x32_bf16 v[168:171], a[200:203], v[64:67], v[168:171]
v_fmamk_f32 v36, v36, 0x3e0293ee, v27
v_fmamk_f32 v37, v37, 0x3e0293ee, v27
v_mfma_f32_16x16x32_bf16 v[172:175], a[204:207], v[64:67], v[172:175]
v_exp_f32 v36, v36
v_mfma_f32_16x16x32_bf16 a[228:231], a[244:247], v[60:63], a[228:231]
v_exp_f32 v37, v37
v_mfma_f32_16x16x32_bf16 v[32:35], a[160:163], a[96:99], 0
v_fmamk_f32 v38, v38, 0x3e0293ee, v27
v_fmamk_f32 v39, v39, 0x3e0293ee, v27
v_mfma_f32_16x16x32_bf16 v[32:35], a[164:167], a[100:103], v[32:35]
v_exp_f32 v38, v38
v_mfma_f32_16x16x32_bf16 v[32:35], a[168:171], a[104:107], v[32:35]
v_exp_f32 v39, v39
v_mfma_f32_16x16x32_bf16 v[32:35], a[172:175], a[108:111], v[32:35]
v_cvt_pk_bf16_f32 v72, v36, v37
v_cvt_pk_bf16_f32 v73, v38, v39
v_mfma_f32_16x16x32_bf16 v[192:195], a[192:195], v[68:71], v[192:195]
ds_read_b128 a[160:163], v44 offset:32768
v_fmamk_f32 v40, v40, 0x3e0293ee, v23
v_mfma_f32_16x16x32_bf16 v[196:199], a[196:199], v[68:71], v[196:199]
v_exp_f32 v40, v40
v_mfma_f32_16x16x32_bf16 v[200:203], a[200:203], v[68:71], v[200:203]
ds_read_b128 a[164:167], v45 offset:32768
v_fmamk_f32 v41, v41, 0x3e0293ee, v23
v_mfma_f32_16x16x32_bf16 v[204:207], a[204:207], v[68:71], v[204:207]
s_waitcnt lgkmcnt(2)
v_exp_f32 v41, v41
v_mfma_f32_16x16x32_bf16 v[112:115], a[208:211], v[56:59], v[112:115]
buffer_store_dwordx4 a[76:79], v28, s[12:15], 0 offen offset:2176 sc0 sc1 nt
v_fmamk_f32 v42, v42, 0x3e0293ee, v23
v_mfma_f32_16x16x32_bf16 v[116:119], a[212:215], v[56:59], v[116:119]
v_exp_f32 v42, v42
v_mfma_f32_16x16x32_bf16 v[120:123], a[216:219], v[56:59], v[120:123]
ds_read_b128 a[168:171], v46 offset:32768
v_fmamk_f32 v43, v43, 0x3e0293ee, v23
v_mfma_f32_16x16x32_bf16 v[124:127], a[220:223], v[56:59], v[124:127]
v_exp_f32 v43, v43
v_mfma_f32_16x16x32_bf16 a[232:235], a[244:247], v[64:67], a[232:235]
v_cvt_pk_bf16_f32 v76, v40, v41
v_cvt_pk_bf16_f32 v77, v42, v43
v_mfma_f32_16x16x32_bf16 v[36:39], a[176:179], a[144:147], 0
ds_read_b128 a[172:175], v47 offset:32768
v_fmamk_f32 v32, v32, 0x3e0293ee, v24
v_mfma_f32_16x16x32_bf16 v[36:39], a[180:183], a[148:151], v[36:39]
v_exp_f32 v32, v32
v_mfma_f32_16x16x32_bf16 v[36:39], a[184:187], a[152:155], v[36:39]
ds_read_b64_tr_b16 a[192:193], v6 offset:32768
v_fmamk_f32 v33, v33, 0x3e0293ee, v24
v_mfma_f32_16x16x32_bf16 v[36:39], a[188:191], a[156:159], v[36:39]
v_exp_f32 v33, v33
v_mfma_f32_16x16x32_bf16 v[144:147], a[208:211], v[60:63], v[144:147]
ds_read_b64_tr_b16 a[194:195], v6 offset:36864
v_fmamk_f32 v34, v34, 0x3e0293ee, v24
v_mfma_f32_16x16x32_bf16 v[148:151], a[212:215], v[60:63], v[148:151]
v_exp_f32 v34, v34
v_mfma_f32_16x16x32_bf16 v[152:155], a[216:219], v[60:63], v[152:155]
ds_read_b64_tr_b16 a[196:197], v7 offset:32768
v_fmamk_f32 v35, v35, 0x3e0293ee, v24
v_mfma_f32_16x16x32_bf16 v[156:159], a[220:223], v[60:63], v[156:159]
v_exp_f32 v35, v35
v_mfma_f32_16x16x32_bf16 v[40:43], a[176:179], a[80:83], 0
ds_read_b64_tr_b16 a[198:199], v7 offset:36864
v_cvt_pk_bf16_f32 v48, v32, v33
v_mfma_f32_16x16x32_bf16 v[40:43], a[180:183], a[84:87], v[40:43]
ds_read_b64_tr_b16 a[200:201], v8 offset:32768
v_cvt_pk_bf16_f32 v49, v34, v35
v_mfma_f32_16x16x32_bf16 v[40:43], a[184:187], a[88:91], v[40:43]
ds_read_b64_tr_b16 a[202:203], v8 offset:36864
v_fmamk_f32 v36, v36, 0x3e0293ee, v27
v_mfma_f32_16x16x32_bf16 v[40:43], a[188:191], a[92:95], v[40:43]
v_exp_f32 v36, v36
v_mfma_f32_16x16x32_bf16 v[176:179], a[208:211], v[64:67], v[176:179]
ds_read_b64_tr_b16 a[204:205], v9 offset:32768
v_fmamk_f32 v37, v37, 0x3e0293ee, v27
v_mfma_f32_16x16x32_bf16 v[180:183], a[212:215], v[64:67], v[180:183]
v_exp_f32 v37, v37
v_mfma_f32_16x16x32_bf16 v[184:187], a[216:219], v[64:67], v[184:187]
ds_read_b64_tr_b16 a[206:207], v9 offset:36864
v_fmamk_f32 v38, v38, 0x3e0293ee, v27
v_mfma_f32_16x16x32_bf16 v[188:191], a[220:223], v[64:67], v[188:191]
v_exp_f32 v38, v38
v_mfma_f32_16x16x32_bf16 a[236:239], a[244:247], v[68:71], a[236:239]
v_fmamk_f32 v39, v39, 0x3e0293ee, v27
v_cvt_pk_bf16_f32 v74, v36, v37
v_mfma_f32_16x16x32_bf16 v[32:35], a[176:179], a[96:99], 0
v_exp_f32 v39, v39
v_mfma_f32_16x16x32_bf16 v[32:35], a[180:183], a[100:103], v[32:35]
ds_read_b128 a[176:179], v44 offset:36864
v_cvt_pk_bf16_f32 v75, v38, v39
v_mfma_f32_16x16x32_bf16 v[32:35], a[184:187], a[104:107], v[32:35]
ds_read_b128 a[180:183], v45 offset:36864
v_fmamk_f32 v40, v40, 0x3e0293ee, v23
v_mfma_f32_16x16x32_bf16 v[32:35], a[188:191], a[108:111], v[32:35]
v_exp_f32 v40, v40
v_mfma_f32_16x16x32_bf16 v[208:211], a[208:211], v[68:71], v[208:211]
ds_read_b128 a[184:187], v46 offset:36864
v_fmamk_f32 v41, v41, 0x3e0293ee, v23
v_mfma_f32_16x16x32_bf16 v[212:215], a[212:215], v[68:71], v[212:215]
v_exp_f32 v41, v41
v_mfma_f32_16x16x32_bf16 v[216:219], a[216:219], v[68:71], v[216:219]
ds_read_b128 a[188:191], v47 offset:36864
v_fmamk_f32 v42, v42, 0x3e0293ee, v23
v_mfma_f32_16x16x32_bf16 v[220:223], a[220:223], v[68:71], v[220:223]
s_waitcnt lgkmcnt(4)
v_exp_f32 v42, v42
v_mfma_f32_16x16x32_bf16 v[36:39], a[160:163], a[80:83], 0
ds_read_b64_tr_b16 a[208:209], v10 offset:32768
v_fmamk_f32 v43, v43, 0x3e0293ee, v23
v_mfma_f32_16x16x32_bf16 v[36:39], a[164:167], a[84:87], v[36:39]
v_exp_f32 v43, v43
v_mfma_f32_16x16x32_bf16 v[36:39], a[168:171], a[88:91], v[36:39]
ds_read_b64_tr_b16 a[210:211], v10 offset:36864
v_cvt_pk_bf16_f32 v78, v40, v41
v_mfma_f32_16x16x32_bf16 v[36:39], a[172:175], a[92:95], v[36:39]
ds_read_b64_tr_b16 a[212:213], v11 offset:32768
v_cvt_pk_bf16_f32 v79, v42, v43
v_mfma_f32_16x16x32_bf16 v[224:227], a[192:195], v[72:75], v[224:227]
ds_read_b64_tr_b16 a[214:215], v11 offset:36864
v_fmamk_f32 v32, v32, 0x3e0293ee, v24
v_mfma_f32_16x16x32_bf16 v[228:231], a[196:199], v[72:75], v[228:231]
v_exp_f32 v32, v32
v_mfma_f32_16x16x32_bf16 v[232:235], a[200:203], v[72:75], v[232:235]
ds_read_b64_tr_b16 a[216:217], v12 offset:32768
v_fmamk_f32 v33, v33, 0x3e0293ee, v24
v_mfma_f32_16x16x32_bf16 v[236:239], a[204:207], v[72:75], v[236:239]
v_exp_f32 v33, v33
v_mfma_f32_16x16x32_bf16 a[240:243], a[244:247], v[72:75], a[240:243]
ds_read_b64_tr_b16 a[218:219], v12 offset:36864
v_fmamk_f32 v34, v34, 0x3e0293ee, v24
v_mfma_f32_16x16x32_bf16 v[40:43], a[160:163], a[96:99], 0
v_exp_f32 v34, v34
v_mfma_f32_16x16x32_bf16 v[40:43], a[164:167], a[100:103], v[40:43]
ds_read_b64_tr_b16 a[220:221], v13 offset:32768
v_fmamk_f32 v35, v35, 0x3e0293ee, v24
v_mfma_f32_16x16x32_bf16 v[40:43], a[168:171], a[104:107], v[40:43]
v_exp_f32 v35, v35
v_mfma_f32_16x16x32_bf16 v[40:43], a[172:175], a[108:111], v[40:43]
ds_read_b64_tr_b16 a[222:223], v13 offset:36864
v_cvt_pk_bf16_f32 v50, v32, v33
v_mfma_f32_16x16x32_bf16 v[96:99], a[192:195], v[76:79], v[96:99]
v_cvt_pk_bf16_f32 v51, v34, v35
v_fmamk_f32 v36, v36, 0x3e0293ee, v23
v_mfma_f32_16x16x32_bf16 v[100:103], a[196:199], v[76:79], v[100:103]
v_exp_f32 v36, v36
v_mfma_f32_16x16x32_bf16 v[104:107], a[200:203], v[76:79], v[104:107]
v_fmamk_f32 v37, v37, 0x3e0293ee, v23
v_fmamk_f32 v38, v38, 0x3e0293ee, v23
v_mfma_f32_16x16x32_bf16 v[108:111], a[204:207], v[76:79], v[108:111]
s_waitcnt vmcnt(0) lgkmcnt(2)
v_exp_f32 v37, v37
v_mfma_f32_16x16x32_bf16 v[32:35], a[176:179], a[80:83], 0
s_barrier
v_exp_f32 v38, v38
v_mfma_f32_16x16x32_bf16 v[32:35], a[180:183], a[84:87], v[32:35]
ds_read_b128 a[160:163], v2 offset:49152
v_fmamk_f32 v39, v39, 0x3e0293ee, v23
v_mfma_f32_16x16x32_bf16 v[32:35], a[184:187], a[88:91], v[32:35]
v_exp_f32 v39, v39
v_mfma_f32_16x16x32_bf16 v[32:35], a[188:191], a[92:95], v[32:35]
ds_read_b128 a[164:167], v3 offset:49152
v_cvt_pk_bf16_f32 v52, v36, v37
v_mfma_f32_16x16x32_bf16 v[128:131], a[192:195], v[48:51], v[128:131]
ds_read_b128 a[168:171], v4 offset:49152
v_cvt_pk_bf16_f32 v53, v38, v39
v_mfma_f32_16x16x32_bf16 v[132:135], a[196:199], v[48:51], v[132:135]
ds_read_b128 a[172:175], v5 offset:49152
v_fmamk_f32 v40, v40, 0x3e0293ee, v24
v_mfma_f32_16x16x32_bf16 v[136:139], a[200:203], v[48:51], v[136:139]
v_exp_f32 v40, v40
v_mfma_f32_16x16x32_bf16 v[140:143], a[204:207], v[48:51], v[140:143]
ds_read_b64_tr_b16 a[192:193], v80 offset:32768
v_fmamk_f32 v41, v41, 0x3e0293ee, v24
v_mfma_f32_16x16x32_bf16 a[224:227], a[244:247], v[76:79], a[224:227]
v_exp_f32 v41, v41
v_mfma_f32_16x16x32_bf16 v[240:243], a[208:211], v[72:75], v[240:243]
ds_read_b64_tr_b16 a[194:195], v80 offset:36864
v_fmamk_f32 v42, v42, 0x3e0293ee, v24
v_mfma_f32_16x16x32_bf16 v[244:247], a[212:215], v[72:75], v[244:247]
v_exp_f32 v42, v42
v_mfma_f32_16x16x32_bf16 v[248:251], a[216:219], v[72:75], v[248:251]
s_waitcnt lgkmcnt(4)
ds_read_b64_tr_b16 a[196:197], v81 offset:32768
v_fmamk_f32 v43, v43, 0x3e0293ee, v24
v_mfma_f32_16x16x32_bf16 v[252:255], a[220:223], v[72:75], v[252:255]
v_exp_f32 v43, v43
v_mfma_f32_16x16x32_bf16 v[36:39], a[176:179], a[96:99], 0
ds_read_b64_tr_b16 a[198:199], v81 offset:36864
v_cvt_pk_bf16_f32 v56, v40, v41
v_mfma_f32_16x16x32_bf16 v[36:39], a[180:183], a[100:103], v[36:39]
ds_read_b64_tr_b16 a[200:201], v82 offset:32768
v_cvt_pk_bf16_f32 v57, v42, v43
v_mfma_f32_16x16x32_bf16 v[36:39], a[184:187], a[104:107], v[36:39]
ds_read_b64_tr_b16 a[202:203], v82 offset:36864
v_fmamk_f32 v32, v32, 0x3e0293ee, v23
v_mfma_f32_16x16x32_bf16 v[36:39], a[188:191], a[108:111], v[36:39]
v_exp_f32 v32, v32
v_mfma_f32_16x16x32_bf16 v[112:115], a[208:211], v[76:79], v[112:115]
ds_read_b64_tr_b16 a[204:205], v83 offset:32768
v_fmamk_f32 v33, v33, 0x3e0293ee, v23
v_mfma_f32_16x16x32_bf16 v[116:119], a[212:215], v[76:79], v[116:119]
v_exp_f32 v33, v33
v_mfma_f32_16x16x32_bf16 v[120:123], a[216:219], v[76:79], v[120:123]
ds_read_b64_tr_b16 a[206:207], v83 offset:36864
v_fmamk_f32 v34, v34, 0x3e0293ee, v23
v_mfma_f32_16x16x32_bf16 v[124:127], a[220:223], v[76:79], v[124:127]
v_exp_f32 v34, v34
v_mfma_f32_16x16x32_bf16 a[228:231], a[244:247], v[48:51], a[228:231]
ds_read_b128 a[176:179], v2 offset:53248
v_fmamk_f32 v35, v35, 0x3e0293ee, v23
v_mfma_f32_16x16x32_bf16 v[40:43], a[160:163], a[144:147], 0
v_exp_f32 v35, v35
v_mfma_f32_16x16x32_bf16 v[40:43], a[164:167], a[148:151], v[40:43]
s_waitcnt lgkmcnt(3)
ds_read_b128 a[180:183], v3 offset:53248
v_cvt_pk_bf16_f32 v54, v32, v33
v_mfma_f32_16x16x32_bf16 v[40:43], a[168:171], a[152:155], v[40:43]
ds_read_b128 a[184:187], v4 offset:53248
v_cvt_pk_bf16_f32 v55, v34, v35
v_mfma_f32_16x16x32_bf16 v[40:43], a[172:175], a[156:159], v[40:43]
ds_read_b128 a[188:191], v5 offset:53248
v_fmamk_f32 v36, v36, 0x3e0293ee, v24
v_mfma_f32_16x16x32_bf16 v[144:147], a[208:211], v[48:51], v[144:147]
v_exp_f32 v36, v36
v_mfma_f32_16x16x32_bf16 v[148:151], a[212:215], v[48:51], v[148:151]
ds_read_b64_tr_b16 a[208:209], v84 offset:32768
v_fmamk_f32 v37, v37, 0x3e0293ee, v24
v_mfma_f32_16x16x32_bf16 v[152:155], a[216:219], v[48:51], v[152:155]
v_exp_f32 v37, v37
v_mfma_f32_16x16x32_bf16 v[156:159], a[220:223], v[48:51], v[156:159]
ds_read_b64_tr_b16 a[210:211], v84 offset:36864
v_fmamk_f32 v38, v38, 0x3e0293ee, v24
v_mfma_f32_16x16x32_bf16 v[32:35], a[160:163], a[80:83], 0
v_exp_f32 v38, v38
v_mfma_f32_16x16x32_bf16 v[32:35], a[164:167], a[84:87], v[32:35]
ds_read_b64_tr_b16 a[212:213], v85 offset:32768
v_fmamk_f32 v39, v39, 0x3e0293ee, v24
v_mfma_f32_16x16x32_bf16 v[32:35], a[168:171], a[88:91], v[32:35]
v_exp_f32 v39, v39
v_mfma_f32_16x16x32_bf16 v[32:35], a[172:175], a[92:95], v[32:35]
ds_read_b64_tr_b16 a[214:215], v85 offset:36864
v_cvt_pk_bf16_f32 v58, v36, v37
v_mfma_f32_16x16x32_bf16 v[96:99], a[192:195], v[52:55], v[96:99]
ds_read_b64_tr_b16 a[216:217], v86 offset:32768
v_cvt_pk_bf16_f32 v59, v38, v39
v_mfma_f32_16x16x32_bf16 v[100:103], a[196:199], v[52:55], v[100:103]
ds_read_b64_tr_b16 a[218:219], v86 offset:36864
v_fmamk_f32 v40, v40, 0x3e0293ee, v27
v_mfma_f32_16x16x32_bf16 v[104:107], a[200:203], v[52:55], v[104:107]
s_waitcnt lgkmcnt(5)
v_exp_f32 v40, v40
v_mfma_f32_16x16x32_bf16 v[108:111], a[204:207], v[52:55], v[108:111]
ds_read_b64_tr_b16 a[220:221], v87 offset:32768
v_fmamk_f32 v41, v41, 0x3e0293ee, v27
v_mfma_f32_16x16x32_bf16 a[224:227], a[244:247], v[52:55], a[224:227]
v_exp_f32 v41, v41
v_mfma_f32_16x16x32_bf16 v[36:39], a[160:163], a[96:99], 0
ds_read_b64_tr_b16 a[222:223], v87 offset:36864
v_fmamk_f32 v42, v42, 0x3e0293ee, v27
v_mfma_f32_16x16x32_bf16 v[36:39], a[164:167], a[100:103], v[36:39]
v_exp_f32 v42, v42
v_mfma_f32_16x16x32_bf16 v[36:39], a[168:171], a[104:107], v[36:39]
v_fmamk_f32 v43, v43, 0x3e0293ee, v27
v_cvt_pk_bf16_f32 v60, v40, v41
v_mfma_f32_16x16x32_bf16 v[36:39], a[172:175], a[108:111], v[36:39]
v_exp_f32 v43, v43
v_mfma_f32_16x16x32_bf16 v[128:131], a[192:195], v[56:59], v[128:131]
ds_read_b128 a[160:163], v44 offset:49152
v_cvt_pk_bf16_f32 v61, v42, v43
v_mfma_f32_16x16x32_bf16 v[132:135], a[196:199], v[56:59], v[132:135]
ds_read_b128 a[164:167], v45 offset:49152
v_fmamk_f32 v32, v32, 0x3e0293ee, v23
v_mfma_f32_16x16x32_bf16 v[136:139], a[200:203], v[56:59], v[136:139]
v_exp_f32 v32, v32
v_mfma_f32_16x16x32_bf16 v[140:143], a[204:207], v[56:59], v[140:143]
ds_read_b128 a[168:171], v46 offset:49152
v_fmamk_f32 v33, v33, 0x3e0293ee, v23
v_mfma_f32_16x16x32_bf16 v[40:43], a[176:179], a[144:147], 0
v_exp_f32 v33, v33
v_mfma_f32_16x16x32_bf16 v[40:43], a[180:183], a[148:151], v[40:43]
ds_read_b128 a[172:175], v47 offset:49152
v_fmamk_f32 v34, v34, 0x3e0293ee, v23
v_mfma_f32_16x16x32_bf16 v[40:43], a[184:187], a[152:155], v[40:43]
v_exp_f32 v34, v34
v_mfma_f32_16x16x32_bf16 v[40:43], a[188:191], a[156:159], v[40:43]
s_waitcnt lgkmcnt(4)
ds_read_b64_tr_b16 a[192:193], v6 offset:49152
v_fmamk_f32 v35, v35, 0x3e0293ee, v23
v_mfma_f32_16x16x32_bf16 v[112:115], a[208:211], v[52:55], v[112:115]
v_exp_f32 v35, v35
v_mfma_f32_16x16x32_bf16 v[116:119], a[212:215], v[52:55], v[116:119]
ds_read_b64_tr_b16 a[194:195], v6 offset:53248
v_cvt_pk_bf16_f32 v64, v32, v33
v_mfma_f32_16x16x32_bf16 v[120:123], a[216:219], v[52:55], v[120:123]
ds_read_b64_tr_b16 a[196:197], v7 offset:49152
v_cvt_pk_bf16_f32 v65, v34, v35
v_mfma_f32_16x16x32_bf16 v[124:127], a[220:223], v[52:55], v[124:127]
ds_read_b64_tr_b16 a[198:199], v7 offset:53248
v_fmamk_f32 v36, v36, 0x3e0293ee, v24
v_mfma_f32_16x16x32_bf16 a[228:231], a[244:247], v[56:59], a[228:231]
v_exp_f32 v36, v36
v_mfma_f32_16x16x32_bf16 v[32:35], a[176:179], a[80:83], 0
ds_read_b64_tr_b16 a[200:201], v8 offset:49152
v_fmamk_f32 v37, v37, 0x3e0293ee, v24
v_mfma_f32_16x16x32_bf16 v[32:35], a[180:183], a[84:87], v[32:35]
v_exp_f32 v37, v37
v_mfma_f32_16x16x32_bf16 v[32:35], a[184:187], a[88:91], v[32:35]
ds_read_b64_tr_b16 a[202:203], v8 offset:53248
v_fmamk_f32 v38, v38, 0x3e0293ee, v24
v_mfma_f32_16x16x32_bf16 v[32:35], a[188:191], a[92:95], v[32:35]
v_exp_f32 v38, v38
v_mfma_f32_16x16x32_bf16 v[144:147], a[208:211], v[56:59], v[144:147]
ds_read_b64_tr_b16 a[204:205], v9 offset:49152
v_fmamk_f32 v39, v39, 0x3e0293ee, v24
v_mfma_f32_16x16x32_bf16 v[148:151], a[212:215], v[56:59], v[148:151]
L_pad0_12:
s_cbranch_execz L_back
v_exp_f32 v39, v39
v_mfma_f32_16x16x32_bf16 v[152:155], a[216:219], v[56:59], v[152:155]
ds_read_b64_tr_b16 a[206:207], v9 offset:53248
v_cvt_pk_bf16_f32 v68, v36, v37
v_mfma_f32_16x16x32_bf16 v[156:159], a[220:223], v[56:59], v[156:159]
v_cvt_pk_bf16_f32 v69, v38, v39
v_fmamk_f32 v40, v40, 0x3e0293ee, v27
v_mfma_f32_16x16x32_bf16 v[36:39], a[176:179], a[96:99], 0
v_exp_f32 v40, v40
v_mfma_f32_16x16x32_bf16 v[36:39], a[180:183], a[100:103], v[36:39]
ds_read_b128 a[176:179], v44 offset:53248
v_fmamk_f32 v41, v41, 0x3e0293ee, v27
v_mfma_f32_16x16x32_bf16 v[36:39], a[184:187], a[104:107], v[36:39]
v_exp_f32 v41, v41
v_fmamk_f32 v42, v42, 0x3e0293ee, v27
v_fmamk_f32 v43, v43, 0x3e0293ee, v27
v_exp_f32 v42, v42
v_exp_f32 v43, v43
v_mfma_f32_16x16x32_bf16 v[36:39], a[188:191], a[108:111], v[36:39]
s_waitcnt lgkmcnt(3)
v_cvt_pk_bf16_f32 v62, v40, v41
v_cvt_pk_bf16_f32 v63, v42, v43
v_mfma_f32_16x16x32_bf16 v[40:43], a[160:163], a[80:83], 0
ds_read_b128 a[180:183], v45 offset:53248
v_fmamk_f32 v32, v32, 0x3e0293ee, v23
v_mfma_f32_16x16x32_bf16 v[40:43], a[164:167], a[84:87], v[40:43]
v_exp_f32 v32, v32
v_mfma_f32_16x16x32_bf16 v[40:43], a[168:171], a[88:91], v[40:43]
ds_read_b128 a[184:187], v46 offset:53248
v_fmamk_f32 v33, v33, 0x3e0293ee, v23
v_mfma_f32_16x16x32_bf16 v[40:43], a[172:175], a[92:95], v[40:43]
v_exp_f32 v33, v33
v_mfma_f32_16x16x32_bf16 v[224:227], a[192:195], v[60:63], v[224:227]
ds_read_b128 a[188:191], v47 offset:53248
v_fmamk_f32 v34, v34, 0x3e0293ee, v23
v_mfma_f32_16x16x32_bf16 v[228:231], a[196:199], v[60:63], v[228:231]
v_exp_f32 v34, v34
v_mfma_f32_16x16x32_bf16 v[232:235], a[200:203], v[60:63], v[232:235]
s_waitcnt lgkmcnt(3)
ds_read_b64_tr_b16 a[208:209], v10 offset:49152
v_fmamk_f32 v35, v35, 0x3e0293ee, v23
v_mfma_f32_16x16x32_bf16 v[236:239], a[204:207], v[60:63], v[236:239]
v_exp_f32 v35, v35
v_mfma_f32_16x16x32_bf16 a[240:243], a[244:247], v[60:63], a[240:243]
v_cvt_pk_bf16_f32 v66, v32, v33
v_cvt_pk_bf16_f32 v67, v34, v35
v_mfma_f32_16x16x32_bf16 v[32:35], a[160:163], a[96:99], 0
ds_read_b64_tr_b16 a[210:211], v10 offset:53248
v_fmamk_f32 v36, v36, 0x3e0293ee, v24
v_mfma_f32_16x16x32_bf16 v[32:35], a[164:167], a[100:103], v[32:35]
v_exp_f32 v36, v36
v_mfma_f32_16x16x32_bf16 v[32:35], a[168:171], a[104:107], v[32:35]
ds_read_b64_tr_b16 a[212:213], v11 offset:49152
v_fmamk_f32 v37, v37, 0x3e0293ee, v24
v_mfma_f32_16x16x32_bf16 v[32:35], a[172:175], a[108:111], v[32:35]
v_exp_f32 v37, v37
v_mfma_f32_16x16x32_bf16 v[96:99], a[192:195], v[64:67], v[96:99]
ds_read_b64_tr_b16 a[214:215], v11 offset:53248
v_fmamk_f32 v38, v38, 0x3e0293ee, v24
v_mfma_f32_16x16x32_bf16 v[100:103], a[196:199], v[64:67], v[100:103]
v_exp_f32 v38, v38
v_mfma_f32_16x16x32_bf16 v[104:107], a[200:203], v[64:67], v[104:107]
ds_read_b64_tr_b16 a[216:217], v12 offset:49152
v_fmamk_f32 v39, v39, 0x3e0293ee, v24
v_mfma_f32_16x16x32_bf16 v[108:111], a[204:207], v[64:67], v[108:111]
v_exp_f32 v39, v39
v_mfma_f32_16x16x32_bf16 a[224:227], a[244:247], v[64:67], a[224:227]
v_cvt_pk_bf16_f32 v70, v36, v37
v_cvt_pk_bf16_f32 v71, v38, v39
v_mfma_f32_16x16x32_bf16 v[36:39], a[176:179], a[80:83], 0
s_waitcnt lgkmcnt(3)
ds_read_b64_tr_b16 a[218:219], v12 offset:53248
v_fmamk_f32 v40, v40, 0x3e0293ee, v23
v_mfma_f32_16x16x32_bf16 v[36:39], a[180:183], a[84:87], v[36:39]
ds_read_b64_tr_b16 a[220:221], v13 offset:49152
v_fmamk_f32 v41, v41, 0x3e0293ee, v23
v_mfma_f32_16x16x32_bf16 v[36:39], a[184:187], a[88:91], v[36:39]
ds_read_b64_tr_b16 a[222:223], v13 offset:53248
v_fmamk_f32 v42, v42, 0x3e0293ee, v23
v_mfma_f32_16x16x32_bf16 v[36:39], a[188:191], a[92:95], v[36:39]
v_exp_f32 v40, v40
v_mfma_f32_16x16x32_bf16 v[128:131], a[192:195], v[68:71], v[128:131]
v_exp_f32 v41, v41
v_mfma_f32_16x16x32_bf16 v[132:135], a[196:199], v[68:71], v[132:135]
v_exp_f32 v42, v42
v_mfma_f32_16x16x32_bf16 v[136:139], a[200:203], v[68:71], v[136:139]
ds_read_b128 a[160:163], v2 offset:32768
v_fmamk_f32 v43, v43, 0x3e0293ee, v23
v_mfma_f32_16x16x32_bf16 v[140:143], a[204:207], v[68:71], v[140:143]
v_exp_f32 v43, v43
v_mfma_f32_16x16x32_bf16 a[228:231], a[244:247], v[68:71], a[228:231]
ds_read_b128 a[164:167], v3 offset:32768
v_cvt_pk_bf16_f32 v72, v40, v41
v_mfma_f32_16x16x32_bf16 v[240:243], a[208:211], v[60:63], v[240:243]
s_waitcnt lgkmcnt(3)
ds_read_b128 a[168:171], v4 offset:32768
v_cvt_pk_bf16_f32 v73, v42, v43
v_mfma_f32_16x16x32_bf16 v[244:247], a[212:215], v[60:63], v[244:247]
ds_read_b128 a[172:175], v5 offset:32768
v_accvgpr_read_b32 v94, a240
v_mfma_f32_16x16x32_bf16 v[248:251], a[216:219], v[60:63], v[248:251]
s_waitcnt lgkmcnt(4)
ds_read_b64_tr_b16 a[192:193], v80 offset:49152
v_fmamk_f32 v32, v32, 0x3e0293ee, v24
v_mfma_f32_16x16x32_bf16 v[252:255], a[220:223], v[60:63], v[252:255]
v_exp_f32 v32, v32
v_mfma_f32_16x16x32_bf16 v[40:43], a[176:179], a[96:99], 0
ds_write_b128 v29, v[240:243] offset:2304
v_fmamk_f32 v33, v33, 0x3e0293ee, v24
v_mfma_f32_16x16x32_bf16 v[40:43], a[180:183], a[100:103], v[40:43]
v_exp_f32 v33, v33
v_mfma_f32_16x16x32_bf16 v[40:43], a[184:187], a[104:107], v[40:43]
ds_write_b128 v29, v[244:247] offset:3328
v_fmamk_f32 v34, v34, 0x3e0293ee, v24
v_mfma_f32_16x16x32_bf16 v[40:43], a[188:191], a[108:111], v[40:43]
v_exp_f32 v34, v34
v_mfma_f32_16x16x32_bf16 v[112:115], a[208:211], v[64:67], v[112:115]
ds_write_b128 v29, v[248:251] offset:4352
v_fmamk_f32 v35, v35, 0x3e0293ee, v24
v_mfma_f32_16x16x32_bf16 v[116:119], a[212:215], v[64:67], v[116:119]
v_exp_f32 v35, v35
v_mfma_f32_16x16x32_bf16 v[120:123], a[216:219], v[64:67], v[120:123]
v_mov_b32 v95, v27
v_cvt_pk_bf16_f32 v76, v32, v33
v_mfma_f32_16x16x32_bf16 v[124:127], a[220:223], v[64:67], v[124:127]
s_waitcnt lgkmcnt(3)
v_cvt_pk_bf16_f32 v77, v34, v35
v_mov_b32 v92, v94
v_mfma_f32_16x16x32_bf16 v[32:35], a[160:163], a[112:115], 0
v_mov_b32 v31, v27
v_fmamk_f32 v36, v36, 0x3e0293ee, v23
v_mfma_f32_16x16x32_bf16 v[32:35], a[164:167], a[116:119], v[32:35]
ds_write_b64 v29, v[94:95] offset:6400
v_fmamk_f32 v37, v37, 0x3e0293ee, v23
v_mfma_f32_16x16x32_bf16 v[32:35], a[168:171], a[120:123], v[32:35]
ds_read_b64_tr_b16 a[194:195], v80 offset:53248
v_fmamk_f32 v38, v38, 0x3e0293ee, v23
v_mfma_f32_16x16x32_bf16 v[32:35], a[172:175], a[124:127], v[32:35]
ds_write_b128 v29, v[252:255] offset:5376
v_fmamk_f32 v39, v39, 0x3e0293ee, v23
v_mfma_f32_16x16x32_bf16 v[144:147], a[208:211], v[68:71], v[144:147]
ds_read_b64_tr_b16 a[196:197], v81 offset:49152
v_fmamk_f32 v40, v40, 0x3e0293ee, v24
v_mfma_f32_16x16x32_bf16 v[148:151], a[212:215], v[68:71], v[148:151]
ds_read_b64_tr_b16 a[198:199], v81 offset:53248
v_fmamk_f32 v41, v41, 0x3e0293ee, v24
v_mfma_f32_16x16x32_bf16 v[152:155], a[216:219], v[68:71], v[152:155]
ds_read_b64_tr_b16 a[200:201], v82 offset:49152
ds_read_b64_tr_b16 a[202:203], v82 offset:53248
v_exp_f32 v36, v36
v_exp_f32 v37, v37
v_exp_f32 v38, v38
v_exp_f32 v39, v39
v_mfma_f32_16x16x32_bf16 v[156:159], a[220:223], v[68:71], v[156:159]
ds_read_b64_tr_b16 a[204:205], v83 offset:49152
ds_read_b64_tr_b16 a[206:207], v83 offset:53248
v_cvt_pk_bf16_f32 v74, v36, v37
v_cvt_pk_bf16_f32 v75, v38, v39
v_mfma_f32_16x16x32_bf16 v[36:39], a[160:163], a[128:131], 0
ds_read_b128 a[176:179], v2 offset:36864
v_fmamk_f32 v42, v42, 0x3e0293ee, v24
v_mfma_f32_16x16x32_bf16 v[36:39], a[164:167], a[132:135], v[36:39]
ds_read_b128 a[180:183], v3 offset:36864
v_fmamk_f32 v43, v43, 0x3e0293ee, v24
v_mfma_f32_16x16x32_bf16 v[36:39], a[168:171], a[136:139], v[36:39]
s_waitcnt lgkmcnt(8)
ds_read_b128 a[184:187], v4 offset:36864
v_fmamk_f32 v32, v32, 0x3e0293ee, v25
v_mfma_f32_16x16x32_bf16 v[36:39], a[172:175], a[140:143], v[36:39]
s_barrier
ds_read_b128 a[188:191], v5 offset:36864
v_fmamk_f32 v33, v33, 0x3e0293ee, v25
v_mfma_f32_16x16x32_bf16 v[96:99], a[192:195], v[72:75], v[96:99]
s_waitcnt lgkmcnt(8)
v_exp_f32 v40, v40
v_mfma_f32_16x16x32_bf16 v[100:103], a[196:199], v[72:75], v[100:103]
s_waitcnt lgkmcnt(6)
v_exp_f32 v41, v41
v_mfma_f32_16x16x32_bf16 v[104:107], a[200:203], v[72:75], v[104:107]
s_waitcnt lgkmcnt(4)
v_exp_f32 v42, v42
v_mfma_f32_16x16x32_bf16 v[108:111], a[204:207], v[72:75], v[108:111]
v_exp_f32 v43, v43
v_mfma_f32_16x16x32_bf16 a[224:227], a[244:247], v[72:75], a[224:227]
s_waitcnt lgkmcnt(3)
ds_read_b64 v[94:95], v30 offset:6400
v_cvt_pk_bf16_f32 v78, v40, v41
v_cvt_pk_bf16_f32 v79, v42, v43
v_mfma_f32_16x16x32_bf16 v[40:43], a[176:179], a[112:115], 0
s_waitcnt lgkmcnt(3)
ds_read_b128 v[240:243], v30 offset:2304
v_fmamk_f32 v34, v34, 0x3e0293ee, v25
v_mfma_f32_16x16x32_bf16 v[40:43], a[180:183], a[116:119], v[40:43]
s_waitcnt lgkmcnt(3)
ds_read_b128 v[244:247], v30 offset:3328
v_fmamk_f32 v35, v35, 0x3e0293ee, v25
v_mfma_f32_16x16x32_bf16 v[40:43], a[184:187], a[120:123], v[40:43]
s_waitcnt lgkmcnt(3)
ds_read_b128 v[248:251], v30 offset:4352
ds_read_b128 v[252:255], v30 offset:5376
v_mfma_f32_16x16x32_bf16 v[40:43], a[188:191], a[124:127], v[40:43]
ds_read_b64_tr_b16 a[208:209], v84 offset:49152
v_accvgpr_read_b32 v88, a224
v_mfma_f32_16x16x32_bf16 v[128:131], a[192:195], v[76:79], v[128:131]
s_waitcnt lgkmcnt(5)
v_sub_f32 v31, v31, v95
v_cmp_nge_f32 vcc, s34, v94
v_exp_f32 v31, v31
v_mfma_f32_16x16x32_bf16 v[132:135], a[196:199], v[76:79], v[132:135]
s_or_b64 s[42:43], s[42:43], vcc
ds_read_b64_tr_b16 a[210:211], v84 offset:53248
v_fmac_f32 v92, v94, v31
v_cmp_nge_f32 vcc, s34, v92
v_mfma_f32_16x16x32_bf16 v[136:139], a[200:203], v[76:79], v[136:139]
s_or_b64 s[42:43], s[42:43], vcc
ds_read_b64_tr_b16 a[212:213], v85 offset:49152
ds_read_b64_tr_b16 a[214:215], v85 offset:53248
v_rcp_f32 v92, v92
v_cmp_nge_f32 vcc, s34, v88
v_rcp_f32 v88, v88
v_mfma_f32_16x16x32_bf16 v[140:143], a[204:207], v[76:79], v[140:143]
s_waitcnt lgkmcnt(4)
s_or_b64 s[42:43], s[42:43], vcc
ds_read_b64_tr_b16 a[216:217], v86 offset:49152
ds_read_b64_tr_b16 a[218:219], v86 offset:53248
v_fmac_f32 v224, v240, v31
v_fmac_f32 v225, v241, v31
v_fmac_f32 v226, v242, v31
v_fmac_f32 v227, v243, v31
v_fmac_f32 v228, v244, v31
v_fmac_f32 v229, v245, v31
v_fmac_f32 v230, v246, v31
v_fmac_f32 v231, v247, v31
v_fmac_f32 v232, v248, v31
v_fmac_f32 v233, v249, v31
v_fmac_f32 v234, v250, v31
v_fmac_f32 v235, v251, v31
v_fmac_f32 v236, v252, v31
v_fmac_f32 v237, v253, v31
v_fmac_f32 v238, v254, v31
v_fmac_f32 v239, v255, v31
v_mul_f32 v224, v224, v92
v_mul_f32 v225, v225, v92
v_mul_f32 v226, v226, v92
v_mul_f32 v227, v227, v92
v_cvt_pk_bf16_f32 v224, v224, v225
v_mul_f32 v228, v228, v92
v_cvt_pk_bf16_f32 v225, v226, v227
v_mul_f32 v229, v229, v92
v_mul_f32 v230, v230, v92
v_mul_f32 v231, v231, v92
v_cvt_pk_bf16_f32 v228, v228, v229
v_mul_f32 v232, v232, v92
v_cvt_pk_bf16_f32 v229, v230, v231
v_mul_f32 v233, v233, v92
v_mul_f32 v234, v234, v92
v_mul_f32 v235, v235, v92
v_cvt_pk_bf16_f32 v232, v232, v233
v_mul_f32 v236, v236, v92
v_cvt_pk_bf16_f32 v233, v234, v235
v_mul_f32 v237, v237, v92
v_mul_f32 v238, v238, v92
v_mul_f32 v239, v239, v92
v_cvt_pk_bf16_f32 v236, v236, v237
v_exp_f32 v32, v32
v_cvt_pk_bf16_f32 v237, v238, v239
v_exp_f32 v33, v33
v_exp_f32 v34, v34
v_exp_f32 v35, v35
v_mul_f32 v96, v96, v88
v_mul_f32 v97, v97, v88
v_mul_f32 v98, v98, v88
v_mul_f32 v99, v99, v88
v_cvt_pk_bf16_f32 v96, v96, v97
v_cvt_pk_bf16_f32 v97, v98, v99
v_mfma_f32_16x16x32_bf16 a[228:231], a[244:247], v[76:79], a[228:231]
ds_write_b64 v20, v[224:225] offset:0
ds_write_b64 v20, v[228:229] offset:32
ds_write_b64 v20, v[232:233] offset:64
ds_write_b64 v20, v[236:237] offset:96
ds_read_b128 a[64:67], v21 offset:0
ds_read_b128 a[68:71], v21 offset:1152
ds_write_b64 v20, v[96:97] offset:0
ds_read_b64_tr_b16 a[220:221], v87 offset:49152
ds_read_b64_tr_b16 a[222:223], v87 offset:53248
v_cvt_pk_bf16_f32 v48, v32, v33
v_cvt_pk_bf16_f32 v49, v34, v35
v_mul_f32 v100, v100, v88
v_mfma_f32_16x16x32_bf16 v[32:35], a[176:179], a[128:131], 0
ds_read_b128 a[160:163], v44 offset:32768
v_mul_f32 v101, v101, v88
v_mul_f32 v102, v102, v88
v_mul_f32 v103, v103, v88
v_cvt_pk_bf16_f32 v100, v100, v101
v_cvt_pk_bf16_f32 v101, v102, v103
v_mfma_f32_16x16x32_bf16 v[32:35], a[180:183], a[132:135], v[32:35]
ds_write_b64 v20, v[100:101] offset:32
ds_read_b128 a[164:167], v45 offset:32768
v_mul_f32 v104, v104, v88
v_mul_f32 v105, v105, v88
v_mfma_f32_16x16x32_bf16 v[32:35], a[184:187], a[136:139], v[32:35]
ds_read_b128 a[168:171], v46 offset:32768
v_mul_f32 v106, v106, v88
v_mul_f32 v107, v107, v88
v_cvt_pk_bf16_f32 v104, v104, v105
v_cvt_pk_bf16_f32 v105, v106, v107
v_mfma_f32_16x16x32_bf16 v[32:35], a[188:191], a[140:143], v[32:35]
s_waitcnt lgkmcnt(15)
ds_write_b64 v20, v[104:105] offset:64
ds_read_b128 a[172:175], v47 offset:32768
v_mul_f32 v108, v108, v88
v_mul_f32 v109, v109, v88
v_mul_f32 v110, v110, v88
v_mul_f32 v111, v111, v88
v_cvt_pk_bf16_f32 v108, v108, v109
v_cvt_pk_bf16_f32 v109, v110, v111
v_mfma_f32_16x16x32_bf16 v[112:115], a[208:211], v[72:75], v[112:115]
s_waitcnt lgkmcnt(15)
ds_write_b64 v20, v[108:109] offset:96
v_add_u32 v22, s38, v19
v_mfma_f32_16x16x32_bf16 v[116:119], a[212:215], v[72:75], v[116:119]
s_add_u32 s38, s58, 0
s_add_u32 s38, s38, s76
ds_read_b128 a[0:3], v21 offset:0
ds_read_b128 a[4:7], v21 offset:1152
v_mfma_f32_16x16x32_bf16 v[120:123], a[216:219], v[72:75], v[120:123]
s_waitcnt lgkmcnt(8)
buffer_store_dwordx4 a[64:67], v22, s[16:19], 0 offen offset:0 sc0 sc1 nt
buffer_store_dwordx4 a[68:71], v22, s[16:19], 0 offen offset:2048 sc0 sc1 nt
s_nop 1
v_add_u32 v22, s38, v19
v_fmamk_f32 v36, v36, 0x3e0293ee, v26
v_fmamk_f32 v37, v37, 0x3e0293ee, v26
v_fmamk_f32 v38, v38, 0x3e0293ee, v26
v_exp_f32 v36, v36
v_exp_f32 v37, v37
v_exp_f32 v38, v38
v_fmamk_f32 v39, v39, 0x3e0293ee, v26
v_accvgpr_read_b32 v89, a228
v_exp_f32 v39, v39
v_cmp_nge_f32 vcc, s34, v89
v_rcp_f32 v89, v89
v_mfma_f32_16x16x32_bf16 v[124:127], a[220:223], v[72:75], v[124:127]
s_add_u32 s38, s58, 4096
v_cvt_pk_bf16_f32 v52, v36, v37
v_cvt_pk_bf16_f32 v53, v38, v39
v_mul_f32 v128, v128, v89
v_mul_f32 v129, v129, v89
v_mul_f32 v130, v130, v89
v_mul_f32 v131, v131, v89
v_cvt_pk_bf16_f32 v128, v128, v129
v_cvt_pk_bf16_f32 v129, v130, v131
v_mfma_f32_16x16x32_bf16 v[36:39], a[160:163], a[112:115], 0
s_waitcnt lgkmcnt(5)
s_add_u32 s38, s38, s76
ds_write_b64 v20, v[128:129] offset:0
v_mul_f32 v132, v132, v89
v_mfma_f32_16x16x32_bf16 v[36:39], a[164:167], a[116:119], v[36:39]
s_or_b64 s[42:43], s[42:43], vcc
v_mul_f32 v133, v133, v89
v_mul_f32 v134, v134, v89
v_mul_f32 v135, v135, v89
v_cvt_pk_bf16_f32 v132, v132, v133
v_cvt_pk_bf16_f32 v133, v134, v135
v_mfma_f32_16x16x32_bf16 v[36:39], a[168:171], a[120:123], v[36:39]
s_waitcnt lgkmcnt(4)
ds_write_b64 v20, v[132:133] offset:32
v_mul_f32 v136, v136, v89
v_mul_f32 v137, v137, v89
v_mfma_f32_16x16x32_bf16 v[36:39], a[172:175], a[124:127], v[36:39]
v_mul_f32 v138, v138, v89
v_mul_f32 v139, v139, v89
v_cvt_pk_bf16_f32 v136, v136, v137
v_cvt_pk_bf16_f32 v137, v138, v139
v_mfma_f32_16x16x32_bf16 v[144:147], a[208:211], v[76:79], v[144:147]
s_waitcnt lgkmcnt(2)
buffer_store_dwordx4 a[0:3], v22, s[16:19], 0 offen offset:0 sc0 sc1 nt
buffer_store_dwordx4 a[4:7], v22, s[16:19], 0 offen offset:2048 sc0 sc1 nt
ds_write_b64 v20, v[136:137] offset:64
ds_read_b64_tr_b16 a[192:193], v6 offset:32768
ds_read_b64_tr_b16 a[194:195], v6 offset:36864
v_mul_f32 v140, v140, v89
v_mul_f32 v141, v141, v89
v_mul_f32 v142, v142, v89
v_mul_f32 v143, v143, v89
v_cvt_pk_bf16_f32 v140, v140, v141
v_cvt_pk_bf16_f32 v141, v142, v143
v_mfma_f32_16x16x32_bf16 v[148:151], a[212:215], v[76:79], v[148:151]
ds_write_b64 v20, v[140:141] offset:96
ds_read_b64_tr_b16 a[196:197], v7 offset:32768
ds_read_b64_tr_b16 a[198:199], v7 offset:36864
v_mfma_f32_16x16x32_bf16 v[152:155], a[216:219], v[76:79], v[152:155]
ds_read_b128 a[16:19], v21 offset:0
ds_read_b128 a[20:23], v21 offset:1152
ds_read_b64_tr_b16 a[200:201], v8 offset:32768
ds_read_b64_tr_b16 a[202:203], v8 offset:36864
v_fmamk_f32 v40, v40, 0x3e0293ee, v25
v_fmamk_f32 v41, v41, 0x3e0293ee, v25
v_fmamk_f32 v42, v42, 0x3e0293ee, v25
v_exp_f32 v40, v40
v_exp_f32 v41, v41
v_exp_f32 v42, v42
v_fmamk_f32 v43, v43, 0x3e0293ee, v25
v_exp_f32 v43, v43
v_mfma_f32_16x16x32_bf16 v[156:159], a[220:223], v[76:79], v[156:159]
ds_read_b64_tr_b16 a[204:205], v9 offset:32768
ds_read_b64_tr_b16 a[206:207], v9 offset:36864
v_add_u32 v22, s38, v19
v_cvt_pk_bf16_f32 v50, v40, v41
v_cvt_pk_bf16_f32 v51, v42, v43
v_mul_f32 v112, v112, v88
v_mul_f32 v113, v113, v88
v_mul_f32 v114, v114, v88
v_mul_f32 v115, v115, v88
v_cvt_pk_bf16_f32 v112, v112, v113
v_cvt_pk_bf16_f32 v113, v114, v115
v_mfma_f32_16x16x32_bf16 v[40:43], a[160:163], a[128:131], 0
s_add_u32 s38, s58, 0
ds_write_b64 v20, v[112:113] offset:0
v_mul_f32 v116, v116, v88
v_mfma_f32_16x16x32_bf16 v[40:43], a[164:167], a[132:135], v[40:43]
s_add_u32 s38, s38, s75
ds_read_b128 a[176:179], v44 offset:36864
v_mul_f32 v117, v117, v88
v_mul_f32 v118, v118, v88
v_mul_f32 v119, v119, v88
v_cvt_pk_bf16_f32 v116, v116, v117
v_cvt_pk_bf16_f32 v117, v118, v119
v_mfma_f32_16x16x32_bf16 v[40:43], a[168:171], a[136:139], v[40:43]
ds_write_b64 v20, v[116:117] offset:32
ds_read_b128 a[180:183], v45 offset:36864
v_mul_f32 v120, v120, v88
v_mul_f32 v121, v121, v88
v_mfma_f32_16x16x32_bf16 v[40:43], a[172:175], a[140:143], v[40:43]
s_waitcnt lgkmcnt(13)
ds_read_b128 a[184:187], v46 offset:36864
v_mul_f32 v122, v122, v88
v_mul_f32 v123, v123, v88
v_cvt_pk_bf16_f32 v120, v120, v121
v_cvt_pk_bf16_f32 v121, v122, v123
v_mfma_f32_16x16x32_bf16 v[160:163], a[192:195], v[48:51], v[160:163]
s_waitcnt lgkmcnt(11)
ds_write_b64 v20, v[120:121] offset:64
ds_read_b128 a[188:191], v47 offset:36864
v_mul_f32 v124, v124, v88
v_mul_f32 v125, v125, v88
v_mul_f32 v126, v126, v88
v_mul_f32 v127, v127, v88
v_cvt_pk_bf16_f32 v124, v124, v125
v_cvt_pk_bf16_f32 v125, v126, v127
v_mfma_f32_16x16x32_bf16 v[164:167], a[196:199], v[48:51], v[164:167]
s_waitcnt lgkmcnt(9)
buffer_store_dwordx4 a[16:19], v22, s[16:19], 0 offen offset:0 sc0 sc1 nt
buffer_store_dwordx4 a[20:23], v22, s[16:19], 0 offen offset:2048 sc0 sc1 nt
ds_write_b64 v20, v[124:125] offset:96
v_mfma_f32_16x16x32_bf16 v[168:171], a[200:203], v[48:51], v[168:171]
s_waitcnt lgkmcnt(8)
ds_read_b128 a[8:11], v21 offset:0
ds_read_b128 a[12:15], v21 offset:1152
v_mfma_f32_16x16x32_bf16 v[172:175], a[204:207], v[48:51], v[172:175]
s_waitcnt lgkmcnt(8)
v_add_u32 v22, s38, v19
v_fmamk_f32 v32, v32, 0x3e0293ee, v26
v_fmamk_f32 v33, v33, 0x3e0293ee, v26
v_fmamk_f32 v34, v34, 0x3e0293ee, v26
v_exp_f32 v32, v32
v_exp_f32 v33, v33
v_exp_f32 v34, v34
v_fmamk_f32 v35, v35, 0x3e0293ee, v26
v_mul_f32 v144, v144, v89
v_mul_f32 v145, v145, v89
v_exp_f32 v35, v35
v_mul_f32 v146, v146, v89
v_mul_f32 v147, v147, v89
v_cvt_pk_bf16_f32 v144, v144, v145
v_cvt_pk_bf16_f32 v145, v146, v147
v_mfma_f32_16x16x32_bf16 a[232:235], a[244:247], v[48:51], a[232:235]
s_add_u32 s38, s58, 4096
ds_write_b64 v20, v[144:145] offset:0
v_cvt_pk_bf16_f32 v54, v32, v33
v_cvt_pk_bf16_f32 v55, v34, v35
v_mul_f32 v148, v148, v89
v_mfma_f32_16x16x32_bf16 v[32:35], a[176:179], a[112:115], 0
s_waitcnt lgkmcnt(7)
s_add_u32 s38, s38, s75
v_mul_f32 v149, v149, v89
v_mul_f32 v150, v150, v89
v_mul_f32 v151, v151, v89
v_cvt_pk_bf16_f32 v148, v148, v149
v_cvt_pk_bf16_f32 v149, v150, v151
v_mfma_f32_16x16x32_bf16 v[32:35], a[180:183], a[116:119], v[32:35]
s_waitcnt lgkmcnt(6)
ds_write_b64 v20, v[148:149] offset:32
v_mul_f32 v152, v152, v89
v_mul_f32 v153, v153, v89
v_mfma_f32_16x16x32_bf16 v[32:35], a[184:187], a[120:123], v[32:35]
s_waitcnt lgkmcnt(5)
v_mul_f32 v154, v154, v89
v_mul_f32 v155, v155, v89
v_cvt_pk_bf16_f32 v152, v152, v153
v_cvt_pk_bf16_f32 v153, v154, v155
v_mfma_f32_16x16x32_bf16 v[32:35], a[188:191], a[124:127], v[32:35]
ds_write_b64 v20, v[152:153] offset:64
v_mul_f32 v156, v156, v89
v_mul_f32 v157, v157, v89
v_mul_f32 v158, v158, v89
v_mul_f32 v159, v159, v89
v_cvt_pk_bf16_f32 v156, v156, v157
v_cvt_pk_bf16_f32 v157, v158, v159
v_mfma_f32_16x16x32_bf16 v[192:195], a[192:195], v[52:55], v[192:195]
s_waitcnt lgkmcnt(3)
buffer_store_dwordx4 a[8:11], v22, s[16:19], 0 offen offset:0 sc0 sc1 nt
buffer_store_dwordx4 a[12:15], v22, s[16:19], 0 offen offset:2048 sc0 sc1 nt
ds_write_b64 v20, v[156:157] offset:96
ds_read_b64_tr_b16 a[208:209], v10 offset:32768
ds_read_b64_tr_b16 a[210:211], v10 offset:36864
v_mfma_f32_16x16x32_bf16 v[196:199], a[196:199], v[52:55], v[196:199]
ds_read_b128 a[24:27], v21 offset:0
ds_read_b128 a[28:31], v21 offset:1152
ds_read_b64_tr_b16 a[212:213], v11 offset:32768
ds_read_b64_tr_b16 a[214:215], v11 offset:36864
v_mfma_f32_16x16x32_bf16 v[200:203], a[200:203], v[52:55], v[200:203]
ds_read_b64_tr_b16 a[216:217], v12 offset:32768
ds_read_b64_tr_b16 a[218:219], v12 offset:36864
v_add_u32 v22, s38, v19
v_fmamk_f32 v36, v36, 0x3e0293ee, v25
v_fmamk_f32 v37, v37, 0x3e0293ee, v25
v_fmamk_f32 v38, v38, 0x3e0293ee, v25
v_exp_f32 v36, v36
v_exp_f32 v37, v37
v_exp_f32 v38, v38
v_fmamk_f32 v39, v39, 0x3e0293ee, v25
v_exp_f32 v39, v39
v_mfma_f32_16x16x32_bf16 v[204:207], a[204:207], v[52:55], v[204:207]
s_add_u32 s38, s58, 8192
ds_read_b64_tr_b16 a[220:221], v13 offset:32768
ds_read_b64_tr_b16 a[222:223], v13 offset:36864
v_cvt_pk_bf16_f32 v56, v36, v37
v_cvt_pk_bf16_f32 v57, v38, v39
v_mfma_f32_16x16x32_bf16 v[36:39], a[176:179], a[128:131], 0
s_add_u32 s38, s38, s76
ds_read_b128 a[160:163], v2 offset:49152
v_fmamk_f32 v40, v40, 0x3e0293ee, v26
v_mfma_f32_16x16x32_bf16 v[36:39], a[180:183], a[132:135], v[36:39]
ds_read_b128 a[164:167], v3 offset:49152
v_fmamk_f32 v41, v41, 0x3e0293ee, v26
v_mfma_f32_16x16x32_bf16 v[36:39], a[184:187], a[136:139], v[36:39]
ds_read_b128 a[168:171], v4 offset:49152
v_fmamk_f32 v42, v42, 0x3e0293ee, v26
v_mfma_f32_16x16x32_bf16 v[36:39], a[188:191], a[140:143], v[36:39]
s_waitcnt lgkmcnt(10)
buffer_store_dwordx4 a[24:27], v22, s[16:19], 0 offen offset:0 sc0 sc1 nt
v_fmamk_f32 v43, v43, 0x3e0293ee, v26
v_mfma_f32_16x16x32_bf16 v[176:179], a[208:211], v[48:51], v[176:179]
s_waitcnt lgkmcnt(7)
buffer_store_dwordx4 a[28:31], v22, s[16:19], 0 offen offset:2048 sc0 sc1 nt
ds_read_b128 a[172:175], v5 offset:49152
v_mfma_f32_16x16x32_bf16 v[180:183], a[212:215], v[48:51], v[180:183]
s_waitcnt lgkmcnt(6)
v_exp_f32 v40, v40
v_mfma_f32_16x16x32_bf16 v[184:187], a[216:219], v[48:51], v[184:187]
s_waitcnt lgkmcnt(4)
v_exp_f32 v41, v41
v_mfma_f32_16x16x32_bf16 v[188:191], a[220:223], v[48:51], v[188:191]
v_exp_f32 v42, v42
v_exp_f32 v43, v43
v_mfma_f32_16x16x32_bf16 a[236:239], a[244:247], v[52:55], a[236:239]
s_waitcnt lgkmcnt(3)
v_cvt_pk_bf16_f32 v60, v40, v41
v_cvt_pk_bf16_f32 v61, v42, v43
v_mfma_f32_16x16x32_bf16 v[40:43], a[160:163], a[112:115], 0
s_waitcnt lgkmcnt(2)
ds_read_b64_tr_b16 a[192:193], v80 offset:32768
v_fmamk_f32 v32, v32, 0x3e0293ee, v25
v_mfma_f32_16x16x32_bf16 v[40:43], a[164:167], a[116:119], v[40:43]
s_waitcnt lgkmcnt(2)
ds_read_b64_tr_b16 a[194:195], v80 offset:36864
v_fmamk_f32 v33, v33, 0x3e0293ee, v25
v_mfma_f32_16x16x32_bf16 v[40:43], a[168:171], a[120:123], v[40:43]
s_waitcnt lgkmcnt(2)
ds_read_b64_tr_b16 a[196:197], v81 offset:32768
v_fmamk_f32 v34, v34, 0x3e0293ee, v25
v_mfma_f32_16x16x32_bf16 v[40:43], a[172:175], a[124:127], v[40:43]
ds_read_b64_tr_b16 a[198:199], v81 offset:36864
v_fmamk_f32 v35, v35, 0x3e0293ee, v25
v_mfma_f32_16x16x32_bf16 v[208:211], a[208:211], v[52:55], v[208:211]
v_exp_f32 v32, v32
v_mfma_f32_16x16x32_bf16 v[212:215], a[212:215], v[52:55], v[212:215]
v_exp_f32 v33, v33
v_mfma_f32_16x16x32_bf16 v[216:219], a[216:219], v[52:55], v[216:219]
ds_read_b64_tr_b16 a[200:201], v82 offset:32768
ds_read_b64_tr_b16 a[202:203], v82 offset:36864
v_exp_f32 v34, v34
v_exp_f32 v35, v35
v_mfma_f32_16x16x32_bf16 v[220:223], a[220:223], v[52:55], v[220:223]
ds_read_b64_tr_b16 a[204:205], v83 offset:32768
ds_read_b64_tr_b16 a[206:207], v83 offset:36864
v_cvt_pk_bf16_f32 v58, v32, v33
v_cvt_pk_bf16_f32 v59, v34, v35
v_mfma_f32_16x16x32_bf16 v[32:35], a[160:163], a[128:131], 0
ds_read_b128 a[176:179], v2 offset:53248
v_fmamk_f32 v36, v36, 0x3e0293ee, v26
v_mfma_f32_16x16x32_bf16 v[32:35], a[164:167], a[132:135], v[32:35]
ds_read_b128 a[180:183], v3 offset:53248
v_fmamk_f32 v37, v37, 0x3e0293ee, v26
v_mfma_f32_16x16x32_bf16 v[32:35], a[168:171], a[136:139], v[32:35]
ds_read_b128 a[184:187], v4 offset:53248
v_fmamk_f32 v38, v38, 0x3e0293ee, v26
v_mfma_f32_16x16x32_bf16 v[32:35], a[172:175], a[140:143], v[32:35]
s_waitcnt lgkmcnt(7)
ds_read_b128 a[188:191], v5 offset:53248
v_fmamk_f32 v39, v39, 0x3e0293ee, v26
v_mfma_f32_16x16x32_bf16 v[160:163], a[192:195], v[56:59], v[160:163]
v_exp_f32 v36, v36
v_mfma_f32_16x16x32_bf16 v[164:167], a[196:199], v[56:59], v[164:167]
s_waitcnt lgkmcnt(6)
v_exp_f32 v37, v37
v_mfma_f32_16x16x32_bf16 v[168:171], a[200:203], v[56:59], v[168:171]
s_waitcnt lgkmcnt(4)
v_exp_f32 v38, v38
v_mfma_f32_16x16x32_bf16 v[172:175], a[204:207], v[56:59], v[172:175]
v_exp_f32 v39, v39
v_mfma_f32_16x16x32_bf16 a[232:235], a[244:247], v[56:59], a[232:235]
s_waitcnt lgkmcnt(3)
v_cvt_pk_bf16_f32 v62, v36, v37
v_cvt_pk_bf16_f32 v63, v38, v39
v_mfma_f32_16x16x32_bf16 v[36:39], a[176:179], a[112:115], 0
s_waitcnt lgkmcnt(2)
ds_read_b64_tr_b16 a[208:209], v84 offset:32768
v_fmamk_f32 v40, v40, 0x3e0293ee, v25
v_mfma_f32_16x16x32_bf16 v[36:39], a[180:183], a[116:119], v[36:39]
s_waitcnt lgkmcnt(2)
ds_read_b64_tr_b16 a[210:211], v84 offset:36864
L_pad0_13:
s_cbranch_execz L_back
v_fmamk_f32 v41, v41, 0x3e0293ee, v25
v_mfma_f32_16x16x32_bf16 v[36:39], a[184:187], a[120:123], v[36:39]
s_waitcnt lgkmcnt(2)
ds_read_b64_tr_b16 a[212:213], v85 offset:32768
v_fmamk_f32 v42, v42, 0x3e0293ee, v25
v_mfma_f32_16x16x32_bf16 v[36:39], a[188:191], a[124:127], v[36:39]
ds_read_b64_tr_b16 a[214:215], v85 offset:36864
v_fmamk_f32 v43, v43, 0x3e0293ee, v25
v_mfma_f32_16x16x32_bf16 v[192:195], a[192:195], v[60:63], v[192:195]
v_exp_f32 v40, v40
v_mfma_f32_16x16x32_bf16 v[196:199], a[196:199], v[60:63], v[196:199]
v_exp_f32 v41, v41
v_mfma_f32_16x16x32_bf16 v[200:203], a[200:203], v[60:63], v[200:203]
ds_read_b64_tr_b16 a[216:217], v86 offset:32768
ds_read_b64_tr_b16 a[218:219], v86 offset:36864
v_exp_f32 v42, v42
v_exp_f32 v43, v43
v_mfma_f32_16x16x32_bf16 v[204:207], a[204:207], v[60:63], v[204:207]
ds_read_b64_tr_b16 a[220:221], v87 offset:32768
ds_read_b64_tr_b16 a[222:223], v87 offset:36864
v_cvt_pk_bf16_f32 v64, v40, v41
v_cvt_pk_bf16_f32 v65, v42, v43
v_mfma_f32_16x16x32_bf16 v[40:43], a[176:179], a[128:131], 0
ds_read_b128 a[160:163], v44 offset:49152
v_fmamk_f32 v32, v32, 0x3e0293ee, v26
v_mfma_f32_16x16x32_bf16 v[40:43], a[180:183], a[132:135], v[40:43]
ds_read_b128 a[164:167], v45 offset:49152
v_fmamk_f32 v33, v33, 0x3e0293ee, v26
v_mfma_f32_16x16x32_bf16 v[40:43], a[184:187], a[136:139], v[40:43]
ds_read_b128 a[168:171], v46 offset:49152
v_fmamk_f32 v34, v34, 0x3e0293ee, v26
v_mfma_f32_16x16x32_bf16 v[40:43], a[188:191], a[140:143], v[40:43]
s_waitcnt lgkmcnt(7)
ds_read_b128 a[172:175], v47 offset:49152
v_fmamk_f32 v35, v35, 0x3e0293ee, v26
v_mfma_f32_16x16x32_bf16 v[176:179], a[208:211], v[56:59], v[176:179]
v_exp_f32 v32, v32
v_mfma_f32_16x16x32_bf16 v[180:183], a[212:215], v[56:59], v[180:183]
s_waitcnt lgkmcnt(6)
v_exp_f32 v33, v33
v_mfma_f32_16x16x32_bf16 v[184:187], a[216:219], v[56:59], v[184:187]
s_waitcnt lgkmcnt(4)
v_exp_f32 v34, v34
v_mfma_f32_16x16x32_bf16 v[188:191], a[220:223], v[56:59], v[188:191]
v_exp_f32 v35, v35
v_mfma_f32_16x16x32_bf16 a[236:239], a[244:247], v[60:63], a[236:239]
s_waitcnt lgkmcnt(3)
v_cvt_pk_bf16_f32 v68, v32, v33
v_cvt_pk_bf16_f32 v69, v34, v35
v_mfma_f32_16x16x32_bf16 v[32:35], a[160:163], a[112:115], 0
s_waitcnt lgkmcnt(2)
ds_read_b64_tr_b16 a[192:193], v6 offset:49152
v_fmamk_f32 v36, v36, 0x3e0293ee, v25
v_mfma_f32_16x16x32_bf16 v[32:35], a[164:167], a[116:119], v[32:35]
s_waitcnt lgkmcnt(2)
ds_read_b64_tr_b16 a[194:195], v6 offset:53248
v_fmamk_f32 v37, v37, 0x3e0293ee, v25
v_mfma_f32_16x16x32_bf16 v[32:35], a[168:171], a[120:123], v[32:35]
s_waitcnt lgkmcnt(2)
ds_read_b64_tr_b16 a[196:197], v7 offset:49152
v_fmamk_f32 v38, v38, 0x3e0293ee, v25
v_mfma_f32_16x16x32_bf16 v[32:35], a[172:175], a[124:127], v[32:35]
ds_read_b64_tr_b16 a[198:199], v7 offset:53248
v_fmamk_f32 v39, v39, 0x3e0293ee, v25
v_mfma_f32_16x16x32_bf16 v[208:211], a[208:211], v[60:63], v[208:211]
v_exp_f32 v36, v36
v_mfma_f32_16x16x32_bf16 v[212:215], a[212:215], v[60:63], v[212:215]
v_exp_f32 v37, v37
v_mfma_f32_16x16x32_bf16 v[216:219], a[216:219], v[60:63], v[216:219]
ds_read_b64_tr_b16 a[200:201], v8 offset:49152
ds_read_b64_tr_b16 a[202:203], v8 offset:53248
v_exp_f32 v38, v38
v_exp_f32 v39, v39
v_mfma_f32_16x16x32_bf16 v[220:223], a[220:223], v[60:63], v[220:223]
ds_read_b64_tr_b16 a[204:205], v9 offset:49152
ds_read_b64_tr_b16 a[206:207], v9 offset:53248
v_cvt_pk_bf16_f32 v66, v36, v37
v_cvt_pk_bf16_f32 v67, v38, v39
v_mfma_f32_16x16x32_bf16 v[36:39], a[160:163], a[128:131], 0
ds_read_b128 a[176:179], v44 offset:53248
v_fmamk_f32 v40, v40, 0x3e0293ee, v26
v_mfma_f32_16x16x32_bf16 v[36:39], a[164:167], a[132:135], v[36:39]
ds_read_b128 a[180:183], v45 offset:53248
v_fmamk_f32 v41, v41, 0x3e0293ee, v26
v_mfma_f32_16x16x32_bf16 v[36:39], a[168:171], a[136:139], v[36:39]
ds_read_b128 a[184:187], v46 offset:53248
v_fmamk_f32 v42, v42, 0x3e0293ee, v26
v_mfma_f32_16x16x32_bf16 v[36:39], a[172:175], a[140:143], v[36:39]
s_waitcnt lgkmcnt(7)
ds_read_b128 a[188:191], v47 offset:53248
v_fmamk_f32 v43, v43, 0x3e0293ee, v26
v_mfma_f32_16x16x32_bf16 v[160:163], a[192:195], v[64:67], v[160:163]
v_exp_f32 v40, v40
v_mfma_f32_16x16x32_bf16 v[164:167], a[196:199], v[64:67], v[164:167]
s_waitcnt lgkmcnt(6)
v_exp_f32 v41, v41
v_mfma_f32_16x16x32_bf16 v[168:171], a[200:203], v[64:67], v[168:171]
s_waitcnt lgkmcnt(4)
v_exp_f32 v42, v42
v_mfma_f32_16x16x32_bf16 v[172:175], a[204:207], v[64:67], v[172:175]
v_exp_f32 v43, v43
v_mfma_f32_16x16x32_bf16 a[232:235], a[244:247], v[64:67], a[232:235]
s_waitcnt lgkmcnt(3)
v_cvt_pk_bf16_f32 v70, v40, v41
v_cvt_pk_bf16_f32 v71, v42, v43
v_mfma_f32_16x16x32_bf16 v[40:43], a[176:179], a[112:115], 0
s_waitcnt lgkmcnt(2)
ds_read_b64_tr_b16 a[208:209], v10 offset:49152
v_fmamk_f32 v32, v32, 0x3e0293ee, v25
v_mfma_f32_16x16x32_bf16 v[40:43], a[180:183], a[116:119], v[40:43]
s_waitcnt lgkmcnt(2)
ds_read_b64_tr_b16 a[210:211], v10 offset:53248
v_fmamk_f32 v33, v33, 0x3e0293ee, v25
v_mfma_f32_16x16x32_bf16 v[40:43], a[184:187], a[120:123], v[40:43]
s_waitcnt lgkmcnt(2)
ds_read_b64_tr_b16 a[212:213], v11 offset:49152
v_fmamk_f32 v34, v34, 0x3e0293ee, v25
v_mfma_f32_16x16x32_bf16 v[40:43], a[188:191], a[124:127], v[40:43]
ds_read_b64_tr_b16 a[214:215], v11 offset:53248
v_fmamk_f32 v35, v35, 0x3e0293ee, v25
v_mfma_f32_16x16x32_bf16 v[192:195], a[192:195], v[68:71], v[192:195]
v_exp_f32 v32, v32
v_mfma_f32_16x16x32_bf16 v[196:199], a[196:199], v[68:71], v[196:199]
v_exp_f32 v33, v33
v_mfma_f32_16x16x32_bf16 v[200:203], a[200:203], v[68:71], v[200:203]
ds_read_b64_tr_b16 a[216:217], v12 offset:49152
ds_read_b64_tr_b16 a[218:219], v12 offset:53248
v_exp_f32 v34, v34
v_exp_f32 v35, v35
v_mfma_f32_16x16x32_bf16 v[204:207], a[204:207], v[68:71], v[204:207]
ds_read_b64_tr_b16 a[220:221], v13 offset:49152
ds_read_b64_tr_b16 a[222:223], v13 offset:53248
v_cvt_pk_bf16_f32 v72, v32, v33
v_cvt_pk_bf16_f32 v73, v34, v35
v_mfma_f32_16x16x32_bf16 v[32:35], a[176:179], a[128:131], 0
ds_read_b64_tr_b16 a[192:193], v80 offset:49152
v_fmamk_f32 v40, v40, 0x3e0293ee, v25
v_mfma_f32_16x16x32_bf16 v[32:35], a[180:183], a[132:135], v[32:35]
ds_read_b64_tr_b16 a[194:195], v80 offset:53248
v_fmamk_f32 v41, v41, 0x3e0293ee, v25
v_mfma_f32_16x16x32_bf16 v[32:35], a[184:187], a[136:139], v[32:35]
ds_read_b64_tr_b16 a[196:197], v81 offset:49152
v_fmamk_f32 v42, v42, 0x3e0293ee, v25
v_mfma_f32_16x16x32_bf16 v[32:35], a[188:191], a[140:143], v[32:35]
s_waitcnt lgkmcnt(7)
ds_read_b64_tr_b16 a[198:199], v81 offset:53248
v_fmamk_f32 v43, v43, 0x3e0293ee, v25
v_mfma_f32_16x16x32_bf16 v[176:179], a[208:211], v[64:67], v[176:179]
ds_read_b64_tr_b16 a[200:201], v82 offset:49152
v_fmamk_f32 v36, v36, 0x3e0293ee, v26
v_mfma_f32_16x16x32_bf16 v[180:183], a[212:215], v[64:67], v[180:183]
s_waitcnt lgkmcnt(7)
ds_read_b64_tr_b16 a[202:203], v82 offset:53248
v_fmamk_f32 v37, v37, 0x3e0293ee, v26
v_mfma_f32_16x16x32_bf16 v[184:187], a[216:219], v[64:67], v[184:187]
s_waitcnt lgkmcnt(6)
ds_read_b64_tr_b16 a[204:205], v83 offset:49152
v_fmamk_f32 v38, v38, 0x3e0293ee, v26
v_mfma_f32_16x16x32_bf16 v[188:191], a[220:223], v[64:67], v[188:191]
ds_read_b64_tr_b16 a[206:207], v83 offset:53248
v_fmamk_f32 v39, v39, 0x3e0293ee, v26
v_mfma_f32_16x16x32_bf16 a[236:239], a[244:247], v[68:71], a[236:239]
v_exp_f32 v40, v40
v_mfma_f32_16x16x32_bf16 v[208:211], a[208:211], v[68:71], v[208:211]
v_exp_f32 v41, v41
v_mfma_f32_16x16x32_bf16 v[212:215], a[212:215], v[68:71], v[212:215]
v_exp_f32 v42, v42
v_exp_f32 v43, v43
v_mfma_f32_16x16x32_bf16 v[216:219], a[216:219], v[68:71], v[216:219]
v_cvt_pk_bf16_f32 v74, v40, v41
v_cvt_pk_bf16_f32 v75, v42, v43
v_mfma_f32_16x16x32_bf16 v[220:223], a[220:223], v[68:71], v[220:223]
s_waitcnt lgkmcnt(3)
v_exp_f32 v36, v36
v_mfma_f32_16x16x32_bf16 v[160:163], a[192:195], v[72:75], v[160:163]
v_exp_f32 v37, v37
v_mfma_f32_16x16x32_bf16 v[164:167], a[196:199], v[72:75], v[164:167]
s_waitcnt lgkmcnt(1)
v_exp_f32 v38, v38
v_mfma_f32_16x16x32_bf16 v[168:171], a[200:203], v[72:75], v[168:171]
s_waitcnt lgkmcnt(0)
ds_read_b64_tr_b16 a[208:209], v84 offset:49152
ds_read_b64_tr_b16 a[210:211], v84 offset:53248
v_exp_f32 v39, v39
v_fmamk_f32 v32, v32, 0x3e0293ee, v26
v_fmamk_f32 v33, v33, 0x3e0293ee, v26
v_fmamk_f32 v34, v34, 0x3e0293ee, v26
v_exp_f32 v32, v32
v_exp_f32 v33, v33
v_exp_f32 v34, v34
v_fmamk_f32 v35, v35, 0x3e0293ee, v26
v_exp_f32 v35, v35
v_mfma_f32_16x16x32_bf16 v[172:175], a[204:207], v[72:75], v[172:175]
ds_read_b64_tr_b16 a[212:213], v85 offset:49152
ds_read_b64_tr_b16 a[214:215], v85 offset:53248
v_cvt_pk_bf16_f32 v76, v36, v37
v_cvt_pk_bf16_f32 v77, v38, v39
v_cvt_pk_bf16_f32 v78, v32, v33
v_cvt_pk_bf16_f32 v79, v34, v35
v_mfma_f32_16x16x32_bf16 a[232:235], a[244:247], v[72:75], a[232:235]
ds_read_b64_tr_b16 a[216:217], v86 offset:49152
ds_read_b64_tr_b16 a[218:219], v86 offset:53248
v_mfma_f32_16x16x32_bf16 v[192:195], a[192:195], v[76:79], v[192:195]
ds_read_b64_tr_b16 a[220:221], v87 offset:49152
ds_read_b64_tr_b16 a[222:223], v87 offset:53248
v_mfma_f32_16x16x32_bf16 v[196:199], a[196:199], v[76:79], v[196:199]
v_add_u32 v22, s38, v19
v_mfma_f32_16x16x32_bf16 v[200:203], a[200:203], v[76:79], v[200:203]
s_add_u32 s38, s58, 12288
v_accvgpr_read_b32 v90, a232
v_cmp_nge_f32 vcc, s34, v90
v_rcp_f32 v90, v90
v_mfma_f32_16x16x32_bf16 v[204:207], a[204:207], v[76:79], v[204:207]
s_or_b64 s[42:43], s[42:43], vcc
v_mul_f32 v160, v160, v90
v_mul_f32 v161, v161, v90
v_mul_f32 v162, v162, v90
v_mul_f32 v163, v163, v90
v_cvt_pk_bf16_f32 v160, v160, v161
v_mul_f32 v164, v164, v90
v_cvt_pk_bf16_f32 v161, v162, v163
v_mul_f32 v165, v165, v90
v_mul_f32 v166, v166, v90
v_mul_f32 v167, v167, v90
v_cvt_pk_bf16_f32 v164, v164, v165
v_mul_f32 v168, v168, v90
v_cvt_pk_bf16_f32 v165, v166, v167
v_mul_f32 v169, v169, v90
v_mul_f32 v170, v170, v90
v_mul_f32 v171, v171, v90
v_cvt_pk_bf16_f32 v168, v168, v169
v_mul_f32 v172, v172, v90
v_cvt_pk_bf16_f32 v169, v170, v171
v_mul_f32 v173, v173, v90
v_mul_f32 v174, v174, v90
v_mul_f32 v175, v175, v90
v_cvt_pk_bf16_f32 v172, v172, v173
v_cvt_pk_bf16_f32 v173, v174, v175
v_mfma_f32_16x16x32_bf16 a[236:239], a[244:247], v[76:79], a[236:239]
s_waitcnt lgkmcnt(6)
s_add_u32 s38, s38, s76
ds_write_b64 v20, v[160:161] offset:0
ds_write_b64 v20, v[164:165] offset:32
ds_write_b64 v20, v[168:169] offset:64
ds_write_b64 v20, v[172:173] offset:96
ds_read_b128 a[32:35], v21 offset:0
ds_read_b128 a[36:39], v21 offset:1152
v_mfma_f32_16x16x32_bf16 v[176:179], a[208:211], v[72:75], v[176:179]
s_waitcnt lgkmcnt(10)
v_mfma_f32_16x16x32_bf16 v[180:183], a[212:215], v[72:75], v[180:183]
s_waitcnt lgkmcnt(8)
v_mfma_f32_16x16x32_bf16 v[184:187], a[216:219], v[72:75], v[184:187]
s_waitcnt lgkmcnt(6)
v_accvgpr_read_b32 v91, a236
v_cmp_nge_f32 vcc, s34, v91
v_rcp_f32 v91, v91
v_mfma_f32_16x16x32_bf16 v[188:191], a[220:223], v[72:75], v[188:191]
s_or_b64 s[42:43], s[42:43], vcc
v_mul_f32 v192, v192, v91
v_mul_f32 v193, v193, v91
v_mul_f32 v194, v194, v91
v_mul_f32 v195, v195, v91
v_cvt_pk_bf16_f32 v192, v192, v193
v_mul_f32 v196, v196, v91
v_cvt_pk_bf16_f32 v193, v194, v195
v_mul_f32 v197, v197, v91
v_mul_f32 v198, v198, v91
v_mul_f32 v199, v199, v91
v_cvt_pk_bf16_f32 v196, v196, v197
v_mul_f32 v200, v200, v91
v_cvt_pk_bf16_f32 v197, v198, v199
v_mul_f32 v201, v201, v91
v_mul_f32 v202, v202, v91
v_mul_f32 v203, v203, v91
v_cvt_pk_bf16_f32 v200, v200, v201
v_mul_f32 v204, v204, v91
v_cvt_pk_bf16_f32 v201, v202, v203
v_mul_f32 v205, v205, v91
v_mul_f32 v206, v206, v91
v_mul_f32 v207, v207, v91
v_cvt_pk_bf16_f32 v204, v204, v205
v_mul_f32 v176, v176, v90
v_cvt_pk_bf16_f32 v205, v206, v207
v_mul_f32 v177, v177, v90
v_mul_f32 v178, v178, v90
v_mul_f32 v179, v179, v90
v_cvt_pk_bf16_f32 v176, v176, v177
v_cvt_pk_bf16_f32 v177, v178, v179
v_mfma_f32_16x16x32_bf16 v[208:211], a[208:211], v[76:79], v[208:211]
ds_write_b64 v20, v[192:193] offset:0
ds_write_b64 v20, v[196:197] offset:32
ds_write_b64 v20, v[200:201] offset:64
ds_write_b64 v20, v[204:205] offset:96
ds_read_b128 a[48:51], v21 offset:0
ds_read_b128 a[52:55], v21 offset:1152
ds_write_b64 v20, v[176:177] offset:0
v_mul_f32 v180, v180, v90
v_mul_f32 v181, v181, v90
v_mul_f32 v182, v182, v90
v_mul_f32 v183, v183, v90
v_cvt_pk_bf16_f32 v180, v180, v181
v_cvt_pk_bf16_f32 v181, v182, v183
v_mfma_f32_16x16x32_bf16 v[212:215], a[212:215], v[76:79], v[212:215]
s_waitcnt lgkmcnt(7)
ds_write_b64 v20, v[180:181] offset:32
buffer_store_dwordx4 a[32:35], v22, s[16:19], 0 offen offset:0 sc0 sc1 nt
buffer_store_dwordx4 a[36:39], v22, s[16:19], 0 offen offset:2048 sc0 sc1 nt
v_mul_f32 v184, v184, v90
v_mul_f32 v185, v185, v90
v_mul_f32 v186, v186, v90
v_mul_f32 v187, v187, v90
v_cvt_pk_bf16_f32 v184, v184, v185
v_add_u32 v22, s38, v19
v_cvt_pk_bf16_f32 v185, v186, v187
v_mfma_f32_16x16x32_bf16 v[216:219], a[216:219], v[76:79], v[216:219]
s_add_u32 s38, s58, 8192
s_add_u32 s38, s38, s75
ds_write_b64 v20, v[184:185] offset:64
v_mul_f32 v188, v188, v90
v_mul_f32 v189, v189, v90
v_mul_f32 v190, v190, v90
v_mul_f32 v191, v191, v90
v_cvt_pk_bf16_f32 v188, v188, v189
v_cvt_pk_bf16_f32 v189, v190, v191
v_mfma_f32_16x16x32_bf16 v[220:223], a[220:223], v[76:79], v[220:223]
s_waitcnt lgkmcnt(3)
buffer_store_dwordx4 a[48:51], v22, s[16:19], 0 offen offset:0 sc0 sc1 nt
buffer_store_dwordx4 a[52:55], v22, s[16:19], 0 offen offset:2048 sc0 sc1 nt
ds_write_b64 v20, v[188:189] offset:96
ds_read_b128 a[40:43], v21 offset:0
ds_read_b128 a[44:47], v21 offset:1152
v_add_u32 v22, s38, v19
v_mul_f32 v208, v208, v91
v_mul_f32 v209, v209, v91
v_mul_f32 v210, v210, v91
v_mul_f32 v211, v211, v91
v_cvt_pk_bf16_f32 v208, v208, v209
v_cvt_pk_bf16_f32 v209, v210, v211
v_mul_f32 v212, v212, v91
ds_write_b64 v20, v[208:209] offset:0
v_mul_f32 v213, v213, v91
v_mul_f32 v214, v214, v91
v_mul_f32 v215, v215, v91
v_cvt_pk_bf16_f32 v212, v212, v213
v_cvt_pk_bf16_f32 v213, v214, v215
v_mul_f32 v216, v216, v91
ds_write_b64 v20, v[212:213] offset:32
v_mul_f32 v217, v217, v91
v_mul_f32 v218, v218, v91
v_mul_f32 v219, v219, v91
v_cvt_pk_bf16_f32 v216, v216, v217
v_cvt_pk_bf16_f32 v217, v218, v219
v_mul_f32 v220, v220, v91
ds_write_b64 v20, v[216:217] offset:64
v_mul_f32 v221, v221, v91
v_mul_f32 v222, v222, v91
v_mul_f32 v223, v223, v91
s_waitcnt lgkmcnt(4)
buffer_store_dwordx4 a[40:43], v22, s[16:19], 0 offen offset:0 sc0 sc1 nt
s_waitcnt lgkmcnt(3)
buffer_store_dwordx4 a[44:47], v22, s[16:19], 0 offen offset:2048 sc0 sc1 nt
v_cvt_pk_bf16_f32 v220, v220, v221
v_cvt_pk_bf16_f32 v221, v222, v223
s_add_u32 s38, s58, 12288
ds_write_b64 v20, v[220:221] offset:96
ds_read_b128 a[56:59], v21 offset:0
ds_read_b128 a[60:63], v21 offset:1152
s_add_u32 s38, s38, s75
v_add_u32 v22, s38, v19
s_waitcnt lgkmcnt(1)
buffer_store_dwordx4 a[56:59], v22, s[16:19], 0 offen offset:0 sc0 sc1 nt
s_waitcnt lgkmcnt(0)
buffer_store_dwordx4 a[60:63], v22, s[16:19], 0 offen offset:2048 sc0 sc1 nt
s_or_b64 s[44:45], s[40:41], s[42:43]
s_cbranch_scc1 L_redo
s_endpgm
.p2align 12
L_main1:
L_pad1_0:
s_cbranch_execz L_pad1_4
s_waitcnt vmcnt(14)
ds_read_b128 a[0:3], v252 offset:0
ds_read_b128 a[160:163], v2 offset:0
ds_read_b128 a[4:7], v253 offset:0
ds_read_b128 a[164:167], v3 offset:0
ds_read_b128 a[8:11], v254 offset:0
ds_read_b128 a[168:171], v4 offset:0
ds_read_b128 a[12:15], v255 offset:0
ds_read_b128 a[172:175], v5 offset:0
s_waitcnt lgkmcnt(6)
v_mfma_f32_16x16x32_bf16 v[32:35], a[160:163], a[0:3], 0
s_waitcnt vmcnt(10) lgkmcnt(4)
s_add_u32 m0, s59, 12288
ds_read_b128 a[16:19], v252 offset:4096
ds_read_b128 a[20:23], v253 offset:4096
ds_read_b128 a[24:27], v254 offset:4096
ds_read_b128 a[28:31], v255 offset:4096
v_mfma_f32_16x16x32_bf16 v[32:35], a[164:167], a[4:7], v[32:35]
s_waitcnt lgkmcnt(6)
s_add_u32 s30, s28, 16384
ds_read_b128 a[176:179], v2 offset:4096
v_add_u32 v248, 4096, v248
v_mfma_f32_16x16x32_bf16 v[32:35], a[168:171], a[8:11], v[32:35]
s_waitcnt lgkmcnt(5)
s_add_u32 s31, s28, 16384
ds_read_b128 a[180:183], v3 offset:4096
v_add_u32 v249, 4096, v249
v_mfma_f32_16x16x32_bf16 v[32:35], a[172:175], a[12:15], v[32:35]
s_waitcnt lgkmcnt(5)
s_add_u32 s38, s58, 0
buffer_load_dwordx4 v248, s[4:7], 0 offen offset:0 nt lds
v_add_u32 v250, 4096, v250
v_mfma_f32_16x16x32_bf16 v[36:39], a[160:163], a[16:19], 0
s_waitcnt vmcnt(7) lgkmcnt(4)
ds_read_b128 a[32:35], v252 offset:8192
ds_read_b128 a[36:39], v253 offset:8192
ds_read_b128 a[40:43], v254 offset:8192
ds_read_b128 a[44:47], v255 offset:8192
v_mfma_f32_16x16x32_bf16 v[36:39], a[164:167], a[20:23], v[36:39]
s_waitcnt lgkmcnt(7)
ds_read_b128 a[184:187], v4 offset:4096
v_xor_b32 v6, s76, v6
v_mfma_f32_16x16x32_bf16 v[36:39], a[168:171], a[24:27], v[36:39]
s_waitcnt lgkmcnt(7)
ds_read_b128 a[188:191], v5 offset:4096
v_max3_f32 v23, v32, v33, v34
v_mfma_f32_16x16x32_bf16 v[36:39], a[172:175], a[28:31], v[36:39]
s_waitcnt lgkmcnt(5)
v_max_f32 v23, v23, v35
v_mov_b32 v93, v23
v_mfma_f32_16x16x32_bf16 v[40:43], a[160:163], a[32:35], 0
s_waitcnt lgkmcnt(4)
v_permlane32_swap_b32 v93, v23
v_mfma_f32_16x16x32_bf16 v[40:43], a[164:167], a[36:39], v[40:43]
s_waitcnt lgkmcnt(3)
v_max_f32 v23, v23, v93
v_mov_b32 v93, v23
v_mfma_f32_16x16x32_bf16 v[40:43], a[168:171], a[40:43], v[40:43]
s_waitcnt lgkmcnt(2)
v_permlane16_swap_b32 v93, v23
v_max_f32 v23, v23, v93
v_mul_f32 v23, 0xbe0293ee, v23
v_fmamk_f32 v32, v32, 0x3e0293ee, v23
v_fmamk_f32 v33, v33, 0x3e0293ee, v23
v_fmamk_f32 v34, v34, 0x3e0293ee, v23
v_exp_f32 v32, v32
v_exp_f32 v33, v33
v_exp_f32 v34, v34
v_fmamk_f32 v35, v35, 0x3e0293ee, v23
v_exp_f32 v35, v35
v_mfma_f32_16x16x32_bf16 v[40:43], a[172:175], a[44:47], v[40:43]
s_waitcnt vmcnt(1)
buffer_load_dwordx4 v249, s[4:7], 0 offen offset:1024 nt lds
v_cvt_pk_bf16_f32 v48, v32, v33
v_cvt_pk_bf16_f32 v49, v34, v35
v_mfma_f32_16x16x32_bf16 v[32:35], a[176:179], a[0:3], 0
s_barrier
v_max3_f32 v24, v36, v37, v38
v_max_f32 v24, v24, v39
v_mov_b32 v93, v24
v_mfma_f32_16x16x32_bf16 v[32:35], a[180:183], a[4:7], v[32:35]
s_waitcnt lgkmcnt(1)
v_permlane32_swap_b32 v93, v24
v_max_f32 v24, v24, v93
v_mov_b32 v93, v24
v_mfma_f32_16x16x32_bf16 v[32:35], a[184:187], a[8:11], v[32:35]
s_waitcnt lgkmcnt(0)
v_permlane16_swap_b32 v93, v24
v_max_f32 v24, v24, v93
v_mul_f32 v24, 0xbe0293ee, v24
v_fmamk_f32 v36, v36, 0x3e0293ee, v24
v_fmamk_f32 v37, v37, 0x3e0293ee, v24
v_fmamk_f32 v38, v38, 0x3e0293ee, v24
v_exp_f32 v36, v36
v_exp_f32 v37, v37
v_exp_f32 v38, v38
v_fmamk_f32 v39, v39, 0x3e0293ee, v24
v_exp_f32 v39, v39
v_mfma_f32_16x16x32_bf16 v[32:35], a[188:191], a[12:15], v[32:35]
v_cvt_pk_bf16_f32 v52, v36, v37
v_cvt_pk_bf16_f32 v53, v38, v39
v_mfma_f32_16x16x32_bf16 v[36:39], a[176:179], a[16:19], 0
ds_read_b128 a[160:163], v2 offset:8192
v_max3_f32 v25, v40, v41, v42
v_max_f32 v25, v25, v43
v_mov_b32 v93, v25
v_mfma_f32_16x16x32_bf16 v[36:39], a[180:183], a[20:23], v[36:39]
buffer_load_dwordx4 v250, s[4:7], 0 offen offset:2048 nt lds
ds_read_b128 a[164:167], v3 offset:8192
v_permlane32_swap_b32 v93, v25
v_max_f32 v25, v25, v93
v_mov_b32 v93, v25
v_mfma_f32_16x16x32_bf16 v[36:39], a[184:187], a[24:27], v[36:39]
ds_read_b128 a[168:171], v4 offset:8192
v_permlane16_swap_b32 v93, v25
v_max_f32 v25, v25, v93
v_mul_f32 v25, 0xbe0293ee, v25
v_fmamk_f32 v40, v40, 0x3e0293ee, v25
v_fmamk_f32 v41, v41, 0x3e0293ee, v25
v_fmamk_f32 v42, v42, 0x3e0293ee, v25
v_exp_f32 v40, v40
v_exp_f32 v41, v41
v_exp_f32 v42, v42
v_fmamk_f32 v43, v43, 0x3e0293ee, v25
v_exp_f32 v43, v43
v_mfma_f32_16x16x32_bf16 v[36:39], a[188:191], a[28:31], v[36:39]
ds_read_b128 a[172:175], v5 offset:8192
v_cvt_pk_bf16_f32 v56, v40, v41
v_cvt_pk_bf16_f32 v57, v42, v43
v_mfma_f32_16x16x32_bf16 v[40:43], a[176:179], a[32:35], 0
ds_read_b64_tr_b16 a[192:193], v6 offset:0
ds_read_b64_tr_b16 a[194:195], v6 offset:4096
v_xor_b32 v7, s76, v7
v_mfma_f32_16x16x32_bf16 v[40:43], a[180:183], a[36:39], v[40:43]
ds_read_b64_tr_b16 a[196:197], v7 offset:0
ds_read_b64_tr_b16 a[198:199], v7 offset:4096
v_xor_b32 v8, s76, v8
v_mfma_f32_16x16x32_bf16 v[40:43], a[184:187], a[40:43], v[40:43]
ds_read_b64_tr_b16 a[200:201], v8 offset:0
ds_read_b64_tr_b16 a[202:203], v8 offset:4096
v_add_u32 v251, 4096, v251
v_fmamk_f32 v32, v32, 0x3e0293ee, v23
v_fmamk_f32 v33, v33, 0x3e0293ee, v23
v_fmamk_f32 v34, v34, 0x3e0293ee, v23
v_exp_f32 v32, v32
v_exp_f32 v33, v33
v_exp_f32 v34, v34
v_fmamk_f32 v35, v35, 0x3e0293ee, v23
v_xor_b32 v9, s76, v9
v_exp_f32 v35, v35
v_mfma_f32_16x16x32_bf16 v[40:43], a[188:191], a[44:47], v[40:43]
s_waitcnt lgkmcnt(8)
buffer_load_dwordx4 v251, s[4:7], 0 offen offset:3072 nt lds
ds_read_b64_tr_b16 a[204:205], v9 offset:0
ds_read_b64_tr_b16 a[206:207], v9 offset:4096
v_cvt_pk_bf16_f32 v50, v32, v33
v_cvt_pk_bf16_f32 v51, v34, v35
v_mfma_f32_16x16x32_bf16 v[32:35], a[160:163], a[0:3], 0
s_add_u32 m0, s59, 16384
ds_read_b128 a[176:179], v2 offset:12288
v_add_u32 v248, s74, v248
v_mfma_f32_16x16x32_bf16 v[32:35], a[164:167], a[4:7], v[32:35]
s_waitcnt lgkmcnt(10)
ds_read_b128 a[180:183], v3 offset:12288
v_fmamk_f32 v36, v36, 0x3e0293ee, v24
v_mfma_f32_16x16x32_bf16 v[32:35], a[168:171], a[8:11], v[32:35]
s_waitcnt lgkmcnt(10)
v_exp_f32 v36, v36
v_mfma_f32_16x16x32_bf16 v[32:35], a[172:175], a[12:15], v[32:35]
s_waitcnt lgkmcnt(8)
buffer_load_dwordx4 v248, s[4:7], 0 offen offset:0 nt lds
v_fmamk_f32 v37, v37, 0x3e0293ee, v24
v_mfma_f32_16x16x32_bf16 v[96:99], a[192:195], v[48:51], 0
s_waitcnt lgkmcnt(6)
v_exp_f32 v37, v37
v_mfma_f32_16x16x32_bf16 v[100:103], a[196:199], v[48:51], 0
s_waitcnt lgkmcnt(4)
v_fmamk_f32 v38, v38, 0x3e0293ee, v24
v_fmamk_f32 v39, v39, 0x3e0293ee, v24
v_mfma_f32_16x16x32_bf16 v[104:107], a[200:203], v[48:51], 0
s_waitcnt lgkmcnt(2)
v_exp_f32 v38, v38
v_mfma_f32_16x16x32_bf16 v[108:111], a[204:207], v[48:51], 0
v_exp_f32 v39, v39
v_mfma_f32_16x16x32_bf16 a[224:227], a[244:247], v[48:51], 0
v_cvt_pk_bf16_f32 v54, v36, v37
v_cvt_pk_bf16_f32 v55, v38, v39
v_mfma_f32_16x16x32_bf16 v[36:39], a[160:163], a[16:19], 0
ds_read_b128 a[184:187], v4 offset:12288
v_add_u32 v249, s74, v249
v_mfma_f32_16x16x32_bf16 v[36:39], a[164:167], a[20:23], v[36:39]
buffer_load_dwordx4 v249, s[4:7], 0 offen offset:1024 nt lds
v_fmamk_f32 v40, v40, 0x3e0293ee, v25
v_mfma_f32_16x16x32_bf16 v[36:39], a[168:171], a[24:27], v[36:39]
v_exp_f32 v40, v40
v_mfma_f32_16x16x32_bf16 v[36:39], a[172:175], a[28:31], v[36:39]
ds_read_b128 a[188:191], v5 offset:12288
v_fmamk_f32 v41, v41, 0x3e0293ee, v25
v_mfma_f32_16x16x32_bf16 v[128:131], a[192:195], v[52:55], 0
v_exp_f32 v41, v41
v_mfma_f32_16x16x32_bf16 v[132:135], a[196:199], v[52:55], 0
v_fmamk_f32 v42, v42, 0x3e0293ee, v25
v_fmamk_f32 v43, v43, 0x3e0293ee, v25
v_mfma_f32_16x16x32_bf16 v[136:139], a[200:203], v[52:55], 0
v_exp_f32 v42, v42
v_exp_f32 v43, v43
v_mfma_f32_16x16x32_bf16 v[140:143], a[204:207], v[52:55], 0
v_add_u32 v250, s74, v250
v_cvt_pk_bf16_f32 v58, v40, v41
v_cvt_pk_bf16_f32 v59, v42, v43
v_mfma_f32_16x16x32_bf16 v[40:43], a[160:163], a[32:35], 0
buffer_load_dwordx4 v250, s[4:7], 0 offen offset:2048 nt lds
v_xor_b32 v10, s76, v10
v_mfma_f32_16x16x32_bf16 v[40:43], a[164:167], a[36:39], v[40:43]
ds_read_b64_tr_b16 a[208:209], v10 offset:0
v_add_u32 v251, s74, v251
v_mfma_f32_16x16x32_bf16 v[40:43], a[168:171], a[40:43], v[40:43]
ds_read_b64_tr_b16 a[210:211], v10 offset:4096
v_xor_b32 v11, s76, v11
v_mfma_f32_16x16x32_bf16 v[40:43], a[172:175], a[44:47], v[40:43]
ds_read_b64_tr_b16 a[212:213], v11 offset:0
v_xor_b32 v12, s76, v12
v_mfma_f32_16x16x32_bf16 v[160:163], a[192:195], v[56:59], 0
buffer_load_dwordx4 v251, s[4:7], 0 offen offset:3072 nt lds
v_xor_b32 v13, s76, v13
v_mfma_f32_16x16x32_bf16 v[164:167], a[196:199], v[56:59], 0
s_add_u32 m0, s32, 16384
ds_read_b64_tr_b16 a[214:215], v11 offset:4096
v_fmamk_f32 v32, v32, 0x3e0293ee, v23
v_mfma_f32_16x16x32_bf16 v[168:171], a[200:203], v[56:59], 0
v_exp_f32 v32, v32
v_mfma_f32_16x16x32_bf16 v[172:175], a[204:207], v[56:59], 0
ds_read_b64_tr_b16 a[216:217], v12 offset:0
ds_read_b64_tr_b16 a[218:219], v12 offset:4096
v_fmamk_f32 v33, v33, 0x3e0293ee, v23
v_fmamk_f32 v34, v34, 0x3e0293ee, v23
v_fmamk_f32 v35, v35, 0x3e0293ee, v23
v_exp_f32 v33, v33
v_exp_f32 v34, v34
v_exp_f32 v35, v35
v_mfma_f32_16x16x32_bf16 a[228:231], a[244:247], v[52:55], 0
s_waitcnt lgkmcnt(6)
ds_read_b64_tr_b16 a[220:221], v13 offset:0
ds_read_b64_tr_b16 a[222:223], v13 offset:4096
v_cvt_pk_bf16_f32 v60, v32, v33
v_cvt_pk_bf16_f32 v61, v34, v35
v_mfma_f32_16x16x32_bf16 v[32:35], a[176:179], a[0:3], 0
v_fmamk_f32 v36, v36, 0x3e0293ee, v24
v_fmamk_f32 v37, v37, 0x3e0293ee, v24
v_mfma_f32_16x16x32_bf16 v[32:35], a[180:183], a[4:7], v[32:35]
buffer_load_dwordx4 v14, s[20:23], s30 offen nt lds
v_fmamk_f32 v38, v38, 0x3e0293ee, v24
v_mfma_f32_16x16x32_bf16 v[32:35], a[184:187], a[8:11], v[32:35]
v_exp_f32 v36, v36
v_mfma_f32_16x16x32_bf16 v[32:35], a[188:191], a[12:15], v[32:35]
s_waitcnt lgkmcnt(5)
v_exp_f32 v37, v37
v_mfma_f32_16x16x32_bf16 v[112:115], a[208:211], v[48:51], 0
s_waitcnt lgkmcnt(4)
v_exp_f32 v38, v38
v_mfma_f32_16x16x32_bf16 v[116:119], a[212:215], v[48:51], 0
s_waitcnt lgkmcnt(2)
v_fmamk_f32 v39, v39, 0x3e0293ee, v24
v_cvt_pk_bf16_f32 v64, v36, v37
v_mfma_f32_16x16x32_bf16 v[120:123], a[216:219], v[48:51], 0
s_waitcnt lgkmcnt(0)
v_exp_f32 v39, v39
v_mfma_f32_16x16x32_bf16 v[124:127], a[220:223], v[48:51], 0
v_cvt_pk_bf16_f32 v65, v38, v39
v_fmamk_f32 v40, v40, 0x3e0293ee, v25
v_mfma_f32_16x16x32_bf16 v[36:39], a[176:179], a[16:19], 0
buffer_load_dwordx4 v15, s[20:23], s30 offen offset:1024 nt lds
v_fmamk_f32 v41, v41, 0x3e0293ee, v25
v_mfma_f32_16x16x32_bf16 v[36:39], a[180:183], a[20:23], v[36:39]
s_add_u32 m0, s32, 81920
v_exp_f32 v40, v40
v_mfma_f32_16x16x32_bf16 v[36:39], a[184:187], a[24:27], v[36:39]
s_add_u32 s30, s28, 24576
v_exp_f32 v41, v41
v_mfma_f32_16x16x32_bf16 v[36:39], a[188:191], a[28:31], v[36:39]
ds_read_b64_tr_b16 a[192:193], v6 offset:8192
v_fmamk_f32 v42, v42, 0x3e0293ee, v25
v_mfma_f32_16x16x32_bf16 v[144:147], a[208:211], v[52:55], 0
v_exp_f32 v42, v42
v_mfma_f32_16x16x32_bf16 v[148:151], a[212:215], v[52:55], 0
buffer_load_dwordx4 v16, s[24:27], s31 offen nt lds
v_fmamk_f32 v43, v43, 0x3e0293ee, v25
v_mfma_f32_16x16x32_bf16 v[152:155], a[216:219], v[52:55], 0
v_exp_f32 v43, v43
v_mfma_f32_16x16x32_bf16 v[156:159], a[220:223], v[52:55], 0
ds_read_b64_tr_b16 a[194:195], v6 offset:12288
v_cvt_pk_bf16_f32 v68, v40, v41
v_mfma_f32_16x16x32_bf16 a[232:235], a[244:247], v[56:59], 0
v_cvt_pk_bf16_f32 v69, v42, v43
v_xor_b32 v2, s77, v2
v_mfma_f32_16x16x32_bf16 v[40:43], a[176:179], a[32:35], 0
ds_read_b128 a[160:163], v2 offset:0
v_xor_b32 v3, s77, v3
v_mfma_f32_16x16x32_bf16 v[40:43], a[180:183], a[36:39], v[40:43]
ds_read_b128 a[164:167], v3 offset:0
v_xor_b32 v4, s77, v4
v_mfma_f32_16x16x32_bf16 v[40:43], a[184:187], a[40:43], v[40:43]
ds_read_b128 a[168:171], v4 offset:0
v_xor_b32 v5, s77, v5
v_mfma_f32_16x16x32_bf16 v[40:43], a[188:191], a[44:47], v[40:43]
ds_read_b128 a[172:175], v5 offset:0
v_fmamk_f32 v32, v32, 0x3e0293ee, v23
v_mfma_f32_16x16x32_bf16 v[176:179], a[208:211], v[56:59], 0
s_waitcnt vmcnt(7)
ds_read_b128 a[48:51], v252 offset:12288
ds_read_b128 a[52:55], v253 offset:12288
ds_read_b128 a[56:59], v254 offset:12288
ds_read_b128 a[60:63], v255 offset:12288
buffer_load_dwordx4 v17, s[24:27], s31 offen offset:1024 nt lds
v_mfma_f32_16x16x32_bf16 v[180:183], a[212:215], v[56:59], 0
s_add_u32 m0, s32, 24576
ds_read_b64_tr_b16 a[196:197], v7 offset:8192
ds_read_b64_tr_b16 a[198:199], v7 offset:12288
v_mfma_f32_16x16x32_bf16 v[184:187], a[216:219], v[56:59], 0
s_add_u32 s31, s28, 24576
ds_read_b64_tr_b16 a[200:201], v8 offset:8192
ds_read_b64_tr_b16 a[202:203], v8 offset:12288
v_exp_f32 v32, v32
v_fmamk_f32 v33, v33, 0x3e0293ee, v23
v_fmamk_f32 v34, v34, 0x3e0293ee, v23
v_fmamk_f32 v35, v35, 0x3e0293ee, v23
v_exp_f32 v33, v33
v_exp_f32 v34, v34
v_exp_f32 v35, v35
v_mfma_f32_16x16x32_bf16 v[188:191], a[220:223], v[56:59], 0
s_waitcnt lgkmcnt(7)
ds_read_b64_tr_b16 a[204:205], v9 offset:8192
ds_read_b64_tr_b16 a[206:207], v9 offset:12288
v_cvt_pk_bf16_f32 v62, v32, v33
v_cvt_pk_bf16_f32 v63, v34, v35
v_mfma_f32_16x16x32_bf16 v[32:35], a[160:163], a[48:51], 0
s_waitcnt lgkmcnt(8)
buffer_load_dwordx4 v14, s[20:23], s30 offen nt lds
v_fmamk_f32 v36, v36, 0x3e0293ee, v24
v_mfma_f32_16x16x32_bf16 v[32:35], a[164:167], a[52:55], v[32:35]
s_waitcnt lgkmcnt(7)
v_exp_f32 v36, v36
v_mfma_f32_16x16x32_bf16 v[32:35], a[168:171], a[56:59], v[32:35]
s_waitcnt lgkmcnt(6)
ds_read_b128 a[176:179], v2 offset:4096
v_fmamk_f32 v37, v37, 0x3e0293ee, v24
v_mfma_f32_16x16x32_bf16 v[32:35], a[172:175], a[60:63], v[32:35]
v_exp_f32 v37, v37
v_mfma_f32_16x16x32_bf16 v[96:99], a[192:195], v[60:63], v[96:99]
s_waitcnt lgkmcnt(5)
ds_read_b128 a[180:183], v3 offset:4096
v_fmamk_f32 v38, v38, 0x3e0293ee, v24
v_mfma_f32_16x16x32_bf16 v[100:103], a[196:199], v[60:63], v[100:103]
s_waitcnt vmcnt(5) lgkmcnt(4)
ds_read_b128 a[64:67], v252 offset:16384
ds_read_b128 a[68:71], v253 offset:16384
ds_read_b128 a[72:75], v254 offset:16384
ds_read_b128 a[76:79], v255 offset:16384
v_mfma_f32_16x16x32_bf16 v[104:107], a[200:203], v[60:63], v[104:107]
s_waitcnt lgkmcnt(6)
v_exp_f32 v38, v38
v_mfma_f32_16x16x32_bf16 v[108:111], a[204:207], v[60:63], v[108:111]
v_fmamk_f32 v39, v39, 0x3e0293ee, v24
v_exp_f32 v39, v39
v_mfma_f32_16x16x32_bf16 a[224:227], a[244:247], v[60:63], a[224:227]
s_waitcnt lgkmcnt(3)
buffer_load_dwordx4 v15, s[20:23], s30 offen offset:1024 nt lds
v_cvt_pk_bf16_f32 v66, v36, v37
v_cvt_pk_bf16_f32 v67, v38, v39
v_mfma_f32_16x16x32_bf16 v[36:39], a[160:163], a[64:67], 0
s_waitcnt lgkmcnt(2)
s_add_u32 m0, s32, 90112
ds_read_b128 a[184:187], v4 offset:4096
v_fmamk_f32 v40, v40, 0x3e0293ee, v25
v_mfma_f32_16x16x32_bf16 v[36:39], a[164:167], a[68:71], v[36:39]
s_waitcnt lgkmcnt(2)
s_add_u32 s30, s28, 32768
ds_read_b128 a[188:191], v5 offset:4096
v_fmamk_f32 v41, v41, 0x3e0293ee, v25
v_mfma_f32_16x16x32_bf16 v[36:39], a[168:171], a[72:75], v[36:39]
s_waitcnt lgkmcnt(2)
v_exp_f32 v40, v40
v_mfma_f32_16x16x32_bf16 v[36:39], a[172:175], a[76:79], v[36:39]
buffer_load_dwordx4 v16, s[24:27], s31 offen nt lds
v_fmamk_f32 v42, v42, 0x3e0293ee, v25
v_mfma_f32_16x16x32_bf16 v[128:131], a[192:195], v[64:67], v[128:131]
v_exp_f32 v41, v41
v_mfma_f32_16x16x32_bf16 v[132:135], a[196:199], v[64:67], v[132:135]
v_exp_f32 v42, v42
v_mfma_f32_16x16x32_bf16 v[136:139], a[200:203], v[64:67], v[136:139]
v_fmamk_f32 v43, v43, 0x3e0293ee, v25
v_exp_f32 v43, v43
v_mfma_f32_16x16x32_bf16 v[140:143], a[204:207], v[64:67], v[140:143]
v_cvt_pk_bf16_f32 v70, v40, v41
v_cvt_pk_bf16_f32 v71, v42, v43
v_mfma_f32_16x16x32_bf16 v[40:43], a[176:179], a[48:51], 0
s_barrier
ds_read_b64_tr_b16 a[208:209], v10 offset:8192
v_max3_f32 v26, v32, v33, v34
v_mfma_f32_16x16x32_bf16 v[40:43], a[180:183], a[52:55], v[40:43]
s_waitcnt lgkmcnt(1)
ds_read_b64_tr_b16 a[210:211], v10 offset:12288
v_max_f32 v26, v26, v35
v_mfma_f32_16x16x32_bf16 v[40:43], a[184:187], a[56:59], v[40:43]
ds_read_b64_tr_b16 a[212:213], v11 offset:8192
ds_read_b64_tr_b16 a[214:215], v11 offset:12288
v_mfma_f32_16x16x32_bf16 v[40:43], a[188:191], a[60:63], v[40:43]
buffer_load_dwordx4 v17, s[24:27], s31 offen offset:1024 nt lds
ds_read_b64_tr_b16 a[216:217], v12 offset:8192
ds_read_b64_tr_b16 a[218:219], v12 offset:12288
v_mfma_f32_16x16x32_bf16 v[160:163], a[192:195], v[68:71], v[160:163]
s_add_u32 m0, s32, 32768
ds_read_b64_tr_b16 a[220:221], v13 offset:8192
ds_read_b64_tr_b16 a[222:223], v13 offset:12288
v_mfma_f32_16x16x32_bf16 v[164:167], a[196:199], v[68:71], v[164:167]
s_add_u32 s31, s28, 32768
buffer_load_dwordx4 v14, s[20:23], s30 offen nt lds
v_mov_b32 v93, v26
v_mfma_f32_16x16x32_bf16 v[168:171], a[200:203], v[68:71], v[168:171]
s_nop 0
v_permlane32_swap_b32 v93, v26
v_mfma_f32_16x16x32_bf16 v[172:175], a[204:207], v[68:71], v[172:175]
v_max_f32 v26, v26, v93
v_mov_b32 v93, v26
v_mfma_f32_16x16x32_bf16 a[228:231], a[244:247], v[64:67], a[228:231]
s_waitcnt lgkmcnt(6)
v_permlane16_swap_b32 v93, v26
v_mfma_f32_16x16x32_bf16 v[112:115], a[208:211], v[60:63], v[112:115]
s_waitcnt lgkmcnt(2)
buffer_load_dwordx4 v15, s[20:23], s30 offen offset:1024 nt lds
v_max_f32 v26, v26, v93
v_mfma_f32_16x16x32_bf16 v[116:119], a[212:215], v[60:63], v[116:119]
s_add_u32 m0, s32, 98304
v_mul_f32 v26, 0xbe0293ee, v26
v_fmamk_f32 v32, v32, 0x3e0293ee, v26
v_mfma_f32_16x16x32_bf16 v[120:123], a[216:219], v[60:63], v[120:123]
s_waitcnt lgkmcnt(0)
s_add_u32 s30, s28, 40960
v_exp_f32 v32, v32
v_fmamk_f32 v33, v33, 0x3e0293ee, v26
v_fmamk_f32 v34, v34, 0x3e0293ee, v26
v_fmamk_f32 v35, v35, 0x3e0293ee, v26
v_exp_f32 v33, v33
v_exp_f32 v34, v34
v_exp_f32 v35, v35
v_mfma_f32_16x16x32_bf16 v[124:127], a[220:223], v[60:63], v[124:127]
v_cvt_pk_bf16_f32 v72, v32, v33
v_cvt_pk_bf16_f32 v73, v34, v35
v_mfma_f32_16x16x32_bf16 v[32:35], a[176:179], a[64:67], 0
v_xor_b32 v44, 0x2000, v2
v_xor_b32 v45, 0x2000, v3
v_mfma_f32_16x16x32_bf16 v[32:35], a[180:183], a[68:71], v[32:35]
ds_read_b128 a[160:163], v44 offset:0
v_xor_b32 v46, 0x2000, v4
v_mfma_f32_16x16x32_bf16 v[32:35], a[184:187], a[72:75], v[32:35]
ds_read_b128 a[164:167], v45 offset:0
v_xor_b32 v47, 0x2000, v5
v_mfma_f32_16x16x32_bf16 v[32:35], a[188:191], a[76:79], v[32:35]
ds_read_b128 a[168:171], v46 offset:0
v_max3_f32 v27, v36, v37, v38
v_mfma_f32_16x16x32_bf16 v[144:147], a[208:211], v[64:67], v[144:147]
ds_read_b128 a[172:175], v47 offset:0
v_max_f32 v27, v27, v39
v_mfma_f32_16x16x32_bf16 v[148:151], a[212:215], v[64:67], v[148:151]
v_mov_b32 v93, v27
v_xor_b32 v6, s77, v6
v_mfma_f32_16x16x32_bf16 v[152:155], a[216:219], v[64:67], v[152:155]
v_permlane32_swap_b32 v93, v27
v_max_f32 v27, v27, v93
v_mov_b32 v93, v27
v_mfma_f32_16x16x32_bf16 v[156:159], a[220:223], v[64:67], v[156:159]
s_nop 0
v_permlane16_swap_b32 v93, v27
v_max_f32 v27, v27, v93
v_mul_f32 v27, 0xbe0293ee, v27
v_fmamk_f32 v36, v36, 0x3e0293ee, v27
v_fmamk_f32 v37, v37, 0x3e0293ee, v27
v_fmamk_f32 v38, v38, 0x3e0293ee, v27
v_exp_f32 v36, v36
v_exp_f32 v37, v37
v_exp_f32 v38, v38
v_fmamk_f32 v39, v39, 0x3e0293ee, v27
v_exp_f32 v39, v39
v_mfma_f32_16x16x32_bf16 a[232:235], a[244:247], v[68:71], a[232:235]
s_waitcnt lgkmcnt(3)
v_cvt_pk_bf16_f32 v76, v36, v37
v_cvt_pk_bf16_f32 v77, v38, v39
v_mfma_f32_16x16x32_bf16 v[36:39], a[160:163], a[48:51], 0
s_waitcnt lgkmcnt(2)
ds_read_b128 a[176:179], v44 offset:4096
v_xor_b32 v7, s77, v7
v_mfma_f32_16x16x32_bf16 v[36:39], a[164:167], a[52:55], v[36:39]
s_waitcnt lgkmcnt(2)
ds_read_b128 a[180:183], v45 offset:4096
v_xor_b32 v8, s77, v8
v_mfma_f32_16x16x32_bf16 v[36:39], a[168:171], a[56:59], v[36:39]
s_waitcnt lgkmcnt(2)
buffer_load_dwordx4 v16, s[24:27], s31 offen nt lds
ds_read_b128 a[184:187], v46 offset:4096
v_mfma_f32_16x16x32_bf16 v[36:39], a[172:175], a[60:63], v[36:39]
ds_read_b128 a[188:191], v47 offset:4096
v_fmamk_f32 v40, v40, 0x3e0293ee, v26
v_mfma_f32_16x16x32_bf16 v[176:179], a[208:211], v[68:71], v[176:179]
ds_read_b64_tr_b16 a[192:193], v6 offset:0
ds_read_b64_tr_b16 a[194:195], v6 offset:4096
v_mfma_f32_16x16x32_bf16 v[180:183], a[212:215], v[68:71], v[180:183]
ds_read_b64_tr_b16 a[196:197], v7 offset:0
ds_read_b64_tr_b16 a[198:199], v7 offset:4096
v_mfma_f32_16x16x32_bf16 v[184:187], a[216:219], v[68:71], v[184:187]
s_waitcnt lgkmcnt(7)
buffer_load_dwordx4 v17, s[24:27], s31 offen offset:1024 nt lds
ds_read_b64_tr_b16 a[200:201], v8 offset:0
ds_read_b64_tr_b16 a[202:203], v8 offset:4096
v_exp_f32 v40, v40
v_fmamk_f32 v41, v41, 0x3e0293ee, v26
v_fmamk_f32 v42, v42, 0x3e0293ee, v26
v_fmamk_f32 v43, v43, 0x3e0293ee, v26
v_exp_f32 v41, v41
v_exp_f32 v42, v42
v_exp_f32 v43, v43
v_xor_b32 v9, s77, v9
v_mfma_f32_16x16x32_bf16 v[188:191], a[220:223], v[68:71], v[188:191]
s_waitcnt vmcnt(4) lgkmcnt(6)
s_add_u32 m0, s32, 40960
ds_read_b64_tr_b16 a[204:205], v9 offset:0
ds_read_b64_tr_b16 a[206:207], v9 offset:4096
v_cvt_pk_bf16_f32 v74, v40, v41
v_cvt_pk_bf16_f32 v75, v42, v43
v_mfma_f32_16x16x32_bf16 v[40:43], a[176:179], a[48:51], 0
s_barrier
ds_read_b128 a[160:163], v2 offset:16384
v_fmamk_f32 v32, v32, 0x3e0293ee, v27
v_mfma_f32_16x16x32_bf16 v[40:43], a[180:183], a[52:55], v[40:43]
s_add_u32 s31, s28, 40960
buffer_load_dwordx4 v14, s[20:23], s30 offen nt lds
v_fmamk_f32 v33, v33, 0x3e0293ee, v27
v_mfma_f32_16x16x32_bf16 v[40:43], a[184:187], a[56:59], v[40:43]
ds_read_b128 a[164:167], v3 offset:16384
v_fmamk_f32 v34, v34, 0x3e0293ee, v27
v_mfma_f32_16x16x32_bf16 v[40:43], a[188:191], a[60:63], v[40:43]
s_waitcnt lgkmcnt(8)
ds_read_b128 a[168:171], v4 offset:16384
v_fmamk_f32 v35, v35, 0x3e0293ee, v27
v_mfma_f32_16x16x32_bf16 v[192:195], a[192:195], v[72:75], 0
s_waitcnt lgkmcnt(7)
ds_read_b128 a[172:175], v5 offset:16384
v_xor_b32 v10, s77, v10
v_mfma_f32_16x16x32_bf16 v[196:199], a[196:199], v[72:75], 0
s_waitcnt lgkmcnt(4)
buffer_load_dwordx4 v15, s[20:23], s30 offen offset:1024 nt lds
v_xor_b32 v11, s77, v11
v_mfma_f32_16x16x32_bf16 v[200:203], a[200:203], v[72:75], 0
s_add_u32 m0, s32, 106496
v_exp_f32 v32, v32
v_mfma_f32_16x16x32_bf16 v[204:207], a[204:207], v[72:75], 0
s_add_u32 s30, s28, 49152
v_exp_f32 v33, v33
v_exp_f32 v34, v34
v_exp_f32 v35, v35
v_mfma_f32_16x16x32_bf16 a[236:239], a[244:247], v[72:75], 0
s_waitcnt lgkmcnt(3)
v_cvt_pk_bf16_f32 v78, v32, v33
v_cvt_pk_bf16_f32 v79, v34, v35
v_mfma_f32_16x16x32_bf16 v[32:35], a[160:163], a[0:3], 0
s_waitcnt lgkmcnt(2)
ds_read_b64_tr_b16 a[208:209], v10 offset:0
ds_read_b64_tr_b16 a[210:211], v10 offset:4096
v_mfma_f32_16x16x32_bf16 v[32:35], a[164:167], a[4:7], v[32:35]
s_waitcnt lgkmcnt(3)
buffer_load_dwordx4 v16, s[24:27], s31 offen nt lds
ds_read_b64_tr_b16 a[212:213], v11 offset:0
ds_read_b64_tr_b16 a[214:215], v11 offset:4096
v_xor_b32 v12, s77, v12
v_mfma_f32_16x16x32_bf16 v[32:35], a[168:171], a[8:11], v[32:35]
s_waitcnt lgkmcnt(4)
ds_read_b64_tr_b16 a[216:217], v12 offset:0
ds_read_b64_tr_b16 a[218:219], v12 offset:4096
v_xor_b32 v13, s77, v13
v_mfma_f32_16x16x32_bf16 v[32:35], a[172:175], a[12:15], v[32:35]
ds_read_b64_tr_b16 a[220:221], v13 offset:0
ds_read_b64_tr_b16 a[222:223], v13 offset:4096
v_mfma_f32_16x16x32_bf16 v[224:227], a[192:195], v[76:79], 0
buffer_load_dwordx4 v17, s[24:27], s31 offen offset:1024 nt lds
v_fmamk_f32 v36, v36, 0x3e0293ee, v26
v_mfma_f32_16x16x32_bf16 v[228:231], a[196:199], v[76:79], 0
s_add_u32 m0, s32, 49152
v_exp_f32 v36, v36
v_mfma_f32_16x16x32_bf16 v[232:235], a[200:203], v[76:79], 0
s_add_u32 s31, s28, 49152
buffer_load_dwordx4 v14, s[20:23], s30 offen nt lds
v_fmamk_f32 v37, v37, 0x3e0293ee, v26
v_mfma_f32_16x16x32_bf16 v[236:239], a[204:207], v[76:79], 0
s_waitcnt lgkmcnt(6)
v_exp_f32 v37, v37
v_mfma_f32_16x16x32_bf16 v[208:211], a[208:211], v[72:75], 0
s_waitcnt lgkmcnt(2)
buffer_load_dwordx4 v15, s[20:23], s30 offen offset:1024 nt lds
v_fmamk_f32 v38, v38, 0x3e0293ee, v26
v_mfma_f32_16x16x32_bf16 v[212:215], a[212:215], v[72:75], 0
s_add_u32 m0, s32, 114688
v_exp_f32 v38, v38
v_mfma_f32_16x16x32_bf16 v[216:219], a[216:219], v[72:75], 0
s_waitcnt lgkmcnt(0)
s_add_u32 s30, s28, 57344
buffer_load_dwordx4 v16, s[24:27], s31 offen nt lds
v_fmamk_f32 v39, v39, 0x3e0293ee, v26
v_mfma_f32_16x16x32_bf16 v[220:223], a[220:223], v[72:75], 0
v_exp_f32 v39, v39
v_mfma_f32_16x16x32_bf16 a[240:243], a[244:247], v[76:79], 0
L_pad1_1:
s_cbranch_execz L_pad1_5
v_cvt_pk_bf16_f32 v48, v36, v37
v_cvt_pk_bf16_f32 v49, v38, v39
v_mfma_f32_16x16x32_bf16 v[36:39], a[160:163], a[16:19], 0
buffer_load_dwordx4 v17, s[24:27], s31 offen offset:1024 nt lds
v_xor_b32 v80, 0x2000, v6
v_mfma_f32_16x16x32_bf16 v[36:39], a[164:167], a[20:23], v[36:39]
s_add_u32 m0, s32, 57344
ds_read_b64_tr_b16 a[192:193], v80 offset:0
v_xor_b32 v81, 0x2000, v7
v_mfma_f32_16x16x32_bf16 v[36:39], a[168:171], a[24:27], v[36:39]
s_add_u32 s31, s28, 57344
ds_read_b64_tr_b16 a[194:195], v80 offset:4096
v_xor_b32 v82, 0x2000, v8
v_mfma_f32_16x16x32_bf16 v[36:39], a[172:175], a[28:31], v[36:39]
ds_read_b64_tr_b16 a[196:197], v81 offset:0
v_xor_b32 v83, 0x2000, v9
v_mfma_f32_16x16x32_bf16 v[240:243], a[208:211], v[76:79], 0
ds_read_b64_tr_b16 a[198:199], v81 offset:4096
v_fmamk_f32 v40, v40, 0x3e0293ee, v26
v_mfma_f32_16x16x32_bf16 v[244:247], a[212:215], v[76:79], 0
v_exp_f32 v40, v40
v_mfma_f32_16x16x32_bf16 v[248:251], a[216:219], v[76:79], 0
ds_read_b64_tr_b16 a[200:201], v82 offset:0
ds_read_b64_tr_b16 a[202:203], v82 offset:4096
v_fmamk_f32 v41, v41, 0x3e0293ee, v26
v_fmamk_f32 v42, v42, 0x3e0293ee, v26
v_fmamk_f32 v43, v43, 0x3e0293ee, v26
v_exp_f32 v41, v41
v_exp_f32 v42, v42
v_exp_f32 v43, v43
v_mfma_f32_16x16x32_bf16 v[252:255], a[220:223], v[76:79], 0
ds_read_b64_tr_b16 a[204:205], v83 offset:0
ds_read_b64_tr_b16 a[206:207], v83 offset:4096
v_cvt_pk_bf16_f32 v50, v40, v41
v_cvt_pk_bf16_f32 v51, v42, v43
v_mfma_f32_16x16x32_bf16 v[40:43], a[160:163], a[32:35], 0
ds_read_b128 a[176:179], v2 offset:20480
v_xor_b32 v84, 0x2000, v10
v_mfma_f32_16x16x32_bf16 v[40:43], a[164:167], a[36:39], v[40:43]
ds_read_b64_tr_b16 a[208:209], v84 offset:0
v_xor_b32 v85, 0x2000, v11
v_mfma_f32_16x16x32_bf16 v[40:43], a[168:171], a[40:43], v[40:43]
ds_read_b64_tr_b16 a[210:211], v84 offset:4096
v_xor_b32 v86, 0x2000, v12
v_mfma_f32_16x16x32_bf16 v[40:43], a[172:175], a[44:47], v[40:43]
s_waitcnt lgkmcnt(8)
ds_read_b64_tr_b16 a[212:213], v85 offset:0
v_xor_b32 v87, 0x2000, v13
v_mfma_f32_16x16x32_bf16 v[192:195], a[192:195], v[48:51], v[192:195]
s_waitcnt lgkmcnt(8)
ds_read_b64_tr_b16 a[214:215], v85 offset:4096
v_fmamk_f32 v32, v32, 0x3e0293ee, v23
v_mfma_f32_16x16x32_bf16 v[196:199], a[196:199], v[48:51], v[196:199]
s_waitcnt lgkmcnt(7)
v_exp_f32 v32, v32
v_mfma_f32_16x16x32_bf16 v[200:203], a[200:203], v[48:51], v[200:203]
s_waitcnt lgkmcnt(5)
ds_read_b64_tr_b16 a[216:217], v86 offset:0
v_fmamk_f32 v33, v33, 0x3e0293ee, v23
v_mfma_f32_16x16x32_bf16 v[204:207], a[204:207], v[48:51], v[204:207]
ds_read_b64_tr_b16 a[218:219], v86 offset:4096
v_exp_f32 v33, v33
v_fmamk_f32 v34, v34, 0x3e0293ee, v23
v_fmamk_f32 v35, v35, 0x3e0293ee, v23
v_exp_f32 v34, v34
v_exp_f32 v35, v35
v_mfma_f32_16x16x32_bf16 a[236:239], a[244:247], v[48:51], a[236:239]
ds_read_b64_tr_b16 a[220:221], v87 offset:0
ds_read_b64_tr_b16 a[222:223], v87 offset:4096
v_cvt_pk_bf16_f32 v52, v32, v33
v_cvt_pk_bf16_f32 v53, v34, v35
v_mfma_f32_16x16x32_bf16 v[32:35], a[160:163], a[48:51], 0
ds_read_b128 a[180:183], v3 offset:20480
v_fmamk_f32 v36, v36, 0x3e0293ee, v24
v_mfma_f32_16x16x32_bf16 v[32:35], a[164:167], a[52:55], v[32:35]
v_exp_f32 v36, v36
v_mfma_f32_16x16x32_bf16 v[32:35], a[168:171], a[56:59], v[32:35]
ds_read_b128 a[184:187], v4 offset:20480
v_fmamk_f32 v37, v37, 0x3e0293ee, v24
v_mfma_f32_16x16x32_bf16 v[32:35], a[172:175], a[60:63], v[32:35]
s_waitcnt lgkmcnt(6)
v_exp_f32 v37, v37
v_mfma_f32_16x16x32_bf16 v[208:211], a[208:211], v[48:51], v[208:211]
ds_read_b128 a[188:191], v5 offset:20480
v_fmamk_f32 v38, v38, 0x3e0293ee, v24
v_mfma_f32_16x16x32_bf16 v[212:215], a[212:215], v[48:51], v[212:215]
s_waitcnt lgkmcnt(5)
v_exp_f32 v38, v38
v_mfma_f32_16x16x32_bf16 v[216:219], a[216:219], v[48:51], v[216:219]
s_waitcnt lgkmcnt(3)
v_fmamk_f32 v39, v39, 0x3e0293ee, v24
v_exp_f32 v39, v39
v_mfma_f32_16x16x32_bf16 v[220:223], a[220:223], v[48:51], v[220:223]
v_cvt_pk_bf16_f32 v56, v36, v37
v_cvt_pk_bf16_f32 v57, v38, v39
v_mfma_f32_16x16x32_bf16 v[36:39], a[160:163], a[64:67], 0
ds_read_b64_tr_b16 a[192:193], v6 offset:16384
v_fmamk_f32 v40, v40, 0x3e0293ee, v25
v_mfma_f32_16x16x32_bf16 v[36:39], a[164:167], a[68:71], v[36:39]
v_exp_f32 v40, v40
v_mfma_f32_16x16x32_bf16 v[36:39], a[168:171], a[72:75], v[36:39]
v_fmamk_f32 v41, v41, 0x3e0293ee, v25
v_fmamk_f32 v42, v42, 0x3e0293ee, v25
v_fmamk_f32 v43, v43, 0x3e0293ee, v25
v_exp_f32 v41, v41
v_exp_f32 v42, v42
v_exp_f32 v43, v43
v_mfma_f32_16x16x32_bf16 v[36:39], a[172:175], a[76:79], v[36:39]
v_cvt_pk_bf16_f32 v60, v40, v41
v_cvt_pk_bf16_f32 v61, v42, v43
v_mfma_f32_16x16x32_bf16 v[40:43], a[176:179], a[0:3], 0
s_barrier
ds_read_b64_tr_b16 a[194:195], v6 offset:20480
v_fmamk_f32 v32, v32, 0x3e0293ee, v26
s_waitcnt lgkmcnt(2)
v_mfma_f32_16x16x32_bf16 v[40:43], a[180:183], a[4:7], v[40:43]
v_exp_f32 v32, v32
v_mfma_f32_16x16x32_bf16 v[40:43], a[184:187], a[8:11], v[40:43]
v_fmamk_f32 v33, v33, 0x3e0293ee, v26
v_fmamk_f32 v34, v34, 0x3e0293ee, v26
v_fmamk_f32 v35, v35, 0x3e0293ee, v26
v_exp_f32 v33, v33
v_exp_f32 v34, v34
v_exp_f32 v35, v35
v_mfma_f32_16x16x32_bf16 v[40:43], a[188:191], a[12:15], v[40:43]
v_cvt_pk_bf16_f32 v64, v32, v33
v_cvt_pk_bf16_f32 v65, v34, v35
v_mfma_f32_16x16x32_bf16 v[32:35], a[176:179], a[16:19], 0
ds_read_b64_tr_b16 a[196:197], v7 offset:16384
v_fmamk_f32 v36, v36, 0x3e0293ee, v27
v_mfma_f32_16x16x32_bf16 v[32:35], a[180:183], a[20:23], v[32:35]
v_exp_f32 v36, v36
v_mfma_f32_16x16x32_bf16 v[32:35], a[184:187], a[24:27], v[32:35]
v_fmamk_f32 v37, v37, 0x3e0293ee, v27
v_fmamk_f32 v38, v38, 0x3e0293ee, v27
v_fmamk_f32 v39, v39, 0x3e0293ee, v27
v_exp_f32 v37, v37
v_exp_f32 v38, v38
v_exp_f32 v39, v39
v_mfma_f32_16x16x32_bf16 v[32:35], a[188:191], a[28:31], v[32:35]
v_cvt_pk_bf16_f32 v68, v36, v37
v_cvt_pk_bf16_f32 v69, v38, v39
v_mfma_f32_16x16x32_bf16 v[36:39], a[176:179], a[32:35], 0
ds_read_b64_tr_b16 a[198:199], v7 offset:20480
v_fmamk_f32 v40, v40, 0x3e0293ee, v23
v_mfma_f32_16x16x32_bf16 v[36:39], a[180:183], a[36:39], v[36:39]
v_exp_f32 v40, v40
v_mfma_f32_16x16x32_bf16 v[36:39], a[184:187], a[40:43], v[36:39]
ds_read_b64_tr_b16 a[200:201], v8 offset:16384
ds_read_b64_tr_b16 a[202:203], v8 offset:20480
v_fmamk_f32 v41, v41, 0x3e0293ee, v23
v_fmamk_f32 v42, v42, 0x3e0293ee, v23
v_fmamk_f32 v43, v43, 0x3e0293ee, v23
v_exp_f32 v41, v41
v_exp_f32 v42, v42
v_exp_f32 v43, v43
v_mfma_f32_16x16x32_bf16 v[36:39], a[188:191], a[44:47], v[36:39]
ds_read_b64_tr_b16 a[204:205], v9 offset:16384
ds_read_b64_tr_b16 a[206:207], v9 offset:20480
v_cvt_pk_bf16_f32 v54, v40, v41
v_cvt_pk_bf16_f32 v55, v42, v43
v_mfma_f32_16x16x32_bf16 v[40:43], a[176:179], a[48:51], 0
buffer_load_dwordx4 v14, s[20:23], s30 offen nt lds
v_fmamk_f32 v32, v32, 0x3e0293ee, v24
v_mfma_f32_16x16x32_bf16 v[40:43], a[180:183], a[52:55], v[40:43]
v_exp_f32 v32, v32
v_mfma_f32_16x16x32_bf16 v[40:43], a[184:187], a[56:59], v[40:43]
ds_read_b128 a[160:163], v44 offset:16384
v_fmamk_f32 v33, v33, 0x3e0293ee, v24
v_mfma_f32_16x16x32_bf16 v[40:43], a[188:191], a[60:63], v[40:43]
s_waitcnt lgkmcnt(6)
v_exp_f32 v33, v33
v_mfma_f32_16x16x32_bf16 v[96:99], a[192:195], v[52:55], v[96:99]
s_waitcnt lgkmcnt(5)
ds_read_b128 a[164:167], v45 offset:16384
v_fmamk_f32 v34, v34, 0x3e0293ee, v24
v_mfma_f32_16x16x32_bf16 v[100:103], a[196:199], v[52:55], v[100:103]
s_waitcnt lgkmcnt(4)
v_exp_f32 v34, v34
v_mfma_f32_16x16x32_bf16 v[104:107], a[200:203], v[52:55], v[104:107]
s_waitcnt lgkmcnt(2)
ds_read_b128 a[168:171], v46 offset:16384
v_fmamk_f32 v35, v35, 0x3e0293ee, v24
v_mfma_f32_16x16x32_bf16 v[108:111], a[204:207], v[52:55], v[108:111]
v_exp_f32 v35, v35
v_mfma_f32_16x16x32_bf16 a[224:227], a[244:247], v[52:55], a[224:227]
v_cvt_pk_bf16_f32 v58, v32, v33
v_cvt_pk_bf16_f32 v59, v34, v35
v_mfma_f32_16x16x32_bf16 v[32:35], a[176:179], a[64:67], 0
ds_read_b128 a[172:175], v47 offset:16384
v_fmamk_f32 v36, v36, 0x3e0293ee, v25
v_mfma_f32_16x16x32_bf16 v[32:35], a[180:183], a[68:71], v[32:35]
v_exp_f32 v36, v36
v_mfma_f32_16x16x32_bf16 v[32:35], a[184:187], a[72:75], v[32:35]
v_fmamk_f32 v37, v37, 0x3e0293ee, v25
v_fmamk_f32 v38, v38, 0x3e0293ee, v25
v_mfma_f32_16x16x32_bf16 v[32:35], a[188:191], a[76:79], v[32:35]
v_exp_f32 v37, v37
v_mfma_f32_16x16x32_bf16 v[128:131], a[192:195], v[56:59], v[128:131]
v_exp_f32 v38, v38
v_mfma_f32_16x16x32_bf16 v[132:135], a[196:199], v[56:59], v[132:135]
s_waitcnt lgkmcnt(1)
buffer_load_dwordx4 v15, s[20:23], s30 offen offset:1024 nt lds
v_fmamk_f32 v39, v39, 0x3e0293ee, v25
v_mfma_f32_16x16x32_bf16 v[136:139], a[200:203], v[56:59], v[136:139]
s_add_u32 m0, s32, 122880
v_exp_f32 v39, v39
v_mfma_f32_16x16x32_bf16 v[140:143], a[204:207], v[56:59], v[140:143]
s_add_u32 s30, s28, 65536
v_cvt_pk_bf16_f32 v62, v36, v37
v_cvt_pk_bf16_f32 v63, v38, v39
v_mfma_f32_16x16x32_bf16 v[36:39], a[160:163], a[0:3], 0
ds_read_b64_tr_b16 a[208:209], v10 offset:16384
v_fmamk_f32 v40, v40, 0x3e0293ee, v26
v_mfma_f32_16x16x32_bf16 v[36:39], a[164:167], a[4:7], v[36:39]
v_exp_f32 v40, v40
v_mfma_f32_16x16x32_bf16 v[36:39], a[168:171], a[8:11], v[36:39]
s_waitcnt lgkmcnt(1)
ds_read_b64_tr_b16 a[210:211], v10 offset:20480
v_fmamk_f32 v41, v41, 0x3e0293ee, v26
v_mfma_f32_16x16x32_bf16 v[36:39], a[172:175], a[12:15], v[36:39]
v_exp_f32 v41, v41
v_mfma_f32_16x16x32_bf16 v[160:163], a[192:195], v[60:63], v[160:163]
ds_read_b64_tr_b16 a[212:213], v11 offset:16384
v_fmamk_f32 v42, v42, 0x3e0293ee, v26
v_mfma_f32_16x16x32_bf16 v[164:167], a[196:199], v[60:63], v[164:167]
v_exp_f32 v42, v42
v_mfma_f32_16x16x32_bf16 v[168:171], a[200:203], v[60:63], v[168:171]
ds_read_b64_tr_b16 a[214:215], v11 offset:20480
v_fmamk_f32 v43, v43, 0x3e0293ee, v26
v_mfma_f32_16x16x32_bf16 v[172:175], a[204:207], v[60:63], v[172:175]
v_exp_f32 v43, v43
v_mfma_f32_16x16x32_bf16 a[228:231], a[244:247], v[56:59], a[228:231]
v_cvt_pk_bf16_f32 v66, v40, v41
v_cvt_pk_bf16_f32 v67, v42, v43
v_mfma_f32_16x16x32_bf16 v[40:43], a[160:163], a[16:19], 0
ds_read_b64_tr_b16 a[216:217], v12 offset:16384
v_fmamk_f32 v32, v32, 0x3e0293ee, v27
v_mfma_f32_16x16x32_bf16 v[40:43], a[164:167], a[20:23], v[40:43]
v_exp_f32 v32, v32
v_mfma_f32_16x16x32_bf16 v[40:43], a[168:171], a[24:27], v[40:43]
ds_read_b64_tr_b16 a[218:219], v12 offset:20480
v_fmamk_f32 v33, v33, 0x3e0293ee, v27
v_mfma_f32_16x16x32_bf16 v[40:43], a[172:175], a[28:31], v[40:43]
v_exp_f32 v33, v33
v_mfma_f32_16x16x32_bf16 v[192:195], a[192:195], v[64:67], v[192:195]
ds_read_b64_tr_b16 a[220:221], v13 offset:16384
v_fmamk_f32 v34, v34, 0x3e0293ee, v27
v_mfma_f32_16x16x32_bf16 v[196:199], a[196:199], v[64:67], v[196:199]
v_exp_f32 v34, v34
v_mfma_f32_16x16x32_bf16 v[200:203], a[200:203], v[64:67], v[200:203]
v_fmamk_f32 v35, v35, 0x3e0293ee, v27
v_exp_f32 v35, v35
v_mfma_f32_16x16x32_bf16 v[204:207], a[204:207], v[64:67], v[204:207]
v_cvt_pk_bf16_f32 v70, v32, v33
v_cvt_pk_bf16_f32 v71, v34, v35
v_mfma_f32_16x16x32_bf16 v[32:35], a[160:163], a[32:35], 0
ds_read_b64_tr_b16 a[222:223], v13 offset:20480
v_fmamk_f32 v36, v36, 0x3e0293ee, v23
v_mfma_f32_16x16x32_bf16 v[32:35], a[164:167], a[36:39], v[32:35]
v_exp_f32 v36, v36
v_mfma_f32_16x16x32_bf16 v[32:35], a[168:171], a[40:43], v[32:35]
buffer_load_dwordx4 v16, s[24:27], s31 offen nt lds
v_fmamk_f32 v37, v37, 0x3e0293ee, v23
v_mfma_f32_16x16x32_bf16 v[32:35], a[172:175], a[44:47], v[32:35]
v_exp_f32 v37, v37
v_mfma_f32_16x16x32_bf16 v[224:227], a[192:195], v[68:71], v[224:227]
ds_read_b128 a[176:179], v44 offset:20480
v_fmamk_f32 v38, v38, 0x3e0293ee, v23
v_mfma_f32_16x16x32_bf16 v[228:231], a[196:199], v[68:71], v[228:231]
v_exp_f32 v38, v38
v_mfma_f32_16x16x32_bf16 v[232:235], a[200:203], v[68:71], v[232:235]
ds_read_b128 a[180:183], v45 offset:20480
v_fmamk_f32 v39, v39, 0x3e0293ee, v23
v_mfma_f32_16x16x32_bf16 v[236:239], a[204:207], v[68:71], v[236:239]
v_exp_f32 v39, v39
v_mfma_f32_16x16x32_bf16 a[232:235], a[244:247], v[60:63], a[232:235]
s_waitcnt lgkmcnt(2)
ds_read_b128 a[184:187], v46 offset:20480
v_cvt_pk_bf16_f32 v72, v36, v37
v_mfma_f32_16x16x32_bf16 v[112:115], a[208:211], v[52:55], v[112:115]
ds_read_b128 a[188:191], v47 offset:20480
v_cvt_pk_bf16_f32 v73, v38, v39
v_mfma_f32_16x16x32_bf16 v[116:119], a[212:215], v[52:55], v[116:119]
v_add_u32 v28, s38, v18
v_fmamk_f32 v40, v40, 0x3e0293ee, v24
v_mfma_f32_16x16x32_bf16 v[120:123], a[216:219], v[52:55], v[120:123]
s_add_u32 s38, s58, 4096
v_exp_f32 v40, v40
v_mfma_f32_16x16x32_bf16 v[124:127], a[220:223], v[52:55], v[124:127]
v_fmamk_f32 v41, v41, 0x3e0293ee, v24
v_fmamk_f32 v42, v42, 0x3e0293ee, v24
v_mfma_f32_16x16x32_bf16 v[36:39], a[160:163], a[48:51], 0
v_exp_f32 v41, v41
v_mfma_f32_16x16x32_bf16 v[36:39], a[164:167], a[52:55], v[36:39]
v_exp_f32 v42, v42
v_mfma_f32_16x16x32_bf16 v[36:39], a[168:171], a[56:59], v[36:39]
v_fmamk_f32 v43, v43, 0x3e0293ee, v24
v_cvt_pk_bf16_f32 v76, v40, v41
v_mfma_f32_16x16x32_bf16 v[36:39], a[172:175], a[60:63], v[36:39]
v_exp_f32 v43, v43
v_mfma_f32_16x16x32_bf16 v[144:147], a[208:211], v[56:59], v[144:147]
v_cvt_pk_bf16_f32 v77, v42, v43
v_fmamk_f32 v32, v32, 0x3e0293ee, v25
v_mfma_f32_16x16x32_bf16 v[148:151], a[212:215], v[56:59], v[148:151]
v_exp_f32 v32, v32
v_mfma_f32_16x16x32_bf16 v[152:155], a[216:219], v[56:59], v[152:155]
v_fmamk_f32 v33, v33, 0x3e0293ee, v25
v_fmamk_f32 v34, v34, 0x3e0293ee, v25
v_mfma_f32_16x16x32_bf16 v[156:159], a[220:223], v[56:59], v[156:159]
v_exp_f32 v33, v33
v_mfma_f32_16x16x32_bf16 a[236:239], a[244:247], v[64:67], a[236:239]
s_waitcnt vmcnt(7) lgkmcnt(0)
buffer_load_dwordx4 v17, s[24:27], s31 offen offset:1024 nt lds
buffer_load_dwordx4 a[80:83], v28, s[8:11], 0 offen offset:0
v_mfma_f32_16x16x32_bf16 v[40:43], a[176:179], a[0:3], 0
s_barrier
v_exp_f32 v34, v34
v_mfma_f32_16x16x32_bf16 v[40:43], a[180:183], a[4:7], v[40:43]
s_add_u32 m0, s32, 0
v_fmamk_f32 v35, v35, 0x3e0293ee, v25
v_cvt_pk_bf16_f32 v48, v32, v33
v_mfma_f32_16x16x32_bf16 v[40:43], a[184:187], a[8:11], v[40:43]
s_add_u32 s31, s28, 65536
v_exp_f32 v35, v35
v_mfma_f32_16x16x32_bf16 v[40:43], a[188:191], a[12:15], v[40:43]
ds_read_b64_tr_b16 a[192:193], v80 offset:16384
v_cvt_pk_bf16_f32 v49, v34, v35
v_mfma_f32_16x16x32_bf16 v[176:179], a[208:211], v[60:63], v[176:179]
buffer_load_dwordx4 a[84:87], v28, s[8:11], 0 offen offset:64
v_fmamk_f32 v36, v36, 0x3e0293ee, v26
v_mfma_f32_16x16x32_bf16 v[180:183], a[212:215], v[60:63], v[180:183]
v_exp_f32 v36, v36
v_mfma_f32_16x16x32_bf16 v[184:187], a[216:219], v[60:63], v[184:187]
buffer_load_dwordx4 v14, s[20:23], s30 offen nt lds
v_fmamk_f32 v37, v37, 0x3e0293ee, v26
v_mfma_f32_16x16x32_bf16 v[188:191], a[220:223], v[60:63], v[188:191]
v_exp_f32 v37, v37
v_mfma_f32_16x16x32_bf16 v[32:35], a[176:179], a[16:19], 0
ds_read_b64_tr_b16 a[194:195], v80 offset:20480
v_fmamk_f32 v38, v38, 0x3e0293ee, v26
v_mfma_f32_16x16x32_bf16 v[32:35], a[180:183], a[20:23], v[32:35]
v_exp_f32 v38, v38
v_mfma_f32_16x16x32_bf16 v[32:35], a[184:187], a[24:27], v[32:35]
ds_read_b64_tr_b16 a[196:197], v81 offset:16384
v_fmamk_f32 v39, v39, 0x3e0293ee, v26
v_mfma_f32_16x16x32_bf16 v[32:35], a[188:191], a[28:31], v[32:35]
v_exp_f32 v39, v39
v_mfma_f32_16x16x32_bf16 v[208:211], a[208:211], v[64:67], v[208:211]
ds_read_b64_tr_b16 a[198:199], v81 offset:20480
v_cvt_pk_bf16_f32 v52, v36, v37
v_mfma_f32_16x16x32_bf16 v[212:215], a[212:215], v[64:67], v[212:215]
ds_read_b64_tr_b16 a[200:201], v82 offset:16384
v_cvt_pk_bf16_f32 v53, v38, v39
v_mfma_f32_16x16x32_bf16 v[216:219], a[216:219], v[64:67], v[216:219]
ds_read_b64_tr_b16 a[202:203], v82 offset:20480
v_fmamk_f32 v40, v40, 0x3e0293ee, v23
v_mfma_f32_16x16x32_bf16 v[220:223], a[220:223], v[64:67], v[220:223]
v_exp_f32 v40, v40
v_mfma_f32_16x16x32_bf16 a[240:243], a[244:247], v[68:71], a[240:243]
ds_read_b64_tr_b16 a[204:205], v83 offset:16384
v_fmamk_f32 v41, v41, 0x3e0293ee, v23
v_mfma_f32_16x16x32_bf16 v[36:39], a[176:179], a[32:35], 0
v_exp_f32 v41, v41
v_mfma_f32_16x16x32_bf16 v[36:39], a[180:183], a[36:39], v[36:39]
ds_read_b64_tr_b16 a[206:207], v83 offset:20480
v_fmamk_f32 v42, v42, 0x3e0293ee, v23
v_mfma_f32_16x16x32_bf16 v[36:39], a[184:187], a[40:43], v[36:39]
v_exp_f32 v42, v42
v_mfma_f32_16x16x32_bf16 v[36:39], a[188:191], a[44:47], v[36:39]
ds_read_b128 a[160:163], v2 offset:32768
v_fmamk_f32 v43, v43, 0x3e0293ee, v23
v_mfma_f32_16x16x32_bf16 v[240:243], a[208:211], v[68:71], v[240:243]
v_exp_f32 v43, v43
v_mfma_f32_16x16x32_bf16 v[244:247], a[212:215], v[68:71], v[244:247]
ds_read_b128 a[164:167], v3 offset:32768
v_cvt_pk_bf16_f32 v74, v40, v41
v_mfma_f32_16x16x32_bf16 v[248:251], a[216:219], v[68:71], v[248:251]
ds_read_b128 a[168:171], v4 offset:32768
v_cvt_pk_bf16_f32 v75, v42, v43
v_mfma_f32_16x16x32_bf16 v[252:255], a[220:223], v[68:71], v[252:255]
ds_read_b128 a[172:175], v5 offset:32768
v_fmamk_f32 v32, v32, 0x3e0293ee, v24
v_mfma_f32_16x16x32_bf16 v[40:43], a[176:179], a[48:51], 0
v_exp_f32 v32, v32
v_mfma_f32_16x16x32_bf16 v[40:43], a[180:183], a[52:55], v[40:43]
s_waitcnt lgkmcnt(3)
buffer_load_dwordx4 v15, s[20:23], s30 offen offset:1024 nt lds
v_fmamk_f32 v33, v33, 0x3e0293ee, v24
v_mfma_f32_16x16x32_bf16 v[40:43], a[184:187], a[56:59], v[40:43]
s_add_u32 m0, s32, 65536
v_exp_f32 v33, v33
v_mfma_f32_16x16x32_bf16 v[40:43], a[188:191], a[60:63], v[40:43]
s_add_u32 s30, s28, 73728
v_fmamk_f32 v34, v34, 0x3e0293ee, v24
v_fmamk_f32 v35, v35, 0x3e0293ee, v24
v_mfma_f32_16x16x32_bf16 v[96:99], a[192:195], v[72:75], v[96:99]
v_exp_f32 v34, v34
v_mfma_f32_16x16x32_bf16 v[100:103], a[196:199], v[72:75], v[100:103]
v_exp_f32 v35, v35
v_mfma_f32_16x16x32_bf16 v[104:107], a[200:203], v[72:75], v[104:107]
v_cvt_pk_bf16_f32 v78, v32, v33
v_cvt_pk_bf16_f32 v79, v34, v35
v_mfma_f32_16x16x32_bf16 v[108:111], a[204:207], v[72:75], v[108:111]
v_fmamk_f32 v36, v36, 0x3e0293ee, v25
v_fmamk_f32 v37, v37, 0x3e0293ee, v25
v_mfma_f32_16x16x32_bf16 a[224:227], a[244:247], v[72:75], a[224:227]
v_exp_f32 v36, v36
v_mfma_f32_16x16x32_bf16 v[32:35], a[160:163], a[0:3], 0
s_waitcnt lgkmcnt(0)
v_exp_f32 v37, v37
v_mfma_f32_16x16x32_bf16 v[32:35], a[164:167], a[4:7], v[32:35]
v_fmamk_f32 v38, v38, 0x3e0293ee, v25
v_fmamk_f32 v39, v39, 0x3e0293ee, v25
v_mfma_f32_16x16x32_bf16 v[32:35], a[168:171], a[8:11], v[32:35]
v_exp_f32 v38, v38
v_mfma_f32_16x16x32_bf16 v[32:35], a[172:175], a[12:15], v[32:35]
v_exp_f32 v39, v39
v_mfma_f32_16x16x32_bf16 v[128:131], a[192:195], v[76:79], v[128:131]
buffer_load_dwordx4 v16, s[24:27], s31 offen nt lds
v_cvt_pk_bf16_f32 v50, v36, v37
v_mfma_f32_16x16x32_bf16 v[132:135], a[196:199], v[76:79], v[132:135]
ds_read_b64_tr_b16 a[208:209], v84 offset:16384
v_cvt_pk_bf16_f32 v51, v38, v39
v_mfma_f32_16x16x32_bf16 v[136:139], a[200:203], v[76:79], v[136:139]
ds_read_b64_tr_b16 a[210:211], v84 offset:20480
v_fmamk_f32 v40, v40, 0x3e0293ee, v26
v_mfma_f32_16x16x32_bf16 v[140:143], a[204:207], v[76:79], v[140:143]
v_exp_f32 v40, v40
v_mfma_f32_16x16x32_bf16 v[36:39], a[160:163], a[16:19], 0
ds_read_b64_tr_b16 a[212:213], v85 offset:16384
v_fmamk_f32 v41, v41, 0x3e0293ee, v26
v_mfma_f32_16x16x32_bf16 v[36:39], a[164:167], a[20:23], v[36:39]
v_exp_f32 v41, v41
v_mfma_f32_16x16x32_bf16 v[36:39], a[168:171], a[24:27], v[36:39]
ds_read_b64_tr_b16 a[214:215], v85 offset:20480
v_fmamk_f32 v42, v42, 0x3e0293ee, v26
v_mfma_f32_16x16x32_bf16 v[36:39], a[172:175], a[28:31], v[36:39]
v_exp_f32 v42, v42
v_mfma_f32_16x16x32_bf16 v[160:163], a[192:195], v[48:51], v[160:163]
ds_read_b64_tr_b16 a[216:217], v86 offset:16384
v_fmamk_f32 v43, v43, 0x3e0293ee, v26
v_mfma_f32_16x16x32_bf16 v[164:167], a[196:199], v[48:51], v[164:167]
v_exp_f32 v43, v43
v_mfma_f32_16x16x32_bf16 v[168:171], a[200:203], v[48:51], v[168:171]
ds_read_b64_tr_b16 a[218:219], v86 offset:20480
v_cvt_pk_bf16_f32 v54, v40, v41
v_mfma_f32_16x16x32_bf16 v[172:175], a[204:207], v[48:51], v[172:175]
ds_read_b64_tr_b16 a[220:221], v87 offset:16384
v_cvt_pk_bf16_f32 v55, v42, v43
v_mfma_f32_16x16x32_bf16 a[228:231], a[244:247], v[76:79], a[228:231]
ds_read_b64_tr_b16 a[222:223], v87 offset:20480
v_fmamk_f32 v32, v32, 0x3e0293ee, v23
v_mfma_f32_16x16x32_bf16 v[40:43], a[160:163], a[32:35], 0
v_exp_f32 v32, v32
v_mfma_f32_16x16x32_bf16 v[40:43], a[164:167], a[36:39], v[40:43]
ds_read_b128 a[176:179], v2 offset:36864
v_fmamk_f32 v33, v33, 0x3e0293ee, v23
v_mfma_f32_16x16x32_bf16 v[40:43], a[168:171], a[40:43], v[40:43]
v_exp_f32 v33, v33
v_mfma_f32_16x16x32_bf16 v[40:43], a[172:175], a[44:47], v[40:43]
ds_read_b128 a[180:183], v3 offset:36864
v_fmamk_f32 v34, v34, 0x3e0293ee, v23
v_mfma_f32_16x16x32_bf16 v[192:195], a[192:195], v[52:55], v[192:195]
buffer_load_dwordx4 v17, s[24:27], s31 offen offset:1024 nt lds
v_fmamk_f32 v35, v35, 0x3e0293ee, v23
v_mfma_f32_16x16x32_bf16 v[196:199], a[196:199], v[52:55], v[196:199]
s_add_u32 m0, s32, 8192
buffer_load_dwordx4 a[88:91], v28, s[8:11], 0 offen offset:128
v_cvt_pk_bf16_f32 v56, v32, v33
v_mfma_f32_16x16x32_bf16 v[200:203], a[200:203], v[52:55], v[200:203]
s_add_u32 s31, s28, 73728
v_exp_f32 v34, v34
v_exp_f32 v35, v35
v_mfma_f32_16x16x32_bf16 v[204:207], a[204:207], v[52:55], v[204:207]
v_cvt_pk_bf16_f32 v57, v34, v35
v_fmamk_f32 v36, v36, 0x3e0293ee, v24
v_mfma_f32_16x16x32_bf16 v[32:35], a[160:163], a[48:51], 0
v_exp_f32 v36, v36
v_mfma_f32_16x16x32_bf16 v[32:35], a[164:167], a[52:55], v[32:35]
ds_read_b128 a[184:187], v4 offset:36864
v_fmamk_f32 v37, v37, 0x3e0293ee, v24
v_mfma_f32_16x16x32_bf16 v[32:35], a[168:171], a[56:59], v[32:35]
v_exp_f32 v37, v37
v_mfma_f32_16x16x32_bf16 v[32:35], a[172:175], a[60:63], v[32:35]
s_waitcnt lgkmcnt(1)
ds_read_b128 a[188:191], v5 offset:36864
v_fmamk_f32 v38, v38, 0x3e0293ee, v24
v_mfma_f32_16x16x32_bf16 v[112:115], a[208:211], v[72:75], v[112:115]
v_exp_f32 v38, v38
v_mfma_f32_16x16x32_bf16 v[116:119], a[212:215], v[72:75], v[116:119]
v_fmamk_f32 v39, v39, 0x3e0293ee, v24
v_cvt_pk_bf16_f32 v60, v36, v37
v_mfma_f32_16x16x32_bf16 v[120:123], a[216:219], v[72:75], v[120:123]
v_exp_f32 v39, v39
v_mfma_f32_16x16x32_bf16 v[124:127], a[220:223], v[72:75], v[124:127]
v_cvt_pk_bf16_f32 v61, v38, v39
v_fmamk_f32 v40, v40, 0x3e0293ee, v25
v_mfma_f32_16x16x32_bf16 a[232:235], a[244:247], v[48:51], a[232:235]
v_exp_f32 v40, v40
v_mfma_f32_16x16x32_bf16 v[36:39], a[160:163], a[64:67], 0
v_fmamk_f32 v41, v41, 0x3e0293ee, v25
v_fmamk_f32 v42, v42, 0x3e0293ee, v25
v_mfma_f32_16x16x32_bf16 v[36:39], a[164:167], a[68:71], v[36:39]
v_exp_f32 v41, v41
v_mfma_f32_16x16x32_bf16 v[36:39], a[168:171], a[72:75], v[36:39]
v_exp_f32 v42, v42
v_mfma_f32_16x16x32_bf16 v[36:39], a[172:175], a[76:79], v[36:39]
v_fmamk_f32 v43, v43, 0x3e0293ee, v25
v_cvt_pk_bf16_f32 v64, v40, v41
v_mfma_f32_16x16x32_bf16 v[144:147], a[208:211], v[76:79], v[144:147]
v_exp_f32 v43, v43
v_mfma_f32_16x16x32_bf16 v[148:151], a[212:215], v[76:79], v[148:151]
ds_read_b64_tr_b16 a[192:193], v6 offset:32768
v_cvt_pk_bf16_f32 v65, v42, v43
v_mfma_f32_16x16x32_bf16 v[152:155], a[216:219], v[76:79], v[152:155]
ds_read_b64_tr_b16 a[194:195], v6 offset:36864
v_fmamk_f32 v32, v32, 0x3e0293ee, v26
v_mfma_f32_16x16x32_bf16 v[156:159], a[220:223], v[76:79], v[156:159]
v_exp_f32 v32, v32
v_mfma_f32_16x16x32_bf16 v[40:43], a[176:179], a[0:3], 0
ds_read_b64_tr_b16 a[196:197], v7 offset:32768
v_fmamk_f32 v33, v33, 0x3e0293ee, v26
v_mfma_f32_16x16x32_bf16 v[40:43], a[180:183], a[4:7], v[40:43]
s_waitcnt lgkmcnt(3)
v_exp_f32 v33, v33
v_mfma_f32_16x16x32_bf16 v[40:43], a[184:187], a[8:11], v[40:43]
ds_read_b64_tr_b16 a[198:199], v7 offset:36864
v_fmamk_f32 v34, v34, 0x3e0293ee, v26
v_mfma_f32_16x16x32_bf16 v[40:43], a[188:191], a[12:15], v[40:43]
v_exp_f32 v34, v34
v_mfma_f32_16x16x32_bf16 v[176:179], a[208:211], v[48:51], v[176:179]
buffer_load_dwordx4 v14, s[20:23], s30 offen nt lds
v_fmamk_f32 v35, v35, 0x3e0293ee, v26
v_mfma_f32_16x16x32_bf16 v[180:183], a[212:215], v[48:51], v[180:183]
v_exp_f32 v35, v35
v_mfma_f32_16x16x32_bf16 v[184:187], a[216:219], v[48:51], v[184:187]
ds_read_b64_tr_b16 a[200:201], v8 offset:32768
v_cvt_pk_bf16_f32 v68, v32, v33
v_mfma_f32_16x16x32_bf16 v[188:191], a[220:223], v[48:51], v[188:191]
ds_read_b64_tr_b16 a[202:203], v8 offset:36864
v_cvt_pk_bf16_f32 v69, v34, v35
v_mfma_f32_16x16x32_bf16 a[236:239], a[244:247], v[52:55], a[236:239]
ds_read_b64_tr_b16 a[204:205], v9 offset:32768
v_fmamk_f32 v36, v36, 0x3e0293ee, v27
v_mfma_f32_16x16x32_bf16 v[32:35], a[176:179], a[16:19], 0
v_exp_f32 v36, v36
v_mfma_f32_16x16x32_bf16 v[32:35], a[180:183], a[20:23], v[32:35]
ds_read_b64_tr_b16 a[206:207], v9 offset:36864
v_fmamk_f32 v37, v37, 0x3e0293ee, v27
v_mfma_f32_16x16x32_bf16 v[32:35], a[184:187], a[24:27], v[32:35]
v_exp_f32 v37, v37
v_mfma_f32_16x16x32_bf16 v[32:35], a[188:191], a[28:31], v[32:35]
v_fmamk_f32 v38, v38, 0x3e0293ee, v27
v_fmamk_f32 v39, v39, 0x3e0293ee, v27
v_mfma_f32_16x16x32_bf16 v[208:211], a[208:211], v[52:55], v[208:211]
v_exp_f32 v38, v38
v_mfma_f32_16x16x32_bf16 v[212:215], a[212:215], v[52:55], v[212:215]
v_exp_f32 v39, v39
v_mfma_f32_16x16x32_bf16 v[216:219], a[216:219], v[52:55], v[216:219]
v_cvt_pk_bf16_f32 v72, v36, v37
v_cvt_pk_bf16_f32 v73, v38, v39
v_mfma_f32_16x16x32_bf16 v[220:223], a[220:223], v[52:55], v[220:223]
ds_read_b128 a[160:163], v44 offset:32768
v_fmamk_f32 v40, v40, 0x3e0293ee, v23
v_mfma_f32_16x16x32_bf16 v[36:39], a[176:179], a[32:35], 0
v_exp_f32 v40, v40
v_mfma_f32_16x16x32_bf16 v[36:39], a[180:183], a[36:39], v[36:39]
ds_read_b128 a[164:167], v45 offset:32768
v_fmamk_f32 v41, v41, 0x3e0293ee, v23
v_mfma_f32_16x16x32_bf16 v[36:39], a[184:187], a[40:43], v[36:39]
L_pad1_2:
s_cbranch_execz L_pad1_6
v_exp_f32 v41, v41
v_fmamk_f32 v42, v42, 0x3e0293ee, v23
v_fmamk_f32 v43, v43, 0x3e0293ee, v23
v_exp_f32 v42, v42
v_exp_f32 v43, v43
v_mfma_f32_16x16x32_bf16 v[36:39], a[188:191], a[44:47], v[36:39]
v_cvt_pk_bf16_f32 v58, v40, v41
v_cvt_pk_bf16_f32 v59, v42, v43
v_mfma_f32_16x16x32_bf16 v[40:43], a[176:179], a[48:51], 0
ds_read_b128 a[168:171], v46 offset:32768
v_fmamk_f32 v32, v32, 0x3e0293ee, v24
v_mfma_f32_16x16x32_bf16 v[40:43], a[180:183], a[52:55], v[40:43]
v_exp_f32 v32, v32
v_mfma_f32_16x16x32_bf16 v[40:43], a[184:187], a[56:59], v[40:43]
ds_read_b128 a[172:175], v47 offset:32768
v_fmamk_f32 v33, v33, 0x3e0293ee, v24
v_mfma_f32_16x16x32_bf16 v[40:43], a[188:191], a[60:63], v[40:43]
s_waitcnt lgkmcnt(3)
v_exp_f32 v33, v33
v_mfma_f32_16x16x32_bf16 v[96:99], a[192:195], v[56:59], v[96:99]
buffer_load_dwordx4 v15, s[20:23], s30 offen offset:1024 nt lds
v_fmamk_f32 v34, v34, 0x3e0293ee, v24
v_mfma_f32_16x16x32_bf16 v[100:103], a[196:199], v[56:59], v[100:103]
s_add_u32 m0, s32, 73728
v_exp_f32 v34, v34
v_mfma_f32_16x16x32_bf16 v[104:107], a[200:203], v[56:59], v[104:107]
s_add_u32 s30, s28, 81920
v_fmamk_f32 v35, v35, 0x3e0293ee, v24
v_cvt_pk_bf16_f32 v62, v32, v33
v_mfma_f32_16x16x32_bf16 v[108:111], a[204:207], v[56:59], v[108:111]
v_exp_f32 v35, v35
v_mfma_f32_16x16x32_bf16 a[224:227], a[244:247], v[56:59], a[224:227]
v_cvt_pk_bf16_f32 v63, v34, v35
v_fmamk_f32 v36, v36, 0x3e0293ee, v25
v_mfma_f32_16x16x32_bf16 v[32:35], a[176:179], a[64:67], 0
v_exp_f32 v36, v36
v_mfma_f32_16x16x32_bf16 v[32:35], a[180:183], a[68:71], v[32:35]
v_fmamk_f32 v37, v37, 0x3e0293ee, v25
v_fmamk_f32 v38, v38, 0x3e0293ee, v25
v_mfma_f32_16x16x32_bf16 v[32:35], a[184:187], a[72:75], v[32:35]
v_exp_f32 v37, v37
v_mfma_f32_16x16x32_bf16 v[32:35], a[188:191], a[76:79], v[32:35]
v_exp_f32 v38, v38
v_mfma_f32_16x16x32_bf16 v[128:131], a[192:195], v[60:63], v[128:131]
v_fmamk_f32 v39, v39, 0x3e0293ee, v25
v_cvt_pk_bf16_f32 v66, v36, v37
v_mfma_f32_16x16x32_bf16 v[132:135], a[196:199], v[60:63], v[132:135]
v_exp_f32 v39, v39
v_mfma_f32_16x16x32_bf16 v[136:139], a[200:203], v[60:63], v[136:139]
ds_read_b64_tr_b16 a[208:209], v10 offset:32768
v_cvt_pk_bf16_f32 v67, v38, v39
v_mfma_f32_16x16x32_bf16 v[140:143], a[204:207], v[60:63], v[140:143]
ds_read_b64_tr_b16 a[210:211], v10 offset:36864
v_fmamk_f32 v40, v40, 0x3e0293ee, v26
v_mfma_f32_16x16x32_bf16 v[36:39], a[160:163], a[0:3], 0
s_waitcnt lgkmcnt(2)
v_exp_f32 v40, v40
v_mfma_f32_16x16x32_bf16 v[36:39], a[164:167], a[4:7], v[36:39]
ds_read_b64_tr_b16 a[212:213], v11 offset:32768
v_fmamk_f32 v41, v41, 0x3e0293ee, v26
v_mfma_f32_16x16x32_bf16 v[36:39], a[168:171], a[8:11], v[36:39]
v_exp_f32 v41, v41
v_mfma_f32_16x16x32_bf16 v[36:39], a[172:175], a[12:15], v[36:39]
ds_read_b64_tr_b16 a[214:215], v11 offset:36864
v_fmamk_f32 v42, v42, 0x3e0293ee, v26
v_mfma_f32_16x16x32_bf16 v[160:163], a[192:195], v[64:67], v[160:163]
v_exp_f32 v42, v42
v_mfma_f32_16x16x32_bf16 v[164:167], a[196:199], v[64:67], v[164:167]
ds_read_b64_tr_b16 a[216:217], v12 offset:32768
v_fmamk_f32 v43, v43, 0x3e0293ee, v26
v_mfma_f32_16x16x32_bf16 v[168:171], a[200:203], v[64:67], v[168:171]
v_exp_f32 v43, v43
v_mfma_f32_16x16x32_bf16 v[172:175], a[204:207], v[64:67], v[172:175]
ds_read_b64_tr_b16 a[218:219], v12 offset:36864
v_cvt_pk_bf16_f32 v70, v40, v41
v_mfma_f32_16x16x32_bf16 a[228:231], a[244:247], v[60:63], a[228:231]
v_cvt_pk_bf16_f32 v71, v42, v43
v_fmamk_f32 v32, v32, 0x3e0293ee, v27
v_mfma_f32_16x16x32_bf16 v[40:43], a[160:163], a[16:19], 0
v_exp_f32 v32, v32
v_mfma_f32_16x16x32_bf16 v[40:43], a[164:167], a[20:23], v[40:43]
buffer_load_dwordx4 v16, s[24:27], s31 offen nt lds
v_fmamk_f32 v33, v33, 0x3e0293ee, v27
v_mfma_f32_16x16x32_bf16 v[40:43], a[168:171], a[24:27], v[40:43]
v_exp_f32 v33, v33
v_mfma_f32_16x16x32_bf16 v[40:43], a[172:175], a[28:31], v[40:43]
ds_read_b64_tr_b16 a[220:221], v13 offset:32768
v_fmamk_f32 v34, v34, 0x3e0293ee, v27
v_mfma_f32_16x16x32_bf16 v[192:195], a[192:195], v[68:71], v[192:195]
v_exp_f32 v34, v34
v_mfma_f32_16x16x32_bf16 v[196:199], a[196:199], v[68:71], v[196:199]
ds_read_b64_tr_b16 a[222:223], v13 offset:36864
v_fmamk_f32 v35, v35, 0x3e0293ee, v27
v_mfma_f32_16x16x32_bf16 v[200:203], a[200:203], v[68:71], v[200:203]
v_exp_f32 v35, v35
v_mfma_f32_16x16x32_bf16 v[204:207], a[204:207], v[68:71], v[204:207]
v_cvt_pk_bf16_f32 v74, v32, v33
v_cvt_pk_bf16_f32 v75, v34, v35
v_mfma_f32_16x16x32_bf16 v[32:35], a[160:163], a[32:35], 0
ds_read_b128 a[176:179], v44 offset:36864
v_fmamk_f32 v36, v36, 0x3e0293ee, v23
v_mfma_f32_16x16x32_bf16 v[32:35], a[164:167], a[36:39], v[32:35]
v_exp_f32 v36, v36
v_mfma_f32_16x16x32_bf16 v[32:35], a[168:171], a[40:43], v[32:35]
ds_read_b128 a[180:183], v45 offset:36864
v_fmamk_f32 v37, v37, 0x3e0293ee, v23
v_mfma_f32_16x16x32_bf16 v[32:35], a[172:175], a[44:47], v[32:35]
v_exp_f32 v37, v37
v_mfma_f32_16x16x32_bf16 v[224:227], a[192:195], v[72:75], v[224:227]
ds_read_b128 a[184:187], v46 offset:36864
v_fmamk_f32 v38, v38, 0x3e0293ee, v23
v_mfma_f32_16x16x32_bf16 v[228:231], a[196:199], v[72:75], v[228:231]
v_exp_f32 v38, v38
v_mfma_f32_16x16x32_bf16 v[232:235], a[200:203], v[72:75], v[232:235]
ds_read_b128 a[188:191], v47 offset:36864
v_fmamk_f32 v39, v39, 0x3e0293ee, v23
v_mfma_f32_16x16x32_bf16 v[236:239], a[204:207], v[72:75], v[236:239]
v_exp_f32 v39, v39
v_mfma_f32_16x16x32_bf16 a[232:235], a[244:247], v[64:67], a[232:235]
s_waitcnt lgkmcnt(3)
v_cvt_pk_bf16_f32 v76, v36, v37
v_cvt_pk_bf16_f32 v77, v38, v39
v_mfma_f32_16x16x32_bf16 v[112:115], a[208:211], v[56:59], v[112:115]
v_fmamk_f32 v40, v40, 0x3e0293ee, v24
v_fmamk_f32 v41, v41, 0x3e0293ee, v24
v_mfma_f32_16x16x32_bf16 v[116:119], a[212:215], v[56:59], v[116:119]
v_exp_f32 v40, v40
v_mfma_f32_16x16x32_bf16 v[120:123], a[216:219], v[56:59], v[120:123]
v_exp_f32 v41, v41
v_mfma_f32_16x16x32_bf16 v[124:127], a[220:223], v[56:59], v[124:127]
buffer_load_dwordx4 v17, s[24:27], s31 offen offset:1024 nt lds
buffer_load_dwordx4 a[92:95], v28, s[8:11], 0 offen offset:192
v_mfma_f32_16x16x32_bf16 v[36:39], a[160:163], a[48:51], 0
s_add_u32 m0, s32, 16384
v_fmamk_f32 v42, v42, 0x3e0293ee, v24
v_fmamk_f32 v43, v43, 0x3e0293ee, v24
v_mfma_f32_16x16x32_bf16 v[36:39], a[164:167], a[52:55], v[36:39]
s_add_u32 s31, s28, 81920
v_exp_f32 v42, v42
v_mfma_f32_16x16x32_bf16 v[36:39], a[168:171], a[56:59], v[36:39]
v_exp_f32 v43, v43
v_mfma_f32_16x16x32_bf16 v[36:39], a[172:175], a[60:63], v[36:39]
v_cvt_pk_bf16_f32 v48, v40, v41
v_cvt_pk_bf16_f32 v49, v42, v43
v_mfma_f32_16x16x32_bf16 v[144:147], a[208:211], v[60:63], v[144:147]
v_add_u32 v28, s38, v18
v_fmamk_f32 v32, v32, 0x3e0293ee, v25
v_mfma_f32_16x16x32_bf16 v[148:151], a[212:215], v[60:63], v[148:151]
s_add_u32 s38, s58, 8192
v_exp_f32 v32, v32
v_mfma_f32_16x16x32_bf16 v[152:155], a[216:219], v[60:63], v[152:155]
buffer_load_dwordx4 a[96:99], v28, s[8:11], 0 offen offset:0
v_fmamk_f32 v33, v33, 0x3e0293ee, v25
v_mfma_f32_16x16x32_bf16 v[156:159], a[220:223], v[60:63], v[156:159]
v_exp_f32 v33, v33
v_mfma_f32_16x16x32_bf16 a[236:239], a[244:247], v[68:71], a[236:239]
s_waitcnt vmcnt(13) lgkmcnt(0)
v_fmamk_f32 v34, v34, 0x3e0293ee, v25
v_fmamk_f32 v35, v35, 0x3e0293ee, v25
v_mfma_f32_16x16x32_bf16 v[40:43], a[176:179], a[0:3], 0
s_barrier
v_exp_f32 v34, v34
v_mfma_f32_16x16x32_bf16 v[40:43], a[180:183], a[4:7], v[40:43]
v_exp_f32 v35, v35
v_mfma_f32_16x16x32_bf16 v[40:43], a[184:187], a[8:11], v[40:43]
v_cvt_pk_bf16_f32 v52, v32, v33
v_cvt_pk_bf16_f32 v53, v34, v35
v_mfma_f32_16x16x32_bf16 v[40:43], a[188:191], a[12:15], v[40:43]
ds_read_b64_tr_b16 a[192:193], v80 offset:32768
v_fmamk_f32 v36, v36, 0x3e0293ee, v26
v_mfma_f32_16x16x32_bf16 v[176:179], a[208:211], v[64:67], v[176:179]
v_exp_f32 v36, v36
v_mfma_f32_16x16x32_bf16 v[180:183], a[212:215], v[64:67], v[180:183]
buffer_load_dwordx4 v14, s[20:23], s30 offen nt lds
v_fmamk_f32 v37, v37, 0x3e0293ee, v26
v_mfma_f32_16x16x32_bf16 v[184:187], a[216:219], v[64:67], v[184:187]
v_exp_f32 v37, v37
v_mfma_f32_16x16x32_bf16 v[188:191], a[220:223], v[64:67], v[188:191]
ds_read_b64_tr_b16 a[194:195], v80 offset:36864
v_fmamk_f32 v38, v38, 0x3e0293ee, v26
v_mfma_f32_16x16x32_bf16 v[32:35], a[176:179], a[16:19], 0
v_exp_f32 v38, v38
v_mfma_f32_16x16x32_bf16 v[32:35], a[180:183], a[20:23], v[32:35]
ds_read_b64_tr_b16 a[196:197], v81 offset:32768
v_fmamk_f32 v39, v39, 0x3e0293ee, v26
v_mfma_f32_16x16x32_bf16 v[32:35], a[184:187], a[24:27], v[32:35]
v_exp_f32 v39, v39
v_mfma_f32_16x16x32_bf16 v[32:35], a[188:191], a[28:31], v[32:35]
ds_read_b64_tr_b16 a[198:199], v81 offset:36864
v_cvt_pk_bf16_f32 v56, v36, v37
v_mfma_f32_16x16x32_bf16 v[208:211], a[208:211], v[68:71], v[208:211]
ds_read_b64_tr_b16 a[200:201], v82 offset:32768
v_cvt_pk_bf16_f32 v57, v38, v39
v_mfma_f32_16x16x32_bf16 v[212:215], a[212:215], v[68:71], v[212:215]
ds_read_b64_tr_b16 a[202:203], v82 offset:36864
v_fmamk_f32 v40, v40, 0x3e0293ee, v23
v_mfma_f32_16x16x32_bf16 v[216:219], a[216:219], v[68:71], v[216:219]
v_exp_f32 v40, v40
v_mfma_f32_16x16x32_bf16 v[220:223], a[220:223], v[68:71], v[220:223]
ds_read_b64_tr_b16 a[204:205], v83 offset:32768
v_fmamk_f32 v41, v41, 0x3e0293ee, v23
v_mfma_f32_16x16x32_bf16 a[240:243], a[244:247], v[72:75], a[240:243]
v_exp_f32 v41, v41
v_mfma_f32_16x16x32_bf16 v[36:39], a[176:179], a[32:35], 0
ds_read_b64_tr_b16 a[206:207], v83 offset:36864
v_fmamk_f32 v42, v42, 0x3e0293ee, v23
v_mfma_f32_16x16x32_bf16 v[36:39], a[180:183], a[36:39], v[36:39]
v_exp_f32 v42, v42
v_mfma_f32_16x16x32_bf16 v[36:39], a[184:187], a[40:43], v[36:39]
ds_read_b128 a[160:163], v2 offset:49152
v_fmamk_f32 v43, v43, 0x3e0293ee, v23
v_mfma_f32_16x16x32_bf16 v[36:39], a[188:191], a[44:47], v[36:39]
v_exp_f32 v43, v43
v_mfma_f32_16x16x32_bf16 v[240:243], a[208:211], v[72:75], v[240:243]
ds_read_b128 a[164:167], v3 offset:49152
v_cvt_pk_bf16_f32 v78, v40, v41
v_mfma_f32_16x16x32_bf16 v[244:247], a[212:215], v[72:75], v[244:247]
ds_read_b128 a[168:171], v4 offset:49152
v_cvt_pk_bf16_f32 v79, v42, v43
v_mfma_f32_16x16x32_bf16 v[248:251], a[216:219], v[72:75], v[248:251]
ds_read_b128 a[172:175], v5 offset:49152
v_fmamk_f32 v32, v32, 0x3e0293ee, v24
v_mfma_f32_16x16x32_bf16 v[252:255], a[220:223], v[72:75], v[252:255]
v_exp_f32 v32, v32
v_mfma_f32_16x16x32_bf16 v[40:43], a[176:179], a[48:51], 0
buffer_load_dwordx4 v15, s[20:23], s30 offen offset:1024 nt lds
v_fmamk_f32 v33, v33, 0x3e0293ee, v24
v_mfma_f32_16x16x32_bf16 v[40:43], a[180:183], a[52:55], v[40:43]
s_add_u32 m0, s32, 81920
v_exp_f32 v33, v33
v_mfma_f32_16x16x32_bf16 v[40:43], a[184:187], a[56:59], v[40:43]
s_add_u32 s30, s28, 90112
v_fmamk_f32 v34, v34, 0x3e0293ee, v24
v_fmamk_f32 v35, v35, 0x3e0293ee, v24
v_mfma_f32_16x16x32_bf16 v[40:43], a[188:191], a[60:63], v[40:43]
s_waitcnt lgkmcnt(3)
v_exp_f32 v34, v34
v_mfma_f32_16x16x32_bf16 v[96:99], a[192:195], v[76:79], v[96:99]
v_exp_f32 v35, v35
v_mfma_f32_16x16x32_bf16 v[100:103], a[196:199], v[76:79], v[100:103]
v_cvt_pk_bf16_f32 v50, v32, v33
v_cvt_pk_bf16_f32 v51, v34, v35
v_mfma_f32_16x16x32_bf16 v[104:107], a[200:203], v[76:79], v[104:107]
v_fmamk_f32 v36, v36, 0x3e0293ee, v25
v_fmamk_f32 v37, v37, 0x3e0293ee, v25
v_mfma_f32_16x16x32_bf16 v[108:111], a[204:207], v[76:79], v[108:111]
v_exp_f32 v36, v36
v_mfma_f32_16x16x32_bf16 a[224:227], a[244:247], v[76:79], a[224:227]
v_exp_f32 v37, v37
v_mfma_f32_16x16x32_bf16 v[32:35], a[160:163], a[0:3], 0
s_waitcnt lgkmcnt(0)
v_fmamk_f32 v38, v38, 0x3e0293ee, v25
v_fmamk_f32 v39, v39, 0x3e0293ee, v25
v_mfma_f32_16x16x32_bf16 v[32:35], a[164:167], a[4:7], v[32:35]
v_exp_f32 v38, v38
v_mfma_f32_16x16x32_bf16 v[32:35], a[168:171], a[8:11], v[32:35]
v_exp_f32 v39, v39
v_mfma_f32_16x16x32_bf16 v[32:35], a[172:175], a[12:15], v[32:35]
v_cvt_pk_bf16_f32 v54, v36, v37
v_cvt_pk_bf16_f32 v55, v38, v39
v_mfma_f32_16x16x32_bf16 v[128:131], a[192:195], v[48:51], v[128:131]
buffer_load_dwordx4 v16, s[24:27], s31 offen nt lds
v_fmamk_f32 v40, v40, 0x3e0293ee, v26
v_mfma_f32_16x16x32_bf16 v[132:135], a[196:199], v[48:51], v[132:135]
v_exp_f32 v40, v40
v_mfma_f32_16x16x32_bf16 v[136:139], a[200:203], v[48:51], v[136:139]
ds_read_b64_tr_b16 a[208:209], v84 offset:32768
v_fmamk_f32 v41, v41, 0x3e0293ee, v26
v_mfma_f32_16x16x32_bf16 v[140:143], a[204:207], v[48:51], v[140:143]
v_exp_f32 v41, v41
v_mfma_f32_16x16x32_bf16 v[36:39], a[160:163], a[16:19], 0
ds_read_b64_tr_b16 a[210:211], v84 offset:36864
v_fmamk_f32 v42, v42, 0x3e0293ee, v26
v_mfma_f32_16x16x32_bf16 v[36:39], a[164:167], a[20:23], v[36:39]
v_exp_f32 v42, v42
v_mfma_f32_16x16x32_bf16 v[36:39], a[168:171], a[24:27], v[36:39]
ds_read_b64_tr_b16 a[212:213], v85 offset:32768
v_fmamk_f32 v43, v43, 0x3e0293ee, v26
v_mfma_f32_16x16x32_bf16 v[36:39], a[172:175], a[28:31], v[36:39]
v_exp_f32 v43, v43
v_mfma_f32_16x16x32_bf16 v[160:163], a[192:195], v[52:55], v[160:163]
ds_read_b64_tr_b16 a[214:215], v85 offset:36864
v_cvt_pk_bf16_f32 v58, v40, v41
v_mfma_f32_16x16x32_bf16 v[164:167], a[196:199], v[52:55], v[164:167]
ds_read_b64_tr_b16 a[216:217], v86 offset:32768
v_cvt_pk_bf16_f32 v59, v42, v43
v_mfma_f32_16x16x32_bf16 v[168:171], a[200:203], v[52:55], v[168:171]
ds_read_b64_tr_b16 a[218:219], v86 offset:36864
v_fmamk_f32 v32, v32, 0x3e0293ee, v23
v_mfma_f32_16x16x32_bf16 v[172:175], a[204:207], v[52:55], v[172:175]
v_exp_f32 v32, v32
v_mfma_f32_16x16x32_bf16 a[228:231], a[244:247], v[48:51], a[228:231]
ds_read_b64_tr_b16 a[220:221], v87 offset:32768
v_fmamk_f32 v33, v33, 0x3e0293ee, v23
v_mfma_f32_16x16x32_bf16 v[40:43], a[160:163], a[32:35], 0
v_exp_f32 v33, v33
v_mfma_f32_16x16x32_bf16 v[40:43], a[164:167], a[36:39], v[40:43]
ds_read_b64_tr_b16 a[222:223], v87 offset:36864
v_fmamk_f32 v34, v34, 0x3e0293ee, v23
v_mfma_f32_16x16x32_bf16 v[40:43], a[168:171], a[40:43], v[40:43]
v_exp_f32 v34, v34
v_mfma_f32_16x16x32_bf16 v[40:43], a[172:175], a[44:47], v[40:43]
ds_read_b128 a[176:179], v2 offset:53248
v_fmamk_f32 v35, v35, 0x3e0293ee, v23
v_mfma_f32_16x16x32_bf16 v[192:195], a[192:195], v[56:59], v[192:195]
buffer_load_dwordx4 v17, s[24:27], s31 offen offset:1024 nt lds
v_cvt_pk_bf16_f32 v60, v32, v33
v_mfma_f32_16x16x32_bf16 v[196:199], a[196:199], v[56:59], v[196:199]
s_add_u32 m0, s32, 24576
buffer_load_dwordx4 a[100:103], v28, s[8:11], 0 offen offset:64
v_fmamk_f32 v36, v36, 0x3e0293ee, v24
v_mfma_f32_16x16x32_bf16 v[200:203], a[200:203], v[56:59], v[200:203]
s_add_u32 s31, s28, 90112
v_exp_f32 v35, v35
v_mfma_f32_16x16x32_bf16 v[204:207], a[204:207], v[56:59], v[204:207]
v_cvt_pk_bf16_f32 v61, v34, v35
v_fmamk_f32 v37, v37, 0x3e0293ee, v24
v_mfma_f32_16x16x32_bf16 v[32:35], a[160:163], a[48:51], 0
v_exp_f32 v36, v36
v_mfma_f32_16x16x32_bf16 v[32:35], a[164:167], a[52:55], v[32:35]
v_exp_f32 v37, v37
v_mfma_f32_16x16x32_bf16 v[32:35], a[168:171], a[56:59], v[32:35]
ds_read_b128 a[180:183], v3 offset:53248
v_fmamk_f32 v38, v38, 0x3e0293ee, v24
v_mfma_f32_16x16x32_bf16 v[32:35], a[172:175], a[60:63], v[32:35]
s_waitcnt lgkmcnt(1)
v_exp_f32 v38, v38
v_mfma_f32_16x16x32_bf16 v[112:115], a[208:211], v[76:79], v[112:115]
ds_read_b128 a[184:187], v4 offset:53248
v_fmamk_f32 v39, v39, 0x3e0293ee, v24
v_mfma_f32_16x16x32_bf16 v[116:119], a[212:215], v[76:79], v[116:119]
v_exp_f32 v39, v39
v_mfma_f32_16x16x32_bf16 v[120:123], a[216:219], v[76:79], v[120:123]
ds_read_b128 a[188:191], v5 offset:53248
v_cvt_pk_bf16_f32 v64, v36, v37
v_mfma_f32_16x16x32_bf16 v[124:127], a[220:223], v[76:79], v[124:127]
v_cvt_pk_bf16_f32 v65, v38, v39
v_fmamk_f32 v40, v40, 0x3e0293ee, v25
v_mfma_f32_16x16x32_bf16 a[232:235], a[244:247], v[52:55], a[232:235]
v_exp_f32 v40, v40
v_mfma_f32_16x16x32_bf16 v[36:39], a[160:163], a[64:67], 0
v_fmamk_f32 v41, v41, 0x3e0293ee, v25
v_fmamk_f32 v42, v42, 0x3e0293ee, v25
v_mfma_f32_16x16x32_bf16 v[36:39], a[164:167], a[68:71], v[36:39]
v_exp_f32 v41, v41
v_mfma_f32_16x16x32_bf16 v[36:39], a[168:171], a[72:75], v[36:39]
v_exp_f32 v42, v42
v_mfma_f32_16x16x32_bf16 v[36:39], a[172:175], a[76:79], v[36:39]
v_fmamk_f32 v43, v43, 0x3e0293ee, v25
v_cvt_pk_bf16_f32 v68, v40, v41
v_mfma_f32_16x16x32_bf16 v[144:147], a[208:211], v[48:51], v[144:147]
v_exp_f32 v43, v43
v_mfma_f32_16x16x32_bf16 v[148:151], a[212:215], v[48:51], v[148:151]
ds_read_b64_tr_b16 a[192:193], v6 offset:49152
v_cvt_pk_bf16_f32 v69, v42, v43
v_mfma_f32_16x16x32_bf16 v[152:155], a[216:219], v[48:51], v[152:155]
ds_read_b64_tr_b16 a[194:195], v6 offset:53248
v_fmamk_f32 v32, v32, 0x3e0293ee, v26
v_mfma_f32_16x16x32_bf16 v[156:159], a[220:223], v[48:51], v[156:159]
v_exp_f32 v32, v32
v_mfma_f32_16x16x32_bf16 v[40:43], a[176:179], a[0:3], 0
s_waitcnt lgkmcnt(2)
ds_read_b64_tr_b16 a[196:197], v7 offset:49152
v_fmamk_f32 v33, v33, 0x3e0293ee, v26
v_mfma_f32_16x16x32_bf16 v[40:43], a[180:183], a[4:7], v[40:43]
v_exp_f32 v33, v33
v_mfma_f32_16x16x32_bf16 v[40:43], a[184:187], a[8:11], v[40:43]
ds_read_b64_tr_b16 a[198:199], v7 offset:53248
v_fmamk_f32 v34, v34, 0x3e0293ee, v26
v_mfma_f32_16x16x32_bf16 v[40:43], a[188:191], a[12:15], v[40:43]
v_exp_f32 v34, v34
v_mfma_f32_16x16x32_bf16 v[176:179], a[208:211], v[52:55], v[176:179]
buffer_load_dwordx4 v14, s[20:23], s30 offen nt lds
v_fmamk_f32 v35, v35, 0x3e0293ee, v26
v_mfma_f32_16x16x32_bf16 v[180:183], a[212:215], v[52:55], v[180:183]
v_exp_f32 v35, v35
v_mfma_f32_16x16x32_bf16 v[184:187], a[216:219], v[52:55], v[184:187]
ds_read_b64_tr_b16 a[200:201], v8 offset:49152
v_cvt_pk_bf16_f32 v72, v32, v33
v_mfma_f32_16x16x32_bf16 v[188:191], a[220:223], v[52:55], v[188:191]
ds_read_b64_tr_b16 a[202:203], v8 offset:53248
v_cvt_pk_bf16_f32 v73, v34, v35
v_mfma_f32_16x16x32_bf16 a[236:239], a[244:247], v[56:59], a[236:239]
ds_read_b64_tr_b16 a[204:205], v9 offset:49152
v_fmamk_f32 v36, v36, 0x3e0293ee, v27
v_mfma_f32_16x16x32_bf16 v[32:35], a[176:179], a[16:19], 0
v_exp_f32 v36, v36
v_mfma_f32_16x16x32_bf16 v[32:35], a[180:183], a[20:23], v[32:35]
ds_read_b64_tr_b16 a[206:207], v9 offset:53248
v_fmamk_f32 v37, v37, 0x3e0293ee, v27
v_mfma_f32_16x16x32_bf16 v[32:35], a[184:187], a[24:27], v[32:35]
v_exp_f32 v37, v37
v_mfma_f32_16x16x32_bf16 v[32:35], a[188:191], a[28:31], v[32:35]
v_fmamk_f32 v38, v38, 0x3e0293ee, v27
v_fmamk_f32 v39, v39, 0x3e0293ee, v27
v_mfma_f32_16x16x32_bf16 v[208:211], a[208:211], v[56:59], v[208:211]
v_exp_f32 v38, v38
v_mfma_f32_16x16x32_bf16 v[212:215], a[212:215], v[56:59], v[212:215]
v_exp_f32 v39, v39
v_mfma_f32_16x16x32_bf16 v[216:219], a[216:219], v[56:59], v[216:219]
v_cvt_pk_bf16_f32 v76, v36, v37
v_cvt_pk_bf16_f32 v77, v38, v39
v_mfma_f32_16x16x32_bf16 v[220:223], a[220:223], v[56:59], v[220:223]
ds_read_b128 a[160:163], v44 offset:49152
v_fmamk_f32 v40, v40, 0x3e0293ee, v23
v_mfma_f32_16x16x32_bf16 v[36:39], a[176:179], a[32:35], 0
v_exp_f32 v40, v40
v_mfma_f32_16x16x32_bf16 v[36:39], a[180:183], a[36:39], v[36:39]
ds_read_b128 a[164:167], v45 offset:49152
v_fmamk_f32 v41, v41, 0x3e0293ee, v23
v_mfma_f32_16x16x32_bf16 v[36:39], a[184:187], a[40:43], v[36:39]
v_exp_f32 v41, v41
v_fmamk_f32 v42, v42, 0x3e0293ee, v23
v_fmamk_f32 v43, v43, 0x3e0293ee, v23
v_exp_f32 v42, v42
v_exp_f32 v43, v43
v_mfma_f32_16x16x32_bf16 v[36:39], a[188:191], a[44:47], v[36:39]
v_cvt_pk_bf16_f32 v62, v40, v41
v_cvt_pk_bf16_f32 v63, v42, v43
v_mfma_f32_16x16x32_bf16 v[40:43], a[176:179], a[48:51], 0
ds_read_b128 a[168:171], v46 offset:49152
v_fmamk_f32 v32, v32, 0x3e0293ee, v24
v_mfma_f32_16x16x32_bf16 v[40:43], a[180:183], a[52:55], v[40:43]
v_exp_f32 v32, v32
v_mfma_f32_16x16x32_bf16 v[40:43], a[184:187], a[56:59], v[40:43]
ds_read_b128 a[172:175], v47 offset:49152
v_fmamk_f32 v33, v33, 0x3e0293ee, v24
v_mfma_f32_16x16x32_bf16 v[40:43], a[188:191], a[60:63], v[40:43]
s_waitcnt lgkmcnt(3)
v_exp_f32 v33, v33
v_mfma_f32_16x16x32_bf16 v[96:99], a[192:195], v[60:63], v[96:99]
buffer_load_dwordx4 v15, s[20:23], s30 offen offset:1024 nt lds
v_fmamk_f32 v34, v34, 0x3e0293ee, v24
v_mfma_f32_16x16x32_bf16 v[100:103], a[196:199], v[60:63], v[100:103]
s_add_u32 m0, s32, 90112
v_exp_f32 v34, v34
v_mfma_f32_16x16x32_bf16 v[104:107], a[200:203], v[60:63], v[104:107]
s_add_u32 s30, s28, 98304
v_fmamk_f32 v35, v35, 0x3e0293ee, v24
v_cvt_pk_bf16_f32 v66, v32, v33
v_mfma_f32_16x16x32_bf16 v[108:111], a[204:207], v[60:63], v[108:111]
v_exp_f32 v35, v35
v_mfma_f32_16x16x32_bf16 a[224:227], a[244:247], v[60:63], a[224:227]
v_cvt_pk_bf16_f32 v67, v34, v35
v_fmamk_f32 v36, v36, 0x3e0293ee, v25
v_mfma_f32_16x16x32_bf16 v[32:35], a[176:179], a[64:67], 0
v_exp_f32 v36, v36
v_mfma_f32_16x16x32_bf16 v[32:35], a[180:183], a[68:71], v[32:35]
v_fmamk_f32 v37, v37, 0x3e0293ee, v25
v_fmamk_f32 v38, v38, 0x3e0293ee, v25
v_mfma_f32_16x16x32_bf16 v[32:35], a[184:187], a[72:75], v[32:35]
v_exp_f32 v37, v37
v_mfma_f32_16x16x32_bf16 v[32:35], a[188:191], a[76:79], v[32:35]
v_exp_f32 v38, v38
v_mfma_f32_16x16x32_bf16 v[128:131], a[192:195], v[64:67], v[128:131]
v_fmamk_f32 v39, v39, 0x3e0293ee, v25
v_cvt_pk_bf16_f32 v70, v36, v37
v_mfma_f32_16x16x32_bf16 v[132:135], a[196:199], v[64:67], v[132:135]
v_exp_f32 v39, v39
v_mfma_f32_16x16x32_bf16 v[136:139], a[200:203], v[64:67], v[136:139]
ds_read_b64_tr_b16 a[208:209], v10 offset:49152
v_cvt_pk_bf16_f32 v71, v38, v39
v_mfma_f32_16x16x32_bf16 v[140:143], a[204:207], v[64:67], v[140:143]
ds_read_b64_tr_b16 a[210:211], v10 offset:53248
v_fmamk_f32 v40, v40, 0x3e0293ee, v26
v_mfma_f32_16x16x32_bf16 v[36:39], a[160:163], a[0:3], 0
s_waitcnt lgkmcnt(2)
v_exp_f32 v40, v40
v_mfma_f32_16x16x32_bf16 v[36:39], a[164:167], a[4:7], v[36:39]
ds_read_b64_tr_b16 a[212:213], v11 offset:49152
v_fmamk_f32 v41, v41, 0x3e0293ee, v26
v_mfma_f32_16x16x32_bf16 v[36:39], a[168:171], a[8:11], v[36:39]
v_exp_f32 v41, v41
v_mfma_f32_16x16x32_bf16 v[36:39], a[172:175], a[12:15], v[36:39]
ds_read_b64_tr_b16 a[214:215], v11 offset:53248
v_fmamk_f32 v42, v42, 0x3e0293ee, v26
v_mfma_f32_16x16x32_bf16 v[160:163], a[192:195], v[68:71], v[160:163]
v_exp_f32 v42, v42
v_mfma_f32_16x16x32_bf16 v[164:167], a[196:199], v[68:71], v[164:167]
ds_read_b64_tr_b16 a[216:217], v12 offset:49152
v_fmamk_f32 v43, v43, 0x3e0293ee, v26
v_mfma_f32_16x16x32_bf16 v[168:171], a[200:203], v[68:71], v[168:171]
v_exp_f32 v43, v43
v_mfma_f32_16x16x32_bf16 v[172:175], a[204:207], v[68:71], v[172:175]
ds_read_b64_tr_b16 a[218:219], v12 offset:53248
v_cvt_pk_bf16_f32 v74, v40, v41
v_mfma_f32_16x16x32_bf16 a[228:231], a[244:247], v[64:67], a[228:231]
v_cvt_pk_bf16_f32 v75, v42, v43
v_fmamk_f32 v32, v32, 0x3e0293ee, v27
v_mfma_f32_16x16x32_bf16 v[40:43], a[160:163], a[16:19], 0
v_exp_f32 v32, v32
v_mfma_f32_16x16x32_bf16 v[40:43], a[164:167], a[20:23], v[40:43]
buffer_load_dwordx4 v16, s[24:27], s31 offen nt lds
v_fmamk_f32 v33, v33, 0x3e0293ee, v27
v_mfma_f32_16x16x32_bf16 v[40:43], a[168:171], a[24:27], v[40:43]
v_exp_f32 v33, v33
v_mfma_f32_16x16x32_bf16 v[40:43], a[172:175], a[28:31], v[40:43]
ds_read_b64_tr_b16 a[220:221], v13 offset:49152
v_fmamk_f32 v34, v34, 0x3e0293ee, v27
v_mfma_f32_16x16x32_bf16 v[192:195], a[192:195], v[72:75], v[192:195]
v_exp_f32 v34, v34
v_mfma_f32_16x16x32_bf16 v[196:199], a[196:199], v[72:75], v[196:199]
ds_read_b64_tr_b16 a[222:223], v13 offset:53248
v_fmamk_f32 v35, v35, 0x3e0293ee, v27
v_mfma_f32_16x16x32_bf16 v[200:203], a[200:203], v[72:75], v[200:203]
v_exp_f32 v35, v35
v_mfma_f32_16x16x32_bf16 v[204:207], a[204:207], v[72:75], v[204:207]
v_cvt_pk_bf16_f32 v78, v32, v33
v_cvt_pk_bf16_f32 v79, v34, v35
v_mfma_f32_16x16x32_bf16 v[32:35], a[160:163], a[32:35], 0
ds_read_b128 a[176:179], v44 offset:53248
v_fmamk_f32 v36, v36, 0x3e0293ee, v23
v_mfma_f32_16x16x32_bf16 v[32:35], a[164:167], a[36:39], v[32:35]
v_exp_f32 v36, v36
v_mfma_f32_16x16x32_bf16 v[32:35], a[168:171], a[40:43], v[32:35]
ds_read_b128 a[180:183], v45 offset:53248
v_fmamk_f32 v37, v37, 0x3e0293ee, v23
v_mfma_f32_16x16x32_bf16 v[32:35], a[172:175], a[44:47], v[32:35]
v_exp_f32 v37, v37
v_mfma_f32_16x16x32_bf16 v[224:227], a[192:195], v[76:79], v[224:227]
ds_read_b128 a[184:187], v46 offset:53248
v_fmamk_f32 v38, v38, 0x3e0293ee, v23
v_mfma_f32_16x16x32_bf16 v[228:231], a[196:199], v[76:79], v[228:231]
v_exp_f32 v38, v38
v_mfma_f32_16x16x32_bf16 v[232:235], a[200:203], v[76:79], v[232:235]
ds_read_b128 a[188:191], v47 offset:53248
v_fmamk_f32 v39, v39, 0x3e0293ee, v23
v_mfma_f32_16x16x32_bf16 v[236:239], a[204:207], v[76:79], v[236:239]
v_exp_f32 v39, v39
v_mfma_f32_16x16x32_bf16 a[232:235], a[244:247], v[68:71], a[232:235]
s_waitcnt lgkmcnt(3)
v_cvt_pk_bf16_f32 v48, v36, v37
v_cvt_pk_bf16_f32 v49, v38, v39
v_mfma_f32_16x16x32_bf16 v[112:115], a[208:211], v[60:63], v[112:115]
v_fmamk_f32 v40, v40, 0x3e0293ee, v24
v_fmamk_f32 v41, v41, 0x3e0293ee, v24
v_mfma_f32_16x16x32_bf16 v[116:119], a[212:215], v[60:63], v[116:119]
v_exp_f32 v40, v40
v_mfma_f32_16x16x32_bf16 v[120:123], a[216:219], v[60:63], v[120:123]
v_exp_f32 v41, v41
v_mfma_f32_16x16x32_bf16 v[124:127], a[220:223], v[60:63], v[124:127]
buffer_load_dwordx4 v17, s[24:27], s31 offen offset:1024 nt lds
buffer_load_dwordx4 a[104:107], v28, s[8:11], 0 offen offset:128
v_mfma_f32_16x16x32_bf16 v[36:39], a[160:163], a[48:51], 0
s_add_u32 m0, s32, 32768
v_fmamk_f32 v42, v42, 0x3e0293ee, v24
v_fmamk_f32 v43, v43, 0x3e0293ee, v24
v_mfma_f32_16x16x32_bf16 v[36:39], a[164:167], a[52:55], v[36:39]
s_add_u32 s31, s28, 98304
v_exp_f32 v42, v42
v_mfma_f32_16x16x32_bf16 v[36:39], a[168:171], a[56:59], v[36:39]
v_exp_f32 v43, v43
v_mfma_f32_16x16x32_bf16 v[36:39], a[172:175], a[60:63], v[36:39]
v_cvt_pk_bf16_f32 v52, v40, v41
v_cvt_pk_bf16_f32 v53, v42, v43
v_mfma_f32_16x16x32_bf16 v[144:147], a[208:211], v[64:67], v[144:147]
buffer_load_dwordx4 a[108:111], v28, s[8:11], 0 offen offset:192
v_fmamk_f32 v32, v32, 0x3e0293ee, v25
v_mfma_f32_16x16x32_bf16 v[148:151], a[212:215], v[64:67], v[148:151]
v_exp_f32 v32, v32
v_mfma_f32_16x16x32_bf16 v[152:155], a[216:219], v[64:67], v[152:155]
v_fmamk_f32 v33, v33, 0x3e0293ee, v25
v_fmamk_f32 v34, v34, 0x3e0293ee, v25
v_mfma_f32_16x16x32_bf16 v[156:159], a[220:223], v[64:67], v[156:159]
v_exp_f32 v33, v33
v_mfma_f32_16x16x32_bf16 a[236:239], a[244:247], v[72:75], a[236:239]
s_waitcnt vmcnt(13) lgkmcnt(0)
v_exp_f32 v34, v34
v_mfma_f32_16x16x32_bf16 v[40:43], a[176:179], a[0:3], 0
s_barrier
v_fmamk_f32 v35, v35, 0x3e0293ee, v25
v_cvt_pk_bf16_f32 v56, v32, v33
v_mfma_f32_16x16x32_bf16 v[40:43], a[180:183], a[4:7], v[40:43]
L_pad1_3:
s_cbranch_execz L_pad1_7
v_exp_f32 v35, v35
v_mfma_f32_16x16x32_bf16 v[40:43], a[184:187], a[8:11], v[40:43]
ds_read_b64_tr_b16 a[192:193], v80 offset:49152
v_cvt_pk_bf16_f32 v57, v34, v35
v_mfma_f32_16x16x32_bf16 v[40:43], a[188:191], a[12:15], v[40:43]
ds_read_b64_tr_b16 a[194:195], v80 offset:53248
v_fmamk_f32 v36, v36, 0x3e0293ee, v26
v_mfma_f32_16x16x32_bf16 v[176:179], a[208:211], v[68:71], v[176:179]
v_exp_f32 v36, v36
v_mfma_f32_16x16x32_bf16 v[180:183], a[212:215], v[68:71], v[180:183]
buffer_load_dwordx4 v14, s[20:23], s30 offen nt lds
v_fmamk_f32 v37, v37, 0x3e0293ee, v26
v_mfma_f32_16x16x32_bf16 v[184:187], a[216:219], v[68:71], v[184:187]
v_exp_f32 v37, v37
v_mfma_f32_16x16x32_bf16 v[188:191], a[220:223], v[68:71], v[188:191]
ds_read_b64_tr_b16 a[196:197], v81 offset:49152
v_fmamk_f32 v38, v38, 0x3e0293ee, v26
v_mfma_f32_16x16x32_bf16 v[32:35], a[176:179], a[16:19], 0
v_exp_f32 v38, v38
v_mfma_f32_16x16x32_bf16 v[32:35], a[180:183], a[20:23], v[32:35]
ds_read_b64_tr_b16 a[198:199], v81 offset:53248
v_fmamk_f32 v39, v39, 0x3e0293ee, v26
v_mfma_f32_16x16x32_bf16 v[32:35], a[184:187], a[24:27], v[32:35]
v_exp_f32 v39, v39
v_mfma_f32_16x16x32_bf16 v[32:35], a[188:191], a[28:31], v[32:35]
ds_read_b64_tr_b16 a[200:201], v82 offset:49152
v_cvt_pk_bf16_f32 v60, v36, v37
v_mfma_f32_16x16x32_bf16 v[208:211], a[208:211], v[72:75], v[208:211]
ds_read_b64_tr_b16 a[202:203], v82 offset:53248
v_cvt_pk_bf16_f32 v61, v38, v39
v_mfma_f32_16x16x32_bf16 v[212:215], a[212:215], v[72:75], v[212:215]
ds_read_b64_tr_b16 a[204:205], v83 offset:49152
v_fmamk_f32 v40, v40, 0x3e0293ee, v23
v_mfma_f32_16x16x32_bf16 v[216:219], a[216:219], v[72:75], v[216:219]
v_exp_f32 v40, v40
v_mfma_f32_16x16x32_bf16 v[220:223], a[220:223], v[72:75], v[220:223]
ds_read_b64_tr_b16 a[206:207], v83 offset:53248
v_fmamk_f32 v41, v41, 0x3e0293ee, v23
v_mfma_f32_16x16x32_bf16 a[240:243], a[244:247], v[76:79], a[240:243]
v_exp_f32 v41, v41
v_mfma_f32_16x16x32_bf16 v[36:39], a[176:179], a[32:35], 0
ds_read_b128 a[160:163], v2 offset:0
v_fmamk_f32 v42, v42, 0x3e0293ee, v23
v_mfma_f32_16x16x32_bf16 v[36:39], a[180:183], a[36:39], v[36:39]
v_exp_f32 v42, v42
v_mfma_f32_16x16x32_bf16 v[36:39], a[184:187], a[40:43], v[36:39]
ds_read_b128 a[164:167], v3 offset:0
v_fmamk_f32 v43, v43, 0x3e0293ee, v23
v_mfma_f32_16x16x32_bf16 v[36:39], a[188:191], a[44:47], v[36:39]
v_exp_f32 v43, v43
v_mfma_f32_16x16x32_bf16 v[240:243], a[208:211], v[76:79], v[240:243]
ds_read_b128 a[168:171], v4 offset:0
v_cvt_pk_bf16_f32 v50, v40, v41
v_mfma_f32_16x16x32_bf16 v[244:247], a[212:215], v[76:79], v[244:247]
ds_read_b128 a[172:175], v5 offset:0
v_cvt_pk_bf16_f32 v51, v42, v43
v_mfma_f32_16x16x32_bf16 v[248:251], a[216:219], v[76:79], v[248:251]
buffer_load_dwordx4 v15, s[20:23], s30 offen offset:1024 nt lds
v_fmamk_f32 v32, v32, 0x3e0293ee, v24
v_mfma_f32_16x16x32_bf16 v[252:255], a[220:223], v[76:79], v[252:255]
s_add_u32 m0, s32, 98304
v_exp_f32 v32, v32
v_mfma_f32_16x16x32_bf16 v[40:43], a[176:179], a[48:51], 0
s_add_u32 s30, s28, 106496
v_fmamk_f32 v33, v33, 0x3e0293ee, v24
v_fmamk_f32 v34, v34, 0x3e0293ee, v24
v_mfma_f32_16x16x32_bf16 v[40:43], a[180:183], a[52:55], v[40:43]
v_exp_f32 v33, v33
v_mfma_f32_16x16x32_bf16 v[40:43], a[184:187], a[56:59], v[40:43]
v_exp_f32 v34, v34
v_mfma_f32_16x16x32_bf16 v[40:43], a[188:191], a[60:63], v[40:43]
s_waitcnt lgkmcnt(2)
v_fmamk_f32 v35, v35, 0x3e0293ee, v24
v_cvt_pk_bf16_f32 v54, v32, v33
v_mfma_f32_16x16x32_bf16 v[96:99], a[192:195], v[48:51], v[96:99]
v_exp_f32 v35, v35
v_mfma_f32_16x16x32_bf16 v[100:103], a[196:199], v[48:51], v[100:103]
v_cvt_pk_bf16_f32 v55, v34, v35
v_fmamk_f32 v36, v36, 0x3e0293ee, v25
v_mfma_f32_16x16x32_bf16 v[104:107], a[200:203], v[48:51], v[104:107]
v_exp_f32 v36, v36
v_mfma_f32_16x16x32_bf16 v[108:111], a[204:207], v[48:51], v[108:111]
v_fmamk_f32 v37, v37, 0x3e0293ee, v25
v_fmamk_f32 v38, v38, 0x3e0293ee, v25
v_mfma_f32_16x16x32_bf16 a[224:227], a[244:247], v[48:51], a[224:227]
v_exp_f32 v37, v37
v_mfma_f32_16x16x32_bf16 v[32:35], a[160:163], a[0:3], 0
v_exp_f32 v38, v38
v_mfma_f32_16x16x32_bf16 v[32:35], a[164:167], a[4:7], v[32:35]
s_waitcnt lgkmcnt(0)
v_fmamk_f32 v39, v39, 0x3e0293ee, v25
v_cvt_pk_bf16_f32 v58, v36, v37
v_mfma_f32_16x16x32_bf16 v[32:35], a[168:171], a[8:11], v[32:35]
v_exp_f32 v39, v39
v_mfma_f32_16x16x32_bf16 v[32:35], a[172:175], a[12:15], v[32:35]
ds_read_b64_tr_b16 a[208:209], v84 offset:49152
v_cvt_pk_bf16_f32 v59, v38, v39
v_mfma_f32_16x16x32_bf16 v[128:131], a[192:195], v[52:55], v[128:131]
buffer_load_dwordx4 v16, s[24:27], s31 offen nt lds
v_fmamk_f32 v40, v40, 0x3e0293ee, v26
v_mfma_f32_16x16x32_bf16 v[132:135], a[196:199], v[52:55], v[132:135]
v_exp_f32 v40, v40
v_mfma_f32_16x16x32_bf16 v[136:139], a[200:203], v[52:55], v[136:139]
ds_read_b64_tr_b16 a[210:211], v84 offset:53248
v_fmamk_f32 v41, v41, 0x3e0293ee, v26
v_mfma_f32_16x16x32_bf16 v[140:143], a[204:207], v[52:55], v[140:143]
v_exp_f32 v41, v41
v_mfma_f32_16x16x32_bf16 v[36:39], a[160:163], a[16:19], 0
ds_read_b64_tr_b16 a[212:213], v85 offset:49152
v_fmamk_f32 v42, v42, 0x3e0293ee, v26
v_mfma_f32_16x16x32_bf16 v[36:39], a[164:167], a[20:23], v[36:39]
v_exp_f32 v42, v42
v_mfma_f32_16x16x32_bf16 v[36:39], a[168:171], a[24:27], v[36:39]
ds_read_b64_tr_b16 a[214:215], v85 offset:53248
v_fmamk_f32 v43, v43, 0x3e0293ee, v26
v_mfma_f32_16x16x32_bf16 v[36:39], a[172:175], a[28:31], v[36:39]
v_exp_f32 v43, v43
v_mfma_f32_16x16x32_bf16 v[160:163], a[192:195], v[56:59], v[160:163]
ds_read_b64_tr_b16 a[216:217], v86 offset:49152
v_cvt_pk_bf16_f32 v62, v40, v41
v_mfma_f32_16x16x32_bf16 v[164:167], a[196:199], v[56:59], v[164:167]
ds_read_b64_tr_b16 a[218:219], v86 offset:53248
v_cvt_pk_bf16_f32 v63, v42, v43
v_mfma_f32_16x16x32_bf16 v[168:171], a[200:203], v[56:59], v[168:171]
ds_read_b64_tr_b16 a[220:221], v87 offset:49152
v_add_u32 v28, s38, v18
v_mfma_f32_16x16x32_bf16 v[172:175], a[204:207], v[56:59], v[172:175]
s_add_u32 s38, s58, 12288
ds_read_b64_tr_b16 a[222:223], v87 offset:53248
v_fmamk_f32 v32, v32, 0x3e0293ee, v23
v_mfma_f32_16x16x32_bf16 a[228:231], a[244:247], v[52:55], a[228:231]
v_exp_f32 v32, v32
v_mfma_f32_16x16x32_bf16 v[40:43], a[160:163], a[32:35], 0
ds_read_b128 a[176:179], v2 offset:4096
v_fmamk_f32 v33, v33, 0x3e0293ee, v23
v_mfma_f32_16x16x32_bf16 v[40:43], a[164:167], a[36:39], v[40:43]
v_exp_f32 v33, v33
v_mfma_f32_16x16x32_bf16 v[40:43], a[168:171], a[40:43], v[40:43]
ds_read_b128 a[180:183], v3 offset:4096
v_fmamk_f32 v34, v34, 0x3e0293ee, v23
v_mfma_f32_16x16x32_bf16 v[40:43], a[172:175], a[44:47], v[40:43]
v_exp_f32 v34, v34
v_mfma_f32_16x16x32_bf16 v[192:195], a[192:195], v[60:63], v[192:195]
buffer_load_dwordx4 v17, s[24:27], s31 offen offset:1024 nt lds
v_fmamk_f32 v35, v35, 0x3e0293ee, v23
v_mfma_f32_16x16x32_bf16 v[196:199], a[196:199], v[60:63], v[196:199]
s_add_u32 m0, s32, 40960
buffer_load_dwordx4 a[112:115], v28, s[8:11], 0 offen offset:0
v_cvt_pk_bf16_f32 v64, v32, v33
v_mfma_f32_16x16x32_bf16 v[200:203], a[200:203], v[60:63], v[200:203]
s_add_u32 s31, s28, 106496
v_exp_f32 v35, v35
v_mfma_f32_16x16x32_bf16 v[204:207], a[204:207], v[60:63], v[204:207]
v_cvt_pk_bf16_f32 v65, v34, v35
v_fmamk_f32 v36, v36, 0x3e0293ee, v24
v_mfma_f32_16x16x32_bf16 v[32:35], a[160:163], a[48:51], 0
v_exp_f32 v36, v36
v_mfma_f32_16x16x32_bf16 v[32:35], a[164:167], a[52:55], v[32:35]
ds_read_b128 a[184:187], v4 offset:4096
v_fmamk_f32 v37, v37, 0x3e0293ee, v24
v_mfma_f32_16x16x32_bf16 v[32:35], a[168:171], a[56:59], v[32:35]
v_exp_f32 v37, v37
v_mfma_f32_16x16x32_bf16 v[32:35], a[172:175], a[60:63], v[32:35]
s_waitcnt lgkmcnt(1)
ds_read_b128 a[188:191], v5 offset:4096
v_fmamk_f32 v38, v38, 0x3e0293ee, v24
v_mfma_f32_16x16x32_bf16 v[112:115], a[208:211], v[48:51], v[112:115]
v_exp_f32 v38, v38
v_mfma_f32_16x16x32_bf16 v[116:119], a[212:215], v[48:51], v[116:119]
v_fmamk_f32 v39, v39, 0x3e0293ee, v24
v_cvt_pk_bf16_f32 v68, v36, v37
v_mfma_f32_16x16x32_bf16 v[120:123], a[216:219], v[48:51], v[120:123]
v_exp_f32 v39, v39
v_mfma_f32_16x16x32_bf16 v[124:127], a[220:223], v[48:51], v[124:127]
v_cvt_pk_bf16_f32 v69, v38, v39
v_fmamk_f32 v40, v40, 0x3e0293ee, v25
v_mfma_f32_16x16x32_bf16 a[232:235], a[244:247], v[56:59], a[232:235]
v_exp_f32 v40, v40
v_mfma_f32_16x16x32_bf16 v[36:39], a[160:163], a[64:67], 0
v_fmamk_f32 v41, v41, 0x3e0293ee, v25
v_fmamk_f32 v42, v42, 0x3e0293ee, v25
v_mfma_f32_16x16x32_bf16 v[36:39], a[164:167], a[68:71], v[36:39]
v_exp_f32 v41, v41
v_mfma_f32_16x16x32_bf16 v[36:39], a[168:171], a[72:75], v[36:39]
v_exp_f32 v42, v42
v_mfma_f32_16x16x32_bf16 v[36:39], a[172:175], a[76:79], v[36:39]
v_fmamk_f32 v43, v43, 0x3e0293ee, v25
v_cvt_pk_bf16_f32 v72, v40, v41
v_mfma_f32_16x16x32_bf16 v[144:147], a[208:211], v[52:55], v[144:147]
v_exp_f32 v43, v43
v_mfma_f32_16x16x32_bf16 v[148:151], a[212:215], v[52:55], v[148:151]
ds_read_b64_tr_b16 a[192:193], v6 offset:0
v_cvt_pk_bf16_f32 v73, v42, v43
v_mfma_f32_16x16x32_bf16 v[152:155], a[216:219], v[52:55], v[152:155]
ds_read_b64_tr_b16 a[194:195], v6 offset:4096
v_fmamk_f32 v32, v32, 0x3e0293ee, v26
v_mfma_f32_16x16x32_bf16 v[156:159], a[220:223], v[52:55], v[156:159]
v_exp_f32 v32, v32
v_mfma_f32_16x16x32_bf16 v[40:43], a[176:179], a[0:3], 0
ds_read_b64_tr_b16 a[196:197], v7 offset:0
v_fmamk_f32 v33, v33, 0x3e0293ee, v26
v_mfma_f32_16x16x32_bf16 v[40:43], a[180:183], a[4:7], v[40:43]
s_waitcnt lgkmcnt(3)
v_exp_f32 v33, v33
v_mfma_f32_16x16x32_bf16 v[40:43], a[184:187], a[8:11], v[40:43]
ds_read_b64_tr_b16 a[198:199], v7 offset:4096
v_fmamk_f32 v34, v34, 0x3e0293ee, v26
v_mfma_f32_16x16x32_bf16 v[40:43], a[188:191], a[12:15], v[40:43]
v_exp_f32 v34, v34
v_mfma_f32_16x16x32_bf16 v[176:179], a[208:211], v[56:59], v[176:179]
buffer_load_dwordx4 v14, s[20:23], s30 offen nt lds
v_fmamk_f32 v35, v35, 0x3e0293ee, v26
v_mfma_f32_16x16x32_bf16 v[180:183], a[212:215], v[56:59], v[180:183]
v_exp_f32 v35, v35
v_mfma_f32_16x16x32_bf16 v[184:187], a[216:219], v[56:59], v[184:187]
ds_read_b64_tr_b16 a[200:201], v8 offset:0
v_cvt_pk_bf16_f32 v76, v32, v33
v_mfma_f32_16x16x32_bf16 v[188:191], a[220:223], v[56:59], v[188:191]
ds_read_b64_tr_b16 a[202:203], v8 offset:4096
v_cvt_pk_bf16_f32 v77, v34, v35
v_mfma_f32_16x16x32_bf16 a[236:239], a[244:247], v[60:63], a[236:239]
ds_read_b64_tr_b16 a[204:205], v9 offset:0
v_fmamk_f32 v36, v36, 0x3e0293ee, v27
v_mfma_f32_16x16x32_bf16 v[32:35], a[176:179], a[16:19], 0
v_exp_f32 v36, v36
v_mfma_f32_16x16x32_bf16 v[32:35], a[180:183], a[20:23], v[32:35]
ds_read_b64_tr_b16 a[206:207], v9 offset:4096
v_fmamk_f32 v37, v37, 0x3e0293ee, v27
v_mfma_f32_16x16x32_bf16 v[32:35], a[184:187], a[24:27], v[32:35]
v_exp_f32 v37, v37
v_mfma_f32_16x16x32_bf16 v[32:35], a[188:191], a[28:31], v[32:35]
v_fmamk_f32 v38, v38, 0x3e0293ee, v27
v_fmamk_f32 v39, v39, 0x3e0293ee, v27
v_mfma_f32_16x16x32_bf16 v[208:211], a[208:211], v[60:63], v[208:211]
v_exp_f32 v38, v38
v_mfma_f32_16x16x32_bf16 v[212:215], a[212:215], v[60:63], v[212:215]
v_exp_f32 v39, v39
v_mfma_f32_16x16x32_bf16 v[216:219], a[216:219], v[60:63], v[216:219]
v_cvt_pk_bf16_f32 v48, v36, v37
v_cvt_pk_bf16_f32 v49, v38, v39
v_mfma_f32_16x16x32_bf16 v[220:223], a[220:223], v[60:63], v[220:223]
ds_read_b128 a[160:163], v44 offset:0
v_fmamk_f32 v40, v40, 0x3e0293ee, v23
v_mfma_f32_16x16x32_bf16 v[36:39], a[176:179], a[32:35], 0
v_exp_f32 v40, v40
v_mfma_f32_16x16x32_bf16 v[36:39], a[180:183], a[36:39], v[36:39]
ds_read_b128 a[164:167], v45 offset:0
v_fmamk_f32 v41, v41, 0x3e0293ee, v23
v_mfma_f32_16x16x32_bf16 v[36:39], a[184:187], a[40:43], v[36:39]
v_exp_f32 v41, v41
v_fmamk_f32 v42, v42, 0x3e0293ee, v23
v_fmamk_f32 v43, v43, 0x3e0293ee, v23
v_exp_f32 v42, v42
v_exp_f32 v43, v43
v_mfma_f32_16x16x32_bf16 v[36:39], a[188:191], a[44:47], v[36:39]
v_cvt_pk_bf16_f32 v66, v40, v41
v_cvt_pk_bf16_f32 v67, v42, v43
v_mfma_f32_16x16x32_bf16 v[40:43], a[176:179], a[48:51], 0
ds_read_b128 a[168:171], v46 offset:0
v_fmamk_f32 v32, v32, 0x3e0293ee, v24
v_mfma_f32_16x16x32_bf16 v[40:43], a[180:183], a[52:55], v[40:43]
v_exp_f32 v32, v32
v_mfma_f32_16x16x32_bf16 v[40:43], a[184:187], a[56:59], v[40:43]
ds_read_b128 a[172:175], v47 offset:0
v_fmamk_f32 v33, v33, 0x3e0293ee, v24
v_mfma_f32_16x16x32_bf16 v[40:43], a[188:191], a[60:63], v[40:43]
s_waitcnt lgkmcnt(3)
v_exp_f32 v33, v33
v_mfma_f32_16x16x32_bf16 v[96:99], a[192:195], v[64:67], v[96:99]
buffer_load_dwordx4 v15, s[20:23], s30 offen offset:1024 nt lds
v_fmamk_f32 v34, v34, 0x3e0293ee, v24
v_mfma_f32_16x16x32_bf16 v[100:103], a[196:199], v[64:67], v[100:103]
s_add_u32 m0, s32, 106496
v_exp_f32 v34, v34
v_mfma_f32_16x16x32_bf16 v[104:107], a[200:203], v[64:67], v[104:107]
s_add_u32 s30, s28, 114688
v_fmamk_f32 v35, v35, 0x3e0293ee, v24
v_cvt_pk_bf16_f32 v70, v32, v33
v_mfma_f32_16x16x32_bf16 v[108:111], a[204:207], v[64:67], v[108:111]
v_exp_f32 v35, v35
v_mfma_f32_16x16x32_bf16 a[224:227], a[244:247], v[64:67], a[224:227]
v_cvt_pk_bf16_f32 v71, v34, v35
v_fmamk_f32 v36, v36, 0x3e0293ee, v25
v_mfma_f32_16x16x32_bf16 v[32:35], a[176:179], a[64:67], 0
v_exp_f32 v36, v36
v_mfma_f32_16x16x32_bf16 v[32:35], a[180:183], a[68:71], v[32:35]
v_fmamk_f32 v37, v37, 0x3e0293ee, v25
v_fmamk_f32 v38, v38, 0x3e0293ee, v25
v_mfma_f32_16x16x32_bf16 v[32:35], a[184:187], a[72:75], v[32:35]
v_exp_f32 v37, v37
v_mfma_f32_16x16x32_bf16 v[32:35], a[188:191], a[76:79], v[32:35]
v_exp_f32 v38, v38
v_mfma_f32_16x16x32_bf16 v[128:131], a[192:195], v[68:71], v[128:131]
v_fmamk_f32 v39, v39, 0x3e0293ee, v25
v_cvt_pk_bf16_f32 v74, v36, v37
v_mfma_f32_16x16x32_bf16 v[132:135], a[196:199], v[68:71], v[132:135]
v_exp_f32 v39, v39
v_mfma_f32_16x16x32_bf16 v[136:139], a[200:203], v[68:71], v[136:139]
ds_read_b64_tr_b16 a[208:209], v10 offset:0
v_cvt_pk_bf16_f32 v75, v38, v39
v_mfma_f32_16x16x32_bf16 v[140:143], a[204:207], v[68:71], v[140:143]
ds_read_b64_tr_b16 a[210:211], v10 offset:4096
v_fmamk_f32 v40, v40, 0x3e0293ee, v26
v_mfma_f32_16x16x32_bf16 v[36:39], a[160:163], a[0:3], 0
s_waitcnt lgkmcnt(2)
v_exp_f32 v40, v40
v_mfma_f32_16x16x32_bf16 v[36:39], a[164:167], a[4:7], v[36:39]
ds_read_b64_tr_b16 a[212:213], v11 offset:0
v_fmamk_f32 v41, v41, 0x3e0293ee, v26
v_mfma_f32_16x16x32_bf16 v[36:39], a[168:171], a[8:11], v[36:39]
v_exp_f32 v41, v41
v_mfma_f32_16x16x32_bf16 v[36:39], a[172:175], a[12:15], v[36:39]
ds_read_b64_tr_b16 a[214:215], v11 offset:4096
v_fmamk_f32 v42, v42, 0x3e0293ee, v26
v_mfma_f32_16x16x32_bf16 v[160:163], a[192:195], v[72:75], v[160:163]
v_exp_f32 v42, v42
v_mfma_f32_16x16x32_bf16 v[164:167], a[196:199], v[72:75], v[164:167]
ds_read_b64_tr_b16 a[216:217], v12 offset:0
v_fmamk_f32 v43, v43, 0x3e0293ee, v26
v_mfma_f32_16x16x32_bf16 v[168:171], a[200:203], v[72:75], v[168:171]
v_exp_f32 v43, v43
v_mfma_f32_16x16x32_bf16 v[172:175], a[204:207], v[72:75], v[172:175]
ds_read_b64_tr_b16 a[218:219], v12 offset:4096
v_cvt_pk_bf16_f32 v78, v40, v41
v_mfma_f32_16x16x32_bf16 a[228:231], a[244:247], v[68:71], a[228:231]
v_cvt_pk_bf16_f32 v79, v42, v43
v_fmamk_f32 v32, v32, 0x3e0293ee, v27
v_mfma_f32_16x16x32_bf16 v[40:43], a[160:163], a[16:19], 0
v_exp_f32 v32, v32
v_mfma_f32_16x16x32_bf16 v[40:43], a[164:167], a[20:23], v[40:43]
buffer_load_dwordx4 v16, s[24:27], s31 offen nt lds
v_fmamk_f32 v33, v33, 0x3e0293ee, v27
v_mfma_f32_16x16x32_bf16 v[40:43], a[168:171], a[24:27], v[40:43]
v_exp_f32 v33, v33
v_mfma_f32_16x16x32_bf16 v[40:43], a[172:175], a[28:31], v[40:43]
ds_read_b64_tr_b16 a[220:221], v13 offset:0
v_fmamk_f32 v34, v34, 0x3e0293ee, v27
v_mfma_f32_16x16x32_bf16 v[192:195], a[192:195], v[76:79], v[192:195]
v_exp_f32 v34, v34
v_mfma_f32_16x16x32_bf16 v[196:199], a[196:199], v[76:79], v[196:199]
ds_read_b64_tr_b16 a[222:223], v13 offset:4096
v_fmamk_f32 v35, v35, 0x3e0293ee, v27
v_mfma_f32_16x16x32_bf16 v[200:203], a[200:203], v[76:79], v[200:203]
v_exp_f32 v35, v35
v_mfma_f32_16x16x32_bf16 v[204:207], a[204:207], v[76:79], v[204:207]
v_cvt_pk_bf16_f32 v50, v32, v33
v_cvt_pk_bf16_f32 v51, v34, v35
v_mfma_f32_16x16x32_bf16 v[32:35], a[160:163], a[32:35], 0
ds_read_b128 a[176:179], v44 offset:4096
v_fmamk_f32 v36, v36, 0x3e0293ee, v23
v_mfma_f32_16x16x32_bf16 v[32:35], a[164:167], a[36:39], v[32:35]
v_exp_f32 v36, v36
v_mfma_f32_16x16x32_bf16 v[32:35], a[168:171], a[40:43], v[32:35]
ds_read_b128 a[180:183], v45 offset:4096
v_fmamk_f32 v37, v37, 0x3e0293ee, v23
v_mfma_f32_16x16x32_bf16 v[32:35], a[172:175], a[44:47], v[32:35]
v_exp_f32 v37, v37
v_mfma_f32_16x16x32_bf16 v[224:227], a[192:195], v[48:51], v[224:227]
ds_read_b128 a[184:187], v46 offset:4096
v_fmamk_f32 v38, v38, 0x3e0293ee, v23
v_mfma_f32_16x16x32_bf16 v[228:231], a[196:199], v[48:51], v[228:231]
v_exp_f32 v38, v38
v_mfma_f32_16x16x32_bf16 v[232:235], a[200:203], v[48:51], v[232:235]
ds_read_b128 a[188:191], v47 offset:4096
v_fmamk_f32 v39, v39, 0x3e0293ee, v23
v_mfma_f32_16x16x32_bf16 v[236:239], a[204:207], v[48:51], v[236:239]
v_exp_f32 v39, v39
v_mfma_f32_16x16x32_bf16 a[232:235], a[244:247], v[72:75], a[232:235]
s_waitcnt lgkmcnt(3)
v_cvt_pk_bf16_f32 v52, v36, v37
v_cvt_pk_bf16_f32 v53, v38, v39
v_mfma_f32_16x16x32_bf16 v[112:115], a[208:211], v[64:67], v[112:115]
v_fmamk_f32 v40, v40, 0x3e0293ee, v24
v_fmamk_f32 v41, v41, 0x3e0293ee, v24
v_mfma_f32_16x16x32_bf16 v[116:119], a[212:215], v[64:67], v[116:119]
v_exp_f32 v40, v40
v_mfma_f32_16x16x32_bf16 v[120:123], a[216:219], v[64:67], v[120:123]
v_exp_f32 v41, v41
v_mfma_f32_16x16x32_bf16 v[124:127], a[220:223], v[64:67], v[124:127]
buffer_load_dwordx4 v17, s[24:27], s31 offen offset:1024 nt lds
buffer_load_dwordx4 a[116:119], v28, s[8:11], 0 offen offset:64
v_mfma_f32_16x16x32_bf16 v[36:39], a[160:163], a[48:51], 0
s_add_u32 m0, s32, 49152
v_fmamk_f32 v42, v42, 0x3e0293ee, v24
v_fmamk_f32 v43, v43, 0x3e0293ee, v24
v_mfma_f32_16x16x32_bf16 v[36:39], a[164:167], a[52:55], v[36:39]
s_add_u32 s31, s28, 114688
v_exp_f32 v42, v42
v_mfma_f32_16x16x32_bf16 v[36:39], a[168:171], a[56:59], v[36:39]
v_exp_f32 v43, v43
v_mfma_f32_16x16x32_bf16 v[36:39], a[172:175], a[60:63], v[36:39]
v_cvt_pk_bf16_f32 v56, v40, v41
v_cvt_pk_bf16_f32 v57, v42, v43
v_mfma_f32_16x16x32_bf16 v[144:147], a[208:211], v[68:71], v[144:147]
buffer_load_dwordx4 a[120:123], v28, s[8:11], 0 offen offset:128
v_fmamk_f32 v32, v32, 0x3e0293ee, v25
v_mfma_f32_16x16x32_bf16 v[148:151], a[212:215], v[68:71], v[148:151]
v_exp_f32 v32, v32
v_mfma_f32_16x16x32_bf16 v[152:155], a[216:219], v[68:71], v[152:155]
v_fmamk_f32 v33, v33, 0x3e0293ee, v25
v_fmamk_f32 v34, v34, 0x3e0293ee, v25
v_mfma_f32_16x16x32_bf16 v[156:159], a[220:223], v[68:71], v[156:159]
v_exp_f32 v33, v33
v_mfma_f32_16x16x32_bf16 a[236:239], a[244:247], v[76:79], a[236:239]
s_waitcnt vmcnt(13) lgkmcnt(0)
v_exp_f32 v34, v34
v_mfma_f32_16x16x32_bf16 v[40:43], a[176:179], a[0:3], 0
s_barrier
v_fmamk_f32 v35, v35, 0x3e0293ee, v25
v_cvt_pk_bf16_f32 v60, v32, v33
v_mfma_f32_16x16x32_bf16 v[40:43], a[180:183], a[4:7], v[40:43]
v_exp_f32 v35, v35
v_mfma_f32_16x16x32_bf16 v[40:43], a[184:187], a[8:11], v[40:43]
ds_read_b64_tr_b16 a[192:193], v80 offset:0
v_cvt_pk_bf16_f32 v61, v34, v35
v_mfma_f32_16x16x32_bf16 v[40:43], a[188:191], a[12:15], v[40:43]
ds_read_b64_tr_b16 a[194:195], v80 offset:4096
v_fmamk_f32 v36, v36, 0x3e0293ee, v26
v_mfma_f32_16x16x32_bf16 v[176:179], a[208:211], v[72:75], v[176:179]
v_exp_f32 v36, v36
v_mfma_f32_16x16x32_bf16 v[180:183], a[212:215], v[72:75], v[180:183]
buffer_load_dwordx4 v14, s[20:23], s30 offen nt lds
v_fmamk_f32 v37, v37, 0x3e0293ee, v26
v_mfma_f32_16x16x32_bf16 v[184:187], a[216:219], v[72:75], v[184:187]
v_exp_f32 v37, v37
v_mfma_f32_16x16x32_bf16 v[188:191], a[220:223], v[72:75], v[188:191]
ds_read_b64_tr_b16 a[196:197], v81 offset:0
v_fmamk_f32 v38, v38, 0x3e0293ee, v26
v_mfma_f32_16x16x32_bf16 v[32:35], a[176:179], a[16:19], 0
v_exp_f32 v38, v38
v_mfma_f32_16x16x32_bf16 v[32:35], a[180:183], a[20:23], v[32:35]
ds_read_b64_tr_b16 a[198:199], v81 offset:4096
v_fmamk_f32 v39, v39, 0x3e0293ee, v26
v_mfma_f32_16x16x32_bf16 v[32:35], a[184:187], a[24:27], v[32:35]
v_exp_f32 v39, v39
v_mfma_f32_16x16x32_bf16 v[32:35], a[188:191], a[28:31], v[32:35]
ds_read_b64_tr_b16 a[200:201], v82 offset:0
v_cvt_pk_bf16_f32 v64, v36, v37
v_mfma_f32_16x16x32_bf16 v[208:211], a[208:211], v[76:79], v[208:211]
ds_read_b64_tr_b16 a[202:203], v82 offset:4096
v_cvt_pk_bf16_f32 v65, v38, v39
v_mfma_f32_16x16x32_bf16 v[212:215], a[212:215], v[76:79], v[212:215]
ds_read_b64_tr_b16 a[204:205], v83 offset:0
v_fmamk_f32 v40, v40, 0x3e0293ee, v23
v_mfma_f32_16x16x32_bf16 v[216:219], a[216:219], v[76:79], v[216:219]
v_exp_f32 v40, v40
v_mfma_f32_16x16x32_bf16 v[220:223], a[220:223], v[76:79], v[220:223]
ds_read_b64_tr_b16 a[206:207], v83 offset:4096
v_fmamk_f32 v41, v41, 0x3e0293ee, v23
v_mfma_f32_16x16x32_bf16 a[240:243], a[244:247], v[48:51], a[240:243]
v_exp_f32 v41, v41
v_mfma_f32_16x16x32_bf16 v[36:39], a[176:179], a[32:35], 0
ds_read_b128 a[160:163], v2 offset:16384
v_fmamk_f32 v42, v42, 0x3e0293ee, v23
v_mfma_f32_16x16x32_bf16 v[36:39], a[180:183], a[36:39], v[36:39]
v_exp_f32 v42, v42
v_mfma_f32_16x16x32_bf16 v[36:39], a[184:187], a[40:43], v[36:39]
ds_read_b128 a[164:167], v3 offset:16384
v_fmamk_f32 v43, v43, 0x3e0293ee, v23
v_mfma_f32_16x16x32_bf16 v[36:39], a[188:191], a[44:47], v[36:39]
v_exp_f32 v43, v43
v_mfma_f32_16x16x32_bf16 v[240:243], a[208:211], v[48:51], v[240:243]
ds_read_b128 a[168:171], v4 offset:16384
v_cvt_pk_bf16_f32 v54, v40, v41
v_mfma_f32_16x16x32_bf16 v[244:247], a[212:215], v[48:51], v[244:247]
ds_read_b128 a[172:175], v5 offset:16384
v_cvt_pk_bf16_f32 v55, v42, v43
v_mfma_f32_16x16x32_bf16 v[248:251], a[216:219], v[48:51], v[248:251]
buffer_load_dwordx4 v15, s[20:23], s30 offen offset:1024 nt lds
v_fmamk_f32 v32, v32, 0x3e0293ee, v24
v_mfma_f32_16x16x32_bf16 v[252:255], a[220:223], v[48:51], v[252:255]
s_add_u32 m0, s32, 114688
v_exp_f32 v32, v32
v_mfma_f32_16x16x32_bf16 v[40:43], a[176:179], a[48:51], 0
s_add_u32 s30, s28, 122880
v_fmamk_f32 v33, v33, 0x3e0293ee, v24
v_fmamk_f32 v34, v34, 0x3e0293ee, v24
v_mfma_f32_16x16x32_bf16 v[40:43], a[180:183], a[52:55], v[40:43]
v_exp_f32 v33, v33
v_mfma_f32_16x16x32_bf16 v[40:43], a[184:187], a[56:59], v[40:43]
v_exp_f32 v34, v34
v_mfma_f32_16x16x32_bf16 v[40:43], a[188:191], a[60:63], v[40:43]
s_waitcnt lgkmcnt(2)
v_fmamk_f32 v35, v35, 0x3e0293ee, v24
v_cvt_pk_bf16_f32 v58, v32, v33
v_mfma_f32_16x16x32_bf16 v[96:99], a[192:195], v[52:55], v[96:99]
v_exp_f32 v35, v35
v_mfma_f32_16x16x32_bf16 v[100:103], a[196:199], v[52:55], v[100:103]
v_cvt_pk_bf16_f32 v59, v34, v35
v_fmamk_f32 v36, v36, 0x3e0293ee, v25
v_mfma_f32_16x16x32_bf16 v[104:107], a[200:203], v[52:55], v[104:107]
v_exp_f32 v36, v36
v_mfma_f32_16x16x32_bf16 v[108:111], a[204:207], v[52:55], v[108:111]
v_fmamk_f32 v37, v37, 0x3e0293ee, v25
v_fmamk_f32 v38, v38, 0x3e0293ee, v25
v_mfma_f32_16x16x32_bf16 a[224:227], a[244:247], v[52:55], a[224:227]
v_exp_f32 v37, v37
v_mfma_f32_16x16x32_bf16 v[32:35], a[160:163], a[0:3], 0
v_exp_f32 v38, v38
v_mfma_f32_16x16x32_bf16 v[32:35], a[164:167], a[4:7], v[32:35]
s_waitcnt lgkmcnt(0)
v_fmamk_f32 v39, v39, 0x3e0293ee, v25
v_cvt_pk_bf16_f32 v62, v36, v37
v_mfma_f32_16x16x32_bf16 v[32:35], a[168:171], a[8:11], v[32:35]
v_exp_f32 v39, v39
v_mfma_f32_16x16x32_bf16 v[32:35], a[172:175], a[12:15], v[32:35]
ds_read_b64_tr_b16 a[208:209], v84 offset:0
v_cvt_pk_bf16_f32 v63, v38, v39
v_mfma_f32_16x16x32_bf16 v[128:131], a[192:195], v[56:59], v[128:131]
buffer_load_dwordx4 v16, s[24:27], s31 offen nt lds
v_fmamk_f32 v40, v40, 0x3e0293ee, v26
v_mfma_f32_16x16x32_bf16 v[132:135], a[196:199], v[56:59], v[132:135]
v_exp_f32 v40, v40
v_mfma_f32_16x16x32_bf16 v[136:139], a[200:203], v[56:59], v[136:139]
ds_read_b64_tr_b16 a[210:211], v84 offset:4096
v_fmamk_f32 v41, v41, 0x3e0293ee, v26
v_mfma_f32_16x16x32_bf16 v[140:143], a[204:207], v[56:59], v[140:143]
v_exp_f32 v41, v41
v_mfma_f32_16x16x32_bf16 v[36:39], a[160:163], a[16:19], 0
ds_read_b64_tr_b16 a[212:213], v85 offset:0
v_fmamk_f32 v42, v42, 0x3e0293ee, v26
v_mfma_f32_16x16x32_bf16 v[36:39], a[164:167], a[20:23], v[36:39]
v_exp_f32 v42, v42
v_mfma_f32_16x16x32_bf16 v[36:39], a[168:171], a[24:27], v[36:39]
ds_read_b64_tr_b16 a[214:215], v85 offset:4096
v_fmamk_f32 v43, v43, 0x3e0293ee, v26
v_mfma_f32_16x16x32_bf16 v[36:39], a[172:175], a[28:31], v[36:39]
v_exp_f32 v43, v43
v_mfma_f32_16x16x32_bf16 v[160:163], a[192:195], v[60:63], v[160:163]
ds_read_b64_tr_b16 a[216:217], v86 offset:0
v_cvt_pk_bf16_f32 v66, v40, v41
v_mfma_f32_16x16x32_bf16 v[164:167], a[196:199], v[60:63], v[164:167]
ds_read_b64_tr_b16 a[218:219], v86 offset:4096
v_cvt_pk_bf16_f32 v67, v42, v43
v_mfma_f32_16x16x32_bf16 v[168:171], a[200:203], v[60:63], v[168:171]
ds_read_b64_tr_b16 a[220:221], v87 offset:0
v_fmamk_f32 v32, v32, 0x3e0293ee, v23
v_mfma_f32_16x16x32_bf16 v[172:175], a[204:207], v[60:63], v[172:175]
v_exp_f32 v32, v32
v_mfma_f32_16x16x32_bf16 a[228:231], a[244:247], v[56:59], a[228:231]
ds_read_b64_tr_b16 a[222:223], v87 offset:4096
v_fmamk_f32 v33, v33, 0x3e0293ee, v23
v_mfma_f32_16x16x32_bf16 v[40:43], a[160:163], a[32:35], 0
v_exp_f32 v33, v33
v_mfma_f32_16x16x32_bf16 v[40:43], a[164:167], a[36:39], v[40:43]
ds_read_b128 a[176:179], v2 offset:20480
v_fmamk_f32 v34, v34, 0x3e0293ee, v23
v_mfma_f32_16x16x32_bf16 v[40:43], a[168:171], a[40:43], v[40:43]
v_exp_f32 v34, v34
v_mfma_f32_16x16x32_bf16 v[40:43], a[172:175], a[44:47], v[40:43]
ds_read_b128 a[180:183], v3 offset:20480
v_fmamk_f32 v35, v35, 0x3e0293ee, v23
v_mfma_f32_16x16x32_bf16 v[192:195], a[192:195], v[64:67], v[192:195]
buffer_load_dwordx4 v17, s[24:27], s31 offen offset:1024 nt lds
v_cvt_pk_bf16_f32 v68, v32, v33
v_mfma_f32_16x16x32_bf16 v[196:199], a[196:199], v[64:67], v[196:199]
s_add_u32 m0, s32, 57344
buffer_load_dwordx4 a[124:127], v28, s[8:11], 0 offen offset:192
v_fmamk_f32 v36, v36, 0x3e0293ee, v24
v_mfma_f32_16x16x32_bf16 v[200:203], a[200:203], v[64:67], v[200:203]
s_add_u32 s31, s28, 122880
v_exp_f32 v35, v35
v_mfma_f32_16x16x32_bf16 v[204:207], a[204:207], v[64:67], v[204:207]
L_pad1_4:
s_cbranch_execz L_pad1_8
v_cvt_pk_bf16_f32 v69, v34, v35
v_fmamk_f32 v37, v37, 0x3e0293ee, v24
v_mfma_f32_16x16x32_bf16 v[32:35], a[160:163], a[48:51], 0
v_exp_f32 v36, v36
v_mfma_f32_16x16x32_bf16 v[32:35], a[164:167], a[52:55], v[32:35]
v_exp_f32 v37, v37
v_mfma_f32_16x16x32_bf16 v[32:35], a[168:171], a[56:59], v[32:35]
ds_read_b128 a[184:187], v4 offset:20480
v_fmamk_f32 v38, v38, 0x3e0293ee, v24
v_mfma_f32_16x16x32_bf16 v[32:35], a[172:175], a[60:63], v[32:35]
s_waitcnt lgkmcnt(1)
v_exp_f32 v38, v38
v_mfma_f32_16x16x32_bf16 v[112:115], a[208:211], v[52:55], v[112:115]
ds_read_b128 a[188:191], v5 offset:20480
v_fmamk_f32 v39, v39, 0x3e0293ee, v24
v_mfma_f32_16x16x32_bf16 v[116:119], a[212:215], v[52:55], v[116:119]
v_exp_f32 v39, v39
v_mfma_f32_16x16x32_bf16 v[120:123], a[216:219], v[52:55], v[120:123]
v_cvt_pk_bf16_f32 v72, v36, v37
v_cvt_pk_bf16_f32 v73, v38, v39
v_mfma_f32_16x16x32_bf16 v[124:127], a[220:223], v[52:55], v[124:127]
v_fmamk_f32 v40, v40, 0x3e0293ee, v25
v_fmamk_f32 v41, v41, 0x3e0293ee, v25
v_mfma_f32_16x16x32_bf16 a[232:235], a[244:247], v[60:63], a[232:235]
v_exp_f32 v40, v40
v_mfma_f32_16x16x32_bf16 v[36:39], a[160:163], a[64:67], 0
v_exp_f32 v41, v41
v_mfma_f32_16x16x32_bf16 v[36:39], a[164:167], a[68:71], v[36:39]
v_fmamk_f32 v42, v42, 0x3e0293ee, v25
v_fmamk_f32 v43, v43, 0x3e0293ee, v25
v_mfma_f32_16x16x32_bf16 v[36:39], a[168:171], a[72:75], v[36:39]
v_exp_f32 v42, v42
v_mfma_f32_16x16x32_bf16 v[36:39], a[172:175], a[76:79], v[36:39]
v_exp_f32 v43, v43
v_mfma_f32_16x16x32_bf16 v[144:147], a[208:211], v[56:59], v[144:147]
v_cvt_pk_bf16_f32 v76, v40, v41
v_cvt_pk_bf16_f32 v77, v42, v43
v_mfma_f32_16x16x32_bf16 v[148:151], a[212:215], v[56:59], v[148:151]
ds_read_b64_tr_b16 a[192:193], v6 offset:16384
v_fmamk_f32 v32, v32, 0x3e0293ee, v26
v_mfma_f32_16x16x32_bf16 v[152:155], a[216:219], v[56:59], v[152:155]
v_exp_f32 v32, v32
v_mfma_f32_16x16x32_bf16 v[156:159], a[220:223], v[56:59], v[156:159]
ds_read_b64_tr_b16 a[194:195], v6 offset:20480
v_fmamk_f32 v33, v33, 0x3e0293ee, v26
v_mfma_f32_16x16x32_bf16 v[40:43], a[176:179], a[0:3], 0
v_exp_f32 v33, v33
v_mfma_f32_16x16x32_bf16 v[40:43], a[180:183], a[4:7], v[40:43]
s_waitcnt lgkmcnt(2)
ds_read_b64_tr_b16 a[196:197], v7 offset:16384
v_fmamk_f32 v34, v34, 0x3e0293ee, v26
v_mfma_f32_16x16x32_bf16 v[40:43], a[184:187], a[8:11], v[40:43]
v_exp_f32 v34, v34
v_mfma_f32_16x16x32_bf16 v[40:43], a[188:191], a[12:15], v[40:43]
ds_read_b64_tr_b16 a[198:199], v7 offset:20480
v_fmamk_f32 v35, v35, 0x3e0293ee, v26
v_mfma_f32_16x16x32_bf16 v[176:179], a[208:211], v[60:63], v[176:179]
v_exp_f32 v35, v35
v_mfma_f32_16x16x32_bf16 v[180:183], a[212:215], v[60:63], v[180:183]
buffer_load_dwordx4 v14, s[20:23], s30 offen nt lds
v_cvt_pk_bf16_f32 v48, v32, v33
v_mfma_f32_16x16x32_bf16 v[184:187], a[216:219], v[60:63], v[184:187]
ds_read_b64_tr_b16 a[200:201], v8 offset:16384
v_cvt_pk_bf16_f32 v49, v34, v35
v_mfma_f32_16x16x32_bf16 v[188:191], a[220:223], v[60:63], v[188:191]
ds_read_b64_tr_b16 a[202:203], v8 offset:20480
v_fmamk_f32 v36, v36, 0x3e0293ee, v27
v_mfma_f32_16x16x32_bf16 a[236:239], a[244:247], v[64:67], a[236:239]
v_exp_f32 v36, v36
v_mfma_f32_16x16x32_bf16 v[32:35], a[176:179], a[16:19], 0
ds_read_b64_tr_b16 a[204:205], v9 offset:16384
v_fmamk_f32 v37, v37, 0x3e0293ee, v27
v_mfma_f32_16x16x32_bf16 v[32:35], a[180:183], a[20:23], v[32:35]
v_exp_f32 v37, v37
v_mfma_f32_16x16x32_bf16 v[32:35], a[184:187], a[24:27], v[32:35]
ds_read_b64_tr_b16 a[206:207], v9 offset:20480
v_fmamk_f32 v38, v38, 0x3e0293ee, v27
v_mfma_f32_16x16x32_bf16 v[32:35], a[188:191], a[28:31], v[32:35]
v_exp_f32 v38, v38
v_mfma_f32_16x16x32_bf16 v[208:211], a[208:211], v[64:67], v[208:211]
v_fmamk_f32 v39, v39, 0x3e0293ee, v27
v_cvt_pk_bf16_f32 v52, v36, v37
v_mfma_f32_16x16x32_bf16 v[212:215], a[212:215], v[64:67], v[212:215]
v_exp_f32 v39, v39
v_mfma_f32_16x16x32_bf16 v[216:219], a[216:219], v[64:67], v[216:219]
ds_read_b128 a[160:163], v44 offset:16384
v_cvt_pk_bf16_f32 v53, v38, v39
v_mfma_f32_16x16x32_bf16 v[220:223], a[220:223], v[64:67], v[220:223]
ds_read_b128 a[164:167], v45 offset:16384
v_fmamk_f32 v40, v40, 0x3e0293ee, v23
v_mfma_f32_16x16x32_bf16 v[36:39], a[176:179], a[32:35], 0
v_exp_f32 v40, v40
v_mfma_f32_16x16x32_bf16 v[36:39], a[180:183], a[36:39], v[36:39]
v_fmamk_f32 v41, v41, 0x3e0293ee, v23
v_fmamk_f32 v42, v42, 0x3e0293ee, v23
v_mfma_f32_16x16x32_bf16 v[36:39], a[184:187], a[40:43], v[36:39]
v_exp_f32 v41, v41
v_exp_f32 v42, v42
v_fmamk_f32 v43, v43, 0x3e0293ee, v23
v_exp_f32 v43, v43
v_mfma_f32_16x16x32_bf16 v[36:39], a[188:191], a[44:47], v[36:39]
v_cvt_pk_bf16_f32 v70, v40, v41
v_cvt_pk_bf16_f32 v71, v42, v43
v_mfma_f32_16x16x32_bf16 v[40:43], a[176:179], a[48:51], 0
ds_read_b128 a[168:171], v46 offset:16384
v_fmamk_f32 v32, v32, 0x3e0293ee, v24
v_mfma_f32_16x16x32_bf16 v[40:43], a[180:183], a[52:55], v[40:43]
v_exp_f32 v32, v32
v_mfma_f32_16x16x32_bf16 v[40:43], a[184:187], a[56:59], v[40:43]
ds_read_b128 a[172:175], v47 offset:16384
v_fmamk_f32 v33, v33, 0x3e0293ee, v24
v_mfma_f32_16x16x32_bf16 v[40:43], a[188:191], a[60:63], v[40:43]
s_waitcnt lgkmcnt(2)
v_exp_f32 v33, v33
v_mfma_f32_16x16x32_bf16 v[96:99], a[192:195], v[68:71], v[96:99]
buffer_load_dwordx4 v15, s[20:23], s30 offen offset:1024 nt lds
v_fmamk_f32 v34, v34, 0x3e0293ee, v24
v_mfma_f32_16x16x32_bf16 v[100:103], a[196:199], v[68:71], v[100:103]
s_add_u32 m0, s32, 122880
v_exp_f32 v34, v34
v_mfma_f32_16x16x32_bf16 v[104:107], a[200:203], v[68:71], v[104:107]
s_add_u32 s30, s29, 0
v_fmamk_f32 v35, v35, 0x3e0293ee, v24
v_cvt_pk_bf16_f32 v74, v32, v33
v_mfma_f32_16x16x32_bf16 v[108:111], a[204:207], v[68:71], v[108:111]
v_exp_f32 v35, v35
v_mfma_f32_16x16x32_bf16 a[224:227], a[244:247], v[68:71], a[224:227]
v_cvt_pk_bf16_f32 v75, v34, v35
v_fmamk_f32 v36, v36, 0x3e0293ee, v25
v_mfma_f32_16x16x32_bf16 v[32:35], a[176:179], a[64:67], 0
v_exp_f32 v36, v36
v_mfma_f32_16x16x32_bf16 v[32:35], a[180:183], a[68:71], v[32:35]
v_fmamk_f32 v37, v37, 0x3e0293ee, v25
v_fmamk_f32 v38, v38, 0x3e0293ee, v25
v_mfma_f32_16x16x32_bf16 v[32:35], a[184:187], a[72:75], v[32:35]
v_exp_f32 v37, v37
v_mfma_f32_16x16x32_bf16 v[32:35], a[188:191], a[76:79], v[32:35]
v_exp_f32 v38, v38
v_mfma_f32_16x16x32_bf16 v[128:131], a[192:195], v[72:75], v[128:131]
v_fmamk_f32 v39, v39, 0x3e0293ee, v25
v_cvt_pk_bf16_f32 v78, v36, v37
v_mfma_f32_16x16x32_bf16 v[132:135], a[196:199], v[72:75], v[132:135]
v_exp_f32 v39, v39
v_mfma_f32_16x16x32_bf16 v[136:139], a[200:203], v[72:75], v[136:139]
ds_read_b64_tr_b16 a[208:209], v10 offset:16384
v_cvt_pk_bf16_f32 v79, v38, v39
v_mfma_f32_16x16x32_bf16 v[140:143], a[204:207], v[72:75], v[140:143]
ds_read_b64_tr_b16 a[210:211], v10 offset:20480
v_fmamk_f32 v40, v40, 0x3e0293ee, v26
v_mfma_f32_16x16x32_bf16 v[36:39], a[160:163], a[0:3], 0
v_exp_f32 v40, v40
v_mfma_f32_16x16x32_bf16 v[36:39], a[164:167], a[4:7], v[36:39]
s_waitcnt lgkmcnt(2)
ds_read_b64_tr_b16 a[212:213], v11 offset:16384
v_fmamk_f32 v41, v41, 0x3e0293ee, v26
v_mfma_f32_16x16x32_bf16 v[36:39], a[168:171], a[8:11], v[36:39]
v_exp_f32 v41, v41
v_mfma_f32_16x16x32_bf16 v[36:39], a[172:175], a[12:15], v[36:39]
ds_read_b64_tr_b16 a[214:215], v11 offset:20480
v_fmamk_f32 v42, v42, 0x3e0293ee, v26
v_mfma_f32_16x16x32_bf16 v[160:163], a[192:195], v[76:79], v[160:163]
v_exp_f32 v42, v42
v_mfma_f32_16x16x32_bf16 v[164:167], a[196:199], v[76:79], v[164:167]
ds_read_b64_tr_b16 a[216:217], v12 offset:16384
v_fmamk_f32 v43, v43, 0x3e0293ee, v26
v_mfma_f32_16x16x32_bf16 v[168:171], a[200:203], v[76:79], v[168:171]
v_exp_f32 v43, v43
v_mfma_f32_16x16x32_bf16 v[172:175], a[204:207], v[76:79], v[172:175]
ds_read_b64_tr_b16 a[218:219], v12 offset:20480
v_cvt_pk_bf16_f32 v50, v40, v41
v_mfma_f32_16x16x32_bf16 a[228:231], a[244:247], v[72:75], a[228:231]
v_cvt_pk_bf16_f32 v51, v42, v43
v_fmamk_f32 v32, v32, 0x3e0293ee, v27
v_mfma_f32_16x16x32_bf16 v[40:43], a[160:163], a[16:19], 0
v_exp_f32 v32, v32
v_mfma_f32_16x16x32_bf16 v[40:43], a[164:167], a[20:23], v[40:43]
buffer_load_dwordx4 v16, s[24:27], s31 offen nt lds
v_fmamk_f32 v33, v33, 0x3e0293ee, v27
v_mfma_f32_16x16x32_bf16 v[40:43], a[168:171], a[24:27], v[40:43]
v_exp_f32 v33, v33
v_mfma_f32_16x16x32_bf16 v[40:43], a[172:175], a[28:31], v[40:43]
ds_read_b64_tr_b16 a[220:221], v13 offset:16384
v_fmamk_f32 v34, v34, 0x3e0293ee, v27
v_mfma_f32_16x16x32_bf16 v[192:195], a[192:195], v[48:51], v[192:195]
v_exp_f32 v34, v34
v_mfma_f32_16x16x32_bf16 v[196:199], a[196:199], v[48:51], v[196:199]
ds_read_b64_tr_b16 a[222:223], v13 offset:20480
v_fmamk_f32 v35, v35, 0x3e0293ee, v27
v_mfma_f32_16x16x32_bf16 v[200:203], a[200:203], v[48:51], v[200:203]
v_exp_f32 v35, v35
v_mfma_f32_16x16x32_bf16 v[204:207], a[204:207], v[48:51], v[204:207]
v_cvt_pk_bf16_f32 v54, v32, v33
v_cvt_pk_bf16_f32 v55, v34, v35
v_mfma_f32_16x16x32_bf16 v[32:35], a[160:163], a[32:35], 0
ds_read_b128 a[176:179], v44 offset:20480
v_add_u32 v28, s38, v18
v_mfma_f32_16x16x32_bf16 v[32:35], a[164:167], a[36:39], v[32:35]
s_mov_b32 s38, s73
ds_read_b128 a[180:183], v45 offset:20480
v_fmamk_f32 v36, v36, 0x3e0293ee, v23
v_mfma_f32_16x16x32_bf16 v[32:35], a[168:171], a[40:43], v[32:35]
v_exp_f32 v36, v36
v_mfma_f32_16x16x32_bf16 v[32:35], a[172:175], a[44:47], v[32:35]
ds_read_b128 a[184:187], v46 offset:20480
v_fmamk_f32 v37, v37, 0x3e0293ee, v23
v_mfma_f32_16x16x32_bf16 v[224:227], a[192:195], v[52:55], v[224:227]
v_exp_f32 v37, v37
v_mfma_f32_16x16x32_bf16 v[228:231], a[196:199], v[52:55], v[228:231]
ds_read_b128 a[188:191], v47 offset:20480
v_fmamk_f32 v38, v38, 0x3e0293ee, v23
v_mfma_f32_16x16x32_bf16 v[232:235], a[200:203], v[52:55], v[232:235]
v_exp_f32 v38, v38
v_mfma_f32_16x16x32_bf16 v[236:239], a[204:207], v[52:55], v[236:239]
v_fmamk_f32 v39, v39, 0x3e0293ee, v23
v_cvt_pk_bf16_f32 v56, v36, v37
v_mfma_f32_16x16x32_bf16 a[232:235], a[244:247], v[76:79], a[232:235]
s_waitcnt lgkmcnt(3)
v_exp_f32 v39, v39
v_mfma_f32_16x16x32_bf16 v[112:115], a[208:211], v[68:71], v[112:115]
v_cvt_pk_bf16_f32 v57, v38, v39
v_fmamk_f32 v40, v40, 0x3e0293ee, v24
v_mfma_f32_16x16x32_bf16 v[116:119], a[212:215], v[68:71], v[116:119]
v_exp_f32 v40, v40
v_mfma_f32_16x16x32_bf16 v[120:123], a[216:219], v[68:71], v[120:123]
v_fmamk_f32 v41, v41, 0x3e0293ee, v24
v_fmamk_f32 v42, v42, 0x3e0293ee, v24
v_mfma_f32_16x16x32_bf16 v[124:127], a[220:223], v[68:71], v[124:127]
buffer_load_dwordx4 v17, s[24:27], s31 offen offset:1024 nt lds
buffer_load_dwordx4 a[128:131], v28, s[8:11], 0 offen offset:0
v_mfma_f32_16x16x32_bf16 v[36:39], a[160:163], a[48:51], 0
s_add_u32 m0, s32, 0
v_exp_f32 v41, v41
v_mfma_f32_16x16x32_bf16 v[36:39], a[164:167], a[52:55], v[36:39]
s_add_u32 s31, s29, 0
v_exp_f32 v42, v42
v_mfma_f32_16x16x32_bf16 v[36:39], a[168:171], a[56:59], v[36:39]
v_fmamk_f32 v43, v43, 0x3e0293ee, v24
v_cvt_pk_bf16_f32 v60, v40, v41
v_mfma_f32_16x16x32_bf16 v[36:39], a[172:175], a[60:63], v[36:39]
v_exp_f32 v43, v43
v_mfma_f32_16x16x32_bf16 v[144:147], a[208:211], v[72:75], v[144:147]
buffer_load_dwordx4 a[132:135], v28, s[8:11], 0 offen offset:64
v_cvt_pk_bf16_f32 v61, v42, v43
v_mfma_f32_16x16x32_bf16 v[148:151], a[212:215], v[72:75], v[148:151]
v_fmamk_f32 v32, v32, 0x3e0293ee, v25
v_fmamk_f32 v33, v33, 0x3e0293ee, v25
v_mfma_f32_16x16x32_bf16 v[152:155], a[216:219], v[72:75], v[152:155]
v_exp_f32 v32, v32
v_mfma_f32_16x16x32_bf16 v[156:159], a[220:223], v[72:75], v[156:159]
v_exp_f32 v33, v33
v_mfma_f32_16x16x32_bf16 a[236:239], a[244:247], v[48:51], a[236:239]
s_waitcnt vmcnt(13) lgkmcnt(0)
v_fmamk_f32 v34, v34, 0x3e0293ee, v25
v_fmamk_f32 v35, v35, 0x3e0293ee, v25
v_mfma_f32_16x16x32_bf16 v[40:43], a[176:179], a[0:3], 0
s_barrier
v_exp_f32 v34, v34
v_mfma_f32_16x16x32_bf16 v[40:43], a[180:183], a[4:7], v[40:43]
v_exp_f32 v35, v35
v_mfma_f32_16x16x32_bf16 v[40:43], a[184:187], a[8:11], v[40:43]
v_cvt_pk_bf16_f32 v64, v32, v33
v_cvt_pk_bf16_f32 v65, v34, v35
v_mfma_f32_16x16x32_bf16 v[40:43], a[188:191], a[12:15], v[40:43]
ds_read_b64_tr_b16 a[192:193], v80 offset:16384
v_fmamk_f32 v36, v36, 0x3e0293ee, v26
v_mfma_f32_16x16x32_bf16 v[176:179], a[208:211], v[76:79], v[176:179]
v_exp_f32 v36, v36
v_mfma_f32_16x16x32_bf16 v[180:183], a[212:215], v[76:79], v[180:183]
buffer_load_dwordx4 v14, s[20:23], s30 offen nt lds
v_fmamk_f32 v37, v37, 0x3e0293ee, v26
v_mfma_f32_16x16x32_bf16 v[184:187], a[216:219], v[76:79], v[184:187]
v_exp_f32 v37, v37
v_mfma_f32_16x16x32_bf16 v[188:191], a[220:223], v[76:79], v[188:191]
ds_read_b64_tr_b16 a[194:195], v80 offset:20480
v_fmamk_f32 v38, v38, 0x3e0293ee, v26
v_mfma_f32_16x16x32_bf16 v[32:35], a[176:179], a[16:19], 0
v_exp_f32 v38, v38
v_mfma_f32_16x16x32_bf16 v[32:35], a[180:183], a[20:23], v[32:35]
ds_read_b64_tr_b16 a[196:197], v81 offset:16384
v_fmamk_f32 v39, v39, 0x3e0293ee, v26
v_mfma_f32_16x16x32_bf16 v[32:35], a[184:187], a[24:27], v[32:35]
v_exp_f32 v39, v39
v_mfma_f32_16x16x32_bf16 v[32:35], a[188:191], a[28:31], v[32:35]
ds_read_b64_tr_b16 a[198:199], v81 offset:20480
v_cvt_pk_bf16_f32 v68, v36, v37
v_mfma_f32_16x16x32_bf16 v[208:211], a[208:211], v[48:51], v[208:211]
ds_read_b64_tr_b16 a[200:201], v82 offset:16384
v_cvt_pk_bf16_f32 v69, v38, v39
v_mfma_f32_16x16x32_bf16 v[212:215], a[212:215], v[48:51], v[212:215]
ds_read_b64_tr_b16 a[202:203], v82 offset:20480
v_fmamk_f32 v40, v40, 0x3e0293ee, v23
v_mfma_f32_16x16x32_bf16 v[216:219], a[216:219], v[48:51], v[216:219]
v_exp_f32 v40, v40
v_mfma_f32_16x16x32_bf16 v[220:223], a[220:223], v[48:51], v[220:223]
ds_read_b64_tr_b16 a[204:205], v83 offset:16384
v_fmamk_f32 v41, v41, 0x3e0293ee, v23
v_mfma_f32_16x16x32_bf16 a[240:243], a[244:247], v[52:55], a[240:243]
v_exp_f32 v41, v41
v_mfma_f32_16x16x32_bf16 v[36:39], a[176:179], a[32:35], 0
ds_read_b64_tr_b16 a[206:207], v83 offset:20480
v_fmamk_f32 v42, v42, 0x3e0293ee, v23
v_mfma_f32_16x16x32_bf16 v[36:39], a[180:183], a[36:39], v[36:39]
v_exp_f32 v42, v42
v_mfma_f32_16x16x32_bf16 v[36:39], a[184:187], a[40:43], v[36:39]
ds_read_b128 a[160:163], v2 offset:32768
v_fmamk_f32 v43, v43, 0x3e0293ee, v23
v_mfma_f32_16x16x32_bf16 v[36:39], a[188:191], a[44:47], v[36:39]
v_exp_f32 v43, v43
v_mfma_f32_16x16x32_bf16 v[240:243], a[208:211], v[52:55], v[240:243]
ds_read_b128 a[164:167], v3 offset:32768
v_cvt_pk_bf16_f32 v58, v40, v41
v_mfma_f32_16x16x32_bf16 v[244:247], a[212:215], v[52:55], v[244:247]
ds_read_b128 a[168:171], v4 offset:32768
v_cvt_pk_bf16_f32 v59, v42, v43
v_mfma_f32_16x16x32_bf16 v[248:251], a[216:219], v[52:55], v[248:251]
ds_read_b128 a[172:175], v5 offset:32768
v_fmamk_f32 v32, v32, 0x3e0293ee, v24
v_mfma_f32_16x16x32_bf16 v[252:255], a[220:223], v[52:55], v[252:255]
v_exp_f32 v32, v32
v_mfma_f32_16x16x32_bf16 v[40:43], a[176:179], a[48:51], 0
buffer_load_dwordx4 v15, s[20:23], s30 offen offset:1024 nt lds
v_fmamk_f32 v33, v33, 0x3e0293ee, v24
v_mfma_f32_16x16x32_bf16 v[40:43], a[180:183], a[52:55], v[40:43]
s_add_u32 m0, s32, 65536
v_exp_f32 v33, v33
v_mfma_f32_16x16x32_bf16 v[40:43], a[184:187], a[56:59], v[40:43]
s_add_u32 s30, s29, 8192
v_fmamk_f32 v34, v34, 0x3e0293ee, v24
v_fmamk_f32 v35, v35, 0x3e0293ee, v24
v_mfma_f32_16x16x32_bf16 v[40:43], a[188:191], a[60:63], v[40:43]
s_waitcnt lgkmcnt(3)
v_exp_f32 v34, v34
v_mfma_f32_16x16x32_bf16 v[96:99], a[192:195], v[56:59], v[96:99]
v_exp_f32 v35, v35
v_mfma_f32_16x16x32_bf16 v[100:103], a[196:199], v[56:59], v[100:103]
v_cvt_pk_bf16_f32 v62, v32, v33
v_cvt_pk_bf16_f32 v63, v34, v35
v_mfma_f32_16x16x32_bf16 v[104:107], a[200:203], v[56:59], v[104:107]
v_fmamk_f32 v36, v36, 0x3e0293ee, v25
v_fmamk_f32 v37, v37, 0x3e0293ee, v25
v_mfma_f32_16x16x32_bf16 v[108:111], a[204:207], v[56:59], v[108:111]
v_exp_f32 v36, v36
v_mfma_f32_16x16x32_bf16 a[224:227], a[244:247], v[56:59], a[224:227]
v_exp_f32 v37, v37
v_mfma_f32_16x16x32_bf16 v[32:35], a[160:163], a[0:3], 0
s_waitcnt lgkmcnt(0)
v_fmamk_f32 v38, v38, 0x3e0293ee, v25
v_fmamk_f32 v39, v39, 0x3e0293ee, v25
v_mfma_f32_16x16x32_bf16 v[32:35], a[164:167], a[4:7], v[32:35]
v_exp_f32 v38, v38
v_mfma_f32_16x16x32_bf16 v[32:35], a[168:171], a[8:11], v[32:35]
v_exp_f32 v39, v39
v_mfma_f32_16x16x32_bf16 v[32:35], a[172:175], a[12:15], v[32:35]
v_cvt_pk_bf16_f32 v66, v36, v37
v_cvt_pk_bf16_f32 v67, v38, v39
v_mfma_f32_16x16x32_bf16 v[128:131], a[192:195], v[60:63], v[128:131]
buffer_load_dwordx4 v16, s[24:27], s31 offen nt lds
v_fmamk_f32 v40, v40, 0x3e0293ee, v26
v_mfma_f32_16x16x32_bf16 v[132:135], a[196:199], v[60:63], v[132:135]
v_exp_f32 v40, v40
v_mfma_f32_16x16x32_bf16 v[136:139], a[200:203], v[60:63], v[136:139]
ds_read_b64_tr_b16 a[208:209], v84 offset:16384
v_fmamk_f32 v41, v41, 0x3e0293ee, v26
v_mfma_f32_16x16x32_bf16 v[140:143], a[204:207], v[60:63], v[140:143]
v_exp_f32 v41, v41
v_mfma_f32_16x16x32_bf16 v[36:39], a[160:163], a[16:19], 0
ds_read_b64_tr_b16 a[210:211], v84 offset:20480
v_fmamk_f32 v42, v42, 0x3e0293ee, v26
v_mfma_f32_16x16x32_bf16 v[36:39], a[164:167], a[20:23], v[36:39]
v_exp_f32 v42, v42
v_mfma_f32_16x16x32_bf16 v[36:39], a[168:171], a[24:27], v[36:39]
ds_read_b64_tr_b16 a[212:213], v85 offset:16384
v_fmamk_f32 v43, v43, 0x3e0293ee, v26
v_mfma_f32_16x16x32_bf16 v[36:39], a[172:175], a[28:31], v[36:39]
v_exp_f32 v43, v43
v_mfma_f32_16x16x32_bf16 v[160:163], a[192:195], v[64:67], v[160:163]
ds_read_b64_tr_b16 a[214:215], v85 offset:20480
v_cvt_pk_bf16_f32 v70, v40, v41
v_mfma_f32_16x16x32_bf16 v[164:167], a[196:199], v[64:67], v[164:167]
ds_read_b64_tr_b16 a[216:217], v86 offset:16384
v_cvt_pk_bf16_f32 v71, v42, v43
v_mfma_f32_16x16x32_bf16 v[168:171], a[200:203], v[64:67], v[168:171]
ds_read_b64_tr_b16 a[218:219], v86 offset:20480
v_fmamk_f32 v32, v32, 0x3e0293ee, v23
v_mfma_f32_16x16x32_bf16 v[172:175], a[204:207], v[64:67], v[172:175]
v_exp_f32 v32, v32
v_mfma_f32_16x16x32_bf16 a[228:231], a[244:247], v[60:63], a[228:231]
ds_read_b64_tr_b16 a[220:221], v87 offset:16384
v_fmamk_f32 v33, v33, 0x3e0293ee, v23
v_mfma_f32_16x16x32_bf16 v[40:43], a[160:163], a[32:35], 0
v_exp_f32 v33, v33
v_mfma_f32_16x16x32_bf16 v[40:43], a[164:167], a[36:39], v[40:43]
ds_read_b64_tr_b16 a[222:223], v87 offset:20480
v_fmamk_f32 v34, v34, 0x3e0293ee, v23
v_mfma_f32_16x16x32_bf16 v[40:43], a[168:171], a[40:43], v[40:43]
v_exp_f32 v34, v34
v_mfma_f32_16x16x32_bf16 v[40:43], a[172:175], a[44:47], v[40:43]
ds_read_b128 a[176:179], v2 offset:36864
v_fmamk_f32 v35, v35, 0x3e0293ee, v23
v_mfma_f32_16x16x32_bf16 v[192:195], a[192:195], v[68:71], v[192:195]
buffer_load_dwordx4 v17, s[24:27], s31 offen offset:1024 nt lds
v_cvt_pk_bf16_f32 v72, v32, v33
v_mfma_f32_16x16x32_bf16 v[196:199], a[196:199], v[68:71], v[196:199]
s_add_u32 m0, s32, 8192
buffer_load_dwordx4 a[136:139], v28, s[8:11], 0 offen offset:128
v_fmamk_f32 v36, v36, 0x3e0293ee, v24
v_mfma_f32_16x16x32_bf16 v[200:203], a[200:203], v[68:71], v[200:203]
s_add_u32 s31, s29, 8192
v_exp_f32 v35, v35
v_mfma_f32_16x16x32_bf16 v[204:207], a[204:207], v[68:71], v[204:207]
v_cvt_pk_bf16_f32 v73, v34, v35
v_fmamk_f32 v37, v37, 0x3e0293ee, v24
v_mfma_f32_16x16x32_bf16 v[32:35], a[160:163], a[48:51], 0
v_exp_f32 v36, v36
v_mfma_f32_16x16x32_bf16 v[32:35], a[164:167], a[52:55], v[32:35]
v_exp_f32 v37, v37
v_mfma_f32_16x16x32_bf16 v[32:35], a[168:171], a[56:59], v[32:35]
ds_read_b128 a[180:183], v3 offset:36864
v_fmamk_f32 v38, v38, 0x3e0293ee, v24
v_mfma_f32_16x16x32_bf16 v[32:35], a[172:175], a[60:63], v[32:35]
s_waitcnt lgkmcnt(1)
v_exp_f32 v38, v38
v_mfma_f32_16x16x32_bf16 v[112:115], a[208:211], v[56:59], v[112:115]
ds_read_b128 a[184:187], v4 offset:36864
v_fmamk_f32 v39, v39, 0x3e0293ee, v24
v_mfma_f32_16x16x32_bf16 v[116:119], a[212:215], v[56:59], v[116:119]
v_exp_f32 v39, v39
v_mfma_f32_16x16x32_bf16 v[120:123], a[216:219], v[56:59], v[120:123]
ds_read_b128 a[188:191], v5 offset:36864
v_cvt_pk_bf16_f32 v76, v36, v37
v_mfma_f32_16x16x32_bf16 v[124:127], a[220:223], v[56:59], v[124:127]
v_cvt_pk_bf16_f32 v77, v38, v39
v_fmamk_f32 v40, v40, 0x3e0293ee, v25
v_mfma_f32_16x16x32_bf16 a[232:235], a[244:247], v[64:67], a[232:235]
v_exp_f32 v40, v40
v_mfma_f32_16x16x32_bf16 v[36:39], a[160:163], a[64:67], 0
v_fmamk_f32 v41, v41, 0x3e0293ee, v25
v_fmamk_f32 v42, v42, 0x3e0293ee, v25
v_mfma_f32_16x16x32_bf16 v[36:39], a[164:167], a[68:71], v[36:39]
v_exp_f32 v41, v41
v_mfma_f32_16x16x32_bf16 v[36:39], a[168:171], a[72:75], v[36:39]
v_exp_f32 v42, v42
v_mfma_f32_16x16x32_bf16 v[36:39], a[172:175], a[76:79], v[36:39]
v_fmamk_f32 v43, v43, 0x3e0293ee, v25
v_cvt_pk_bf16_f32 v48, v40, v41
v_mfma_f32_16x16x32_bf16 v[144:147], a[208:211], v[60:63], v[144:147]
v_exp_f32 v43, v43
v_mfma_f32_16x16x32_bf16 v[148:151], a[212:215], v[60:63], v[148:151]
ds_read_b64_tr_b16 a[192:193], v6 offset:32768
v_cvt_pk_bf16_f32 v49, v42, v43
v_mfma_f32_16x16x32_bf16 v[152:155], a[216:219], v[60:63], v[152:155]
ds_read_b64_tr_b16 a[194:195], v6 offset:36864
v_fmamk_f32 v32, v32, 0x3e0293ee, v26
v_mfma_f32_16x16x32_bf16 v[156:159], a[220:223], v[60:63], v[156:159]
v_exp_f32 v32, v32
v_mfma_f32_16x16x32_bf16 v[40:43], a[176:179], a[0:3], 0
s_waitcnt lgkmcnt(2)
ds_read_b64_tr_b16 a[196:197], v7 offset:32768
v_fmamk_f32 v33, v33, 0x3e0293ee, v26
v_mfma_f32_16x16x32_bf16 v[40:43], a[180:183], a[4:7], v[40:43]
v_exp_f32 v33, v33
v_mfma_f32_16x16x32_bf16 v[40:43], a[184:187], a[8:11], v[40:43]
ds_read_b64_tr_b16 a[198:199], v7 offset:36864
v_fmamk_f32 v34, v34, 0x3e0293ee, v26
v_mfma_f32_16x16x32_bf16 v[40:43], a[188:191], a[12:15], v[40:43]
v_exp_f32 v34, v34
v_mfma_f32_16x16x32_bf16 v[176:179], a[208:211], v[64:67], v[176:179]
buffer_load_dwordx4 v14, s[20:23], s30 offen nt lds
v_fmamk_f32 v35, v35, 0x3e0293ee, v26
v_mfma_f32_16x16x32_bf16 v[180:183], a[212:215], v[64:67], v[180:183]
v_exp_f32 v35, v35
v_mfma_f32_16x16x32_bf16 v[184:187], a[216:219], v[64:67], v[184:187]
ds_read_b64_tr_b16 a[200:201], v8 offset:32768
v_cvt_pk_bf16_f32 v52, v32, v33
v_mfma_f32_16x16x32_bf16 v[188:191], a[220:223], v[64:67], v[188:191]
ds_read_b64_tr_b16 a[202:203], v8 offset:36864
v_cvt_pk_bf16_f32 v53, v34, v35
v_mfma_f32_16x16x32_bf16 a[236:239], a[244:247], v[68:71], a[236:239]
ds_read_b64_tr_b16 a[204:205], v9 offset:32768
v_fmamk_f32 v36, v36, 0x3e0293ee, v27
v_mfma_f32_16x16x32_bf16 v[32:35], a[176:179], a[16:19], 0
v_exp_f32 v36, v36
v_mfma_f32_16x16x32_bf16 v[32:35], a[180:183], a[20:23], v[32:35]
ds_read_b64_tr_b16 a[206:207], v9 offset:36864
v_fmamk_f32 v37, v37, 0x3e0293ee, v27
v_mfma_f32_16x16x32_bf16 v[32:35], a[184:187], a[24:27], v[32:35]
v_exp_f32 v37, v37
v_mfma_f32_16x16x32_bf16 v[32:35], a[188:191], a[28:31], v[32:35]
v_fmamk_f32 v38, v38, 0x3e0293ee, v27
v_fmamk_f32 v39, v39, 0x3e0293ee, v27
v_mfma_f32_16x16x32_bf16 v[208:211], a[208:211], v[68:71], v[208:211]
v_exp_f32 v38, v38
v_mfma_f32_16x16x32_bf16 v[212:215], a[212:215], v[68:71], v[212:215]
v_exp_f32 v39, v39
v_mfma_f32_16x16x32_bf16 v[216:219], a[216:219], v[68:71], v[216:219]
v_cvt_pk_bf16_f32 v56, v36, v37
v_cvt_pk_bf16_f32 v57, v38, v39
v_mfma_f32_16x16x32_bf16 v[220:223], a[220:223], v[68:71], v[220:223]
ds_read_b128 a[160:163], v44 offset:32768
v_fmamk_f32 v40, v40, 0x3e0293ee, v23
v_mfma_f32_16x16x32_bf16 v[36:39], a[176:179], a[32:35], 0
v_exp_f32 v40, v40
v_mfma_f32_16x16x32_bf16 v[36:39], a[180:183], a[36:39], v[36:39]
ds_read_b128 a[164:167], v45 offset:32768
v_fmamk_f32 v41, v41, 0x3e0293ee, v23
v_mfma_f32_16x16x32_bf16 v[36:39], a[184:187], a[40:43], v[36:39]
v_exp_f32 v41, v41
v_fmamk_f32 v42, v42, 0x3e0293ee, v23
v_fmamk_f32 v43, v43, 0x3e0293ee, v23
v_exp_f32 v42, v42
v_exp_f32 v43, v43
v_mfma_f32_16x16x32_bf16 v[36:39], a[188:191], a[44:47], v[36:39]
v_cvt_pk_bf16_f32 v74, v40, v41
v_cvt_pk_bf16_f32 v75, v42, v43
v_mfma_f32_16x16x32_bf16 v[40:43], a[176:179], a[48:51], 0
ds_read_b128 a[168:171], v46 offset:32768
v_fmamk_f32 v32, v32, 0x3e0293ee, v24
v_mfma_f32_16x16x32_bf16 v[40:43], a[180:183], a[52:55], v[40:43]
v_exp_f32 v32, v32
v_mfma_f32_16x16x32_bf16 v[40:43], a[184:187], a[56:59], v[40:43]
ds_read_b128 a[172:175], v47 offset:32768
v_fmamk_f32 v33, v33, 0x3e0293ee, v24
v_mfma_f32_16x16x32_bf16 v[40:43], a[188:191], a[60:63], v[40:43]
s_waitcnt lgkmcnt(3)
v_exp_f32 v33, v33
v_mfma_f32_16x16x32_bf16 v[96:99], a[192:195], v[72:75], v[96:99]
buffer_load_dwordx4 v15, s[20:23], s30 offen offset:1024 nt lds
v_fmamk_f32 v34, v34, 0x3e0293ee, v24
v_mfma_f32_16x16x32_bf16 v[100:103], a[196:199], v[72:75], v[100:103]
s_add_u32 m0, s32, 73728
v_exp_f32 v34, v34
v_mfma_f32_16x16x32_bf16 v[104:107], a[200:203], v[72:75], v[104:107]
s_add_u32 s30, s29, 16384
v_fmamk_f32 v35, v35, 0x3e0293ee, v24
v_cvt_pk_bf16_f32 v78, v32, v33
v_mfma_f32_16x16x32_bf16 v[108:111], a[204:207], v[72:75], v[108:111]
v_exp_f32 v35, v35
v_mfma_f32_16x16x32_bf16 a[224:227], a[244:247], v[72:75], a[224:227]
v_cvt_pk_bf16_f32 v79, v34, v35
v_fmamk_f32 v36, v36, 0x3e0293ee, v25
v_mfma_f32_16x16x32_bf16 v[32:35], a[176:179], a[64:67], 0
v_exp_f32 v36, v36
v_mfma_f32_16x16x32_bf16 v[32:35], a[180:183], a[68:71], v[32:35]
v_fmamk_f32 v37, v37, 0x3e0293ee, v25
v_fmamk_f32 v38, v38, 0x3e0293ee, v25
v_mfma_f32_16x16x32_bf16 v[32:35], a[184:187], a[72:75], v[32:35]
v_exp_f32 v37, v37
v_mfma_f32_16x16x32_bf16 v[32:35], a[188:191], a[76:79], v[32:35]
v_exp_f32 v38, v38
v_mfma_f32_16x16x32_bf16 v[128:131], a[192:195], v[76:79], v[128:131]
v_fmamk_f32 v39, v39, 0x3e0293ee, v25
v_cvt_pk_bf16_f32 v50, v36, v37
v_mfma_f32_16x16x32_bf16 v[132:135], a[196:199], v[76:79], v[132:135]
v_exp_f32 v39, v39
v_mfma_f32_16x16x32_bf16 v[136:139], a[200:203], v[76:79], v[136:139]
ds_read_b64_tr_b16 a[208:209], v10 offset:32768
v_cvt_pk_bf16_f32 v51, v38, v39
v_mfma_f32_16x16x32_bf16 v[140:143], a[204:207], v[76:79], v[140:143]
ds_read_b64_tr_b16 a[210:211], v10 offset:36864
v_fmamk_f32 v40, v40, 0x3e0293ee, v26
v_mfma_f32_16x16x32_bf16 v[36:39], a[160:163], a[0:3], 0
s_waitcnt lgkmcnt(2)
v_exp_f32 v40, v40
v_mfma_f32_16x16x32_bf16 v[36:39], a[164:167], a[4:7], v[36:39]
ds_read_b64_tr_b16 a[212:213], v11 offset:32768
v_fmamk_f32 v41, v41, 0x3e0293ee, v26
v_mfma_f32_16x16x32_bf16 v[36:39], a[168:171], a[8:11], v[36:39]
v_exp_f32 v41, v41
v_mfma_f32_16x16x32_bf16 v[36:39], a[172:175], a[12:15], v[36:39]
ds_read_b64_tr_b16 a[214:215], v11 offset:36864
v_fmamk_f32 v42, v42, 0x3e0293ee, v26
v_mfma_f32_16x16x32_bf16 v[160:163], a[192:195], v[48:51], v[160:163]
L_pad1_5:
s_cbranch_execz L_pad1_9
v_exp_f32 v42, v42
v_mfma_f32_16x16x32_bf16 v[164:167], a[196:199], v[48:51], v[164:167]
ds_read_b64_tr_b16 a[216:217], v12 offset:32768
v_fmamk_f32 v43, v43, 0x3e0293ee, v26
v_mfma_f32_16x16x32_bf16 v[168:171], a[200:203], v[48:51], v[168:171]
v_exp_f32 v43, v43
v_mfma_f32_16x16x32_bf16 v[172:175], a[204:207], v[48:51], v[172:175]
ds_read_b64_tr_b16 a[218:219], v12 offset:36864
v_cvt_pk_bf16_f32 v54, v40, v41
v_mfma_f32_16x16x32_bf16 a[228:231], a[244:247], v[76:79], a[228:231]
v_cvt_pk_bf16_f32 v55, v42, v43
v_fmamk_f32 v32, v32, 0x3e0293ee, v27
v_mfma_f32_16x16x32_bf16 v[40:43], a[160:163], a[16:19], 0
v_exp_f32 v32, v32
v_mfma_f32_16x16x32_bf16 v[40:43], a[164:167], a[20:23], v[40:43]
buffer_load_dwordx4 v16, s[24:27], s31 offen nt lds
v_fmamk_f32 v33, v33, 0x3e0293ee, v27
v_mfma_f32_16x16x32_bf16 v[40:43], a[168:171], a[24:27], v[40:43]
v_exp_f32 v33, v33
v_mfma_f32_16x16x32_bf16 v[40:43], a[172:175], a[28:31], v[40:43]
ds_read_b64_tr_b16 a[220:221], v13 offset:32768
v_fmamk_f32 v34, v34, 0x3e0293ee, v27
v_mfma_f32_16x16x32_bf16 v[192:195], a[192:195], v[52:55], v[192:195]
v_exp_f32 v34, v34
v_mfma_f32_16x16x32_bf16 v[196:199], a[196:199], v[52:55], v[196:199]
ds_read_b64_tr_b16 a[222:223], v13 offset:36864
v_fmamk_f32 v35, v35, 0x3e0293ee, v27
v_mfma_f32_16x16x32_bf16 v[200:203], a[200:203], v[52:55], v[200:203]
v_exp_f32 v35, v35
v_mfma_f32_16x16x32_bf16 v[204:207], a[204:207], v[52:55], v[204:207]
v_cvt_pk_bf16_f32 v58, v32, v33
v_cvt_pk_bf16_f32 v59, v34, v35
v_mfma_f32_16x16x32_bf16 v[32:35], a[160:163], a[32:35], 0
ds_read_b128 a[176:179], v44 offset:36864
v_fmamk_f32 v36, v36, 0x3e0293ee, v23
v_mfma_f32_16x16x32_bf16 v[32:35], a[164:167], a[36:39], v[32:35]
v_exp_f32 v36, v36
v_mfma_f32_16x16x32_bf16 v[32:35], a[168:171], a[40:43], v[32:35]
ds_read_b128 a[180:183], v45 offset:36864
v_fmamk_f32 v37, v37, 0x3e0293ee, v23
v_mfma_f32_16x16x32_bf16 v[32:35], a[172:175], a[44:47], v[32:35]
v_exp_f32 v37, v37
v_mfma_f32_16x16x32_bf16 v[224:227], a[192:195], v[56:59], v[224:227]
ds_read_b128 a[184:187], v46 offset:36864
v_fmamk_f32 v38, v38, 0x3e0293ee, v23
v_mfma_f32_16x16x32_bf16 v[228:231], a[196:199], v[56:59], v[228:231]
v_exp_f32 v38, v38
v_mfma_f32_16x16x32_bf16 v[232:235], a[200:203], v[56:59], v[232:235]
ds_read_b128 a[188:191], v47 offset:36864
v_fmamk_f32 v39, v39, 0x3e0293ee, v23
v_mfma_f32_16x16x32_bf16 v[236:239], a[204:207], v[56:59], v[236:239]
v_exp_f32 v39, v39
v_mfma_f32_16x16x32_bf16 a[232:235], a[244:247], v[48:51], a[232:235]
s_waitcnt lgkmcnt(3)
v_cvt_pk_bf16_f32 v60, v36, v37
v_cvt_pk_bf16_f32 v61, v38, v39
v_mfma_f32_16x16x32_bf16 v[112:115], a[208:211], v[72:75], v[112:115]
v_fmamk_f32 v40, v40, 0x3e0293ee, v24
v_fmamk_f32 v41, v41, 0x3e0293ee, v24
v_mfma_f32_16x16x32_bf16 v[116:119], a[212:215], v[72:75], v[116:119]
v_exp_f32 v40, v40
v_mfma_f32_16x16x32_bf16 v[120:123], a[216:219], v[72:75], v[120:123]
v_exp_f32 v41, v41
v_mfma_f32_16x16x32_bf16 v[124:127], a[220:223], v[72:75], v[124:127]
buffer_load_dwordx4 v17, s[24:27], s31 offen offset:1024 nt lds
buffer_load_dwordx4 a[140:143], v28, s[8:11], 0 offen offset:192
v_mfma_f32_16x16x32_bf16 v[36:39], a[160:163], a[48:51], 0
s_add_u32 m0, s32, 16384
v_fmamk_f32 v42, v42, 0x3e0293ee, v24
v_fmamk_f32 v43, v43, 0x3e0293ee, v24
v_mfma_f32_16x16x32_bf16 v[36:39], a[164:167], a[52:55], v[36:39]
s_add_u32 s31, s29, 16384
v_exp_f32 v42, v42
v_mfma_f32_16x16x32_bf16 v[36:39], a[168:171], a[56:59], v[36:39]
v_exp_f32 v43, v43
v_mfma_f32_16x16x32_bf16 v[36:39], a[172:175], a[60:63], v[36:39]
v_cvt_pk_bf16_f32 v64, v40, v41
v_cvt_pk_bf16_f32 v65, v42, v43
v_mfma_f32_16x16x32_bf16 v[144:147], a[208:211], v[76:79], v[144:147]
v_add_u32 v28, s38, v18
v_fmamk_f32 v32, v32, 0x3e0293ee, v25
v_mfma_f32_16x16x32_bf16 v[148:151], a[212:215], v[76:79], v[148:151]
s_add_u32 s38, s63, 0
v_exp_f32 v32, v32
v_mfma_f32_16x16x32_bf16 v[152:155], a[216:219], v[76:79], v[152:155]
s_add_u32 s38, s38, s76
buffer_load_dwordx4 a[144:147], v28, s[8:11], 0 offen offset:0
v_fmamk_f32 v33, v33, 0x3e0293ee, v25
v_mfma_f32_16x16x32_bf16 v[156:159], a[220:223], v[76:79], v[156:159]
v_exp_f32 v33, v33
v_mfma_f32_16x16x32_bf16 a[236:239], a[244:247], v[52:55], a[236:239]
s_waitcnt vmcnt(13) lgkmcnt(0)
v_fmamk_f32 v34, v34, 0x3e0293ee, v25
v_fmamk_f32 v35, v35, 0x3e0293ee, v25
v_mfma_f32_16x16x32_bf16 v[40:43], a[176:179], a[0:3], 0
s_barrier
v_exp_f32 v34, v34
v_mfma_f32_16x16x32_bf16 v[40:43], a[180:183], a[4:7], v[40:43]
v_exp_f32 v35, v35
v_mfma_f32_16x16x32_bf16 v[40:43], a[184:187], a[8:11], v[40:43]
v_cvt_pk_bf16_f32 v68, v32, v33
v_cvt_pk_bf16_f32 v69, v34, v35
v_mfma_f32_16x16x32_bf16 v[40:43], a[188:191], a[12:15], v[40:43]
ds_read_b64_tr_b16 a[192:193], v80 offset:32768
v_fmamk_f32 v36, v36, 0x3e0293ee, v26
v_mfma_f32_16x16x32_bf16 v[176:179], a[208:211], v[48:51], v[176:179]
v_exp_f32 v36, v36
v_mfma_f32_16x16x32_bf16 v[180:183], a[212:215], v[48:51], v[180:183]
buffer_load_dwordx4 v14, s[20:23], s30 offen nt lds
v_fmamk_f32 v37, v37, 0x3e0293ee, v26
v_mfma_f32_16x16x32_bf16 v[184:187], a[216:219], v[48:51], v[184:187]
v_exp_f32 v37, v37
v_mfma_f32_16x16x32_bf16 v[188:191], a[220:223], v[48:51], v[188:191]
ds_read_b64_tr_b16 a[194:195], v80 offset:36864
v_fmamk_f32 v38, v38, 0x3e0293ee, v26
v_mfma_f32_16x16x32_bf16 v[32:35], a[176:179], a[16:19], 0
v_exp_f32 v38, v38
v_mfma_f32_16x16x32_bf16 v[32:35], a[180:183], a[20:23], v[32:35]
ds_read_b64_tr_b16 a[196:197], v81 offset:32768
v_fmamk_f32 v39, v39, 0x3e0293ee, v26
v_mfma_f32_16x16x32_bf16 v[32:35], a[184:187], a[24:27], v[32:35]
v_exp_f32 v39, v39
v_mfma_f32_16x16x32_bf16 v[32:35], a[188:191], a[28:31], v[32:35]
ds_read_b64_tr_b16 a[198:199], v81 offset:36864
v_cvt_pk_bf16_f32 v72, v36, v37
v_mfma_f32_16x16x32_bf16 v[208:211], a[208:211], v[52:55], v[208:211]
ds_read_b64_tr_b16 a[200:201], v82 offset:32768
v_cvt_pk_bf16_f32 v73, v38, v39
v_mfma_f32_16x16x32_bf16 v[212:215], a[212:215], v[52:55], v[212:215]
ds_read_b64_tr_b16 a[202:203], v82 offset:36864
v_fmamk_f32 v40, v40, 0x3e0293ee, v23
v_mfma_f32_16x16x32_bf16 v[216:219], a[216:219], v[52:55], v[216:219]
v_exp_f32 v40, v40
v_mfma_f32_16x16x32_bf16 v[220:223], a[220:223], v[52:55], v[220:223]
ds_read_b64_tr_b16 a[204:205], v83 offset:32768
v_fmamk_f32 v41, v41, 0x3e0293ee, v23
v_mfma_f32_16x16x32_bf16 a[240:243], a[244:247], v[56:59], a[240:243]
v_exp_f32 v41, v41
v_mfma_f32_16x16x32_bf16 v[36:39], a[176:179], a[32:35], 0
ds_read_b64_tr_b16 a[206:207], v83 offset:36864
v_fmamk_f32 v42, v42, 0x3e0293ee, v23
v_mfma_f32_16x16x32_bf16 v[36:39], a[180:183], a[36:39], v[36:39]
v_exp_f32 v42, v42
v_mfma_f32_16x16x32_bf16 v[36:39], a[184:187], a[40:43], v[36:39]
ds_read_b128 a[160:163], v2 offset:49152
v_fmamk_f32 v43, v43, 0x3e0293ee, v23
v_mfma_f32_16x16x32_bf16 v[36:39], a[188:191], a[44:47], v[36:39]
v_exp_f32 v43, v43
v_mfma_f32_16x16x32_bf16 v[240:243], a[208:211], v[56:59], v[240:243]
ds_read_b128 a[164:167], v3 offset:49152
v_cvt_pk_bf16_f32 v62, v40, v41
v_mfma_f32_16x16x32_bf16 v[244:247], a[212:215], v[56:59], v[244:247]
ds_read_b128 a[168:171], v4 offset:49152
v_cvt_pk_bf16_f32 v63, v42, v43
v_mfma_f32_16x16x32_bf16 v[248:251], a[216:219], v[56:59], v[248:251]
ds_read_b128 a[172:175], v5 offset:49152
v_fmamk_f32 v32, v32, 0x3e0293ee, v24
v_mfma_f32_16x16x32_bf16 v[252:255], a[220:223], v[56:59], v[252:255]
v_exp_f32 v32, v32
v_mfma_f32_16x16x32_bf16 v[40:43], a[176:179], a[48:51], 0
buffer_load_dwordx4 v15, s[20:23], s30 offen offset:1024 nt lds
v_fmamk_f32 v33, v33, 0x3e0293ee, v24
v_mfma_f32_16x16x32_bf16 v[40:43], a[180:183], a[52:55], v[40:43]
s_add_u32 m0, s32, 81920
v_exp_f32 v33, v33
v_mfma_f32_16x16x32_bf16 v[40:43], a[184:187], a[56:59], v[40:43]
s_add_u32 s30, s29, 24576
v_fmamk_f32 v34, v34, 0x3e0293ee, v24
v_fmamk_f32 v35, v35, 0x3e0293ee, v24
v_mfma_f32_16x16x32_bf16 v[40:43], a[188:191], a[60:63], v[40:43]
s_waitcnt lgkmcnt(3)
v_exp_f32 v34, v34
v_mfma_f32_16x16x32_bf16 v[96:99], a[192:195], v[60:63], v[96:99]
v_exp_f32 v35, v35
v_mfma_f32_16x16x32_bf16 v[100:103], a[196:199], v[60:63], v[100:103]
v_cvt_pk_bf16_f32 v66, v32, v33
v_cvt_pk_bf16_f32 v67, v34, v35
v_mfma_f32_16x16x32_bf16 v[104:107], a[200:203], v[60:63], v[104:107]
v_fmamk_f32 v36, v36, 0x3e0293ee, v25
v_fmamk_f32 v37, v37, 0x3e0293ee, v25
v_mfma_f32_16x16x32_bf16 v[108:111], a[204:207], v[60:63], v[108:111]
v_exp_f32 v36, v36
v_mfma_f32_16x16x32_bf16 a[224:227], a[244:247], v[60:63], a[224:227]
v_exp_f32 v37, v37
v_mfma_f32_16x16x32_bf16 v[32:35], a[160:163], a[0:3], 0
s_waitcnt lgkmcnt(0)
v_fmamk_f32 v38, v38, 0x3e0293ee, v25
v_fmamk_f32 v39, v39, 0x3e0293ee, v25
v_mfma_f32_16x16x32_bf16 v[32:35], a[164:167], a[4:7], v[32:35]
v_exp_f32 v38, v38
v_mfma_f32_16x16x32_bf16 v[32:35], a[168:171], a[8:11], v[32:35]
v_exp_f32 v39, v39
v_mfma_f32_16x16x32_bf16 v[32:35], a[172:175], a[12:15], v[32:35]
v_cvt_pk_bf16_f32 v70, v36, v37
v_cvt_pk_bf16_f32 v71, v38, v39
v_mfma_f32_16x16x32_bf16 v[128:131], a[192:195], v[64:67], v[128:131]
buffer_load_dwordx4 v16, s[24:27], s31 offen nt lds
v_fmamk_f32 v40, v40, 0x3e0293ee, v26
v_mfma_f32_16x16x32_bf16 v[132:135], a[196:199], v[64:67], v[132:135]
v_exp_f32 v40, v40
v_mfma_f32_16x16x32_bf16 v[136:139], a[200:203], v[64:67], v[136:139]
ds_read_b64_tr_b16 a[208:209], v84 offset:32768
v_fmamk_f32 v41, v41, 0x3e0293ee, v26
v_mfma_f32_16x16x32_bf16 v[140:143], a[204:207], v[64:67], v[140:143]
v_exp_f32 v41, v41
v_mfma_f32_16x16x32_bf16 v[36:39], a[160:163], a[16:19], 0
ds_read_b64_tr_b16 a[210:211], v84 offset:36864
v_fmamk_f32 v42, v42, 0x3e0293ee, v26
v_mfma_f32_16x16x32_bf16 v[36:39], a[164:167], a[20:23], v[36:39]
v_exp_f32 v42, v42
v_mfma_f32_16x16x32_bf16 v[36:39], a[168:171], a[24:27], v[36:39]
ds_read_b64_tr_b16 a[212:213], v85 offset:32768
v_fmamk_f32 v43, v43, 0x3e0293ee, v26
v_mfma_f32_16x16x32_bf16 v[36:39], a[172:175], a[28:31], v[36:39]
v_exp_f32 v43, v43
v_mfma_f32_16x16x32_bf16 v[160:163], a[192:195], v[68:71], v[160:163]
ds_read_b64_tr_b16 a[214:215], v85 offset:36864
v_cvt_pk_bf16_f32 v74, v40, v41
v_mfma_f32_16x16x32_bf16 v[164:167], a[196:199], v[68:71], v[164:167]
ds_read_b64_tr_b16 a[216:217], v86 offset:32768
v_cvt_pk_bf16_f32 v75, v42, v43
v_mfma_f32_16x16x32_bf16 v[168:171], a[200:203], v[68:71], v[168:171]
ds_read_b64_tr_b16 a[218:219], v86 offset:36864
v_fmamk_f32 v32, v32, 0x3e0293ee, v23
v_mfma_f32_16x16x32_bf16 v[172:175], a[204:207], v[68:71], v[172:175]
v_exp_f32 v32, v32
v_mfma_f32_16x16x32_bf16 a[228:231], a[244:247], v[64:67], a[228:231]
ds_read_b64_tr_b16 a[220:221], v87 offset:32768
v_fmamk_f32 v33, v33, 0x3e0293ee, v23
v_mfma_f32_16x16x32_bf16 v[40:43], a[160:163], a[32:35], 0
v_exp_f32 v33, v33
v_mfma_f32_16x16x32_bf16 v[40:43], a[164:167], a[36:39], v[40:43]
ds_read_b64_tr_b16 a[222:223], v87 offset:36864
v_fmamk_f32 v34, v34, 0x3e0293ee, v23
v_mfma_f32_16x16x32_bf16 v[40:43], a[168:171], a[40:43], v[40:43]
v_exp_f32 v34, v34
v_mfma_f32_16x16x32_bf16 v[40:43], a[172:175], a[44:47], v[40:43]
ds_read_b128 a[176:179], v2 offset:53248
v_fmamk_f32 v35, v35, 0x3e0293ee, v23
v_mfma_f32_16x16x32_bf16 v[192:195], a[192:195], v[72:75], v[192:195]
buffer_load_dwordx4 v17, s[24:27], s31 offen offset:1024 nt lds
v_cvt_pk_bf16_f32 v76, v32, v33
v_mfma_f32_16x16x32_bf16 v[196:199], a[196:199], v[72:75], v[196:199]
s_add_u32 m0, s32, 24576
buffer_load_dwordx4 a[148:151], v28, s[8:11], 0 offen offset:64
v_fmamk_f32 v36, v36, 0x3e0293ee, v24
v_mfma_f32_16x16x32_bf16 v[200:203], a[200:203], v[72:75], v[200:203]
s_add_u32 s31, s29, 24576
v_exp_f32 v35, v35
v_mfma_f32_16x16x32_bf16 v[204:207], a[204:207], v[72:75], v[204:207]
v_cvt_pk_bf16_f32 v77, v34, v35
v_fmamk_f32 v37, v37, 0x3e0293ee, v24
v_mfma_f32_16x16x32_bf16 v[32:35], a[160:163], a[48:51], 0
v_exp_f32 v36, v36
v_mfma_f32_16x16x32_bf16 v[32:35], a[164:167], a[52:55], v[32:35]
v_exp_f32 v37, v37
v_mfma_f32_16x16x32_bf16 v[32:35], a[168:171], a[56:59], v[32:35]
ds_read_b128 a[180:183], v3 offset:53248
v_fmamk_f32 v38, v38, 0x3e0293ee, v24
v_mfma_f32_16x16x32_bf16 v[32:35], a[172:175], a[60:63], v[32:35]
s_waitcnt lgkmcnt(1)
v_exp_f32 v38, v38
v_mfma_f32_16x16x32_bf16 v[112:115], a[208:211], v[60:63], v[112:115]
ds_read_b128 a[184:187], v4 offset:53248
v_fmamk_f32 v39, v39, 0x3e0293ee, v24
v_mfma_f32_16x16x32_bf16 v[116:119], a[212:215], v[60:63], v[116:119]
v_exp_f32 v39, v39
v_mfma_f32_16x16x32_bf16 v[120:123], a[216:219], v[60:63], v[120:123]
ds_read_b128 a[188:191], v5 offset:53248
v_cvt_pk_bf16_f32 v48, v36, v37
v_mfma_f32_16x16x32_bf16 v[124:127], a[220:223], v[60:63], v[124:127]
v_cvt_pk_bf16_f32 v49, v38, v39
v_fmamk_f32 v40, v40, 0x3e0293ee, v25
v_mfma_f32_16x16x32_bf16 a[232:235], a[244:247], v[68:71], a[232:235]
v_exp_f32 v40, v40
v_mfma_f32_16x16x32_bf16 v[36:39], a[160:163], a[64:67], 0
v_fmamk_f32 v41, v41, 0x3e0293ee, v25
v_fmamk_f32 v42, v42, 0x3e0293ee, v25
v_mfma_f32_16x16x32_bf16 v[36:39], a[164:167], a[68:71], v[36:39]
v_exp_f32 v41, v41
v_mfma_f32_16x16x32_bf16 v[36:39], a[168:171], a[72:75], v[36:39]
v_exp_f32 v42, v42
v_mfma_f32_16x16x32_bf16 v[36:39], a[172:175], a[76:79], v[36:39]
v_fmamk_f32 v43, v43, 0x3e0293ee, v25
v_cvt_pk_bf16_f32 v52, v40, v41
v_mfma_f32_16x16x32_bf16 v[144:147], a[208:211], v[64:67], v[144:147]
v_exp_f32 v43, v43
v_mfma_f32_16x16x32_bf16 v[148:151], a[212:215], v[64:67], v[148:151]
ds_read_b64_tr_b16 a[192:193], v6 offset:49152
v_cvt_pk_bf16_f32 v53, v42, v43
v_mfma_f32_16x16x32_bf16 v[152:155], a[216:219], v[64:67], v[152:155]
ds_read_b64_tr_b16 a[194:195], v6 offset:53248
v_fmamk_f32 v32, v32, 0x3e0293ee, v26
v_mfma_f32_16x16x32_bf16 v[156:159], a[220:223], v[64:67], v[156:159]
v_exp_f32 v32, v32
v_mfma_f32_16x16x32_bf16 v[40:43], a[176:179], a[0:3], 0
s_waitcnt lgkmcnt(2)
ds_read_b64_tr_b16 a[196:197], v7 offset:49152
v_fmamk_f32 v33, v33, 0x3e0293ee, v26
v_mfma_f32_16x16x32_bf16 v[40:43], a[180:183], a[4:7], v[40:43]
v_exp_f32 v33, v33
v_mfma_f32_16x16x32_bf16 v[40:43], a[184:187], a[8:11], v[40:43]
ds_read_b64_tr_b16 a[198:199], v7 offset:53248
v_fmamk_f32 v34, v34, 0x3e0293ee, v26
v_mfma_f32_16x16x32_bf16 v[40:43], a[188:191], a[12:15], v[40:43]
v_exp_f32 v34, v34
v_mfma_f32_16x16x32_bf16 v[176:179], a[208:211], v[68:71], v[176:179]
buffer_load_dwordx4 v14, s[20:23], s30 offen nt lds
v_fmamk_f32 v35, v35, 0x3e0293ee, v26
v_mfma_f32_16x16x32_bf16 v[180:183], a[212:215], v[68:71], v[180:183]
v_exp_f32 v35, v35
v_mfma_f32_16x16x32_bf16 v[184:187], a[216:219], v[68:71], v[184:187]
ds_read_b64_tr_b16 a[200:201], v8 offset:49152
v_cvt_pk_bf16_f32 v56, v32, v33
v_mfma_f32_16x16x32_bf16 v[188:191], a[220:223], v[68:71], v[188:191]
ds_read_b64_tr_b16 a[202:203], v8 offset:53248
v_cvt_pk_bf16_f32 v57, v34, v35
v_mfma_f32_16x16x32_bf16 a[236:239], a[244:247], v[72:75], a[236:239]
ds_read_b64_tr_b16 a[204:205], v9 offset:49152
v_fmamk_f32 v36, v36, 0x3e0293ee, v27
v_mfma_f32_16x16x32_bf16 v[32:35], a[176:179], a[16:19], 0
v_exp_f32 v36, v36
v_mfma_f32_16x16x32_bf16 v[32:35], a[180:183], a[20:23], v[32:35]
ds_read_b64_tr_b16 a[206:207], v9 offset:53248
v_fmamk_f32 v37, v37, 0x3e0293ee, v27
v_mfma_f32_16x16x32_bf16 v[32:35], a[184:187], a[24:27], v[32:35]
v_exp_f32 v37, v37
v_mfma_f32_16x16x32_bf16 v[32:35], a[188:191], a[28:31], v[32:35]
v_fmamk_f32 v38, v38, 0x3e0293ee, v27
v_fmamk_f32 v39, v39, 0x3e0293ee, v27
v_mfma_f32_16x16x32_bf16 v[208:211], a[208:211], v[72:75], v[208:211]
v_exp_f32 v38, v38
v_mfma_f32_16x16x32_bf16 v[212:215], a[212:215], v[72:75], v[212:215]
v_exp_f32 v39, v39
v_mfma_f32_16x16x32_bf16 v[216:219], a[216:219], v[72:75], v[216:219]
v_cvt_pk_bf16_f32 v60, v36, v37
v_cvt_pk_bf16_f32 v61, v38, v39
v_mfma_f32_16x16x32_bf16 v[220:223], a[220:223], v[72:75], v[220:223]
ds_read_b128 a[160:163], v44 offset:49152
v_fmamk_f32 v40, v40, 0x3e0293ee, v23
v_mfma_f32_16x16x32_bf16 v[36:39], a[176:179], a[32:35], 0
v_exp_f32 v40, v40
v_mfma_f32_16x16x32_bf16 v[36:39], a[180:183], a[36:39], v[36:39]
ds_read_b128 a[164:167], v45 offset:49152
v_fmamk_f32 v41, v41, 0x3e0293ee, v23
v_mfma_f32_16x16x32_bf16 v[36:39], a[184:187], a[40:43], v[36:39]
v_exp_f32 v41, v41
v_fmamk_f32 v42, v42, 0x3e0293ee, v23
v_fmamk_f32 v43, v43, 0x3e0293ee, v23
v_exp_f32 v42, v42
v_exp_f32 v43, v43
v_mfma_f32_16x16x32_bf16 v[36:39], a[188:191], a[44:47], v[36:39]
v_cvt_pk_bf16_f32 v78, v40, v41
v_cvt_pk_bf16_f32 v79, v42, v43
v_mfma_f32_16x16x32_bf16 v[40:43], a[176:179], a[48:51], 0
ds_read_b128 a[168:171], v46 offset:49152
v_fmamk_f32 v32, v32, 0x3e0293ee, v24
v_mfma_f32_16x16x32_bf16 v[40:43], a[180:183], a[52:55], v[40:43]
v_exp_f32 v32, v32
v_mfma_f32_16x16x32_bf16 v[40:43], a[184:187], a[56:59], v[40:43]
ds_read_b128 a[172:175], v47 offset:49152
v_fmamk_f32 v33, v33, 0x3e0293ee, v24
v_mfma_f32_16x16x32_bf16 v[40:43], a[188:191], a[60:63], v[40:43]
s_waitcnt lgkmcnt(3)
v_exp_f32 v33, v33
v_mfma_f32_16x16x32_bf16 v[96:99], a[192:195], v[76:79], v[96:99]
buffer_load_dwordx4 v15, s[20:23], s30 offen offset:1024 nt lds
v_fmamk_f32 v34, v34, 0x3e0293ee, v24
v_mfma_f32_16x16x32_bf16 v[100:103], a[196:199], v[76:79], v[100:103]
s_add_u32 m0, s32, 90112
v_exp_f32 v34, v34
v_mfma_f32_16x16x32_bf16 v[104:107], a[200:203], v[76:79], v[104:107]
s_add_u32 s30, s29, 32768
v_fmamk_f32 v35, v35, 0x3e0293ee, v24
v_cvt_pk_bf16_f32 v50, v32, v33
v_mfma_f32_16x16x32_bf16 v[108:111], a[204:207], v[76:79], v[108:111]
v_exp_f32 v35, v35
v_mfma_f32_16x16x32_bf16 a[224:227], a[244:247], v[76:79], a[224:227]
v_cvt_pk_bf16_f32 v51, v34, v35
v_fmamk_f32 v36, v36, 0x3e0293ee, v25
v_mfma_f32_16x16x32_bf16 v[32:35], a[176:179], a[64:67], 0
v_exp_f32 v36, v36
v_mfma_f32_16x16x32_bf16 v[32:35], a[180:183], a[68:71], v[32:35]
v_fmamk_f32 v37, v37, 0x3e0293ee, v25
v_fmamk_f32 v38, v38, 0x3e0293ee, v25
v_mfma_f32_16x16x32_bf16 v[32:35], a[184:187], a[72:75], v[32:35]
v_exp_f32 v37, v37
v_mfma_f32_16x16x32_bf16 v[32:35], a[188:191], a[76:79], v[32:35]
v_exp_f32 v38, v38
v_mfma_f32_16x16x32_bf16 v[128:131], a[192:195], v[48:51], v[128:131]
v_fmamk_f32 v39, v39, 0x3e0293ee, v25
v_cvt_pk_bf16_f32 v54, v36, v37
v_mfma_f32_16x16x32_bf16 v[132:135], a[196:199], v[48:51], v[132:135]
v_exp_f32 v39, v39
v_mfma_f32_16x16x32_bf16 v[136:139], a[200:203], v[48:51], v[136:139]
ds_read_b64_tr_b16 a[208:209], v10 offset:49152
v_cvt_pk_bf16_f32 v55, v38, v39
v_mfma_f32_16x16x32_bf16 v[140:143], a[204:207], v[48:51], v[140:143]
ds_read_b64_tr_b16 a[210:211], v10 offset:53248
v_fmamk_f32 v40, v40, 0x3e0293ee, v26
v_mfma_f32_16x16x32_bf16 v[36:39], a[160:163], a[0:3], 0
s_waitcnt lgkmcnt(2)
v_exp_f32 v40, v40
v_mfma_f32_16x16x32_bf16 v[36:39], a[164:167], a[4:7], v[36:39]
ds_read_b64_tr_b16 a[212:213], v11 offset:49152
v_fmamk_f32 v41, v41, 0x3e0293ee, v26
v_mfma_f32_16x16x32_bf16 v[36:39], a[168:171], a[8:11], v[36:39]
v_exp_f32 v41, v41
v_mfma_f32_16x16x32_bf16 v[36:39], a[172:175], a[12:15], v[36:39]
ds_read_b64_tr_b16 a[214:215], v11 offset:53248
v_fmamk_f32 v42, v42, 0x3e0293ee, v26
v_mfma_f32_16x16x32_bf16 v[160:163], a[192:195], v[52:55], v[160:163]
v_exp_f32 v42, v42
v_mfma_f32_16x16x32_bf16 v[164:167], a[196:199], v[52:55], v[164:167]
ds_read_b64_tr_b16 a[216:217], v12 offset:49152
v_fmamk_f32 v43, v43, 0x3e0293ee, v26
v_mfma_f32_16x16x32_bf16 v[168:171], a[200:203], v[52:55], v[168:171]
v_exp_f32 v43, v43
v_mfma_f32_16x16x32_bf16 v[172:175], a[204:207], v[52:55], v[172:175]
ds_read_b64_tr_b16 a[218:219], v12 offset:53248
v_cvt_pk_bf16_f32 v58, v40, v41
v_mfma_f32_16x16x32_bf16 a[228:231], a[244:247], v[48:51], a[228:231]
v_cvt_pk_bf16_f32 v59, v42, v43
v_fmamk_f32 v32, v32, 0x3e0293ee, v27
v_mfma_f32_16x16x32_bf16 v[40:43], a[160:163], a[16:19], 0
v_exp_f32 v32, v32
v_mfma_f32_16x16x32_bf16 v[40:43], a[164:167], a[20:23], v[40:43]
buffer_load_dwordx4 v16, s[24:27], s31 offen nt lds
v_fmamk_f32 v33, v33, 0x3e0293ee, v27
v_mfma_f32_16x16x32_bf16 v[40:43], a[168:171], a[24:27], v[40:43]
v_exp_f32 v33, v33
v_mfma_f32_16x16x32_bf16 v[40:43], a[172:175], a[28:31], v[40:43]
ds_read_b64_tr_b16 a[220:221], v13 offset:49152
v_fmamk_f32 v34, v34, 0x3e0293ee, v27
v_mfma_f32_16x16x32_bf16 v[192:195], a[192:195], v[56:59], v[192:195]
v_exp_f32 v34, v34
v_mfma_f32_16x16x32_bf16 v[196:199], a[196:199], v[56:59], v[196:199]
ds_read_b64_tr_b16 a[222:223], v13 offset:53248
v_fmamk_f32 v35, v35, 0x3e0293ee, v27
v_mfma_f32_16x16x32_bf16 v[200:203], a[200:203], v[56:59], v[200:203]
v_exp_f32 v35, v35
v_mfma_f32_16x16x32_bf16 v[204:207], a[204:207], v[56:59], v[204:207]
v_cvt_pk_bf16_f32 v62, v32, v33
v_cvt_pk_bf16_f32 v63, v34, v35
v_mfma_f32_16x16x32_bf16 v[32:35], a[160:163], a[32:35], 0
ds_read_b128 a[176:179], v44 offset:53248
v_fmamk_f32 v36, v36, 0x3e0293ee, v23
v_mfma_f32_16x16x32_bf16 v[32:35], a[164:167], a[36:39], v[32:35]
v_exp_f32 v36, v36
v_mfma_f32_16x16x32_bf16 v[32:35], a[168:171], a[40:43], v[32:35]
ds_read_b128 a[180:183], v45 offset:53248
v_fmamk_f32 v37, v37, 0x3e0293ee, v23
v_mfma_f32_16x16x32_bf16 v[32:35], a[172:175], a[44:47], v[32:35]
v_exp_f32 v37, v37
v_mfma_f32_16x16x32_bf16 v[224:227], a[192:195], v[60:63], v[224:227]
ds_read_b128 a[184:187], v46 offset:53248
v_fmamk_f32 v38, v38, 0x3e0293ee, v23
v_mfma_f32_16x16x32_bf16 v[228:231], a[196:199], v[60:63], v[228:231]
v_exp_f32 v38, v38
v_mfma_f32_16x16x32_bf16 v[232:235], a[200:203], v[60:63], v[232:235]
ds_read_b128 a[188:191], v47 offset:53248
v_fmamk_f32 v39, v39, 0x3e0293ee, v23
v_mfma_f32_16x16x32_bf16 v[236:239], a[204:207], v[60:63], v[236:239]
v_exp_f32 v39, v39
v_mfma_f32_16x16x32_bf16 a[232:235], a[244:247], v[52:55], a[232:235]
s_waitcnt lgkmcnt(3)
v_cvt_pk_bf16_f32 v64, v36, v37
v_cvt_pk_bf16_f32 v65, v38, v39
v_mfma_f32_16x16x32_bf16 v[112:115], a[208:211], v[76:79], v[112:115]
v_fmamk_f32 v40, v40, 0x3e0293ee, v24
v_fmamk_f32 v41, v41, 0x3e0293ee, v24
v_mfma_f32_16x16x32_bf16 v[116:119], a[212:215], v[76:79], v[116:119]
v_exp_f32 v40, v40
v_mfma_f32_16x16x32_bf16 v[120:123], a[216:219], v[76:79], v[120:123]
v_exp_f32 v41, v41
v_mfma_f32_16x16x32_bf16 v[124:127], a[220:223], v[76:79], v[124:127]
buffer_load_dwordx4 v17, s[24:27], s31 offen offset:1024 nt lds
buffer_load_dwordx4 a[152:155], v28, s[8:11], 0 offen offset:128
v_mfma_f32_16x16x32_bf16 v[36:39], a[160:163], a[48:51], 0
s_add_u32 m0, s32, 32768
v_fmamk_f32 v42, v42, 0x3e0293ee, v24
v_fmamk_f32 v43, v43, 0x3e0293ee, v24
v_mfma_f32_16x16x32_bf16 v[36:39], a[164:167], a[52:55], v[36:39]
s_add_u32 s31, s29, 32768
v_exp_f32 v42, v42
v_mfma_f32_16x16x32_bf16 v[36:39], a[168:171], a[56:59], v[36:39]
v_exp_f32 v43, v43
v_mfma_f32_16x16x32_bf16 v[36:39], a[172:175], a[60:63], v[36:39]
v_cvt_pk_bf16_f32 v68, v40, v41
v_cvt_pk_bf16_f32 v69, v42, v43
v_mfma_f32_16x16x32_bf16 v[144:147], a[208:211], v[48:51], v[144:147]
buffer_load_dwordx4 a[156:159], v28, s[8:11], 0 offen offset:192
v_fmamk_f32 v32, v32, 0x3e0293ee, v25
v_mfma_f32_16x16x32_bf16 v[148:151], a[212:215], v[48:51], v[148:151]
v_exp_f32 v32, v32
v_mfma_f32_16x16x32_bf16 v[152:155], a[216:219], v[48:51], v[152:155]
v_fmamk_f32 v33, v33, 0x3e0293ee, v25
v_fmamk_f32 v34, v34, 0x3e0293ee, v25
v_mfma_f32_16x16x32_bf16 v[156:159], a[220:223], v[48:51], v[156:159]
v_exp_f32 v33, v33
v_mfma_f32_16x16x32_bf16 a[236:239], a[244:247], v[56:59], a[236:239]
s_waitcnt vmcnt(13) lgkmcnt(0)
v_exp_f32 v34, v34
v_mfma_f32_16x16x32_bf16 v[40:43], a[176:179], a[0:3], 0
s_barrier
v_fmamk_f32 v35, v35, 0x3e0293ee, v25
v_cvt_pk_bf16_f32 v72, v32, v33
v_mfma_f32_16x16x32_bf16 v[40:43], a[180:183], a[4:7], v[40:43]
v_exp_f32 v35, v35
v_mfma_f32_16x16x32_bf16 v[40:43], a[184:187], a[8:11], v[40:43]
ds_read_b64_tr_b16 a[192:193], v80 offset:49152
v_cvt_pk_bf16_f32 v73, v34, v35
v_mfma_f32_16x16x32_bf16 v[40:43], a[188:191], a[12:15], v[40:43]
ds_read_b64_tr_b16 a[194:195], v80 offset:53248
v_fmamk_f32 v36, v36, 0x3e0293ee, v26
v_mfma_f32_16x16x32_bf16 v[176:179], a[208:211], v[52:55], v[176:179]
v_exp_f32 v36, v36
v_mfma_f32_16x16x32_bf16 v[180:183], a[212:215], v[52:55], v[180:183]
buffer_load_dwordx4 v14, s[20:23], s30 offen nt lds
v_fmamk_f32 v37, v37, 0x3e0293ee, v26
v_mfma_f32_16x16x32_bf16 v[184:187], a[216:219], v[52:55], v[184:187]
v_exp_f32 v37, v37
v_mfma_f32_16x16x32_bf16 v[188:191], a[220:223], v[52:55], v[188:191]
ds_read_b64_tr_b16 a[196:197], v81 offset:49152
v_fmamk_f32 v38, v38, 0x3e0293ee, v26
v_mfma_f32_16x16x32_bf16 v[32:35], a[176:179], a[16:19], 0
v_exp_f32 v38, v38
v_mfma_f32_16x16x32_bf16 v[32:35], a[180:183], a[20:23], v[32:35]
ds_read_b64_tr_b16 a[198:199], v81 offset:53248
v_fmamk_f32 v39, v39, 0x3e0293ee, v26
v_mfma_f32_16x16x32_bf16 v[32:35], a[184:187], a[24:27], v[32:35]
v_exp_f32 v39, v39
v_mfma_f32_16x16x32_bf16 v[32:35], a[188:191], a[28:31], v[32:35]
ds_read_b64_tr_b16 a[200:201], v82 offset:49152
v_cvt_pk_bf16_f32 v76, v36, v37
v_mfma_f32_16x16x32_bf16 v[208:211], a[208:211], v[56:59], v[208:211]
ds_read_b64_tr_b16 a[202:203], v82 offset:53248
v_cvt_pk_bf16_f32 v77, v38, v39
v_mfma_f32_16x16x32_bf16 v[212:215], a[212:215], v[56:59], v[212:215]
ds_read_b64_tr_b16 a[204:205], v83 offset:49152
v_fmamk_f32 v40, v40, 0x3e0293ee, v23
v_mfma_f32_16x16x32_bf16 v[216:219], a[216:219], v[56:59], v[216:219]
v_exp_f32 v40, v40
v_mfma_f32_16x16x32_bf16 v[220:223], a[220:223], v[56:59], v[220:223]
ds_read_b64_tr_b16 a[206:207], v83 offset:53248
v_fmamk_f32 v41, v41, 0x3e0293ee, v23
v_mfma_f32_16x16x32_bf16 a[240:243], a[244:247], v[60:63], a[240:243]
v_exp_f32 v41, v41
v_mfma_f32_16x16x32_bf16 v[36:39], a[176:179], a[32:35], 0
v_fmamk_f32 v42, v42, 0x3e0293ee, v23
v_fmamk_f32 v43, v43, 0x3e0293ee, v23
v_mfma_f32_16x16x32_bf16 v[36:39], a[180:183], a[36:39], v[36:39]
v_exp_f32 v42, v42
v_mfma_f32_16x16x32_bf16 v[36:39], a[184:187], a[40:43], v[36:39]
v_exp_f32 v43, v43
v_mfma_f32_16x16x32_bf16 v[36:39], a[188:191], a[44:47], v[36:39]
v_cvt_pk_bf16_f32 v66, v40, v41
v_cvt_pk_bf16_f32 v67, v42, v43
v_mfma_f32_16x16x32_bf16 v[240:243], a[208:211], v[60:63], v[240:243]
buffer_load_dwordx4 v15, s[20:23], s30 offen offset:1024 nt lds
v_xor_b32 v2, s77, v2
v_mfma_f32_16x16x32_bf16 v[244:247], a[212:215], v[60:63], v[244:247]
s_add_u32 m0, s32, 98304
ds_read_b128 a[160:163], v2 offset:0
v_xor_b32 v3, s77, v3
v_mfma_f32_16x16x32_bf16 v[248:251], a[216:219], v[60:63], v[248:251]
s_add_u32 s30, s29, 40960
ds_read_b128 a[164:167], v3 offset:0
v_xor_b32 v4, s77, v4
v_mfma_f32_16x16x32_bf16 v[252:255], a[220:223], v[60:63], v[252:255]
L_pad1_6:
s_cbranch_execz L_pad1_10
ds_read_b128 a[168:171], v4 offset:0
v_xor_b32 v5, s77, v5
v_mfma_f32_16x16x32_bf16 v[40:43], a[176:179], a[48:51], 0
ds_read_b128 a[172:175], v5 offset:0
v_accvgpr_read_b32 v94, a240
v_mfma_f32_16x16x32_bf16 v[40:43], a[180:183], a[52:55], v[40:43]
ds_write_b128 v29, v[240:243] offset:2304
v_mov_b32 v95, v27
v_mfma_f32_16x16x32_bf16 v[40:43], a[184:187], a[56:59], v[40:43]
ds_write_b64 v29, v[94:95] offset:6400
v_fmamk_f32 v32, v32, 0x3e0293ee, v24
v_mfma_f32_16x16x32_bf16 v[40:43], a[188:191], a[60:63], v[40:43]
s_waitcnt lgkmcnt(6)
v_exp_f32 v32, v32
v_mfma_f32_16x16x32_bf16 v[96:99], a[192:195], v[64:67], v[96:99]
ds_write_b128 v29, v[244:247] offset:3328
v_fmamk_f32 v33, v33, 0x3e0293ee, v24
v_mfma_f32_16x16x32_bf16 v[100:103], a[196:199], v[64:67], v[100:103]
v_exp_f32 v33, v33
v_mfma_f32_16x16x32_bf16 v[104:107], a[200:203], v[64:67], v[104:107]
ds_write_b128 v29, v[248:251] offset:4352
v_fmamk_f32 v34, v34, 0x3e0293ee, v24
v_mfma_f32_16x16x32_bf16 v[108:111], a[204:207], v[64:67], v[108:111]
v_exp_f32 v34, v34
v_fmamk_f32 v35, v35, 0x3e0293ee, v24
v_mov_b32 v92, v94
v_exp_f32 v35, v35
v_mfma_f32_16x16x32_bf16 a[224:227], a[244:247], v[64:67], a[224:227]
s_waitcnt lgkmcnt(4)
v_cvt_pk_bf16_f32 v70, v32, v33
v_cvt_pk_bf16_f32 v71, v34, v35
v_mov_b32 v31, v27
v_mfma_f32_16x16x32_bf16 v[32:35], a[160:163], a[80:83], 0
ds_write_b128 v29, v[252:255] offset:5376
v_fmamk_f32 v36, v36, 0x3e0293ee, v25
v_mfma_f32_16x16x32_bf16 v[32:35], a[164:167], a[84:87], v[32:35]
v_exp_f32 v36, v36
v_mfma_f32_16x16x32_bf16 v[32:35], a[168:171], a[88:91], v[32:35]
v_fmamk_f32 v37, v37, 0x3e0293ee, v25
v_fmamk_f32 v38, v38, 0x3e0293ee, v25
v_mfma_f32_16x16x32_bf16 v[32:35], a[172:175], a[92:95], v[32:35]
v_exp_f32 v37, v37
v_mfma_f32_16x16x32_bf16 v[128:131], a[192:195], v[68:71], v[128:131]
v_exp_f32 v38, v38
v_mfma_f32_16x16x32_bf16 v[132:135], a[196:199], v[68:71], v[132:135]
buffer_load_dwordx4 v16, s[24:27], s31 offen nt lds
v_fmamk_f32 v39, v39, 0x3e0293ee, v25
v_mfma_f32_16x16x32_bf16 v[136:139], a[200:203], v[68:71], v[136:139]
v_exp_f32 v39, v39
v_mfma_f32_16x16x32_bf16 v[140:143], a[204:207], v[68:71], v[140:143]
v_cvt_pk_bf16_f32 v74, v36, v37
v_cvt_pk_bf16_f32 v75, v38, v39
v_mfma_f32_16x16x32_bf16 v[36:39], a[160:163], a[96:99], 0
ds_read_b64_tr_b16 a[208:209], v84 offset:49152
v_fmamk_f32 v40, v40, 0x3e0293ee, v26
v_mfma_f32_16x16x32_bf16 v[36:39], a[164:167], a[100:103], v[36:39]
s_waitcnt lgkmcnt(1)
v_exp_f32 v40, v40
v_mfma_f32_16x16x32_bf16 v[36:39], a[168:171], a[104:107], v[36:39]
s_barrier
ds_read_b64 v[94:95], v30 offset:6400
v_fmamk_f32 v41, v41, 0x3e0293ee, v26
v_mfma_f32_16x16x32_bf16 v[36:39], a[172:175], a[108:111], v[36:39]
v_exp_f32 v41, v41
v_mfma_f32_16x16x32_bf16 v[160:163], a[192:195], v[72:75], v[160:163]
ds_read_b128 v[240:243], v30 offset:2304
v_fmamk_f32 v42, v42, 0x3e0293ee, v26
v_mfma_f32_16x16x32_bf16 v[164:167], a[196:199], v[72:75], v[164:167]
v_exp_f32 v42, v42
v_mfma_f32_16x16x32_bf16 v[168:171], a[200:203], v[72:75], v[168:171]
ds_read_b128 v[244:247], v30 offset:3328
v_fmamk_f32 v43, v43, 0x3e0293ee, v26
v_mfma_f32_16x16x32_bf16 v[172:175], a[204:207], v[72:75], v[172:175]
v_exp_f32 v43, v43
v_mfma_f32_16x16x32_bf16 a[228:231], a[244:247], v[68:71], a[228:231]
v_cvt_pk_bf16_f32 v78, v40, v41
v_cvt_pk_bf16_f32 v79, v42, v43
v_mfma_f32_16x16x32_bf16 v[40:43], a[160:163], a[112:115], 0
s_waitcnt lgkmcnt(2)
ds_read_b128 v[248:251], v30 offset:4352
v_sub_f32 v31, v31, v95
v_mfma_f32_16x16x32_bf16 v[40:43], a[164:167], a[116:119], v[40:43]
ds_read_b128 v[252:255], v30 offset:5376
v_cmp_nge_f32 vcc, s34, v94
v_mfma_f32_16x16x32_bf16 v[40:43], a[168:171], a[120:123], v[40:43]
s_or_b64 s[40:41], s[40:41], vcc
v_exp_f32 v31, v31
v_mfma_f32_16x16x32_bf16 v[40:43], a[172:175], a[124:127], v[40:43]
ds_read_b64_tr_b16 a[210:211], v84 offset:53248
v_max3_f32 v23, v32, v33, v34
v_mfma_f32_16x16x32_bf16 v[192:195], a[192:195], v[76:79], v[192:195]
v_max_f32 v23, v23, v35
v_mov_b32 v93, v23
v_mfma_f32_16x16x32_bf16 v[196:199], a[196:199], v[76:79], v[196:199]
ds_read_b64_tr_b16 a[212:213], v85 offset:49152
ds_read_b64_tr_b16 a[214:215], v85 offset:53248
v_fmac_f32 v92, v94, v31
v_permlane32_swap_b32 v93, v23
v_cmp_nge_f32 vcc, s34, v92
v_max_f32 v23, v23, v93
v_mov_b32 v93, v23
v_mfma_f32_16x16x32_bf16 v[200:203], a[200:203], v[76:79], v[200:203]
s_or_b64 s[40:41], s[40:41], vcc
ds_read_b64_tr_b16 a[216:217], v86 offset:49152
ds_read_b64_tr_b16 a[218:219], v86 offset:53248
v_permlane16_swap_b32 v93, v23
v_max_f32 v23, v23, v93
v_mul_f32 v23, 0xbe0293ee, v23
v_fmamk_f32 v32, v32, 0x3e0293ee, v23
v_fmamk_f32 v33, v33, 0x3e0293ee, v23
v_fmamk_f32 v34, v34, 0x3e0293ee, v23
v_exp_f32 v32, v32
v_exp_f32 v33, v33
v_exp_f32 v34, v34
v_fmamk_f32 v35, v35, 0x3e0293ee, v23
v_exp_f32 v35, v35
v_mfma_f32_16x16x32_bf16 v[204:207], a[204:207], v[76:79], v[204:207]
s_waitcnt lgkmcnt(7)
ds_read_b64_tr_b16 a[220:221], v87 offset:49152
ds_read_b64_tr_b16 a[222:223], v87 offset:53248
v_rcp_f32 v92, v92
v_fmac_f32 v224, v240, v31
v_cvt_pk_bf16_f32 v48, v32, v33
v_cvt_pk_bf16_f32 v49, v34, v35
v_mfma_f32_16x16x32_bf16 v[32:35], a[160:163], a[128:131], 0
v_fmac_f32 v225, v241, v31
v_fmac_f32 v226, v242, v31
v_mfma_f32_16x16x32_bf16 v[32:35], a[164:167], a[132:135], v[32:35]
v_fmac_f32 v227, v243, v31
v_fmac_f32 v228, v244, v31
v_mfma_f32_16x16x32_bf16 v[32:35], a[168:171], a[136:139], v[32:35]
s_waitcnt vmcnt(15)
v_fmac_f32 v229, v245, v31
v_fmac_f32 v230, v246, v31
v_mfma_f32_16x16x32_bf16 v[32:35], a[172:175], a[140:143], v[32:35]
s_waitcnt lgkmcnt(6)
v_fmac_f32 v231, v247, v31
v_fmac_f32 v232, v248, v31
v_mfma_f32_16x16x32_bf16 v[112:115], a[208:211], v[64:67], v[112:115]
s_waitcnt lgkmcnt(4)
v_fmac_f32 v233, v249, v31
v_fmac_f32 v234, v250, v31
v_mfma_f32_16x16x32_bf16 v[116:119], a[212:215], v[64:67], v[116:119]
s_waitcnt lgkmcnt(2)
v_fmac_f32 v235, v251, v31
v_fmac_f32 v236, v252, v31
v_max3_f32 v24, v36, v37, v38
v_max_f32 v24, v24, v39
v_mov_b32 v93, v24
v_mfma_f32_16x16x32_bf16 v[120:123], a[216:219], v[64:67], v[120:123]
s_waitcnt lgkmcnt(0)
v_fmac_f32 v237, v253, v31
v_fmac_f32 v238, v254, v31
v_permlane32_swap_b32 v93, v24
v_max_f32 v24, v24, v93
v_mov_b32 v93, v24
v_mfma_f32_16x16x32_bf16 v[124:127], a[220:223], v[64:67], v[124:127]
v_fmac_f32 v239, v255, v31
v_permlane16_swap_b32 v93, v24
v_max_f32 v24, v24, v93
v_mul_f32 v24, 0xbe0293ee, v24
v_fmamk_f32 v36, v36, 0x3e0293ee, v24
v_fmamk_f32 v37, v37, 0x3e0293ee, v24
v_fmamk_f32 v38, v38, 0x3e0293ee, v24
v_exp_f32 v36, v36
v_exp_f32 v37, v37
v_exp_f32 v38, v38
v_fmamk_f32 v39, v39, 0x3e0293ee, v24
v_exp_f32 v39, v39
v_mfma_f32_16x16x32_bf16 a[232:235], a[244:247], v[72:75], a[232:235]
s_waitcnt vmcnt(14)
buffer_load_dwordx4 v17, s[24:27], s31 offen offset:1024 nt lds
v_cvt_pk_bf16_f32 v52, v36, v37
v_cvt_pk_bf16_f32 v53, v38, v39
v_mfma_f32_16x16x32_bf16 v[36:39], a[160:163], a[144:147], 0
s_waitcnt vmcnt(10)
s_add_u32 m0, s32, 40960
ds_read_b128 a[176:179], v2 offset:4096
v_max3_f32 v25, v40, v41, v42
v_mfma_f32_16x16x32_bf16 v[36:39], a[164:167], a[148:151], v[36:39]
s_waitcnt vmcnt(5)
s_add_u32 s31, s29, 40960
ds_read_b128 a[180:183], v3 offset:4096
v_max_f32 v25, v25, v43
v_mfma_f32_16x16x32_bf16 v[36:39], a[168:171], a[152:155], v[36:39]
s_waitcnt vmcnt(4)
ds_read_b128 a[184:187], v4 offset:4096
v_mov_b32 v93, v25
v_mfma_f32_16x16x32_bf16 v[36:39], a[172:175], a[156:159], v[36:39]
ds_read_b128 a[188:191], v5 offset:4096
v_pk_mul_f32 v[224:225], v[224:225], v[92:93] op_sel:[0,0] op_sel_hi:[1,0]
v_pk_mul_f32 v[226:227], v[226:227], v[92:93] op_sel:[0,0] op_sel_hi:[1,0]
v_pk_mul_f32 v[228:229], v[228:229], v[92:93] op_sel:[0,0] op_sel_hi:[1,0]
v_cvt_pk_bf16_f32 v224, v224, v225
v_cvt_pk_bf16_f32 v225, v226, v227
v_pk_mul_f32 v[230:231], v[230:231], v[92:93] op_sel:[0,0] op_sel_hi:[1,0]
v_cvt_pk_bf16_f32 v228, v228, v229
v_pk_mul_f32 v[232:233], v[232:233], v[92:93] op_sel:[0,0] op_sel_hi:[1,0]
v_cvt_pk_bf16_f32 v229, v230, v231
v_pk_mul_f32 v[234:235], v[234:235], v[92:93] op_sel:[0,0] op_sel_hi:[1,0]
v_cvt_pk_bf16_f32 v232, v232, v233
v_pk_mul_f32 v[236:237], v[236:237], v[92:93] op_sel:[0,0] op_sel_hi:[1,0]
v_cvt_pk_bf16_f32 v233, v234, v235
v_pk_mul_f32 v[238:239], v[238:239], v[92:93] op_sel:[0,0] op_sel_hi:[1,0]
v_cvt_pk_bf16_f32 v236, v236, v237
v_accvgpr_read_b32 v88, a224
v_cvt_pk_bf16_f32 v237, v238, v239
v_mfma_f32_16x16x32_bf16 v[144:147], a[208:211], v[68:71], v[144:147]
ds_write2_b64 v20, v[224:225], v[228:229] offset0:0 offset1:4
ds_write2_b64 v20, v[232:233], v[236:237] offset0:8 offset1:12
v_permlane32_swap_b32 v93, v25
v_mfma_f32_16x16x32_bf16 v[148:151], a[212:215], v[68:71], v[148:151]
v_max_f32 v25, v25, v93
v_mov_b32 v93, v25
v_mfma_f32_16x16x32_bf16 v[152:155], a[216:219], v[68:71], v[152:155]
s_nop 0
v_permlane16_swap_b32 v93, v25
v_max_f32 v25, v25, v93
v_mul_f32 v25, 0xbe0293ee, v25
v_fmamk_f32 v40, v40, 0x3e0293ee, v25
v_fmamk_f32 v41, v41, 0x3e0293ee, v25
v_fmamk_f32 v42, v42, 0x3e0293ee, v25
v_exp_f32 v40, v40
v_exp_f32 v41, v41
v_exp_f32 v42, v42
v_fmamk_f32 v43, v43, 0x3e0293ee, v25
v_exp_f32 v43, v43
v_mfma_f32_16x16x32_bf16 v[156:159], a[220:223], v[68:71], v[156:159]
s_waitcnt lgkmcnt(5)
v_cvt_pk_bf16_f32 v56, v40, v41
v_cvt_pk_bf16_f32 v57, v42, v43
v_mfma_f32_16x16x32_bf16 v[40:43], a[176:179], a[80:83], 0
s_waitcnt lgkmcnt(3)
v_cmp_nge_f32 vcc, s34, v88
v_max3_f32 v26, v32, v33, v34
v_mfma_f32_16x16x32_bf16 v[40:43], a[180:183], a[84:87], v[40:43]
s_or_b64 s[40:41], s[40:41], vcc
v_rcp_f32 v88, v88
v_mfma_f32_16x16x32_bf16 v[40:43], a[184:187], a[88:91], v[40:43]
s_waitcnt lgkmcnt(2)
v_max_f32 v26, v26, v35
v_mov_b32 v93, v26
v_mfma_f32_16x16x32_bf16 v[40:43], a[188:191], a[92:95], v[40:43]
ds_read_b128 a[64:67], v21 offset:0
ds_read_b128 a[68:71], v21 offset:1152
v_pk_mul_f32 v[96:97], v[96:97], v[88:89] op_sel:[0,0] op_sel_hi:[1,0]
v_pk_mul_f32 v[98:99], v[98:99], v[88:89] op_sel:[0,0] op_sel_hi:[1,0]
v_pk_mul_f32 v[100:101], v[100:101], v[88:89] op_sel:[0,0] op_sel_hi:[1,0]
v_cvt_pk_bf16_f32 v96, v96, v97
v_cvt_pk_bf16_f32 v97, v98, v99
v_pk_mul_f32 v[102:103], v[102:103], v[88:89] op_sel:[0,0] op_sel_hi:[1,0]
v_cvt_pk_bf16_f32 v100, v100, v101
v_pk_mul_f32 v[104:105], v[104:105], v[88:89] op_sel:[0,0] op_sel_hi:[1,0]
v_cvt_pk_bf16_f32 v101, v102, v103
v_pk_mul_f32 v[106:107], v[106:107], v[88:89] op_sel:[0,0] op_sel_hi:[1,0]
v_cvt_pk_bf16_f32 v104, v104, v105
v_pk_mul_f32 v[108:109], v[108:109], v[88:89] op_sel:[0,0] op_sel_hi:[1,0]
v_cvt_pk_bf16_f32 v105, v106, v107
v_pk_mul_f32 v[110:111], v[110:111], v[88:89] op_sel:[0,0] op_sel_hi:[1,0]
v_cvt_pk_bf16_f32 v108, v108, v109
v_permlane32_swap_b32 v93, v26
v_cvt_pk_bf16_f32 v109, v110, v111
v_mfma_f32_16x16x32_bf16 v[176:179], a[208:211], v[72:75], v[176:179]
ds_write2_b64 v20, v[96:97], v[100:101] offset0:0 offset1:4
ds_write2_b64 v20, v[104:105], v[108:109] offset0:8 offset1:12
buffer_load_dwordx4 v14, s[20:23], s30 offen nt lds
v_max_f32 v26, v26, v93
v_mfma_f32_16x16x32_bf16 v[180:183], a[212:215], v[72:75], v[180:183]
v_mov_b32 v93, v26
v_accvgpr_read_b32 v89, a228
v_mfma_f32_16x16x32_bf16 v[184:187], a[216:219], v[72:75], v[184:187]
v_permlane16_swap_b32 v93, v26
v_mfma_f32_16x16x32_bf16 v[188:191], a[220:223], v[72:75], v[188:191]
v_max_f32 v26, v26, v93
v_mul_f32 v26, 0xbe0293ee, v26
v_fmamk_f32 v32, v32, 0x3e0293ee, v26
v_fmamk_f32 v33, v33, 0x3e0293ee, v26
v_fmamk_f32 v34, v34, 0x3e0293ee, v26
v_exp_f32 v32, v32
v_exp_f32 v33, v33
v_exp_f32 v34, v34
v_fmamk_f32 v35, v35, 0x3e0293ee, v26
v_exp_f32 v35, v35
v_mfma_f32_16x16x32_bf16 a[236:239], a[244:247], v[76:79], a[236:239]
v_cvt_pk_bf16_f32 v60, v32, v33
v_cvt_pk_bf16_f32 v61, v34, v35
v_mfma_f32_16x16x32_bf16 v[32:35], a[176:179], a[96:99], 0
v_cmp_nge_f32 vcc, s34, v89
v_max3_f32 v27, v36, v37, v38
v_mfma_f32_16x16x32_bf16 v[32:35], a[180:183], a[100:103], v[32:35]
s_or_b64 s[40:41], s[40:41], vcc
v_rcp_f32 v89, v89
v_mfma_f32_16x16x32_bf16 v[32:35], a[184:187], a[104:107], v[32:35]
ds_read_b128 a[0:3], v21 offset:0
ds_read_b128 a[4:7], v21 offset:1152
v_pk_mul_f32 v[128:129], v[128:129], v[88:89] op_sel:[0,1] op_sel_hi:[1,1]
v_pk_mul_f32 v[130:131], v[130:131], v[88:89] op_sel:[0,1] op_sel_hi:[1,1]
v_pk_mul_f32 v[132:133], v[132:133], v[88:89] op_sel:[0,1] op_sel_hi:[1,1]
v_cvt_pk_bf16_f32 v128, v128, v129
v_cvt_pk_bf16_f32 v129, v130, v131
v_pk_mul_f32 v[134:135], v[134:135], v[88:89] op_sel:[0,1] op_sel_hi:[1,1]
v_cvt_pk_bf16_f32 v132, v132, v133
v_pk_mul_f32 v[136:137], v[136:137], v[88:89] op_sel:[0,1] op_sel_hi:[1,1]
v_cvt_pk_bf16_f32 v133, v134, v135
v_pk_mul_f32 v[138:139], v[138:139], v[88:89] op_sel:[0,1] op_sel_hi:[1,1]
v_cvt_pk_bf16_f32 v136, v136, v137
v_pk_mul_f32 v[140:141], v[140:141], v[88:89] op_sel:[0,1] op_sel_hi:[1,1]
v_cvt_pk_bf16_f32 v137, v138, v139
v_pk_mul_f32 v[142:143], v[142:143], v[88:89] op_sel:[0,1] op_sel_hi:[1,1]
v_cvt_pk_bf16_f32 v140, v140, v141
v_max_f32 v27, v27, v39
v_cvt_pk_bf16_f32 v141, v142, v143
v_mov_b32 v93, v27
v_mfma_f32_16x16x32_bf16 v[32:35], a[188:191], a[108:111], v[32:35]
ds_write2_b64 v20, v[128:129], v[132:133] offset0:0 offset1:4
ds_write2_b64 v20, v[136:137], v[140:141] offset0:8 offset1:12
v_permlane32_swap_b32 v93, v27
v_mfma_f32_16x16x32_bf16 v[208:211], a[208:211], v[76:79], v[208:211]
v_max_f32 v27, v27, v93
v_mov_b32 v93, v27
v_mfma_f32_16x16x32_bf16 v[212:215], a[212:215], v[76:79], v[212:215]
s_nop 0
v_permlane16_swap_b32 v93, v27
v_mfma_f32_16x16x32_bf16 v[216:219], a[216:219], v[76:79], v[216:219]
v_max_f32 v27, v27, v93
v_mul_f32 v27, 0xbe0293ee, v27
v_fmamk_f32 v36, v36, 0x3e0293ee, v27
v_fmamk_f32 v37, v37, 0x3e0293ee, v27
v_fmamk_f32 v38, v38, 0x3e0293ee, v27
v_exp_f32 v36, v36
v_exp_f32 v37, v37
v_exp_f32 v38, v38
v_fmamk_f32 v39, v39, 0x3e0293ee, v27
v_exp_f32 v39, v39
v_mfma_f32_16x16x32_bf16 v[220:223], a[220:223], v[76:79], v[220:223]
v_cvt_pk_bf16_f32 v64, v36, v37
v_cvt_pk_bf16_f32 v65, v38, v39
v_xor_b32 v6, s78, v6
v_mfma_f32_16x16x32_bf16 v[36:39], a[176:179], a[112:115], 0
ds_read_b64_tr_b16 a[192:193], v6 offset:0
ds_read_b64_tr_b16 a[194:195], v6 offset:4096
v_xor_b32 v7, s78, v7
v_mfma_f32_16x16x32_bf16 v[36:39], a[180:183], a[116:119], v[36:39]
ds_read_b64_tr_b16 a[196:197], v7 offset:0
ds_read_b64_tr_b16 a[198:199], v7 offset:4096
v_xor_b32 v8, s78, v8
v_mfma_f32_16x16x32_bf16 v[36:39], a[184:187], a[120:123], v[36:39]
ds_read_b128 a[16:19], v21 offset:0
ds_read_b128 a[20:23], v21 offset:1152
ds_read_b64_tr_b16 a[200:201], v8 offset:0
ds_read_b64_tr_b16 a[202:203], v8 offset:4096
v_pk_mul_f32 v[112:113], v[112:113], v[88:89] op_sel:[0,0] op_sel_hi:[1,0]
v_pk_mul_f32 v[114:115], v[114:115], v[88:89] op_sel:[0,0] op_sel_hi:[1,0]
v_pk_mul_f32 v[116:117], v[116:117], v[88:89] op_sel:[0,0] op_sel_hi:[1,0]
v_cvt_pk_bf16_f32 v112, v112, v113
v_cvt_pk_bf16_f32 v113, v114, v115
v_pk_mul_f32 v[118:119], v[118:119], v[88:89] op_sel:[0,0] op_sel_hi:[1,0]
v_cvt_pk_bf16_f32 v116, v116, v117
v_pk_mul_f32 v[120:121], v[120:121], v[88:89] op_sel:[0,0] op_sel_hi:[1,0]
v_cvt_pk_bf16_f32 v117, v118, v119
v_pk_mul_f32 v[122:123], v[122:123], v[88:89] op_sel:[0,0] op_sel_hi:[1,0]
v_cvt_pk_bf16_f32 v120, v120, v121
v_pk_mul_f32 v[124:125], v[124:125], v[88:89] op_sel:[0,0] op_sel_hi:[1,0]
v_cvt_pk_bf16_f32 v121, v122, v123
v_pk_mul_f32 v[126:127], v[126:127], v[88:89] op_sel:[0,0] op_sel_hi:[1,0]
v_cvt_pk_bf16_f32 v124, v124, v125
v_fmamk_f32 v40, v40, 0x3e0293ee, v23
v_cvt_pk_bf16_f32 v125, v126, v127
v_fmamk_f32 v41, v41, 0x3e0293ee, v23
v_exp_f32 v40, v40
v_fmamk_f32 v42, v42, 0x3e0293ee, v23
v_exp_f32 v41, v41
v_fmamk_f32 v43, v43, 0x3e0293ee, v23
v_exp_f32 v42, v42
v_xor_b32 v9, s78, v9
v_exp_f32 v43, v43
v_mfma_f32_16x16x32_bf16 v[36:39], a[188:191], a[124:127], v[36:39]
ds_write2_b64 v20, v[112:113], v[116:117] offset0:0 offset1:4
ds_write2_b64 v20, v[120:121], v[124:125] offset0:8 offset1:12
ds_read_b64_tr_b16 a[204:205], v9 offset:0
ds_read_b64_tr_b16 a[206:207], v9 offset:4096
v_cvt_pk_bf16_f32 v50, v40, v41
v_cvt_pk_bf16_f32 v51, v42, v43
v_mfma_f32_16x16x32_bf16 v[40:43], a[176:179], a[128:131], 0
ds_read_b128 a[160:163], v2 offset:8192
v_accvgpr_read_b32 v90, a232
v_mfma_f32_16x16x32_bf16 v[40:43], a[180:183], a[132:135], v[40:43]
ds_read_b128 a[164:167], v3 offset:8192
v_cmp_nge_f32 vcc, s34, v90
v_mfma_f32_16x16x32_bf16 v[40:43], a[184:187], a[136:139], v[40:43]
s_or_b64 s[40:41], s[40:41], vcc
v_rcp_f32 v90, v90
v_mfma_f32_16x16x32_bf16 v[40:43], a[188:191], a[140:143], v[40:43]
s_waitcnt lgkmcnt(12)
ds_read_b128 a[168:171], v4 offset:8192
v_fmamk_f32 v32, v32, 0x3e0293ee, v24
v_mfma_f32_16x16x32_bf16 v[96:99], a[192:195], v[48:51], 0
s_waitcnt lgkmcnt(11)
v_exp_f32 v32, v32
v_mfma_f32_16x16x32_bf16 v[100:103], a[196:199], v[48:51], 0
s_waitcnt lgkmcnt(7)
ds_read_b128 a[172:175], v5 offset:8192
v_fmamk_f32 v33, v33, 0x3e0293ee, v24
v_mfma_f32_16x16x32_bf16 v[104:107], a[200:203], v[48:51], 0
s_waitcnt lgkmcnt(4)
ds_read_b128 a[8:11], v21 offset:0
ds_read_b128 a[12:15], v21 offset:1152
v_pk_mul_f32 v[160:161], v[160:161], v[90:91] op_sel:[0,0] op_sel_hi:[1,0]
v_pk_mul_f32 v[162:163], v[162:163], v[90:91] op_sel:[0,0] op_sel_hi:[1,0]
v_pk_mul_f32 v[164:165], v[164:165], v[90:91] op_sel:[0,0] op_sel_hi:[1,0]
v_cvt_pk_bf16_f32 v160, v160, v161
v_cvt_pk_bf16_f32 v161, v162, v163
v_pk_mul_f32 v[166:167], v[166:167], v[90:91] op_sel:[0,0] op_sel_hi:[1,0]
v_cvt_pk_bf16_f32 v164, v164, v165
v_pk_mul_f32 v[168:169], v[168:169], v[90:91] op_sel:[0,0] op_sel_hi:[1,0]
v_cvt_pk_bf16_f32 v165, v166, v167
v_pk_mul_f32 v[170:171], v[170:171], v[90:91] op_sel:[0,0] op_sel_hi:[1,0]
v_cvt_pk_bf16_f32 v168, v168, v169
v_pk_mul_f32 v[172:173], v[172:173], v[90:91] op_sel:[0,0] op_sel_hi:[1,0]
v_cvt_pk_bf16_f32 v169, v170, v171
v_pk_mul_f32 v[174:175], v[174:175], v[90:91] op_sel:[0,0] op_sel_hi:[1,0]
v_cvt_pk_bf16_f32 v172, v172, v173
v_exp_f32 v33, v33
v_cvt_pk_bf16_f32 v173, v174, v175
v_mfma_f32_16x16x32_bf16 v[108:111], a[204:207], v[48:51], 0
ds_write2_b64 v20, v[160:161], v[164:165] offset0:0 offset1:4
ds_write2_b64 v20, v[168:169], v[172:173] offset0:8 offset1:12
v_fmamk_f32 v34, v34, 0x3e0293ee, v24
v_fmamk_f32 v35, v35, 0x3e0293ee, v24
v_exp_f32 v34, v34
v_exp_f32 v35, v35
v_mfma_f32_16x16x32_bf16 a[224:227], a[244:247], v[48:51], 0
v_cvt_pk_bf16_f32 v54, v32, v33
v_cvt_pk_bf16_f32 v55, v34, v35
v_mfma_f32_16x16x32_bf16 v[32:35], a[176:179], a[144:147], 0
buffer_load_dwordx4 v15, s[20:23], s30 offen offset:1024 nt lds
v_fmamk_f32 v36, v36, 0x3e0293ee, v25
v_mfma_f32_16x16x32_bf16 v[32:35], a[180:183], a[148:151], v[32:35]
s_add_u32 m0, s32, 106496
v_exp_f32 v36, v36
v_mfma_f32_16x16x32_bf16 v[32:35], a[184:187], a[152:155], v[32:35]
s_add_u32 s30, s29, 49152
v_fmamk_f32 v37, v37, 0x3e0293ee, v25
v_fmamk_f32 v38, v38, 0x3e0293ee, v25
v_mfma_f32_16x16x32_bf16 v[32:35], a[188:191], a[156:159], v[32:35]
v_exp_f32 v37, v37
v_mfma_f32_16x16x32_bf16 v[128:131], a[192:195], v[52:55], 0
v_exp_f32 v38, v38
v_mfma_f32_16x16x32_bf16 v[132:135], a[196:199], v[52:55], 0
ds_read_b128 a[32:35], v21 offset:0
ds_read_b128 a[36:39], v21 offset:1152
v_pk_mul_f32 v[144:145], v[144:145], v[88:89] op_sel:[0,1] op_sel_hi:[1,1]
v_pk_mul_f32 v[146:147], v[146:147], v[88:89] op_sel:[0,1] op_sel_hi:[1,1]
v_pk_mul_f32 v[148:149], v[148:149], v[88:89] op_sel:[0,1] op_sel_hi:[1,1]
v_cvt_pk_bf16_f32 v144, v144, v145
v_cvt_pk_bf16_f32 v145, v146, v147
v_pk_mul_f32 v[150:151], v[150:151], v[88:89] op_sel:[0,1] op_sel_hi:[1,1]
v_cvt_pk_bf16_f32 v148, v148, v149
v_pk_mul_f32 v[152:153], v[152:153], v[88:89] op_sel:[0,1] op_sel_hi:[1,1]
v_cvt_pk_bf16_f32 v149, v150, v151
v_pk_mul_f32 v[154:155], v[154:155], v[88:89] op_sel:[0,1] op_sel_hi:[1,1]
v_cvt_pk_bf16_f32 v152, v152, v153
v_pk_mul_f32 v[156:157], v[156:157], v[88:89] op_sel:[0,1] op_sel_hi:[1,1]
v_cvt_pk_bf16_f32 v153, v154, v155
v_pk_mul_f32 v[158:159], v[158:159], v[88:89] op_sel:[0,1] op_sel_hi:[1,1]
v_cvt_pk_bf16_f32 v156, v156, v157
v_fmamk_f32 v39, v39, 0x3e0293ee, v25
v_cvt_pk_bf16_f32 v157, v158, v159
v_cvt_pk_bf16_f32 v58, v36, v37
v_mfma_f32_16x16x32_bf16 v[136:139], a[200:203], v[52:55], 0
ds_write2_b64 v20, v[144:145], v[148:149] offset0:0 offset1:4
ds_write2_b64 v20, v[152:153], v[156:157] offset0:8 offset1:12
v_exp_f32 v39, v39
v_mfma_f32_16x16x32_bf16 v[140:143], a[204:207], v[52:55], 0
s_waitcnt lgkmcnt(4)
v_cvt_pk_bf16_f32 v59, v38, v39
v_fmamk_f32 v40, v40, 0x3e0293ee, v26
v_mfma_f32_16x16x32_bf16 v[36:39], a[160:163], a[80:83], 0
v_exp_f32 v40, v40
v_mfma_f32_16x16x32_bf16 v[36:39], a[164:167], a[84:87], v[36:39]
v_fmamk_f32 v41, v41, 0x3e0293ee, v26
v_fmamk_f32 v42, v42, 0x3e0293ee, v26
v_mfma_f32_16x16x32_bf16 v[36:39], a[168:171], a[88:91], v[36:39]
v_exp_f32 v41, v41
v_mfma_f32_16x16x32_bf16 v[36:39], a[172:175], a[92:95], v[36:39]
v_exp_f32 v42, v42
v_mfma_f32_16x16x32_bf16 v[160:163], a[192:195], v[56:59], 0
v_fmamk_f32 v43, v43, 0x3e0293ee, v26
v_cvt_pk_bf16_f32 v62, v40, v41
v_mfma_f32_16x16x32_bf16 v[164:167], a[196:199], v[56:59], 0
ds_read_b128 a[24:27], v21 offset:0
ds_read_b128 a[28:31], v21 offset:1152
v_pk_mul_f32 v[176:177], v[176:177], v[90:91] op_sel:[0,0] op_sel_hi:[1,0]
v_pk_mul_f32 v[178:179], v[178:179], v[90:91] op_sel:[0,0] op_sel_hi:[1,0]
v_pk_mul_f32 v[180:181], v[180:181], v[90:91] op_sel:[0,0] op_sel_hi:[1,0]
v_cvt_pk_bf16_f32 v176, v176, v177
v_cvt_pk_bf16_f32 v177, v178, v179
v_pk_mul_f32 v[182:183], v[182:183], v[90:91] op_sel:[0,0] op_sel_hi:[1,0]
v_cvt_pk_bf16_f32 v180, v180, v181
v_pk_mul_f32 v[184:185], v[184:185], v[90:91] op_sel:[0,0] op_sel_hi:[1,0]
v_cvt_pk_bf16_f32 v181, v182, v183
v_pk_mul_f32 v[186:187], v[186:187], v[90:91] op_sel:[0,0] op_sel_hi:[1,0]
v_cvt_pk_bf16_f32 v184, v184, v185
v_pk_mul_f32 v[188:189], v[188:189], v[90:91] op_sel:[0,0] op_sel_hi:[1,0]
v_cvt_pk_bf16_f32 v185, v186, v187
v_pk_mul_f32 v[190:191], v[190:191], v[90:91] op_sel:[0,0] op_sel_hi:[1,0]
v_cvt_pk_bf16_f32 v188, v188, v189
v_exp_f32 v43, v43
v_cvt_pk_bf16_f32 v189, v190, v191
v_mfma_f32_16x16x32_bf16 v[168:171], a[200:203], v[56:59], 0
ds_write2_b64 v20, v[176:177], v[180:181] offset0:0 offset1:4
ds_write2_b64 v20, v[184:185], v[188:189] offset0:8 offset1:12
v_cvt_pk_bf16_f32 v63, v42, v43
v_accvgpr_read_b32 v91, a236
v_mfma_f32_16x16x32_bf16 v[172:175], a[204:207], v[56:59], 0
v_cmp_nge_f32 vcc, s34, v91
v_fmamk_f32 v32, v32, 0x3e0293ee, v27
v_mfma_f32_16x16x32_bf16 a[228:231], a[244:247], v[52:55], 0
s_or_b64 s[40:41], s[40:41], vcc
v_rcp_f32 v91, v91
v_mfma_f32_16x16x32_bf16 v[40:43], a[160:163], a[96:99], 0
v_exp_f32 v32, v32
v_mfma_f32_16x16x32_bf16 v[40:43], a[164:167], a[100:103], v[40:43]
buffer_load_dwordx4 v16, s[24:27], s31 offen nt lds
v_fmamk_f32 v33, v33, 0x3e0293ee, v27
v_mfma_f32_16x16x32_bf16 v[40:43], a[168:171], a[104:107], v[40:43]
v_exp_f32 v33, v33
v_mfma_f32_16x16x32_bf16 v[40:43], a[172:175], a[108:111], v[40:43]
ds_read_b128 a[40:43], v21 offset:0
ds_read_b128 a[44:47], v21 offset:1152
v_pk_mul_f32 v[192:193], v[192:193], v[90:91] op_sel:[0,1] op_sel_hi:[1,1]
v_pk_mul_f32 v[194:195], v[194:195], v[90:91] op_sel:[0,1] op_sel_hi:[1,1]
v_cvt_pk_bf16_f32 v192, v192, v193
v_cvt_pk_bf16_f32 v193, v194, v195
v_pk_mul_f32 v[196:197], v[196:197], v[90:91] op_sel:[0,1] op_sel_hi:[1,1]
v_pk_mul_f32 v[198:199], v[198:199], v[90:91] op_sel:[0,1] op_sel_hi:[1,1]
v_cvt_pk_bf16_f32 v196, v196, v197
v_cvt_pk_bf16_f32 v197, v198, v199
ds_write2_b64 v20, v[192:193], v[196:197] offset0:0 offset1:4
v_fmamk_f32 v34, v34, 0x3e0293ee, v27
v_fmamk_f32 v35, v35, 0x3e0293ee, v27
v_mfma_f32_16x16x32_bf16 v[192:195], a[192:195], v[60:63], 0
v_pk_mul_f32 v[200:201], v[200:201], v[90:91] op_sel:[0,1] op_sel_hi:[1,1]
v_pk_mul_f32 v[202:203], v[202:203], v[90:91] op_sel:[0,1] op_sel_hi:[1,1]
v_pk_mul_f32 v[204:205], v[204:205], v[90:91] op_sel:[0,1] op_sel_hi:[1,1]
v_cvt_pk_bf16_f32 v200, v200, v201
v_cvt_pk_bf16_f32 v201, v202, v203
v_pk_mul_f32 v[206:207], v[206:207], v[90:91] op_sel:[0,1] op_sel_hi:[1,1]
v_cvt_pk_bf16_f32 v204, v204, v205
v_exp_f32 v34, v34
v_cvt_pk_bf16_f32 v205, v206, v207
v_mfma_f32_16x16x32_bf16 v[196:199], a[196:199], v[60:63], 0
ds_write2_b64 v20, v[200:201], v[204:205] offset0:8 offset1:12
v_exp_f32 v35, v35
v_mfma_f32_16x16x32_bf16 v[200:203], a[200:203], v[60:63], 0
v_cvt_pk_bf16_f32 v66, v32, v33
v_cvt_pk_bf16_f32 v67, v34, v35
v_mfma_f32_16x16x32_bf16 v[204:207], a[204:207], v[60:63], 0
v_xor_b32 v10, s78, v10
v_xor_b32 v11, s78, v11
v_mfma_f32_16x16x32_bf16 v[32:35], a[160:163], a[112:115], 0
ds_read_b64_tr_b16 a[208:209], v10 offset:0
v_xor_b32 v12, s78, v12
v_mfma_f32_16x16x32_bf16 v[32:35], a[164:167], a[116:119], v[32:35]
ds_read_b64_tr_b16 a[210:211], v10 offset:4096
v_xor_b32 v13, s78, v13
v_mfma_f32_16x16x32_bf16 v[32:35], a[168:171], a[120:123], v[32:35]
ds_read_b64_tr_b16 a[212:213], v11 offset:0
v_fmamk_f32 v36, v36, 0x3e0293ee, v23
v_mfma_f32_16x16x32_bf16 v[32:35], a[172:175], a[124:127], v[32:35]
ds_read_b64_tr_b16 a[214:215], v11 offset:4096
v_fmamk_f32 v37, v37, 0x3e0293ee, v23
v_mfma_f32_16x16x32_bf16 v[224:227], a[192:195], v[64:67], 0
ds_read_b128 a[48:51], v21 offset:0
ds_read_b128 a[52:55], v21 offset:1152
v_pk_mul_f32 v[208:209], v[208:209], v[90:91] op_sel:[0,1] op_sel_hi:[1,1]
v_pk_mul_f32 v[210:211], v[210:211], v[90:91] op_sel:[0,1] op_sel_hi:[1,1]
v_pk_mul_f32 v[212:213], v[212:213], v[90:91] op_sel:[0,1] op_sel_hi:[1,1]
v_cvt_pk_bf16_f32 v208, v208, v209
v_cvt_pk_bf16_f32 v209, v210, v211
v_pk_mul_f32 v[214:215], v[214:215], v[90:91] op_sel:[0,1] op_sel_hi:[1,1]
v_cvt_pk_bf16_f32 v212, v212, v213
v_pk_mul_f32 v[216:217], v[216:217], v[90:91] op_sel:[0,1] op_sel_hi:[1,1]
v_cvt_pk_bf16_f32 v213, v214, v215
v_pk_mul_f32 v[218:219], v[218:219], v[90:91] op_sel:[0,1] op_sel_hi:[1,1]
v_cvt_pk_bf16_f32 v216, v216, v217
v_pk_mul_f32 v[220:221], v[220:221], v[90:91] op_sel:[0,1] op_sel_hi:[1,1]
v_cvt_pk_bf16_f32 v217, v218, v219
v_pk_mul_f32 v[222:223], v[222:223], v[90:91] op_sel:[0,1] op_sel_hi:[1,1]
v_cvt_pk_bf16_f32 v220, v220, v221
v_exp_f32 v36, v36
v_cvt_pk_bf16_f32 v221, v222, v223
v_mfma_f32_16x16x32_bf16 v[228:231], a[196:199], v[64:67], 0
L_pad1_7:
s_cbranch_execz L_pad1_11
ds_write2_b64 v20, v[208:209], v[212:213] offset0:0 offset1:4
ds_write2_b64 v20, v[216:217], v[220:221] offset0:8 offset1:12
v_exp_f32 v37, v37
v_mfma_f32_16x16x32_bf16 v[232:235], a[200:203], v[64:67], 0
ds_read_b64_tr_b16 a[216:217], v12 offset:0
v_fmamk_f32 v38, v38, 0x3e0293ee, v23
v_mfma_f32_16x16x32_bf16 v[236:239], a[204:207], v[64:67], 0
ds_read_b64_tr_b16 a[218:219], v12 offset:4096
v_exp_f32 v38, v38
v_fmamk_f32 v39, v39, 0x3e0293ee, v23
v_exp_f32 v39, v39
v_mfma_f32_16x16x32_bf16 a[232:235], a[244:247], v[56:59], 0
ds_read_b64_tr_b16 a[220:221], v13 offset:0
ds_read_b64_tr_b16 a[222:223], v13 offset:4096
v_cvt_pk_bf16_f32 v68, v36, v37
v_cvt_pk_bf16_f32 v69, v38, v39
v_mfma_f32_16x16x32_bf16 v[36:39], a[160:163], a[128:131], 0
ds_read_b128 a[176:179], v2 offset:12288
v_fmamk_f32 v40, v40, 0x3e0293ee, v24
v_mfma_f32_16x16x32_bf16 v[36:39], a[164:167], a[132:135], v[36:39]
v_exp_f32 v40, v40
v_mfma_f32_16x16x32_bf16 v[36:39], a[168:171], a[136:139], v[36:39]
ds_read_b128 a[180:183], v3 offset:12288
v_fmamk_f32 v41, v41, 0x3e0293ee, v24
v_mfma_f32_16x16x32_bf16 v[36:39], a[172:175], a[140:143], v[36:39]
s_waitcnt lgkmcnt(8)
ds_read_b128 a[56:59], v21 offset:0
ds_read_b128 a[60:63], v21 offset:1152
v_exp_f32 v41, v41
v_mfma_f32_16x16x32_bf16 v[112:115], a[208:211], v[48:51], 0
ds_read_b128 a[184:187], v4 offset:12288
v_fmamk_f32 v42, v42, 0x3e0293ee, v24
v_mfma_f32_16x16x32_bf16 v[116:119], a[212:215], v[48:51], 0
s_waitcnt lgkmcnt(7)
v_exp_f32 v42, v42
v_mfma_f32_16x16x32_bf16 v[120:123], a[216:219], v[48:51], 0
s_waitcnt lgkmcnt(5)
v_fmamk_f32 v43, v43, 0x3e0293ee, v24
v_exp_f32 v43, v43
v_mfma_f32_16x16x32_bf16 v[124:127], a[220:223], v[48:51], 0
v_cvt_pk_bf16_f32 v72, v40, v41
v_cvt_pk_bf16_f32 v73, v42, v43
v_mfma_f32_16x16x32_bf16 v[40:43], a[160:163], a[144:147], 0
ds_read_b128 a[188:191], v5 offset:12288
v_fmamk_f32 v32, v32, 0x3e0293ee, v25
v_mfma_f32_16x16x32_bf16 v[40:43], a[164:167], a[148:151], v[40:43]
v_exp_f32 v32, v32
v_mfma_f32_16x16x32_bf16 v[40:43], a[168:171], a[152:155], v[40:43]
buffer_load_dwordx4 v17, s[24:27], s31 offen offset:1024 nt lds
v_fmamk_f32 v33, v33, 0x3e0293ee, v25
v_mfma_f32_16x16x32_bf16 v[40:43], a[172:175], a[156:159], v[40:43]
s_add_u32 m0, s32, 49152
v_exp_f32 v33, v33
v_mfma_f32_16x16x32_bf16 v[144:147], a[208:211], v[52:55], 0
s_add_u32 s31, s29, 49152
v_fmamk_f32 v34, v34, 0x3e0293ee, v25
v_fmamk_f32 v35, v35, 0x3e0293ee, v25
v_mfma_f32_16x16x32_bf16 v[148:151], a[212:215], v[52:55], 0
v_exp_f32 v34, v34
v_mfma_f32_16x16x32_bf16 v[152:155], a[216:219], v[52:55], 0
v_exp_f32 v35, v35
v_mfma_f32_16x16x32_bf16 v[156:159], a[220:223], v[52:55], 0
v_cvt_pk_bf16_f32 v76, v32, v33
v_cvt_pk_bf16_f32 v77, v34, v35
v_mfma_f32_16x16x32_bf16 a[236:239], a[244:247], v[60:63], 0
s_waitcnt lgkmcnt(0)
v_fmamk_f32 v36, v36, 0x3e0293ee, v26
v_fmamk_f32 v37, v37, 0x3e0293ee, v26
v_mfma_f32_16x16x32_bf16 v[32:35], a[176:179], a[80:83], 0
s_barrier
v_exp_f32 v36, v36
v_mfma_f32_16x16x32_bf16 v[32:35], a[180:183], a[84:87], v[32:35]
v_exp_f32 v37, v37
v_mfma_f32_16x16x32_bf16 v[32:35], a[184:187], a[88:91], v[32:35]
v_fmamk_f32 v38, v38, 0x3e0293ee, v26
v_fmamk_f32 v39, v39, 0x3e0293ee, v26
v_mfma_f32_16x16x32_bf16 v[32:35], a[188:191], a[92:95], v[32:35]
v_exp_f32 v38, v38
v_mfma_f32_16x16x32_bf16 v[176:179], a[208:211], v[56:59], 0
v_exp_f32 v39, v39
v_mfma_f32_16x16x32_bf16 v[180:183], a[212:215], v[56:59], 0
buffer_load_dwordx4 v14, s[20:23], s30 offen nt lds
v_cvt_pk_bf16_f32 v48, v36, v37
v_mfma_f32_16x16x32_bf16 v[184:187], a[216:219], v[56:59], 0
ds_read_b64_tr_b16 a[192:193], v6 offset:8192
v_cvt_pk_bf16_f32 v49, v38, v39
v_mfma_f32_16x16x32_bf16 v[188:191], a[220:223], v[56:59], 0
ds_read_b64_tr_b16 a[194:195], v6 offset:12288
v_fmamk_f32 v40, v40, 0x3e0293ee, v27
v_mfma_f32_16x16x32_bf16 v[36:39], a[176:179], a[96:99], 0
v_exp_f32 v40, v40
v_mfma_f32_16x16x32_bf16 v[36:39], a[180:183], a[100:103], v[36:39]
ds_read_b64_tr_b16 a[196:197], v7 offset:8192
v_fmamk_f32 v41, v41, 0x3e0293ee, v27
v_mfma_f32_16x16x32_bf16 v[36:39], a[184:187], a[104:107], v[36:39]
v_exp_f32 v41, v41
v_mfma_f32_16x16x32_bf16 v[36:39], a[188:191], a[108:111], v[36:39]
ds_read_b64_tr_b16 a[198:199], v7 offset:12288
v_fmamk_f32 v42, v42, 0x3e0293ee, v27
v_mfma_f32_16x16x32_bf16 v[208:211], a[208:211], v[60:63], 0
v_exp_f32 v42, v42
v_mfma_f32_16x16x32_bf16 v[212:215], a[212:215], v[60:63], 0
ds_read_b64_tr_b16 a[200:201], v8 offset:8192
v_fmamk_f32 v43, v43, 0x3e0293ee, v27
v_mfma_f32_16x16x32_bf16 v[216:219], a[216:219], v[60:63], 0
v_exp_f32 v43, v43
v_mfma_f32_16x16x32_bf16 v[220:223], a[220:223], v[60:63], 0
ds_read_b64_tr_b16 a[202:203], v8 offset:12288
v_cvt_pk_bf16_f32 v52, v40, v41
v_mfma_f32_16x16x32_bf16 a[240:243], a[244:247], v[64:67], 0
v_cvt_pk_bf16_f32 v53, v42, v43
v_fmamk_f32 v32, v32, 0x3e0293ee, v23
v_mfma_f32_16x16x32_bf16 v[40:43], a[176:179], a[112:115], 0
v_exp_f32 v32, v32
v_mfma_f32_16x16x32_bf16 v[40:43], a[180:183], a[116:119], v[40:43]
ds_read_b64_tr_b16 a[204:205], v9 offset:8192
v_fmamk_f32 v33, v33, 0x3e0293ee, v23
v_mfma_f32_16x16x32_bf16 v[40:43], a[184:187], a[120:123], v[40:43]
v_exp_f32 v33, v33
v_mfma_f32_16x16x32_bf16 v[40:43], a[188:191], a[124:127], v[40:43]
ds_read_b64_tr_b16 a[206:207], v9 offset:12288
v_fmamk_f32 v34, v34, 0x3e0293ee, v23
v_mfma_f32_16x16x32_bf16 v[240:243], a[208:211], v[64:67], 0
v_exp_f32 v34, v34
v_mfma_f32_16x16x32_bf16 v[244:247], a[212:215], v[64:67], 0
ds_read_b128 a[160:163], v2 offset:16384
v_fmamk_f32 v35, v35, 0x3e0293ee, v23
v_mfma_f32_16x16x32_bf16 v[248:251], a[216:219], v[64:67], 0
v_exp_f32 v35, v35
v_mfma_f32_16x16x32_bf16 v[252:255], a[220:223], v[64:67], 0
v_cvt_pk_bf16_f32 v70, v32, v33
v_cvt_pk_bf16_f32 v71, v34, v35
v_mfma_f32_16x16x32_bf16 v[32:35], a[176:179], a[128:131], 0
ds_read_b128 a[164:167], v3 offset:16384
v_fmamk_f32 v36, v36, 0x3e0293ee, v24
v_mfma_f32_16x16x32_bf16 v[32:35], a[180:183], a[132:135], v[32:35]
v_exp_f32 v36, v36
v_mfma_f32_16x16x32_bf16 v[32:35], a[184:187], a[136:139], v[32:35]
ds_read_b128 a[168:171], v4 offset:16384
v_fmamk_f32 v37, v37, 0x3e0293ee, v24
v_mfma_f32_16x16x32_bf16 v[32:35], a[188:191], a[140:143], v[32:35]
s_waitcnt lgkmcnt(3)
v_exp_f32 v37, v37
v_mfma_f32_16x16x32_bf16 v[96:99], a[192:195], v[68:71], v[96:99]
buffer_load_dwordx4 v15, s[20:23], s30 offen offset:1024 nt lds
v_fmamk_f32 v38, v38, 0x3e0293ee, v24
v_mfma_f32_16x16x32_bf16 v[100:103], a[196:199], v[68:71], v[100:103]
s_add_u32 m0, s32, 114688
v_exp_f32 v38, v38
v_mfma_f32_16x16x32_bf16 v[104:107], a[200:203], v[68:71], v[104:107]
s_add_u32 s30, s29, 57344
ds_read_b128 a[172:175], v5 offset:16384
v_fmamk_f32 v39, v39, 0x3e0293ee, v24
v_mfma_f32_16x16x32_bf16 v[108:111], a[204:207], v[68:71], v[108:111]
v_exp_f32 v39, v39
v_mfma_f32_16x16x32_bf16 a[224:227], a[244:247], v[68:71], a[224:227]
v_cvt_pk_bf16_f32 v74, v36, v37
v_cvt_pk_bf16_f32 v75, v38, v39
v_mfma_f32_16x16x32_bf16 v[36:39], a[176:179], a[144:147], 0
v_fmamk_f32 v40, v40, 0x3e0293ee, v25
v_fmamk_f32 v41, v41, 0x3e0293ee, v25
v_mfma_f32_16x16x32_bf16 v[36:39], a[180:183], a[148:151], v[36:39]
v_exp_f32 v40, v40
v_mfma_f32_16x16x32_bf16 v[36:39], a[184:187], a[152:155], v[36:39]
v_exp_f32 v41, v41
v_mfma_f32_16x16x32_bf16 v[36:39], a[188:191], a[156:159], v[36:39]
v_fmamk_f32 v42, v42, 0x3e0293ee, v25
v_fmamk_f32 v43, v43, 0x3e0293ee, v25
v_mfma_f32_16x16x32_bf16 v[128:131], a[192:195], v[72:75], v[128:131]
v_exp_f32 v42, v42
v_mfma_f32_16x16x32_bf16 v[132:135], a[196:199], v[72:75], v[132:135]
v_exp_f32 v43, v43
v_mfma_f32_16x16x32_bf16 v[136:139], a[200:203], v[72:75], v[136:139]
v_cvt_pk_bf16_f32 v78, v40, v41
v_cvt_pk_bf16_f32 v79, v42, v43
v_mfma_f32_16x16x32_bf16 v[140:143], a[204:207], v[72:75], v[140:143]
s_waitcnt lgkmcnt(0)
v_fmamk_f32 v32, v32, 0x3e0293ee, v26
v_fmamk_f32 v33, v33, 0x3e0293ee, v26
v_mfma_f32_16x16x32_bf16 v[40:43], a[160:163], a[80:83], 0
v_exp_f32 v32, v32
v_mfma_f32_16x16x32_bf16 v[40:43], a[164:167], a[84:87], v[40:43]
v_exp_f32 v33, v33
v_mfma_f32_16x16x32_bf16 v[40:43], a[168:171], a[88:91], v[40:43]
v_fmamk_f32 v34, v34, 0x3e0293ee, v26
v_fmamk_f32 v35, v35, 0x3e0293ee, v26
v_mfma_f32_16x16x32_bf16 v[40:43], a[172:175], a[92:95], v[40:43]
v_exp_f32 v34, v34
v_mfma_f32_16x16x32_bf16 v[160:163], a[192:195], v[76:79], v[160:163]
v_exp_f32 v35, v35
v_mfma_f32_16x16x32_bf16 v[164:167], a[196:199], v[76:79], v[164:167]
buffer_load_dwordx4 v16, s[24:27], s31 offen nt lds
v_cvt_pk_bf16_f32 v50, v32, v33
v_mfma_f32_16x16x32_bf16 v[168:171], a[200:203], v[76:79], v[168:171]
ds_read_b64_tr_b16 a[208:209], v10 offset:8192
v_cvt_pk_bf16_f32 v51, v34, v35
v_mfma_f32_16x16x32_bf16 v[172:175], a[204:207], v[76:79], v[172:175]
ds_read_b64_tr_b16 a[210:211], v10 offset:12288
v_fmamk_f32 v36, v36, 0x3e0293ee, v27
v_mfma_f32_16x16x32_bf16 a[228:231], a[244:247], v[72:75], a[228:231]
v_exp_f32 v36, v36
v_mfma_f32_16x16x32_bf16 v[32:35], a[160:163], a[96:99], 0
ds_read_b64_tr_b16 a[212:213], v11 offset:8192
v_fmamk_f32 v37, v37, 0x3e0293ee, v27
v_mfma_f32_16x16x32_bf16 v[32:35], a[164:167], a[100:103], v[32:35]
v_exp_f32 v37, v37
v_mfma_f32_16x16x32_bf16 v[32:35], a[168:171], a[104:107], v[32:35]
ds_read_b64_tr_b16 a[214:215], v11 offset:12288
v_fmamk_f32 v38, v38, 0x3e0293ee, v27
v_mfma_f32_16x16x32_bf16 v[32:35], a[172:175], a[108:111], v[32:35]
v_exp_f32 v38, v38
v_mfma_f32_16x16x32_bf16 v[192:195], a[192:195], v[48:51], v[192:195]
ds_read_b64_tr_b16 a[216:217], v12 offset:8192
v_fmamk_f32 v39, v39, 0x3e0293ee, v27
v_mfma_f32_16x16x32_bf16 v[196:199], a[196:199], v[48:51], v[196:199]
v_exp_f32 v39, v39
v_mfma_f32_16x16x32_bf16 v[200:203], a[200:203], v[48:51], v[200:203]
ds_read_b64_tr_b16 a[218:219], v12 offset:12288
v_cvt_pk_bf16_f32 v54, v36, v37
v_mfma_f32_16x16x32_bf16 v[204:207], a[204:207], v[48:51], v[204:207]
v_cvt_pk_bf16_f32 v55, v38, v39
v_fmamk_f32 v40, v40, 0x3e0293ee, v23
v_mfma_f32_16x16x32_bf16 v[36:39], a[160:163], a[112:115], 0
v_exp_f32 v40, v40
v_mfma_f32_16x16x32_bf16 v[36:39], a[164:167], a[116:119], v[36:39]
ds_read_b64_tr_b16 a[220:221], v13 offset:8192
v_fmamk_f32 v41, v41, 0x3e0293ee, v23
v_mfma_f32_16x16x32_bf16 v[36:39], a[168:171], a[120:123], v[36:39]
v_exp_f32 v41, v41
v_mfma_f32_16x16x32_bf16 v[36:39], a[172:175], a[124:127], v[36:39]
ds_read_b64_tr_b16 a[222:223], v13 offset:12288
v_fmamk_f32 v42, v42, 0x3e0293ee, v23
v_mfma_f32_16x16x32_bf16 v[224:227], a[192:195], v[52:55], v[224:227]
v_exp_f32 v42, v42
v_mfma_f32_16x16x32_bf16 v[228:231], a[196:199], v[52:55], v[228:231]
ds_read_b128 a[176:179], v2 offset:20480
v_fmamk_f32 v43, v43, 0x3e0293ee, v23
v_mfma_f32_16x16x32_bf16 v[232:235], a[200:203], v[52:55], v[232:235]
v_exp_f32 v43, v43
v_mfma_f32_16x16x32_bf16 v[236:239], a[204:207], v[52:55], v[236:239]
ds_read_b128 a[180:183], v3 offset:20480
v_cvt_pk_bf16_f32 v56, v40, v41
v_mfma_f32_16x16x32_bf16 a[232:235], a[244:247], v[76:79], a[232:235]
v_cvt_pk_bf16_f32 v57, v42, v43
v_fmamk_f32 v32, v32, 0x3e0293ee, v24
v_mfma_f32_16x16x32_bf16 v[40:43], a[160:163], a[128:131], 0
v_exp_f32 v32, v32
v_mfma_f32_16x16x32_bf16 v[40:43], a[164:167], a[132:135], v[40:43]
s_waitcnt lgkmcnt(2)
buffer_load_dwordx4 v17, s[24:27], s31 offen offset:1024 nt lds
v_fmamk_f32 v33, v33, 0x3e0293ee, v24
v_mfma_f32_16x16x32_bf16 v[40:43], a[168:171], a[136:139], v[40:43]
s_add_u32 m0, s32, 57344
v_exp_f32 v33, v33
v_mfma_f32_16x16x32_bf16 v[40:43], a[172:175], a[140:143], v[40:43]
s_add_u32 s31, s29, 57344
ds_read_b128 a[184:187], v4 offset:20480
v_fmamk_f32 v34, v34, 0x3e0293ee, v24
v_mfma_f32_16x16x32_bf16 v[112:115], a[208:211], v[68:71], v[112:115]
v_exp_f32 v34, v34
v_mfma_f32_16x16x32_bf16 v[116:119], a[212:215], v[68:71], v[116:119]
ds_read_b128 a[188:191], v5 offset:20480
v_fmamk_f32 v35, v35, 0x3e0293ee, v24
v_mfma_f32_16x16x32_bf16 v[120:123], a[216:219], v[68:71], v[120:123]
v_exp_f32 v35, v35
v_mfma_f32_16x16x32_bf16 v[124:127], a[220:223], v[68:71], v[124:127]
v_cvt_pk_bf16_f32 v60, v32, v33
v_cvt_pk_bf16_f32 v61, v34, v35
v_mfma_f32_16x16x32_bf16 v[32:35], a[160:163], a[144:147], 0
v_fmamk_f32 v36, v36, 0x3e0293ee, v25
v_fmamk_f32 v37, v37, 0x3e0293ee, v25
v_mfma_f32_16x16x32_bf16 v[32:35], a[164:167], a[148:151], v[32:35]
v_exp_f32 v36, v36
v_mfma_f32_16x16x32_bf16 v[32:35], a[168:171], a[152:155], v[32:35]
v_exp_f32 v37, v37
v_mfma_f32_16x16x32_bf16 v[32:35], a[172:175], a[156:159], v[32:35]
v_fmamk_f32 v38, v38, 0x3e0293ee, v25
v_fmamk_f32 v39, v39, 0x3e0293ee, v25
v_mfma_f32_16x16x32_bf16 v[144:147], a[208:211], v[72:75], v[144:147]
v_exp_f32 v38, v38
v_mfma_f32_16x16x32_bf16 v[148:151], a[212:215], v[72:75], v[148:151]
v_exp_f32 v39, v39
v_mfma_f32_16x16x32_bf16 v[152:155], a[216:219], v[72:75], v[152:155]
v_cvt_pk_bf16_f32 v64, v36, v37
v_cvt_pk_bf16_f32 v65, v38, v39
v_mfma_f32_16x16x32_bf16 v[156:159], a[220:223], v[72:75], v[156:159]
v_fmamk_f32 v40, v40, 0x3e0293ee, v26
v_fmamk_f32 v41, v41, 0x3e0293ee, v26
v_mfma_f32_16x16x32_bf16 a[236:239], a[244:247], v[48:51], a[236:239]
s_waitcnt lgkmcnt(0)
v_exp_f32 v40, v40
v_mfma_f32_16x16x32_bf16 v[36:39], a[176:179], a[80:83], 0
v_exp_f32 v41, v41
v_mfma_f32_16x16x32_bf16 v[36:39], a[180:183], a[84:87], v[36:39]
v_fmamk_f32 v42, v42, 0x3e0293ee, v26
v_fmamk_f32 v43, v43, 0x3e0293ee, v26
v_mfma_f32_16x16x32_bf16 v[36:39], a[184:187], a[88:91], v[36:39]
v_exp_f32 v42, v42
v_mfma_f32_16x16x32_bf16 v[36:39], a[188:191], a[92:95], v[36:39]
v_exp_f32 v43, v43
v_mfma_f32_16x16x32_bf16 v[176:179], a[208:211], v[76:79], v[176:179]
v_cvt_pk_bf16_f32 v68, v40, v41
v_cvt_pk_bf16_f32 v69, v42, v43
v_mfma_f32_16x16x32_bf16 v[180:183], a[212:215], v[76:79], v[180:183]
ds_read_b64_tr_b16 a[192:193], v6 offset:16384
v_fmamk_f32 v32, v32, 0x3e0293ee, v27
v_mfma_f32_16x16x32_bf16 v[184:187], a[216:219], v[76:79], v[184:187]
v_exp_f32 v32, v32
v_mfma_f32_16x16x32_bf16 v[188:191], a[220:223], v[76:79], v[188:191]
ds_read_b64_tr_b16 a[194:195], v6 offset:20480
v_fmamk_f32 v33, v33, 0x3e0293ee, v27
v_mfma_f32_16x16x32_bf16 v[40:43], a[176:179], a[96:99], 0
v_exp_f32 v33, v33
v_mfma_f32_16x16x32_bf16 v[40:43], a[180:183], a[100:103], v[40:43]
ds_read_b64_tr_b16 a[196:197], v7 offset:16384
v_fmamk_f32 v34, v34, 0x3e0293ee, v27
v_mfma_f32_16x16x32_bf16 v[40:43], a[184:187], a[104:107], v[40:43]
v_exp_f32 v34, v34
v_mfma_f32_16x16x32_bf16 v[40:43], a[188:191], a[108:111], v[40:43]
ds_read_b64_tr_b16 a[198:199], v7 offset:20480
v_fmamk_f32 v35, v35, 0x3e0293ee, v27
v_mfma_f32_16x16x32_bf16 v[208:211], a[208:211], v[48:51], v[208:211]
v_exp_f32 v35, v35
v_mfma_f32_16x16x32_bf16 v[212:215], a[212:215], v[48:51], v[212:215]
ds_read_b64_tr_b16 a[200:201], v8 offset:16384
v_cvt_pk_bf16_f32 v72, v32, v33
v_mfma_f32_16x16x32_bf16 v[216:219], a[216:219], v[48:51], v[216:219]
ds_read_b64_tr_b16 a[202:203], v8 offset:20480
v_cvt_pk_bf16_f32 v73, v34, v35
v_mfma_f32_16x16x32_bf16 v[220:223], a[220:223], v[48:51], v[220:223]
ds_read_b64_tr_b16 a[204:205], v9 offset:16384
v_add_u32 v28, s38, v19
v_mfma_f32_16x16x32_bf16 a[240:243], a[244:247], v[52:55], a[240:243]
s_add_u32 s38, s63, 0
buffer_store_dwordx4 a[0:3], v28, s[12:15], 0 offen offset:0 sc0 sc1 nt
buffer_load_dwordx4 v14, s[20:23], s30 offen nt lds
buffer_load_dwordx4 v15, s[20:23], s30 offen offset:1024 nt lds
v_mfma_f32_16x16x32_bf16 v[32:35], a[176:179], a[112:115], 0
s_add_u32 m0, s32, 122880
ds_read_b64_tr_b16 a[206:207], v9 offset:20480
v_fmamk_f32 v36, v36, 0x3e0293ee, v23
v_mfma_f32_16x16x32_bf16 v[32:35], a[180:183], a[116:119], v[32:35]
s_add_u32 s38, s38, s75
v_exp_f32 v36, v36
v_mfma_f32_16x16x32_bf16 v[32:35], a[184:187], a[120:123], v[32:35]
s_add_u32 s30, s29, 65536
ds_read_b128 a[160:163], v2 offset:24576
v_fmamk_f32 v37, v37, 0x3e0293ee, v23
v_mfma_f32_16x16x32_bf16 v[32:35], a[188:191], a[124:127], v[32:35]
v_exp_f32 v37, v37
v_mfma_f32_16x16x32_bf16 v[240:243], a[208:211], v[52:55], v[240:243]
ds_read_b128 a[164:167], v3 offset:24576
v_fmamk_f32 v38, v38, 0x3e0293ee, v23
v_mfma_f32_16x16x32_bf16 v[244:247], a[212:215], v[52:55], v[244:247]
v_exp_f32 v38, v38
v_mfma_f32_16x16x32_bf16 v[248:251], a[216:219], v[52:55], v[248:251]
v_fmamk_f32 v39, v39, 0x3e0293ee, v23
v_exp_f32 v39, v39
v_mfma_f32_16x16x32_bf16 v[252:255], a[220:223], v[52:55], v[252:255]
v_cvt_pk_bf16_f32 v58, v36, v37
v_cvt_pk_bf16_f32 v59, v38, v39
v_mfma_f32_16x16x32_bf16 v[36:39], a[176:179], a[128:131], 0
ds_read_b128 a[168:171], v4 offset:24576
v_fmamk_f32 v40, v40, 0x3e0293ee, v24
v_mfma_f32_16x16x32_bf16 v[36:39], a[180:183], a[132:135], v[36:39]
v_exp_f32 v40, v40
v_mfma_f32_16x16x32_bf16 v[36:39], a[184:187], a[136:139], v[36:39]
ds_read_b128 a[172:175], v5 offset:24576
v_fmamk_f32 v41, v41, 0x3e0293ee, v24
v_mfma_f32_16x16x32_bf16 v[36:39], a[188:191], a[140:143], v[36:39]
s_waitcnt lgkmcnt(3)
v_exp_f32 v41, v41
v_mfma_f32_16x16x32_bf16 v[96:99], a[192:195], v[56:59], v[96:99]
v_fmamk_f32 v42, v42, 0x3e0293ee, v24
v_fmamk_f32 v43, v43, 0x3e0293ee, v24
v_mfma_f32_16x16x32_bf16 v[100:103], a[196:199], v[56:59], v[100:103]
v_exp_f32 v42, v42
v_mfma_f32_16x16x32_bf16 v[104:107], a[200:203], v[56:59], v[104:107]
v_exp_f32 v43, v43
v_mfma_f32_16x16x32_bf16 v[108:111], a[204:207], v[56:59], v[108:111]
v_cvt_pk_bf16_f32 v62, v40, v41
v_cvt_pk_bf16_f32 v63, v42, v43
v_mfma_f32_16x16x32_bf16 a[224:227], a[244:247], v[56:59], a[224:227]
v_fmamk_f32 v32, v32, 0x3e0293ee, v25
v_fmamk_f32 v33, v33, 0x3e0293ee, v25
v_mfma_f32_16x16x32_bf16 v[40:43], a[176:179], a[144:147], 0
v_exp_f32 v32, v32
v_mfma_f32_16x16x32_bf16 v[40:43], a[180:183], a[148:151], v[40:43]
v_exp_f32 v33, v33
v_mfma_f32_16x16x32_bf16 v[40:43], a[184:187], a[152:155], v[40:43]
v_fmamk_f32 v34, v34, 0x3e0293ee, v25
v_fmamk_f32 v35, v35, 0x3e0293ee, v25
v_mfma_f32_16x16x32_bf16 v[40:43], a[188:191], a[156:159], v[40:43]
v_exp_f32 v34, v34
v_mfma_f32_16x16x32_bf16 v[128:131], a[192:195], v[60:63], v[128:131]
v_exp_f32 v35, v35
v_mfma_f32_16x16x32_bf16 v[132:135], a[196:199], v[60:63], v[132:135]
v_cvt_pk_bf16_f32 v66, v32, v33
v_cvt_pk_bf16_f32 v67, v34, v35
v_mfma_f32_16x16x32_bf16 v[136:139], a[200:203], v[60:63], v[136:139]
v_fmamk_f32 v36, v36, 0x3e0293ee, v26
v_fmamk_f32 v37, v37, 0x3e0293ee, v26
v_mfma_f32_16x16x32_bf16 v[140:143], a[204:207], v[60:63], v[140:143]
v_exp_f32 v36, v36
v_mfma_f32_16x16x32_bf16 v[32:35], a[160:163], a[80:83], 0
s_waitcnt lgkmcnt(0)
v_exp_f32 v37, v37
v_mfma_f32_16x16x32_bf16 v[32:35], a[164:167], a[84:87], v[32:35]
v_fmamk_f32 v38, v38, 0x3e0293ee, v26
v_fmamk_f32 v39, v39, 0x3e0293ee, v26
v_mfma_f32_16x16x32_bf16 v[32:35], a[168:171], a[88:91], v[32:35]
v_exp_f32 v38, v38
v_mfma_f32_16x16x32_bf16 v[32:35], a[172:175], a[92:95], v[32:35]
v_exp_f32 v39, v39
v_mfma_f32_16x16x32_bf16 v[160:163], a[192:195], v[64:67], v[160:163]
v_cvt_pk_bf16_f32 v70, v36, v37
v_cvt_pk_bf16_f32 v71, v38, v39
v_mfma_f32_16x16x32_bf16 v[164:167], a[196:199], v[64:67], v[164:167]
ds_read_b64_tr_b16 a[208:209], v10 offset:16384
v_fmamk_f32 v40, v40, 0x3e0293ee, v27
v_mfma_f32_16x16x32_bf16 v[168:171], a[200:203], v[64:67], v[168:171]
ds_read_b64_tr_b16 a[210:211], v10 offset:20480
v_fmamk_f32 v41, v41, 0x3e0293ee, v27
v_mfma_f32_16x16x32_bf16 v[172:175], a[204:207], v[64:67], v[172:175]
ds_read_b64_tr_b16 a[212:213], v11 offset:16384
v_fmamk_f32 v42, v42, 0x3e0293ee, v27
v_mfma_f32_16x16x32_bf16 a[228:231], a[244:247], v[60:63], a[228:231]
ds_read_b64_tr_b16 a[214:215], v11 offset:20480
v_fmamk_f32 v43, v43, 0x3e0293ee, v27
v_mfma_f32_16x16x32_bf16 v[36:39], a[160:163], a[96:99], 0
buffer_store_dwordx4 a[4:7], v28, s[12:15], 0 offen offset:2048 sc0 sc1 nt
buffer_load_dwordx4 v16, s[24:27], s31 offen nt lds
buffer_load_dwordx4 v17, s[24:27], s31 offen offset:1024 nt lds
v_mfma_f32_16x16x32_bf16 v[36:39], a[164:167], a[100:103], v[36:39]
s_add_u32 m0, s32, 0
v_exp_f32 v40, v40
v_mfma_f32_16x16x32_bf16 v[36:39], a[168:171], a[104:107], v[36:39]
s_add_u32 s31, s29, 65536
v_exp_f32 v41, v41
v_mfma_f32_16x16x32_bf16 v[36:39], a[172:175], a[108:111], v[36:39]
v_exp_f32 v42, v42
v_mfma_f32_16x16x32_bf16 v[192:195], a[192:195], v[68:71], v[192:195]
v_exp_f32 v43, v43
v_mfma_f32_16x16x32_bf16 v[196:199], a[196:199], v[68:71], v[196:199]
ds_read_b64_tr_b16 a[216:217], v12 offset:16384
v_cvt_pk_bf16_f32 v74, v40, v41
v_mfma_f32_16x16x32_bf16 v[200:203], a[200:203], v[68:71], v[200:203]
ds_read_b64_tr_b16 a[218:219], v12 offset:20480
v_cvt_pk_bf16_f32 v75, v42, v43
v_mfma_f32_16x16x32_bf16 v[204:207], a[204:207], v[68:71], v[204:207]
ds_read_b64_tr_b16 a[220:221], v13 offset:16384
v_fmamk_f32 v32, v32, 0x3e0293ee, v23
v_mfma_f32_16x16x32_bf16 v[40:43], a[160:163], a[112:115], 0
v_exp_f32 v32, v32
v_mfma_f32_16x16x32_bf16 v[40:43], a[164:167], a[116:119], v[40:43]
ds_read_b64_tr_b16 a[222:223], v13 offset:20480
v_fmamk_f32 v33, v33, 0x3e0293ee, v23
v_mfma_f32_16x16x32_bf16 v[40:43], a[168:171], a[120:123], v[40:43]
v_exp_f32 v33, v33
v_mfma_f32_16x16x32_bf16 v[40:43], a[172:175], a[124:127], v[40:43]
ds_read_b128 a[176:179], v2 offset:28672
v_fmamk_f32 v34, v34, 0x3e0293ee, v23
v_mfma_f32_16x16x32_bf16 v[224:227], a[192:195], v[72:75], v[224:227]
v_exp_f32 v34, v34
v_mfma_f32_16x16x32_bf16 v[228:231], a[196:199], v[72:75], v[228:231]
ds_read_b128 a[180:183], v3 offset:28672
v_fmamk_f32 v35, v35, 0x3e0293ee, v23
v_mfma_f32_16x16x32_bf16 v[232:235], a[200:203], v[72:75], v[232:235]
v_exp_f32 v35, v35
v_mfma_f32_16x16x32_bf16 v[236:239], a[204:207], v[72:75], v[236:239]
ds_read_b128 a[184:187], v4 offset:28672
v_cvt_pk_bf16_f32 v76, v32, v33
v_mfma_f32_16x16x32_bf16 a[232:235], a[244:247], v[64:67], a[232:235]
v_cvt_pk_bf16_f32 v77, v34, v35
v_fmamk_f32 v36, v36, 0x3e0293ee, v24
v_mfma_f32_16x16x32_bf16 v[32:35], a[160:163], a[128:131], 0
v_exp_f32 v36, v36
v_mfma_f32_16x16x32_bf16 v[32:35], a[164:167], a[132:135], v[32:35]
ds_read_b128 a[188:191], v5 offset:28672
v_fmamk_f32 v37, v37, 0x3e0293ee, v24
v_mfma_f32_16x16x32_bf16 v[32:35], a[168:171], a[136:139], v[32:35]
v_exp_f32 v37, v37
v_mfma_f32_16x16x32_bf16 v[32:35], a[172:175], a[140:143], v[32:35]
s_waitcnt lgkmcnt(3)
v_fmamk_f32 v38, v38, 0x3e0293ee, v24
v_fmamk_f32 v39, v39, 0x3e0293ee, v24
v_mfma_f32_16x16x32_bf16 v[112:115], a[208:211], v[56:59], v[112:115]
v_exp_f32 v38, v38
v_mfma_f32_16x16x32_bf16 v[116:119], a[212:215], v[56:59], v[116:119]
v_exp_f32 v39, v39
v_mfma_f32_16x16x32_bf16 v[120:123], a[216:219], v[56:59], v[120:123]
v_cvt_pk_bf16_f32 v48, v36, v37
v_cvt_pk_bf16_f32 v49, v38, v39
v_mfma_f32_16x16x32_bf16 v[124:127], a[220:223], v[56:59], v[124:127]
v_fmamk_f32 v40, v40, 0x3e0293ee, v25
v_fmamk_f32 v41, v41, 0x3e0293ee, v25
v_mfma_f32_16x16x32_bf16 v[36:39], a[160:163], a[144:147], 0
v_exp_f32 v40, v40
v_mfma_f32_16x16x32_bf16 v[36:39], a[164:167], a[148:151], v[36:39]
v_exp_f32 v41, v41
v_mfma_f32_16x16x32_bf16 v[36:39], a[168:171], a[152:155], v[36:39]
v_fmamk_f32 v42, v42, 0x3e0293ee, v25
v_fmamk_f32 v43, v43, 0x3e0293ee, v25
v_mfma_f32_16x16x32_bf16 v[36:39], a[172:175], a[156:159], v[36:39]
v_exp_f32 v42, v42
v_mfma_f32_16x16x32_bf16 v[144:147], a[208:211], v[60:63], v[144:147]
v_exp_f32 v43, v43
v_mfma_f32_16x16x32_bf16 v[148:151], a[212:215], v[60:63], v[148:151]
v_cvt_pk_bf16_f32 v52, v40, v41
v_cvt_pk_bf16_f32 v53, v42, v43
v_mfma_f32_16x16x32_bf16 v[152:155], a[216:219], v[60:63], v[152:155]
v_fmamk_f32 v32, v32, 0x3e0293ee, v26
v_fmamk_f32 v33, v33, 0x3e0293ee, v26
v_mfma_f32_16x16x32_bf16 v[156:159], a[220:223], v[60:63], v[156:159]
v_exp_f32 v32, v32
v_mfma_f32_16x16x32_bf16 a[236:239], a[244:247], v[68:71], a[236:239]
s_waitcnt vmcnt(8) lgkmcnt(0)
v_exp_f32 v33, v33
v_mfma_f32_16x16x32_bf16 v[40:43], a[176:179], a[80:83], 0
s_barrier
v_fmamk_f32 v34, v34, 0x3e0293ee, v26
v_fmamk_f32 v35, v35, 0x3e0293ee, v26
v_mfma_f32_16x16x32_bf16 v[40:43], a[180:183], a[84:87], v[40:43]
v_exp_f32 v34, v34
v_mfma_f32_16x16x32_bf16 v[40:43], a[184:187], a[88:91], v[40:43]
v_exp_f32 v35, v35
v_mfma_f32_16x16x32_bf16 v[40:43], a[188:191], a[92:95], v[40:43]
v_cvt_pk_bf16_f32 v56, v32, v33
v_cvt_pk_bf16_f32 v57, v34, v35
v_mfma_f32_16x16x32_bf16 v[176:179], a[208:211], v[64:67], v[176:179]
ds_read_b64_tr_b16 a[192:193], v6 offset:24576
v_fmamk_f32 v36, v36, 0x3e0293ee, v27
v_mfma_f32_16x16x32_bf16 v[180:183], a[212:215], v[64:67], v[180:183]
v_exp_f32 v36, v36
v_mfma_f32_16x16x32_bf16 v[184:187], a[216:219], v[64:67], v[184:187]
ds_read_b64_tr_b16 a[194:195], v6 offset:28672
v_fmamk_f32 v37, v37, 0x3e0293ee, v27
v_mfma_f32_16x16x32_bf16 v[188:191], a[220:223], v[64:67], v[188:191]
v_exp_f32 v37, v37
v_mfma_f32_16x16x32_bf16 v[32:35], a[176:179], a[96:99], 0
ds_read_b64_tr_b16 a[196:197], v7 offset:24576
v_fmamk_f32 v38, v38, 0x3e0293ee, v27
v_mfma_f32_16x16x32_bf16 v[32:35], a[180:183], a[100:103], v[32:35]
v_exp_f32 v38, v38
v_mfma_f32_16x16x32_bf16 v[32:35], a[184:187], a[104:107], v[32:35]
ds_read_b64_tr_b16 a[198:199], v7 offset:28672
v_fmamk_f32 v39, v39, 0x3e0293ee, v27
v_mfma_f32_16x16x32_bf16 v[32:35], a[188:191], a[108:111], v[32:35]
v_exp_f32 v39, v39
v_mfma_f32_16x16x32_bf16 v[208:211], a[208:211], v[68:71], v[208:211]
ds_read_b64_tr_b16 a[200:201], v8 offset:24576
v_cvt_pk_bf16_f32 v60, v36, v37
v_mfma_f32_16x16x32_bf16 v[212:215], a[212:215], v[68:71], v[212:215]
ds_read_b64_tr_b16 a[202:203], v8 offset:28672
v_cvt_pk_bf16_f32 v61, v38, v39
v_mfma_f32_16x16x32_bf16 v[216:219], a[216:219], v[68:71], v[216:219]
ds_read_b64_tr_b16 a[204:205], v9 offset:24576
v_add_u32 v28, s38, v19
v_mfma_f32_16x16x32_bf16 v[220:223], a[220:223], v[68:71], v[220:223]
s_add_u32 s38, s63, 4096
buffer_store_dwordx4 a[8:11], v28, s[12:15], 0 offen offset:0 sc0 sc1 nt
buffer_load_dwordx4 v14, s[20:23], s30 offen nt lds
buffer_load_dwordx4 v15, s[20:23], s30 offen offset:1024 nt lds
v_mfma_f32_16x16x32_bf16 a[240:243], a[244:247], v[72:75], a[240:243]
s_add_u32 m0, s32, 65536
ds_read_b64_tr_b16 a[206:207], v9 offset:28672
v_fmamk_f32 v40, v40, 0x3e0293ee, v23
v_mfma_f32_16x16x32_bf16 v[36:39], a[176:179], a[112:115], 0
s_add_u32 s38, s38, s76
v_exp_f32 v40, v40
v_mfma_f32_16x16x32_bf16 v[36:39], a[180:183], a[116:119], v[36:39]
s_add_u32 s30, s29, 73728
ds_read_b128 a[160:163], v2 offset:32768
v_fmamk_f32 v41, v41, 0x3e0293ee, v23
v_mfma_f32_16x16x32_bf16 v[36:39], a[184:187], a[120:123], v[36:39]
L_pad1_8:
s_cbranch_execz L_pad1_12
v_exp_f32 v41, v41
v_mfma_f32_16x16x32_bf16 v[36:39], a[188:191], a[124:127], v[36:39]
ds_read_b128 a[164:167], v3 offset:32768
v_fmamk_f32 v42, v42, 0x3e0293ee, v23
v_mfma_f32_16x16x32_bf16 v[240:243], a[208:211], v[72:75], v[240:243]
v_exp_f32 v42, v42
v_mfma_f32_16x16x32_bf16 v[244:247], a[212:215], v[72:75], v[244:247]
ds_read_b128 a[168:171], v4 offset:32768
v_fmamk_f32 v43, v43, 0x3e0293ee, v23
v_mfma_f32_16x16x32_bf16 v[248:251], a[216:219], v[72:75], v[248:251]
v_exp_f32 v43, v43
v_mfma_f32_16x16x32_bf16 v[252:255], a[220:223], v[72:75], v[252:255]
v_cvt_pk_bf16_f32 v78, v40, v41
v_cvt_pk_bf16_f32 v79, v42, v43
v_mfma_f32_16x16x32_bf16 v[40:43], a[176:179], a[128:131], 0
ds_read_b128 a[172:175], v5 offset:32768
v_fmamk_f32 v32, v32, 0x3e0293ee, v24
v_mfma_f32_16x16x32_bf16 v[40:43], a[180:183], a[132:135], v[40:43]
v_exp_f32 v32, v32
v_mfma_f32_16x16x32_bf16 v[40:43], a[184:187], a[136:139], v[40:43]
v_fmamk_f32 v33, v33, 0x3e0293ee, v24
v_fmamk_f32 v34, v34, 0x3e0293ee, v24
v_mfma_f32_16x16x32_bf16 v[40:43], a[188:191], a[140:143], v[40:43]
s_waitcnt lgkmcnt(2)
v_exp_f32 v33, v33
v_mfma_f32_16x16x32_bf16 v[96:99], a[192:195], v[76:79], v[96:99]
v_exp_f32 v34, v34
v_mfma_f32_16x16x32_bf16 v[100:103], a[196:199], v[76:79], v[100:103]
v_fmamk_f32 v35, v35, 0x3e0293ee, v24
v_cvt_pk_bf16_f32 v50, v32, v33
v_mfma_f32_16x16x32_bf16 v[104:107], a[200:203], v[76:79], v[104:107]
v_exp_f32 v35, v35
v_mfma_f32_16x16x32_bf16 v[108:111], a[204:207], v[76:79], v[108:111]
v_cvt_pk_bf16_f32 v51, v34, v35
v_fmamk_f32 v36, v36, 0x3e0293ee, v25
v_mfma_f32_16x16x32_bf16 a[224:227], a[244:247], v[76:79], a[224:227]
v_exp_f32 v36, v36
v_mfma_f32_16x16x32_bf16 v[32:35], a[176:179], a[144:147], 0
v_fmamk_f32 v37, v37, 0x3e0293ee, v25
v_fmamk_f32 v38, v38, 0x3e0293ee, v25
v_mfma_f32_16x16x32_bf16 v[32:35], a[180:183], a[148:151], v[32:35]
v_exp_f32 v37, v37
v_mfma_f32_16x16x32_bf16 v[32:35], a[184:187], a[152:155], v[32:35]
v_exp_f32 v38, v38
v_mfma_f32_16x16x32_bf16 v[32:35], a[188:191], a[156:159], v[32:35]
v_fmamk_f32 v39, v39, 0x3e0293ee, v25
v_cvt_pk_bf16_f32 v54, v36, v37
v_mfma_f32_16x16x32_bf16 v[128:131], a[192:195], v[48:51], v[128:131]
v_exp_f32 v39, v39
v_mfma_f32_16x16x32_bf16 v[132:135], a[196:199], v[48:51], v[132:135]
v_cvt_pk_bf16_f32 v55, v38, v39
v_fmamk_f32 v40, v40, 0x3e0293ee, v26
v_mfma_f32_16x16x32_bf16 v[136:139], a[200:203], v[48:51], v[136:139]
v_exp_f32 v40, v40
v_mfma_f32_16x16x32_bf16 v[140:143], a[204:207], v[48:51], v[140:143]
v_fmamk_f32 v41, v41, 0x3e0293ee, v26
v_fmamk_f32 v42, v42, 0x3e0293ee, v26
v_mfma_f32_16x16x32_bf16 v[36:39], a[160:163], a[80:83], 0
v_exp_f32 v41, v41
v_mfma_f32_16x16x32_bf16 v[36:39], a[164:167], a[84:87], v[36:39]
s_waitcnt lgkmcnt(0)
v_exp_f32 v42, v42
v_mfma_f32_16x16x32_bf16 v[36:39], a[168:171], a[88:91], v[36:39]
v_fmamk_f32 v43, v43, 0x3e0293ee, v26
v_cvt_pk_bf16_f32 v58, v40, v41
v_mfma_f32_16x16x32_bf16 v[36:39], a[172:175], a[92:95], v[36:39]
v_exp_f32 v43, v43
v_mfma_f32_16x16x32_bf16 v[160:163], a[192:195], v[52:55], v[160:163]
ds_read_b64_tr_b16 a[208:209], v10 offset:24576
v_cvt_pk_bf16_f32 v59, v42, v43
v_mfma_f32_16x16x32_bf16 v[164:167], a[196:199], v[52:55], v[164:167]
ds_read_b64_tr_b16 a[210:211], v10 offset:28672
v_fmamk_f32 v32, v32, 0x3e0293ee, v27
v_mfma_f32_16x16x32_bf16 v[168:171], a[200:203], v[52:55], v[168:171]
ds_read_b64_tr_b16 a[212:213], v11 offset:24576
v_fmamk_f32 v33, v33, 0x3e0293ee, v27
v_mfma_f32_16x16x32_bf16 v[172:175], a[204:207], v[52:55], v[172:175]
ds_read_b64_tr_b16 a[214:215], v11 offset:28672
v_fmamk_f32 v34, v34, 0x3e0293ee, v27
v_mfma_f32_16x16x32_bf16 a[228:231], a[244:247], v[48:51], a[228:231]
ds_read_b64_tr_b16 a[216:217], v12 offset:24576
v_fmamk_f32 v35, v35, 0x3e0293ee, v27
v_mfma_f32_16x16x32_bf16 v[40:43], a[160:163], a[96:99], 0
buffer_store_dwordx4 a[12:15], v28, s[12:15], 0 offen offset:2048 sc0 sc1 nt
buffer_load_dwordx4 v16, s[24:27], s31 offen nt lds
buffer_load_dwordx4 v17, s[24:27], s31 offen offset:1024 nt lds
v_mfma_f32_16x16x32_bf16 v[40:43], a[164:167], a[100:103], v[40:43]
s_add_u32 m0, s32, 8192
v_exp_f32 v32, v32
v_mfma_f32_16x16x32_bf16 v[40:43], a[168:171], a[104:107], v[40:43]
s_add_u32 s31, s29, 73728
v_exp_f32 v33, v33
v_mfma_f32_16x16x32_bf16 v[40:43], a[172:175], a[108:111], v[40:43]
v_exp_f32 v34, v34
v_mfma_f32_16x16x32_bf16 v[192:195], a[192:195], v[56:59], v[192:195]
v_exp_f32 v35, v35
v_mfma_f32_16x16x32_bf16 v[196:199], a[196:199], v[56:59], v[196:199]
ds_read_b64_tr_b16 a[218:219], v12 offset:28672
v_cvt_pk_bf16_f32 v62, v32, v33
v_mfma_f32_16x16x32_bf16 v[200:203], a[200:203], v[56:59], v[200:203]
ds_read_b64_tr_b16 a[220:221], v13 offset:24576
v_cvt_pk_bf16_f32 v63, v34, v35
v_mfma_f32_16x16x32_bf16 v[204:207], a[204:207], v[56:59], v[204:207]
ds_read_b64_tr_b16 a[222:223], v13 offset:28672
v_fmamk_f32 v36, v36, 0x3e0293ee, v23
v_mfma_f32_16x16x32_bf16 v[32:35], a[160:163], a[112:115], 0
v_exp_f32 v36, v36
v_mfma_f32_16x16x32_bf16 v[32:35], a[164:167], a[116:119], v[32:35]
ds_read_b128 a[176:179], v2 offset:36864
v_fmamk_f32 v37, v37, 0x3e0293ee, v23
v_mfma_f32_16x16x32_bf16 v[32:35], a[168:171], a[120:123], v[32:35]
v_exp_f32 v37, v37
v_mfma_f32_16x16x32_bf16 v[32:35], a[172:175], a[124:127], v[32:35]
ds_read_b128 a[180:183], v3 offset:36864
v_fmamk_f32 v38, v38, 0x3e0293ee, v23
v_mfma_f32_16x16x32_bf16 v[224:227], a[192:195], v[60:63], v[224:227]
v_exp_f32 v38, v38
v_mfma_f32_16x16x32_bf16 v[228:231], a[196:199], v[60:63], v[228:231]
ds_read_b128 a[184:187], v4 offset:36864
v_fmamk_f32 v39, v39, 0x3e0293ee, v23
v_mfma_f32_16x16x32_bf16 v[232:235], a[200:203], v[60:63], v[232:235]
v_exp_f32 v39, v39
v_mfma_f32_16x16x32_bf16 v[236:239], a[204:207], v[60:63], v[236:239]
v_cvt_pk_bf16_f32 v64, v36, v37
v_cvt_pk_bf16_f32 v65, v38, v39
v_mfma_f32_16x16x32_bf16 a[232:235], a[244:247], v[52:55], a[232:235]
ds_read_b128 a[188:191], v5 offset:36864
v_fmamk_f32 v40, v40, 0x3e0293ee, v24
v_mfma_f32_16x16x32_bf16 v[36:39], a[160:163], a[128:131], 0
v_exp_f32 v40, v40
v_mfma_f32_16x16x32_bf16 v[36:39], a[164:167], a[132:135], v[36:39]
v_fmamk_f32 v41, v41, 0x3e0293ee, v24
v_fmamk_f32 v42, v42, 0x3e0293ee, v24
v_mfma_f32_16x16x32_bf16 v[36:39], a[168:171], a[136:139], v[36:39]
v_exp_f32 v41, v41
v_mfma_f32_16x16x32_bf16 v[36:39], a[172:175], a[140:143], v[36:39]
s_waitcnt lgkmcnt(2)
v_exp_f32 v42, v42
v_mfma_f32_16x16x32_bf16 v[112:115], a[208:211], v[76:79], v[112:115]
v_fmamk_f32 v43, v43, 0x3e0293ee, v24
v_cvt_pk_bf16_f32 v68, v40, v41
v_mfma_f32_16x16x32_bf16 v[116:119], a[212:215], v[76:79], v[116:119]
v_exp_f32 v43, v43
v_mfma_f32_16x16x32_bf16 v[120:123], a[216:219], v[76:79], v[120:123]
v_cvt_pk_bf16_f32 v69, v42, v43
v_fmamk_f32 v32, v32, 0x3e0293ee, v25
v_mfma_f32_16x16x32_bf16 v[124:127], a[220:223], v[76:79], v[124:127]
v_exp_f32 v32, v32
v_mfma_f32_16x16x32_bf16 v[40:43], a[160:163], a[144:147], 0
v_fmamk_f32 v33, v33, 0x3e0293ee, v25
v_fmamk_f32 v34, v34, 0x3e0293ee, v25
v_mfma_f32_16x16x32_bf16 v[40:43], a[164:167], a[148:151], v[40:43]
v_exp_f32 v33, v33
v_mfma_f32_16x16x32_bf16 v[40:43], a[168:171], a[152:155], v[40:43]
v_exp_f32 v34, v34
v_mfma_f32_16x16x32_bf16 v[40:43], a[172:175], a[156:159], v[40:43]
v_fmamk_f32 v35, v35, 0x3e0293ee, v25
v_cvt_pk_bf16_f32 v72, v32, v33
v_mfma_f32_16x16x32_bf16 v[144:147], a[208:211], v[48:51], v[144:147]
v_exp_f32 v35, v35
v_mfma_f32_16x16x32_bf16 v[148:151], a[212:215], v[48:51], v[148:151]
v_cvt_pk_bf16_f32 v73, v34, v35
v_fmamk_f32 v36, v36, 0x3e0293ee, v26
v_mfma_f32_16x16x32_bf16 v[152:155], a[216:219], v[48:51], v[152:155]
v_exp_f32 v36, v36
v_mfma_f32_16x16x32_bf16 v[156:159], a[220:223], v[48:51], v[156:159]
v_fmamk_f32 v37, v37, 0x3e0293ee, v26
v_fmamk_f32 v38, v38, 0x3e0293ee, v26
v_mfma_f32_16x16x32_bf16 a[236:239], a[244:247], v[56:59], a[236:239]
v_exp_f32 v37, v37
v_mfma_f32_16x16x32_bf16 v[32:35], a[176:179], a[80:83], 0
v_exp_f32 v38, v38
v_mfma_f32_16x16x32_bf16 v[32:35], a[180:183], a[84:87], v[32:35]
s_waitcnt lgkmcnt(0)
v_fmamk_f32 v39, v39, 0x3e0293ee, v26
v_cvt_pk_bf16_f32 v76, v36, v37
v_mfma_f32_16x16x32_bf16 v[32:35], a[184:187], a[88:91], v[32:35]
v_exp_f32 v39, v39
v_mfma_f32_16x16x32_bf16 v[32:35], a[188:191], a[92:95], v[32:35]
ds_read_b64_tr_b16 a[192:193], v6 offset:32768
v_cvt_pk_bf16_f32 v77, v38, v39
v_mfma_f32_16x16x32_bf16 v[176:179], a[208:211], v[52:55], v[176:179]
ds_read_b64_tr_b16 a[194:195], v6 offset:36864
v_fmamk_f32 v40, v40, 0x3e0293ee, v27
v_mfma_f32_16x16x32_bf16 v[180:183], a[212:215], v[52:55], v[180:183]
v_exp_f32 v40, v40
v_mfma_f32_16x16x32_bf16 v[184:187], a[216:219], v[52:55], v[184:187]
ds_read_b64_tr_b16 a[196:197], v7 offset:32768
v_fmamk_f32 v41, v41, 0x3e0293ee, v27
v_mfma_f32_16x16x32_bf16 v[188:191], a[220:223], v[52:55], v[188:191]
v_exp_f32 v41, v41
v_mfma_f32_16x16x32_bf16 v[36:39], a[176:179], a[96:99], 0
ds_read_b64_tr_b16 a[198:199], v7 offset:36864
v_fmamk_f32 v42, v42, 0x3e0293ee, v27
v_mfma_f32_16x16x32_bf16 v[36:39], a[180:183], a[100:103], v[36:39]
v_exp_f32 v42, v42
v_mfma_f32_16x16x32_bf16 v[36:39], a[184:187], a[104:107], v[36:39]
ds_read_b64_tr_b16 a[200:201], v8 offset:32768
v_fmamk_f32 v43, v43, 0x3e0293ee, v27
v_mfma_f32_16x16x32_bf16 v[36:39], a[188:191], a[108:111], v[36:39]
v_exp_f32 v43, v43
v_mfma_f32_16x16x32_bf16 v[208:211], a[208:211], v[56:59], v[208:211]
ds_read_b64_tr_b16 a[202:203], v8 offset:36864
v_cvt_pk_bf16_f32 v48, v40, v41
v_mfma_f32_16x16x32_bf16 v[212:215], a[212:215], v[56:59], v[212:215]
ds_read_b64_tr_b16 a[204:205], v9 offset:32768
v_cvt_pk_bf16_f32 v49, v42, v43
v_mfma_f32_16x16x32_bf16 v[216:219], a[216:219], v[56:59], v[216:219]
ds_read_b64_tr_b16 a[206:207], v9 offset:36864
v_add_u32 v28, s38, v19
v_mfma_f32_16x16x32_bf16 v[220:223], a[220:223], v[56:59], v[220:223]
s_add_u32 s38, s63, 4096
buffer_store_dwordx4 a[16:19], v28, s[12:15], 0 offen offset:0 sc0 sc1 nt
buffer_load_dwordx4 v14, s[20:23], s30 offen nt lds
buffer_load_dwordx4 v15, s[20:23], s30 offen offset:1024 nt lds
v_mfma_f32_16x16x32_bf16 a[240:243], a[244:247], v[60:63], a[240:243]
s_add_u32 m0, s32, 73728
ds_read_b128 a[160:163], v2 offset:40960
v_fmamk_f32 v32, v32, 0x3e0293ee, v23
v_mfma_f32_16x16x32_bf16 v[40:43], a[176:179], a[112:115], 0
s_add_u32 s38, s38, s75
v_exp_f32 v32, v32
v_mfma_f32_16x16x32_bf16 v[40:43], a[180:183], a[116:119], v[40:43]
s_add_u32 s30, s29, 81920
ds_read_b128 a[164:167], v3 offset:40960
v_fmamk_f32 v33, v33, 0x3e0293ee, v23
v_mfma_f32_16x16x32_bf16 v[40:43], a[184:187], a[120:123], v[40:43]
v_exp_f32 v33, v33
v_mfma_f32_16x16x32_bf16 v[40:43], a[188:191], a[124:127], v[40:43]
v_fmamk_f32 v34, v34, 0x3e0293ee, v23
v_fmamk_f32 v35, v35, 0x3e0293ee, v23
v_mfma_f32_16x16x32_bf16 v[240:243], a[208:211], v[60:63], v[240:243]
v_exp_f32 v34, v34
v_mfma_f32_16x16x32_bf16 v[244:247], a[212:215], v[60:63], v[244:247]
v_exp_f32 v35, v35
v_mfma_f32_16x16x32_bf16 v[248:251], a[216:219], v[60:63], v[248:251]
ds_read_b128 a[168:171], v4 offset:40960
v_cvt_pk_bf16_f32 v66, v32, v33
v_mfma_f32_16x16x32_bf16 v[252:255], a[220:223], v[60:63], v[252:255]
v_cvt_pk_bf16_f32 v67, v34, v35
v_fmamk_f32 v36, v36, 0x3e0293ee, v24
v_mfma_f32_16x16x32_bf16 v[32:35], a[176:179], a[128:131], 0
v_exp_f32 v36, v36
v_mfma_f32_16x16x32_bf16 v[32:35], a[180:183], a[132:135], v[32:35]
ds_read_b128 a[172:175], v5 offset:40960
v_fmamk_f32 v37, v37, 0x3e0293ee, v24
v_mfma_f32_16x16x32_bf16 v[32:35], a[184:187], a[136:139], v[32:35]
v_exp_f32 v37, v37
v_mfma_f32_16x16x32_bf16 v[32:35], a[188:191], a[140:143], v[32:35]
s_waitcnt lgkmcnt(2)
v_fmamk_f32 v38, v38, 0x3e0293ee, v24
v_fmamk_f32 v39, v39, 0x3e0293ee, v24
v_mfma_f32_16x16x32_bf16 v[96:99], a[192:195], v[64:67], v[96:99]
v_exp_f32 v38, v38
v_mfma_f32_16x16x32_bf16 v[100:103], a[196:199], v[64:67], v[100:103]
v_exp_f32 v39, v39
v_mfma_f32_16x16x32_bf16 v[104:107], a[200:203], v[64:67], v[104:107]
v_cvt_pk_bf16_f32 v70, v36, v37
v_cvt_pk_bf16_f32 v71, v38, v39
v_mfma_f32_16x16x32_bf16 v[108:111], a[204:207], v[64:67], v[108:111]
v_fmamk_f32 v40, v40, 0x3e0293ee, v25
v_fmamk_f32 v41, v41, 0x3e0293ee, v25
v_mfma_f32_16x16x32_bf16 a[224:227], a[244:247], v[64:67], a[224:227]
v_exp_f32 v40, v40
v_mfma_f32_16x16x32_bf16 v[36:39], a[176:179], a[144:147], 0
v_exp_f32 v41, v41
v_mfma_f32_16x16x32_bf16 v[36:39], a[180:183], a[148:151], v[36:39]
v_fmamk_f32 v42, v42, 0x3e0293ee, v25
v_fmamk_f32 v43, v43, 0x3e0293ee, v25
v_mfma_f32_16x16x32_bf16 v[36:39], a[184:187], a[152:155], v[36:39]
v_exp_f32 v42, v42
v_mfma_f32_16x16x32_bf16 v[36:39], a[188:191], a[156:159], v[36:39]
v_exp_f32 v43, v43
v_mfma_f32_16x16x32_bf16 v[128:131], a[192:195], v[68:71], v[128:131]
v_cvt_pk_bf16_f32 v74, v40, v41
v_cvt_pk_bf16_f32 v75, v42, v43
v_mfma_f32_16x16x32_bf16 v[132:135], a[196:199], v[68:71], v[132:135]
v_fmamk_f32 v32, v32, 0x3e0293ee, v26
v_fmamk_f32 v33, v33, 0x3e0293ee, v26
v_mfma_f32_16x16x32_bf16 v[136:139], a[200:203], v[68:71], v[136:139]
v_exp_f32 v32, v32
v_mfma_f32_16x16x32_bf16 v[140:143], a[204:207], v[68:71], v[140:143]
v_exp_f32 v33, v33
v_mfma_f32_16x16x32_bf16 v[40:43], a[160:163], a[80:83], 0
v_fmamk_f32 v34, v34, 0x3e0293ee, v26
v_fmamk_f32 v35, v35, 0x3e0293ee, v26
v_mfma_f32_16x16x32_bf16 v[40:43], a[164:167], a[84:87], v[40:43]
s_waitcnt lgkmcnt(0)
v_exp_f32 v34, v34
v_mfma_f32_16x16x32_bf16 v[40:43], a[168:171], a[88:91], v[40:43]
v_exp_f32 v35, v35
v_mfma_f32_16x16x32_bf16 v[40:43], a[172:175], a[92:95], v[40:43]
v_cvt_pk_bf16_f32 v78, v32, v33
v_cvt_pk_bf16_f32 v79, v34, v35
v_mfma_f32_16x16x32_bf16 v[160:163], a[192:195], v[72:75], v[160:163]
ds_read_b64_tr_b16 a[208:209], v10 offset:32768
v_fmamk_f32 v36, v36, 0x3e0293ee, v27
v_mfma_f32_16x16x32_bf16 v[164:167], a[196:199], v[72:75], v[164:167]
ds_read_b64_tr_b16 a[210:211], v10 offset:36864
v_fmamk_f32 v37, v37, 0x3e0293ee, v27
v_mfma_f32_16x16x32_bf16 v[168:171], a[200:203], v[72:75], v[168:171]
ds_read_b64_tr_b16 a[212:213], v11 offset:32768
v_fmamk_f32 v38, v38, 0x3e0293ee, v27
v_mfma_f32_16x16x32_bf16 v[172:175], a[204:207], v[72:75], v[172:175]
ds_read_b64_tr_b16 a[214:215], v11 offset:36864
v_fmamk_f32 v39, v39, 0x3e0293ee, v27
v_mfma_f32_16x16x32_bf16 a[228:231], a[244:247], v[68:71], a[228:231]
buffer_store_dwordx4 a[20:23], v28, s[12:15], 0 offen offset:2048 sc0 sc1 nt
buffer_load_dwordx4 v16, s[24:27], s31 offen nt lds
buffer_load_dwordx4 v17, s[24:27], s31 offen offset:1024 nt lds
v_mfma_f32_16x16x32_bf16 v[32:35], a[160:163], a[96:99], 0
s_add_u32 m0, s32, 16384
v_exp_f32 v36, v36
v_mfma_f32_16x16x32_bf16 v[32:35], a[164:167], a[100:103], v[32:35]
s_add_u32 s31, s29, 81920
v_exp_f32 v37, v37
v_mfma_f32_16x16x32_bf16 v[32:35], a[168:171], a[104:107], v[32:35]
v_exp_f32 v38, v38
v_mfma_f32_16x16x32_bf16 v[32:35], a[172:175], a[108:111], v[32:35]
v_exp_f32 v39, v39
v_mfma_f32_16x16x32_bf16 v[192:195], a[192:195], v[76:79], v[192:195]
ds_read_b64_tr_b16 a[216:217], v12 offset:32768
v_cvt_pk_bf16_f32 v50, v36, v37
v_mfma_f32_16x16x32_bf16 v[196:199], a[196:199], v[76:79], v[196:199]
ds_read_b64_tr_b16 a[218:219], v12 offset:36864
v_cvt_pk_bf16_f32 v51, v38, v39
v_mfma_f32_16x16x32_bf16 v[200:203], a[200:203], v[76:79], v[200:203]
ds_read_b64_tr_b16 a[220:221], v13 offset:32768
v_fmamk_f32 v40, v40, 0x3e0293ee, v23
v_mfma_f32_16x16x32_bf16 v[204:207], a[204:207], v[76:79], v[204:207]
v_exp_f32 v40, v40
v_mfma_f32_16x16x32_bf16 v[36:39], a[160:163], a[112:115], 0
ds_read_b64_tr_b16 a[222:223], v13 offset:36864
v_fmamk_f32 v41, v41, 0x3e0293ee, v23
v_mfma_f32_16x16x32_bf16 v[36:39], a[164:167], a[116:119], v[36:39]
v_exp_f32 v41, v41
v_mfma_f32_16x16x32_bf16 v[36:39], a[168:171], a[120:123], v[36:39]
ds_read_b128 a[176:179], v2 offset:45056
v_fmamk_f32 v42, v42, 0x3e0293ee, v23
v_mfma_f32_16x16x32_bf16 v[36:39], a[172:175], a[124:127], v[36:39]
v_exp_f32 v42, v42
v_mfma_f32_16x16x32_bf16 v[224:227], a[192:195], v[48:51], v[224:227]
ds_read_b128 a[180:183], v3 offset:45056
v_fmamk_f32 v43, v43, 0x3e0293ee, v23
v_mfma_f32_16x16x32_bf16 v[228:231], a[196:199], v[48:51], v[228:231]
v_exp_f32 v43, v43
v_mfma_f32_16x16x32_bf16 v[232:235], a[200:203], v[48:51], v[232:235]
ds_read_b128 a[184:187], v4 offset:45056
v_cvt_pk_bf16_f32 v52, v40, v41
v_mfma_f32_16x16x32_bf16 v[236:239], a[204:207], v[48:51], v[236:239]
ds_read_b128 a[188:191], v5 offset:45056
v_cvt_pk_bf16_f32 v53, v42, v43
v_mfma_f32_16x16x32_bf16 a[232:235], a[244:247], v[72:75], a[232:235]
v_fmamk_f32 v32, v32, 0x3e0293ee, v24
v_fmamk_f32 v33, v33, 0x3e0293ee, v24
v_mfma_f32_16x16x32_bf16 v[40:43], a[160:163], a[128:131], 0
v_exp_f32 v32, v32
v_mfma_f32_16x16x32_bf16 v[40:43], a[164:167], a[132:135], v[40:43]
v_exp_f32 v33, v33
v_mfma_f32_16x16x32_bf16 v[40:43], a[168:171], a[136:139], v[40:43]
v_fmamk_f32 v34, v34, 0x3e0293ee, v24
v_fmamk_f32 v35, v35, 0x3e0293ee, v24
v_mfma_f32_16x16x32_bf16 v[40:43], a[172:175], a[140:143], v[40:43]
s_waitcnt lgkmcnt(2)
v_exp_f32 v34, v34
v_mfma_f32_16x16x32_bf16 v[112:115], a[208:211], v[64:67], v[112:115]
v_exp_f32 v35, v35
v_mfma_f32_16x16x32_bf16 v[116:119], a[212:215], v[64:67], v[116:119]
v_cvt_pk_bf16_f32 v56, v32, v33
v_cvt_pk_bf16_f32 v57, v34, v35
v_mfma_f32_16x16x32_bf16 v[120:123], a[216:219], v[64:67], v[120:123]
v_fmamk_f32 v36, v36, 0x3e0293ee, v25
v_fmamk_f32 v37, v37, 0x3e0293ee, v25
v_mfma_f32_16x16x32_bf16 v[124:127], a[220:223], v[64:67], v[124:127]
v_exp_f32 v36, v36
v_mfma_f32_16x16x32_bf16 v[32:35], a[160:163], a[144:147], 0
v_exp_f32 v37, v37
v_mfma_f32_16x16x32_bf16 v[32:35], a[164:167], a[148:151], v[32:35]
v_fmamk_f32 v38, v38, 0x3e0293ee, v25
v_fmamk_f32 v39, v39, 0x3e0293ee, v25
v_mfma_f32_16x16x32_bf16 v[32:35], a[168:171], a[152:155], v[32:35]
v_exp_f32 v38, v38
v_mfma_f32_16x16x32_bf16 v[32:35], a[172:175], a[156:159], v[32:35]
v_exp_f32 v39, v39
v_mfma_f32_16x16x32_bf16 v[144:147], a[208:211], v[68:71], v[144:147]
v_cvt_pk_bf16_f32 v60, v36, v37
v_cvt_pk_bf16_f32 v61, v38, v39
v_mfma_f32_16x16x32_bf16 v[148:151], a[212:215], v[68:71], v[148:151]
v_fmamk_f32 v40, v40, 0x3e0293ee, v26
v_fmamk_f32 v41, v41, 0x3e0293ee, v26
v_mfma_f32_16x16x32_bf16 v[152:155], a[216:219], v[68:71], v[152:155]
v_exp_f32 v40, v40
v_mfma_f32_16x16x32_bf16 v[156:159], a[220:223], v[68:71], v[156:159]
v_exp_f32 v41, v41
v_mfma_f32_16x16x32_bf16 a[236:239], a[244:247], v[76:79], a[236:239]
s_waitcnt vmcnt(8) lgkmcnt(0)
v_fmamk_f32 v42, v42, 0x3e0293ee, v26
v_fmamk_f32 v43, v43, 0x3e0293ee, v26
v_mfma_f32_16x16x32_bf16 v[36:39], a[176:179], a[80:83], 0
s_barrier
v_exp_f32 v42, v42
v_mfma_f32_16x16x32_bf16 v[36:39], a[180:183], a[84:87], v[36:39]
v_exp_f32 v43, v43
v_mfma_f32_16x16x32_bf16 v[36:39], a[184:187], a[88:91], v[36:39]
v_cvt_pk_bf16_f32 v64, v40, v41
v_cvt_pk_bf16_f32 v65, v42, v43
v_mfma_f32_16x16x32_bf16 v[36:39], a[188:191], a[92:95], v[36:39]
ds_read_b64_tr_b16 a[192:193], v6 offset:40960
v_fmamk_f32 v32, v32, 0x3e0293ee, v27
v_mfma_f32_16x16x32_bf16 v[176:179], a[208:211], v[72:75], v[176:179]
v_exp_f32 v32, v32
v_mfma_f32_16x16x32_bf16 v[180:183], a[212:215], v[72:75], v[180:183]
ds_read_b64_tr_b16 a[194:195], v6 offset:45056
v_fmamk_f32 v33, v33, 0x3e0293ee, v27
v_mfma_f32_16x16x32_bf16 v[184:187], a[216:219], v[72:75], v[184:187]
v_exp_f32 v33, v33
v_mfma_f32_16x16x32_bf16 v[188:191], a[220:223], v[72:75], v[188:191]
ds_read_b64_tr_b16 a[196:197], v7 offset:40960
v_fmamk_f32 v34, v34, 0x3e0293ee, v27
v_mfma_f32_16x16x32_bf16 v[40:43], a[176:179], a[96:99], 0
v_exp_f32 v34, v34
v_mfma_f32_16x16x32_bf16 v[40:43], a[180:183], a[100:103], v[40:43]
ds_read_b64_tr_b16 a[198:199], v7 offset:45056
v_fmamk_f32 v35, v35, 0x3e0293ee, v27
v_mfma_f32_16x16x32_bf16 v[40:43], a[184:187], a[104:107], v[40:43]
v_exp_f32 v35, v35
v_mfma_f32_16x16x32_bf16 v[40:43], a[188:191], a[108:111], v[40:43]
ds_read_b64_tr_b16 a[200:201], v8 offset:40960
v_cvt_pk_bf16_f32 v68, v32, v33
v_mfma_f32_16x16x32_bf16 v[208:211], a[208:211], v[76:79], v[208:211]
ds_read_b64_tr_b16 a[202:203], v8 offset:45056
v_cvt_pk_bf16_f32 v69, v34, v35
v_mfma_f32_16x16x32_bf16 v[212:215], a[212:215], v[76:79], v[212:215]
ds_read_b64_tr_b16 a[204:205], v9 offset:40960
v_add_u32 v28, s38, v19
v_mfma_f32_16x16x32_bf16 v[216:219], a[216:219], v[76:79], v[216:219]
s_add_u32 s38, s63, 8192
buffer_store_dwordx4 a[24:27], v28, s[12:15], 0 offen offset:0 sc0 sc1 nt
buffer_load_dwordx4 v14, s[20:23], s30 offen nt lds
buffer_load_dwordx4 v15, s[20:23], s30 offen offset:1024 nt lds
v_mfma_f32_16x16x32_bf16 v[220:223], a[220:223], v[76:79], v[220:223]
s_add_u32 m0, s32, 81920
ds_read_b64_tr_b16 a[206:207], v9 offset:45056
v_fmamk_f32 v36, v36, 0x3e0293ee, v23
v_mfma_f32_16x16x32_bf16 a[240:243], a[244:247], v[48:51], a[240:243]
s_add_u32 s38, s38, s76
v_exp_f32 v36, v36
v_mfma_f32_16x16x32_bf16 v[32:35], a[176:179], a[112:115], 0
s_add_u32 s30, s29, 90112
ds_read_b128 a[160:163], v2 offset:49152
v_fmamk_f32 v37, v37, 0x3e0293ee, v23
v_mfma_f32_16x16x32_bf16 v[32:35], a[180:183], a[116:119], v[32:35]
v_exp_f32 v37, v37
v_mfma_f32_16x16x32_bf16 v[32:35], a[184:187], a[120:123], v[32:35]
ds_read_b128 a[164:167], v3 offset:49152
v_fmamk_f32 v38, v38, 0x3e0293ee, v23
v_mfma_f32_16x16x32_bf16 v[32:35], a[188:191], a[124:127], v[32:35]
v_exp_f32 v38, v38
v_mfma_f32_16x16x32_bf16 v[240:243], a[208:211], v[48:51], v[240:243]
ds_read_b128 a[168:171], v4 offset:49152
v_fmamk_f32 v39, v39, 0x3e0293ee, v23
v_mfma_f32_16x16x32_bf16 v[244:247], a[212:215], v[48:51], v[244:247]
v_exp_f32 v39, v39
v_mfma_f32_16x16x32_bf16 v[248:251], a[216:219], v[48:51], v[248:251]
v_cvt_pk_bf16_f32 v54, v36, v37
v_cvt_pk_bf16_f32 v55, v38, v39
v_mfma_f32_16x16x32_bf16 v[252:255], a[220:223], v[48:51], v[252:255]
ds_read_b128 a[172:175], v5 offset:49152
v_fmamk_f32 v40, v40, 0x3e0293ee, v24
v_mfma_f32_16x16x32_bf16 v[36:39], a[176:179], a[128:131], 0
v_exp_f32 v40, v40
v_mfma_f32_16x16x32_bf16 v[36:39], a[180:183], a[132:135], v[36:39]
v_fmamk_f32 v41, v41, 0x3e0293ee, v24
v_fmamk_f32 v42, v42, 0x3e0293ee, v24
v_mfma_f32_16x16x32_bf16 v[36:39], a[184:187], a[136:139], v[36:39]
v_exp_f32 v41, v41
v_mfma_f32_16x16x32_bf16 v[36:39], a[188:191], a[140:143], v[36:39]
s_waitcnt lgkmcnt(2)
v_exp_f32 v42, v42
v_mfma_f32_16x16x32_bf16 v[96:99], a[192:195], v[52:55], v[96:99]
v_fmamk_f32 v43, v43, 0x3e0293ee, v24
v_cvt_pk_bf16_f32 v58, v40, v41
v_mfma_f32_16x16x32_bf16 v[100:103], a[196:199], v[52:55], v[100:103]
v_exp_f32 v43, v43
v_mfma_f32_16x16x32_bf16 v[104:107], a[200:203], v[52:55], v[104:107]
v_cvt_pk_bf16_f32 v59, v42, v43
v_fmamk_f32 v32, v32, 0x3e0293ee, v25
v_mfma_f32_16x16x32_bf16 v[108:111], a[204:207], v[52:55], v[108:111]
v_exp_f32 v32, v32
v_mfma_f32_16x16x32_bf16 a[224:227], a[244:247], v[52:55], a[224:227]
v_fmamk_f32 v33, v33, 0x3e0293ee, v25
v_fmamk_f32 v34, v34, 0x3e0293ee, v25
v_mfma_f32_16x16x32_bf16 v[40:43], a[176:179], a[144:147], 0
v_exp_f32 v33, v33
v_mfma_f32_16x16x32_bf16 v[40:43], a[180:183], a[148:151], v[40:43]
v_exp_f32 v34, v34
v_mfma_f32_16x16x32_bf16 v[40:43], a[184:187], a[152:155], v[40:43]
v_fmamk_f32 v35, v35, 0x3e0293ee, v25
v_cvt_pk_bf16_f32 v62, v32, v33
v_mfma_f32_16x16x32_bf16 v[40:43], a[188:191], a[156:159], v[40:43]
v_exp_f32 v35, v35
v_mfma_f32_16x16x32_bf16 v[128:131], a[192:195], v[56:59], v[128:131]
v_cvt_pk_bf16_f32 v63, v34, v35
v_fmamk_f32 v36, v36, 0x3e0293ee, v26
v_mfma_f32_16x16x32_bf16 v[132:135], a[196:199], v[56:59], v[132:135]
v_exp_f32 v36, v36
v_mfma_f32_16x16x32_bf16 v[136:139], a[200:203], v[56:59], v[136:139]
v_fmamk_f32 v37, v37, 0x3e0293ee, v26
v_fmamk_f32 v38, v38, 0x3e0293ee, v26
v_mfma_f32_16x16x32_bf16 v[140:143], a[204:207], v[56:59], v[140:143]
v_exp_f32 v37, v37
v_mfma_f32_16x16x32_bf16 v[32:35], a[160:163], a[80:83], 0
v_exp_f32 v38, v38
v_mfma_f32_16x16x32_bf16 v[32:35], a[164:167], a[84:87], v[32:35]
s_waitcnt lgkmcnt(0)
v_fmamk_f32 v39, v39, 0x3e0293ee, v26
v_cvt_pk_bf16_f32 v66, v36, v37
v_mfma_f32_16x16x32_bf16 v[32:35], a[168:171], a[88:91], v[32:35]
v_exp_f32 v39, v39
v_mfma_f32_16x16x32_bf16 v[32:35], a[172:175], a[92:95], v[32:35]
ds_read_b64_tr_b16 a[208:209], v10 offset:40960
v_cvt_pk_bf16_f32 v67, v38, v39
v_mfma_f32_16x16x32_bf16 v[160:163], a[192:195], v[60:63], v[160:163]
ds_read_b64_tr_b16 a[210:211], v10 offset:45056
v_fmamk_f32 v40, v40, 0x3e0293ee, v27
v_mfma_f32_16x16x32_bf16 v[164:167], a[196:199], v[60:63], v[164:167]
ds_read_b64_tr_b16 a[212:213], v11 offset:40960
v_fmamk_f32 v41, v41, 0x3e0293ee, v27
v_mfma_f32_16x16x32_bf16 v[168:171], a[200:203], v[60:63], v[168:171]
ds_read_b64_tr_b16 a[214:215], v11 offset:45056
v_fmamk_f32 v42, v42, 0x3e0293ee, v27
v_mfma_f32_16x16x32_bf16 v[172:175], a[204:207], v[60:63], v[172:175]
ds_read_b64_tr_b16 a[216:217], v12 offset:40960
v_fmamk_f32 v43, v43, 0x3e0293ee, v27
v_mfma_f32_16x16x32_bf16 a[228:231], a[244:247], v[56:59], a[228:231]
buffer_store_dwordx4 a[28:31], v28, s[12:15], 0 offen offset:2048 sc0 sc1 nt
buffer_load_dwordx4 v16, s[24:27], s31 offen nt lds
buffer_load_dwordx4 v17, s[24:27], s31 offen offset:1024 nt lds
v_mfma_f32_16x16x32_bf16 v[36:39], a[160:163], a[96:99], 0
s_add_u32 m0, s32, 24576
v_exp_f32 v40, v40
v_mfma_f32_16x16x32_bf16 v[36:39], a[164:167], a[100:103], v[36:39]
s_add_u32 s31, s29, 90112
v_exp_f32 v41, v41
v_mfma_f32_16x16x32_bf16 v[36:39], a[168:171], a[104:107], v[36:39]
v_exp_f32 v42, v42
v_mfma_f32_16x16x32_bf16 v[36:39], a[172:175], a[108:111], v[36:39]
v_exp_f32 v43, v43
v_mfma_f32_16x16x32_bf16 v[192:195], a[192:195], v[64:67], v[192:195]
ds_read_b64_tr_b16 a[218:219], v12 offset:45056
v_cvt_pk_bf16_f32 v70, v40, v41
v_mfma_f32_16x16x32_bf16 v[196:199], a[196:199], v[64:67], v[196:199]
ds_read_b64_tr_b16 a[220:221], v13 offset:40960
v_cvt_pk_bf16_f32 v71, v42, v43
v_mfma_f32_16x16x32_bf16 v[200:203], a[200:203], v[64:67], v[200:203]
ds_read_b64_tr_b16 a[222:223], v13 offset:45056
v_fmamk_f32 v32, v32, 0x3e0293ee, v23
v_mfma_f32_16x16x32_bf16 v[204:207], a[204:207], v[64:67], v[204:207]
v_exp_f32 v32, v32
v_mfma_f32_16x16x32_bf16 v[40:43], a[160:163], a[112:115], 0
ds_read_b128 a[176:179], v2 offset:53248
v_fmamk_f32 v33, v33, 0x3e0293ee, v23
v_mfma_f32_16x16x32_bf16 v[40:43], a[164:167], a[116:119], v[40:43]
v_exp_f32 v33, v33
v_mfma_f32_16x16x32_bf16 v[40:43], a[168:171], a[120:123], v[40:43]
L_pad1_9:
s_cbranch_execz L_pad1_13
ds_read_b128 a[180:183], v3 offset:53248
v_fmamk_f32 v34, v34, 0x3e0293ee, v23
v_mfma_f32_16x16x32_bf16 v[40:43], a[172:175], a[124:127], v[40:43]
v_exp_f32 v34, v34
v_mfma_f32_16x16x32_bf16 v[224:227], a[192:195], v[68:71], v[224:227]
ds_read_b128 a[184:187], v4 offset:53248
v_fmamk_f32 v35, v35, 0x3e0293ee, v23
v_mfma_f32_16x16x32_bf16 v[228:231], a[196:199], v[68:71], v[228:231]
v_exp_f32 v35, v35
v_mfma_f32_16x16x32_bf16 v[232:235], a[200:203], v[68:71], v[232:235]
v_cvt_pk_bf16_f32 v72, v32, v33
v_cvt_pk_bf16_f32 v73, v34, v35
v_mfma_f32_16x16x32_bf16 v[236:239], a[204:207], v[68:71], v[236:239]
ds_read_b128 a[188:191], v5 offset:53248
v_fmamk_f32 v36, v36, 0x3e0293ee, v24
v_mfma_f32_16x16x32_bf16 a[232:235], a[244:247], v[60:63], a[232:235]
v_exp_f32 v36, v36
v_mfma_f32_16x16x32_bf16 v[32:35], a[160:163], a[128:131], 0
v_fmamk_f32 v37, v37, 0x3e0293ee, v24
v_fmamk_f32 v38, v38, 0x3e0293ee, v24
v_mfma_f32_16x16x32_bf16 v[32:35], a[164:167], a[132:135], v[32:35]
v_exp_f32 v37, v37
v_mfma_f32_16x16x32_bf16 v[32:35], a[168:171], a[136:139], v[32:35]
v_exp_f32 v38, v38
v_mfma_f32_16x16x32_bf16 v[32:35], a[172:175], a[140:143], v[32:35]
s_waitcnt lgkmcnt(1)
v_fmamk_f32 v39, v39, 0x3e0293ee, v24
v_cvt_pk_bf16_f32 v76, v36, v37
v_mfma_f32_16x16x32_bf16 v[112:115], a[208:211], v[52:55], v[112:115]
v_exp_f32 v39, v39
v_mfma_f32_16x16x32_bf16 v[116:119], a[212:215], v[52:55], v[116:119]
v_cvt_pk_bf16_f32 v77, v38, v39
v_fmamk_f32 v40, v40, 0x3e0293ee, v25
v_mfma_f32_16x16x32_bf16 v[120:123], a[216:219], v[52:55], v[120:123]
v_exp_f32 v40, v40
v_mfma_f32_16x16x32_bf16 v[124:127], a[220:223], v[52:55], v[124:127]
v_fmamk_f32 v41, v41, 0x3e0293ee, v25
v_fmamk_f32 v42, v42, 0x3e0293ee, v25
v_mfma_f32_16x16x32_bf16 v[36:39], a[160:163], a[144:147], 0
v_exp_f32 v41, v41
v_mfma_f32_16x16x32_bf16 v[36:39], a[164:167], a[148:151], v[36:39]
v_exp_f32 v42, v42
v_mfma_f32_16x16x32_bf16 v[36:39], a[168:171], a[152:155], v[36:39]
v_fmamk_f32 v43, v43, 0x3e0293ee, v25
v_cvt_pk_bf16_f32 v48, v40, v41
v_mfma_f32_16x16x32_bf16 v[36:39], a[172:175], a[156:159], v[36:39]
v_exp_f32 v43, v43
v_mfma_f32_16x16x32_bf16 v[144:147], a[208:211], v[56:59], v[144:147]
v_cvt_pk_bf16_f32 v49, v42, v43
v_fmamk_f32 v32, v32, 0x3e0293ee, v26
v_mfma_f32_16x16x32_bf16 v[148:151], a[212:215], v[56:59], v[148:151]
v_exp_f32 v32, v32
v_mfma_f32_16x16x32_bf16 v[152:155], a[216:219], v[56:59], v[152:155]
v_fmamk_f32 v33, v33, 0x3e0293ee, v26
v_fmamk_f32 v34, v34, 0x3e0293ee, v26
v_mfma_f32_16x16x32_bf16 v[156:159], a[220:223], v[56:59], v[156:159]
v_exp_f32 v33, v33
v_mfma_f32_16x16x32_bf16 a[236:239], a[244:247], v[64:67], a[236:239]
v_exp_f32 v34, v34
v_mfma_f32_16x16x32_bf16 v[40:43], a[176:179], a[80:83], 0
v_fmamk_f32 v35, v35, 0x3e0293ee, v26
v_cvt_pk_bf16_f32 v52, v32, v33
v_mfma_f32_16x16x32_bf16 v[40:43], a[180:183], a[84:87], v[40:43]
v_exp_f32 v35, v35
v_mfma_f32_16x16x32_bf16 v[40:43], a[184:187], a[88:91], v[40:43]
s_waitcnt lgkmcnt(0)
ds_read_b64_tr_b16 a[192:193], v6 offset:49152
v_cvt_pk_bf16_f32 v53, v34, v35
v_mfma_f32_16x16x32_bf16 v[40:43], a[188:191], a[92:95], v[40:43]
ds_read_b64_tr_b16 a[194:195], v6 offset:53248
v_fmamk_f32 v36, v36, 0x3e0293ee, v27
v_mfma_f32_16x16x32_bf16 v[176:179], a[208:211], v[60:63], v[176:179]
v_exp_f32 v36, v36
v_mfma_f32_16x16x32_bf16 v[180:183], a[212:215], v[60:63], v[180:183]
ds_read_b64_tr_b16 a[196:197], v7 offset:49152
v_fmamk_f32 v37, v37, 0x3e0293ee, v27
v_mfma_f32_16x16x32_bf16 v[184:187], a[216:219], v[60:63], v[184:187]
v_exp_f32 v37, v37
v_mfma_f32_16x16x32_bf16 v[188:191], a[220:223], v[60:63], v[188:191]
ds_read_b64_tr_b16 a[198:199], v7 offset:53248
v_fmamk_f32 v38, v38, 0x3e0293ee, v27
v_mfma_f32_16x16x32_bf16 v[32:35], a[176:179], a[96:99], 0
v_exp_f32 v38, v38
v_mfma_f32_16x16x32_bf16 v[32:35], a[180:183], a[100:103], v[32:35]
ds_read_b64_tr_b16 a[200:201], v8 offset:49152
v_fmamk_f32 v39, v39, 0x3e0293ee, v27
v_mfma_f32_16x16x32_bf16 v[32:35], a[184:187], a[104:107], v[32:35]
v_exp_f32 v39, v39
v_mfma_f32_16x16x32_bf16 v[32:35], a[188:191], a[108:111], v[32:35]
ds_read_b64_tr_b16 a[202:203], v8 offset:53248
v_cvt_pk_bf16_f32 v56, v36, v37
v_mfma_f32_16x16x32_bf16 v[208:211], a[208:211], v[64:67], v[208:211]
ds_read_b64_tr_b16 a[204:205], v9 offset:49152
v_cvt_pk_bf16_f32 v57, v38, v39
v_mfma_f32_16x16x32_bf16 v[212:215], a[212:215], v[64:67], v[212:215]
ds_read_b64_tr_b16 a[206:207], v9 offset:53248
v_add_u32 v28, s38, v19
v_mfma_f32_16x16x32_bf16 v[216:219], a[216:219], v[64:67], v[216:219]
s_add_u32 s38, s63, 8192
buffer_store_dwordx4 a[32:35], v28, s[12:15], 0 offen offset:0 sc0 sc1 nt
buffer_load_dwordx4 v14, s[20:23], s30 offen nt lds
buffer_load_dwordx4 v15, s[20:23], s30 offen offset:1024 nt lds
v_mfma_f32_16x16x32_bf16 v[220:223], a[220:223], v[64:67], v[220:223]
s_add_u32 m0, s32, 90112
ds_read_b128 a[160:163], v2 offset:57344
v_fmamk_f32 v40, v40, 0x3e0293ee, v23
v_mfma_f32_16x16x32_bf16 a[240:243], a[244:247], v[68:71], a[240:243]
s_add_u32 s38, s38, s75
v_exp_f32 v40, v40
v_mfma_f32_16x16x32_bf16 v[36:39], a[176:179], a[112:115], 0
s_add_u32 s30, s29, 98304
ds_read_b128 a[164:167], v3 offset:57344
v_fmamk_f32 v41, v41, 0x3e0293ee, v23
v_mfma_f32_16x16x32_bf16 v[36:39], a[180:183], a[116:119], v[36:39]
v_exp_f32 v41, v41
v_mfma_f32_16x16x32_bf16 v[36:39], a[184:187], a[120:123], v[36:39]
v_fmamk_f32 v42, v42, 0x3e0293ee, v23
v_fmamk_f32 v43, v43, 0x3e0293ee, v23
v_mfma_f32_16x16x32_bf16 v[36:39], a[188:191], a[124:127], v[36:39]
v_exp_f32 v42, v42
v_mfma_f32_16x16x32_bf16 v[240:243], a[208:211], v[68:71], v[240:243]
v_exp_f32 v43, v43
v_mfma_f32_16x16x32_bf16 v[244:247], a[212:215], v[68:71], v[244:247]
ds_read_b128 a[168:171], v4 offset:57344
v_cvt_pk_bf16_f32 v74, v40, v41
v_mfma_f32_16x16x32_bf16 v[248:251], a[216:219], v[68:71], v[248:251]
ds_read_b128 a[172:175], v5 offset:57344
v_cvt_pk_bf16_f32 v75, v42, v43
v_mfma_f32_16x16x32_bf16 v[252:255], a[220:223], v[68:71], v[252:255]
v_fmamk_f32 v32, v32, 0x3e0293ee, v24
v_fmamk_f32 v33, v33, 0x3e0293ee, v24
v_mfma_f32_16x16x32_bf16 v[40:43], a[176:179], a[128:131], 0
v_exp_f32 v32, v32
v_mfma_f32_16x16x32_bf16 v[40:43], a[180:183], a[132:135], v[40:43]
v_exp_f32 v33, v33
v_mfma_f32_16x16x32_bf16 v[40:43], a[184:187], a[136:139], v[40:43]
v_fmamk_f32 v34, v34, 0x3e0293ee, v24
v_fmamk_f32 v35, v35, 0x3e0293ee, v24
v_mfma_f32_16x16x32_bf16 v[40:43], a[188:191], a[140:143], v[40:43]
s_waitcnt lgkmcnt(2)
v_exp_f32 v34, v34
v_mfma_f32_16x16x32_bf16 v[96:99], a[192:195], v[72:75], v[96:99]
v_exp_f32 v35, v35
v_mfma_f32_16x16x32_bf16 v[100:103], a[196:199], v[72:75], v[100:103]
v_cvt_pk_bf16_f32 v78, v32, v33
v_cvt_pk_bf16_f32 v79, v34, v35
v_mfma_f32_16x16x32_bf16 v[104:107], a[200:203], v[72:75], v[104:107]
v_fmamk_f32 v36, v36, 0x3e0293ee, v25
v_fmamk_f32 v37, v37, 0x3e0293ee, v25
v_mfma_f32_16x16x32_bf16 v[108:111], a[204:207], v[72:75], v[108:111]
v_exp_f32 v36, v36
v_mfma_f32_16x16x32_bf16 a[224:227], a[244:247], v[72:75], a[224:227]
v_exp_f32 v37, v37
v_mfma_f32_16x16x32_bf16 v[32:35], a[176:179], a[144:147], 0
v_fmamk_f32 v38, v38, 0x3e0293ee, v25
v_fmamk_f32 v39, v39, 0x3e0293ee, v25
v_mfma_f32_16x16x32_bf16 v[32:35], a[180:183], a[148:151], v[32:35]
v_exp_f32 v38, v38
v_mfma_f32_16x16x32_bf16 v[32:35], a[184:187], a[152:155], v[32:35]
v_exp_f32 v39, v39
v_mfma_f32_16x16x32_bf16 v[32:35], a[188:191], a[156:159], v[32:35]
v_cvt_pk_bf16_f32 v50, v36, v37
v_cvt_pk_bf16_f32 v51, v38, v39
v_mfma_f32_16x16x32_bf16 v[128:131], a[192:195], v[76:79], v[128:131]
v_fmamk_f32 v40, v40, 0x3e0293ee, v26
v_fmamk_f32 v41, v41, 0x3e0293ee, v26
v_mfma_f32_16x16x32_bf16 v[132:135], a[196:199], v[76:79], v[132:135]
v_exp_f32 v40, v40
v_mfma_f32_16x16x32_bf16 v[136:139], a[200:203], v[76:79], v[136:139]
v_exp_f32 v41, v41
v_mfma_f32_16x16x32_bf16 v[140:143], a[204:207], v[76:79], v[140:143]
v_fmamk_f32 v42, v42, 0x3e0293ee, v26
v_fmamk_f32 v43, v43, 0x3e0293ee, v26
v_mfma_f32_16x16x32_bf16 v[36:39], a[160:163], a[80:83], 0
v_exp_f32 v42, v42
v_mfma_f32_16x16x32_bf16 v[36:39], a[164:167], a[84:87], v[36:39]
s_waitcnt lgkmcnt(0)
v_exp_f32 v43, v43
v_mfma_f32_16x16x32_bf16 v[36:39], a[168:171], a[88:91], v[36:39]
v_cvt_pk_bf16_f32 v54, v40, v41
v_cvt_pk_bf16_f32 v55, v42, v43
v_mfma_f32_16x16x32_bf16 v[36:39], a[172:175], a[92:95], v[36:39]
ds_read_b64_tr_b16 a[208:209], v10 offset:49152
v_fmamk_f32 v32, v32, 0x3e0293ee, v27
v_mfma_f32_16x16x32_bf16 v[160:163], a[192:195], v[48:51], v[160:163]
ds_read_b64_tr_b16 a[210:211], v10 offset:53248
v_fmamk_f32 v33, v33, 0x3e0293ee, v27
v_mfma_f32_16x16x32_bf16 v[164:167], a[196:199], v[48:51], v[164:167]
ds_read_b64_tr_b16 a[212:213], v11 offset:49152
v_fmamk_f32 v34, v34, 0x3e0293ee, v27
v_mfma_f32_16x16x32_bf16 v[168:171], a[200:203], v[48:51], v[168:171]
ds_read_b64_tr_b16 a[214:215], v11 offset:53248
v_fmamk_f32 v35, v35, 0x3e0293ee, v27
v_mfma_f32_16x16x32_bf16 v[172:175], a[204:207], v[48:51], v[172:175]
buffer_store_dwordx4 a[36:39], v28, s[12:15], 0 offen offset:2048 sc0 sc1 nt
buffer_load_dwordx4 v16, s[24:27], s31 offen nt lds
buffer_load_dwordx4 v17, s[24:27], s31 offen offset:1024 nt lds
v_mfma_f32_16x16x32_bf16 a[228:231], a[244:247], v[76:79], a[228:231]
s_add_u32 m0, s32, 32768
v_exp_f32 v32, v32
v_mfma_f32_16x16x32_bf16 v[40:43], a[160:163], a[96:99], 0
s_add_u32 s31, s29, 98304
v_exp_f32 v33, v33
v_mfma_f32_16x16x32_bf16 v[40:43], a[164:167], a[100:103], v[40:43]
v_exp_f32 v34, v34
v_mfma_f32_16x16x32_bf16 v[40:43], a[168:171], a[104:107], v[40:43]
v_exp_f32 v35, v35
v_mfma_f32_16x16x32_bf16 v[40:43], a[172:175], a[108:111], v[40:43]
ds_read_b64_tr_b16 a[216:217], v12 offset:49152
v_cvt_pk_bf16_f32 v58, v32, v33
v_mfma_f32_16x16x32_bf16 v[192:195], a[192:195], v[52:55], v[192:195]
ds_read_b64_tr_b16 a[218:219], v12 offset:53248
v_cvt_pk_bf16_f32 v59, v34, v35
v_mfma_f32_16x16x32_bf16 v[196:199], a[196:199], v[52:55], v[196:199]
ds_read_b64_tr_b16 a[220:221], v13 offset:49152
v_fmamk_f32 v36, v36, 0x3e0293ee, v23
v_mfma_f32_16x16x32_bf16 v[200:203], a[200:203], v[52:55], v[200:203]
v_exp_f32 v36, v36
v_mfma_f32_16x16x32_bf16 v[204:207], a[204:207], v[52:55], v[204:207]
ds_read_b64_tr_b16 a[222:223], v13 offset:53248
v_fmamk_f32 v37, v37, 0x3e0293ee, v23
v_mfma_f32_16x16x32_bf16 v[32:35], a[160:163], a[112:115], 0
v_exp_f32 v37, v37
v_mfma_f32_16x16x32_bf16 v[32:35], a[164:167], a[116:119], v[32:35]
ds_read_b128 a[176:179], v2 offset:61440
v_fmamk_f32 v38, v38, 0x3e0293ee, v23
v_mfma_f32_16x16x32_bf16 v[32:35], a[168:171], a[120:123], v[32:35]
v_exp_f32 v38, v38
v_mfma_f32_16x16x32_bf16 v[32:35], a[172:175], a[124:127], v[32:35]
ds_read_b128 a[180:183], v3 offset:61440
v_fmamk_f32 v39, v39, 0x3e0293ee, v23
v_mfma_f32_16x16x32_bf16 v[224:227], a[192:195], v[56:59], v[224:227]
v_exp_f32 v39, v39
v_mfma_f32_16x16x32_bf16 v[228:231], a[196:199], v[56:59], v[228:231]
ds_read_b128 a[184:187], v4 offset:61440
v_cvt_pk_bf16_f32 v60, v36, v37
v_mfma_f32_16x16x32_bf16 v[232:235], a[200:203], v[56:59], v[232:235]
ds_read_b128 a[188:191], v5 offset:61440
v_cvt_pk_bf16_f32 v61, v38, v39
v_mfma_f32_16x16x32_bf16 v[236:239], a[204:207], v[56:59], v[236:239]
v_fmamk_f32 v40, v40, 0x3e0293ee, v24
v_fmamk_f32 v41, v41, 0x3e0293ee, v24
v_mfma_f32_16x16x32_bf16 a[232:235], a[244:247], v[48:51], a[232:235]
v_exp_f32 v40, v40
v_mfma_f32_16x16x32_bf16 v[36:39], a[160:163], a[128:131], 0
v_exp_f32 v41, v41
v_mfma_f32_16x16x32_bf16 v[36:39], a[164:167], a[132:135], v[36:39]
v_fmamk_f32 v42, v42, 0x3e0293ee, v24
v_fmamk_f32 v43, v43, 0x3e0293ee, v24
v_mfma_f32_16x16x32_bf16 v[36:39], a[168:171], a[136:139], v[36:39]
v_exp_f32 v42, v42
v_mfma_f32_16x16x32_bf16 v[36:39], a[172:175], a[140:143], v[36:39]
s_waitcnt lgkmcnt(2)
v_exp_f32 v43, v43
v_mfma_f32_16x16x32_bf16 v[112:115], a[208:211], v[72:75], v[112:115]
v_cvt_pk_bf16_f32 v64, v40, v41
v_cvt_pk_bf16_f32 v65, v42, v43
v_mfma_f32_16x16x32_bf16 v[116:119], a[212:215], v[72:75], v[116:119]
v_fmamk_f32 v32, v32, 0x3e0293ee, v25
v_fmamk_f32 v33, v33, 0x3e0293ee, v25
v_mfma_f32_16x16x32_bf16 v[120:123], a[216:219], v[72:75], v[120:123]
v_exp_f32 v32, v32
v_mfma_f32_16x16x32_bf16 v[124:127], a[220:223], v[72:75], v[124:127]
v_exp_f32 v33, v33
v_mfma_f32_16x16x32_bf16 v[40:43], a[160:163], a[144:147], 0
v_fmamk_f32 v34, v34, 0x3e0293ee, v25
v_fmamk_f32 v35, v35, 0x3e0293ee, v25
v_mfma_f32_16x16x32_bf16 v[40:43], a[164:167], a[148:151], v[40:43]
v_exp_f32 v34, v34
v_mfma_f32_16x16x32_bf16 v[40:43], a[168:171], a[152:155], v[40:43]
v_exp_f32 v35, v35
v_mfma_f32_16x16x32_bf16 v[40:43], a[172:175], a[156:159], v[40:43]
v_cvt_pk_bf16_f32 v68, v32, v33
v_cvt_pk_bf16_f32 v69, v34, v35
v_mfma_f32_16x16x32_bf16 v[144:147], a[208:211], v[76:79], v[144:147]
v_fmamk_f32 v36, v36, 0x3e0293ee, v26
v_fmamk_f32 v37, v37, 0x3e0293ee, v26
v_mfma_f32_16x16x32_bf16 v[148:151], a[212:215], v[76:79], v[148:151]
v_exp_f32 v36, v36
v_mfma_f32_16x16x32_bf16 v[152:155], a[216:219], v[76:79], v[152:155]
v_exp_f32 v37, v37
v_mfma_f32_16x16x32_bf16 v[156:159], a[220:223], v[76:79], v[156:159]
v_fmamk_f32 v38, v38, 0x3e0293ee, v26
v_fmamk_f32 v39, v39, 0x3e0293ee, v26
v_mfma_f32_16x16x32_bf16 a[236:239], a[244:247], v[52:55], a[236:239]
s_waitcnt vmcnt(8) lgkmcnt(0)
v_exp_f32 v38, v38
v_mfma_f32_16x16x32_bf16 v[32:35], a[176:179], a[80:83], 0
s_barrier
v_exp_f32 v39, v39
v_mfma_f32_16x16x32_bf16 v[32:35], a[180:183], a[84:87], v[32:35]
v_cvt_pk_bf16_f32 v72, v36, v37
v_cvt_pk_bf16_f32 v73, v38, v39
v_mfma_f32_16x16x32_bf16 v[32:35], a[184:187], a[88:91], v[32:35]
ds_read_b64_tr_b16 a[192:193], v6 offset:57344
v_fmamk_f32 v40, v40, 0x3e0293ee, v27
v_mfma_f32_16x16x32_bf16 v[32:35], a[188:191], a[92:95], v[32:35]
v_exp_f32 v40, v40
v_mfma_f32_16x16x32_bf16 v[176:179], a[208:211], v[48:51], v[176:179]
ds_read_b64_tr_b16 a[194:195], v6 offset:61440
v_fmamk_f32 v41, v41, 0x3e0293ee, v27
v_mfma_f32_16x16x32_bf16 v[180:183], a[212:215], v[48:51], v[180:183]
v_exp_f32 v41, v41
v_mfma_f32_16x16x32_bf16 v[184:187], a[216:219], v[48:51], v[184:187]
ds_read_b64_tr_b16 a[196:197], v7 offset:57344
v_fmamk_f32 v42, v42, 0x3e0293ee, v27
v_mfma_f32_16x16x32_bf16 v[188:191], a[220:223], v[48:51], v[188:191]
v_exp_f32 v42, v42
v_mfma_f32_16x16x32_bf16 v[36:39], a[176:179], a[96:99], 0
ds_read_b64_tr_b16 a[198:199], v7 offset:61440
v_fmamk_f32 v43, v43, 0x3e0293ee, v27
v_mfma_f32_16x16x32_bf16 v[36:39], a[180:183], a[100:103], v[36:39]
v_exp_f32 v43, v43
v_mfma_f32_16x16x32_bf16 v[36:39], a[184:187], a[104:107], v[36:39]
ds_read_b64_tr_b16 a[200:201], v8 offset:57344
v_cvt_pk_bf16_f32 v76, v40, v41
v_mfma_f32_16x16x32_bf16 v[36:39], a[188:191], a[108:111], v[36:39]
ds_read_b64_tr_b16 a[202:203], v8 offset:61440
v_cvt_pk_bf16_f32 v77, v42, v43
v_mfma_f32_16x16x32_bf16 v[208:211], a[208:211], v[52:55], v[208:211]
ds_read_b64_tr_b16 a[204:205], v9 offset:57344
v_add_u32 v28, s38, v19
v_mfma_f32_16x16x32_bf16 v[212:215], a[212:215], v[52:55], v[212:215]
s_add_u32 s38, s63, 12288
buffer_store_dwordx4 a[40:43], v28, s[12:15], 0 offen offset:0 sc0 sc1 nt
buffer_load_dwordx4 v14, s[20:23], s30 offen nt lds
buffer_load_dwordx4 v15, s[20:23], s30 offen offset:1024 nt lds
v_mfma_f32_16x16x32_bf16 v[216:219], a[216:219], v[52:55], v[216:219]
s_add_u32 m0, s32, 98304
ds_read_b64_tr_b16 a[206:207], v9 offset:61440
v_fmamk_f32 v32, v32, 0x3e0293ee, v23
v_mfma_f32_16x16x32_bf16 v[220:223], a[220:223], v[52:55], v[220:223]
s_add_u32 s38, s38, s76
v_exp_f32 v32, v32
v_mfma_f32_16x16x32_bf16 a[240:243], a[244:247], v[56:59], a[240:243]
s_add_u32 s30, s29, 106496
ds_read_b128 a[160:163], v2 offset:0
v_fmamk_f32 v33, v33, 0x3e0293ee, v23
v_mfma_f32_16x16x32_bf16 v[40:43], a[176:179], a[112:115], 0
v_exp_f32 v33, v33
v_mfma_f32_16x16x32_bf16 v[40:43], a[180:183], a[116:119], v[40:43]
ds_read_b128 a[164:167], v3 offset:0
v_fmamk_f32 v34, v34, 0x3e0293ee, v23
v_mfma_f32_16x16x32_bf16 v[40:43], a[184:187], a[120:123], v[40:43]
v_exp_f32 v34, v34
v_mfma_f32_16x16x32_bf16 v[40:43], a[188:191], a[124:127], v[40:43]
ds_read_b128 a[168:171], v4 offset:0
v_fmamk_f32 v35, v35, 0x3e0293ee, v23
v_mfma_f32_16x16x32_bf16 v[240:243], a[208:211], v[56:59], v[240:243]
v_exp_f32 v35, v35
v_mfma_f32_16x16x32_bf16 v[244:247], a[212:215], v[56:59], v[244:247]
v_cvt_pk_bf16_f32 v62, v32, v33
v_cvt_pk_bf16_f32 v63, v34, v35
v_mfma_f32_16x16x32_bf16 v[248:251], a[216:219], v[56:59], v[248:251]
ds_read_b128 a[172:175], v5 offset:0
v_fmamk_f32 v36, v36, 0x3e0293ee, v24
v_mfma_f32_16x16x32_bf16 v[252:255], a[220:223], v[56:59], v[252:255]
v_exp_f32 v36, v36
v_mfma_f32_16x16x32_bf16 v[32:35], a[176:179], a[128:131], 0
v_fmamk_f32 v37, v37, 0x3e0293ee, v24
v_fmamk_f32 v38, v38, 0x3e0293ee, v24
v_mfma_f32_16x16x32_bf16 v[32:35], a[180:183], a[132:135], v[32:35]
v_exp_f32 v37, v37
v_mfma_f32_16x16x32_bf16 v[32:35], a[184:187], a[136:139], v[32:35]
v_exp_f32 v38, v38
v_mfma_f32_16x16x32_bf16 v[32:35], a[188:191], a[140:143], v[32:35]
s_waitcnt lgkmcnt(1)
v_fmamk_f32 v39, v39, 0x3e0293ee, v24
v_cvt_pk_bf16_f32 v66, v36, v37
v_mfma_f32_16x16x32_bf16 v[96:99], a[192:195], v[60:63], v[96:99]
v_exp_f32 v39, v39
v_mfma_f32_16x16x32_bf16 v[100:103], a[196:199], v[60:63], v[100:103]
v_cvt_pk_bf16_f32 v67, v38, v39
v_fmamk_f32 v40, v40, 0x3e0293ee, v25
v_mfma_f32_16x16x32_bf16 v[104:107], a[200:203], v[60:63], v[104:107]
v_exp_f32 v40, v40
v_mfma_f32_16x16x32_bf16 v[108:111], a[204:207], v[60:63], v[108:111]
v_fmamk_f32 v41, v41, 0x3e0293ee, v25
v_fmamk_f32 v42, v42, 0x3e0293ee, v25
v_mfma_f32_16x16x32_bf16 a[224:227], a[244:247], v[60:63], a[224:227]
v_exp_f32 v41, v41
v_mfma_f32_16x16x32_bf16 v[36:39], a[176:179], a[144:147], 0
v_exp_f32 v42, v42
v_mfma_f32_16x16x32_bf16 v[36:39], a[180:183], a[148:151], v[36:39]
v_fmamk_f32 v43, v43, 0x3e0293ee, v25
v_cvt_pk_bf16_f32 v70, v40, v41
v_mfma_f32_16x16x32_bf16 v[36:39], a[184:187], a[152:155], v[36:39]
v_exp_f32 v43, v43
v_mfma_f32_16x16x32_bf16 v[36:39], a[188:191], a[156:159], v[36:39]
v_cvt_pk_bf16_f32 v71, v42, v43
v_fmamk_f32 v32, v32, 0x3e0293ee, v26
v_mfma_f32_16x16x32_bf16 v[128:131], a[192:195], v[64:67], v[128:131]
v_exp_f32 v32, v32
v_mfma_f32_16x16x32_bf16 v[132:135], a[196:199], v[64:67], v[132:135]
v_fmamk_f32 v33, v33, 0x3e0293ee, v26
v_fmamk_f32 v34, v34, 0x3e0293ee, v26
v_mfma_f32_16x16x32_bf16 v[136:139], a[200:203], v[64:67], v[136:139]
v_exp_f32 v33, v33
v_mfma_f32_16x16x32_bf16 v[140:143], a[204:207], v[64:67], v[140:143]
v_exp_f32 v34, v34
v_mfma_f32_16x16x32_bf16 v[40:43], a[160:163], a[80:83], 0
v_fmamk_f32 v35, v35, 0x3e0293ee, v26
v_cvt_pk_bf16_f32 v74, v32, v33
v_mfma_f32_16x16x32_bf16 v[40:43], a[164:167], a[84:87], v[40:43]
v_exp_f32 v35, v35
v_mfma_f32_16x16x32_bf16 v[40:43], a[168:171], a[88:91], v[40:43]
s_waitcnt lgkmcnt(0)
ds_read_b64_tr_b16 a[208:209], v10 offset:57344
v_cvt_pk_bf16_f32 v75, v34, v35
v_mfma_f32_16x16x32_bf16 v[40:43], a[172:175], a[92:95], v[40:43]
ds_read_b64_tr_b16 a[210:211], v10 offset:61440
v_fmamk_f32 v36, v36, 0x3e0293ee, v27
v_mfma_f32_16x16x32_bf16 v[160:163], a[192:195], v[68:71], v[160:163]
ds_read_b64_tr_b16 a[212:213], v11 offset:57344
v_fmamk_f32 v37, v37, 0x3e0293ee, v27
v_mfma_f32_16x16x32_bf16 v[164:167], a[196:199], v[68:71], v[164:167]
ds_read_b64_tr_b16 a[214:215], v11 offset:61440
v_fmamk_f32 v38, v38, 0x3e0293ee, v27
v_mfma_f32_16x16x32_bf16 v[168:171], a[200:203], v[68:71], v[168:171]
ds_read_b64_tr_b16 a[216:217], v12 offset:57344
v_fmamk_f32 v39, v39, 0x3e0293ee, v27
v_mfma_f32_16x16x32_bf16 v[172:175], a[204:207], v[68:71], v[172:175]
buffer_store_dwordx4 a[44:47], v28, s[12:15], 0 offen offset:2048 sc0 sc1 nt
buffer_load_dwordx4 v16, s[24:27], s31 offen nt lds
buffer_load_dwordx4 v17, s[24:27], s31 offen offset:1024 nt lds
v_mfma_f32_16x16x32_bf16 a[228:231], a[244:247], v[64:67], a[228:231]
s_add_u32 m0, s32, 40960
v_exp_f32 v36, v36
v_mfma_f32_16x16x32_bf16 v[32:35], a[160:163], a[96:99], 0
s_add_u32 s31, s29, 106496
v_exp_f32 v37, v37
v_mfma_f32_16x16x32_bf16 v[32:35], a[164:167], a[100:103], v[32:35]
v_exp_f32 v38, v38
v_mfma_f32_16x16x32_bf16 v[32:35], a[168:171], a[104:107], v[32:35]
v_exp_f32 v39, v39
v_mfma_f32_16x16x32_bf16 v[32:35], a[172:175], a[108:111], v[32:35]
ds_read_b64_tr_b16 a[218:219], v12 offset:61440
v_cvt_pk_bf16_f32 v78, v36, v37
v_mfma_f32_16x16x32_bf16 v[192:195], a[192:195], v[72:75], v[192:195]
ds_read_b64_tr_b16 a[220:221], v13 offset:57344
v_cvt_pk_bf16_f32 v79, v38, v39
v_mfma_f32_16x16x32_bf16 v[196:199], a[196:199], v[72:75], v[196:199]
ds_read_b64_tr_b16 a[222:223], v13 offset:61440
v_fmamk_f32 v40, v40, 0x3e0293ee, v23
v_mfma_f32_16x16x32_bf16 v[200:203], a[200:203], v[72:75], v[200:203]
v_exp_f32 v40, v40
v_mfma_f32_16x16x32_bf16 v[204:207], a[204:207], v[72:75], v[204:207]
ds_read_b128 a[176:179], v2 offset:4096
v_fmamk_f32 v41, v41, 0x3e0293ee, v23
v_mfma_f32_16x16x32_bf16 v[36:39], a[160:163], a[112:115], 0
v_exp_f32 v41, v41
v_mfma_f32_16x16x32_bf16 v[36:39], a[164:167], a[116:119], v[36:39]
ds_read_b128 a[180:183], v3 offset:4096
v_fmamk_f32 v42, v42, 0x3e0293ee, v23
v_mfma_f32_16x16x32_bf16 v[36:39], a[168:171], a[120:123], v[36:39]
v_exp_f32 v42, v42
v_mfma_f32_16x16x32_bf16 v[36:39], a[172:175], a[124:127], v[36:39]
ds_read_b128 a[184:187], v4 offset:4096
v_fmamk_f32 v43, v43, 0x3e0293ee, v23
v_mfma_f32_16x16x32_bf16 v[224:227], a[192:195], v[76:79], v[224:227]
v_exp_f32 v43, v43
v_mfma_f32_16x16x32_bf16 v[228:231], a[196:199], v[76:79], v[228:231]
v_cvt_pk_bf16_f32 v48, v40, v41
v_cvt_pk_bf16_f32 v49, v42, v43
v_mfma_f32_16x16x32_bf16 v[232:235], a[200:203], v[76:79], v[232:235]
ds_read_b128 a[188:191], v5 offset:4096
v_fmamk_f32 v32, v32, 0x3e0293ee, v24
v_mfma_f32_16x16x32_bf16 v[236:239], a[204:207], v[76:79], v[236:239]
v_exp_f32 v32, v32
v_mfma_f32_16x16x32_bf16 a[232:235], a[244:247], v[68:71], a[232:235]
v_fmamk_f32 v33, v33, 0x3e0293ee, v24
v_fmamk_f32 v34, v34, 0x3e0293ee, v24
v_mfma_f32_16x16x32_bf16 v[40:43], a[160:163], a[128:131], 0
v_exp_f32 v33, v33
v_mfma_f32_16x16x32_bf16 v[40:43], a[164:167], a[132:135], v[40:43]
v_exp_f32 v34, v34
v_mfma_f32_16x16x32_bf16 v[40:43], a[168:171], a[136:139], v[40:43]
v_fmamk_f32 v35, v35, 0x3e0293ee, v24
v_cvt_pk_bf16_f32 v52, v32, v33
v_mfma_f32_16x16x32_bf16 v[40:43], a[172:175], a[140:143], v[40:43]
s_waitcnt lgkmcnt(1)
v_exp_f32 v35, v35
v_mfma_f32_16x16x32_bf16 v[112:115], a[208:211], v[60:63], v[112:115]
v_cvt_pk_bf16_f32 v53, v34, v35
v_fmamk_f32 v36, v36, 0x3e0293ee, v25
v_mfma_f32_16x16x32_bf16 v[116:119], a[212:215], v[60:63], v[116:119]
v_exp_f32 v36, v36
v_mfma_f32_16x16x32_bf16 v[120:123], a[216:219], v[60:63], v[120:123]
v_fmamk_f32 v37, v37, 0x3e0293ee, v25
v_fmamk_f32 v38, v38, 0x3e0293ee, v25
v_mfma_f32_16x16x32_bf16 v[124:127], a[220:223], v[60:63], v[124:127]
v_exp_f32 v37, v37
v_mfma_f32_16x16x32_bf16 v[32:35], a[160:163], a[144:147], 0
v_exp_f32 v38, v38
v_mfma_f32_16x16x32_bf16 v[32:35], a[164:167], a[148:151], v[32:35]
v_fmamk_f32 v39, v39, 0x3e0293ee, v25
v_cvt_pk_bf16_f32 v56, v36, v37
v_mfma_f32_16x16x32_bf16 v[32:35], a[168:171], a[152:155], v[32:35]
v_exp_f32 v39, v39
v_mfma_f32_16x16x32_bf16 v[32:35], a[172:175], a[156:159], v[32:35]
v_cvt_pk_bf16_f32 v57, v38, v39
v_fmamk_f32 v40, v40, 0x3e0293ee, v26
v_mfma_f32_16x16x32_bf16 v[144:147], a[208:211], v[64:67], v[144:147]
v_exp_f32 v40, v40
v_mfma_f32_16x16x32_bf16 v[148:151], a[212:215], v[64:67], v[148:151]
v_fmamk_f32 v41, v41, 0x3e0293ee, v26
v_fmamk_f32 v42, v42, 0x3e0293ee, v26
v_mfma_f32_16x16x32_bf16 v[152:155], a[216:219], v[64:67], v[152:155]
v_exp_f32 v41, v41
v_mfma_f32_16x16x32_bf16 v[156:159], a[220:223], v[64:67], v[156:159]
v_exp_f32 v42, v42
v_mfma_f32_16x16x32_bf16 a[236:239], a[244:247], v[72:75], a[236:239]
v_fmamk_f32 v43, v43, 0x3e0293ee, v26
v_cvt_pk_bf16_f32 v60, v40, v41
v_mfma_f32_16x16x32_bf16 v[36:39], a[176:179], a[80:83], 0
v_exp_f32 v43, v43
v_mfma_f32_16x16x32_bf16 v[36:39], a[180:183], a[84:87], v[36:39]
ds_read_b64_tr_b16 a[192:193], v6 offset:0
v_cvt_pk_bf16_f32 v61, v42, v43
v_mfma_f32_16x16x32_bf16 v[36:39], a[184:187], a[88:91], v[36:39]
s_waitcnt lgkmcnt(1)
ds_read_b64_tr_b16 a[194:195], v6 offset:4096
v_fmamk_f32 v32, v32, 0x3e0293ee, v27
v_mfma_f32_16x16x32_bf16 v[36:39], a[188:191], a[92:95], v[36:39]
v_exp_f32 v32, v32
v_mfma_f32_16x16x32_bf16 v[176:179], a[208:211], v[68:71], v[176:179]
ds_read_b64_tr_b16 a[196:197], v7 offset:0
v_fmamk_f32 v33, v33, 0x3e0293ee, v27
v_mfma_f32_16x16x32_bf16 v[180:183], a[212:215], v[68:71], v[180:183]
v_exp_f32 v33, v33
v_mfma_f32_16x16x32_bf16 v[184:187], a[216:219], v[68:71], v[184:187]
ds_read_b64_tr_b16 a[198:199], v7 offset:4096
v_fmamk_f32 v34, v34, 0x3e0293ee, v27
v_mfma_f32_16x16x32_bf16 v[188:191], a[220:223], v[68:71], v[188:191]
v_exp_f32 v34, v34
v_mfma_f32_16x16x32_bf16 v[40:43], a[176:179], a[96:99], 0
ds_read_b64_tr_b16 a[200:201], v8 offset:0
v_fmamk_f32 v35, v35, 0x3e0293ee, v27
v_mfma_f32_16x16x32_bf16 v[40:43], a[180:183], a[100:103], v[40:43]
v_exp_f32 v35, v35
v_mfma_f32_16x16x32_bf16 v[40:43], a[184:187], a[104:107], v[40:43]
ds_read_b64_tr_b16 a[202:203], v8 offset:4096
v_cvt_pk_bf16_f32 v64, v32, v33
v_mfma_f32_16x16x32_bf16 v[40:43], a[188:191], a[108:111], v[40:43]
ds_read_b64_tr_b16 a[204:205], v9 offset:0
v_cvt_pk_bf16_f32 v65, v34, v35
v_mfma_f32_16x16x32_bf16 v[208:211], a[208:211], v[72:75], v[208:211]
ds_read_b64_tr_b16 a[206:207], v9 offset:4096
v_add_u32 v28, s38, v19
v_mfma_f32_16x16x32_bf16 v[212:215], a[212:215], v[72:75], v[212:215]
s_add_u32 s38, s63, 12288
buffer_store_dwordx4 a[48:51], v28, s[12:15], 0 offen offset:0 sc0 sc1 nt
buffer_load_dwordx4 v14, s[20:23], s30 offen nt lds
buffer_load_dwordx4 v15, s[20:23], s30 offen offset:1024 nt lds
v_mfma_f32_16x16x32_bf16 v[216:219], a[216:219], v[72:75], v[216:219]
s_add_u32 m0, s32, 106496
ds_read_b128 a[160:163], v2 offset:8192
v_fmamk_f32 v36, v36, 0x3e0293ee, v23
v_mfma_f32_16x16x32_bf16 v[220:223], a[220:223], v[72:75], v[220:223]
s_add_u32 s38, s38, s75
v_exp_f32 v36, v36
v_mfma_f32_16x16x32_bf16 a[240:243], a[244:247], v[76:79], a[240:243]
s_add_u32 s30, s29, 114688
ds_read_b128 a[164:167], v3 offset:8192
v_fmamk_f32 v37, v37, 0x3e0293ee, v23
v_mfma_f32_16x16x32_bf16 v[32:35], a[176:179], a[112:115], 0
v_exp_f32 v37, v37
v_mfma_f32_16x16x32_bf16 v[32:35], a[180:183], a[116:119], v[32:35]
v_fmamk_f32 v38, v38, 0x3e0293ee, v23
v_fmamk_f32 v39, v39, 0x3e0293ee, v23
v_mfma_f32_16x16x32_bf16 v[32:35], a[184:187], a[120:123], v[32:35]
L_pad1_10:
s_cbranch_execz L_back
v_exp_f32 v38, v38
v_mfma_f32_16x16x32_bf16 v[32:35], a[188:191], a[124:127], v[32:35]
v_exp_f32 v39, v39
v_mfma_f32_16x16x32_bf16 v[240:243], a[208:211], v[76:79], v[240:243]
ds_read_b128 a[168:171], v4 offset:8192
v_cvt_pk_bf16_f32 v50, v36, v37
v_mfma_f32_16x16x32_bf16 v[244:247], a[212:215], v[76:79], v[244:247]
ds_read_b128 a[172:175], v5 offset:8192
v_cvt_pk_bf16_f32 v51, v38, v39
v_mfma_f32_16x16x32_bf16 v[248:251], a[216:219], v[76:79], v[248:251]
v_fmamk_f32 v40, v40, 0x3e0293ee, v24
v_fmamk_f32 v41, v41, 0x3e0293ee, v24
v_mfma_f32_16x16x32_bf16 v[252:255], a[220:223], v[76:79], v[252:255]
v_exp_f32 v40, v40
v_mfma_f32_16x16x32_bf16 v[36:39], a[176:179], a[128:131], 0
v_exp_f32 v41, v41
v_mfma_f32_16x16x32_bf16 v[36:39], a[180:183], a[132:135], v[36:39]
v_fmamk_f32 v42, v42, 0x3e0293ee, v24
v_fmamk_f32 v43, v43, 0x3e0293ee, v24
v_mfma_f32_16x16x32_bf16 v[36:39], a[184:187], a[136:139], v[36:39]
v_exp_f32 v42, v42
v_mfma_f32_16x16x32_bf16 v[36:39], a[188:191], a[140:143], v[36:39]
s_waitcnt lgkmcnt(2)
v_exp_f32 v43, v43
v_mfma_f32_16x16x32_bf16 v[96:99], a[192:195], v[48:51], v[96:99]
v_cvt_pk_bf16_f32 v54, v40, v41
v_cvt_pk_bf16_f32 v55, v42, v43
v_mfma_f32_16x16x32_bf16 v[100:103], a[196:199], v[48:51], v[100:103]
v_fmamk_f32 v32, v32, 0x3e0293ee, v25
v_fmamk_f32 v33, v33, 0x3e0293ee, v25
v_mfma_f32_16x16x32_bf16 v[104:107], a[200:203], v[48:51], v[104:107]
v_exp_f32 v32, v32
v_mfma_f32_16x16x32_bf16 v[108:111], a[204:207], v[48:51], v[108:111]
v_exp_f32 v33, v33
v_mfma_f32_16x16x32_bf16 a[224:227], a[244:247], v[48:51], a[224:227]
v_fmamk_f32 v34, v34, 0x3e0293ee, v25
v_fmamk_f32 v35, v35, 0x3e0293ee, v25
v_mfma_f32_16x16x32_bf16 v[40:43], a[176:179], a[144:147], 0
v_exp_f32 v34, v34
v_mfma_f32_16x16x32_bf16 v[40:43], a[180:183], a[148:151], v[40:43]
v_exp_f32 v35, v35
v_mfma_f32_16x16x32_bf16 v[40:43], a[184:187], a[152:155], v[40:43]
v_cvt_pk_bf16_f32 v58, v32, v33
v_cvt_pk_bf16_f32 v59, v34, v35
v_mfma_f32_16x16x32_bf16 v[40:43], a[188:191], a[156:159], v[40:43]
v_fmamk_f32 v36, v36, 0x3e0293ee, v26
v_fmamk_f32 v37, v37, 0x3e0293ee, v26
v_mfma_f32_16x16x32_bf16 v[128:131], a[192:195], v[52:55], v[128:131]
v_exp_f32 v36, v36
v_mfma_f32_16x16x32_bf16 v[132:135], a[196:199], v[52:55], v[132:135]
v_exp_f32 v37, v37
v_mfma_f32_16x16x32_bf16 v[136:139], a[200:203], v[52:55], v[136:139]
v_fmamk_f32 v38, v38, 0x3e0293ee, v26
v_fmamk_f32 v39, v39, 0x3e0293ee, v26
v_mfma_f32_16x16x32_bf16 v[140:143], a[204:207], v[52:55], v[140:143]
v_exp_f32 v38, v38
v_mfma_f32_16x16x32_bf16 v[32:35], a[160:163], a[80:83], 0
v_exp_f32 v39, v39
v_mfma_f32_16x16x32_bf16 v[32:35], a[164:167], a[84:87], v[32:35]
s_waitcnt lgkmcnt(0)
v_cvt_pk_bf16_f32 v62, v36, v37
v_cvt_pk_bf16_f32 v63, v38, v39
v_mfma_f32_16x16x32_bf16 v[32:35], a[168:171], a[88:91], v[32:35]
ds_read_b64_tr_b16 a[208:209], v10 offset:0
v_fmamk_f32 v40, v40, 0x3e0293ee, v27
v_mfma_f32_16x16x32_bf16 v[32:35], a[172:175], a[92:95], v[32:35]
v_exp_f32 v40, v40
v_mfma_f32_16x16x32_bf16 v[160:163], a[192:195], v[56:59], v[160:163]
ds_read_b64_tr_b16 a[210:211], v10 offset:4096
v_fmamk_f32 v41, v41, 0x3e0293ee, v27
v_mfma_f32_16x16x32_bf16 v[164:167], a[196:199], v[56:59], v[164:167]
ds_read_b64_tr_b16 a[212:213], v11 offset:0
v_fmamk_f32 v42, v42, 0x3e0293ee, v27
v_mfma_f32_16x16x32_bf16 v[168:171], a[200:203], v[56:59], v[168:171]
ds_read_b64_tr_b16 a[214:215], v11 offset:4096
v_fmamk_f32 v43, v43, 0x3e0293ee, v27
v_mfma_f32_16x16x32_bf16 v[172:175], a[204:207], v[56:59], v[172:175]
buffer_store_dwordx4 a[52:55], v28, s[12:15], 0 offen offset:2048 sc0 sc1 nt
buffer_load_dwordx4 v16, s[24:27], s31 offen nt lds
buffer_load_dwordx4 v17, s[24:27], s31 offen offset:1024 nt lds
v_mfma_f32_16x16x32_bf16 a[228:231], a[244:247], v[52:55], a[228:231]
s_add_u32 m0, s32, 49152
v_exp_f32 v41, v41
v_mfma_f32_16x16x32_bf16 v[36:39], a[160:163], a[96:99], 0
s_add_u32 s31, s29, 114688
v_exp_f32 v42, v42
v_mfma_f32_16x16x32_bf16 v[36:39], a[164:167], a[100:103], v[36:39]
v_exp_f32 v43, v43
v_mfma_f32_16x16x32_bf16 v[36:39], a[168:171], a[104:107], v[36:39]
ds_read_b64_tr_b16 a[216:217], v12 offset:0
v_cvt_pk_bf16_f32 v66, v40, v41
v_mfma_f32_16x16x32_bf16 v[36:39], a[172:175], a[108:111], v[36:39]
ds_read_b64_tr_b16 a[218:219], v12 offset:4096
v_cvt_pk_bf16_f32 v67, v42, v43
v_mfma_f32_16x16x32_bf16 v[192:195], a[192:195], v[60:63], v[192:195]
ds_read_b64_tr_b16 a[220:221], v13 offset:0
v_fmamk_f32 v32, v32, 0x3e0293ee, v23
v_mfma_f32_16x16x32_bf16 v[196:199], a[196:199], v[60:63], v[196:199]
v_exp_f32 v32, v32
v_mfma_f32_16x16x32_bf16 v[200:203], a[200:203], v[60:63], v[200:203]
ds_read_b64_tr_b16 a[222:223], v13 offset:4096
v_fmamk_f32 v33, v33, 0x3e0293ee, v23
v_mfma_f32_16x16x32_bf16 v[204:207], a[204:207], v[60:63], v[204:207]
v_exp_f32 v33, v33
v_mfma_f32_16x16x32_bf16 v[40:43], a[160:163], a[112:115], 0
ds_read_b128 a[176:179], v2 offset:12288
v_fmamk_f32 v34, v34, 0x3e0293ee, v23
v_mfma_f32_16x16x32_bf16 v[40:43], a[164:167], a[116:119], v[40:43]
v_exp_f32 v34, v34
v_mfma_f32_16x16x32_bf16 v[40:43], a[168:171], a[120:123], v[40:43]
ds_read_b128 a[180:183], v3 offset:12288
v_fmamk_f32 v35, v35, 0x3e0293ee, v23
v_mfma_f32_16x16x32_bf16 v[40:43], a[172:175], a[124:127], v[40:43]
v_exp_f32 v35, v35
v_mfma_f32_16x16x32_bf16 v[224:227], a[192:195], v[64:67], v[224:227]
ds_read_b128 a[184:187], v4 offset:12288
v_cvt_pk_bf16_f32 v68, v32, v33
v_mfma_f32_16x16x32_bf16 v[228:231], a[196:199], v[64:67], v[228:231]
ds_read_b128 a[188:191], v5 offset:12288
v_cvt_pk_bf16_f32 v69, v34, v35
v_mfma_f32_16x16x32_bf16 v[232:235], a[200:203], v[64:67], v[232:235]
v_fmamk_f32 v36, v36, 0x3e0293ee, v24
v_fmamk_f32 v37, v37, 0x3e0293ee, v24
v_mfma_f32_16x16x32_bf16 v[236:239], a[204:207], v[64:67], v[236:239]
v_exp_f32 v36, v36
v_mfma_f32_16x16x32_bf16 a[232:235], a[244:247], v[56:59], a[232:235]
v_exp_f32 v37, v37
v_mfma_f32_16x16x32_bf16 v[32:35], a[160:163], a[128:131], 0
v_fmamk_f32 v38, v38, 0x3e0293ee, v24
v_fmamk_f32 v39, v39, 0x3e0293ee, v24
v_mfma_f32_16x16x32_bf16 v[32:35], a[164:167], a[132:135], v[32:35]
v_exp_f32 v38, v38
v_mfma_f32_16x16x32_bf16 v[32:35], a[168:171], a[136:139], v[32:35]
v_exp_f32 v39, v39
v_mfma_f32_16x16x32_bf16 v[32:35], a[172:175], a[140:143], v[32:35]
s_waitcnt lgkmcnt(1)
v_cvt_pk_bf16_f32 v72, v36, v37
v_cvt_pk_bf16_f32 v73, v38, v39
v_mfma_f32_16x16x32_bf16 v[112:115], a[208:211], v[48:51], v[112:115]
v_fmamk_f32 v40, v40, 0x3e0293ee, v25
v_fmamk_f32 v41, v41, 0x3e0293ee, v25
v_mfma_f32_16x16x32_bf16 v[116:119], a[212:215], v[48:51], v[116:119]
v_exp_f32 v40, v40
v_mfma_f32_16x16x32_bf16 v[120:123], a[216:219], v[48:51], v[120:123]
v_exp_f32 v41, v41
v_mfma_f32_16x16x32_bf16 v[124:127], a[220:223], v[48:51], v[124:127]
v_fmamk_f32 v42, v42, 0x3e0293ee, v25
v_fmamk_f32 v43, v43, 0x3e0293ee, v25
v_mfma_f32_16x16x32_bf16 v[36:39], a[160:163], a[144:147], 0
v_exp_f32 v42, v42
v_mfma_f32_16x16x32_bf16 v[36:39], a[164:167], a[148:151], v[36:39]
v_exp_f32 v43, v43
v_mfma_f32_16x16x32_bf16 v[36:39], a[168:171], a[152:155], v[36:39]
v_cvt_pk_bf16_f32 v76, v40, v41
v_cvt_pk_bf16_f32 v77, v42, v43
v_mfma_f32_16x16x32_bf16 v[36:39], a[172:175], a[156:159], v[36:39]
v_fmamk_f32 v32, v32, 0x3e0293ee, v26
v_fmamk_f32 v33, v33, 0x3e0293ee, v26
v_mfma_f32_16x16x32_bf16 v[144:147], a[208:211], v[52:55], v[144:147]
v_exp_f32 v32, v32
v_mfma_f32_16x16x32_bf16 v[148:151], a[212:215], v[52:55], v[148:151]
v_exp_f32 v33, v33
v_mfma_f32_16x16x32_bf16 v[152:155], a[216:219], v[52:55], v[152:155]
v_fmamk_f32 v34, v34, 0x3e0293ee, v26
v_fmamk_f32 v35, v35, 0x3e0293ee, v26
v_mfma_f32_16x16x32_bf16 v[156:159], a[220:223], v[52:55], v[156:159]
v_exp_f32 v34, v34
v_mfma_f32_16x16x32_bf16 a[236:239], a[244:247], v[60:63], a[236:239]
s_waitcnt vmcnt(8) lgkmcnt(0)
v_exp_f32 v35, v35
v_mfma_f32_16x16x32_bf16 v[40:43], a[176:179], a[80:83], 0
s_barrier
v_cvt_pk_bf16_f32 v48, v32, v33
v_cvt_pk_bf16_f32 v49, v34, v35
v_mfma_f32_16x16x32_bf16 v[40:43], a[180:183], a[84:87], v[40:43]
ds_read_b64_tr_b16 a[192:193], v6 offset:8192
v_fmamk_f32 v36, v36, 0x3e0293ee, v27
v_mfma_f32_16x16x32_bf16 v[40:43], a[184:187], a[88:91], v[40:43]
v_exp_f32 v36, v36
v_mfma_f32_16x16x32_bf16 v[40:43], a[188:191], a[92:95], v[40:43]
ds_read_b64_tr_b16 a[194:195], v6 offset:12288
v_fmamk_f32 v37, v37, 0x3e0293ee, v27
v_mfma_f32_16x16x32_bf16 v[176:179], a[208:211], v[56:59], v[176:179]
v_exp_f32 v37, v37
v_mfma_f32_16x16x32_bf16 v[180:183], a[212:215], v[56:59], v[180:183]
ds_read_b64_tr_b16 a[196:197], v7 offset:8192
v_fmamk_f32 v38, v38, 0x3e0293ee, v27
v_mfma_f32_16x16x32_bf16 v[184:187], a[216:219], v[56:59], v[184:187]
v_exp_f32 v38, v38
v_mfma_f32_16x16x32_bf16 v[188:191], a[220:223], v[56:59], v[188:191]
ds_read_b64_tr_b16 a[198:199], v7 offset:12288
v_fmamk_f32 v39, v39, 0x3e0293ee, v27
v_mfma_f32_16x16x32_bf16 v[32:35], a[176:179], a[96:99], 0
v_exp_f32 v39, v39
v_mfma_f32_16x16x32_bf16 v[32:35], a[180:183], a[100:103], v[32:35]
ds_read_b64_tr_b16 a[200:201], v8 offset:8192
v_cvt_pk_bf16_f32 v52, v36, v37
v_mfma_f32_16x16x32_bf16 v[32:35], a[184:187], a[104:107], v[32:35]
ds_read_b64_tr_b16 a[202:203], v8 offset:12288
v_cvt_pk_bf16_f32 v53, v38, v39
v_mfma_f32_16x16x32_bf16 v[32:35], a[188:191], a[108:111], v[32:35]
ds_read_b64_tr_b16 a[204:205], v9 offset:8192
v_add_u32 v28, s38, v19
v_mfma_f32_16x16x32_bf16 v[208:211], a[208:211], v[60:63], v[208:211]
s_mov_b32 s38, s72
buffer_store_dwordx4 a[56:59], v28, s[12:15], 0 offen offset:0 sc0 sc1 nt
buffer_load_dwordx4 v14, s[20:23], s30 offen nt lds
buffer_load_dwordx4 v15, s[20:23], s30 offen offset:1024 nt lds
v_mfma_f32_16x16x32_bf16 v[212:215], a[212:215], v[60:63], v[212:215]
s_add_u32 m0, s32, 114688
ds_read_b64_tr_b16 a[206:207], v9 offset:12288
v_fmamk_f32 v40, v40, 0x3e0293ee, v23
v_mfma_f32_16x16x32_bf16 v[216:219], a[216:219], v[60:63], v[216:219]
s_add_u32 s38, s38, s76
v_exp_f32 v40, v40
v_mfma_f32_16x16x32_bf16 v[220:223], a[220:223], v[60:63], v[220:223]
s_add_u32 s30, s29, 122880
ds_read_b128 a[160:163], v2 offset:16384
v_fmamk_f32 v41, v41, 0x3e0293ee, v23
v_mfma_f32_16x16x32_bf16 a[240:243], a[244:247], v[64:67], a[240:243]
v_exp_f32 v41, v41
v_mfma_f32_16x16x32_bf16 v[36:39], a[176:179], a[112:115], 0
ds_read_b128 a[164:167], v3 offset:16384
v_fmamk_f32 v42, v42, 0x3e0293ee, v23
v_mfma_f32_16x16x32_bf16 v[36:39], a[180:183], a[116:119], v[36:39]
v_exp_f32 v42, v42
v_mfma_f32_16x16x32_bf16 v[36:39], a[184:187], a[120:123], v[36:39]
ds_read_b128 a[168:171], v4 offset:16384
v_fmamk_f32 v43, v43, 0x3e0293ee, v23
v_mfma_f32_16x16x32_bf16 v[36:39], a[188:191], a[124:127], v[36:39]
v_exp_f32 v43, v43
v_mfma_f32_16x16x32_bf16 v[240:243], a[208:211], v[64:67], v[240:243]
v_cvt_pk_bf16_f32 v70, v40, v41
v_cvt_pk_bf16_f32 v71, v42, v43
v_mfma_f32_16x16x32_bf16 v[244:247], a[212:215], v[64:67], v[244:247]
ds_read_b128 a[172:175], v5 offset:16384
v_fmamk_f32 v32, v32, 0x3e0293ee, v24
v_mfma_f32_16x16x32_bf16 v[248:251], a[216:219], v[64:67], v[248:251]
v_exp_f32 v32, v32
v_mfma_f32_16x16x32_bf16 v[252:255], a[220:223], v[64:67], v[252:255]
v_fmamk_f32 v33, v33, 0x3e0293ee, v24
v_fmamk_f32 v34, v34, 0x3e0293ee, v24
v_mfma_f32_16x16x32_bf16 v[40:43], a[176:179], a[128:131], 0
v_exp_f32 v33, v33
v_mfma_f32_16x16x32_bf16 v[40:43], a[180:183], a[132:135], v[40:43]
v_exp_f32 v34, v34
v_mfma_f32_16x16x32_bf16 v[40:43], a[184:187], a[136:139], v[40:43]
v_fmamk_f32 v35, v35, 0x3e0293ee, v24
v_cvt_pk_bf16_f32 v74, v32, v33
v_mfma_f32_16x16x32_bf16 v[40:43], a[188:191], a[140:143], v[40:43]
s_waitcnt lgkmcnt(1)
v_exp_f32 v35, v35
v_mfma_f32_16x16x32_bf16 v[96:99], a[192:195], v[68:71], v[96:99]
v_cvt_pk_bf16_f32 v75, v34, v35
v_fmamk_f32 v36, v36, 0x3e0293ee, v25
v_mfma_f32_16x16x32_bf16 v[100:103], a[196:199], v[68:71], v[100:103]
v_exp_f32 v36, v36
v_mfma_f32_16x16x32_bf16 v[104:107], a[200:203], v[68:71], v[104:107]
v_fmamk_f32 v37, v37, 0x3e0293ee, v25
v_fmamk_f32 v38, v38, 0x3e0293ee, v25
v_mfma_f32_16x16x32_bf16 v[108:111], a[204:207], v[68:71], v[108:111]
v_exp_f32 v37, v37
v_mfma_f32_16x16x32_bf16 a[224:227], a[244:247], v[68:71], a[224:227]
v_exp_f32 v38, v38
v_mfma_f32_16x16x32_bf16 v[32:35], a[176:179], a[144:147], 0
v_fmamk_f32 v39, v39, 0x3e0293ee, v25
v_cvt_pk_bf16_f32 v78, v36, v37
v_mfma_f32_16x16x32_bf16 v[32:35], a[180:183], a[148:151], v[32:35]
v_exp_f32 v39, v39
v_mfma_f32_16x16x32_bf16 v[32:35], a[184:187], a[152:155], v[32:35]
v_cvt_pk_bf16_f32 v79, v38, v39
v_fmamk_f32 v40, v40, 0x3e0293ee, v26
v_mfma_f32_16x16x32_bf16 v[32:35], a[188:191], a[156:159], v[32:35]
v_exp_f32 v40, v40
v_mfma_f32_16x16x32_bf16 v[128:131], a[192:195], v[72:75], v[128:131]
v_fmamk_f32 v41, v41, 0x3e0293ee, v26
v_fmamk_f32 v42, v42, 0x3e0293ee, v26
v_mfma_f32_16x16x32_bf16 v[132:135], a[196:199], v[72:75], v[132:135]
v_exp_f32 v41, v41
v_mfma_f32_16x16x32_bf16 v[136:139], a[200:203], v[72:75], v[136:139]
v_exp_f32 v42, v42
v_mfma_f32_16x16x32_bf16 v[140:143], a[204:207], v[72:75], v[140:143]
v_fmamk_f32 v43, v43, 0x3e0293ee, v26
v_cvt_pk_bf16_f32 v50, v40, v41
v_mfma_f32_16x16x32_bf16 v[36:39], a[160:163], a[80:83], 0
v_exp_f32 v43, v43
v_mfma_f32_16x16x32_bf16 v[36:39], a[164:167], a[84:87], v[36:39]
ds_read_b64_tr_b16 a[208:209], v10 offset:8192
v_cvt_pk_bf16_f32 v51, v42, v43
v_mfma_f32_16x16x32_bf16 v[36:39], a[168:171], a[88:91], v[36:39]
s_waitcnt lgkmcnt(1)
ds_read_b64_tr_b16 a[210:211], v10 offset:12288
v_fmamk_f32 v32, v32, 0x3e0293ee, v27
v_mfma_f32_16x16x32_bf16 v[36:39], a[172:175], a[92:95], v[36:39]
v_exp_f32 v32, v32
v_mfma_f32_16x16x32_bf16 v[160:163], a[192:195], v[76:79], v[160:163]
ds_read_b64_tr_b16 a[212:213], v11 offset:8192
v_fmamk_f32 v33, v33, 0x3e0293ee, v27
v_mfma_f32_16x16x32_bf16 v[164:167], a[196:199], v[76:79], v[164:167]
ds_read_b64_tr_b16 a[214:215], v11 offset:12288
v_fmamk_f32 v34, v34, 0x3e0293ee, v27
v_mfma_f32_16x16x32_bf16 v[168:171], a[200:203], v[76:79], v[168:171]
ds_read_b64_tr_b16 a[216:217], v12 offset:8192
v_fmamk_f32 v35, v35, 0x3e0293ee, v27
v_mfma_f32_16x16x32_bf16 v[172:175], a[204:207], v[76:79], v[172:175]
buffer_store_dwordx4 a[60:63], v28, s[12:15], 0 offen offset:2048 sc0 sc1 nt
buffer_load_dwordx4 v16, s[24:27], s31 offen nt lds
buffer_load_dwordx4 v17, s[24:27], s31 offen offset:1024 nt lds
v_mfma_f32_16x16x32_bf16 a[228:231], a[244:247], v[72:75], a[228:231]
s_add_u32 m0, s32, 57344
v_exp_f32 v33, v33
v_mfma_f32_16x16x32_bf16 v[40:43], a[160:163], a[96:99], 0
s_add_u32 s31, s29, 122880
v_exp_f32 v34, v34
v_mfma_f32_16x16x32_bf16 v[40:43], a[164:167], a[100:103], v[40:43]
v_exp_f32 v35, v35
v_mfma_f32_16x16x32_bf16 v[40:43], a[168:171], a[104:107], v[40:43]
ds_read_b64_tr_b16 a[218:219], v12 offset:12288
v_cvt_pk_bf16_f32 v54, v32, v33
v_mfma_f32_16x16x32_bf16 v[40:43], a[172:175], a[108:111], v[40:43]
ds_read_b64_tr_b16 a[220:221], v13 offset:8192
v_cvt_pk_bf16_f32 v55, v34, v35
v_mfma_f32_16x16x32_bf16 v[192:195], a[192:195], v[48:51], v[192:195]
ds_read_b64_tr_b16 a[222:223], v13 offset:12288
v_fmamk_f32 v36, v36, 0x3e0293ee, v23
v_mfma_f32_16x16x32_bf16 v[196:199], a[196:199], v[48:51], v[196:199]
v_exp_f32 v36, v36
v_mfma_f32_16x16x32_bf16 v[200:203], a[200:203], v[48:51], v[200:203]
ds_read_b128 a[176:179], v2 offset:20480
v_fmamk_f32 v37, v37, 0x3e0293ee, v23
v_mfma_f32_16x16x32_bf16 v[204:207], a[204:207], v[48:51], v[204:207]
v_exp_f32 v37, v37
v_mfma_f32_16x16x32_bf16 v[32:35], a[160:163], a[112:115], 0
ds_read_b128 a[180:183], v3 offset:20480
v_fmamk_f32 v38, v38, 0x3e0293ee, v23
v_mfma_f32_16x16x32_bf16 v[32:35], a[164:167], a[116:119], v[32:35]
v_exp_f32 v38, v38
v_mfma_f32_16x16x32_bf16 v[32:35], a[168:171], a[120:123], v[32:35]
ds_read_b128 a[184:187], v4 offset:20480
v_fmamk_f32 v39, v39, 0x3e0293ee, v23
v_mfma_f32_16x16x32_bf16 v[32:35], a[172:175], a[124:127], v[32:35]
v_exp_f32 v39, v39
v_mfma_f32_16x16x32_bf16 v[224:227], a[192:195], v[52:55], v[224:227]
v_cvt_pk_bf16_f32 v56, v36, v37
v_cvt_pk_bf16_f32 v57, v38, v39
v_mfma_f32_16x16x32_bf16 v[228:231], a[196:199], v[52:55], v[228:231]
ds_read_b128 a[188:191], v5 offset:20480
v_fmamk_f32 v40, v40, 0x3e0293ee, v24
v_mfma_f32_16x16x32_bf16 v[232:235], a[200:203], v[52:55], v[232:235]
v_exp_f32 v40, v40
v_mfma_f32_16x16x32_bf16 v[236:239], a[204:207], v[52:55], v[236:239]
v_fmamk_f32 v41, v41, 0x3e0293ee, v24
v_fmamk_f32 v42, v42, 0x3e0293ee, v24
v_mfma_f32_16x16x32_bf16 a[232:235], a[244:247], v[76:79], a[232:235]
v_exp_f32 v41, v41
v_mfma_f32_16x16x32_bf16 v[36:39], a[160:163], a[128:131], 0
v_exp_f32 v42, v42
v_mfma_f32_16x16x32_bf16 v[36:39], a[164:167], a[132:135], v[36:39]
v_fmamk_f32 v43, v43, 0x3e0293ee, v24
v_cvt_pk_bf16_f32 v60, v40, v41
v_mfma_f32_16x16x32_bf16 v[36:39], a[168:171], a[136:139], v[36:39]
v_exp_f32 v43, v43
v_mfma_f32_16x16x32_bf16 v[36:39], a[172:175], a[140:143], v[36:39]
s_waitcnt lgkmcnt(1)
v_cvt_pk_bf16_f32 v61, v42, v43
v_fmamk_f32 v32, v32, 0x3e0293ee, v25
v_mfma_f32_16x16x32_bf16 v[112:115], a[208:211], v[68:71], v[112:115]
v_exp_f32 v32, v32
v_mfma_f32_16x16x32_bf16 v[116:119], a[212:215], v[68:71], v[116:119]
v_fmamk_f32 v33, v33, 0x3e0293ee, v25
v_fmamk_f32 v34, v34, 0x3e0293ee, v25
v_mfma_f32_16x16x32_bf16 v[120:123], a[216:219], v[68:71], v[120:123]
v_exp_f32 v33, v33
v_mfma_f32_16x16x32_bf16 v[124:127], a[220:223], v[68:71], v[124:127]
v_exp_f32 v34, v34
v_mfma_f32_16x16x32_bf16 v[40:43], a[160:163], a[144:147], 0
v_fmamk_f32 v35, v35, 0x3e0293ee, v25
v_cvt_pk_bf16_f32 v64, v32, v33
v_mfma_f32_16x16x32_bf16 v[40:43], a[164:167], a[148:151], v[40:43]
v_exp_f32 v35, v35
v_mfma_f32_16x16x32_bf16 v[40:43], a[168:171], a[152:155], v[40:43]
v_cvt_pk_bf16_f32 v65, v34, v35
v_fmamk_f32 v36, v36, 0x3e0293ee, v26
v_mfma_f32_16x16x32_bf16 v[40:43], a[172:175], a[156:159], v[40:43]
v_exp_f32 v36, v36
v_mfma_f32_16x16x32_bf16 v[144:147], a[208:211], v[72:75], v[144:147]
v_fmamk_f32 v37, v37, 0x3e0293ee, v26
v_fmamk_f32 v38, v38, 0x3e0293ee, v26
v_mfma_f32_16x16x32_bf16 v[148:151], a[212:215], v[72:75], v[148:151]
v_exp_f32 v37, v37
v_mfma_f32_16x16x32_bf16 v[152:155], a[216:219], v[72:75], v[152:155]
v_exp_f32 v38, v38
v_mfma_f32_16x16x32_bf16 v[156:159], a[220:223], v[72:75], v[156:159]
v_fmamk_f32 v39, v39, 0x3e0293ee, v26
v_cvt_pk_bf16_f32 v68, v36, v37
v_mfma_f32_16x16x32_bf16 a[236:239], a[244:247], v[48:51], a[236:239]
v_exp_f32 v39, v39
v_mfma_f32_16x16x32_bf16 v[32:35], a[176:179], a[80:83], 0
ds_read_b64_tr_b16 a[192:193], v6 offset:16384
v_cvt_pk_bf16_f32 v69, v38, v39
v_mfma_f32_16x16x32_bf16 v[32:35], a[180:183], a[84:87], v[32:35]
ds_read_b64_tr_b16 a[194:195], v6 offset:20480
v_fmamk_f32 v40, v40, 0x3e0293ee, v27
v_mfma_f32_16x16x32_bf16 v[32:35], a[184:187], a[88:91], v[32:35]
s_waitcnt lgkmcnt(2)
v_exp_f32 v40, v40
v_mfma_f32_16x16x32_bf16 v[32:35], a[188:191], a[92:95], v[32:35]
ds_read_b64_tr_b16 a[196:197], v7 offset:16384
v_fmamk_f32 v41, v41, 0x3e0293ee, v27
v_mfma_f32_16x16x32_bf16 v[176:179], a[208:211], v[76:79], v[176:179]
v_exp_f32 v41, v41
v_mfma_f32_16x16x32_bf16 v[180:183], a[212:215], v[76:79], v[180:183]
ds_read_b64_tr_b16 a[198:199], v7 offset:20480
v_fmamk_f32 v42, v42, 0x3e0293ee, v27
v_mfma_f32_16x16x32_bf16 v[184:187], a[216:219], v[76:79], v[184:187]
v_exp_f32 v42, v42
v_mfma_f32_16x16x32_bf16 v[188:191], a[220:223], v[76:79], v[188:191]
ds_read_b64_tr_b16 a[200:201], v8 offset:16384
v_fmamk_f32 v43, v43, 0x3e0293ee, v27
v_mfma_f32_16x16x32_bf16 v[36:39], a[176:179], a[96:99], 0
v_exp_f32 v43, v43
v_mfma_f32_16x16x32_bf16 v[36:39], a[180:183], a[100:103], v[36:39]
ds_read_b64_tr_b16 a[202:203], v8 offset:20480
v_cvt_pk_bf16_f32 v72, v40, v41
v_mfma_f32_16x16x32_bf16 v[36:39], a[184:187], a[104:107], v[36:39]
ds_read_b64_tr_b16 a[204:205], v9 offset:16384
v_cvt_pk_bf16_f32 v73, v42, v43
v_mfma_f32_16x16x32_bf16 v[36:39], a[188:191], a[108:111], v[36:39]
ds_read_b64_tr_b16 a[206:207], v9 offset:20480
v_add_u32 v28, s38, v19
v_mfma_f32_16x16x32_bf16 v[208:211], a[208:211], v[48:51], v[208:211]
s_add_u32 s38, s58, 0
buffer_store_dwordx4 a[64:67], v28, s[12:15], 0 offen offset:0 sc0 sc1 nt
buffer_load_dwordx4 v14, s[20:23], s30 offen nt lds
buffer_load_dwordx4 v15, s[20:23], s30 offen offset:1024 nt lds
v_mfma_f32_16x16x32_bf16 v[212:215], a[212:215], v[48:51], v[212:215]
s_add_u32 m0, s32, 122880
ds_read_b128 a[160:163], v2 offset:24576
v_fmamk_f32 v32, v32, 0x3e0293ee, v23
v_mfma_f32_16x16x32_bf16 v[216:219], a[216:219], v[48:51], v[216:219]
v_exp_f32 v32, v32
v_mfma_f32_16x16x32_bf16 v[220:223], a[220:223], v[48:51], v[220:223]
ds_read_b128 a[164:167], v3 offset:24576
v_fmamk_f32 v33, v33, 0x3e0293ee, v23
v_mfma_f32_16x16x32_bf16 a[240:243], a[244:247], v[52:55], a[240:243]
v_exp_f32 v33, v33
v_mfma_f32_16x16x32_bf16 v[40:43], a[176:179], a[112:115], 0
v_fmamk_f32 v34, v34, 0x3e0293ee, v23
v_fmamk_f32 v35, v35, 0x3e0293ee, v23
v_mfma_f32_16x16x32_bf16 v[40:43], a[180:183], a[116:119], v[40:43]
v_exp_f32 v34, v34
v_mfma_f32_16x16x32_bf16 v[40:43], a[184:187], a[120:123], v[40:43]
v_exp_f32 v35, v35
v_mfma_f32_16x16x32_bf16 v[40:43], a[188:191], a[124:127], v[40:43]
ds_read_b128 a[168:171], v4 offset:24576
v_cvt_pk_bf16_f32 v58, v32, v33
v_mfma_f32_16x16x32_bf16 v[240:243], a[208:211], v[52:55], v[240:243]
ds_read_b128 a[172:175], v5 offset:24576
v_cvt_pk_bf16_f32 v59, v34, v35
v_mfma_f32_16x16x32_bf16 v[244:247], a[212:215], v[52:55], v[244:247]
v_fmamk_f32 v36, v36, 0x3e0293ee, v24
v_fmamk_f32 v37, v37, 0x3e0293ee, v24
v_mfma_f32_16x16x32_bf16 v[248:251], a[216:219], v[52:55], v[248:251]
v_exp_f32 v36, v36
v_mfma_f32_16x16x32_bf16 v[252:255], a[220:223], v[52:55], v[252:255]
v_exp_f32 v37, v37
v_mfma_f32_16x16x32_bf16 v[32:35], a[176:179], a[128:131], 0
v_fmamk_f32 v38, v38, 0x3e0293ee, v24
v_fmamk_f32 v39, v39, 0x3e0293ee, v24
v_mfma_f32_16x16x32_bf16 v[32:35], a[180:183], a[132:135], v[32:35]
v_exp_f32 v38, v38
v_mfma_f32_16x16x32_bf16 v[32:35], a[184:187], a[136:139], v[32:35]
v_exp_f32 v39, v39
v_mfma_f32_16x16x32_bf16 v[32:35], a[188:191], a[140:143], v[32:35]
s_waitcnt lgkmcnt(1)
v_cvt_pk_bf16_f32 v62, v36, v37
v_cvt_pk_bf16_f32 v63, v38, v39
v_mfma_f32_16x16x32_bf16 v[96:99], a[192:195], v[56:59], v[96:99]
v_fmamk_f32 v40, v40, 0x3e0293ee, v25
v_fmamk_f32 v41, v41, 0x3e0293ee, v25
v_mfma_f32_16x16x32_bf16 v[100:103], a[196:199], v[56:59], v[100:103]
v_exp_f32 v40, v40
v_mfma_f32_16x16x32_bf16 v[104:107], a[200:203], v[56:59], v[104:107]
v_exp_f32 v41, v41
v_mfma_f32_16x16x32_bf16 v[108:111], a[204:207], v[56:59], v[108:111]
v_fmamk_f32 v42, v42, 0x3e0293ee, v25
v_fmamk_f32 v43, v43, 0x3e0293ee, v25
v_mfma_f32_16x16x32_bf16 a[224:227], a[244:247], v[56:59], a[224:227]
v_exp_f32 v42, v42
v_mfma_f32_16x16x32_bf16 v[36:39], a[176:179], a[144:147], 0
v_exp_f32 v43, v43
v_mfma_f32_16x16x32_bf16 v[36:39], a[180:183], a[148:151], v[36:39]
v_cvt_pk_bf16_f32 v66, v40, v41
v_cvt_pk_bf16_f32 v67, v42, v43
v_mfma_f32_16x16x32_bf16 v[36:39], a[184:187], a[152:155], v[36:39]
v_fmamk_f32 v32, v32, 0x3e0293ee, v26
v_fmamk_f32 v33, v33, 0x3e0293ee, v26
v_mfma_f32_16x16x32_bf16 v[36:39], a[188:191], a[156:159], v[36:39]
v_exp_f32 v32, v32
v_mfma_f32_16x16x32_bf16 v[128:131], a[192:195], v[60:63], v[128:131]
v_exp_f32 v33, v33
v_mfma_f32_16x16x32_bf16 v[132:135], a[196:199], v[60:63], v[132:135]
v_fmamk_f32 v34, v34, 0x3e0293ee, v26
v_fmamk_f32 v35, v35, 0x3e0293ee, v26
v_mfma_f32_16x16x32_bf16 v[136:139], a[200:203], v[60:63], v[136:139]
v_exp_f32 v34, v34
v_mfma_f32_16x16x32_bf16 v[140:143], a[204:207], v[60:63], v[140:143]
v_exp_f32 v35, v35
v_mfma_f32_16x16x32_bf16 v[40:43], a[160:163], a[80:83], 0
v_cvt_pk_bf16_f32 v70, v32, v33
v_cvt_pk_bf16_f32 v71, v34, v35
v_mfma_f32_16x16x32_bf16 v[40:43], a[164:167], a[84:87], v[40:43]
ds_read_b64_tr_b16 a[208:209], v10 offset:16384
v_fmamk_f32 v36, v36, 0x3e0293ee, v27
v_mfma_f32_16x16x32_bf16 v[40:43], a[168:171], a[88:91], v[40:43]
s_waitcnt lgkmcnt(1)
v_exp_f32 v36, v36
v_mfma_f32_16x16x32_bf16 v[40:43], a[172:175], a[92:95], v[40:43]
ds_read_b64_tr_b16 a[210:211], v10 offset:20480
v_fmamk_f32 v37, v37, 0x3e0293ee, v27
v_mfma_f32_16x16x32_bf16 v[160:163], a[192:195], v[64:67], v[160:163]
ds_read_b64_tr_b16 a[212:213], v11 offset:16384
v_fmamk_f32 v38, v38, 0x3e0293ee, v27
v_mfma_f32_16x16x32_bf16 v[164:167], a[196:199], v[64:67], v[164:167]
ds_read_b64_tr_b16 a[214:215], v11 offset:20480
v_fmamk_f32 v39, v39, 0x3e0293ee, v27
v_mfma_f32_16x16x32_bf16 v[168:171], a[200:203], v[64:67], v[168:171]
buffer_store_dwordx4 a[68:71], v28, s[12:15], 0 offen offset:2048 sc0 sc1 nt
buffer_load_dwordx4 v16, s[24:27], s31 offen nt lds
buffer_load_dwordx4 v17, s[24:27], s31 offen offset:1024 nt lds
v_mfma_f32_16x16x32_bf16 v[172:175], a[204:207], v[64:67], v[172:175]
v_exp_f32 v37, v37
v_mfma_f32_16x16x32_bf16 a[228:231], a[244:247], v[60:63], a[228:231]
v_exp_f32 v38, v38
v_mfma_f32_16x16x32_bf16 v[32:35], a[160:163], a[96:99], 0
v_exp_f32 v39, v39
v_mfma_f32_16x16x32_bf16 v[32:35], a[164:167], a[100:103], v[32:35]
ds_read_b64_tr_b16 a[216:217], v12 offset:16384
v_cvt_pk_bf16_f32 v74, v36, v37
v_mfma_f32_16x16x32_bf16 v[32:35], a[168:171], a[104:107], v[32:35]
ds_read_b64_tr_b16 a[218:219], v12 offset:20480
v_cvt_pk_bf16_f32 v75, v38, v39
v_mfma_f32_16x16x32_bf16 v[32:35], a[172:175], a[108:111], v[32:35]
ds_read_b64_tr_b16 a[220:221], v13 offset:16384
v_fmamk_f32 v40, v40, 0x3e0293ee, v23
v_mfma_f32_16x16x32_bf16 v[192:195], a[192:195], v[68:71], v[192:195]
v_exp_f32 v40, v40
v_mfma_f32_16x16x32_bf16 v[196:199], a[196:199], v[68:71], v[196:199]
ds_read_b64_tr_b16 a[222:223], v13 offset:20480
v_fmamk_f32 v41, v41, 0x3e0293ee, v23
v_mfma_f32_16x16x32_bf16 v[200:203], a[200:203], v[68:71], v[200:203]
v_exp_f32 v41, v41
v_mfma_f32_16x16x32_bf16 v[204:207], a[204:207], v[68:71], v[204:207]
ds_read_b128 a[176:179], v2 offset:28672
v_fmamk_f32 v42, v42, 0x3e0293ee, v23
v_mfma_f32_16x16x32_bf16 v[36:39], a[160:163], a[112:115], 0
v_exp_f32 v42, v42
v_mfma_f32_16x16x32_bf16 v[36:39], a[164:167], a[116:119], v[36:39]
ds_read_b128 a[180:183], v3 offset:28672
v_fmamk_f32 v43, v43, 0x3e0293ee, v23
v_mfma_f32_16x16x32_bf16 v[36:39], a[168:171], a[120:123], v[36:39]
v_exp_f32 v43, v43
v_mfma_f32_16x16x32_bf16 v[36:39], a[172:175], a[124:127], v[36:39]
ds_read_b128 a[184:187], v4 offset:28672
v_cvt_pk_bf16_f32 v76, v40, v41
v_mfma_f32_16x16x32_bf16 v[224:227], a[192:195], v[72:75], v[224:227]
ds_read_b128 a[188:191], v5 offset:28672
v_cvt_pk_bf16_f32 v77, v42, v43
v_mfma_f32_16x16x32_bf16 v[228:231], a[196:199], v[72:75], v[228:231]
L_pad1_11:
s_cbranch_execz L_back
v_fmamk_f32 v32, v32, 0x3e0293ee, v24
v_fmamk_f32 v33, v33, 0x3e0293ee, v24
v_mfma_f32_16x16x32_bf16 v[232:235], a[200:203], v[72:75], v[232:235]
v_exp_f32 v32, v32
v_mfma_f32_16x16x32_bf16 v[236:239], a[204:207], v[72:75], v[236:239]
v_exp_f32 v33, v33
v_mfma_f32_16x16x32_bf16 a[232:235], a[244:247], v[64:67], a[232:235]
v_fmamk_f32 v34, v34, 0x3e0293ee, v24
v_fmamk_f32 v35, v35, 0x3e0293ee, v24
v_mfma_f32_16x16x32_bf16 v[40:43], a[160:163], a[128:131], 0
v_exp_f32 v34, v34
v_mfma_f32_16x16x32_bf16 v[40:43], a[164:167], a[132:135], v[40:43]
v_exp_f32 v35, v35
v_mfma_f32_16x16x32_bf16 v[40:43], a[168:171], a[136:139], v[40:43]
v_cvt_pk_bf16_f32 v48, v32, v33
v_cvt_pk_bf16_f32 v49, v34, v35
v_mfma_f32_16x16x32_bf16 v[40:43], a[172:175], a[140:143], v[40:43]
s_waitcnt lgkmcnt(0)
v_fmamk_f32 v36, v36, 0x3e0293ee, v25
v_fmamk_f32 v37, v37, 0x3e0293ee, v25
v_mfma_f32_16x16x32_bf16 v[112:115], a[208:211], v[56:59], v[112:115]
v_exp_f32 v36, v36
v_mfma_f32_16x16x32_bf16 v[116:119], a[212:215], v[56:59], v[116:119]
v_exp_f32 v37, v37
v_mfma_f32_16x16x32_bf16 v[120:123], a[216:219], v[56:59], v[120:123]
v_fmamk_f32 v38, v38, 0x3e0293ee, v25
v_fmamk_f32 v39, v39, 0x3e0293ee, v25
v_mfma_f32_16x16x32_bf16 v[124:127], a[220:223], v[56:59], v[124:127]
v_exp_f32 v38, v38
v_mfma_f32_16x16x32_bf16 v[32:35], a[160:163], a[144:147], 0
v_exp_f32 v39, v39
v_mfma_f32_16x16x32_bf16 v[32:35], a[164:167], a[148:151], v[32:35]
v_cvt_pk_bf16_f32 v52, v36, v37
v_cvt_pk_bf16_f32 v53, v38, v39
v_mfma_f32_16x16x32_bf16 v[32:35], a[168:171], a[152:155], v[32:35]
v_fmamk_f32 v40, v40, 0x3e0293ee, v26
v_fmamk_f32 v41, v41, 0x3e0293ee, v26
v_mfma_f32_16x16x32_bf16 v[32:35], a[172:175], a[156:159], v[32:35]
v_exp_f32 v40, v40
v_mfma_f32_16x16x32_bf16 v[144:147], a[208:211], v[60:63], v[144:147]
v_exp_f32 v41, v41
v_mfma_f32_16x16x32_bf16 v[148:151], a[212:215], v[60:63], v[148:151]
v_fmamk_f32 v42, v42, 0x3e0293ee, v26
v_fmamk_f32 v43, v43, 0x3e0293ee, v26
v_mfma_f32_16x16x32_bf16 v[152:155], a[216:219], v[60:63], v[152:155]
v_exp_f32 v42, v42
v_mfma_f32_16x16x32_bf16 v[156:159], a[220:223], v[60:63], v[156:159]
v_exp_f32 v43, v43
v_mfma_f32_16x16x32_bf16 a[236:239], a[244:247], v[68:71], a[236:239]
s_waitcnt vmcnt(8)
v_cvt_pk_bf16_f32 v56, v40, v41
v_cvt_pk_bf16_f32 v57, v42, v43
v_mfma_f32_16x16x32_bf16 v[36:39], a[176:179], a[80:83], 0
s_barrier
ds_read_b64_tr_b16 a[192:193], v6 offset:24576
v_fmamk_f32 v32, v32, 0x3e0293ee, v27
v_mfma_f32_16x16x32_bf16 v[36:39], a[180:183], a[84:87], v[36:39]
v_exp_f32 v32, v32
v_mfma_f32_16x16x32_bf16 v[36:39], a[184:187], a[88:91], v[36:39]
ds_read_b64_tr_b16 a[194:195], v6 offset:28672
v_fmamk_f32 v33, v33, 0x3e0293ee, v27
v_mfma_f32_16x16x32_bf16 v[36:39], a[188:191], a[92:95], v[36:39]
v_exp_f32 v33, v33
v_mfma_f32_16x16x32_bf16 v[176:179], a[208:211], v[64:67], v[176:179]
ds_read_b64_tr_b16 a[196:197], v7 offset:24576
v_fmamk_f32 v34, v34, 0x3e0293ee, v27
v_mfma_f32_16x16x32_bf16 v[180:183], a[212:215], v[64:67], v[180:183]
v_exp_f32 v34, v34
v_mfma_f32_16x16x32_bf16 v[184:187], a[216:219], v[64:67], v[184:187]
ds_read_b64_tr_b16 a[198:199], v7 offset:28672
v_fmamk_f32 v35, v35, 0x3e0293ee, v27
v_mfma_f32_16x16x32_bf16 v[188:191], a[220:223], v[64:67], v[188:191]
v_exp_f32 v35, v35
v_mfma_f32_16x16x32_bf16 v[40:43], a[176:179], a[96:99], 0
ds_read_b64_tr_b16 a[200:201], v8 offset:24576
v_cvt_pk_bf16_f32 v60, v32, v33
v_mfma_f32_16x16x32_bf16 v[40:43], a[180:183], a[100:103], v[40:43]
ds_read_b64_tr_b16 a[202:203], v8 offset:28672
v_cvt_pk_bf16_f32 v61, v34, v35
v_mfma_f32_16x16x32_bf16 v[40:43], a[184:187], a[104:107], v[40:43]
ds_read_b64_tr_b16 a[204:205], v9 offset:24576
v_fmamk_f32 v36, v36, 0x3e0293ee, v23
v_mfma_f32_16x16x32_bf16 v[40:43], a[188:191], a[108:111], v[40:43]
v_exp_f32 v36, v36
v_mfma_f32_16x16x32_bf16 v[208:211], a[208:211], v[68:71], v[208:211]
ds_read_b64_tr_b16 a[206:207], v9 offset:28672
v_fmamk_f32 v37, v37, 0x3e0293ee, v23
v_mfma_f32_16x16x32_bf16 v[212:215], a[212:215], v[68:71], v[212:215]
v_exp_f32 v37, v37
v_mfma_f32_16x16x32_bf16 v[216:219], a[216:219], v[68:71], v[216:219]
ds_read_b128 a[160:163], v2 offset:32768
v_fmamk_f32 v38, v38, 0x3e0293ee, v23
v_mfma_f32_16x16x32_bf16 v[220:223], a[220:223], v[68:71], v[220:223]
v_exp_f32 v38, v38
v_mfma_f32_16x16x32_bf16 a[240:243], a[244:247], v[72:75], a[240:243]
ds_read_b128 a[164:167], v3 offset:32768
v_fmamk_f32 v39, v39, 0x3e0293ee, v23
v_mfma_f32_16x16x32_bf16 v[32:35], a[176:179], a[112:115], 0
v_exp_f32 v39, v39
v_mfma_f32_16x16x32_bf16 v[32:35], a[180:183], a[116:119], v[32:35]
ds_read_b128 a[168:171], v4 offset:32768
v_cvt_pk_bf16_f32 v78, v36, v37
v_mfma_f32_16x16x32_bf16 v[32:35], a[184:187], a[120:123], v[32:35]
ds_read_b128 a[172:175], v5 offset:32768
v_cvt_pk_bf16_f32 v79, v38, v39
v_mfma_f32_16x16x32_bf16 v[32:35], a[188:191], a[124:127], v[32:35]
v_fmamk_f32 v40, v40, 0x3e0293ee, v24
v_fmamk_f32 v41, v41, 0x3e0293ee, v24
v_mfma_f32_16x16x32_bf16 v[240:243], a[208:211], v[72:75], v[240:243]
v_exp_f32 v40, v40
v_mfma_f32_16x16x32_bf16 v[244:247], a[212:215], v[72:75], v[244:247]
v_exp_f32 v41, v41
v_mfma_f32_16x16x32_bf16 v[248:251], a[216:219], v[72:75], v[248:251]
v_fmamk_f32 v42, v42, 0x3e0293ee, v24
v_fmamk_f32 v43, v43, 0x3e0293ee, v24
v_mfma_f32_16x16x32_bf16 v[252:255], a[220:223], v[72:75], v[252:255]
v_exp_f32 v42, v42
v_mfma_f32_16x16x32_bf16 v[36:39], a[176:179], a[128:131], 0
v_exp_f32 v43, v43
v_mfma_f32_16x16x32_bf16 v[36:39], a[180:183], a[132:135], v[36:39]
v_cvt_pk_bf16_f32 v50, v40, v41
v_cvt_pk_bf16_f32 v51, v42, v43
v_mfma_f32_16x16x32_bf16 v[36:39], a[184:187], a[136:139], v[36:39]
v_fmamk_f32 v32, v32, 0x3e0293ee, v25
v_fmamk_f32 v33, v33, 0x3e0293ee, v25
v_mfma_f32_16x16x32_bf16 v[36:39], a[188:191], a[140:143], v[36:39]
s_waitcnt lgkmcnt(0)
v_exp_f32 v32, v32
v_mfma_f32_16x16x32_bf16 v[96:99], a[192:195], v[76:79], v[96:99]
v_exp_f32 v33, v33
v_mfma_f32_16x16x32_bf16 v[100:103], a[196:199], v[76:79], v[100:103]
v_fmamk_f32 v34, v34, 0x3e0293ee, v25
v_fmamk_f32 v35, v35, 0x3e0293ee, v25
v_mfma_f32_16x16x32_bf16 v[104:107], a[200:203], v[76:79], v[104:107]
v_exp_f32 v34, v34
v_mfma_f32_16x16x32_bf16 v[108:111], a[204:207], v[76:79], v[108:111]
v_exp_f32 v35, v35
v_mfma_f32_16x16x32_bf16 a[224:227], a[244:247], v[76:79], a[224:227]
v_cvt_pk_bf16_f32 v54, v32, v33
v_cvt_pk_bf16_f32 v55, v34, v35
v_mfma_f32_16x16x32_bf16 v[40:43], a[176:179], a[144:147], 0
ds_read_b64_tr_b16 a[208:209], v10 offset:24576
v_fmamk_f32 v36, v36, 0x3e0293ee, v26
v_mfma_f32_16x16x32_bf16 v[40:43], a[180:183], a[148:151], v[40:43]
v_exp_f32 v36, v36
v_mfma_f32_16x16x32_bf16 v[40:43], a[184:187], a[152:155], v[40:43]
ds_read_b64_tr_b16 a[210:211], v10 offset:28672
v_fmamk_f32 v37, v37, 0x3e0293ee, v26
v_mfma_f32_16x16x32_bf16 v[40:43], a[188:191], a[156:159], v[40:43]
v_exp_f32 v37, v37
v_mfma_f32_16x16x32_bf16 v[128:131], a[192:195], v[48:51], v[128:131]
ds_read_b64_tr_b16 a[212:213], v11 offset:24576
v_fmamk_f32 v38, v38, 0x3e0293ee, v26
v_mfma_f32_16x16x32_bf16 v[132:135], a[196:199], v[48:51], v[132:135]
v_exp_f32 v38, v38
v_mfma_f32_16x16x32_bf16 v[136:139], a[200:203], v[48:51], v[136:139]
ds_read_b64_tr_b16 a[214:215], v11 offset:28672
v_fmamk_f32 v39, v39, 0x3e0293ee, v26
v_mfma_f32_16x16x32_bf16 v[140:143], a[204:207], v[48:51], v[140:143]
v_exp_f32 v39, v39
v_mfma_f32_16x16x32_bf16 v[32:35], a[160:163], a[80:83], 0
ds_read_b64_tr_b16 a[216:217], v12 offset:24576
v_cvt_pk_bf16_f32 v58, v36, v37
v_mfma_f32_16x16x32_bf16 v[32:35], a[164:167], a[84:87], v[32:35]
ds_read_b64_tr_b16 a[218:219], v12 offset:28672
v_cvt_pk_bf16_f32 v59, v38, v39
v_mfma_f32_16x16x32_bf16 v[32:35], a[168:171], a[88:91], v[32:35]
ds_read_b64_tr_b16 a[220:221], v13 offset:24576
v_fmamk_f32 v40, v40, 0x3e0293ee, v27
v_mfma_f32_16x16x32_bf16 v[32:35], a[172:175], a[92:95], v[32:35]
v_exp_f32 v40, v40
v_mfma_f32_16x16x32_bf16 v[160:163], a[192:195], v[52:55], v[160:163]
ds_read_b64_tr_b16 a[222:223], v13 offset:28672
v_fmamk_f32 v41, v41, 0x3e0293ee, v27
v_mfma_f32_16x16x32_bf16 v[164:167], a[196:199], v[52:55], v[164:167]
v_exp_f32 v41, v41
v_mfma_f32_16x16x32_bf16 v[168:171], a[200:203], v[52:55], v[168:171]
ds_read_b128 a[176:179], v2 offset:36864
v_fmamk_f32 v42, v42, 0x3e0293ee, v27
v_mfma_f32_16x16x32_bf16 v[172:175], a[204:207], v[52:55], v[172:175]
v_exp_f32 v42, v42
v_mfma_f32_16x16x32_bf16 a[228:231], a[244:247], v[48:51], a[228:231]
ds_read_b128 a[180:183], v3 offset:36864
v_fmamk_f32 v43, v43, 0x3e0293ee, v27
v_mfma_f32_16x16x32_bf16 v[36:39], a[160:163], a[96:99], 0
v_exp_f32 v43, v43
v_mfma_f32_16x16x32_bf16 v[36:39], a[164:167], a[100:103], v[36:39]
ds_read_b128 a[184:187], v4 offset:36864
v_cvt_pk_bf16_f32 v62, v40, v41
v_mfma_f32_16x16x32_bf16 v[36:39], a[168:171], a[104:107], v[36:39]
ds_read_b128 a[188:191], v5 offset:36864
v_cvt_pk_bf16_f32 v63, v42, v43
v_mfma_f32_16x16x32_bf16 v[36:39], a[172:175], a[108:111], v[36:39]
v_fmamk_f32 v32, v32, 0x3e0293ee, v23
v_fmamk_f32 v33, v33, 0x3e0293ee, v23
v_mfma_f32_16x16x32_bf16 v[192:195], a[192:195], v[56:59], v[192:195]
v_exp_f32 v32, v32
v_mfma_f32_16x16x32_bf16 v[196:199], a[196:199], v[56:59], v[196:199]
v_exp_f32 v33, v33
v_mfma_f32_16x16x32_bf16 v[200:203], a[200:203], v[56:59], v[200:203]
v_fmamk_f32 v34, v34, 0x3e0293ee, v23
v_fmamk_f32 v35, v35, 0x3e0293ee, v23
v_mfma_f32_16x16x32_bf16 v[204:207], a[204:207], v[56:59], v[204:207]
v_exp_f32 v34, v34
v_mfma_f32_16x16x32_bf16 v[40:43], a[160:163], a[112:115], 0
v_exp_f32 v35, v35
v_mfma_f32_16x16x32_bf16 v[40:43], a[164:167], a[116:119], v[40:43]
v_cvt_pk_bf16_f32 v64, v32, v33
v_cvt_pk_bf16_f32 v65, v34, v35
v_mfma_f32_16x16x32_bf16 v[40:43], a[168:171], a[120:123], v[40:43]
ds_read_b128 a[160:163], v2 offset:40960
v_fmamk_f32 v36, v36, 0x3e0293ee, v24
v_mfma_f32_16x16x32_bf16 v[40:43], a[172:175], a[124:127], v[40:43]
v_exp_f32 v36, v36
v_mfma_f32_16x16x32_bf16 v[224:227], a[192:195], v[60:63], v[224:227]
ds_read_b128 a[164:167], v3 offset:40960
v_fmamk_f32 v37, v37, 0x3e0293ee, v24
v_mfma_f32_16x16x32_bf16 v[228:231], a[196:199], v[60:63], v[228:231]
v_exp_f32 v37, v37
v_mfma_f32_16x16x32_bf16 v[232:235], a[200:203], v[60:63], v[232:235]
v_fmamk_f32 v38, v38, 0x3e0293ee, v24
v_fmamk_f32 v39, v39, 0x3e0293ee, v24
v_mfma_f32_16x16x32_bf16 v[236:239], a[204:207], v[60:63], v[236:239]
v_exp_f32 v38, v38
v_mfma_f32_16x16x32_bf16 a[232:235], a[244:247], v[52:55], a[232:235]
s_waitcnt lgkmcnt(2)
v_exp_f32 v39, v39
v_mfma_f32_16x16x32_bf16 v[112:115], a[208:211], v[76:79], v[112:115]
ds_read_b128 a[168:171], v4 offset:40960
v_cvt_pk_bf16_f32 v68, v36, v37
v_mfma_f32_16x16x32_bf16 v[116:119], a[212:215], v[76:79], v[116:119]
ds_read_b128 a[172:175], v5 offset:40960
v_cvt_pk_bf16_f32 v69, v38, v39
v_mfma_f32_16x16x32_bf16 v[120:123], a[216:219], v[76:79], v[120:123]
ds_read_b64_tr_b16 a[192:193], v6 offset:32768
v_fmamk_f32 v40, v40, 0x3e0293ee, v25
v_mfma_f32_16x16x32_bf16 v[124:127], a[220:223], v[76:79], v[124:127]
v_exp_f32 v40, v40
v_mfma_f32_16x16x32_bf16 v[32:35], a[176:179], a[80:83], 0
ds_read_b64_tr_b16 a[194:195], v6 offset:36864
v_fmamk_f32 v41, v41, 0x3e0293ee, v25
v_mfma_f32_16x16x32_bf16 v[32:35], a[180:183], a[84:87], v[32:35]
v_exp_f32 v41, v41
v_mfma_f32_16x16x32_bf16 v[32:35], a[184:187], a[88:91], v[32:35]
ds_read_b64_tr_b16 a[196:197], v7 offset:32768
v_fmamk_f32 v42, v42, 0x3e0293ee, v25
v_mfma_f32_16x16x32_bf16 v[32:35], a[188:191], a[92:95], v[32:35]
v_exp_f32 v42, v42
v_mfma_f32_16x16x32_bf16 v[144:147], a[208:211], v[48:51], v[144:147]
ds_read_b64_tr_b16 a[198:199], v7 offset:36864
v_fmamk_f32 v43, v43, 0x3e0293ee, v25
v_mfma_f32_16x16x32_bf16 v[148:151], a[212:215], v[48:51], v[148:151]
v_exp_f32 v43, v43
v_mfma_f32_16x16x32_bf16 v[152:155], a[216:219], v[48:51], v[152:155]
ds_read_b64_tr_b16 a[200:201], v8 offset:32768
v_cvt_pk_bf16_f32 v72, v40, v41
v_mfma_f32_16x16x32_bf16 v[156:159], a[220:223], v[48:51], v[156:159]
ds_read_b64_tr_b16 a[202:203], v8 offset:36864
v_cvt_pk_bf16_f32 v73, v42, v43
v_mfma_f32_16x16x32_bf16 a[236:239], a[244:247], v[56:59], a[236:239]
ds_read_b64_tr_b16 a[204:205], v9 offset:32768
v_fmamk_f32 v32, v32, 0x3e0293ee, v23
v_mfma_f32_16x16x32_bf16 v[176:179], a[208:211], v[52:55], v[176:179]
v_exp_f32 v32, v32
v_mfma_f32_16x16x32_bf16 v[180:183], a[212:215], v[52:55], v[180:183]
ds_read_b64_tr_b16 a[206:207], v9 offset:36864
v_fmamk_f32 v33, v33, 0x3e0293ee, v23
v_mfma_f32_16x16x32_bf16 v[184:187], a[216:219], v[52:55], v[184:187]
v_exp_f32 v33, v33
v_mfma_f32_16x16x32_bf16 v[188:191], a[220:223], v[52:55], v[188:191]
v_fmamk_f32 v34, v34, 0x3e0293ee, v23
v_fmamk_f32 v35, v35, 0x3e0293ee, v23
v_mfma_f32_16x16x32_bf16 v[36:39], a[176:179], a[96:99], 0
v_exp_f32 v34, v34
v_mfma_f32_16x16x32_bf16 v[36:39], a[180:183], a[100:103], v[36:39]
v_exp_f32 v35, v35
v_mfma_f32_16x16x32_bf16 v[36:39], a[184:187], a[104:107], v[36:39]
v_cvt_pk_bf16_f32 v66, v32, v33
v_cvt_pk_bf16_f32 v67, v34, v35
v_mfma_f32_16x16x32_bf16 v[36:39], a[188:191], a[108:111], v[36:39]
v_add_u32 v22, s38, v19
v_mfma_f32_16x16x32_bf16 v[208:211], a[208:211], v[56:59], v[208:211]
s_add_u32 s38, s58, 4096
v_mfma_f32_16x16x32_bf16 v[212:215], a[212:215], v[56:59], v[212:215]
v_mfma_f32_16x16x32_bf16 v[216:219], a[216:219], v[56:59], v[216:219]
s_nop 2
v_fmamk_f32 v36, v36, 0x3e0293ee, v24
v_fmamk_f32 v37, v37, 0x3e0293ee, v24
v_mfma_f32_16x16x32_bf16 v[220:223], a[220:223], v[56:59], v[220:223]
v_exp_f32 v36, v36
v_mfma_f32_16x16x32_bf16 a[240:243], a[244:247], v[60:63], a[240:243]
v_exp_f32 v37, v37
v_mfma_f32_16x16x32_bf16 v[40:43], a[176:179], a[112:115], 0
ds_read_b128 a[176:179], v2 offset:45056
v_fmamk_f32 v38, v38, 0x3e0293ee, v24
v_mfma_f32_16x16x32_bf16 v[40:43], a[180:183], a[116:119], v[40:43]
v_exp_f32 v38, v38
v_mfma_f32_16x16x32_bf16 v[40:43], a[184:187], a[120:123], v[40:43]
ds_read_b128 a[180:183], v3 offset:45056
v_fmamk_f32 v39, v39, 0x3e0293ee, v24
v_mfma_f32_16x16x32_bf16 v[40:43], a[188:191], a[124:127], v[40:43]
v_exp_f32 v39, v39
v_mfma_f32_16x16x32_bf16 v[240:243], a[208:211], v[60:63], v[240:243]
ds_read_b128 a[184:187], v4 offset:45056
v_cvt_pk_bf16_f32 v70, v36, v37
v_mfma_f32_16x16x32_bf16 v[244:247], a[212:215], v[60:63], v[244:247]
ds_read_b128 a[188:191], v5 offset:45056
v_cvt_pk_bf16_f32 v71, v38, v39
v_mfma_f32_16x16x32_bf16 v[248:251], a[216:219], v[60:63], v[248:251]
ds_read_b64_tr_b16 a[208:209], v10 offset:32768
v_fmamk_f32 v40, v40, 0x3e0293ee, v25
v_mfma_f32_16x16x32_bf16 v[252:255], a[220:223], v[60:63], v[252:255]
s_waitcnt lgkmcnt(5)
v_exp_f32 v40, v40
v_mfma_f32_16x16x32_bf16 v[32:35], a[160:163], a[80:83], 0
ds_read_b64_tr_b16 a[210:211], v10 offset:36864
v_fmamk_f32 v41, v41, 0x3e0293ee, v25
v_mfma_f32_16x16x32_bf16 v[32:35], a[164:167], a[84:87], v[32:35]
v_exp_f32 v41, v41
v_mfma_f32_16x16x32_bf16 v[32:35], a[168:171], a[88:91], v[32:35]
ds_read_b64_tr_b16 a[212:213], v11 offset:32768
v_fmamk_f32 v42, v42, 0x3e0293ee, v25
v_mfma_f32_16x16x32_bf16 v[32:35], a[172:175], a[92:95], v[32:35]
v_exp_f32 v42, v42
v_mfma_f32_16x16x32_bf16 v[96:99], a[192:195], v[64:67], v[96:99]
ds_read_b64_tr_b16 a[214:215], v11 offset:36864
v_fmamk_f32 v43, v43, 0x3e0293ee, v25
v_mfma_f32_16x16x32_bf16 v[100:103], a[196:199], v[64:67], v[100:103]
v_exp_f32 v43, v43
v_mfma_f32_16x16x32_bf16 v[104:107], a[200:203], v[64:67], v[104:107]
ds_read_b64_tr_b16 a[216:217], v12 offset:32768
v_cvt_pk_bf16_f32 v74, v40, v41
v_mfma_f32_16x16x32_bf16 v[108:111], a[204:207], v[64:67], v[108:111]
ds_read_b64_tr_b16 a[218:219], v12 offset:36864
v_cvt_pk_bf16_f32 v75, v42, v43
v_mfma_f32_16x16x32_bf16 a[224:227], a[244:247], v[64:67], a[224:227]
ds_read_b64_tr_b16 a[220:221], v13 offset:32768
v_fmamk_f32 v32, v32, 0x3e0293ee, v23
v_mfma_f32_16x16x32_bf16 v[36:39], a[160:163], a[96:99], 0
v_exp_f32 v32, v32
v_mfma_f32_16x16x32_bf16 v[36:39], a[164:167], a[100:103], v[36:39]
ds_read_b64_tr_b16 a[222:223], v13 offset:36864
v_fmamk_f32 v33, v33, 0x3e0293ee, v23
v_mfma_f32_16x16x32_bf16 v[36:39], a[168:171], a[104:107], v[36:39]
v_exp_f32 v33, v33
v_mfma_f32_16x16x32_bf16 v[36:39], a[172:175], a[108:111], v[36:39]
v_fmamk_f32 v34, v34, 0x3e0293ee, v23
v_fmamk_f32 v35, v35, 0x3e0293ee, v23
v_mfma_f32_16x16x32_bf16 v[128:131], a[192:195], v[68:71], v[128:131]
v_exp_f32 v34, v34
v_mfma_f32_16x16x32_bf16 v[132:135], a[196:199], v[68:71], v[132:135]
v_exp_f32 v35, v35
v_mfma_f32_16x16x32_bf16 v[136:139], a[200:203], v[68:71], v[136:139]
v_cvt_pk_bf16_f32 v76, v32, v33
v_cvt_pk_bf16_f32 v77, v34, v35
v_mfma_f32_16x16x32_bf16 v[140:143], a[204:207], v[68:71], v[140:143]
v_fmamk_f32 v36, v36, 0x3e0293ee, v24
v_fmamk_f32 v37, v37, 0x3e0293ee, v24
v_mfma_f32_16x16x32_bf16 v[40:43], a[160:163], a[112:115], 0
v_exp_f32 v36, v36
v_mfma_f32_16x16x32_bf16 v[40:43], a[164:167], a[116:119], v[40:43]
v_exp_f32 v37, v37
v_mfma_f32_16x16x32_bf16 v[40:43], a[168:171], a[120:123], v[40:43]
v_fmamk_f32 v38, v38, 0x3e0293ee, v24
v_fmamk_f32 v39, v39, 0x3e0293ee, v24
v_mfma_f32_16x16x32_bf16 v[40:43], a[172:175], a[124:127], v[40:43]
v_exp_f32 v38, v38
v_mfma_f32_16x16x32_bf16 v[160:163], a[192:195], v[72:75], v[160:163]
v_exp_f32 v39, v39
v_mfma_f32_16x16x32_bf16 v[164:167], a[196:199], v[72:75], v[164:167]
v_cvt_pk_bf16_f32 v48, v36, v37
v_cvt_pk_bf16_f32 v49, v38, v39
v_mfma_f32_16x16x32_bf16 v[168:171], a[200:203], v[72:75], v[168:171]
ds_read_b64_tr_b16 a[192:193], v6 offset:40960
v_fmamk_f32 v40, v40, 0x3e0293ee, v25
v_mfma_f32_16x16x32_bf16 v[172:175], a[204:207], v[72:75], v[172:175]
v_exp_f32 v40, v40
v_mfma_f32_16x16x32_bf16 a[228:231], a[244:247], v[68:71], a[228:231]
s_waitcnt vmcnt(0) lgkmcnt(1)
ds_read_b64_tr_b16 a[194:195], v6 offset:45056
v_fmamk_f32 v41, v41, 0x3e0293ee, v25
v_mfma_f32_16x16x32_bf16 v[32:35], a[176:179], a[80:83], 0
s_barrier
v_exp_f32 v41, v41
v_mfma_f32_16x16x32_bf16 v[32:35], a[180:183], a[84:87], v[32:35]
ds_read_b128 a[160:163], v2 offset:49152
v_fmamk_f32 v42, v42, 0x3e0293ee, v25
v_mfma_f32_16x16x32_bf16 v[32:35], a[184:187], a[88:91], v[32:35]
v_exp_f32 v42, v42
v_mfma_f32_16x16x32_bf16 v[32:35], a[188:191], a[92:95], v[32:35]
ds_read_b128 a[164:167], v3 offset:49152
v_fmamk_f32 v43, v43, 0x3e0293ee, v25
v_mfma_f32_16x16x32_bf16 v[112:115], a[208:211], v[64:67], v[112:115]
v_exp_f32 v43, v43
v_mfma_f32_16x16x32_bf16 v[116:119], a[212:215], v[64:67], v[116:119]
ds_read_b128 a[168:171], v4 offset:49152
v_cvt_pk_bf16_f32 v52, v40, v41
v_mfma_f32_16x16x32_bf16 v[120:123], a[216:219], v[64:67], v[120:123]
ds_read_b128 a[172:175], v5 offset:49152
v_cvt_pk_bf16_f32 v53, v42, v43
v_mfma_f32_16x16x32_bf16 v[124:127], a[220:223], v[64:67], v[124:127]
ds_read_b64_tr_b16 a[196:197], v7 offset:40960
v_fmamk_f32 v32, v32, 0x3e0293ee, v23
v_mfma_f32_16x16x32_bf16 v[36:39], a[176:179], a[96:99], 0
ds_read_b64_tr_b16 a[198:199], v7 offset:45056
v_fmamk_f32 v33, v33, 0x3e0293ee, v23
v_mfma_f32_16x16x32_bf16 v[36:39], a[180:183], a[100:103], v[36:39]
v_exp_f32 v32, v32
v_mfma_f32_16x16x32_bf16 v[36:39], a[184:187], a[104:107], v[36:39]
v_exp_f32 v33, v33
v_mfma_f32_16x16x32_bf16 v[36:39], a[188:191], a[108:111], v[36:39]
ds_read_b64_tr_b16 a[200:201], v8 offset:40960
v_fmamk_f32 v34, v34, 0x3e0293ee, v23
v_mfma_f32_16x16x32_bf16 v[144:147], a[208:211], v[68:71], v[144:147]
v_exp_f32 v34, v34
v_mfma_f32_16x16x32_bf16 v[148:151], a[212:215], v[68:71], v[148:151]
ds_read_b64_tr_b16 a[202:203], v8 offset:45056
v_fmamk_f32 v35, v35, 0x3e0293ee, v23
v_mfma_f32_16x16x32_bf16 v[152:155], a[216:219], v[68:71], v[152:155]
v_exp_f32 v35, v35
v_mfma_f32_16x16x32_bf16 v[156:159], a[220:223], v[68:71], v[156:159]
ds_read_b64_tr_b16 a[204:205], v9 offset:40960
v_cvt_pk_bf16_f32 v78, v32, v33
v_mfma_f32_16x16x32_bf16 a[232:235], a[244:247], v[72:75], a[232:235]
ds_read_b64_tr_b16 a[206:207], v9 offset:45056
v_cvt_pk_bf16_f32 v79, v34, v35
v_mfma_f32_16x16x32_bf16 v[40:43], a[176:179], a[112:115], 0
ds_read_b128 a[176:179], v2 offset:53248
v_fmamk_f32 v36, v36, 0x3e0293ee, v24
v_mfma_f32_16x16x32_bf16 v[40:43], a[180:183], a[116:119], v[40:43]
v_exp_f32 v36, v36
v_mfma_f32_16x16x32_bf16 v[40:43], a[184:187], a[120:123], v[40:43]
ds_read_b128 a[180:183], v3 offset:53248
v_fmamk_f32 v37, v37, 0x3e0293ee, v24
v_mfma_f32_16x16x32_bf16 v[40:43], a[188:191], a[124:127], v[40:43]
v_exp_f32 v37, v37
v_mfma_f32_16x16x32_bf16 v[176:179], a[208:211], v[72:75], v[176:179]
v_fmamk_f32 v38, v38, 0x3e0293ee, v24
v_fmamk_f32 v39, v39, 0x3e0293ee, v24
v_mfma_f32_16x16x32_bf16 v[180:183], a[212:215], v[72:75], v[180:183]
v_exp_f32 v38, v38
v_mfma_f32_16x16x32_bf16 v[184:187], a[216:219], v[72:75], v[184:187]
v_exp_f32 v39, v39
v_mfma_f32_16x16x32_bf16 v[188:191], a[220:223], v[72:75], v[188:191]
s_waitcnt lgkmcnt(2)
ds_read_b128 a[184:187], v4 offset:53248
v_cvt_pk_bf16_f32 v50, v36, v37
v_mfma_f32_16x16x32_bf16 v[32:35], a[160:163], a[80:83], 0
ds_read_b128 a[188:191], v5 offset:53248
v_cvt_pk_bf16_f32 v51, v38, v39
v_mfma_f32_16x16x32_bf16 v[32:35], a[164:167], a[84:87], v[32:35]
ds_read_b64_tr_b16 a[208:209], v10 offset:40960
v_fmamk_f32 v40, v40, 0x3e0293ee, v25
v_mfma_f32_16x16x32_bf16 v[32:35], a[168:171], a[88:91], v[32:35]
v_exp_f32 v40, v40
v_mfma_f32_16x16x32_bf16 v[32:35], a[172:175], a[92:95], v[32:35]
ds_read_b64_tr_b16 a[210:211], v10 offset:45056
v_fmamk_f32 v41, v41, 0x3e0293ee, v25
v_mfma_f32_16x16x32_bf16 v[96:99], a[192:195], v[76:79], v[96:99]
v_exp_f32 v41, v41
v_mfma_f32_16x16x32_bf16 v[100:103], a[196:199], v[76:79], v[100:103]
ds_read_b64_tr_b16 a[212:213], v11 offset:40960
v_fmamk_f32 v42, v42, 0x3e0293ee, v25
v_mfma_f32_16x16x32_bf16 v[104:107], a[200:203], v[76:79], v[104:107]
v_exp_f32 v42, v42
v_mfma_f32_16x16x32_bf16 v[108:111], a[204:207], v[76:79], v[108:111]
ds_read_b64_tr_b16 a[214:215], v11 offset:45056
v_fmamk_f32 v43, v43, 0x3e0293ee, v25
v_mfma_f32_16x16x32_bf16 a[224:227], a[244:247], v[76:79], a[224:227]
v_exp_f32 v43, v43
v_mfma_f32_16x16x32_bf16 v[36:39], a[160:163], a[96:99], 0
ds_read_b64_tr_b16 a[216:217], v12 offset:40960
v_cvt_pk_bf16_f32 v54, v40, v41
v_mfma_f32_16x16x32_bf16 v[36:39], a[164:167], a[100:103], v[36:39]
ds_read_b64_tr_b16 a[218:219], v12 offset:45056
v_cvt_pk_bf16_f32 v55, v42, v43
v_mfma_f32_16x16x32_bf16 v[36:39], a[168:171], a[104:107], v[36:39]
ds_read_b64_tr_b16 a[220:221], v13 offset:40960
v_fmamk_f32 v32, v32, 0x3e0293ee, v23
v_mfma_f32_16x16x32_bf16 v[36:39], a[172:175], a[108:111], v[36:39]
v_exp_f32 v32, v32
v_mfma_f32_16x16x32_bf16 v[128:131], a[192:195], v[48:51], v[128:131]
ds_read_b64_tr_b16 a[222:223], v13 offset:45056
v_fmamk_f32 v33, v33, 0x3e0293ee, v23
v_mfma_f32_16x16x32_bf16 v[132:135], a[196:199], v[48:51], v[132:135]
v_exp_f32 v33, v33
v_mfma_f32_16x16x32_bf16 v[136:139], a[200:203], v[48:51], v[136:139]
v_fmamk_f32 v34, v34, 0x3e0293ee, v23
v_fmamk_f32 v35, v35, 0x3e0293ee, v23
v_mfma_f32_16x16x32_bf16 v[140:143], a[204:207], v[48:51], v[140:143]
v_exp_f32 v34, v34
v_mfma_f32_16x16x32_bf16 v[40:43], a[160:163], a[112:115], 0
v_exp_f32 v35, v35
v_mfma_f32_16x16x32_bf16 v[40:43], a[164:167], a[116:119], v[40:43]
v_cvt_pk_bf16_f32 v56, v32, v33
v_cvt_pk_bf16_f32 v57, v34, v35
v_mfma_f32_16x16x32_bf16 v[40:43], a[168:171], a[120:123], v[40:43]
ds_read_b128 a[160:163], v2 offset:57344
v_fmamk_f32 v36, v36, 0x3e0293ee, v24
v_mfma_f32_16x16x32_bf16 v[40:43], a[172:175], a[124:127], v[40:43]
v_exp_f32 v36, v36
v_mfma_f32_16x16x32_bf16 v[160:163], a[192:195], v[52:55], v[160:163]
ds_read_b128 a[164:167], v3 offset:57344
v_fmamk_f32 v37, v37, 0x3e0293ee, v24
v_mfma_f32_16x16x32_bf16 v[164:167], a[196:199], v[52:55], v[164:167]
v_exp_f32 v37, v37
v_mfma_f32_16x16x32_bf16 v[168:171], a[200:203], v[52:55], v[168:171]
v_fmamk_f32 v38, v38, 0x3e0293ee, v24
v_fmamk_f32 v39, v39, 0x3e0293ee, v24
v_mfma_f32_16x16x32_bf16 v[172:175], a[204:207], v[52:55], v[172:175]
v_exp_f32 v38, v38
v_mfma_f32_16x16x32_bf16 a[228:231], a[244:247], v[48:51], a[228:231]
s_waitcnt lgkmcnt(2)
v_exp_f32 v39, v39
v_mfma_f32_16x16x32_bf16 v[32:35], a[176:179], a[80:83], 0
ds_read_b128 a[168:171], v4 offset:57344
v_cvt_pk_bf16_f32 v60, v36, v37
v_mfma_f32_16x16x32_bf16 v[32:35], a[180:183], a[84:87], v[32:35]
ds_read_b128 a[172:175], v5 offset:57344
v_cvt_pk_bf16_f32 v61, v38, v39
v_mfma_f32_16x16x32_bf16 v[32:35], a[184:187], a[88:91], v[32:35]
ds_read_b64_tr_b16 a[192:193], v6 offset:49152
v_fmamk_f32 v40, v40, 0x3e0293ee, v25
v_mfma_f32_16x16x32_bf16 v[32:35], a[188:191], a[92:95], v[32:35]
v_exp_f32 v40, v40
v_mfma_f32_16x16x32_bf16 v[112:115], a[208:211], v[76:79], v[112:115]
ds_read_b64_tr_b16 a[194:195], v6 offset:53248
v_fmamk_f32 v41, v41, 0x3e0293ee, v25
v_mfma_f32_16x16x32_bf16 v[116:119], a[212:215], v[76:79], v[116:119]
v_exp_f32 v41, v41
v_mfma_f32_16x16x32_bf16 v[120:123], a[216:219], v[76:79], v[120:123]
ds_read_b64_tr_b16 a[196:197], v7 offset:49152
v_fmamk_f32 v42, v42, 0x3e0293ee, v25
v_mfma_f32_16x16x32_bf16 v[124:127], a[220:223], v[76:79], v[124:127]
v_exp_f32 v42, v42
v_mfma_f32_16x16x32_bf16 v[36:39], a[176:179], a[96:99], 0
ds_read_b64_tr_b16 a[198:199], v7 offset:53248
v_fmamk_f32 v43, v43, 0x3e0293ee, v25
v_mfma_f32_16x16x32_bf16 v[36:39], a[180:183], a[100:103], v[36:39]
v_exp_f32 v43, v43
v_mfma_f32_16x16x32_bf16 v[36:39], a[184:187], a[104:107], v[36:39]
ds_read_b64_tr_b16 a[200:201], v8 offset:49152
v_cvt_pk_bf16_f32 v64, v40, v41
v_mfma_f32_16x16x32_bf16 v[36:39], a[188:191], a[108:111], v[36:39]
ds_read_b64_tr_b16 a[202:203], v8 offset:53248
v_cvt_pk_bf16_f32 v65, v42, v43
v_mfma_f32_16x16x32_bf16 v[144:147], a[208:211], v[48:51], v[144:147]
ds_read_b64_tr_b16 a[204:205], v9 offset:49152
v_fmamk_f32 v32, v32, 0x3e0293ee, v23
v_mfma_f32_16x16x32_bf16 v[148:151], a[212:215], v[48:51], v[148:151]
v_exp_f32 v32, v32
v_mfma_f32_16x16x32_bf16 v[152:155], a[216:219], v[48:51], v[152:155]
ds_read_b64_tr_b16 a[206:207], v9 offset:53248
v_fmamk_f32 v33, v33, 0x3e0293ee, v23
v_mfma_f32_16x16x32_bf16 v[156:159], a[220:223], v[48:51], v[156:159]
v_exp_f32 v33, v33
v_mfma_f32_16x16x32_bf16 a[232:235], a[244:247], v[52:55], a[232:235]
v_fmamk_f32 v34, v34, 0x3e0293ee, v23
v_fmamk_f32 v35, v35, 0x3e0293ee, v23
v_mfma_f32_16x16x32_bf16 v[40:43], a[176:179], a[112:115], 0
v_exp_f32 v34, v34
v_mfma_f32_16x16x32_bf16 v[40:43], a[180:183], a[116:119], v[40:43]
v_exp_f32 v35, v35
v_mfma_f32_16x16x32_bf16 v[40:43], a[184:187], a[120:123], v[40:43]
v_cvt_pk_bf16_f32 v58, v32, v33
v_cvt_pk_bf16_f32 v59, v34, v35
v_mfma_f32_16x16x32_bf16 v[40:43], a[188:191], a[124:127], v[40:43]
L_pad1_12:
s_cbranch_execz L_back
ds_read_b128 a[176:179], v2 offset:61440
v_fmamk_f32 v36, v36, 0x3e0293ee, v24
v_mfma_f32_16x16x32_bf16 v[176:179], a[208:211], v[52:55], v[176:179]
v_exp_f32 v36, v36
v_mfma_f32_16x16x32_bf16 v[180:183], a[212:215], v[52:55], v[180:183]
ds_read_b128 a[180:183], v3 offset:61440
v_fmamk_f32 v37, v37, 0x3e0293ee, v24
v_mfma_f32_16x16x32_bf16 v[184:187], a[216:219], v[52:55], v[184:187]
v_exp_f32 v37, v37
v_mfma_f32_16x16x32_bf16 v[188:191], a[220:223], v[52:55], v[188:191]
s_waitcnt lgkmcnt(2)
v_fmamk_f32 v38, v38, 0x3e0293ee, v24
v_fmamk_f32 v39, v39, 0x3e0293ee, v24
v_mfma_f32_16x16x32_bf16 v[32:35], a[160:163], a[80:83], 0
v_exp_f32 v38, v38
v_mfma_f32_16x16x32_bf16 v[32:35], a[164:167], a[84:87], v[32:35]
v_exp_f32 v39, v39
v_mfma_f32_16x16x32_bf16 v[32:35], a[168:171], a[88:91], v[32:35]
ds_read_b128 a[184:187], v4 offset:61440
v_cvt_pk_bf16_f32 v62, v36, v37
v_mfma_f32_16x16x32_bf16 v[32:35], a[172:175], a[92:95], v[32:35]
ds_read_b128 a[188:191], v5 offset:61440
v_cvt_pk_bf16_f32 v63, v38, v39
v_mfma_f32_16x16x32_bf16 v[96:99], a[192:195], v[56:59], v[96:99]
ds_read_b64_tr_b16 a[208:209], v10 offset:49152
v_fmamk_f32 v40, v40, 0x3e0293ee, v25
v_mfma_f32_16x16x32_bf16 v[100:103], a[196:199], v[56:59], v[100:103]
v_exp_f32 v40, v40
v_mfma_f32_16x16x32_bf16 v[104:107], a[200:203], v[56:59], v[104:107]
ds_read_b64_tr_b16 a[210:211], v10 offset:53248
v_fmamk_f32 v41, v41, 0x3e0293ee, v25
v_mfma_f32_16x16x32_bf16 v[108:111], a[204:207], v[56:59], v[108:111]
v_exp_f32 v41, v41
v_mfma_f32_16x16x32_bf16 a[224:227], a[244:247], v[56:59], a[224:227]
ds_read_b64_tr_b16 a[212:213], v11 offset:49152
v_fmamk_f32 v42, v42, 0x3e0293ee, v25
v_mfma_f32_16x16x32_bf16 v[36:39], a[160:163], a[96:99], 0
v_exp_f32 v42, v42
v_mfma_f32_16x16x32_bf16 v[36:39], a[164:167], a[100:103], v[36:39]
ds_read_b64_tr_b16 a[214:215], v11 offset:53248
v_fmamk_f32 v43, v43, 0x3e0293ee, v25
v_mfma_f32_16x16x32_bf16 v[36:39], a[168:171], a[104:107], v[36:39]
v_exp_f32 v43, v43
v_mfma_f32_16x16x32_bf16 v[36:39], a[172:175], a[108:111], v[36:39]
ds_read_b64_tr_b16 a[216:217], v12 offset:49152
v_cvt_pk_bf16_f32 v66, v40, v41
v_mfma_f32_16x16x32_bf16 v[128:131], a[192:195], v[60:63], v[128:131]
ds_read_b64_tr_b16 a[218:219], v12 offset:53248
v_cvt_pk_bf16_f32 v67, v42, v43
v_mfma_f32_16x16x32_bf16 v[132:135], a[196:199], v[60:63], v[132:135]
ds_read_b64_tr_b16 a[220:221], v13 offset:49152
v_fmamk_f32 v32, v32, 0x3e0293ee, v23
v_mfma_f32_16x16x32_bf16 v[136:139], a[200:203], v[60:63], v[136:139]
v_exp_f32 v32, v32
v_mfma_f32_16x16x32_bf16 v[140:143], a[204:207], v[60:63], v[140:143]
ds_read_b64_tr_b16 a[222:223], v13 offset:53248
v_fmamk_f32 v33, v33, 0x3e0293ee, v23
v_mfma_f32_16x16x32_bf16 v[40:43], a[160:163], a[112:115], 0
v_exp_f32 v33, v33
v_mfma_f32_16x16x32_bf16 v[40:43], a[164:167], a[116:119], v[40:43]
v_fmamk_f32 v34, v34, 0x3e0293ee, v23
v_fmamk_f32 v35, v35, 0x3e0293ee, v23
v_mfma_f32_16x16x32_bf16 v[40:43], a[168:171], a[120:123], v[40:43]
v_exp_f32 v34, v34
v_mfma_f32_16x16x32_bf16 v[40:43], a[172:175], a[124:127], v[40:43]
v_exp_f32 v35, v35
v_mfma_f32_16x16x32_bf16 v[160:163], a[192:195], v[64:67], v[160:163]
v_cvt_pk_bf16_f32 v68, v32, v33
v_cvt_pk_bf16_f32 v69, v34, v35
v_mfma_f32_16x16x32_bf16 v[164:167], a[196:199], v[64:67], v[164:167]
ds_read_b128 a[160:163], v2 offset:32768
v_fmamk_f32 v36, v36, 0x3e0293ee, v24
v_mfma_f32_16x16x32_bf16 v[168:171], a[200:203], v[64:67], v[168:171]
v_exp_f32 v36, v36
v_mfma_f32_16x16x32_bf16 v[172:175], a[204:207], v[64:67], v[172:175]
ds_read_b128 a[164:167], v3 offset:32768
v_fmamk_f32 v37, v37, 0x3e0293ee, v24
v_mfma_f32_16x16x32_bf16 a[228:231], a[244:247], v[60:63], a[228:231]
s_waitcnt lgkmcnt(2)
v_exp_f32 v37, v37
v_mfma_f32_16x16x32_bf16 v[32:35], a[176:179], a[80:83], 0
v_fmamk_f32 v38, v38, 0x3e0293ee, v24
v_fmamk_f32 v39, v39, 0x3e0293ee, v24
v_mfma_f32_16x16x32_bf16 v[32:35], a[180:183], a[84:87], v[32:35]
v_exp_f32 v38, v38
v_mfma_f32_16x16x32_bf16 v[32:35], a[184:187], a[88:91], v[32:35]
v_exp_f32 v39, v39
v_mfma_f32_16x16x32_bf16 v[32:35], a[188:191], a[92:95], v[32:35]
ds_read_b128 a[168:171], v4 offset:32768
v_cvt_pk_bf16_f32 v72, v36, v37
v_mfma_f32_16x16x32_bf16 v[112:115], a[208:211], v[56:59], v[112:115]
ds_read_b128 a[172:175], v5 offset:32768
v_cvt_pk_bf16_f32 v73, v38, v39
v_mfma_f32_16x16x32_bf16 v[116:119], a[212:215], v[56:59], v[116:119]
ds_read_b64_tr_b16 a[192:193], v6 offset:57344
v_fmamk_f32 v40, v40, 0x3e0293ee, v25
v_mfma_f32_16x16x32_bf16 v[120:123], a[216:219], v[56:59], v[120:123]
v_exp_f32 v40, v40
v_mfma_f32_16x16x32_bf16 v[124:127], a[220:223], v[56:59], v[124:127]
ds_read_b64_tr_b16 a[194:195], v6 offset:61440
v_fmamk_f32 v41, v41, 0x3e0293ee, v25
v_mfma_f32_16x16x32_bf16 v[36:39], a[176:179], a[96:99], 0
v_exp_f32 v41, v41
v_mfma_f32_16x16x32_bf16 v[36:39], a[180:183], a[100:103], v[36:39]
ds_read_b64_tr_b16 a[196:197], v7 offset:57344
v_fmamk_f32 v42, v42, 0x3e0293ee, v25
v_mfma_f32_16x16x32_bf16 v[36:39], a[184:187], a[104:107], v[36:39]
v_exp_f32 v42, v42
v_mfma_f32_16x16x32_bf16 v[36:39], a[188:191], a[108:111], v[36:39]
ds_read_b64_tr_b16 a[198:199], v7 offset:61440
v_fmamk_f32 v43, v43, 0x3e0293ee, v25
v_mfma_f32_16x16x32_bf16 v[144:147], a[208:211], v[60:63], v[144:147]
v_exp_f32 v43, v43
v_mfma_f32_16x16x32_bf16 v[148:151], a[212:215], v[60:63], v[148:151]
ds_read_b64_tr_b16 a[200:201], v8 offset:57344
v_cvt_pk_bf16_f32 v76, v40, v41
v_mfma_f32_16x16x32_bf16 v[152:155], a[216:219], v[60:63], v[152:155]
ds_read_b64_tr_b16 a[202:203], v8 offset:61440
v_cvt_pk_bf16_f32 v77, v42, v43
v_mfma_f32_16x16x32_bf16 v[156:159], a[220:223], v[60:63], v[156:159]
ds_read_b64_tr_b16 a[204:205], v9 offset:57344
v_fmamk_f32 v32, v32, 0x3e0293ee, v23
v_mfma_f32_16x16x32_bf16 a[232:235], a[244:247], v[64:67], a[232:235]
v_exp_f32 v32, v32
v_mfma_f32_16x16x32_bf16 v[40:43], a[176:179], a[112:115], 0
ds_read_b64_tr_b16 a[206:207], v9 offset:61440
v_fmamk_f32 v33, v33, 0x3e0293ee, v23
v_mfma_f32_16x16x32_bf16 v[40:43], a[180:183], a[116:119], v[40:43]
v_exp_f32 v33, v33
v_mfma_f32_16x16x32_bf16 v[40:43], a[184:187], a[120:123], v[40:43]
ds_read_b128 a[176:179], v2 offset:36864
v_fmamk_f32 v34, v34, 0x3e0293ee, v23
v_mfma_f32_16x16x32_bf16 v[40:43], a[188:191], a[124:127], v[40:43]
v_exp_f32 v34, v34
v_mfma_f32_16x16x32_bf16 v[176:179], a[208:211], v[64:67], v[176:179]
ds_read_b128 a[180:183], v3 offset:36864
v_fmamk_f32 v35, v35, 0x3e0293ee, v23
v_mfma_f32_16x16x32_bf16 v[180:183], a[212:215], v[64:67], v[180:183]
v_exp_f32 v35, v35
v_mfma_f32_16x16x32_bf16 v[184:187], a[216:219], v[64:67], v[184:187]
v_cvt_pk_bf16_f32 v70, v32, v33
v_cvt_pk_bf16_f32 v71, v34, v35
v_mfma_f32_16x16x32_bf16 v[188:191], a[220:223], v[64:67], v[188:191]
s_waitcnt lgkmcnt(3)
ds_read_b128 a[184:187], v4 offset:36864
v_fmamk_f32 v36, v36, 0x3e0293ee, v24
v_mfma_f32_16x16x32_bf16 v[32:35], a[160:163], a[128:131], 0
v_exp_f32 v36, v36
v_mfma_f32_16x16x32_bf16 v[32:35], a[164:167], a[132:135], v[32:35]
ds_read_b128 a[188:191], v5 offset:36864
v_fmamk_f32 v37, v37, 0x3e0293ee, v24
v_mfma_f32_16x16x32_bf16 v[32:35], a[168:171], a[136:139], v[32:35]
v_exp_f32 v37, v37
v_mfma_f32_16x16x32_bf16 v[32:35], a[172:175], a[140:143], v[32:35]
ds_read_b64_tr_b16 a[208:209], v10 offset:57344
v_fmamk_f32 v38, v38, 0x3e0293ee, v24
v_mfma_f32_16x16x32_bf16 v[96:99], a[192:195], v[68:71], v[96:99]
v_exp_f32 v38, v38
v_mfma_f32_16x16x32_bf16 v[100:103], a[196:199], v[68:71], v[100:103]
ds_read_b64_tr_b16 a[210:211], v10 offset:61440
v_fmamk_f32 v39, v39, 0x3e0293ee, v24
v_mfma_f32_16x16x32_bf16 v[104:107], a[200:203], v[68:71], v[104:107]
s_waitcnt lgkmcnt(4)
v_exp_f32 v39, v39
v_mfma_f32_16x16x32_bf16 v[108:111], a[204:207], v[68:71], v[108:111]
ds_read_b64_tr_b16 a[212:213], v11 offset:57344
v_cvt_pk_bf16_f32 v74, v36, v37
v_mfma_f32_16x16x32_bf16 a[224:227], a[244:247], v[68:71], a[224:227]
v_cvt_pk_bf16_f32 v75, v38, v39
v_fmamk_f32 v40, v40, 0x3e0293ee, v25
v_mfma_f32_16x16x32_bf16 v[36:39], a[160:163], a[144:147], 0
v_exp_f32 v40, v40
v_mfma_f32_16x16x32_bf16 v[36:39], a[164:167], a[148:151], v[36:39]
ds_read_b64_tr_b16 a[214:215], v11 offset:61440
v_fmamk_f32 v41, v41, 0x3e0293ee, v25
v_mfma_f32_16x16x32_bf16 v[36:39], a[168:171], a[152:155], v[36:39]
ds_read_b64_tr_b16 a[216:217], v12 offset:57344
v_accvgpr_read_b32 v88, a224
v_mfma_f32_16x16x32_bf16 v[36:39], a[172:175], a[156:159], v[36:39]
ds_read_b64_tr_b16 a[218:219], v12 offset:61440
v_cmp_nge_f32 vcc, s34, v88
v_mfma_f32_16x16x32_bf16 v[128:131], a[192:195], v[72:75], v[128:131]
s_or_b64 s[42:43], s[42:43], vcc
v_rcp_f32 v88, v88
v_mfma_f32_16x16x32_bf16 v[132:135], a[196:199], v[72:75], v[132:135]
v_exp_f32 v41, v41
v_mfma_f32_16x16x32_bf16 v[136:139], a[200:203], v[72:75], v[136:139]
ds_read_b64_tr_b16 a[220:221], v13 offset:57344
v_fmamk_f32 v42, v42, 0x3e0293ee, v25
v_mfma_f32_16x16x32_bf16 v[140:143], a[204:207], v[72:75], v[140:143]
v_exp_f32 v42, v42
v_fmamk_f32 v43, v43, 0x3e0293ee, v25
v_mul_f32 v96, v96, v88
v_mul_f32 v97, v97, v88
v_exp_f32 v43, v43
v_mul_f32 v98, v98, v88
v_mul_f32 v99, v99, v88
v_cvt_pk_bf16_f32 v96, v96, v97
v_cvt_pk_bf16_f32 v97, v98, v99
v_mfma_f32_16x16x32_bf16 a[228:231], a[244:247], v[72:75], a[228:231]
ds_write_b64 v20, v[96:97] offset:0
v_cvt_pk_bf16_f32 v78, v40, v41
v_cvt_pk_bf16_f32 v79, v42, v43
v_mul_f32 v100, v100, v88
v_mfma_f32_16x16x32_bf16 v[40:43], a[176:179], a[128:131], 0
v_mul_f32 v101, v101, v88
v_mul_f32 v102, v102, v88
v_mul_f32 v103, v103, v88
v_cvt_pk_bf16_f32 v100, v100, v101
v_cvt_pk_bf16_f32 v101, v102, v103
v_mfma_f32_16x16x32_bf16 v[40:43], a[180:183], a[132:135], v[40:43]
s_waitcnt lgkmcnt(3)
ds_write_b64 v20, v[100:101] offset:32
v_mul_f32 v104, v104, v88
v_mul_f32 v105, v105, v88
v_mfma_f32_16x16x32_bf16 v[40:43], a[184:187], a[136:139], v[40:43]
v_mul_f32 v106, v106, v88
v_mul_f32 v107, v107, v88
v_cvt_pk_bf16_f32 v104, v104, v105
v_cvt_pk_bf16_f32 v105, v106, v107
v_mfma_f32_16x16x32_bf16 v[40:43], a[188:191], a[140:143], v[40:43]
ds_write_b64 v20, v[104:105] offset:64
v_mul_f32 v108, v108, v88
v_mul_f32 v109, v109, v88
v_mul_f32 v110, v110, v88
v_mul_f32 v111, v111, v88
v_cvt_pk_bf16_f32 v108, v108, v109
v_cvt_pk_bf16_f32 v109, v110, v111
v_mfma_f32_16x16x32_bf16 v[160:163], a[192:195], v[76:79], v[160:163]
ds_write_b64 v20, v[108:109] offset:96
ds_read_b64_tr_b16 a[222:223], v13 offset:61440
v_mfma_f32_16x16x32_bf16 v[164:167], a[196:199], v[76:79], v[164:167]
ds_read_b128 a[0:3], v21 offset:0
ds_read_b128 a[4:7], v21 offset:1152
v_mfma_f32_16x16x32_bf16 v[168:171], a[200:203], v[76:79], v[168:171]
v_accvgpr_read_b32 v89, a228
v_cmp_nge_f32 vcc, s34, v89
v_rcp_f32 v89, v89
v_mfma_f32_16x16x32_bf16 v[172:175], a[204:207], v[76:79], v[172:175]
s_or_b64 s[42:43], s[42:43], vcc
v_mul_f32 v128, v128, v89
v_mul_f32 v129, v129, v89
v_mul_f32 v130, v130, v89
v_mul_f32 v131, v131, v89
v_cvt_pk_bf16_f32 v128, v128, v129
v_cvt_pk_bf16_f32 v129, v130, v131
v_mfma_f32_16x16x32_bf16 a[232:235], a[244:247], v[76:79], a[232:235]
ds_write_b64 v20, v[128:129] offset:0
v_mul_f32 v132, v132, v89
v_mfma_f32_16x16x32_bf16 v[112:115], a[208:211], v[68:71], v[112:115]
v_mul_f32 v133, v133, v89
v_mul_f32 v134, v134, v89
v_mul_f32 v135, v135, v89
v_cvt_pk_bf16_f32 v132, v132, v133
v_cvt_pk_bf16_f32 v133, v134, v135
v_mfma_f32_16x16x32_bf16 v[116:119], a[212:215], v[68:71], v[116:119]
s_waitcnt lgkmcnt(6)
ds_write_b64 v20, v[132:133] offset:32
v_mul_f32 v136, v136, v89
v_mul_f32 v137, v137, v89
v_mfma_f32_16x16x32_bf16 v[120:123], a[216:219], v[68:71], v[120:123]
s_waitcnt lgkmcnt(4)
v_fmamk_f32 v32, v32, 0x3e0293ee, v26
v_fmamk_f32 v33, v33, 0x3e0293ee, v26
v_fmamk_f32 v34, v34, 0x3e0293ee, v26
v_exp_f32 v32, v32
v_exp_f32 v33, v33
v_exp_f32 v34, v34
v_fmamk_f32 v35, v35, 0x3e0293ee, v26
v_mul_f32 v138, v138, v89
v_mul_f32 v139, v139, v89
v_exp_f32 v35, v35
v_cvt_pk_bf16_f32 v136, v136, v137
v_cvt_pk_bf16_f32 v137, v138, v139
v_mfma_f32_16x16x32_bf16 v[124:127], a[220:223], v[68:71], v[124:127]
s_waitcnt lgkmcnt(2)
buffer_store_dwordx4 a[0:3], v22, s[16:19], 0 offen offset:0 sc0 sc1 nt
buffer_store_dwordx4 a[4:7], v22, s[16:19], 0 offen offset:2048 sc0 sc1 nt
ds_write_b64 v20, v[136:137] offset:64
v_cvt_pk_bf16_f32 v48, v32, v33
v_cvt_pk_bf16_f32 v49, v34, v35
v_mul_f32 v140, v140, v89
v_mul_f32 v141, v141, v89
v_mul_f32 v142, v142, v89
v_mul_f32 v143, v143, v89
v_cvt_pk_bf16_f32 v140, v140, v141
v_cvt_pk_bf16_f32 v141, v142, v143
v_mfma_f32_16x16x32_bf16 v[32:35], a[176:179], a[144:147], 0
ds_write_b64 v20, v[140:141] offset:96
ds_read_b128 a[160:163], v2 offset:40960
v_mfma_f32_16x16x32_bf16 v[32:35], a[180:183], a[148:151], v[32:35]
ds_read_b128 a[16:19], v21 offset:0
ds_read_b128 a[20:23], v21 offset:1152
ds_read_b128 a[164:167], v3 offset:40960
v_add_u32 v22, s38, v19
v_mfma_f32_16x16x32_bf16 v[32:35], a[184:187], a[152:155], v[32:35]
s_add_u32 s38, s58, 8192
ds_read_b128 a[168:171], v4 offset:40960
v_accvgpr_read_b32 v90, a232
v_cmp_nge_f32 vcc, s34, v90
v_rcp_f32 v90, v90
v_mfma_f32_16x16x32_bf16 v[32:35], a[188:191], a[156:159], v[32:35]
s_or_b64 s[42:43], s[42:43], vcc
ds_read_b128 a[172:175], v5 offset:40960
v_mul_f32 v160, v160, v90
v_mul_f32 v161, v161, v90
v_mul_f32 v162, v162, v90
v_mul_f32 v163, v163, v90
v_cvt_pk_bf16_f32 v160, v160, v161
v_cvt_pk_bf16_f32 v161, v162, v163
v_mfma_f32_16x16x32_bf16 v[144:147], a[208:211], v[72:75], v[144:147]
ds_write_b64 v20, v[160:161] offset:0
v_mul_f32 v164, v164, v90
v_mfma_f32_16x16x32_bf16 v[148:151], a[212:215], v[72:75], v[148:151]
v_mul_f32 v165, v165, v90
v_mul_f32 v166, v166, v90
v_mul_f32 v167, v167, v90
v_cvt_pk_bf16_f32 v164, v164, v165
v_cvt_pk_bf16_f32 v165, v166, v167
v_mfma_f32_16x16x32_bf16 v[152:155], a[216:219], v[72:75], v[152:155]
ds_write_b64 v20, v[164:165] offset:32
v_fmamk_f32 v36, v36, 0x3e0293ee, v27
v_fmamk_f32 v37, v37, 0x3e0293ee, v27
v_fmamk_f32 v38, v38, 0x3e0293ee, v27
v_exp_f32 v36, v36
v_exp_f32 v37, v37
v_exp_f32 v38, v38
v_fmamk_f32 v39, v39, 0x3e0293ee, v27
v_mul_f32 v168, v168, v90
v_mul_f32 v169, v169, v90
v_exp_f32 v39, v39
v_mfma_f32_16x16x32_bf16 v[156:159], a[220:223], v[72:75], v[156:159]
s_waitcnt lgkmcnt(7)
v_cvt_pk_bf16_f32 v52, v36, v37
v_cvt_pk_bf16_f32 v53, v38, v39
v_mul_f32 v170, v170, v90
v_mul_f32 v171, v171, v90
v_cvt_pk_bf16_f32 v168, v168, v169
v_mul_f32 v172, v172, v90
v_cvt_pk_bf16_f32 v169, v170, v171
v_mul_f32 v173, v173, v90
v_mul_f32 v174, v174, v90
v_mul_f32 v175, v175, v90
v_cvt_pk_bf16_f32 v172, v172, v173
v_mul_f32 v112, v112, v88
v_cvt_pk_bf16_f32 v173, v174, v175
v_mul_f32 v113, v113, v88
v_mul_f32 v114, v114, v88
v_mul_f32 v115, v115, v88
v_cvt_pk_bf16_f32 v112, v112, v113
v_cvt_pk_bf16_f32 v113, v114, v115
v_mfma_f32_16x16x32_bf16 v[36:39], a[160:163], a[128:131], 0
s_waitcnt lgkmcnt(4)
buffer_store_dwordx4 a[16:19], v22, s[16:19], 0 offen offset:0 sc0 sc1 nt
buffer_store_dwordx4 a[20:23], v22, s[16:19], 0 offen offset:2048 sc0 sc1 nt
ds_write_b64 v20, v[168:169] offset:64
ds_write_b64 v20, v[172:173] offset:96
ds_read_b128 a[32:35], v21 offset:0
ds_read_b128 a[36:39], v21 offset:1152
ds_write_b64 v20, v[112:113] offset:0
v_mul_f32 v116, v116, v88
v_mfma_f32_16x16x32_bf16 v[36:39], a[164:167], a[132:135], v[36:39]
s_waitcnt lgkmcnt(8)
v_mul_f32 v117, v117, v88
v_mul_f32 v118, v118, v88
v_mul_f32 v119, v119, v88
v_cvt_pk_bf16_f32 v116, v116, v117
v_cvt_pk_bf16_f32 v117, v118, v119
v_mfma_f32_16x16x32_bf16 v[36:39], a[168:171], a[136:139], v[36:39]
s_waitcnt lgkmcnt(7)
ds_write_b64 v20, v[116:117] offset:32
v_add_u32 v22, s38, v19
v_mul_f32 v120, v120, v88
v_mul_f32 v121, v121, v88
v_mfma_f32_16x16x32_bf16 v[36:39], a[172:175], a[140:143], v[36:39]
s_add_u32 s38, s58, 0
v_mul_f32 v122, v122, v88
v_mul_f32 v123, v123, v88
v_cvt_pk_bf16_f32 v120, v120, v121
v_cvt_pk_bf16_f32 v121, v122, v123
v_mfma_f32_16x16x32_bf16 v[176:179], a[208:211], v[76:79], v[176:179]
ds_write_b64 v20, v[120:121] offset:64
ds_read_b64_tr_b16 a[192:193], v6 offset:32768
ds_read_b64_tr_b16 a[194:195], v6 offset:36864
v_mul_f32 v124, v124, v88
v_mul_f32 v125, v125, v88
v_mul_f32 v126, v126, v88
v_mul_f32 v127, v127, v88
v_cvt_pk_bf16_f32 v124, v124, v125
v_cvt_pk_bf16_f32 v125, v126, v127
v_mfma_f32_16x16x32_bf16 v[180:183], a[212:215], v[76:79], v[180:183]
ds_write_b64 v20, v[124:125] offset:96
ds_read_b64_tr_b16 a[196:197], v7 offset:32768
ds_read_b64_tr_b16 a[198:199], v7 offset:36864
v_mfma_f32_16x16x32_bf16 v[184:187], a[216:219], v[76:79], v[184:187]
s_waitcnt lgkmcnt(8)
buffer_store_dwordx4 a[32:35], v22, s[16:19], 0 offen offset:0 sc0 sc1 nt
buffer_store_dwordx4 a[36:39], v22, s[16:19], 0 offen offset:2048 sc0 sc1 nt
ds_read_b128 a[8:11], v21 offset:0
ds_read_b128 a[12:15], v21 offset:1152
ds_read_b64_tr_b16 a[200:201], v8 offset:32768
ds_read_b64_tr_b16 a[202:203], v8 offset:36864
v_add_u32 v22, s38, v19
v_fmamk_f32 v40, v40, 0x3e0293ee, v26
v_fmamk_f32 v41, v41, 0x3e0293ee, v26
v_fmamk_f32 v42, v42, 0x3e0293ee, v26
v_exp_f32 v40, v40
v_exp_f32 v41, v41
v_exp_f32 v42, v42
v_fmamk_f32 v43, v43, 0x3e0293ee, v26
v_exp_f32 v43, v43
v_mfma_f32_16x16x32_bf16 v[188:191], a[220:223], v[76:79], v[188:191]
s_add_u32 s38, s58, 4096
ds_read_b64_tr_b16 a[204:205], v9 offset:32768
ds_read_b64_tr_b16 a[206:207], v9 offset:36864
v_cvt_pk_bf16_f32 v50, v40, v41
v_cvt_pk_bf16_f32 v51, v42, v43
v_mul_f32 v144, v144, v89
v_mul_f32 v145, v145, v89
v_mul_f32 v146, v146, v89
v_mul_f32 v147, v147, v89
v_cvt_pk_bf16_f32 v144, v144, v145
v_cvt_pk_bf16_f32 v145, v146, v147
v_mfma_f32_16x16x32_bf16 v[40:43], a[160:163], a[144:147], 0
ds_write_b64 v20, v[144:145] offset:0
v_mul_f32 v148, v148, v89
v_mfma_f32_16x16x32_bf16 v[40:43], a[164:167], a[148:151], v[40:43]
ds_read_b128 a[176:179], v2 offset:45056
v_mul_f32 v149, v149, v89
v_mul_f32 v150, v150, v89
v_mul_f32 v151, v151, v89
v_cvt_pk_bf16_f32 v148, v148, v149
v_cvt_pk_bf16_f32 v149, v150, v151
v_mfma_f32_16x16x32_bf16 v[40:43], a[168:171], a[152:155], v[40:43]
ds_write_b64 v20, v[148:149] offset:32
ds_read_b128 a[180:183], v3 offset:45056
v_mul_f32 v152, v152, v89
v_mul_f32 v153, v153, v89
v_mfma_f32_16x16x32_bf16 v[40:43], a[172:175], a[156:159], v[40:43]
s_waitcnt lgkmcnt(13)
ds_read_b128 a[184:187], v4 offset:45056
v_mul_f32 v154, v154, v89
v_mul_f32 v155, v155, v89
v_cvt_pk_bf16_f32 v152, v152, v153
v_cvt_pk_bf16_f32 v153, v154, v155
v_mfma_f32_16x16x32_bf16 v[192:195], a[192:195], v[48:51], v[192:195]
s_waitcnt lgkmcnt(11)
ds_write_b64 v20, v[152:153] offset:64
ds_read_b128 a[188:191], v5 offset:45056
v_mul_f32 v156, v156, v89
v_mul_f32 v157, v157, v89
v_mul_f32 v158, v158, v89
v_mul_f32 v159, v159, v89
v_cvt_pk_bf16_f32 v156, v156, v157
v_cvt_pk_bf16_f32 v157, v158, v159
v_mfma_f32_16x16x32_bf16 v[196:199], a[196:199], v[48:51], v[196:199]
s_waitcnt lgkmcnt(9)
buffer_store_dwordx4 a[8:11], v22, s[16:19], 0 offen offset:128 sc0 sc1 nt
buffer_store_dwordx4 a[12:15], v22, s[16:19], 0 offen offset:2176 sc0 sc1 nt
ds_write_b64 v20, v[156:157] offset:96
v_mfma_f32_16x16x32_bf16 v[200:203], a[200:203], v[48:51], v[200:203]
s_waitcnt lgkmcnt(8)
ds_read_b128 a[24:27], v21 offset:0
ds_read_b128 a[28:31], v21 offset:1152
v_add_u32 v22, s38, v19
v_mfma_f32_16x16x32_bf16 v[204:207], a[204:207], v[48:51], v[204:207]
s_add_u32 s38, s58, 8192
v_fmamk_f32 v32, v32, 0x3e0293ee, v27
v_fmamk_f32 v33, v33, 0x3e0293ee, v27
v_fmamk_f32 v34, v34, 0x3e0293ee, v27
v_exp_f32 v32, v32
v_exp_f32 v33, v33
v_exp_f32 v34, v34
v_fmamk_f32 v35, v35, 0x3e0293ee, v27
v_mul_f32 v176, v176, v90
v_mul_f32 v177, v177, v90
v_exp_f32 v35, v35
v_mul_f32 v178, v178, v90
v_mul_f32 v179, v179, v90
v_cvt_pk_bf16_f32 v176, v176, v177
v_cvt_pk_bf16_f32 v177, v178, v179
v_mfma_f32_16x16x32_bf16 a[236:239], a[244:247], v[48:51], a[236:239]
s_waitcnt lgkmcnt(8)
ds_write_b64 v20, v[176:177] offset:0
v_cvt_pk_bf16_f32 v54, v32, v33
v_cvt_pk_bf16_f32 v55, v34, v35
v_mul_f32 v180, v180, v90
v_mfma_f32_16x16x32_bf16 v[32:35], a[176:179], a[128:131], 0
s_waitcnt lgkmcnt(7)
v_mul_f32 v181, v181, v90
v_mul_f32 v182, v182, v90
v_mul_f32 v183, v183, v90
v_cvt_pk_bf16_f32 v180, v180, v181
v_cvt_pk_bf16_f32 v181, v182, v183
v_mfma_f32_16x16x32_bf16 v[32:35], a[180:183], a[132:135], v[32:35]
s_waitcnt lgkmcnt(6)
ds_write_b64 v20, v[180:181] offset:32
v_mul_f32 v184, v184, v90
v_mul_f32 v185, v185, v90
v_mfma_f32_16x16x32_bf16 v[32:35], a[184:187], a[136:139], v[32:35]
s_waitcnt lgkmcnt(5)
v_mul_f32 v186, v186, v90
v_mul_f32 v187, v187, v90
v_cvt_pk_bf16_f32 v184, v184, v185
v_cvt_pk_bf16_f32 v185, v186, v187
v_mfma_f32_16x16x32_bf16 v[32:35], a[188:191], a[140:143], v[32:35]
ds_write_b64 v20, v[184:185] offset:64
v_mul_f32 v188, v188, v90
v_mul_f32 v189, v189, v90
v_mul_f32 v190, v190, v90
v_mul_f32 v191, v191, v90
v_cvt_pk_bf16_f32 v188, v188, v189
v_cvt_pk_bf16_f32 v189, v190, v191
v_mfma_f32_16x16x32_bf16 v[224:227], a[192:195], v[52:55], v[224:227]
s_waitcnt lgkmcnt(3)
buffer_store_dwordx4 a[24:27], v22, s[16:19], 0 offen offset:128 sc0 sc1 nt
buffer_store_dwordx4 a[28:31], v22, s[16:19], 0 offen offset:2176 sc0 sc1 nt
ds_write_b64 v20, v[188:189] offset:96
ds_read_b64_tr_b16 a[208:209], v10 offset:32768
ds_read_b64_tr_b16 a[210:211], v10 offset:36864
v_mfma_f32_16x16x32_bf16 v[228:231], a[196:199], v[52:55], v[228:231]
ds_read_b128 a[40:43], v21 offset:0
ds_read_b128 a[44:47], v21 offset:1152
ds_read_b64_tr_b16 a[212:213], v11 offset:32768
ds_read_b64_tr_b16 a[214:215], v11 offset:36864
v_add_u32 v22, s38, v19
v_mfma_f32_16x16x32_bf16 v[232:235], a[200:203], v[52:55], v[232:235]
s_add_u32 s38, s58, 12288
ds_read_b64_tr_b16 a[216:217], v12 offset:32768
ds_read_b64_tr_b16 a[218:219], v12 offset:36864
v_fmamk_f32 v36, v36, 0x3e0293ee, v26
v_fmamk_f32 v37, v37, 0x3e0293ee, v26
v_fmamk_f32 v38, v38, 0x3e0293ee, v26
v_exp_f32 v36, v36
v_exp_f32 v37, v37
v_exp_f32 v38, v38
v_fmamk_f32 v39, v39, 0x3e0293ee, v26
v_exp_f32 v39, v39
v_mfma_f32_16x16x32_bf16 v[236:239], a[204:207], v[52:55], v[236:239]
ds_read_b64_tr_b16 a[220:221], v13 offset:32768
ds_read_b64_tr_b16 a[222:223], v13 offset:36864
v_cvt_pk_bf16_f32 v56, v36, v37
v_cvt_pk_bf16_f32 v57, v38, v39
v_mfma_f32_16x16x32_bf16 v[36:39], a[176:179], a[144:147], 0
ds_read_b128 a[160:163], v2 offset:49152
v_fmamk_f32 v40, v40, 0x3e0293ee, v27
v_mfma_f32_16x16x32_bf16 v[36:39], a[180:183], a[148:151], v[36:39]
ds_read_b128 a[164:167], v3 offset:49152
v_fmamk_f32 v41, v41, 0x3e0293ee, v27
v_mfma_f32_16x16x32_bf16 v[36:39], a[184:187], a[152:155], v[36:39]
ds_read_b128 a[168:171], v4 offset:49152
v_fmamk_f32 v42, v42, 0x3e0293ee, v27
v_mfma_f32_16x16x32_bf16 v[36:39], a[188:191], a[156:159], v[36:39]
s_waitcnt lgkmcnt(10)
buffer_store_dwordx4 a[40:43], v22, s[16:19], 0 offen offset:128 sc0 sc1 nt
v_fmamk_f32 v43, v43, 0x3e0293ee, v27
v_mfma_f32_16x16x32_bf16 v[208:211], a[208:211], v[48:51], v[208:211]
s_waitcnt lgkmcnt(7)
buffer_store_dwordx4 a[44:47], v22, s[16:19], 0 offen offset:2176 sc0 sc1 nt
ds_read_b128 a[172:175], v5 offset:49152
v_mfma_f32_16x16x32_bf16 v[212:215], a[212:215], v[48:51], v[212:215]
s_waitcnt lgkmcnt(6)
v_exp_f32 v40, v40
v_mfma_f32_16x16x32_bf16 v[216:219], a[216:219], v[48:51], v[216:219]
s_waitcnt lgkmcnt(4)
v_exp_f32 v41, v41
v_mfma_f32_16x16x32_bf16 v[220:223], a[220:223], v[48:51], v[220:223]
v_exp_f32 v42, v42
v_exp_f32 v43, v43
v_mfma_f32_16x16x32_bf16 a[240:243], a[244:247], v[52:55], a[240:243]
s_waitcnt lgkmcnt(3)
v_cvt_pk_bf16_f32 v60, v40, v41
v_cvt_pk_bf16_f32 v61, v42, v43
v_mfma_f32_16x16x32_bf16 v[40:43], a[160:163], a[128:131], 0
s_waitcnt lgkmcnt(2)
ds_read_b64_tr_b16 a[192:193], v6 offset:40960
v_fmamk_f32 v32, v32, 0x3e0293ee, v26
v_mfma_f32_16x16x32_bf16 v[40:43], a[164:167], a[132:135], v[40:43]
s_waitcnt lgkmcnt(2)
ds_read_b64_tr_b16 a[194:195], v6 offset:45056
v_fmamk_f32 v33, v33, 0x3e0293ee, v26
v_mfma_f32_16x16x32_bf16 v[40:43], a[168:171], a[136:139], v[40:43]
s_waitcnt lgkmcnt(2)
ds_read_b64_tr_b16 a[196:197], v7 offset:40960
v_fmamk_f32 v34, v34, 0x3e0293ee, v26
v_mfma_f32_16x16x32_bf16 v[40:43], a[172:175], a[140:143], v[40:43]
ds_read_b64_tr_b16 a[198:199], v7 offset:45056
v_fmamk_f32 v35, v35, 0x3e0293ee, v26
v_mfma_f32_16x16x32_bf16 v[240:243], a[208:211], v[52:55], v[240:243]
v_exp_f32 v32, v32
v_mfma_f32_16x16x32_bf16 v[244:247], a[212:215], v[52:55], v[244:247]
v_exp_f32 v33, v33
v_mfma_f32_16x16x32_bf16 v[248:251], a[216:219], v[52:55], v[248:251]
ds_read_b64_tr_b16 a[200:201], v8 offset:40960
ds_read_b64_tr_b16 a[202:203], v8 offset:45056
v_exp_f32 v34, v34
v_exp_f32 v35, v35
v_mfma_f32_16x16x32_bf16 v[252:255], a[220:223], v[52:55], v[252:255]
ds_read_b64_tr_b16 a[204:205], v9 offset:40960
ds_read_b64_tr_b16 a[206:207], v9 offset:45056
v_cvt_pk_bf16_f32 v58, v32, v33
v_cvt_pk_bf16_f32 v59, v34, v35
v_mfma_f32_16x16x32_bf16 v[32:35], a[160:163], a[144:147], 0
ds_read_b128 a[176:179], v2 offset:53248
v_fmamk_f32 v36, v36, 0x3e0293ee, v27
v_mfma_f32_16x16x32_bf16 v[32:35], a[164:167], a[148:151], v[32:35]
ds_read_b128 a[180:183], v3 offset:53248
v_fmamk_f32 v37, v37, 0x3e0293ee, v27
v_mfma_f32_16x16x32_bf16 v[32:35], a[168:171], a[152:155], v[32:35]
ds_read_b128 a[184:187], v4 offset:53248
v_fmamk_f32 v38, v38, 0x3e0293ee, v27
v_mfma_f32_16x16x32_bf16 v[32:35], a[172:175], a[156:159], v[32:35]
s_waitcnt lgkmcnt(7)
ds_read_b128 a[188:191], v5 offset:53248
v_fmamk_f32 v39, v39, 0x3e0293ee, v27
v_mfma_f32_16x16x32_bf16 v[192:195], a[192:195], v[56:59], v[192:195]
L_pad1_13:
s_cbranch_execz L_back
v_exp_f32 v36, v36
v_mfma_f32_16x16x32_bf16 v[196:199], a[196:199], v[56:59], v[196:199]
s_waitcnt lgkmcnt(6)
v_exp_f32 v37, v37
v_mfma_f32_16x16x32_bf16 v[200:203], a[200:203], v[56:59], v[200:203]
s_waitcnt lgkmcnt(4)
v_exp_f32 v38, v38
v_mfma_f32_16x16x32_bf16 v[204:207], a[204:207], v[56:59], v[204:207]
v_exp_f32 v39, v39
v_mfma_f32_16x16x32_bf16 a[236:239], a[244:247], v[56:59], a[236:239]
s_waitcnt lgkmcnt(3)
v_cvt_pk_bf16_f32 v62, v36, v37
v_cvt_pk_bf16_f32 v63, v38, v39
v_mfma_f32_16x16x32_bf16 v[36:39], a[176:179], a[128:131], 0
s_waitcnt lgkmcnt(2)
ds_read_b64_tr_b16 a[208:209], v10 offset:40960
v_fmamk_f32 v40, v40, 0x3e0293ee, v26
v_mfma_f32_16x16x32_bf16 v[36:39], a[180:183], a[132:135], v[36:39]
s_waitcnt lgkmcnt(2)
ds_read_b64_tr_b16 a[210:211], v10 offset:45056
v_fmamk_f32 v41, v41, 0x3e0293ee, v26
v_mfma_f32_16x16x32_bf16 v[36:39], a[184:187], a[136:139], v[36:39]
s_waitcnt lgkmcnt(2)
ds_read_b64_tr_b16 a[212:213], v11 offset:40960
v_fmamk_f32 v42, v42, 0x3e0293ee, v26
v_mfma_f32_16x16x32_bf16 v[36:39], a[188:191], a[140:143], v[36:39]
ds_read_b64_tr_b16 a[214:215], v11 offset:45056
v_fmamk_f32 v43, v43, 0x3e0293ee, v26
v_mfma_f32_16x16x32_bf16 v[224:227], a[192:195], v[60:63], v[224:227]
v_exp_f32 v40, v40
v_mfma_f32_16x16x32_bf16 v[228:231], a[196:199], v[60:63], v[228:231]
v_exp_f32 v41, v41
v_mfma_f32_16x16x32_bf16 v[232:235], a[200:203], v[60:63], v[232:235]
ds_read_b64_tr_b16 a[216:217], v12 offset:40960
ds_read_b64_tr_b16 a[218:219], v12 offset:45056
v_exp_f32 v42, v42
v_exp_f32 v43, v43
v_mfma_f32_16x16x32_bf16 v[236:239], a[204:207], v[60:63], v[236:239]
ds_read_b64_tr_b16 a[220:221], v13 offset:40960
ds_read_b64_tr_b16 a[222:223], v13 offset:45056
v_cvt_pk_bf16_f32 v64, v40, v41
v_cvt_pk_bf16_f32 v65, v42, v43
v_mfma_f32_16x16x32_bf16 v[40:43], a[176:179], a[144:147], 0
ds_read_b128 a[160:163], v2 offset:57344
v_fmamk_f32 v32, v32, 0x3e0293ee, v27
v_mfma_f32_16x16x32_bf16 v[40:43], a[180:183], a[148:151], v[40:43]
ds_read_b128 a[164:167], v3 offset:57344
v_fmamk_f32 v33, v33, 0x3e0293ee, v27
v_mfma_f32_16x16x32_bf16 v[40:43], a[184:187], a[152:155], v[40:43]
ds_read_b128 a[168:171], v4 offset:57344
v_fmamk_f32 v34, v34, 0x3e0293ee, v27
v_mfma_f32_16x16x32_bf16 v[40:43], a[188:191], a[156:159], v[40:43]
s_waitcnt lgkmcnt(7)
ds_read_b128 a[172:175], v5 offset:57344
v_fmamk_f32 v35, v35, 0x3e0293ee, v27
v_mfma_f32_16x16x32_bf16 v[208:211], a[208:211], v[56:59], v[208:211]
v_exp_f32 v32, v32
v_mfma_f32_16x16x32_bf16 v[212:215], a[212:215], v[56:59], v[212:215]
s_waitcnt lgkmcnt(6)
v_exp_f32 v33, v33
v_mfma_f32_16x16x32_bf16 v[216:219], a[216:219], v[56:59], v[216:219]
s_waitcnt lgkmcnt(4)
v_exp_f32 v34, v34
v_mfma_f32_16x16x32_bf16 v[220:223], a[220:223], v[56:59], v[220:223]
v_exp_f32 v35, v35
v_mfma_f32_16x16x32_bf16 a[240:243], a[244:247], v[60:63], a[240:243]
s_waitcnt lgkmcnt(3)
v_cvt_pk_bf16_f32 v68, v32, v33
v_cvt_pk_bf16_f32 v69, v34, v35
v_mfma_f32_16x16x32_bf16 v[32:35], a[160:163], a[128:131], 0
s_waitcnt lgkmcnt(2)
ds_read_b64_tr_b16 a[192:193], v6 offset:49152
v_fmamk_f32 v36, v36, 0x3e0293ee, v26
v_mfma_f32_16x16x32_bf16 v[32:35], a[164:167], a[132:135], v[32:35]
s_waitcnt lgkmcnt(2)
ds_read_b64_tr_b16 a[194:195], v6 offset:53248
v_fmamk_f32 v37, v37, 0x3e0293ee, v26
v_mfma_f32_16x16x32_bf16 v[32:35], a[168:171], a[136:139], v[32:35]
s_waitcnt lgkmcnt(2)
ds_read_b64_tr_b16 a[196:197], v7 offset:49152
v_fmamk_f32 v38, v38, 0x3e0293ee, v26
v_mfma_f32_16x16x32_bf16 v[32:35], a[172:175], a[140:143], v[32:35]
ds_read_b64_tr_b16 a[198:199], v7 offset:53248
v_fmamk_f32 v39, v39, 0x3e0293ee, v26
v_mfma_f32_16x16x32_bf16 v[240:243], a[208:211], v[60:63], v[240:243]
v_exp_f32 v36, v36
v_mfma_f32_16x16x32_bf16 v[244:247], a[212:215], v[60:63], v[244:247]
v_exp_f32 v37, v37
v_mfma_f32_16x16x32_bf16 v[248:251], a[216:219], v[60:63], v[248:251]
ds_read_b64_tr_b16 a[200:201], v8 offset:49152
ds_read_b64_tr_b16 a[202:203], v8 offset:53248
v_exp_f32 v38, v38
v_exp_f32 v39, v39
v_mfma_f32_16x16x32_bf16 v[252:255], a[220:223], v[60:63], v[252:255]
ds_read_b64_tr_b16 a[204:205], v9 offset:49152
ds_read_b64_tr_b16 a[206:207], v9 offset:53248
v_cvt_pk_bf16_f32 v66, v36, v37
v_cvt_pk_bf16_f32 v67, v38, v39
v_mfma_f32_16x16x32_bf16 v[36:39], a[160:163], a[144:147], 0
ds_read_b128 a[176:179], v2 offset:61440
v_fmamk_f32 v40, v40, 0x3e0293ee, v27
v_mfma_f32_16x16x32_bf16 v[36:39], a[164:167], a[148:151], v[36:39]
ds_read_b128 a[180:183], v3 offset:61440
v_fmamk_f32 v41, v41, 0x3e0293ee, v27
v_mfma_f32_16x16x32_bf16 v[36:39], a[168:171], a[152:155], v[36:39]
ds_read_b128 a[184:187], v4 offset:61440
v_fmamk_f32 v42, v42, 0x3e0293ee, v27
v_mfma_f32_16x16x32_bf16 v[36:39], a[172:175], a[156:159], v[36:39]
s_waitcnt lgkmcnt(7)
ds_read_b128 a[188:191], v5 offset:61440
v_fmamk_f32 v43, v43, 0x3e0293ee, v27
v_mfma_f32_16x16x32_bf16 v[192:195], a[192:195], v[64:67], v[192:195]
v_exp_f32 v40, v40
v_mfma_f32_16x16x32_bf16 v[196:199], a[196:199], v[64:67], v[196:199]
s_waitcnt lgkmcnt(6)
v_exp_f32 v41, v41
v_mfma_f32_16x16x32_bf16 v[200:203], a[200:203], v[64:67], v[200:203]
s_waitcnt lgkmcnt(4)
v_exp_f32 v42, v42
v_mfma_f32_16x16x32_bf16 v[204:207], a[204:207], v[64:67], v[204:207]
v_exp_f32 v43, v43
v_mfma_f32_16x16x32_bf16 a[236:239], a[244:247], v[64:67], a[236:239]
s_waitcnt lgkmcnt(3)
v_cvt_pk_bf16_f32 v70, v40, v41
v_cvt_pk_bf16_f32 v71, v42, v43
v_mfma_f32_16x16x32_bf16 v[40:43], a[176:179], a[128:131], 0
s_waitcnt lgkmcnt(2)
ds_read_b64_tr_b16 a[208:209], v10 offset:49152
v_fmamk_f32 v32, v32, 0x3e0293ee, v26
v_mfma_f32_16x16x32_bf16 v[40:43], a[180:183], a[132:135], v[40:43]
s_waitcnt lgkmcnt(2)
ds_read_b64_tr_b16 a[210:211], v10 offset:53248
v_fmamk_f32 v33, v33, 0x3e0293ee, v26
v_mfma_f32_16x16x32_bf16 v[40:43], a[184:187], a[136:139], v[40:43]
s_waitcnt lgkmcnt(2)
ds_read_b64_tr_b16 a[212:213], v11 offset:49152
v_fmamk_f32 v34, v34, 0x3e0293ee, v26
v_mfma_f32_16x16x32_bf16 v[40:43], a[188:191], a[140:143], v[40:43]
ds_read_b64_tr_b16 a[214:215], v11 offset:53248
v_fmamk_f32 v35, v35, 0x3e0293ee, v26
v_mfma_f32_16x16x32_bf16 v[224:227], a[192:195], v[68:71], v[224:227]
v_exp_f32 v32, v32
v_mfma_f32_16x16x32_bf16 v[228:231], a[196:199], v[68:71], v[228:231]
v_exp_f32 v33, v33
v_mfma_f32_16x16x32_bf16 v[232:235], a[200:203], v[68:71], v[232:235]
ds_read_b64_tr_b16 a[216:217], v12 offset:49152
ds_read_b64_tr_b16 a[218:219], v12 offset:53248
v_exp_f32 v34, v34
v_exp_f32 v35, v35
v_mfma_f32_16x16x32_bf16 v[236:239], a[204:207], v[68:71], v[236:239]
ds_read_b64_tr_b16 a[220:221], v13 offset:49152
ds_read_b64_tr_b16 a[222:223], v13 offset:53248
v_cvt_pk_bf16_f32 v72, v32, v33
v_cvt_pk_bf16_f32 v73, v34, v35
v_mfma_f32_16x16x32_bf16 v[32:35], a[176:179], a[144:147], 0
ds_read_b64_tr_b16 a[192:193], v6 offset:57344
v_fmamk_f32 v40, v40, 0x3e0293ee, v26
v_mfma_f32_16x16x32_bf16 v[32:35], a[180:183], a[148:151], v[32:35]
ds_read_b64_tr_b16 a[194:195], v6 offset:61440
v_fmamk_f32 v41, v41, 0x3e0293ee, v26
v_mfma_f32_16x16x32_bf16 v[32:35], a[184:187], a[152:155], v[32:35]
ds_read_b64_tr_b16 a[196:197], v7 offset:57344
v_fmamk_f32 v42, v42, 0x3e0293ee, v26
v_mfma_f32_16x16x32_bf16 v[32:35], a[188:191], a[156:159], v[32:35]
s_waitcnt lgkmcnt(7)
ds_read_b64_tr_b16 a[198:199], v7 offset:61440
v_fmamk_f32 v43, v43, 0x3e0293ee, v26
v_mfma_f32_16x16x32_bf16 v[208:211], a[208:211], v[64:67], v[208:211]
ds_read_b64_tr_b16 a[200:201], v8 offset:57344
v_fmamk_f32 v36, v36, 0x3e0293ee, v27
v_mfma_f32_16x16x32_bf16 v[212:215], a[212:215], v[64:67], v[212:215]
s_waitcnt lgkmcnt(7)
ds_read_b64_tr_b16 a[202:203], v8 offset:61440
v_fmamk_f32 v37, v37, 0x3e0293ee, v27
v_mfma_f32_16x16x32_bf16 v[216:219], a[216:219], v[64:67], v[216:219]
s_waitcnt lgkmcnt(6)
ds_read_b64_tr_b16 a[204:205], v9 offset:57344
v_fmamk_f32 v38, v38, 0x3e0293ee, v27
v_mfma_f32_16x16x32_bf16 v[220:223], a[220:223], v[64:67], v[220:223]
ds_read_b64_tr_b16 a[206:207], v9 offset:61440
v_fmamk_f32 v39, v39, 0x3e0293ee, v27
v_mfma_f32_16x16x32_bf16 a[240:243], a[244:247], v[68:71], a[240:243]
v_exp_f32 v40, v40
v_mfma_f32_16x16x32_bf16 v[240:243], a[208:211], v[68:71], v[240:243]
v_exp_f32 v41, v41
v_mfma_f32_16x16x32_bf16 v[244:247], a[212:215], v[68:71], v[244:247]
v_exp_f32 v42, v42
v_exp_f32 v43, v43
v_mfma_f32_16x16x32_bf16 v[248:251], a[216:219], v[68:71], v[248:251]
v_cvt_pk_bf16_f32 v74, v40, v41
v_cvt_pk_bf16_f32 v75, v42, v43
v_mfma_f32_16x16x32_bf16 v[252:255], a[220:223], v[68:71], v[252:255]
s_waitcnt lgkmcnt(3)
v_exp_f32 v36, v36
v_mfma_f32_16x16x32_bf16 v[192:195], a[192:195], v[72:75], v[192:195]
v_exp_f32 v37, v37
v_mfma_f32_16x16x32_bf16 v[196:199], a[196:199], v[72:75], v[196:199]
s_waitcnt lgkmcnt(1)
v_exp_f32 v38, v38
v_mfma_f32_16x16x32_bf16 v[200:203], a[200:203], v[72:75], v[200:203]
s_waitcnt lgkmcnt(0)
ds_read_b64_tr_b16 a[208:209], v10 offset:57344
ds_read_b64_tr_b16 a[210:211], v10 offset:61440
v_exp_f32 v39, v39
v_fmamk_f32 v32, v32, 0x3e0293ee, v27
v_fmamk_f32 v33, v33, 0x3e0293ee, v27
v_fmamk_f32 v34, v34, 0x3e0293ee, v27
v_exp_f32 v32, v32
v_exp_f32 v33, v33
v_exp_f32 v34, v34
v_fmamk_f32 v35, v35, 0x3e0293ee, v27
v_exp_f32 v35, v35
v_mfma_f32_16x16x32_bf16 v[204:207], a[204:207], v[72:75], v[204:207]
ds_read_b64_tr_b16 a[212:213], v11 offset:57344
ds_read_b64_tr_b16 a[214:215], v11 offset:61440
v_cvt_pk_bf16_f32 v76, v36, v37
v_cvt_pk_bf16_f32 v77, v38, v39
v_cvt_pk_bf16_f32 v78, v32, v33
v_cvt_pk_bf16_f32 v79, v34, v35
v_mfma_f32_16x16x32_bf16 a[236:239], a[244:247], v[72:75], a[236:239]
ds_read_b64_tr_b16 a[216:217], v12 offset:57344
ds_read_b64_tr_b16 a[218:219], v12 offset:61440
v_mfma_f32_16x16x32_bf16 v[224:227], a[192:195], v[76:79], v[224:227]
ds_read_b64_tr_b16 a[220:221], v13 offset:57344
ds_read_b64_tr_b16 a[222:223], v13 offset:61440
v_mfma_f32_16x16x32_bf16 v[228:231], a[196:199], v[76:79], v[228:231]
v_add_u32 v22, s38, v19
v_mfma_f32_16x16x32_bf16 v[232:235], a[200:203], v[76:79], v[232:235]
s_mov_b32 s38, s73
v_accvgpr_read_b32 v91, a236
v_cmp_nge_f32 vcc, s34, v91
v_rcp_f32 v91, v91
v_mfma_f32_16x16x32_bf16 v[236:239], a[204:207], v[76:79], v[236:239]
s_or_b64 s[42:43], s[42:43], vcc
v_mul_f32 v192, v192, v91
v_mul_f32 v193, v193, v91
v_mul_f32 v194, v194, v91
v_mul_f32 v195, v195, v91
v_cvt_pk_bf16_f32 v192, v192, v193
v_mul_f32 v196, v196, v91
v_cvt_pk_bf16_f32 v193, v194, v195
v_mul_f32 v197, v197, v91
v_mul_f32 v198, v198, v91
v_mul_f32 v199, v199, v91
v_cvt_pk_bf16_f32 v196, v196, v197
v_mul_f32 v200, v200, v91
v_cvt_pk_bf16_f32 v197, v198, v199
v_mul_f32 v201, v201, v91
v_mul_f32 v202, v202, v91
v_mul_f32 v203, v203, v91
v_cvt_pk_bf16_f32 v200, v200, v201
v_mul_f32 v204, v204, v91
v_cvt_pk_bf16_f32 v201, v202, v203
v_mul_f32 v205, v205, v91
v_mul_f32 v206, v206, v91
v_mul_f32 v207, v207, v91
v_cvt_pk_bf16_f32 v204, v204, v205
v_cvt_pk_bf16_f32 v205, v206, v207
v_mfma_f32_16x16x32_bf16 a[240:243], a[244:247], v[76:79], a[240:243]
s_waitcnt lgkmcnt(6)
ds_write_b64 v20, v[192:193] offset:0
ds_write_b64 v20, v[196:197] offset:32
ds_write_b64 v20, v[200:201] offset:64
ds_write_b64 v20, v[204:205] offset:96
ds_read_b128 a[48:51], v21 offset:0
ds_read_b128 a[52:55], v21 offset:1152
v_mfma_f32_16x16x32_bf16 v[208:211], a[208:211], v[72:75], v[208:211]
s_waitcnt lgkmcnt(10)
v_mfma_f32_16x16x32_bf16 v[212:215], a[212:215], v[72:75], v[212:215]
s_waitcnt lgkmcnt(8)
v_mfma_f32_16x16x32_bf16 v[216:219], a[216:219], v[72:75], v[216:219]
s_waitcnt lgkmcnt(6)
v_accvgpr_read_b32 v92, a240
v_cmp_nge_f32 vcc, s34, v92
v_rcp_f32 v92, v92
v_mfma_f32_16x16x32_bf16 v[220:223], a[220:223], v[72:75], v[220:223]
s_or_b64 s[42:43], s[42:43], vcc
v_mul_f32 v224, v224, v92
v_mul_f32 v225, v225, v92
v_mul_f32 v226, v226, v92
v_mul_f32 v227, v227, v92
v_cvt_pk_bf16_f32 v224, v224, v225
v_mul_f32 v228, v228, v92
v_cvt_pk_bf16_f32 v225, v226, v227
v_mul_f32 v229, v229, v92
v_mul_f32 v230, v230, v92
v_mul_f32 v231, v231, v92
v_cvt_pk_bf16_f32 v228, v228, v229
v_mul_f32 v232, v232, v92
v_cvt_pk_bf16_f32 v229, v230, v231
v_mul_f32 v233, v233, v92
v_mul_f32 v234, v234, v92
v_mul_f32 v235, v235, v92
v_cvt_pk_bf16_f32 v232, v232, v233
v_mul_f32 v236, v236, v92
v_cvt_pk_bf16_f32 v233, v234, v235
v_mul_f32 v237, v237, v92
v_mul_f32 v238, v238, v92
v_mul_f32 v239, v239, v92
v_cvt_pk_bf16_f32 v236, v236, v237
v_mul_f32 v208, v208, v91
v_cvt_pk_bf16_f32 v237, v238, v239
v_mul_f32 v209, v209, v91
v_mul_f32 v210, v210, v91
v_mul_f32 v211, v211, v91
v_cvt_pk_bf16_f32 v208, v208, v209
v_cvt_pk_bf16_f32 v209, v210, v211
v_mfma_f32_16x16x32_bf16 v[240:243], a[208:211], v[76:79], v[240:243]
ds_write_b64 v20, v[224:225] offset:0
ds_write_b64 v20, v[228:229] offset:32
ds_write_b64 v20, v[232:233] offset:64
ds_write_b64 v20, v[236:237] offset:96
ds_read_b128 a[64:67], v21 offset:0
ds_read_b128 a[68:71], v21 offset:1152
ds_write_b64 v20, v[208:209] offset:0
v_mul_f32 v212, v212, v91
v_mul_f32 v213, v213, v91
v_mul_f32 v214, v214, v91
v_mul_f32 v215, v215, v91
v_cvt_pk_bf16_f32 v212, v212, v213
v_cvt_pk_bf16_f32 v213, v214, v215
v_mfma_f32_16x16x32_bf16 v[244:247], a[212:215], v[76:79], v[244:247]
s_waitcnt lgkmcnt(7)
ds_write_b64 v20, v[212:213] offset:32
buffer_store_dwordx4 a[48:51], v22, s[16:19], 0 offen offset:0 sc0 sc1 nt
buffer_store_dwordx4 a[52:55], v22, s[16:19], 0 offen offset:2048 sc0 sc1 nt
v_mul_f32 v216, v216, v91
v_mul_f32 v217, v217, v91
v_mul_f32 v218, v218, v91
v_mul_f32 v219, v219, v91
v_cvt_pk_bf16_f32 v216, v216, v217
v_add_u32 v22, s38, v19
v_cvt_pk_bf16_f32 v217, v218, v219
v_mfma_f32_16x16x32_bf16 v[248:251], a[216:219], v[76:79], v[248:251]
s_add_u32 s38, s58, 12288
ds_write_b64 v20, v[216:217] offset:64
v_mul_f32 v220, v220, v91
v_mul_f32 v221, v221, v91
v_mul_f32 v222, v222, v91
v_mul_f32 v223, v223, v91
v_cvt_pk_bf16_f32 v220, v220, v221
v_cvt_pk_bf16_f32 v221, v222, v223
v_mfma_f32_16x16x32_bf16 v[252:255], a[220:223], v[76:79], v[252:255]
s_waitcnt lgkmcnt(3)
buffer_store_dwordx4 a[64:67], v22, s[16:19], 0 offen offset:0 sc0 sc1 nt
buffer_store_dwordx4 a[68:71], v22, s[16:19], 0 offen offset:2048 sc0 sc1 nt
ds_write_b64 v20, v[220:221] offset:96
ds_read_b128 a[56:59], v21 offset:0
ds_read_b128 a[60:63], v21 offset:1152
v_add_u32 v22, s38, v19
v_mul_f32 v240, v240, v92
v_mul_f32 v241, v241, v92
v_mul_f32 v242, v242, v92
v_mul_f32 v243, v243, v92
v_cvt_pk_bf16_f32 v240, v240, v241
v_cvt_pk_bf16_f32 v241, v242, v243
v_mul_f32 v244, v244, v92
ds_write_b64 v20, v[240:241] offset:0
v_mul_f32 v245, v245, v92
v_mul_f32 v246, v246, v92
v_mul_f32 v247, v247, v92
v_cvt_pk_bf16_f32 v244, v244, v245
v_cvt_pk_bf16_f32 v245, v246, v247
v_mul_f32 v248, v248, v92
ds_write_b64 v20, v[244:245] offset:32
v_mul_f32 v249, v249, v92
v_mul_f32 v250, v250, v92
v_mul_f32 v251, v251, v92
v_cvt_pk_bf16_f32 v248, v248, v249
v_cvt_pk_bf16_f32 v249, v250, v251
v_mul_f32 v252, v252, v92
ds_write_b64 v20, v[248:249] offset:64
v_mul_f32 v253, v253, v92
v_mul_f32 v254, v254, v92
v_mul_f32 v255, v255, v92
s_waitcnt lgkmcnt(4)
buffer_store_dwordx4 a[56:59], v22, s[16:19], 0 offen offset:128 sc0 sc1 nt
s_waitcnt lgkmcnt(3)
buffer_store_dwordx4 a[60:63], v22, s[16:19], 0 offen offset:2176 sc0 sc1 nt
v_cvt_pk_bf16_f32 v252, v252, v253
v_cvt_pk_bf16_f32 v253, v254, v255
s_mov_b32 s38, s73
ds_write_b64 v20, v[252:253] offset:96
ds_read_b128 a[72:75], v21 offset:0
ds_read_b128 a[76:79], v21 offset:1152
v_add_u32 v22, s38, v19
s_waitcnt lgkmcnt(1)
buffer_store_dwordx4 a[72:75], v22, s[16:19], 0 offen offset:128 sc0 sc1 nt
s_waitcnt lgkmcnt(0)
buffer_store_dwordx4 a[76:79], v22, s[16:19], 0 offen offset:2176 sc0 sc1 nt
s_or_b64 s[44:45], s[40:41], s[42:43]
s_cbranch_scc1 L_redo
s_endpgm
L_fast_end:
L_redo:
s_waitcnt vmcnt(0) lgkmcnt(0)
v_and_b32 v28, 15, v0
v_bfe_u32 v29, v0, 4, 2
v_lshrrev_b32 v93, 2, v28
v_lshl_add_u32 v93, v29, 2, v93
v_and_b32 v94, 7, v93
v_lshlrev_b32 v94, 5, v94
v_and_b32 v95, 3, v28
v_lshlrev_b32 v95, 3, v95
v_xor_b32 v94, v94, v95
v_lshl_add_u32 v94, v93, 8, v94
v_add_u32 v6, s79, v94
v_xor_b32 v7, 0x20, v6
v_xor_b32 v8, 0x40, v6
v_xor_b32 v9, 0x60, v6
v_xor_b32 v10, 0x80, v6
v_xor_b32 v11, 0xa0, v6
v_xor_b32 v12, 0xc0, v6
v_xor_b32 v13, 0xe0, v6
v_lshlrev_b32 v31, 1, v29
v_xor_b32 v31, v31, v28
v_lshlrev_b32 v30, 8, v29
v_lshl_add_u32 v16, v31, 4, v30
v_xor_b32 v17, 0x80, v16
v_lshlrev_b32 v30, 8, v28
v_lshl_add_u32 v19, v29, 3, v30
s_cmp_eq_u64 s[40:41], 0
s_cbranch_scc1 L_chk2
s_mov_b32 s36, s12
s_mov_b32 s37, s13
s_mov_b32 s52, s4
s_mov_b32 s53, s5
s_mov_b32 s47, s28
s_mov_b32 s50, s63
s_mov_b32 s51, s72
s_mov_b32 s44, 0
s_branch L_slow
L_chk2:
s_cmp_eq_u64 s[42:43], 0
s_cbranch_scc1 L_end
s_mov_b32 s36, s16
s_mov_b32 s37, s17
s_mov_b32 s52, s8
s_mov_b32 s53, s9
s_mov_b32 s47, s29
s_mov_b32 s50, s58
s_mov_b32 s51, s73
s_mov_b32 s44, 1
L_slow:
s_mov_b32 s38, 155648
s_mov_b32 s39, 0x20000
s_mov_b32 s54, 155648
s_mov_b32 s55, 0x20000
s_add_u32 s45, s50, 0
v_add_u32 v22, s45, v18
buffer_load_dwordx4 a[0:3], v22, s[52:55], 0 offen offset:0
buffer_load_dwordx4 a[4:7], v22, s[52:55], 0 offen offset:64
buffer_load_dwordx4 a[8:11], v22, s[52:55], 0 offen offset:128
buffer_load_dwordx4 a[12:15], v22, s[52:55], 0 offen offset:192
s_add_u32 s45, s50, 4096
v_add_u32 v22, s45, v18
buffer_load_dwordx4 a[16:19], v22, s[52:55], 0 offen offset:0
buffer_load_dwordx4 a[20:23], v22, s[52:55], 0 offen offset:64
buffer_load_dwordx4 a[24:27], v22, s[52:55], 0 offen offset:128
buffer_load_dwordx4 a[28:31], v22, s[52:55], 0 offen offset:192
s_add_u32 s45, s50, 8192
v_add_u32 v22, s45, v18
buffer_load_dwordx4 a[32:35], v22, s[52:55], 0 offen offset:0
buffer_load_dwordx4 a[36:39], v22, s[52:55], 0 offen offset:64
buffer_load_dwordx4 a[40:43], v22, s[52:55], 0 offen offset:128
buffer_load_dwordx4 a[44:47], v22, s[52:55], 0 offen offset:192
s_add_u32 s45, s50, 12288
v_add_u32 v22, s45, v18
buffer_load_dwordx4 a[48:51], v22, s[52:55], 0 offen offset:0
buffer_load_dwordx4 a[52:55], v22, s[52:55], 0 offen offset:64
buffer_load_dwordx4 a[56:59], v22, s[52:55], 0 offen offset:128
buffer_load_dwordx4 a[60:63], v22, s[52:55], 0 offen offset:192
s_mov_b32 s45, s51
v_add_u32 v22, s45, v18
buffer_load_dwordx4 a[64:67], v22, s[52:55], 0 offen offset:0
buffer_load_dwordx4 a[68:71], v22, s[52:55], 0 offen offset:64
buffer_load_dwordx4 a[72:75], v22, s[52:55], 0 offen offset:128
buffer_load_dwordx4 a[76:79], v22, s[52:55], 0 offen offset:192
v_mov_b32 v23, 0xff800000
v_mov_b32 v24, 0xff800000
v_mov_b32 v25, 0xff800000
v_mov_b32 v26, 0xff800000
v_mov_b32 v27, 0xff800000
s_mov_b32 s48, s47
s_mov_b32 s45, 32
L_s1:
buffer_load_dwordx4 a[160:163], v18, s[20:23], s48 offen offset:0
buffer_load_dwordx4 a[164:167], v18, s[20:23], s48 offen offset:64
buffer_load_dwordx4 a[168:171], v18, s[20:23], s48 offen offset:128
buffer_load_dwordx4 a[172:175], v18, s[20:23], s48 offen offset:192
s_waitcnt vmcnt(0)
v_mfma_f32_16x16x32_bf16 v[48:51], a[160:163], a[0:3], 0
v_mfma_f32_16x16x32_bf16 v[48:51], a[164:167], a[4:7], v[48:51]
v_mfma_f32_16x16x32_bf16 v[48:51], a[168:171], a[8:11], v[48:51]
v_mfma_f32_16x16x32_bf16 v[48:51], a[172:175], a[12:15], v[48:51]
v_mfma_f32_16x16x32_bf16 v[52:55], a[160:163], a[16:19], 0
v_mfma_f32_16x16x32_bf16 v[52:55], a[164:167], a[20:23], v[52:55]
v_mfma_f32_16x16x32_bf16 v[52:55], a[168:171], a[24:27], v[52:55]
v_mfma_f32_16x16x32_bf16 v[52:55], a[172:175], a[28:31], v[52:55]
v_mfma_f32_16x16x32_bf16 v[56:59], a[160:163], a[32:35], 0
v_mfma_f32_16x16x32_bf16 v[56:59], a[164:167], a[36:39], v[56:59]
v_mfma_f32_16x16x32_bf16 v[56:59], a[168:171], a[40:43], v[56:59]
v_mfma_f32_16x16x32_bf16 v[56:59], a[172:175], a[44:47], v[56:59]
v_mfma_f32_16x16x32_bf16 v[60:63], a[160:163], a[48:51], 0
v_mfma_f32_16x16x32_bf16 v[60:63], a[164:167], a[52:55], v[60:63]
v_mfma_f32_16x16x32_bf16 v[60:63], a[168:171], a[56:59], v[60:63]
v_mfma_f32_16x16x32_bf16 v[60:63], a[172:175], a[60:63], v[60:63]
v_mfma_f32_16x16x32_bf16 v[64:67], a[160:163], a[64:67], 0
v_mfma_f32_16x16x32_bf16 v[64:67], a[164:167], a[68:71], v[64:67]
v_mfma_f32_16x16x32_bf16 v[64:67], a[168:171], a[72:75], v[64:67]
v_mfma_f32_16x16x32_bf16 v[64:67], a[172:175], a[76:79], v[64:67]
s_nop 7
s_nop 7
v_max3_f32 v23, v23, v48, v49
v_max3_f32 v23, v23, v50, v51
v_max3_f32 v24, v24, v52, v53
v_max3_f32 v24, v24, v54, v55
v_max3_f32 v25, v25, v56, v57
v_max3_f32 v25, v25, v58, v59
v_max3_f32 v26, v26, v60, v61
v_max3_f32 v26, v26, v62, v63
v_max3_f32 v27, v27, v64, v65
v_max3_f32 v27, v27, v66, v67
s_add_u32 s48, s48, 4096
s_sub_u32 s45, s45, 1
s_cmp_lg_u32 s45, 0
s_cbranch_scc1 L_s1
v_mov_b32 v93, v23
s_nop 1
v_permlane32_swap_b32 v93, v23
s_nop 1
v_max_f32 v23, v23, v93
v_mov_b32 v93, v23
s_nop 1
v_permlane16_swap_b32 v93, v23
s_nop 1
v_max_f32 v23, v23, v93
v_mul_f32 v23, 0xbe0293ee, v23
v_mov_b32 v93, v24
s_nop 1
v_permlane32_swap_b32 v93, v24
s_nop 1
v_max_f32 v24, v24, v93
v_mov_b32 v93, v24
s_nop 1
v_permlane16_swap_b32 v93, v24
s_nop 1
v_max_f32 v24, v24, v93
v_mul_f32 v24, 0xbe0293ee, v24
v_mov_b32 v93, v25
s_nop 1
v_permlane32_swap_b32 v93, v25
s_nop 1
v_max_f32 v25, v25, v93
v_mov_b32 v93, v25
s_nop 1
v_permlane16_swap_b32 v93, v25
s_nop 1
v_max_f32 v25, v25, v93
v_mul_f32 v25, 0xbe0293ee, v25
v_mov_b32 v93, v26
s_nop 1
v_permlane32_swap_b32 v93, v26
s_nop 1
v_max_f32 v26, v26, v93
v_mov_b32 v93, v26
s_nop 1
v_permlane16_swap_b32 v93, v26
s_nop 1
v_max_f32 v26, v26, v93
v_mul_f32 v26, 0xbe0293ee, v26
v_mov_b32 v93, v27
s_nop 1
v_permlane32_swap_b32 v93, v27
s_nop 1
v_max_f32 v27, v27, v93
v_mov_b32 v93, v27
s_nop 1
v_permlane16_swap_b32 v93, v27
s_nop 1
v_max_f32 v27, v27, v93
v_mul_f32 v27, 0xbe0293ee, v27
v_mov_b32 v96, 0
v_mov_b32 v97, 0
v_mov_b32 v98, 0
v_mov_b32 v99, 0
v_mov_b32 v100, 0
v_mov_b32 v101, 0
v_mov_b32 v102, 0
v_mov_b32 v103, 0
v_mov_b32 v104, 0
v_mov_b32 v105, 0
v_mov_b32 v106, 0
v_mov_b32 v107, 0
v_mov_b32 v108, 0
v_mov_b32 v109, 0
v_mov_b32 v110, 0
v_mov_b32 v111, 0
v_mov_b32 v112, 0
v_mov_b32 v113, 0
v_mov_b32 v114, 0
v_mov_b32 v115, 0
v_mov_b32 v116, 0
v_mov_b32 v117, 0
v_mov_b32 v118, 0
v_mov_b32 v119, 0
v_mov_b32 v120, 0
v_mov_b32 v121, 0
v_mov_b32 v122, 0
v_mov_b32 v123, 0
v_mov_b32 v124, 0
v_mov_b32 v125, 0
v_mov_b32 v126, 0
v_mov_b32 v127, 0
v_mov_b32 v128, 0
v_mov_b32 v129, 0
v_mov_b32 v130, 0
v_mov_b32 v131, 0
v_mov_b32 v132, 0
v_mov_b32 v133, 0
v_mov_b32 v134, 0
v_mov_b32 v135, 0
v_mov_b32 v136, 0
v_mov_b32 v137, 0
v_mov_b32 v138, 0
v_mov_b32 v139, 0
v_mov_b32 v140, 0
v_mov_b32 v141, 0
v_mov_b32 v142, 0
v_mov_b32 v143, 0
v_mov_b32 v144, 0
v_mov_b32 v145, 0
v_mov_b32 v146, 0
v_mov_b32 v147, 0
v_mov_b32 v148, 0
v_mov_b32 v149, 0
v_mov_b32 v150, 0
v_mov_b32 v151, 0
v_mov_b32 v152, 0
v_mov_b32 v153, 0
v_mov_b32 v154, 0
v_mov_b32 v155, 0
v_mov_b32 v156, 0
v_mov_b32 v157, 0
v_mov_b32 v158, 0
v_mov_b32 v159, 0
v_mov_b32 v160, 0
v_mov_b32 v161, 0
v_mov_b32 v162, 0
v_mov_b32 v163, 0
v_mov_b32 v164, 0
v_mov_b32 v165, 0
v_mov_b32 v166, 0
v_mov_b32 v167, 0
v_mov_b32 v168, 0
v_mov_b32 v169, 0
v_mov_b32 v170, 0
v_mov_b32 v171, 0
v_mov_b32 v172, 0
v_mov_b32 v173, 0
v_mov_b32 v174, 0
v_mov_b32 v175, 0
v_mov_b32 v176, 0
v_mov_b32 v177, 0
v_mov_b32 v178, 0
v_mov_b32 v179, 0
v_mov_b32 v180, 0
v_mov_b32 v181, 0
v_mov_b32 v182, 0
v_mov_b32 v183, 0
v_mov_b32 v184, 0
v_mov_b32 v185, 0
v_mov_b32 v186, 0
v_mov_b32 v187, 0
v_mov_b32 v188, 0
v_mov_b32 v189, 0
v_mov_b32 v190, 0
v_mov_b32 v191, 0
v_mov_b32 v192, 0
v_mov_b32 v193, 0
v_mov_b32 v194, 0
v_mov_b32 v195, 0
v_mov_b32 v196, 0
v_mov_b32 v197, 0
v_mov_b32 v198, 0
v_mov_b32 v199, 0
v_mov_b32 v200, 0
v_mov_b32 v201, 0
v_mov_b32 v202, 0
v_mov_b32 v203, 0
v_mov_b32 v204, 0
v_mov_b32 v205, 0
v_mov_b32 v206, 0
v_mov_b32 v207, 0
v_mov_b32 v208, 0
v_mov_b32 v209, 0
v_mov_b32 v210, 0
v_mov_b32 v211, 0
v_mov_b32 v212, 0
v_mov_b32 v213, 0
v_mov_b32 v214, 0
v_mov_b32 v215, 0
v_mov_b32 v216, 0
v_mov_b32 v217, 0
v_mov_b32 v218, 0
v_mov_b32 v219, 0
v_mov_b32 v220, 0
v_mov_b32 v221, 0
v_mov_b32 v222, 0
v_mov_b32 v223, 0
v_mov_b32 v224, 0
v_mov_b32 v225, 0
v_mov_b32 v226, 0
v_mov_b32 v227, 0
v_mov_b32 v228, 0
v_mov_b32 v229, 0
v_mov_b32 v230, 0
v_mov_b32 v231, 0
v_mov_b32 v232, 0
v_mov_b32 v233, 0
v_mov_b32 v234, 0
v_mov_b32 v235, 0
v_mov_b32 v236, 0
v_mov_b32 v237, 0
v_mov_b32 v238, 0
v_mov_b32 v239, 0
v_mov_b32 v240, 0
v_mov_b32 v241, 0
v_mov_b32 v242, 0
v_mov_b32 v243, 0
v_mov_b32 v244, 0
v_mov_b32 v245, 0
v_mov_b32 v246, 0
v_mov_b32 v247, 0
v_mov_b32 v248, 0
v_mov_b32 v249, 0
v_mov_b32 v250, 0
v_mov_b32 v251, 0
v_mov_b32 v252, 0
v_mov_b32 v253, 0
v_mov_b32 v254, 0
v_mov_b32 v255, 0
v_accvgpr_write_b32 a224, 0
v_accvgpr_write_b32 a225, 0
v_accvgpr_write_b32 a226, 0
v_accvgpr_write_b32 a227, 0
v_accvgpr_write_b32 a228, 0
v_accvgpr_write_b32 a229, 0
v_accvgpr_write_b32 a230, 0
v_accvgpr_write_b32 a231, 0
v_accvgpr_write_b32 a232, 0
v_accvgpr_write_b32 a233, 0
v_accvgpr_write_b32 a234, 0
v_accvgpr_write_b32 a235, 0
v_accvgpr_write_b32 a236, 0
v_accvgpr_write_b32 a237, 0
v_accvgpr_write_b32 a238, 0
v_accvgpr_write_b32 a239, 0
v_accvgpr_write_b32 a240, 0
v_accvgpr_write_b32 a241, 0
v_accvgpr_write_b32 a242, 0
v_accvgpr_write_b32 a243, 0
s_mov_b32 s48, s47
s_mov_b32 s45, 16
L_s2:
s_add_u32 s49, s48, 4096
buffer_load_dwordx4 a[160:163], v18, s[20:23], s48 offen offset:0
buffer_load_dwordx4 a[164:167], v18, s[20:23], s48 offen offset:64
buffer_load_dwordx4 a[168:171], v18, s[20:23], s48 offen offset:128
buffer_load_dwordx4 a[172:175], v18, s[20:23], s48 offen offset:192
buffer_load_dwordx4 a[176:179], v18, s[20:23], s49 offen offset:0
buffer_load_dwordx4 a[180:183], v18, s[20:23], s49 offen offset:64
buffer_load_dwordx4 a[184:187], v18, s[20:23], s49 offen offset:128
buffer_load_dwordx4 a[188:191], v18, s[20:23], s49 offen offset:192
s_add_u32 m0, s79, 0
s_nop 0
buffer_load_dwordx4 v16, s[24:27], s48 offen offset:0 lds
buffer_load_dwordx4 v17, s[24:27], s48 offen offset:1024 lds
buffer_load_dwordx4 v16, s[24:27], s48 offen offset:2048 lds
buffer_load_dwordx4 v17, s[24:27], s48 offen offset:3072 lds
s_add_u32 m0, s79, 4096
s_nop 0
buffer_load_dwordx4 v16, s[24:27], s49 offen offset:0 lds
buffer_load_dwordx4 v17, s[24:27], s49 offen offset:1024 lds
buffer_load_dwordx4 v16, s[24:27], s49 offen offset:2048 lds
buffer_load_dwordx4 v17, s[24:27], s49 offen offset:3072 lds
s_waitcnt vmcnt(0)
ds_read_b64_tr_b16 a[192:193], v6 offset:0
ds_read_b64_tr_b16 a[194:195], v6 offset:4096
ds_read_b64_tr_b16 a[196:197], v7 offset:0
ds_read_b64_tr_b16 a[198:199], v7 offset:4096
ds_read_b64_tr_b16 a[200:201], v8 offset:0
ds_read_b64_tr_b16 a[202:203], v8 offset:4096
ds_read_b64_tr_b16 a[204:205], v9 offset:0
ds_read_b64_tr_b16 a[206:207], v9 offset:4096
ds_read_b64_tr_b16 a[208:209], v10 offset:0
ds_read_b64_tr_b16 a[210:211], v10 offset:4096
ds_read_b64_tr_b16 a[212:213], v11 offset:0
ds_read_b64_tr_b16 a[214:215], v11 offset:4096
ds_read_b64_tr_b16 a[216:217], v12 offset:0
ds_read_b64_tr_b16 a[218:219], v12 offset:4096
ds_read_b64_tr_b16 a[220:221], v13 offset:0
ds_read_b64_tr_b16 a[222:223], v13 offset:4096
v_mfma_f32_16x16x32_bf16 v[48:51], a[160:163], a[0:3], 0
v_mfma_f32_16x16x32_bf16 v[48:51], a[164:167], a[4:7], v[48:51]
v_mfma_f32_16x16x32_bf16 v[48:51], a[168:171], a[8:11], v[48:51]
v_mfma_f32_16x16x32_bf16 v[48:51], a[172:175], a[12:15], v[48:51]
v_mfma_f32_16x16x32_bf16 v[52:55], a[176:179], a[0:3], 0
v_mfma_f32_16x16x32_bf16 v[52:55], a[180:183], a[4:7], v[52:55]
v_mfma_f32_16x16x32_bf16 v[52:55], a[184:187], a[8:11], v[52:55]
v_mfma_f32_16x16x32_bf16 v[52:55], a[188:191], a[12:15], v[52:55]
v_mfma_f32_16x16x32_bf16 v[56:59], a[160:163], a[16:19], 0
v_mfma_f32_16x16x32_bf16 v[56:59], a[164:167], a[20:23], v[56:59]
v_mfma_f32_16x16x32_bf16 v[56:59], a[168:171], a[24:27], v[56:59]
v_mfma_f32_16x16x32_bf16 v[56:59], a[172:175], a[28:31], v[56:59]
v_mfma_f32_16x16x32_bf16 v[60:63], a[176:179], a[16:19], 0
v_mfma_f32_16x16x32_bf16 v[60:63], a[180:183], a[20:23], v[60:63]
v_mfma_f32_16x16x32_bf16 v[60:63], a[184:187], a[24:27], v[60:63]
v_mfma_f32_16x16x32_bf16 v[60:63], a[188:191], a[28:31], v[60:63]
v_mfma_f32_16x16x32_bf16 v[64:67], a[160:163], a[32:35], 0
v_mfma_f32_16x16x32_bf16 v[64:67], a[164:167], a[36:39], v[64:67]
v_mfma_f32_16x16x32_bf16 v[64:67], a[168:171], a[40:43], v[64:67]
v_mfma_f32_16x16x32_bf16 v[64:67], a[172:175], a[44:47], v[64:67]
v_mfma_f32_16x16x32_bf16 v[68:71], a[176:179], a[32:35], 0
v_mfma_f32_16x16x32_bf16 v[68:71], a[180:183], a[36:39], v[68:71]
v_mfma_f32_16x16x32_bf16 v[68:71], a[184:187], a[40:43], v[68:71]
v_mfma_f32_16x16x32_bf16 v[68:71], a[188:191], a[44:47], v[68:71]
v_mfma_f32_16x16x32_bf16 v[72:75], a[160:163], a[48:51], 0
v_mfma_f32_16x16x32_bf16 v[72:75], a[164:167], a[52:55], v[72:75]
v_mfma_f32_16x16x32_bf16 v[72:75], a[168:171], a[56:59], v[72:75]
v_mfma_f32_16x16x32_bf16 v[72:75], a[172:175], a[60:63], v[72:75]
v_mfma_f32_16x16x32_bf16 v[76:79], a[176:179], a[48:51], 0
v_mfma_f32_16x16x32_bf16 v[76:79], a[180:183], a[52:55], v[76:79]
v_mfma_f32_16x16x32_bf16 v[76:79], a[184:187], a[56:59], v[76:79]
v_mfma_f32_16x16x32_bf16 v[76:79], a[188:191], a[60:63], v[76:79]
v_mfma_f32_16x16x32_bf16 v[80:83], a[160:163], a[64:67], 0
v_mfma_f32_16x16x32_bf16 v[80:83], a[164:167], a[68:71], v[80:83]
v_mfma_f32_16x16x32_bf16 v[80:83], a[168:171], a[72:75], v[80:83]
v_mfma_f32_16x16x32_bf16 v[80:83], a[172:175], a[76:79], v[80:83]
v_mfma_f32_16x16x32_bf16 v[84:87], a[176:179], a[64:67], 0
v_mfma_f32_16x16x32_bf16 v[84:87], a[180:183], a[68:71], v[84:87]
v_mfma_f32_16x16x32_bf16 v[84:87], a[184:187], a[72:75], v[84:87]
v_mfma_f32_16x16x32_bf16 v[84:87], a[188:191], a[76:79], v[84:87]
s_nop 7
s_nop 7
v_fmamk_f32 v48, v48, 0x3e0293ee, v23
v_fmamk_f32 v49, v49, 0x3e0293ee, v23
v_fmamk_f32 v50, v50, 0x3e0293ee, v23
v_fmamk_f32 v51, v51, 0x3e0293ee, v23
v_fmamk_f32 v52, v52, 0x3e0293ee, v23
v_fmamk_f32 v53, v53, 0x3e0293ee, v23
v_fmamk_f32 v54, v54, 0x3e0293ee, v23
v_fmamk_f32 v55, v55, 0x3e0293ee, v23
v_exp_f32 v48, v48
v_exp_f32 v49, v49
v_exp_f32 v50, v50
v_exp_f32 v51, v51
v_exp_f32 v52, v52
v_exp_f32 v53, v53
v_exp_f32 v54, v54
v_exp_f32 v55, v55
s_nop 0
v_cvt_pk_bf16_f32 v48, v48, v49
v_cvt_pk_bf16_f32 v49, v50, v51
v_cvt_pk_bf16_f32 v50, v52, v53
v_cvt_pk_bf16_f32 v51, v54, v55
v_fmamk_f32 v56, v56, 0x3e0293ee, v24
v_fmamk_f32 v57, v57, 0x3e0293ee, v24
v_fmamk_f32 v58, v58, 0x3e0293ee, v24
v_fmamk_f32 v59, v59, 0x3e0293ee, v24
v_fmamk_f32 v60, v60, 0x3e0293ee, v24
v_fmamk_f32 v61, v61, 0x3e0293ee, v24
v_fmamk_f32 v62, v62, 0x3e0293ee, v24
v_fmamk_f32 v63, v63, 0x3e0293ee, v24
v_exp_f32 v56, v56
v_exp_f32 v57, v57
v_exp_f32 v58, v58
v_exp_f32 v59, v59
v_exp_f32 v60, v60
v_exp_f32 v61, v61
v_exp_f32 v62, v62
v_exp_f32 v63, v63
s_nop 0
v_cvt_pk_bf16_f32 v56, v56, v57
v_cvt_pk_bf16_f32 v57, v58, v59
v_cvt_pk_bf16_f32 v58, v60, v61
v_cvt_pk_bf16_f32 v59, v62, v63
v_fmamk_f32 v64, v64, 0x3e0293ee, v25
v_fmamk_f32 v65, v65, 0x3e0293ee, v25
v_fmamk_f32 v66, v66, 0x3e0293ee, v25
v_fmamk_f32 v67, v67, 0x3e0293ee, v25
v_fmamk_f32 v68, v68, 0x3e0293ee, v25
v_fmamk_f32 v69, v69, 0x3e0293ee, v25
v_fmamk_f32 v70, v70, 0x3e0293ee, v25
v_fmamk_f32 v71, v71, 0x3e0293ee, v25
v_exp_f32 v64, v64
v_exp_f32 v65, v65
v_exp_f32 v66, v66
v_exp_f32 v67, v67
v_exp_f32 v68, v68
v_exp_f32 v69, v69
v_exp_f32 v70, v70
v_exp_f32 v71, v71
s_nop 0
v_cvt_pk_bf16_f32 v64, v64, v65
v_cvt_pk_bf16_f32 v65, v66, v67
v_cvt_pk_bf16_f32 v66, v68, v69
v_cvt_pk_bf16_f32 v67, v70, v71
v_fmamk_f32 v72, v72, 0x3e0293ee, v26
v_fmamk_f32 v73, v73, 0x3e0293ee, v26
v_fmamk_f32 v74, v74, 0x3e0293ee, v26
v_fmamk_f32 v75, v75, 0x3e0293ee, v26
v_fmamk_f32 v76, v76, 0x3e0293ee, v26
v_fmamk_f32 v77, v77, 0x3e0293ee, v26
v_fmamk_f32 v78, v78, 0x3e0293ee, v26
v_fmamk_f32 v79, v79, 0x3e0293ee, v26
v_exp_f32 v72, v72
v_exp_f32 v73, v73
v_exp_f32 v74, v74
v_exp_f32 v75, v75
v_exp_f32 v76, v76
v_exp_f32 v77, v77
v_exp_f32 v78, v78
v_exp_f32 v79, v79
s_nop 0
v_cvt_pk_bf16_f32 v72, v72, v73
v_cvt_pk_bf16_f32 v73, v74, v75
v_cvt_pk_bf16_f32 v74, v76, v77
v_cvt_pk_bf16_f32 v75, v78, v79
v_fmamk_f32 v80, v80, 0x3e0293ee, v27
v_fmamk_f32 v81, v81, 0x3e0293ee, v27
v_fmamk_f32 v82, v82, 0x3e0293ee, v27
v_fmamk_f32 v83, v83, 0x3e0293ee, v27
v_fmamk_f32 v84, v84, 0x3e0293ee, v27
v_fmamk_f32 v85, v85, 0x3e0293ee, v27
v_fmamk_f32 v86, v86, 0x3e0293ee, v27
v_fmamk_f32 v87, v87, 0x3e0293ee, v27
v_exp_f32 v80, v80
v_exp_f32 v81, v81
v_exp_f32 v82, v82
v_exp_f32 v83, v83
v_exp_f32 v84, v84
v_exp_f32 v85, v85
v_exp_f32 v86, v86
v_exp_f32 v87, v87
s_nop 0
v_cvt_pk_bf16_f32 v80, v80, v81
v_cvt_pk_bf16_f32 v81, v82, v83
v_cvt_pk_bf16_f32 v82, v84, v85
v_cvt_pk_bf16_f32 v83, v86, v87
s_waitcnt lgkmcnt(0)
s_nop 1
v_mfma_f32_16x16x32_bf16 v[96:99], a[192:195], v[48:51], v[96:99]
v_mfma_f32_16x16x32_bf16 v[100:103], a[196:199], v[48:51], v[100:103]
v_mfma_f32_16x16x32_bf16 v[104:107], a[200:203], v[48:51], v[104:107]
v_mfma_f32_16x16x32_bf16 v[108:111], a[204:207], v[48:51], v[108:111]
v_mfma_f32_16x16x32_bf16 v[112:115], a[208:211], v[48:51], v[112:115]
v_mfma_f32_16x16x32_bf16 v[116:119], a[212:215], v[48:51], v[116:119]
v_mfma_f32_16x16x32_bf16 v[120:123], a[216:219], v[48:51], v[120:123]
v_mfma_f32_16x16x32_bf16 v[124:127], a[220:223], v[48:51], v[124:127]
v_mfma_f32_16x16x32_bf16 a[224:227], a[244:247], v[48:51], a[224:227]
v_mfma_f32_16x16x32_bf16 v[128:131], a[192:195], v[56:59], v[128:131]
v_mfma_f32_16x16x32_bf16 v[132:135], a[196:199], v[56:59], v[132:135]
v_mfma_f32_16x16x32_bf16 v[136:139], a[200:203], v[56:59], v[136:139]
v_mfma_f32_16x16x32_bf16 v[140:143], a[204:207], v[56:59], v[140:143]
v_mfma_f32_16x16x32_bf16 v[144:147], a[208:211], v[56:59], v[144:147]
v_mfma_f32_16x16x32_bf16 v[148:151], a[212:215], v[56:59], v[148:151]
v_mfma_f32_16x16x32_bf16 v[152:155], a[216:219], v[56:59], v[152:155]
v_mfma_f32_16x16x32_bf16 v[156:159], a[220:223], v[56:59], v[156:159]
v_mfma_f32_16x16x32_bf16 a[228:231], a[244:247], v[56:59], a[228:231]
v_mfma_f32_16x16x32_bf16 v[160:163], a[192:195], v[64:67], v[160:163]
v_mfma_f32_16x16x32_bf16 v[164:167], a[196:199], v[64:67], v[164:167]
v_mfma_f32_16x16x32_bf16 v[168:171], a[200:203], v[64:67], v[168:171]
v_mfma_f32_16x16x32_bf16 v[172:175], a[204:207], v[64:67], v[172:175]
v_mfma_f32_16x16x32_bf16 v[176:179], a[208:211], v[64:67], v[176:179]
v_mfma_f32_16x16x32_bf16 v[180:183], a[212:215], v[64:67], v[180:183]
v_mfma_f32_16x16x32_bf16 v[184:187], a[216:219], v[64:67], v[184:187]
v_mfma_f32_16x16x32_bf16 v[188:191], a[220:223], v[64:67], v[188:191]
v_mfma_f32_16x16x32_bf16 a[232:235], a[244:247], v[64:67], a[232:235]
v_mfma_f32_16x16x32_bf16 v[192:195], a[192:195], v[72:75], v[192:195]
v_mfma_f32_16x16x32_bf16 v[196:199], a[196:199], v[72:75], v[196:199]
v_mfma_f32_16x16x32_bf16 v[200:203], a[200:203], v[72:75], v[200:203]
v_mfma_f32_16x16x32_bf16 v[204:207], a[204:207], v[72:75], v[204:207]
v_mfma_f32_16x16x32_bf16 v[208:211], a[208:211], v[72:75], v[208:211]
v_mfma_f32_16x16x32_bf16 v[212:215], a[212:215], v[72:75], v[212:215]
v_mfma_f32_16x16x32_bf16 v[216:219], a[216:219], v[72:75], v[216:219]
v_mfma_f32_16x16x32_bf16 v[220:223], a[220:223], v[72:75], v[220:223]
v_mfma_f32_16x16x32_bf16 a[236:239], a[244:247], v[72:75], a[236:239]
v_mfma_f32_16x16x32_bf16 v[224:227], a[192:195], v[80:83], v[224:227]
v_mfma_f32_16x16x32_bf16 v[228:231], a[196:199], v[80:83], v[228:231]
v_mfma_f32_16x16x32_bf16 v[232:235], a[200:203], v[80:83], v[232:235]
v_mfma_f32_16x16x32_bf16 v[236:239], a[204:207], v[80:83], v[236:239]
v_mfma_f32_16x16x32_bf16 v[240:243], a[208:211], v[80:83], v[240:243]
v_mfma_f32_16x16x32_bf16 v[244:247], a[212:215], v[80:83], v[244:247]
v_mfma_f32_16x16x32_bf16 v[248:251], a[216:219], v[80:83], v[248:251]
v_mfma_f32_16x16x32_bf16 v[252:255], a[220:223], v[80:83], v[252:255]
v_mfma_f32_16x16x32_bf16 a[240:243], a[244:247], v[80:83], a[240:243]
s_nop 7
s_nop 7
s_add_u32 s48, s48, 8192
s_sub_u32 s45, s45, 1
s_cmp_lg_u32 s45, 0
s_cbranch_scc1 L_s2
v_accvgpr_read_b32 v88, a224
s_add_u32 s45, s50, 0
v_rcp_f32 v88, v88
v_add_u32 v22, s45, v19
v_mul_f32 v96, v96, v88
v_mul_f32 v97, v97, v88
v_mul_f32 v98, v98, v88
v_mul_f32 v99, v99, v88
v_cvt_pk_bf16_f32 v96, v96, v97
v_cvt_pk_bf16_f32 v97, v98, v99
buffer_store_dwordx2 v[96:97], v22, s[36:39], 0 offen offset:0
v_mul_f32 v100, v100, v88
v_mul_f32 v101, v101, v88
v_mul_f32 v102, v102, v88
v_mul_f32 v103, v103, v88
v_cvt_pk_bf16_f32 v100, v100, v101
v_cvt_pk_bf16_f32 v101, v102, v103
buffer_store_dwordx2 v[100:101], v22, s[36:39], 0 offen offset:32
v_mul_f32 v104, v104, v88
v_mul_f32 v105, v105, v88
v_mul_f32 v106, v106, v88
v_mul_f32 v107, v107, v88
v_cvt_pk_bf16_f32 v104, v104, v105
v_cvt_pk_bf16_f32 v105, v106, v107
buffer_store_dwordx2 v[104:105], v22, s[36:39], 0 offen offset:64
v_mul_f32 v108, v108, v88
v_mul_f32 v109, v109, v88
v_mul_f32 v110, v110, v88
v_mul_f32 v111, v111, v88
v_cvt_pk_bf16_f32 v108, v108, v109
v_cvt_pk_bf16_f32 v109, v110, v111
buffer_store_dwordx2 v[108:109], v22, s[36:39], 0 offen offset:96
v_mul_f32 v112, v112, v88
v_mul_f32 v113, v113, v88
v_mul_f32 v114, v114, v88
v_mul_f32 v115, v115, v88
v_cvt_pk_bf16_f32 v112, v112, v113
v_cvt_pk_bf16_f32 v113, v114, v115
buffer_store_dwordx2 v[112:113], v22, s[36:39], 0 offen offset:128
v_mul_f32 v116, v116, v88
v_mul_f32 v117, v117, v88
v_mul_f32 v118, v118, v88
v_mul_f32 v119, v119, v88
v_cvt_pk_bf16_f32 v116, v116, v117
v_cvt_pk_bf16_f32 v117, v118, v119
buffer_store_dwordx2 v[116:117], v22, s[36:39], 0 offen offset:160
v_mul_f32 v120, v120, v88
v_mul_f32 v121, v121, v88
v_mul_f32 v122, v122, v88
v_mul_f32 v123, v123, v88
v_cvt_pk_bf16_f32 v120, v120, v121
v_cvt_pk_bf16_f32 v121, v122, v123
buffer_store_dwordx2 v[120:121], v22, s[36:39], 0 offen offset:192
v_mul_f32 v124, v124, v88
v_mul_f32 v125, v125, v88
v_mul_f32 v126, v126, v88
v_mul_f32 v127, v127, v88
v_cvt_pk_bf16_f32 v124, v124, v125
v_cvt_pk_bf16_f32 v125, v126, v127
buffer_store_dwordx2 v[124:125], v22, s[36:39], 0 offen offset:224
s_nop 1
v_accvgpr_read_b32 v88, a228
s_add_u32 s45, s50, 4096
v_rcp_f32 v88, v88
v_add_u32 v22, s45, v19
v_mul_f32 v128, v128, v88
v_mul_f32 v129, v129, v88
v_mul_f32 v130, v130, v88
v_mul_f32 v131, v131, v88
v_cvt_pk_bf16_f32 v128, v128, v129
v_cvt_pk_bf16_f32 v129, v130, v131
buffer_store_dwordx2 v[128:129], v22, s[36:39], 0 offen offset:0
v_mul_f32 v132, v132, v88
v_mul_f32 v133, v133, v88
v_mul_f32 v134, v134, v88
v_mul_f32 v135, v135, v88
v_cvt_pk_bf16_f32 v132, v132, v133
v_cvt_pk_bf16_f32 v133, v134, v135
buffer_store_dwordx2 v[132:133], v22, s[36:39], 0 offen offset:32
v_mul_f32 v136, v136, v88
v_mul_f32 v137, v137, v88
v_mul_f32 v138, v138, v88
v_mul_f32 v139, v139, v88
v_cvt_pk_bf16_f32 v136, v136, v137
v_cvt_pk_bf16_f32 v137, v138, v139
buffer_store_dwordx2 v[136:137], v22, s[36:39], 0 offen offset:64
v_mul_f32 v140, v140, v88
v_mul_f32 v141, v141, v88
v_mul_f32 v142, v142, v88
v_mul_f32 v143, v143, v88
v_cvt_pk_bf16_f32 v140, v140, v141
v_cvt_pk_bf16_f32 v141, v142, v143
buffer_store_dwordx2 v[140:141], v22, s[36:39], 0 offen offset:96
v_mul_f32 v144, v144, v88
v_mul_f32 v145, v145, v88
v_mul_f32 v146, v146, v88
v_mul_f32 v147, v147, v88
v_cvt_pk_bf16_f32 v144, v144, v145
v_cvt_pk_bf16_f32 v145, v146, v147
buffer_store_dwordx2 v[144:145], v22, s[36:39], 0 offen offset:128
v_mul_f32 v148, v148, v88
v_mul_f32 v149, v149, v88
v_mul_f32 v150, v150, v88
v_mul_f32 v151, v151, v88
v_cvt_pk_bf16_f32 v148, v148, v149
v_cvt_pk_bf16_f32 v149, v150, v151
buffer_store_dwordx2 v[148:149], v22, s[36:39], 0 offen offset:160
v_mul_f32 v152, v152, v88
v_mul_f32 v153, v153, v88
v_mul_f32 v154, v154, v88
v_mul_f32 v155, v155, v88
v_cvt_pk_bf16_f32 v152, v152, v153
v_cvt_pk_bf16_f32 v153, v154, v155
buffer_store_dwordx2 v[152:153], v22, s[36:39], 0 offen offset:192
v_mul_f32 v156, v156, v88
v_mul_f32 v157, v157, v88
v_mul_f32 v158, v158, v88
v_mul_f32 v159, v159, v88
v_cvt_pk_bf16_f32 v156, v156, v157
v_cvt_pk_bf16_f32 v157, v158, v159
buffer_store_dwordx2 v[156:157], v22, s[36:39], 0 offen offset:224
s_nop 1
v_accvgpr_read_b32 v88, a232
s_add_u32 s45, s50, 8192
v_rcp_f32 v88, v88
v_add_u32 v22, s45, v19
v_mul_f32 v160, v160, v88
v_mul_f32 v161, v161, v88
v_mul_f32 v162, v162, v88
v_mul_f32 v163, v163, v88
v_cvt_pk_bf16_f32 v160, v160, v161
v_cvt_pk_bf16_f32 v161, v162, v163
buffer_store_dwordx2 v[160:161], v22, s[36:39], 0 offen offset:0
v_mul_f32 v164, v164, v88
v_mul_f32 v165, v165, v88
v_mul_f32 v166, v166, v88
v_mul_f32 v167, v167, v88
v_cvt_pk_bf16_f32 v164, v164, v165
v_cvt_pk_bf16_f32 v165, v166, v167
buffer_store_dwordx2 v[164:165], v22, s[36:39], 0 offen offset:32
v_mul_f32 v168, v168, v88
v_mul_f32 v169, v169, v88
v_mul_f32 v170, v170, v88
v_mul_f32 v171, v171, v88
v_cvt_pk_bf16_f32 v168, v168, v169
v_cvt_pk_bf16_f32 v169, v170, v171
buffer_store_dwordx2 v[168:169], v22, s[36:39], 0 offen offset:64
v_mul_f32 v172, v172, v88
v_mul_f32 v173, v173, v88
v_mul_f32 v174, v174, v88
v_mul_f32 v175, v175, v88
v_cvt_pk_bf16_f32 v172, v172, v173
v_cvt_pk_bf16_f32 v173, v174, v175
buffer_store_dwordx2 v[172:173], v22, s[36:39], 0 offen offset:96
v_mul_f32 v176, v176, v88
v_mul_f32 v177, v177, v88
v_mul_f32 v178, v178, v88
v_mul_f32 v179, v179, v88
v_cvt_pk_bf16_f32 v176, v176, v177
v_cvt_pk_bf16_f32 v177, v178, v179
buffer_store_dwordx2 v[176:177], v22, s[36:39], 0 offen offset:128
v_mul_f32 v180, v180, v88
v_mul_f32 v181, v181, v88
v_mul_f32 v182, v182, v88
v_mul_f32 v183, v183, v88
v_cvt_pk_bf16_f32 v180, v180, v181
v_cvt_pk_bf16_f32 v181, v182, v183
buffer_store_dwordx2 v[180:181], v22, s[36:39], 0 offen offset:160
v_mul_f32 v184, v184, v88
v_mul_f32 v185, v185, v88
v_mul_f32 v186, v186, v88
v_mul_f32 v187, v187, v88
v_cvt_pk_bf16_f32 v184, v184, v185
v_cvt_pk_bf16_f32 v185, v186, v187
buffer_store_dwordx2 v[184:185], v22, s[36:39], 0 offen offset:192
v_mul_f32 v188, v188, v88
v_mul_f32 v189, v189, v88
v_mul_f32 v190, v190, v88
v_mul_f32 v191, v191, v88
v_cvt_pk_bf16_f32 v188, v188, v189
v_cvt_pk_bf16_f32 v189, v190, v191
buffer_store_dwordx2 v[188:189], v22, s[36:39], 0 offen offset:224
s_nop 1
v_accvgpr_read_b32 v88, a236
s_add_u32 s45, s50, 12288
v_rcp_f32 v88, v88
v_add_u32 v22, s45, v19
v_mul_f32 v192, v192, v88
v_mul_f32 v193, v193, v88
v_mul_f32 v194, v194, v88
v_mul_f32 v195, v195, v88
v_cvt_pk_bf16_f32 v192, v192, v193
v_cvt_pk_bf16_f32 v193, v194, v195
buffer_store_dwordx2 v[192:193], v22, s[36:39], 0 offen offset:0
v_mul_f32 v196, v196, v88
v_mul_f32 v197, v197, v88
v_mul_f32 v198, v198, v88
v_mul_f32 v199, v199, v88
v_cvt_pk_bf16_f32 v196, v196, v197
v_cvt_pk_bf16_f32 v197, v198, v199
buffer_store_dwordx2 v[196:197], v22, s[36:39], 0 offen offset:32
v_mul_f32 v200, v200, v88
v_mul_f32 v201, v201, v88
v_mul_f32 v202, v202, v88
v_mul_f32 v203, v203, v88
v_cvt_pk_bf16_f32 v200, v200, v201
v_cvt_pk_bf16_f32 v201, v202, v203
buffer_store_dwordx2 v[200:201], v22, s[36:39], 0 offen offset:64
v_mul_f32 v204, v204, v88
v_mul_f32 v205, v205, v88
v_mul_f32 v206, v206, v88
v_mul_f32 v207, v207, v88
v_cvt_pk_bf16_f32 v204, v204, v205
v_cvt_pk_bf16_f32 v205, v206, v207
buffer_store_dwordx2 v[204:205], v22, s[36:39], 0 offen offset:96
v_mul_f32 v208, v208, v88
v_mul_f32 v209, v209, v88
v_mul_f32 v210, v210, v88
v_mul_f32 v211, v211, v88
v_cvt_pk_bf16_f32 v208, v208, v209
v_cvt_pk_bf16_f32 v209, v210, v211
buffer_store_dwordx2 v[208:209], v22, s[36:39], 0 offen offset:128
v_mul_f32 v212, v212, v88
v_mul_f32 v213, v213, v88
v_mul_f32 v214, v214, v88
v_mul_f32 v215, v215, v88
v_cvt_pk_bf16_f32 v212, v212, v213
v_cvt_pk_bf16_f32 v213, v214, v215
buffer_store_dwordx2 v[212:213], v22, s[36:39], 0 offen offset:160
v_mul_f32 v216, v216, v88
v_mul_f32 v217, v217, v88
v_mul_f32 v218, v218, v88
v_mul_f32 v219, v219, v88
v_cvt_pk_bf16_f32 v216, v216, v217
v_cvt_pk_bf16_f32 v217, v218, v219
buffer_store_dwordx2 v[216:217], v22, s[36:39], 0 offen offset:192
v_mul_f32 v220, v220, v88
v_mul_f32 v221, v221, v88
v_mul_f32 v222, v222, v88
v_mul_f32 v223, v223, v88
v_cvt_pk_bf16_f32 v220, v220, v221
v_cvt_pk_bf16_f32 v221, v222, v223
buffer_store_dwordx2 v[220:221], v22, s[36:39], 0 offen offset:224
s_nop 1
v_accvgpr_read_b32 v88, a240
s_mov_b32 s45, s51
v_rcp_f32 v88, v88
v_add_u32 v22, s45, v19
v_mul_f32 v224, v224, v88
v_mul_f32 v225, v225, v88
v_mul_f32 v226, v226, v88
v_mul_f32 v227, v227, v88
v_cvt_pk_bf16_f32 v224, v224, v225
v_cvt_pk_bf16_f32 v225, v226, v227
buffer_store_dwordx2 v[224:225], v22, s[36:39], 0 offen offset:0
v_mul_f32 v228, v228, v88
v_mul_f32 v229, v229, v88
v_mul_f32 v230, v230, v88
v_mul_f32 v231, v231, v88
v_cvt_pk_bf16_f32 v228, v228, v229
v_cvt_pk_bf16_f32 v229, v230, v231
buffer_store_dwordx2 v[228:229], v22, s[36:39], 0 offen offset:32
v_mul_f32 v232, v232, v88
v_mul_f32 v233, v233, v88
v_mul_f32 v234, v234, v88
v_mul_f32 v235, v235, v88
v_cvt_pk_bf16_f32 v232, v232, v233
v_cvt_pk_bf16_f32 v233, v234, v235
buffer_store_dwordx2 v[232:233], v22, s[36:39], 0 offen offset:64
v_mul_f32 v236, v236, v88
v_mul_f32 v237, v237, v88
v_mul_f32 v238, v238, v88
v_mul_f32 v239, v239, v88
v_cvt_pk_bf16_f32 v236, v236, v237
v_cvt_pk_bf16_f32 v237, v238, v239
buffer_store_dwordx2 v[236:237], v22, s[36:39], 0 offen offset:96
v_mul_f32 v240, v240, v88
v_mul_f32 v241, v241, v88
v_mul_f32 v242, v242, v88
v_mul_f32 v243, v243, v88
v_cvt_pk_bf16_f32 v240, v240, v241
v_cvt_pk_bf16_f32 v241, v242, v243
buffer_store_dwordx2 v[240:241], v22, s[36:39], 0 offen offset:128
v_mul_f32 v244, v244, v88
v_mul_f32 v245, v245, v88
v_mul_f32 v246, v246, v88
v_mul_f32 v247, v247, v88
v_cvt_pk_bf16_f32 v244, v244, v245
v_cvt_pk_bf16_f32 v245, v246, v247
buffer_store_dwordx2 v[244:245], v22, s[36:39], 0 offen offset:160
v_mul_f32 v248, v248, v88
v_mul_f32 v249, v249, v88
v_mul_f32 v250, v250, v88
v_mul_f32 v251, v251, v88
v_cvt_pk_bf16_f32 v248, v248, v249
v_cvt_pk_bf16_f32 v249, v250, v251
buffer_store_dwordx2 v[248:249], v22, s[36:39], 0 offen offset:192
v_mul_f32 v252, v252, v88
v_mul_f32 v253, v253, v88
v_mul_f32 v254, v254, v88
v_mul_f32 v255, v255, v88
v_cvt_pk_bf16_f32 v252, v252, v253
v_cvt_pk_bf16_f32 v253, v254, v255
buffer_store_dwordx2 v[252:253], v22, s[36:39], 0 offen offset:224
s_nop 1
s_waitcnt vmcnt(0)
s_cmp_eq_u32 s44, 0
s_cbranch_scc1 L_chk2
L_end:
s_endpgm
.section .rodata,"a"
.p2align 6
.amdhsa_kernel standalone__mha_softmax__near_ridge_kernel
  .amdhsa_next_free_vgpr 512
  .amdhsa_next_free_sgpr 102
  .amdhsa_accum_offset 256
  .amdhsa_group_segment_fixed_size 0
  .amdhsa_kernarg_size 48
  .amdhsa_user_sgpr_count 2
  .amdhsa_user_sgpr_kernarg_segment_ptr 1
  .amdhsa_system_sgpr_workgroup_id_x 1
  .amdhsa_float_denorm_mode_32 3
.end_amdhsa_kernel
```
